```python
import torch

def _softmax(x, axis=-1):
    return torch.softmax(x, dim=axis)
def _gelu(x):
    return torch.nn.functional.gelu(x, approximate="tanh")
def _silu(x):
    return torch.nn.functional.silu(x)
def _sigmoid(x):
    return torch.sigmoid(x)
def _layernorm(x, axis=-1, eps=1e-5):
    m = x.mean(dim=axis, keepdim=True)
    v = x.var(dim=axis, keepdim=True, unbiased=False)
    return (x - m) / torch.sqrt(v + eps)
def _scatter_add(tgt, idx, src, axis=0):
    return tgt.clone().index_add_(axis, idx, src)
def _segment_sum(src, seg, n):
    out = torch.zeros((n,) + src.shape[1:], dtype=src.dtype)
    return out.index_add_(0, seg, src)
def _pad(x, pw):
    flat = tuple(v for pair in reversed(pw) for v in pair)
    return torch.nn.functional.pad(x, flat)

kernel_name = 'standalone__deep_cross_xdeepfm__recsys'

def setup_inputs():

    _w = (lambda a: (lambda t: t.to(torch.bfloat16) if t.is_floating_point() else t)(torch.as_tensor(a)))
    B, F, D, L = 4096, 26, 64, 3
    V = min(1000000, 100000)
    Din = F * D
    return {
        "idx": _w((lambda lo, hi, *s: torch.randint(lo, hi, s))(0, V, B, F).to(torch.int64)),
        "table": _w((lambda *s: torch.randn(*s, dtype=torch.bfloat16) * 0.8)(V, D)),
        "ws_cin": _w((lambda *s: torch.randn(*s, dtype=torch.bfloat16) * 0.2)(L, F, F, F) * (1.0 / F)),
        "w_cin_out": _w((lambda *s: torch.randn(*s, dtype=torch.bfloat16) * 0.2)(L * F) * ((L * F) ** -0.5)),
        "w_dnn1": _w((lambda *s: torch.randn(*s, dtype=torch.bfloat16) * 0.8)(Din, Din) * (Din ** -0.5)),
        "b_dnn1": _w((lambda *s: torch.randn(*s, dtype=torch.bfloat16) * 1.6)(Din) * 0.1),
        "w_dnn2": _w((lambda *s: torch.randn(*s, dtype=torch.bfloat16) * 0.2)(Din) * (Din ** -0.5)),
        "b_out": _w((lambda *s: torch.randn(*s, dtype=torch.bfloat16) * 0.2)(1)),
    }

def reference(idx, table, ws_cin, w_cin_out, w_dnn1, b_dnn1, w_dnn2, b_out):
    x0 = table[idx]
    B = x0.shape[0]
    L = ws_cin.shape[0]
    xk = x0
    pooled = []
    for l in range(L):
        xk = torch.einsum('bid,bjd,hij->bhd', xk, x0, ws_cin[l])
        pooled.append(xk.sum(axis=-1))
    p_plus = torch.stack(pooled, axis=1).reshape(B, -1)
    logit_cin = p_plus @ w_cin_out
    h = x0.reshape(B, -1)
    h = _gelu(h @ w_dnn1 + b_dnn1)
    logit_dnn = h @ w_dnn2
    return logit_cin + logit_dnn + b_out
```

```asm
; @launch grid=(256,1,1) block=(512,1,1) lds=163840
.amdgcn_target "amdgcn-amd-amdhsa--gfx950"
.text
.globl standalone__deep_cross_xdeepfm__recsys_kernel
.p2align 8
.type standalone__deep_cross_xdeepfm__recsys_kernel,@function
standalone__deep_cross_xdeepfm__recsys_kernel:
  s_cmp_ge_u32 s2, 256
  s_cbranch_scc1 L_end
  s_load_dwordx16 s[4:19], s[0:1], 0
  s_load_dwordx4 s[20:23], s[0:1], 64
  s_load_dwordx2 s[24:25], s[0:1], 80
  v_lshrrev_b32 v1, 6, v0
  s_getpc_b64 s[92:93]
L_pc:
  s_and_b32 s68, s2, 0xf8
  v_add_u32 v2, s68, v1
  v_and_b32 v3, 32, v0
  v_lshl_add_u32 v2, v3, 3, v2
  v_lshlrev_b32 v2, 7, v2
  v_min_u32 v2, L_end-L_pc, v2
  v_mov_b32 v3, s93
  v_add_co_u32 v2, vcc, s92, v2
  s_nop 1
  v_addc_co_u32 v3, vcc, 0, v3, vcc
  global_load_dword v251, v[2:3], off
  v_and_b32 v0, 63, v0
  v_readfirstlane_b32 s3, v1
  s_and_b32 s68, s2, 7
  s_lshr_b32 s69, s2, 3
  s_and_b32 s80, s2, 0xf8
  s_add_u32 s80, s80, s3
  s_lshl_b32 s80, s80, 21
  s_min_u32 s70, s68, 1
  s_add_u32 s71, s69, s70
  s_cmp_ge_u32 s71, 22
  s_cbranch_scc1 L_cin
  s_mul_i32 s68, s68, 21
  s_add_u32 s68, s68, s71
  s_mul_i32 s26, s68, 5042
  s_lshr_b32 s26, s26, 16
  s_mul_i32 s69, s26, 13
  s_sub_u32 s27, s68, s69
  s_lshl_b32 s77, s27, 8
  s_mul_i32 s71, s26, 320
  s_mul_i32 s70, s3, 7
  v_min_u32 v118, 6, v0
  v_add_u32 v118, s70, v118
  v_min_u32 v118, 51, v118
  v_lshrrev_b32 v116, 1, v118
  v_mul_u32_u24 v116, 96, v116
  v_lshl_add_u32 v118, v118, 2, v116
  s_mul_i32 s78, s27, 25
  s_min_u32 s78, s78, 294
  s_add_u32 s78, s78, s71
  s_mul_i32 s78, s78, 104
  v_lshrrev_b32 v116, 4, v0
  v_lshlrev_b32 v11, 4, v0
  s_and_b32 s79, s3, 3
  s_waitcnt lgkmcnt(0)
  s_mov_b32 s28, s4
  s_and_b32 s29, s5, 0xffff
  s_mov_b32 s30, 425984
  s_mov_b32 s31, 0x20000
  buffer_load_dwordx3 v[108:110], v118, s[28:31], s78 offen
  s_mov_b32 s32, s6
  s_and_b32 s33, s7, 0xffff
  s_mov_b32 s34, 12800000
  s_mov_b32 s35, 0x20000
  v_mov_b32 v114, s80
  buffer_load_dword v115, v114, s[32:35], 0 offen
  s_cmp_ge_u32 s3, 4
  s_cbranch_scc1 L_ld
  s_mov_b32 s48, s14
  s_and_b32 s49, s15, 0xffff
  s_mov_b32 s50, 3328
  s_mov_b32 s51, 0x20000
  s_mov_b32 m0, 147456
  s_mov_b64 exec, 0xffff
  buffer_load_dwordx4 v11, s[48:51], s77 offen lds
  s_mov_b64 exec, -1
  s_and_b32 s68, s3, 1
  s_lshr_b32 s69, s3, 1
  v_bfe_u32 v117, v0, 2, 2
  v_lshl_add_u32 v118, v116, 3, v117
  v_lshlrev_b32 v118, 8, v118
  v_bfe_u32 v117, v0, 2, 3
  s_lshl_b32 s70, s69, 2
  v_xor_b32 v117, s70, v117
  v_lshl_add_u32 v118, v117, 5, v118
  v_and_b32 v117, 3, v0
  v_lshl_add_u32 v118, v117, 3, v118
  v_add_u32 v1, 122880, v118
  v_xor_b32 v2, 32, v1
  v_xor_b32 v3, 64, v1
  v_xor_b32 v4, 96, v1
  s_lshl_b32 s70, s69, 7
  s_add_u32 s70, s70, 147456
  v_lshlrev_b32 v118, 3, v116
  v_add_u32 v9, s70, v118
  v_and_b32 v118, 15, v0
  v_lshlrev_b32 v118, 7, v118
  v_bfe_u32 v117, v0, 1, 3
  v_xor_b32 v117, v117, v116
  v_lshl_add_u32 v118, v117, 4, v118
  s_mul_i32 s70, s68, 20480
  v_add_u32 v5, s70, v118
  v_xor_b32 v7, 64, v5
  v_add_u32 v6, 81920, v5
  v_add_u32 v8, 81920, v7
  s_mul_i32 s70, s3, 640
  s_add_u32 s70, s70, 147968
  v_and_b32 v118, 15, v0
  v_lshlrev_b32 v118, 2, v118
  v_add_u32 v118, s70, v118
  v_lshrrev_b32 v117, 5, v0
  v_lshl_add_u32 v118, v117, 6, v118
  v_bfe_u32 v117, v0, 4, 1
  v_lshl_add_u32 v10, v117, 7, v118
  s_mov_b32 s72, 0
  v_mov_b32 v12, 0xc0135761
  v_mov_b32 v13, 0xc0135761
  v_mov_b32 v14, 0xbdd2d3e8
  v_mov_b32 v15, 0xbdd2d3e8
  v_mov_b32 v248, 1.0
  v_mov_b32 v249, 1.0
  s_waitcnt vmcnt(2)
  v_lshlrev_b32 v108, 7, v108
  buffer_load_dword v250, v108, s[32:35], 0 offen
  v_lshlrev_b32 v110, 7, v110
  buffer_load_dword v251, v110, s[32:35], 0 offen
  s_waitcnt vmcnt(2)
  ds_read_b64 v[18:19], v9 offset:0
  ds_read_b64 v[22:23], v9 offset:32
  ds_read_b64 v[26:27], v9 offset:64
  ds_read_b64 v[30:31], v9 offset:96
  s_waitcnt lgkmcnt(3)
  v_lshlrev_b32 v16, 16, v18
  v_and_b32 v17, 0xffff0000, v18
  v_lshlrev_b32 v18, 16, v19
  v_and_b32 v19, 0xffff0000, v19
  s_waitcnt lgkmcnt(2)
  v_lshlrev_b32 v20, 16, v22
  v_and_b32 v21, 0xffff0000, v22
  v_lshlrev_b32 v22, 16, v23
  v_and_b32 v23, 0xffff0000, v23
  s_waitcnt lgkmcnt(1)
  v_lshlrev_b32 v24, 16, v26
  v_and_b32 v25, 0xffff0000, v26
  v_lshlrev_b32 v26, 16, v27
  v_and_b32 v27, 0xffff0000, v27
  s_waitcnt lgkmcnt(0)
  v_lshlrev_b32 v28, 16, v30
  v_and_b32 v29, 0xffff0000, v30
  v_lshlrev_b32 v30, 16, v31
  v_and_b32 v31, 0xffff0000, v31
  s_waitcnt vmcnt(2)
  v_mov_b64 v[88:89], v[16:17]
  v_mov_b64 v[90:91], v[18:19]
  v_mov_b64 v[92:93], v[20:21]
  v_mov_b64 v[94:95], v[22:23]
  v_mov_b64 v[96:97], v[24:25]
  v_mov_b64 v[98:99], v[26:27]
  v_mov_b64 v[100:101], v[28:29]
  v_mov_b64 v[102:103], v[30:31]
  v_mov_b64 v[104:105], v[16:17]
  v_mov_b64 v[106:107], v[18:19]
  v_mov_b64 v[108:109], v[20:21]
  v_mov_b64 v[110:111], v[22:23]
  v_mov_b64 v[112:113], v[24:25]
  v_mov_b64 v[114:115], v[26:27]
  v_mov_b64 v[116:117], v[28:29]
  v_mov_b64 v[118:119], v[30:31]
  v_mov_b64 v[120:121], v[16:17]
  v_mov_b64 v[122:123], v[18:19]
  v_mov_b64 v[124:125], v[20:21]
  v_mov_b64 v[126:127], v[22:23]
  v_mov_b64 v[128:129], v[24:25]
  v_mov_b64 v[130:131], v[26:27]
  v_mov_b64 v[132:133], v[28:29]
  v_mov_b64 v[134:135], v[30:31]
  v_mov_b64 v[136:137], v[16:17]
  v_mov_b64 v[138:139], v[18:19]
  v_mov_b64 v[140:141], v[20:21]
  v_mov_b64 v[142:143], v[22:23]
  v_mov_b64 v[144:145], v[24:25]
  v_mov_b64 v[146:147], v[26:27]
  v_mov_b64 v[148:149], v[28:29]
  v_mov_b64 v[150:151], v[30:31]
  v_mov_b64 v[152:153], v[16:17]
  v_mov_b64 v[154:155], v[18:19]
  v_mov_b64 v[156:157], v[20:21]
  v_mov_b64 v[158:159], v[22:23]
  v_mov_b64 v[160:161], v[24:25]
  v_mov_b64 v[162:163], v[26:27]
  v_mov_b64 v[164:165], v[28:29]
  v_mov_b64 v[166:167], v[30:31]
  v_mov_b64 v[168:169], v[16:17]
  v_mov_b64 v[170:171], v[18:19]
  v_mov_b64 v[172:173], v[20:21]
  v_mov_b64 v[174:175], v[22:23]
  v_mov_b64 v[176:177], v[24:25]
  v_mov_b64 v[178:179], v[26:27]
  v_mov_b64 v[180:181], v[28:29]
  v_mov_b64 v[182:183], v[30:31]
  v_mov_b64 v[184:185], v[16:17]
  v_mov_b64 v[186:187], v[18:19]
  v_mov_b64 v[188:189], v[20:21]
  v_mov_b64 v[190:191], v[22:23]
  v_mov_b64 v[192:193], v[24:25]
  v_mov_b64 v[194:195], v[26:27]
  v_mov_b64 v[196:197], v[28:29]
  v_mov_b64 v[198:199], v[30:31]
  v_mov_b64 v[200:201], v[16:17]
  v_mov_b64 v[202:203], v[18:19]
  v_mov_b64 v[204:205], v[20:21]
  v_mov_b64 v[206:207], v[22:23]
  v_mov_b64 v[208:209], v[24:25]
  v_mov_b64 v[210:211], v[26:27]
  v_mov_b64 v[212:213], v[28:29]
  v_mov_b64 v[214:215], v[30:31]
  v_mov_b64 v[216:217], v[16:17]
  v_mov_b64 v[218:219], v[18:19]
  v_mov_b64 v[220:221], v[20:21]
  v_mov_b64 v[222:223], v[22:23]
  v_mov_b64 v[224:225], v[24:25]
  v_mov_b64 v[226:227], v[26:27]
  v_mov_b64 v[228:229], v[28:29]
  v_mov_b64 v[230:231], v[30:31]
  v_mov_b64 v[232:233], v[16:17]
  v_mov_b64 v[234:235], v[18:19]
  v_mov_b64 v[236:237], v[20:21]
  v_mov_b64 v[238:239], v[22:23]
  v_mov_b64 v[240:241], v[24:25]
  v_mov_b64 v[242:243], v[26:27]
  v_mov_b64 v[244:245], v[28:29]
  v_mov_b64 v[246:247], v[30:31]
  s_barrier
  s_setprio 1
  ds_read_b64_tr_b16 v[16:17], v1 offset:0
  ds_read_b64_tr_b16 v[18:19], v1 offset:1024
  ds_read_b128 v[48:51], v5 offset:0
  ds_read_b64_tr_b16 v[20:21], v2 offset:0
  ds_read_b64_tr_b16 v[22:23], v2 offset:1024
  ds_read_b64_tr_b16 v[24:25], v3 offset:0
  ds_read_b64_tr_b16 v[26:27], v3 offset:1024
  ds_read_b64_tr_b16 v[28:29], v4 offset:0
  ds_read_b64_tr_b16 v[30:31], v4 offset:1024
  ds_read_b128 v[52:55], v5 offset:2048
  ds_read_b128 v[56:59], v5 offset:4096
  ds_read_b128 v[60:63], v5 offset:6144
  ds_read_b128 v[64:67], v5 offset:8192
  ds_read_b128 v[68:71], v5 offset:10240
  ds_read_b128 v[72:75], v5 offset:12288
  ds_read_b128 v[76:79], v5 offset:14336
  ds_read_b128 v[80:83], v5 offset:16384
  ds_read_b128 v[84:87], v5 offset:18432
L_dnn_loop0:
  s_waitcnt lgkmcnt(14)
  v_mfma_f32_16x16x32_bf16 v[88:91], v[16:19], v[48:51], v[88:91]
  s_waitcnt lgkmcnt(13)
  v_mfma_f32_16x16x32_bf16 v[92:95], v[20:23], v[48:51], v[92:95]
  s_waitcnt lgkmcnt(11)
  v_mfma_f32_16x16x32_bf16 v[96:99], v[24:27], v[48:51], v[96:99]
  s_waitcnt lgkmcnt(9)
  v_mfma_f32_16x16x32_bf16 v[100:103], v[28:31], v[48:51], v[100:103]
  s_waitcnt lgkmcnt(8)
  v_mfma_f32_16x16x32_bf16 v[116:119], v[28:31], v[52:55], v[116:119]
  v_mfma_f32_16x16x32_bf16 v[112:115], v[24:27], v[52:55], v[112:115]
  v_mfma_f32_16x16x32_bf16 v[108:111], v[20:23], v[52:55], v[108:111]
  v_mfma_f32_16x16x32_bf16 v[104:107], v[16:19], v[52:55], v[104:107]
  s_waitcnt lgkmcnt(0)
  s_barrier
  v_mfma_f32_16x16x32_bf16 v[120:123], v[16:19], v[56:59], v[120:123]
  ds_read_b128 v[48:51], v7 offset:0
  v_mfma_f32_16x16x32_bf16 v[124:127], v[20:23], v[56:59], v[124:127]
  ds_read_b128 v[52:55], v7 offset:2048
  v_mfma_f32_16x16x32_bf16 v[128:131], v[24:27], v[56:59], v[128:131]
  ds_read_b64_tr_b16 v[32:33], v1 offset:8192
  v_mfma_f32_16x16x32_bf16 v[132:135], v[28:31], v[56:59], v[132:135]
  ds_read_b128 v[56:59], v7 offset:4096
  v_mfma_f32_16x16x32_bf16 v[148:151], v[28:31], v[60:63], v[148:151]
  ds_read_b64_tr_b16 v[34:35], v1 offset:9216
  v_mfma_f32_16x16x32_bf16 v[144:147], v[24:27], v[60:63], v[144:147]
  ds_read_b64_tr_b16 v[36:37], v2 offset:8192
  v_mfma_f32_16x16x32_bf16 v[140:143], v[20:23], v[60:63], v[140:143]
  ds_read_b64_tr_b16 v[38:39], v2 offset:9216
  v_mfma_f32_16x16x32_bf16 v[136:139], v[16:19], v[60:63], v[136:139]
  ds_read_b128 v[60:63], v7 offset:6144
  v_mfma_f32_16x16x32_bf16 v[152:155], v[16:19], v[64:67], v[152:155]
  ds_read_b64_tr_b16 v[40:41], v3 offset:8192
  v_mfma_f32_16x16x32_bf16 v[156:159], v[20:23], v[64:67], v[156:159]
  ds_read_b64_tr_b16 v[42:43], v3 offset:9216
  v_mfma_f32_16x16x32_bf16 v[160:163], v[24:27], v[64:67], v[160:163]
  ds_read_b64_tr_b16 v[44:45], v4 offset:8192
  v_mfma_f32_16x16x32_bf16 v[164:167], v[28:31], v[64:67], v[164:167]
  ds_read_b128 v[64:67], v7 offset:8192
  v_mfma_f32_16x16x32_bf16 v[180:183], v[28:31], v[68:71], v[180:183]
  ds_read_b64_tr_b16 v[46:47], v4 offset:9216
  v_mfma_f32_16x16x32_bf16 v[176:179], v[24:27], v[68:71], v[176:179]
  v_mfma_f32_16x16x32_bf16 v[172:175], v[20:23], v[68:71], v[172:175]
  v_mfma_f32_16x16x32_bf16 v[168:171], v[16:19], v[68:71], v[168:171]
  ds_read_b128 v[68:71], v7 offset:10240
  v_mfma_f32_16x16x32_bf16 v[184:187], v[16:19], v[72:75], v[184:187]
  v_mfma_f32_16x16x32_bf16 v[188:191], v[20:23], v[72:75], v[188:191]
  v_mfma_f32_16x16x32_bf16 v[192:195], v[24:27], v[72:75], v[192:195]
  v_mfma_f32_16x16x32_bf16 v[196:199], v[28:31], v[72:75], v[196:199]
  ds_read_b128 v[72:75], v7 offset:12288
  v_mfma_f32_16x16x32_bf16 v[212:215], v[28:31], v[76:79], v[212:215]
  v_mfma_f32_16x16x32_bf16 v[208:211], v[24:27], v[76:79], v[208:211]
  v_mfma_f32_16x16x32_bf16 v[204:207], v[20:23], v[76:79], v[204:207]
  v_mfma_f32_16x16x32_bf16 v[200:203], v[16:19], v[76:79], v[200:203]
  ds_read_b128 v[76:79], v7 offset:14336
  v_mfma_f32_16x16x32_bf16 v[216:219], v[16:19], v[80:83], v[216:219]
  v_mfma_f32_16x16x32_bf16 v[220:223], v[20:23], v[80:83], v[220:223]
  v_mfma_f32_16x16x32_bf16 v[224:227], v[24:27], v[80:83], v[224:227]
  v_mfma_f32_16x16x32_bf16 v[228:231], v[28:31], v[80:83], v[228:231]
  ds_read_b128 v[80:83], v7 offset:16384
  v_mfma_f32_16x16x32_bf16 v[244:247], v[28:31], v[84:87], v[244:247]
  s_waitcnt lgkmcnt(4)
  v_mfma_f32_16x16x32_bf16 v[240:243], v[24:27], v[84:87], v[240:243]
  v_mfma_f32_16x16x32_bf16 v[236:239], v[20:23], v[84:87], v[236:239]
  v_mfma_f32_16x16x32_bf16 v[232:235], v[16:19], v[84:87], v[232:235]
  ds_read_b128 v[84:87], v7 offset:18432
  v_mfma_f32_16x16x32_bf16 v[88:91], v[32:35], v[48:51], v[88:91]
  v_mfma_f32_16x16x32_bf16 v[92:95], v[36:39], v[48:51], v[92:95]
  v_mfma_f32_16x16x32_bf16 v[96:99], v[40:43], v[48:51], v[96:99]
  v_mfma_f32_16x16x32_bf16 v[100:103], v[44:47], v[48:51], v[100:103]
  v_mfma_f32_16x16x32_bf16 v[116:119], v[44:47], v[52:55], v[116:119]
  v_mfma_f32_16x16x32_bf16 v[112:115], v[40:43], v[52:55], v[112:115]
  v_mfma_f32_16x16x32_bf16 v[108:111], v[36:39], v[52:55], v[108:111]
  v_mfma_f32_16x16x32_bf16 v[104:107], v[32:35], v[52:55], v[104:107]
  s_waitcnt lgkmcnt(0)
  s_barrier
  v_mfma_f32_16x16x32_bf16 v[120:123], v[32:35], v[56:59], v[120:123]
  ds_read_b128 v[48:51], v5 offset:40960
  v_mfma_f32_16x16x32_bf16 v[124:127], v[36:39], v[56:59], v[124:127]
  ds_read_b128 v[52:55], v5 offset:43008
  v_mfma_f32_16x16x32_bf16 v[128:131], v[40:43], v[56:59], v[128:131]
  ds_read_b64_tr_b16 v[16:17], v1 offset:16384
  v_mfma_f32_16x16x32_bf16 v[132:135], v[44:47], v[56:59], v[132:135]
  ds_read_b128 v[56:59], v5 offset:45056
  v_mfma_f32_16x16x32_bf16 v[148:151], v[44:47], v[60:63], v[148:151]
  ds_read_b64_tr_b16 v[18:19], v1 offset:17408
  v_mfma_f32_16x16x32_bf16 v[144:147], v[40:43], v[60:63], v[144:147]
  ds_read_b64_tr_b16 v[20:21], v2 offset:16384
  v_mfma_f32_16x16x32_bf16 v[140:143], v[36:39], v[60:63], v[140:143]
  ds_read_b64_tr_b16 v[22:23], v2 offset:17408
  v_mfma_f32_16x16x32_bf16 v[136:139], v[32:35], v[60:63], v[136:139]
  ds_read_b128 v[60:63], v5 offset:47104
  v_mfma_f32_16x16x32_bf16 v[152:155], v[32:35], v[64:67], v[152:155]
  ds_read_b64_tr_b16 v[24:25], v3 offset:16384
  v_mfma_f32_16x16x32_bf16 v[156:159], v[36:39], v[64:67], v[156:159]
  ds_read_b64_tr_b16 v[26:27], v3 offset:17408
  v_mfma_f32_16x16x32_bf16 v[160:163], v[40:43], v[64:67], v[160:163]
  ds_read_b64_tr_b16 v[28:29], v4 offset:16384
  v_mfma_f32_16x16x32_bf16 v[164:167], v[44:47], v[64:67], v[164:167]
  ds_read_b128 v[64:67], v5 offset:49152
  v_mfma_f32_16x16x32_bf16 v[180:183], v[44:47], v[68:71], v[180:183]
  ds_read_b64_tr_b16 v[30:31], v4 offset:17408
  v_mfma_f32_16x16x32_bf16 v[176:179], v[40:43], v[68:71], v[176:179]
  v_mfma_f32_16x16x32_bf16 v[172:175], v[36:39], v[68:71], v[172:175]
  v_mfma_f32_16x16x32_bf16 v[168:171], v[32:35], v[68:71], v[168:171]
  ds_read_b128 v[68:71], v5 offset:51200
  v_mfma_f32_16x16x32_bf16 v[184:187], v[32:35], v[72:75], v[184:187]
  v_mfma_f32_16x16x32_bf16 v[188:191], v[36:39], v[72:75], v[188:191]
  v_mfma_f32_16x16x32_bf16 v[192:195], v[40:43], v[72:75], v[192:195]
  v_mfma_f32_16x16x32_bf16 v[196:199], v[44:47], v[72:75], v[196:199]
  ds_read_b128 v[72:75], v5 offset:53248
  v_mfma_f32_16x16x32_bf16 v[212:215], v[44:47], v[76:79], v[212:215]
  v_mfma_f32_16x16x32_bf16 v[208:211], v[40:43], v[76:79], v[208:211]
  v_mfma_f32_16x16x32_bf16 v[204:207], v[36:39], v[76:79], v[204:207]
  v_mfma_f32_16x16x32_bf16 v[200:203], v[32:35], v[76:79], v[200:203]
  ds_read_b128 v[76:79], v5 offset:55296
  v_mfma_f32_16x16x32_bf16 v[216:219], v[32:35], v[80:83], v[216:219]
  v_mfma_f32_16x16x32_bf16 v[220:223], v[36:39], v[80:83], v[220:223]
  v_mfma_f32_16x16x32_bf16 v[224:227], v[40:43], v[80:83], v[224:227]
  v_mfma_f32_16x16x32_bf16 v[228:231], v[44:47], v[80:83], v[228:231]
  ds_read_b128 v[80:83], v5 offset:57344
  v_mfma_f32_16x16x32_bf16 v[244:247], v[44:47], v[84:87], v[244:247]
  s_waitcnt lgkmcnt(4)
  v_mfma_f32_16x16x32_bf16 v[240:243], v[40:43], v[84:87], v[240:243]
  v_mfma_f32_16x16x32_bf16 v[236:239], v[36:39], v[84:87], v[236:239]
  v_mfma_f32_16x16x32_bf16 v[232:235], v[32:35], v[84:87], v[232:235]
  ds_read_b128 v[84:87], v5 offset:59392
  v_mfma_f32_16x16x32_bf16 v[88:91], v[16:19], v[48:51], v[88:91]
  v_mfma_f32_16x16x32_bf16 v[92:95], v[20:23], v[48:51], v[92:95]
  v_mfma_f32_16x16x32_bf16 v[96:99], v[24:27], v[48:51], v[96:99]
  v_mfma_f32_16x16x32_bf16 v[100:103], v[28:31], v[48:51], v[100:103]
  v_mfma_f32_16x16x32_bf16 v[116:119], v[28:31], v[52:55], v[116:119]
  v_mfma_f32_16x16x32_bf16 v[112:115], v[24:27], v[52:55], v[112:115]
  v_mfma_f32_16x16x32_bf16 v[108:111], v[20:23], v[52:55], v[108:111]
  v_mfma_f32_16x16x32_bf16 v[104:107], v[16:19], v[52:55], v[104:107]
  s_waitcnt lgkmcnt(0)
  s_barrier
  v_mfma_f32_16x16x32_bf16 v[120:123], v[16:19], v[56:59], v[120:123]
  ds_read_b128 v[48:51], v7 offset:40960
  v_mfma_f32_16x16x32_bf16 v[124:127], v[20:23], v[56:59], v[124:127]
  ds_read_b128 v[52:55], v7 offset:43008
  v_mfma_f32_16x16x32_bf16 v[128:131], v[24:27], v[56:59], v[128:131]
  ds_read_b64_tr_b16 v[32:33], v1 offset:0
  v_mfma_f32_16x16x32_bf16 v[132:135], v[28:31], v[56:59], v[132:135]
  ds_read_b128 v[56:59], v7 offset:45056
  v_mfma_f32_16x16x32_bf16 v[148:151], v[28:31], v[60:63], v[148:151]
  ds_read_b64_tr_b16 v[34:35], v1 offset:1024
  v_mfma_f32_16x16x32_bf16 v[144:147], v[24:27], v[60:63], v[144:147]
  ds_read_b64_tr_b16 v[36:37], v2 offset:0
  v_mfma_f32_16x16x32_bf16 v[140:143], v[20:23], v[60:63], v[140:143]
  ds_read_b64_tr_b16 v[38:39], v2 offset:1024
  v_mfma_f32_16x16x32_bf16 v[136:139], v[16:19], v[60:63], v[136:139]
  ds_read_b128 v[60:63], v7 offset:47104
  v_mfma_f32_16x16x32_bf16 v[152:155], v[16:19], v[64:67], v[152:155]
  ds_read_b64_tr_b16 v[40:41], v3 offset:0
  v_mfma_f32_16x16x32_bf16 v[156:159], v[20:23], v[64:67], v[156:159]
  ds_read_b64_tr_b16 v[42:43], v3 offset:1024
  v_mfma_f32_16x16x32_bf16 v[160:163], v[24:27], v[64:67], v[160:163]
  ds_read_b64_tr_b16 v[44:45], v4 offset:0
  v_mfma_f32_16x16x32_bf16 v[164:167], v[28:31], v[64:67], v[164:167]
  ds_read_b128 v[64:67], v7 offset:49152
  v_mfma_f32_16x16x32_bf16 v[180:183], v[28:31], v[68:71], v[180:183]
  ds_read_b64_tr_b16 v[46:47], v4 offset:1024
  v_mfma_f32_16x16x32_bf16 v[176:179], v[24:27], v[68:71], v[176:179]
  v_mfma_f32_16x16x32_bf16 v[172:175], v[20:23], v[68:71], v[172:175]
  v_mfma_f32_16x16x32_bf16 v[168:171], v[16:19], v[68:71], v[168:171]
  ds_read_b128 v[68:71], v7 offset:51200
  v_mfma_f32_16x16x32_bf16 v[184:187], v[16:19], v[72:75], v[184:187]
  v_mfma_f32_16x16x32_bf16 v[188:191], v[20:23], v[72:75], v[188:191]
  v_mfma_f32_16x16x32_bf16 v[192:195], v[24:27], v[72:75], v[192:195]
  v_mfma_f32_16x16x32_bf16 v[196:199], v[28:31], v[72:75], v[196:199]
  ds_read_b128 v[72:75], v7 offset:53248
  v_mfma_f32_16x16x32_bf16 v[212:215], v[28:31], v[76:79], v[212:215]
  v_mfma_f32_16x16x32_bf16 v[208:211], v[24:27], v[76:79], v[208:211]
  v_mfma_f32_16x16x32_bf16 v[204:207], v[20:23], v[76:79], v[204:207]
  v_mfma_f32_16x16x32_bf16 v[200:203], v[16:19], v[76:79], v[200:203]
  ds_read_b128 v[76:79], v7 offset:55296
  v_mfma_f32_16x16x32_bf16 v[216:219], v[16:19], v[80:83], v[216:219]
  v_mfma_f32_16x16x32_bf16 v[220:223], v[20:23], v[80:83], v[220:223]
  v_mfma_f32_16x16x32_bf16 v[224:227], v[24:27], v[80:83], v[224:227]
  v_mfma_f32_16x16x32_bf16 v[228:231], v[28:31], v[80:83], v[228:231]
  ds_read_b128 v[80:83], v7 offset:57344
  v_mfma_f32_16x16x32_bf16 v[244:247], v[28:31], v[84:87], v[244:247]
  s_waitcnt lgkmcnt(4)
  v_mfma_f32_16x16x32_bf16 v[240:243], v[24:27], v[84:87], v[240:243]
  v_mfma_f32_16x16x32_bf16 v[236:239], v[20:23], v[84:87], v[236:239]
  v_mfma_f32_16x16x32_bf16 v[232:235], v[16:19], v[84:87], v[232:235]
  ds_read_b128 v[84:87], v7 offset:59392
  v_mfma_f32_16x16x32_bf16 v[88:91], v[32:35], v[48:51], v[88:91]
  v_mfma_f32_16x16x32_bf16 v[92:95], v[36:39], v[48:51], v[92:95]
  v_mfma_f32_16x16x32_bf16 v[96:99], v[40:43], v[48:51], v[96:99]
  v_mfma_f32_16x16x32_bf16 v[100:103], v[44:47], v[48:51], v[100:103]
  v_mfma_f32_16x16x32_bf16 v[116:119], v[44:47], v[52:55], v[116:119]
  v_mfma_f32_16x16x32_bf16 v[112:115], v[40:43], v[52:55], v[112:115]
  v_mfma_f32_16x16x32_bf16 v[108:111], v[36:39], v[52:55], v[108:111]
  v_mfma_f32_16x16x32_bf16 v[104:107], v[32:35], v[52:55], v[104:107]
  s_waitcnt lgkmcnt(0)
  s_barrier
  v_mfma_f32_16x16x32_bf16 v[120:123], v[32:35], v[56:59], v[120:123]
  ds_read_b128 v[48:51], v6 offset:0
  v_mfma_f32_16x16x32_bf16 v[124:127], v[36:39], v[56:59], v[124:127]
  ds_read_b128 v[52:55], v6 offset:2048
  v_mfma_f32_16x16x32_bf16 v[128:131], v[40:43], v[56:59], v[128:131]
  ds_read_b64_tr_b16 v[16:17], v1 offset:8192
  v_mfma_f32_16x16x32_bf16 v[132:135], v[44:47], v[56:59], v[132:135]
  ds_read_b128 v[56:59], v6 offset:4096
  v_mfma_f32_16x16x32_bf16 v[148:151], v[44:47], v[60:63], v[148:151]
  ds_read_b64_tr_b16 v[18:19], v1 offset:9216
  v_mfma_f32_16x16x32_bf16 v[144:147], v[40:43], v[60:63], v[144:147]
  ds_read_b64_tr_b16 v[20:21], v2 offset:8192
  v_mfma_f32_16x16x32_bf16 v[140:143], v[36:39], v[60:63], v[140:143]
  ds_read_b64_tr_b16 v[22:23], v2 offset:9216
  v_mfma_f32_16x16x32_bf16 v[136:139], v[32:35], v[60:63], v[136:139]
  ds_read_b128 v[60:63], v6 offset:6144
  v_mfma_f32_16x16x32_bf16 v[152:155], v[32:35], v[64:67], v[152:155]
  ds_read_b64_tr_b16 v[24:25], v3 offset:8192
  v_mfma_f32_16x16x32_bf16 v[156:159], v[36:39], v[64:67], v[156:159]
  ds_read_b64_tr_b16 v[26:27], v3 offset:9216
  v_mfma_f32_16x16x32_bf16 v[160:163], v[40:43], v[64:67], v[160:163]
  ds_read_b64_tr_b16 v[28:29], v4 offset:8192
  v_mfma_f32_16x16x32_bf16 v[164:167], v[44:47], v[64:67], v[164:167]
  ds_read_b128 v[64:67], v6 offset:8192
  v_mfma_f32_16x16x32_bf16 v[180:183], v[44:47], v[68:71], v[180:183]
  ds_read_b64_tr_b16 v[30:31], v4 offset:9216
  v_mfma_f32_16x16x32_bf16 v[176:179], v[40:43], v[68:71], v[176:179]
  v_mfma_f32_16x16x32_bf16 v[172:175], v[36:39], v[68:71], v[172:175]
  v_mfma_f32_16x16x32_bf16 v[168:171], v[32:35], v[68:71], v[168:171]
  ds_read_b128 v[68:71], v6 offset:10240
  v_mfma_f32_16x16x32_bf16 v[184:187], v[32:35], v[72:75], v[184:187]
  v_mfma_f32_16x16x32_bf16 v[188:191], v[36:39], v[72:75], v[188:191]
  v_mfma_f32_16x16x32_bf16 v[192:195], v[40:43], v[72:75], v[192:195]
  v_mfma_f32_16x16x32_bf16 v[196:199], v[44:47], v[72:75], v[196:199]
  ds_read_b128 v[72:75], v6 offset:12288
  v_mfma_f32_16x16x32_bf16 v[212:215], v[44:47], v[76:79], v[212:215]
  v_mfma_f32_16x16x32_bf16 v[208:211], v[40:43], v[76:79], v[208:211]
  v_mfma_f32_16x16x32_bf16 v[204:207], v[36:39], v[76:79], v[204:207]
  v_mfma_f32_16x16x32_bf16 v[200:203], v[32:35], v[76:79], v[200:203]
  ds_read_b128 v[76:79], v6 offset:14336
  v_mfma_f32_16x16x32_bf16 v[216:219], v[32:35], v[80:83], v[216:219]
  v_mfma_f32_16x16x32_bf16 v[220:223], v[36:39], v[80:83], v[220:223]
  v_mfma_f32_16x16x32_bf16 v[224:227], v[40:43], v[80:83], v[224:227]
  v_mfma_f32_16x16x32_bf16 v[228:231], v[44:47], v[80:83], v[228:231]
  ds_read_b128 v[80:83], v6 offset:16384
  v_mfma_f32_16x16x32_bf16 v[244:247], v[44:47], v[84:87], v[244:247]
  s_waitcnt lgkmcnt(4)
  v_mfma_f32_16x16x32_bf16 v[240:243], v[40:43], v[84:87], v[240:243]
  v_mfma_f32_16x16x32_bf16 v[236:239], v[36:39], v[84:87], v[236:239]
  v_mfma_f32_16x16x32_bf16 v[232:235], v[32:35], v[84:87], v[232:235]
  ds_read_b128 v[84:87], v6 offset:18432
  v_mfma_f32_16x16x32_bf16 v[88:91], v[16:19], v[48:51], v[88:91]
  v_mfma_f32_16x16x32_bf16 v[92:95], v[20:23], v[48:51], v[92:95]
  v_mfma_f32_16x16x32_bf16 v[96:99], v[24:27], v[48:51], v[96:99]
  v_mfma_f32_16x16x32_bf16 v[100:103], v[28:31], v[48:51], v[100:103]
  v_mfma_f32_16x16x32_bf16 v[116:119], v[28:31], v[52:55], v[116:119]
  v_mfma_f32_16x16x32_bf16 v[112:115], v[24:27], v[52:55], v[112:115]
  v_mfma_f32_16x16x32_bf16 v[108:111], v[20:23], v[52:55], v[108:111]
  v_mfma_f32_16x16x32_bf16 v[104:107], v[16:19], v[52:55], v[104:107]
  s_waitcnt lgkmcnt(0)
  s_barrier
  v_mfma_f32_16x16x32_bf16 v[120:123], v[16:19], v[56:59], v[120:123]
  ds_read_b128 v[48:51], v8 offset:0
  v_mfma_f32_16x16x32_bf16 v[124:127], v[20:23], v[56:59], v[124:127]
  ds_read_b128 v[52:55], v8 offset:2048
  v_mfma_f32_16x16x32_bf16 v[128:131], v[24:27], v[56:59], v[128:131]
  ds_read_b64_tr_b16 v[32:33], v1 offset:16384
  v_mfma_f32_16x16x32_bf16 v[132:135], v[28:31], v[56:59], v[132:135]
  ds_read_b128 v[56:59], v8 offset:4096
  v_mfma_f32_16x16x32_bf16 v[148:151], v[28:31], v[60:63], v[148:151]
  ds_read_b64_tr_b16 v[34:35], v1 offset:17408
  v_mfma_f32_16x16x32_bf16 v[144:147], v[24:27], v[60:63], v[144:147]
  ds_read_b64_tr_b16 v[36:37], v2 offset:16384
  v_mfma_f32_16x16x32_bf16 v[140:143], v[20:23], v[60:63], v[140:143]
  ds_read_b64_tr_b16 v[38:39], v2 offset:17408
  v_mfma_f32_16x16x32_bf16 v[136:139], v[16:19], v[60:63], v[136:139]
  ds_read_b128 v[60:63], v8 offset:6144
  v_mfma_f32_16x16x32_bf16 v[152:155], v[16:19], v[64:67], v[152:155]
  ds_read_b64_tr_b16 v[40:41], v3 offset:16384
  v_mfma_f32_16x16x32_bf16 v[156:159], v[20:23], v[64:67], v[156:159]
  ds_read_b64_tr_b16 v[42:43], v3 offset:17408
  v_mfma_f32_16x16x32_bf16 v[160:163], v[24:27], v[64:67], v[160:163]
  ds_read_b64_tr_b16 v[44:45], v4 offset:16384
  v_mfma_f32_16x16x32_bf16 v[164:167], v[28:31], v[64:67], v[164:167]
  ds_read_b128 v[64:67], v8 offset:8192
  v_mfma_f32_16x16x32_bf16 v[180:183], v[28:31], v[68:71], v[180:183]
  ds_read_b64_tr_b16 v[46:47], v4 offset:17408
  v_mfma_f32_16x16x32_bf16 v[176:179], v[24:27], v[68:71], v[176:179]
  v_mfma_f32_16x16x32_bf16 v[172:175], v[20:23], v[68:71], v[172:175]
  v_mfma_f32_16x16x32_bf16 v[168:171], v[16:19], v[68:71], v[168:171]
  ds_read_b128 v[68:71], v8 offset:10240
  v_mfma_f32_16x16x32_bf16 v[184:187], v[16:19], v[72:75], v[184:187]
  v_mfma_f32_16x16x32_bf16 v[188:191], v[20:23], v[72:75], v[188:191]
  v_mfma_f32_16x16x32_bf16 v[192:195], v[24:27], v[72:75], v[192:195]
  v_mfma_f32_16x16x32_bf16 v[196:199], v[28:31], v[72:75], v[196:199]
  ds_read_b128 v[72:75], v8 offset:12288
  v_mfma_f32_16x16x32_bf16 v[212:215], v[28:31], v[76:79], v[212:215]
  v_mfma_f32_16x16x32_bf16 v[208:211], v[24:27], v[76:79], v[208:211]
  v_mfma_f32_16x16x32_bf16 v[204:207], v[20:23], v[76:79], v[204:207]
  v_mfma_f32_16x16x32_bf16 v[200:203], v[16:19], v[76:79], v[200:203]
  ds_read_b128 v[76:79], v8 offset:14336
  v_mfma_f32_16x16x32_bf16 v[216:219], v[16:19], v[80:83], v[216:219]
  v_mfma_f32_16x16x32_bf16 v[220:223], v[20:23], v[80:83], v[220:223]
  v_mfma_f32_16x16x32_bf16 v[224:227], v[24:27], v[80:83], v[224:227]
  v_mfma_f32_16x16x32_bf16 v[228:231], v[28:31], v[80:83], v[228:231]
  ds_read_b128 v[80:83], v8 offset:16384
  v_mfma_f32_16x16x32_bf16 v[244:247], v[28:31], v[84:87], v[244:247]
  s_waitcnt lgkmcnt(4)
  v_mfma_f32_16x16x32_bf16 v[240:243], v[24:27], v[84:87], v[240:243]
  v_mfma_f32_16x16x32_bf16 v[236:239], v[20:23], v[84:87], v[236:239]
  v_mfma_f32_16x16x32_bf16 v[232:235], v[16:19], v[84:87], v[232:235]
  ds_read_b128 v[84:87], v8 offset:18432
  v_mfma_f32_16x16x32_bf16 v[88:91], v[32:35], v[48:51], v[88:91]
  v_mfma_f32_16x16x32_bf16 v[92:95], v[36:39], v[48:51], v[92:95]
  v_mfma_f32_16x16x32_bf16 v[96:99], v[40:43], v[48:51], v[96:99]
  v_mfma_f32_16x16x32_bf16 v[100:103], v[44:47], v[48:51], v[100:103]
  v_mfma_f32_16x16x32_bf16 v[116:119], v[44:47], v[52:55], v[116:119]
  v_mfma_f32_16x16x32_bf16 v[112:115], v[40:43], v[52:55], v[112:115]
  v_mfma_f32_16x16x32_bf16 v[108:111], v[36:39], v[52:55], v[108:111]
  v_mfma_f32_16x16x32_bf16 v[104:107], v[32:35], v[52:55], v[104:107]
  s_waitcnt lgkmcnt(0)
  s_barrier
  v_mfma_f32_16x16x32_bf16 v[120:123], v[32:35], v[56:59], v[120:123]
  ds_read_b128 v[48:51], v5 offset:0
  v_mfma_f32_16x16x32_bf16 v[124:127], v[36:39], v[56:59], v[124:127]
  ds_read_b128 v[52:55], v5 offset:2048
  v_mfma_f32_16x16x32_bf16 v[128:131], v[40:43], v[56:59], v[128:131]
  ds_read_b64_tr_b16 v[16:17], v1 offset:0
  v_mfma_f32_16x16x32_bf16 v[132:135], v[44:47], v[56:59], v[132:135]
  ds_read_b128 v[56:59], v5 offset:4096
  v_mfma_f32_16x16x32_bf16 v[148:151], v[44:47], v[60:63], v[148:151]
  ds_read_b64_tr_b16 v[18:19], v1 offset:1024
  v_mfma_f32_16x16x32_bf16 v[144:147], v[40:43], v[60:63], v[144:147]
  ds_read_b64_tr_b16 v[20:21], v2 offset:0
  v_mfma_f32_16x16x32_bf16 v[140:143], v[36:39], v[60:63], v[140:143]
  ds_read_b64_tr_b16 v[22:23], v2 offset:1024
  v_mfma_f32_16x16x32_bf16 v[136:139], v[32:35], v[60:63], v[136:139]
  ds_read_b128 v[60:63], v5 offset:6144
  v_mfma_f32_16x16x32_bf16 v[152:155], v[32:35], v[64:67], v[152:155]
  ds_read_b64_tr_b16 v[24:25], v3 offset:0
  v_mfma_f32_16x16x32_bf16 v[156:159], v[36:39], v[64:67], v[156:159]
  ds_read_b64_tr_b16 v[26:27], v3 offset:1024
  v_mfma_f32_16x16x32_bf16 v[160:163], v[40:43], v[64:67], v[160:163]
  ds_read_b64_tr_b16 v[28:29], v4 offset:0
  v_mfma_f32_16x16x32_bf16 v[164:167], v[44:47], v[64:67], v[164:167]
  ds_read_b128 v[64:67], v5 offset:8192
  v_mfma_f32_16x16x32_bf16 v[180:183], v[44:47], v[68:71], v[180:183]
  ds_read_b64_tr_b16 v[30:31], v4 offset:1024
  v_mfma_f32_16x16x32_bf16 v[176:179], v[40:43], v[68:71], v[176:179]
  v_mfma_f32_16x16x32_bf16 v[172:175], v[36:39], v[68:71], v[172:175]
  v_mfma_f32_16x16x32_bf16 v[168:171], v[32:35], v[68:71], v[168:171]
  ds_read_b128 v[68:71], v5 offset:10240
  v_mfma_f32_16x16x32_bf16 v[184:187], v[32:35], v[72:75], v[184:187]
  v_mfma_f32_16x16x32_bf16 v[188:191], v[36:39], v[72:75], v[188:191]
  v_mfma_f32_16x16x32_bf16 v[192:195], v[40:43], v[72:75], v[192:195]
  v_mfma_f32_16x16x32_bf16 v[196:199], v[44:47], v[72:75], v[196:199]
  ds_read_b128 v[72:75], v5 offset:12288
  v_mfma_f32_16x16x32_bf16 v[212:215], v[44:47], v[76:79], v[212:215]
  v_mfma_f32_16x16x32_bf16 v[208:211], v[40:43], v[76:79], v[208:211]
  v_mfma_f32_16x16x32_bf16 v[204:207], v[36:39], v[76:79], v[204:207]
  v_mfma_f32_16x16x32_bf16 v[200:203], v[32:35], v[76:79], v[200:203]
  ds_read_b128 v[76:79], v5 offset:14336
  v_mfma_f32_16x16x32_bf16 v[216:219], v[32:35], v[80:83], v[216:219]
  v_mfma_f32_16x16x32_bf16 v[220:223], v[36:39], v[80:83], v[220:223]
  v_mfma_f32_16x16x32_bf16 v[224:227], v[40:43], v[80:83], v[224:227]
  v_mfma_f32_16x16x32_bf16 v[228:231], v[44:47], v[80:83], v[228:231]
  ds_read_b128 v[80:83], v5 offset:16384
  v_mfma_f32_16x16x32_bf16 v[244:247], v[44:47], v[84:87], v[244:247]
  s_waitcnt lgkmcnt(4)
  v_mfma_f32_16x16x32_bf16 v[240:243], v[40:43], v[84:87], v[240:243]
  s_add_u32 s72, s72, 1
  s_cmp_lt_u32 s72, 8
  v_mfma_f32_16x16x32_bf16 v[236:239], v[36:39], v[84:87], v[236:239]
  v_mfma_f32_16x16x32_bf16 v[232:235], v[32:35], v[84:87], v[232:235]
  ds_read_b128 v[84:87], v5 offset:18432
  s_cbranch_scc1 L_dnn_loop0
L_tail:
  v_mfma_f32_16x16x32_bf16 v[88:91], v[16:19], v[48:51], v[88:91]
  v_mfma_f32_16x16x32_bf16 v[92:95], v[20:23], v[48:51], v[92:95]
  v_mfma_f32_16x16x32_bf16 v[96:99], v[24:27], v[48:51], v[96:99]
  v_mfma_f32_16x16x32_bf16 v[100:103], v[28:31], v[48:51], v[100:103]
  v_mfma_f32_16x16x32_bf16 v[116:119], v[28:31], v[52:55], v[116:119]
  v_mfma_f32_16x16x32_bf16 v[112:115], v[24:27], v[52:55], v[112:115]
  v_mfma_f32_16x16x32_bf16 v[108:111], v[20:23], v[52:55], v[108:111]
  v_mfma_f32_16x16x32_bf16 v[104:107], v[16:19], v[52:55], v[104:107]
  s_waitcnt lgkmcnt(0)
  s_barrier
  v_mfma_f32_16x16x32_bf16 v[120:123], v[16:19], v[56:59], v[120:123]
  ds_read_b128 v[48:51], v7 offset:0
  v_mfma_f32_16x16x32_bf16 v[124:127], v[20:23], v[56:59], v[124:127]
  ds_read_b128 v[52:55], v7 offset:2048
  v_mfma_f32_16x16x32_bf16 v[128:131], v[24:27], v[56:59], v[128:131]
  ds_read_b64_tr_b16 v[32:33], v1 offset:8192
  v_mfma_f32_16x16x32_bf16 v[132:135], v[28:31], v[56:59], v[132:135]
  ds_read_b128 v[56:59], v7 offset:4096
  v_mfma_f32_16x16x32_bf16 v[148:151], v[28:31], v[60:63], v[148:151]
  ds_read_b64_tr_b16 v[34:35], v1 offset:9216
  v_mfma_f32_16x16x32_bf16 v[144:147], v[24:27], v[60:63], v[144:147]
  ds_read_b64_tr_b16 v[36:37], v2 offset:8192
  v_mfma_f32_16x16x32_bf16 v[140:143], v[20:23], v[60:63], v[140:143]
  ds_read_b64_tr_b16 v[38:39], v2 offset:9216
  v_mfma_f32_16x16x32_bf16 v[136:139], v[16:19], v[60:63], v[136:139]
  ds_read_b128 v[60:63], v7 offset:6144
  v_mfma_f32_16x16x32_bf16 v[152:155], v[16:19], v[64:67], v[152:155]
  ds_read_b64_tr_b16 v[40:41], v3 offset:8192
  v_mfma_f32_16x16x32_bf16 v[156:159], v[20:23], v[64:67], v[156:159]
  ds_read_b64_tr_b16 v[42:43], v3 offset:9216
  v_mfma_f32_16x16x32_bf16 v[160:163], v[24:27], v[64:67], v[160:163]
  ds_read_b64_tr_b16 v[44:45], v4 offset:8192
  v_mfma_f32_16x16x32_bf16 v[164:167], v[28:31], v[64:67], v[164:167]
  ds_read_b128 v[64:67], v7 offset:8192
  v_mfma_f32_16x16x32_bf16 v[180:183], v[28:31], v[68:71], v[180:183]
  ds_read_b64_tr_b16 v[46:47], v4 offset:9216
  v_mfma_f32_16x16x32_bf16 v[176:179], v[24:27], v[68:71], v[176:179]
  v_mfma_f32_16x16x32_bf16 v[172:175], v[20:23], v[68:71], v[172:175]
  v_mfma_f32_16x16x32_bf16 v[168:171], v[16:19], v[68:71], v[168:171]
  ds_read_b128 v[68:71], v7 offset:10240
  v_mfma_f32_16x16x32_bf16 v[184:187], v[16:19], v[72:75], v[184:187]
  v_mfma_f32_16x16x32_bf16 v[188:191], v[20:23], v[72:75], v[188:191]
  v_mfma_f32_16x16x32_bf16 v[192:195], v[24:27], v[72:75], v[192:195]
  v_mfma_f32_16x16x32_bf16 v[196:199], v[28:31], v[72:75], v[196:199]
  ds_read_b128 v[72:75], v7 offset:12288
  v_mfma_f32_16x16x32_bf16 v[212:215], v[28:31], v[76:79], v[212:215]
  v_mfma_f32_16x16x32_bf16 v[208:211], v[24:27], v[76:79], v[208:211]
  v_mfma_f32_16x16x32_bf16 v[204:207], v[20:23], v[76:79], v[204:207]
  v_mfma_f32_16x16x32_bf16 v[200:203], v[16:19], v[76:79], v[200:203]
  ds_read_b128 v[76:79], v7 offset:14336
  v_mfma_f32_16x16x32_bf16 v[216:219], v[16:19], v[80:83], v[216:219]
  v_mfma_f32_16x16x32_bf16 v[220:223], v[20:23], v[80:83], v[220:223]
  v_mfma_f32_16x16x32_bf16 v[224:227], v[24:27], v[80:83], v[224:227]
  v_mfma_f32_16x16x32_bf16 v[228:231], v[28:31], v[80:83], v[228:231]
  ds_read_b128 v[80:83], v7 offset:16384
  v_mfma_f32_16x16x32_bf16 v[244:247], v[28:31], v[84:87], v[244:247]
  s_waitcnt lgkmcnt(4)
  v_mfma_f32_16x16x32_bf16 v[240:243], v[24:27], v[84:87], v[240:243]
  v_mfma_f32_16x16x32_bf16 v[236:239], v[20:23], v[84:87], v[236:239]
  v_mfma_f32_16x16x32_bf16 v[232:235], v[16:19], v[84:87], v[232:235]
  ds_read_b128 v[84:87], v7 offset:18432
  v_mfma_f32_16x16x32_bf16 v[88:91], v[32:35], v[48:51], v[88:91]
  v_mfma_f32_16x16x32_bf16 v[92:95], v[36:39], v[48:51], v[92:95]
  v_mfma_f32_16x16x32_bf16 v[96:99], v[40:43], v[48:51], v[96:99]
  v_mfma_f32_16x16x32_bf16 v[100:103], v[44:47], v[48:51], v[100:103]
  v_mfma_f32_16x16x32_bf16 v[116:119], v[44:47], v[52:55], v[116:119]
  v_mfma_f32_16x16x32_bf16 v[112:115], v[40:43], v[52:55], v[112:115]
  v_mfma_f32_16x16x32_bf16 v[108:111], v[36:39], v[52:55], v[108:111]
  v_mfma_f32_16x16x32_bf16 v[104:107], v[32:35], v[52:55], v[104:107]
  s_waitcnt lgkmcnt(0)
  s_barrier
  v_mfma_f32_16x16x32_bf16 v[120:123], v[32:35], v[56:59], v[120:123]
  ds_read_b128 v[48:51], v5 offset:40960
  v_mfma_f32_16x16x32_bf16 v[124:127], v[36:39], v[56:59], v[124:127]
  ds_read_b128 v[52:55], v5 offset:43008
  v_mfma_f32_16x16x32_bf16 v[128:131], v[40:43], v[56:59], v[128:131]
  ds_read_b64_tr_b16 v[16:17], v1 offset:16384
  v_mfma_f32_16x16x32_bf16 v[132:135], v[44:47], v[56:59], v[132:135]
  ds_read_b128 v[56:59], v5 offset:45056
  v_mfma_f32_16x16x32_bf16 v[148:151], v[44:47], v[60:63], v[148:151]
  ds_read_b64_tr_b16 v[18:19], v1 offset:17408
  v_mfma_f32_16x16x32_bf16 v[144:147], v[40:43], v[60:63], v[144:147]
  ds_read_b64_tr_b16 v[20:21], v2 offset:16384
  v_mfma_f32_16x16x32_bf16 v[140:143], v[36:39], v[60:63], v[140:143]
  ds_read_b64_tr_b16 v[22:23], v2 offset:17408
  v_mfma_f32_16x16x32_bf16 v[136:139], v[32:35], v[60:63], v[136:139]
  ds_read_b128 v[60:63], v5 offset:47104
  v_mfma_f32_16x16x32_bf16 v[152:155], v[32:35], v[64:67], v[152:155]
  ds_read_b64_tr_b16 v[24:25], v3 offset:16384
  v_mfma_f32_16x16x32_bf16 v[156:159], v[36:39], v[64:67], v[156:159]
  ds_read_b64_tr_b16 v[26:27], v3 offset:17408
  v_mfma_f32_16x16x32_bf16 v[160:163], v[40:43], v[64:67], v[160:163]
  ds_read_b64_tr_b16 v[28:29], v4 offset:16384
  v_mfma_f32_16x16x32_bf16 v[164:167], v[44:47], v[64:67], v[164:167]
  ds_read_b128 v[64:67], v5 offset:49152
  v_mfma_f32_16x16x32_bf16 v[180:183], v[44:47], v[68:71], v[180:183]
  ds_read_b64_tr_b16 v[30:31], v4 offset:17408
  v_mfma_f32_16x16x32_bf16 v[176:179], v[40:43], v[68:71], v[176:179]
  v_mfma_f32_16x16x32_bf16 v[172:175], v[36:39], v[68:71], v[172:175]
  v_mfma_f32_16x16x32_bf16 v[168:171], v[32:35], v[68:71], v[168:171]
  ds_read_b128 v[68:71], v5 offset:51200
  v_mfma_f32_16x16x32_bf16 v[184:187], v[32:35], v[72:75], v[184:187]
  v_mfma_f32_16x16x32_bf16 v[188:191], v[36:39], v[72:75], v[188:191]
  v_mfma_f32_16x16x32_bf16 v[192:195], v[40:43], v[72:75], v[192:195]
  v_mfma_f32_16x16x32_bf16 v[196:199], v[44:47], v[72:75], v[196:199]
  ds_read_b128 v[72:75], v5 offset:53248
  v_mfma_f32_16x16x32_bf16 v[212:215], v[44:47], v[76:79], v[212:215]
  v_mfma_f32_16x16x32_bf16 v[208:211], v[40:43], v[76:79], v[208:211]
  v_mfma_f32_16x16x32_bf16 v[204:207], v[36:39], v[76:79], v[204:207]
  v_mfma_f32_16x16x32_bf16 v[200:203], v[32:35], v[76:79], v[200:203]
  ds_read_b128 v[76:79], v5 offset:55296
  v_mfma_f32_16x16x32_bf16 v[216:219], v[32:35], v[80:83], v[216:219]
  v_mfma_f32_16x16x32_bf16 v[220:223], v[36:39], v[80:83], v[220:223]
  v_mfma_f32_16x16x32_bf16 v[224:227], v[40:43], v[80:83], v[224:227]
  v_mfma_f32_16x16x32_bf16 v[228:231], v[44:47], v[80:83], v[228:231]
  ds_read_b128 v[80:83], v5 offset:57344
  v_mfma_f32_16x16x32_bf16 v[244:247], v[44:47], v[84:87], v[244:247]
  s_waitcnt lgkmcnt(4)
  v_mfma_f32_16x16x32_bf16 v[240:243], v[40:43], v[84:87], v[240:243]
  v_mfma_f32_16x16x32_bf16 v[236:239], v[36:39], v[84:87], v[236:239]
  v_mfma_f32_16x16x32_bf16 v[232:235], v[32:35], v[84:87], v[232:235]
  ds_read_b128 v[84:87], v5 offset:59392
  v_mfma_f32_16x16x32_bf16 v[88:91], v[16:19], v[48:51], v[88:91]
  v_mfma_f32_16x16x32_bf16 v[92:95], v[20:23], v[48:51], v[92:95]
  v_mfma_f32_16x16x32_bf16 v[96:99], v[24:27], v[48:51], v[96:99]
  v_mfma_f32_16x16x32_bf16 v[100:103], v[28:31], v[48:51], v[100:103]
  v_mfma_f32_16x16x32_bf16 v[116:119], v[28:31], v[52:55], v[116:119]
  v_mfma_f32_16x16x32_bf16 v[112:115], v[24:27], v[52:55], v[112:115]
  v_mfma_f32_16x16x32_bf16 v[108:111], v[20:23], v[52:55], v[108:111]
  v_mfma_f32_16x16x32_bf16 v[104:107], v[16:19], v[52:55], v[104:107]
  s_waitcnt lgkmcnt(0)
  s_barrier
  v_mfma_f32_16x16x32_bf16 v[120:123], v[16:19], v[56:59], v[120:123]
  ds_read_b128 v[48:51], v7 offset:40960
  v_mfma_f32_16x16x32_bf16 v[124:127], v[20:23], v[56:59], v[124:127]
  ds_read_b128 v[52:55], v7 offset:43008
  v_mfma_f32_16x16x32_bf16 v[128:131], v[24:27], v[56:59], v[128:131]
  ds_read_b64_tr_b16 v[32:33], v1 offset:0
  v_mfma_f32_16x16x32_bf16 v[132:135], v[28:31], v[56:59], v[132:135]
  ds_read_b128 v[56:59], v7 offset:45056
  v_mfma_f32_16x16x32_bf16 v[148:151], v[28:31], v[60:63], v[148:151]
  ds_read_b64_tr_b16 v[34:35], v1 offset:1024
  v_mfma_f32_16x16x32_bf16 v[144:147], v[24:27], v[60:63], v[144:147]
  ds_read_b64_tr_b16 v[36:37], v2 offset:0
  v_mfma_f32_16x16x32_bf16 v[140:143], v[20:23], v[60:63], v[140:143]
  ds_read_b64_tr_b16 v[38:39], v2 offset:1024
  v_mfma_f32_16x16x32_bf16 v[136:139], v[16:19], v[60:63], v[136:139]
  ds_read_b128 v[60:63], v7 offset:47104
  v_mfma_f32_16x16x32_bf16 v[152:155], v[16:19], v[64:67], v[152:155]
  ds_read_b64_tr_b16 v[40:41], v3 offset:0
  v_mfma_f32_16x16x32_bf16 v[156:159], v[20:23], v[64:67], v[156:159]
  ds_read_b64_tr_b16 v[42:43], v3 offset:1024
  v_mfma_f32_16x16x32_bf16 v[160:163], v[24:27], v[64:67], v[160:163]
  ds_read_b64_tr_b16 v[44:45], v4 offset:0
  v_mfma_f32_16x16x32_bf16 v[164:167], v[28:31], v[64:67], v[164:167]
  ds_read_b128 v[64:67], v7 offset:49152
  v_mfma_f32_16x16x32_bf16 v[180:183], v[28:31], v[68:71], v[180:183]
  ds_read_b64_tr_b16 v[46:47], v4 offset:1024
  v_mfma_f32_16x16x32_bf16 v[176:179], v[24:27], v[68:71], v[176:179]
  v_mfma_f32_16x16x32_bf16 v[172:175], v[20:23], v[68:71], v[172:175]
  v_mfma_f32_16x16x32_bf16 v[168:171], v[16:19], v[68:71], v[168:171]
  ds_read_b128 v[68:71], v7 offset:51200
  v_mfma_f32_16x16x32_bf16 v[184:187], v[16:19], v[72:75], v[184:187]
  v_mfma_f32_16x16x32_bf16 v[188:191], v[20:23], v[72:75], v[188:191]
  v_mfma_f32_16x16x32_bf16 v[192:195], v[24:27], v[72:75], v[192:195]
  v_mfma_f32_16x16x32_bf16 v[196:199], v[28:31], v[72:75], v[196:199]
  ds_read_b128 v[72:75], v7 offset:53248
  v_mfma_f32_16x16x32_bf16 v[212:215], v[28:31], v[76:79], v[212:215]
  v_mfma_f32_16x16x32_bf16 v[208:211], v[24:27], v[76:79], v[208:211]
  v_mfma_f32_16x16x32_bf16 v[204:207], v[20:23], v[76:79], v[204:207]
  v_mfma_f32_16x16x32_bf16 v[200:203], v[16:19], v[76:79], v[200:203]
  ds_read_b128 v[76:79], v7 offset:55296
  v_mfma_f32_16x16x32_bf16 v[216:219], v[16:19], v[80:83], v[216:219]
  v_mfma_f32_16x16x32_bf16 v[220:223], v[20:23], v[80:83], v[220:223]
  v_mfma_f32_16x16x32_bf16 v[224:227], v[24:27], v[80:83], v[224:227]
  v_mfma_f32_16x16x32_bf16 v[228:231], v[28:31], v[80:83], v[228:231]
  ds_read_b128 v[80:83], v7 offset:57344
  v_mfma_f32_16x16x32_bf16 v[244:247], v[28:31], v[84:87], v[244:247]
  s_waitcnt lgkmcnt(4)
  v_mfma_f32_16x16x32_bf16 v[240:243], v[24:27], v[84:87], v[240:243]
  v_mfma_f32_16x16x32_bf16 v[236:239], v[20:23], v[84:87], v[236:239]
  v_mfma_f32_16x16x32_bf16 v[232:235], v[16:19], v[84:87], v[232:235]
  ds_read_b128 v[84:87], v7 offset:59392
  v_mfma_f32_16x16x32_bf16 v[88:91], v[32:35], v[48:51], v[88:91]
  ds_read_b64 v[18:19], v9 offset:256
  v_mfma_f32_16x16x32_bf16 v[92:95], v[36:39], v[48:51], v[92:95]
  ds_read_b64 v[22:23], v9 offset:288
  v_mfma_f32_16x16x32_bf16 v[96:99], v[40:43], v[48:51], v[96:99]
  ds_read_b64 v[26:27], v9 offset:320
  v_mfma_f32_16x16x32_bf16 v[100:103], v[44:47], v[48:51], v[100:103]
  ds_read_b64 v[30:31], v9 offset:352
  v_mfma_f32_16x16x32_bf16 v[116:119], v[44:47], v[52:55], v[116:119]
  v_mfma_f32_16x16x32_bf16 v[112:115], v[40:43], v[52:55], v[112:115]
  v_mfma_f32_16x16x32_bf16 v[108:111], v[36:39], v[52:55], v[108:111]
  v_mfma_f32_16x16x32_bf16 v[104:107], v[32:35], v[52:55], v[104:107]
  v_mfma_f32_16x16x32_bf16 v[120:123], v[32:35], v[56:59], v[120:123]
  v_mfma_f32_16x16x32_bf16 v[124:127], v[36:39], v[56:59], v[124:127]
  v_mfma_f32_16x16x32_bf16 v[128:131], v[40:43], v[56:59], v[128:131]
  v_mfma_f32_16x16x32_bf16 v[132:135], v[44:47], v[56:59], v[132:135]
  v_mfma_f32_16x16x32_bf16 v[148:151], v[44:47], v[60:63], v[148:151]
  v_mfma_f32_16x16x32_bf16 v[144:147], v[40:43], v[60:63], v[144:147]
  v_mfma_f32_16x16x32_bf16 v[140:143], v[36:39], v[60:63], v[140:143]
  v_mfma_f32_16x16x32_bf16 v[136:139], v[32:35], v[60:63], v[136:139]
  v_mfma_f32_16x16x32_bf16 v[152:155], v[32:35], v[64:67], v[152:155]
  s_waitcnt lgkmcnt(3)
  v_lshlrev_b32 v16, 16, v18
  v_mfma_f32_16x16x32_bf16 v[156:159], v[36:39], v[64:67], v[156:159]
  v_and_b32 v17, 0xffff0000, v18
  v_mfma_f32_16x16x32_bf16 v[160:163], v[40:43], v[64:67], v[160:163]
  v_lshlrev_b32 v18, 16, v19
  v_mfma_f32_16x16x32_bf16 v[164:167], v[44:47], v[64:67], v[164:167]
  v_and_b32 v19, 0xffff0000, v19
  v_mfma_f32_16x16x32_bf16 v[180:183], v[44:47], v[68:71], v[180:183]
  s_waitcnt lgkmcnt(2)
  v_lshlrev_b32 v20, 16, v22
  v_mfma_f32_16x16x32_bf16 v[176:179], v[40:43], v[68:71], v[176:179]
  v_and_b32 v21, 0xffff0000, v22
  v_mfma_f32_16x16x32_bf16 v[172:175], v[36:39], v[68:71], v[172:175]
  v_lshlrev_b32 v22, 16, v23
  v_mfma_f32_16x16x32_bf16 v[168:171], v[32:35], v[68:71], v[168:171]
  v_and_b32 v23, 0xffff0000, v23
  v_mfma_f32_16x16x32_bf16 v[184:187], v[32:35], v[72:75], v[184:187]
  s_waitcnt lgkmcnt(1)
  v_lshlrev_b32 v24, 16, v26
  v_mfma_f32_16x16x32_bf16 v[188:191], v[36:39], v[72:75], v[188:191]
  v_and_b32 v25, 0xffff0000, v26
  v_mfma_f32_16x16x32_bf16 v[192:195], v[40:43], v[72:75], v[192:195]
  v_lshlrev_b32 v26, 16, v27
  v_mfma_f32_16x16x32_bf16 v[196:199], v[44:47], v[72:75], v[196:199]
  v_and_b32 v27, 0xffff0000, v27
  v_mfma_f32_16x16x32_bf16 v[212:215], v[44:47], v[76:79], v[212:215]
  s_waitcnt lgkmcnt(0)
  v_lshlrev_b32 v28, 16, v30
  v_mfma_f32_16x16x32_bf16 v[208:211], v[40:43], v[76:79], v[208:211]
  v_and_b32 v29, 0xffff0000, v30
  v_mfma_f32_16x16x32_bf16 v[204:207], v[36:39], v[76:79], v[204:207]
  v_lshlrev_b32 v30, 16, v31
  v_mfma_f32_16x16x32_bf16 v[200:203], v[32:35], v[76:79], v[200:203]
  v_and_b32 v31, 0xffff0000, v31
  v_mfma_f32_16x16x32_bf16 v[216:219], v[32:35], v[80:83], v[216:219]
  v_mfma_f32_16x16x32_bf16 v[220:223], v[36:39], v[80:83], v[220:223]
  v_mfma_f32_16x16x32_bf16 v[224:227], v[40:43], v[80:83], v[224:227]
  v_mfma_f32_16x16x32_bf16 v[228:231], v[44:47], v[80:83], v[228:231]
  v_mfma_f32_16x16x32_bf16 v[244:247], v[44:47], v[84:87], v[244:247]
  v_mfma_f32_16x16x32_bf16 v[240:243], v[40:43], v[84:87], v[240:243]
  v_mfma_f32_16x16x32_bf16 v[236:239], v[36:39], v[84:87], v[236:239]
  v_mfma_f32_16x16x32_bf16 v[232:235], v[32:35], v[84:87], v[232:235]
L_epi:
  v_pk_mul_f32 v[52:53], v[88:89], v[88:89]
  v_pk_mul_f32 v[56:57], v[104:105], v[104:105]
  v_pk_mul_f32 v[60:61], v[90:91], v[90:91]
  v_pk_mul_f32 v[64:65], v[106:107], v[106:107]
  v_pk_fma_f32 v[52:53], v[52:53], v[14:15], v[12:13]
  v_pk_fma_f32 v[56:57], v[56:57], v[14:15], v[12:13]
  v_pk_fma_f32 v[60:61], v[60:61], v[14:15], v[12:13]
  v_pk_fma_f32 v[64:65], v[64:65], v[14:15], v[12:13]
  v_pk_mul_f32 v[52:53], v[52:53], v[88:89]
  v_pk_mul_f32 v[56:57], v[56:57], v[104:105]
  v_pk_mul_f32 v[60:61], v[60:61], v[90:91]
  v_pk_mul_f32 v[64:65], v[64:65], v[106:107]
  v_exp_f32 v52, v52
  v_exp_f32 v53, v53
  v_exp_f32 v56, v56
  v_exp_f32 v57, v57
  v_exp_f32 v60, v60
  v_exp_f32 v61, v61
  v_exp_f32 v64, v64
  v_exp_f32 v65, v65
  v_pk_mul_f32 v[54:55], v[88:89], v[16:17]
  v_pk_mul_f32 v[58:59], v[104:105], v[16:17]
  v_pk_mul_f32 v[62:63], v[90:91], v[18:19]
  v_pk_mul_f32 v[66:67], v[106:107], v[18:19]
  v_pk_add_f32 v[52:53], v[52:53], v[248:249]
  v_pk_add_f32 v[56:57], v[56:57], v[248:249]
  v_pk_add_f32 v[60:61], v[60:61], v[248:249]
  v_pk_add_f32 v[64:65], v[64:65], v[248:249]
  v_rcp_f32 v52, v52
  v_rcp_f32 v53, v53
  v_rcp_f32 v56, v56
  v_rcp_f32 v57, v57
  v_rcp_f32 v60, v60
  v_rcp_f32 v61, v61
  v_rcp_f32 v64, v64
  v_rcp_f32 v65, v65
  v_pk_mul_f32 v[32:33], v[52:53], v[54:55]
  v_pk_mul_f32 v[34:35], v[56:57], v[58:59]
  v_pk_fma_f32 v[32:33], v[60:61], v[62:63], v[32:33]
  v_pk_fma_f32 v[34:35], v[64:65], v[66:67], v[34:35]
  v_pk_mul_f32 v[68:69], v[92:93], v[92:93]
  v_pk_mul_f32 v[72:73], v[108:109], v[108:109]
  v_pk_mul_f32 v[76:77], v[94:95], v[94:95]
  v_pk_mul_f32 v[80:81], v[110:111], v[110:111]
  v_pk_fma_f32 v[68:69], v[68:69], v[14:15], v[12:13]
  v_pk_fma_f32 v[72:73], v[72:73], v[14:15], v[12:13]
  v_pk_fma_f32 v[76:77], v[76:77], v[14:15], v[12:13]
  v_pk_fma_f32 v[80:81], v[80:81], v[14:15], v[12:13]
  v_pk_mul_f32 v[68:69], v[68:69], v[92:93]
  v_pk_mul_f32 v[72:73], v[72:73], v[108:109]
  v_pk_mul_f32 v[76:77], v[76:77], v[94:95]
  v_pk_mul_f32 v[80:81], v[80:81], v[110:111]
  v_exp_f32 v68, v68
  v_exp_f32 v69, v69
  v_exp_f32 v72, v72
  v_exp_f32 v73, v73
  v_exp_f32 v76, v76
  v_exp_f32 v77, v77
  v_exp_f32 v80, v80
  v_exp_f32 v81, v81
  v_pk_mul_f32 v[70:71], v[92:93], v[20:21]
  v_pk_mul_f32 v[74:75], v[108:109], v[20:21]
  v_pk_mul_f32 v[78:79], v[94:95], v[22:23]
  v_pk_mul_f32 v[82:83], v[110:111], v[22:23]
  v_pk_add_f32 v[68:69], v[68:69], v[248:249]
  v_pk_add_f32 v[72:73], v[72:73], v[248:249]
  v_pk_add_f32 v[76:77], v[76:77], v[248:249]
  v_pk_add_f32 v[80:81], v[80:81], v[248:249]
  v_rcp_f32 v68, v68
  v_rcp_f32 v69, v69
  v_rcp_f32 v72, v72
  v_rcp_f32 v73, v73
  v_rcp_f32 v76, v76
  v_rcp_f32 v77, v77
  v_rcp_f32 v80, v80
  v_rcp_f32 v81, v81
  v_pk_fma_f32 v[32:33], v[68:69], v[70:71], v[32:33]
  v_pk_fma_f32 v[34:35], v[72:73], v[74:75], v[34:35]
  v_pk_fma_f32 v[32:33], v[76:77], v[78:79], v[32:33]
  v_pk_fma_f32 v[34:35], v[80:81], v[82:83], v[34:35]
  v_pk_mul_f32 v[52:53], v[96:97], v[96:97]
  v_pk_mul_f32 v[56:57], v[112:113], v[112:113]
  v_pk_mul_f32 v[60:61], v[98:99], v[98:99]
  v_pk_mul_f32 v[64:65], v[114:115], v[114:115]
  v_pk_fma_f32 v[52:53], v[52:53], v[14:15], v[12:13]
  v_pk_fma_f32 v[56:57], v[56:57], v[14:15], v[12:13]
  v_pk_fma_f32 v[60:61], v[60:61], v[14:15], v[12:13]
  v_pk_fma_f32 v[64:65], v[64:65], v[14:15], v[12:13]
  v_pk_mul_f32 v[52:53], v[52:53], v[96:97]
  v_pk_mul_f32 v[56:57], v[56:57], v[112:113]
  v_pk_mul_f32 v[60:61], v[60:61], v[98:99]
  v_pk_mul_f32 v[64:65], v[64:65], v[114:115]
  v_exp_f32 v52, v52
  v_exp_f32 v53, v53
  v_exp_f32 v56, v56
  v_exp_f32 v57, v57
  v_exp_f32 v60, v60
  v_exp_f32 v61, v61
  v_exp_f32 v64, v64
  v_exp_f32 v65, v65
  v_pk_mul_f32 v[54:55], v[96:97], v[24:25]
  v_pk_mul_f32 v[58:59], v[112:113], v[24:25]
  v_pk_mul_f32 v[62:63], v[98:99], v[26:27]
  v_pk_mul_f32 v[66:67], v[114:115], v[26:27]
  v_pk_add_f32 v[52:53], v[52:53], v[248:249]
  v_pk_add_f32 v[56:57], v[56:57], v[248:249]
  v_pk_add_f32 v[60:61], v[60:61], v[248:249]
  v_pk_add_f32 v[64:65], v[64:65], v[248:249]
  v_rcp_f32 v52, v52
  v_rcp_f32 v53, v53
  v_rcp_f32 v56, v56
  v_rcp_f32 v57, v57
  v_rcp_f32 v60, v60
  v_rcp_f32 v61, v61
  v_rcp_f32 v64, v64
  v_rcp_f32 v65, v65
  v_pk_fma_f32 v[32:33], v[52:53], v[54:55], v[32:33]
  v_pk_fma_f32 v[34:35], v[56:57], v[58:59], v[34:35]
  v_pk_fma_f32 v[32:33], v[60:61], v[62:63], v[32:33]
  v_pk_fma_f32 v[34:35], v[64:65], v[66:67], v[34:35]
  v_pk_mul_f32 v[68:69], v[100:101], v[100:101]
  v_pk_mul_f32 v[72:73], v[116:117], v[116:117]
  v_pk_mul_f32 v[76:77], v[102:103], v[102:103]
  v_pk_mul_f32 v[80:81], v[118:119], v[118:119]
  v_pk_fma_f32 v[68:69], v[68:69], v[14:15], v[12:13]
  v_pk_fma_f32 v[72:73], v[72:73], v[14:15], v[12:13]
  v_pk_fma_f32 v[76:77], v[76:77], v[14:15], v[12:13]
  v_pk_fma_f32 v[80:81], v[80:81], v[14:15], v[12:13]
  v_pk_mul_f32 v[68:69], v[68:69], v[100:101]
  v_pk_mul_f32 v[72:73], v[72:73], v[116:117]
  v_pk_mul_f32 v[76:77], v[76:77], v[102:103]
  v_pk_mul_f32 v[80:81], v[80:81], v[118:119]
  v_exp_f32 v68, v68
  v_exp_f32 v69, v69
  v_exp_f32 v72, v72
  v_exp_f32 v73, v73
  v_exp_f32 v76, v76
  v_exp_f32 v77, v77
  v_exp_f32 v80, v80
  v_exp_f32 v81, v81
  v_pk_mul_f32 v[70:71], v[100:101], v[28:29]
  v_pk_mul_f32 v[74:75], v[116:117], v[28:29]
  v_pk_mul_f32 v[78:79], v[102:103], v[30:31]
  v_pk_mul_f32 v[82:83], v[118:119], v[30:31]
  v_pk_add_f32 v[68:69], v[68:69], v[248:249]
  v_pk_add_f32 v[72:73], v[72:73], v[248:249]
  v_pk_add_f32 v[76:77], v[76:77], v[248:249]
  v_pk_add_f32 v[80:81], v[80:81], v[248:249]
  v_rcp_f32 v68, v68
  v_rcp_f32 v69, v69
  v_rcp_f32 v72, v72
  v_rcp_f32 v73, v73
  v_rcp_f32 v76, v76
  v_rcp_f32 v77, v77
  v_rcp_f32 v80, v80
  v_rcp_f32 v81, v81
  v_pk_fma_f32 v[32:33], v[68:69], v[70:71], v[32:33]
  v_pk_fma_f32 v[34:35], v[72:73], v[74:75], v[34:35]
  v_pk_fma_f32 v[32:33], v[76:77], v[78:79], v[32:33]
  v_pk_fma_f32 v[34:35], v[80:81], v[82:83], v[34:35]
  v_pk_mul_f32 v[52:53], v[120:121], v[120:121]
  v_pk_mul_f32 v[56:57], v[136:137], v[136:137]
  v_pk_mul_f32 v[60:61], v[122:123], v[122:123]
  v_pk_mul_f32 v[64:65], v[138:139], v[138:139]
  v_pk_fma_f32 v[52:53], v[52:53], v[14:15], v[12:13]
  v_pk_fma_f32 v[56:57], v[56:57], v[14:15], v[12:13]
  v_pk_fma_f32 v[60:61], v[60:61], v[14:15], v[12:13]
  v_pk_fma_f32 v[64:65], v[64:65], v[14:15], v[12:13]
  v_pk_mul_f32 v[52:53], v[52:53], v[120:121]
  v_pk_mul_f32 v[56:57], v[56:57], v[136:137]
  v_pk_mul_f32 v[60:61], v[60:61], v[122:123]
  v_pk_mul_f32 v[64:65], v[64:65], v[138:139]
  v_exp_f32 v52, v52
  v_exp_f32 v53, v53
  v_exp_f32 v56, v56
  v_exp_f32 v57, v57
  v_exp_f32 v60, v60
  v_exp_f32 v61, v61
  v_exp_f32 v64, v64
  v_exp_f32 v65, v65
  v_pk_mul_f32 v[54:55], v[120:121], v[16:17]
  v_pk_mul_f32 v[58:59], v[136:137], v[16:17]
  v_pk_mul_f32 v[62:63], v[122:123], v[18:19]
  v_pk_mul_f32 v[66:67], v[138:139], v[18:19]
  v_pk_add_f32 v[52:53], v[52:53], v[248:249]
  v_pk_add_f32 v[56:57], v[56:57], v[248:249]
  v_pk_add_f32 v[60:61], v[60:61], v[248:249]
  v_pk_add_f32 v[64:65], v[64:65], v[248:249]
  v_rcp_f32 v52, v52
  v_rcp_f32 v53, v53
  v_rcp_f32 v56, v56
  v_rcp_f32 v57, v57
  v_rcp_f32 v60, v60
  v_rcp_f32 v61, v61
  v_rcp_f32 v64, v64
  v_rcp_f32 v65, v65
  v_pk_mul_f32 v[36:37], v[52:53], v[54:55]
  v_pk_mul_f32 v[38:39], v[56:57], v[58:59]
  v_pk_fma_f32 v[36:37], v[60:61], v[62:63], v[36:37]
  v_pk_fma_f32 v[38:39], v[64:65], v[66:67], v[38:39]
  v_pk_mul_f32 v[68:69], v[124:125], v[124:125]
  v_pk_mul_f32 v[72:73], v[140:141], v[140:141]
  v_pk_mul_f32 v[76:77], v[126:127], v[126:127]
  v_pk_mul_f32 v[80:81], v[142:143], v[142:143]
  v_pk_fma_f32 v[68:69], v[68:69], v[14:15], v[12:13]
  v_pk_fma_f32 v[72:73], v[72:73], v[14:15], v[12:13]
  v_pk_fma_f32 v[76:77], v[76:77], v[14:15], v[12:13]
  v_pk_fma_f32 v[80:81], v[80:81], v[14:15], v[12:13]
  v_pk_mul_f32 v[68:69], v[68:69], v[124:125]
  v_pk_mul_f32 v[72:73], v[72:73], v[140:141]
  v_pk_mul_f32 v[76:77], v[76:77], v[126:127]
  v_pk_mul_f32 v[80:81], v[80:81], v[142:143]
  v_exp_f32 v68, v68
  v_exp_f32 v69, v69
  v_exp_f32 v72, v72
  v_exp_f32 v73, v73
  v_exp_f32 v76, v76
  v_exp_f32 v77, v77
  v_exp_f32 v80, v80
  v_exp_f32 v81, v81
  v_pk_mul_f32 v[70:71], v[124:125], v[20:21]
  v_pk_mul_f32 v[74:75], v[140:141], v[20:21]
  v_pk_mul_f32 v[78:79], v[126:127], v[22:23]
  v_pk_mul_f32 v[82:83], v[142:143], v[22:23]
  v_pk_add_f32 v[68:69], v[68:69], v[248:249]
  v_pk_add_f32 v[72:73], v[72:73], v[248:249]
  v_pk_add_f32 v[76:77], v[76:77], v[248:249]
  v_pk_add_f32 v[80:81], v[80:81], v[248:249]
  v_rcp_f32 v68, v68
  v_rcp_f32 v69, v69
  v_rcp_f32 v72, v72
  v_rcp_f32 v73, v73
  v_rcp_f32 v76, v76
  v_rcp_f32 v77, v77
  v_rcp_f32 v80, v80
  v_rcp_f32 v81, v81
  v_pk_fma_f32 v[36:37], v[68:69], v[70:71], v[36:37]
  v_pk_fma_f32 v[38:39], v[72:73], v[74:75], v[38:39]
  v_pk_fma_f32 v[36:37], v[76:77], v[78:79], v[36:37]
  v_pk_fma_f32 v[38:39], v[80:81], v[82:83], v[38:39]
  v_pk_mul_f32 v[52:53], v[128:129], v[128:129]
  v_pk_mul_f32 v[56:57], v[144:145], v[144:145]
  v_pk_mul_f32 v[60:61], v[130:131], v[130:131]
  v_pk_mul_f32 v[64:65], v[146:147], v[146:147]
  v_pk_fma_f32 v[52:53], v[52:53], v[14:15], v[12:13]
  v_pk_fma_f32 v[56:57], v[56:57], v[14:15], v[12:13]
  v_pk_fma_f32 v[60:61], v[60:61], v[14:15], v[12:13]
  v_pk_fma_f32 v[64:65], v[64:65], v[14:15], v[12:13]
  v_pk_mul_f32 v[52:53], v[52:53], v[128:129]
  v_pk_mul_f32 v[56:57], v[56:57], v[144:145]
  v_pk_mul_f32 v[60:61], v[60:61], v[130:131]
  v_pk_mul_f32 v[64:65], v[64:65], v[146:147]
  v_exp_f32 v52, v52
  v_exp_f32 v53, v53
  v_exp_f32 v56, v56
  v_exp_f32 v57, v57
  v_exp_f32 v60, v60
  v_exp_f32 v61, v61
  v_exp_f32 v64, v64
  v_exp_f32 v65, v65
  v_pk_mul_f32 v[54:55], v[128:129], v[24:25]
  v_pk_mul_f32 v[58:59], v[144:145], v[24:25]
  v_pk_mul_f32 v[62:63], v[130:131], v[26:27]
  v_pk_mul_f32 v[66:67], v[146:147], v[26:27]
  v_pk_add_f32 v[52:53], v[52:53], v[248:249]
  v_pk_add_f32 v[56:57], v[56:57], v[248:249]
  v_pk_add_f32 v[60:61], v[60:61], v[248:249]
  v_pk_add_f32 v[64:65], v[64:65], v[248:249]
  v_rcp_f32 v52, v52
  v_rcp_f32 v53, v53
  v_rcp_f32 v56, v56
  v_rcp_f32 v57, v57
  v_rcp_f32 v60, v60
  v_rcp_f32 v61, v61
  v_rcp_f32 v64, v64
  v_rcp_f32 v65, v65
  v_pk_fma_f32 v[36:37], v[52:53], v[54:55], v[36:37]
  v_pk_fma_f32 v[38:39], v[56:57], v[58:59], v[38:39]
  v_pk_fma_f32 v[36:37], v[60:61], v[62:63], v[36:37]
  v_pk_fma_f32 v[38:39], v[64:65], v[66:67], v[38:39]
  v_pk_mul_f32 v[68:69], v[132:133], v[132:133]
  v_pk_mul_f32 v[72:73], v[148:149], v[148:149]
  v_pk_mul_f32 v[76:77], v[134:135], v[134:135]
  v_pk_mul_f32 v[80:81], v[150:151], v[150:151]
  v_pk_fma_f32 v[68:69], v[68:69], v[14:15], v[12:13]
  v_pk_fma_f32 v[72:73], v[72:73], v[14:15], v[12:13]
  v_pk_fma_f32 v[76:77], v[76:77], v[14:15], v[12:13]
  v_pk_fma_f32 v[80:81], v[80:81], v[14:15], v[12:13]
  v_pk_mul_f32 v[68:69], v[68:69], v[132:133]
  v_pk_mul_f32 v[72:73], v[72:73], v[148:149]
  v_pk_mul_f32 v[76:77], v[76:77], v[134:135]
  v_pk_mul_f32 v[80:81], v[80:81], v[150:151]
  v_exp_f32 v68, v68
  v_exp_f32 v69, v69
  v_exp_f32 v72, v72
  v_exp_f32 v73, v73
  v_exp_f32 v76, v76
  v_exp_f32 v77, v77
  v_exp_f32 v80, v80
  v_exp_f32 v81, v81
  v_pk_mul_f32 v[70:71], v[132:133], v[28:29]
  v_pk_mul_f32 v[74:75], v[148:149], v[28:29]
  v_pk_mul_f32 v[78:79], v[134:135], v[30:31]
  v_pk_mul_f32 v[82:83], v[150:151], v[30:31]
  v_pk_add_f32 v[68:69], v[68:69], v[248:249]
  v_pk_add_f32 v[72:73], v[72:73], v[248:249]
  v_pk_add_f32 v[76:77], v[76:77], v[248:249]
  v_pk_add_f32 v[80:81], v[80:81], v[248:249]
  v_rcp_f32 v68, v68
  v_rcp_f32 v69, v69
  v_rcp_f32 v72, v72
  v_rcp_f32 v73, v73
  v_rcp_f32 v76, v76
  v_rcp_f32 v77, v77
  v_rcp_f32 v80, v80
  v_rcp_f32 v81, v81
  v_pk_fma_f32 v[36:37], v[68:69], v[70:71], v[36:37]
  v_pk_fma_f32 v[38:39], v[72:73], v[74:75], v[38:39]
  v_pk_fma_f32 v[36:37], v[76:77], v[78:79], v[36:37]
  v_pk_fma_f32 v[38:39], v[80:81], v[82:83], v[38:39]
  v_pk_mul_f32 v[52:53], v[152:153], v[152:153]
  v_pk_mul_f32 v[56:57], v[168:169], v[168:169]
  v_pk_mul_f32 v[60:61], v[154:155], v[154:155]
  v_pk_mul_f32 v[64:65], v[170:171], v[170:171]
  v_pk_fma_f32 v[52:53], v[52:53], v[14:15], v[12:13]
  v_pk_fma_f32 v[56:57], v[56:57], v[14:15], v[12:13]
  v_pk_fma_f32 v[60:61], v[60:61], v[14:15], v[12:13]
  v_pk_fma_f32 v[64:65], v[64:65], v[14:15], v[12:13]
  v_pk_mul_f32 v[52:53], v[52:53], v[152:153]
  v_pk_mul_f32 v[56:57], v[56:57], v[168:169]
  v_pk_mul_f32 v[60:61], v[60:61], v[154:155]
  v_pk_mul_f32 v[64:65], v[64:65], v[170:171]
  v_exp_f32 v52, v52
  v_exp_f32 v53, v53
  v_exp_f32 v56, v56
  v_exp_f32 v57, v57
  v_exp_f32 v60, v60
  v_exp_f32 v61, v61
  v_exp_f32 v64, v64
  v_exp_f32 v65, v65
  v_pk_mul_f32 v[54:55], v[152:153], v[16:17]
  v_pk_mul_f32 v[58:59], v[168:169], v[16:17]
  v_pk_mul_f32 v[62:63], v[154:155], v[18:19]
  v_pk_mul_f32 v[66:67], v[170:171], v[18:19]
  v_pk_add_f32 v[52:53], v[52:53], v[248:249]
  v_pk_add_f32 v[56:57], v[56:57], v[248:249]
  v_pk_add_f32 v[60:61], v[60:61], v[248:249]
  v_pk_add_f32 v[64:65], v[64:65], v[248:249]
  v_rcp_f32 v52, v52
  v_rcp_f32 v53, v53
  v_rcp_f32 v56, v56
  v_rcp_f32 v57, v57
  v_rcp_f32 v60, v60
  v_rcp_f32 v61, v61
  v_rcp_f32 v64, v64
  v_rcp_f32 v65, v65
  v_pk_mul_f32 v[40:41], v[52:53], v[54:55]
  v_pk_mul_f32 v[42:43], v[56:57], v[58:59]
  v_pk_fma_f32 v[40:41], v[60:61], v[62:63], v[40:41]
  v_pk_fma_f32 v[42:43], v[64:65], v[66:67], v[42:43]
  v_pk_mul_f32 v[68:69], v[156:157], v[156:157]
  v_pk_mul_f32 v[72:73], v[172:173], v[172:173]
  v_pk_mul_f32 v[76:77], v[158:159], v[158:159]
  v_pk_mul_f32 v[80:81], v[174:175], v[174:175]
  v_pk_fma_f32 v[68:69], v[68:69], v[14:15], v[12:13]
  v_pk_fma_f32 v[72:73], v[72:73], v[14:15], v[12:13]
  v_pk_fma_f32 v[76:77], v[76:77], v[14:15], v[12:13]
  v_pk_fma_f32 v[80:81], v[80:81], v[14:15], v[12:13]
  v_pk_mul_f32 v[68:69], v[68:69], v[156:157]
  v_pk_mul_f32 v[72:73], v[72:73], v[172:173]
  v_pk_mul_f32 v[76:77], v[76:77], v[158:159]
  v_pk_mul_f32 v[80:81], v[80:81], v[174:175]
  v_exp_f32 v68, v68
  v_exp_f32 v69, v69
  v_exp_f32 v72, v72
  v_exp_f32 v73, v73
  v_exp_f32 v76, v76
  v_exp_f32 v77, v77
  v_exp_f32 v80, v80
  v_exp_f32 v81, v81
  v_pk_mul_f32 v[70:71], v[156:157], v[20:21]
  v_pk_mul_f32 v[74:75], v[172:173], v[20:21]
  v_pk_mul_f32 v[78:79], v[158:159], v[22:23]
  v_pk_mul_f32 v[82:83], v[174:175], v[22:23]
  v_pk_add_f32 v[68:69], v[68:69], v[248:249]
  v_pk_add_f32 v[72:73], v[72:73], v[248:249]
  v_pk_add_f32 v[76:77], v[76:77], v[248:249]
  v_pk_add_f32 v[80:81], v[80:81], v[248:249]
  v_rcp_f32 v68, v68
  v_rcp_f32 v69, v69
  v_rcp_f32 v72, v72
  v_rcp_f32 v73, v73
  v_rcp_f32 v76, v76
  v_rcp_f32 v77, v77
  v_rcp_f32 v80, v80
  v_rcp_f32 v81, v81
  v_pk_fma_f32 v[40:41], v[68:69], v[70:71], v[40:41]
  v_pk_fma_f32 v[42:43], v[72:73], v[74:75], v[42:43]
  v_pk_fma_f32 v[40:41], v[76:77], v[78:79], v[40:41]
  v_pk_fma_f32 v[42:43], v[80:81], v[82:83], v[42:43]
  v_pk_mul_f32 v[52:53], v[160:161], v[160:161]
  v_pk_mul_f32 v[56:57], v[176:177], v[176:177]
  v_pk_mul_f32 v[60:61], v[162:163], v[162:163]
  v_pk_mul_f32 v[64:65], v[178:179], v[178:179]
  v_pk_fma_f32 v[52:53], v[52:53], v[14:15], v[12:13]
  v_pk_fma_f32 v[56:57], v[56:57], v[14:15], v[12:13]
  v_pk_fma_f32 v[60:61], v[60:61], v[14:15], v[12:13]
  v_pk_fma_f32 v[64:65], v[64:65], v[14:15], v[12:13]
  v_pk_mul_f32 v[52:53], v[52:53], v[160:161]
  v_pk_mul_f32 v[56:57], v[56:57], v[176:177]
  v_pk_mul_f32 v[60:61], v[60:61], v[162:163]
  v_pk_mul_f32 v[64:65], v[64:65], v[178:179]
  v_exp_f32 v52, v52
  v_exp_f32 v53, v53
  v_exp_f32 v56, v56
  v_exp_f32 v57, v57
  v_exp_f32 v60, v60
  v_exp_f32 v61, v61
  v_exp_f32 v64, v64
  v_exp_f32 v65, v65
  v_pk_mul_f32 v[54:55], v[160:161], v[24:25]
  v_pk_mul_f32 v[58:59], v[176:177], v[24:25]
  v_pk_mul_f32 v[62:63], v[162:163], v[26:27]
  v_pk_mul_f32 v[66:67], v[178:179], v[26:27]
  v_pk_add_f32 v[52:53], v[52:53], v[248:249]
  v_pk_add_f32 v[56:57], v[56:57], v[248:249]
  v_pk_add_f32 v[60:61], v[60:61], v[248:249]
  v_pk_add_f32 v[64:65], v[64:65], v[248:249]
  v_rcp_f32 v52, v52
  v_rcp_f32 v53, v53
  v_rcp_f32 v56, v56
  v_rcp_f32 v57, v57
  v_rcp_f32 v60, v60
  v_rcp_f32 v61, v61
  v_rcp_f32 v64, v64
  v_rcp_f32 v65, v65
  v_pk_fma_f32 v[40:41], v[52:53], v[54:55], v[40:41]
  v_pk_fma_f32 v[42:43], v[56:57], v[58:59], v[42:43]
  v_pk_fma_f32 v[40:41], v[60:61], v[62:63], v[40:41]
  v_pk_fma_f32 v[42:43], v[64:65], v[66:67], v[42:43]
  v_pk_mul_f32 v[68:69], v[164:165], v[164:165]
  v_pk_mul_f32 v[72:73], v[180:181], v[180:181]
  v_pk_mul_f32 v[76:77], v[166:167], v[166:167]
  v_pk_mul_f32 v[80:81], v[182:183], v[182:183]
  v_pk_fma_f32 v[68:69], v[68:69], v[14:15], v[12:13]
  v_pk_fma_f32 v[72:73], v[72:73], v[14:15], v[12:13]
  v_pk_fma_f32 v[76:77], v[76:77], v[14:15], v[12:13]
  v_pk_fma_f32 v[80:81], v[80:81], v[14:15], v[12:13]
  v_pk_mul_f32 v[68:69], v[68:69], v[164:165]
  v_pk_mul_f32 v[72:73], v[72:73], v[180:181]
  v_pk_mul_f32 v[76:77], v[76:77], v[166:167]
  v_pk_mul_f32 v[80:81], v[80:81], v[182:183]
  v_exp_f32 v68, v68
  v_exp_f32 v69, v69
  v_exp_f32 v72, v72
  v_exp_f32 v73, v73
  v_exp_f32 v76, v76
  v_exp_f32 v77, v77
  v_exp_f32 v80, v80
  v_exp_f32 v81, v81
  v_pk_mul_f32 v[70:71], v[164:165], v[28:29]
  v_pk_mul_f32 v[74:75], v[180:181], v[28:29]
  v_pk_mul_f32 v[78:79], v[166:167], v[30:31]
  v_pk_mul_f32 v[82:83], v[182:183], v[30:31]
  v_pk_add_f32 v[68:69], v[68:69], v[248:249]
  v_pk_add_f32 v[72:73], v[72:73], v[248:249]
  v_pk_add_f32 v[76:77], v[76:77], v[248:249]
  v_pk_add_f32 v[80:81], v[80:81], v[248:249]
  v_rcp_f32 v68, v68
  v_rcp_f32 v69, v69
  v_rcp_f32 v72, v72
  v_rcp_f32 v73, v73
  v_rcp_f32 v76, v76
  v_rcp_f32 v77, v77
  v_rcp_f32 v80, v80
  v_rcp_f32 v81, v81
  v_pk_fma_f32 v[40:41], v[68:69], v[70:71], v[40:41]
  v_pk_fma_f32 v[42:43], v[72:73], v[74:75], v[42:43]
  v_pk_fma_f32 v[40:41], v[76:77], v[78:79], v[40:41]
  v_pk_fma_f32 v[42:43], v[80:81], v[82:83], v[42:43]
  v_pk_mul_f32 v[52:53], v[184:185], v[184:185]
  v_pk_mul_f32 v[56:57], v[200:201], v[200:201]
  v_pk_mul_f32 v[60:61], v[186:187], v[186:187]
  v_pk_mul_f32 v[64:65], v[202:203], v[202:203]
  v_pk_fma_f32 v[52:53], v[52:53], v[14:15], v[12:13]
  v_pk_fma_f32 v[56:57], v[56:57], v[14:15], v[12:13]
  v_pk_fma_f32 v[60:61], v[60:61], v[14:15], v[12:13]
  v_pk_fma_f32 v[64:65], v[64:65], v[14:15], v[12:13]
  v_pk_mul_f32 v[52:53], v[52:53], v[184:185]
  v_pk_mul_f32 v[56:57], v[56:57], v[200:201]
  v_pk_mul_f32 v[60:61], v[60:61], v[186:187]
  v_pk_mul_f32 v[64:65], v[64:65], v[202:203]
  v_exp_f32 v52, v52
  v_exp_f32 v53, v53
  v_exp_f32 v56, v56
  v_exp_f32 v57, v57
  v_exp_f32 v60, v60
  v_exp_f32 v61, v61
  v_exp_f32 v64, v64
  v_exp_f32 v65, v65
  v_pk_mul_f32 v[54:55], v[184:185], v[16:17]
  v_pk_mul_f32 v[58:59], v[200:201], v[16:17]
  v_pk_mul_f32 v[62:63], v[186:187], v[18:19]
  v_pk_mul_f32 v[66:67], v[202:203], v[18:19]
  v_pk_add_f32 v[52:53], v[52:53], v[248:249]
  v_pk_add_f32 v[56:57], v[56:57], v[248:249]
  v_pk_add_f32 v[60:61], v[60:61], v[248:249]
  v_pk_add_f32 v[64:65], v[64:65], v[248:249]
  v_rcp_f32 v52, v52
  v_rcp_f32 v53, v53
  v_rcp_f32 v56, v56
  v_rcp_f32 v57, v57
  v_rcp_f32 v60, v60
  v_rcp_f32 v61, v61
  v_rcp_f32 v64, v64
  v_rcp_f32 v65, v65
  v_pk_mul_f32 v[44:45], v[52:53], v[54:55]
  v_pk_mul_f32 v[46:47], v[56:57], v[58:59]
  v_pk_fma_f32 v[44:45], v[60:61], v[62:63], v[44:45]
  v_pk_fma_f32 v[46:47], v[64:65], v[66:67], v[46:47]
  v_pk_mul_f32 v[68:69], v[188:189], v[188:189]
  v_pk_mul_f32 v[72:73], v[204:205], v[204:205]
  v_pk_mul_f32 v[76:77], v[190:191], v[190:191]
  v_pk_mul_f32 v[80:81], v[206:207], v[206:207]
  v_pk_fma_f32 v[68:69], v[68:69], v[14:15], v[12:13]
  v_pk_fma_f32 v[72:73], v[72:73], v[14:15], v[12:13]
  v_pk_fma_f32 v[76:77], v[76:77], v[14:15], v[12:13]
  v_pk_fma_f32 v[80:81], v[80:81], v[14:15], v[12:13]
  v_pk_mul_f32 v[68:69], v[68:69], v[188:189]
  v_pk_mul_f32 v[72:73], v[72:73], v[204:205]
  v_pk_mul_f32 v[76:77], v[76:77], v[190:191]
  v_pk_mul_f32 v[80:81], v[80:81], v[206:207]
  v_exp_f32 v68, v68
  v_exp_f32 v69, v69
  v_exp_f32 v72, v72
  v_exp_f32 v73, v73
  v_exp_f32 v76, v76
  v_exp_f32 v77, v77
  v_exp_f32 v80, v80
  v_exp_f32 v81, v81
  v_pk_mul_f32 v[70:71], v[188:189], v[20:21]
  v_pk_mul_f32 v[74:75], v[204:205], v[20:21]
  v_pk_mul_f32 v[78:79], v[190:191], v[22:23]
  v_pk_mul_f32 v[82:83], v[206:207], v[22:23]
  v_pk_add_f32 v[68:69], v[68:69], v[248:249]
  v_pk_add_f32 v[72:73], v[72:73], v[248:249]
  v_pk_add_f32 v[76:77], v[76:77], v[248:249]
  v_pk_add_f32 v[80:81], v[80:81], v[248:249]
  v_rcp_f32 v68, v68
  v_rcp_f32 v69, v69
  v_rcp_f32 v72, v72
  v_rcp_f32 v73, v73
  v_rcp_f32 v76, v76
  v_rcp_f32 v77, v77
  v_rcp_f32 v80, v80
  v_rcp_f32 v81, v81
  v_pk_fma_f32 v[44:45], v[68:69], v[70:71], v[44:45]
  v_pk_fma_f32 v[46:47], v[72:73], v[74:75], v[46:47]
  v_pk_fma_f32 v[44:45], v[76:77], v[78:79], v[44:45]
  v_pk_fma_f32 v[46:47], v[80:81], v[82:83], v[46:47]
  v_pk_mul_f32 v[52:53], v[192:193], v[192:193]
  v_pk_mul_f32 v[56:57], v[208:209], v[208:209]
  v_pk_mul_f32 v[60:61], v[194:195], v[194:195]
  v_pk_mul_f32 v[64:65], v[210:211], v[210:211]
  v_pk_fma_f32 v[52:53], v[52:53], v[14:15], v[12:13]
  v_pk_fma_f32 v[56:57], v[56:57], v[14:15], v[12:13]
  v_pk_fma_f32 v[60:61], v[60:61], v[14:15], v[12:13]
  v_pk_fma_f32 v[64:65], v[64:65], v[14:15], v[12:13]
  v_pk_mul_f32 v[52:53], v[52:53], v[192:193]
  v_pk_mul_f32 v[56:57], v[56:57], v[208:209]
  v_pk_mul_f32 v[60:61], v[60:61], v[194:195]
  v_pk_mul_f32 v[64:65], v[64:65], v[210:211]
  v_exp_f32 v52, v52
  v_exp_f32 v53, v53
  v_exp_f32 v56, v56
  v_exp_f32 v57, v57
  v_exp_f32 v60, v60
  v_exp_f32 v61, v61
  v_exp_f32 v64, v64
  v_exp_f32 v65, v65
  v_pk_mul_f32 v[54:55], v[192:193], v[24:25]
  v_pk_mul_f32 v[58:59], v[208:209], v[24:25]
  v_pk_mul_f32 v[62:63], v[194:195], v[26:27]
  v_pk_mul_f32 v[66:67], v[210:211], v[26:27]
  v_pk_add_f32 v[52:53], v[52:53], v[248:249]
  v_pk_add_f32 v[56:57], v[56:57], v[248:249]
  v_pk_add_f32 v[60:61], v[60:61], v[248:249]
  v_pk_add_f32 v[64:65], v[64:65], v[248:249]
  v_rcp_f32 v52, v52
  v_rcp_f32 v53, v53
  v_rcp_f32 v56, v56
  v_rcp_f32 v57, v57
  v_rcp_f32 v60, v60
  v_rcp_f32 v61, v61
  v_rcp_f32 v64, v64
  v_rcp_f32 v65, v65
  v_pk_fma_f32 v[44:45], v[52:53], v[54:55], v[44:45]
  v_pk_fma_f32 v[46:47], v[56:57], v[58:59], v[46:47]
  v_pk_fma_f32 v[44:45], v[60:61], v[62:63], v[44:45]
  v_pk_fma_f32 v[46:47], v[64:65], v[66:67], v[46:47]
  v_pk_mul_f32 v[68:69], v[196:197], v[196:197]
  v_pk_mul_f32 v[72:73], v[212:213], v[212:213]
  v_pk_mul_f32 v[76:77], v[198:199], v[198:199]
  v_pk_mul_f32 v[80:81], v[214:215], v[214:215]
  v_pk_fma_f32 v[68:69], v[68:69], v[14:15], v[12:13]
  v_pk_fma_f32 v[72:73], v[72:73], v[14:15], v[12:13]
  v_pk_fma_f32 v[76:77], v[76:77], v[14:15], v[12:13]
  v_pk_fma_f32 v[80:81], v[80:81], v[14:15], v[12:13]
  v_pk_mul_f32 v[68:69], v[68:69], v[196:197]
  v_pk_mul_f32 v[72:73], v[72:73], v[212:213]
  v_pk_mul_f32 v[76:77], v[76:77], v[198:199]
  v_pk_mul_f32 v[80:81], v[80:81], v[214:215]
  v_exp_f32 v68, v68
  v_exp_f32 v69, v69
  v_exp_f32 v72, v72
  v_exp_f32 v73, v73
  v_exp_f32 v76, v76
  v_exp_f32 v77, v77
  v_exp_f32 v80, v80
  v_exp_f32 v81, v81
  v_pk_mul_f32 v[70:71], v[196:197], v[28:29]
  v_pk_mul_f32 v[74:75], v[212:213], v[28:29]
  v_pk_mul_f32 v[78:79], v[198:199], v[30:31]
  v_pk_mul_f32 v[82:83], v[214:215], v[30:31]
  v_pk_add_f32 v[68:69], v[68:69], v[248:249]
  v_pk_add_f32 v[72:73], v[72:73], v[248:249]
  v_pk_add_f32 v[76:77], v[76:77], v[248:249]
  v_pk_add_f32 v[80:81], v[80:81], v[248:249]
  v_rcp_f32 v68, v68
  v_rcp_f32 v69, v69
  v_rcp_f32 v72, v72
  v_rcp_f32 v73, v73
  v_rcp_f32 v76, v76
  v_rcp_f32 v77, v77
  v_rcp_f32 v80, v80
  v_rcp_f32 v81, v81
  v_pk_fma_f32 v[44:45], v[68:69], v[70:71], v[44:45]
  v_pk_fma_f32 v[46:47], v[72:73], v[74:75], v[46:47]
  v_pk_fma_f32 v[44:45], v[76:77], v[78:79], v[44:45]
  v_pk_fma_f32 v[46:47], v[80:81], v[82:83], v[46:47]
  v_pk_mul_f32 v[52:53], v[216:217], v[216:217]
  v_pk_mul_f32 v[56:57], v[232:233], v[232:233]
  v_pk_mul_f32 v[60:61], v[218:219], v[218:219]
  v_pk_mul_f32 v[64:65], v[234:235], v[234:235]
  v_pk_fma_f32 v[52:53], v[52:53], v[14:15], v[12:13]
  v_pk_fma_f32 v[56:57], v[56:57], v[14:15], v[12:13]
  v_pk_fma_f32 v[60:61], v[60:61], v[14:15], v[12:13]
  v_pk_fma_f32 v[64:65], v[64:65], v[14:15], v[12:13]
  v_pk_mul_f32 v[52:53], v[52:53], v[216:217]
  v_pk_mul_f32 v[56:57], v[56:57], v[232:233]
  v_pk_mul_f32 v[60:61], v[60:61], v[218:219]
  v_pk_mul_f32 v[64:65], v[64:65], v[234:235]
  v_exp_f32 v52, v52
  v_exp_f32 v53, v53
  v_exp_f32 v56, v56
  v_exp_f32 v57, v57
  v_exp_f32 v60, v60
  v_exp_f32 v61, v61
  v_exp_f32 v64, v64
  v_exp_f32 v65, v65
  v_pk_mul_f32 v[54:55], v[216:217], v[16:17]
  v_pk_mul_f32 v[58:59], v[232:233], v[16:17]
  v_pk_mul_f32 v[62:63], v[218:219], v[18:19]
  v_pk_mul_f32 v[66:67], v[234:235], v[18:19]
  v_pk_add_f32 v[52:53], v[52:53], v[248:249]
  v_pk_add_f32 v[56:57], v[56:57], v[248:249]
  v_pk_add_f32 v[60:61], v[60:61], v[248:249]
  v_pk_add_f32 v[64:65], v[64:65], v[248:249]
  v_rcp_f32 v52, v52
  v_rcp_f32 v53, v53
  v_rcp_f32 v56, v56
  v_rcp_f32 v57, v57
  v_rcp_f32 v60, v60
  v_rcp_f32 v61, v61
  v_rcp_f32 v64, v64
  v_rcp_f32 v65, v65
  v_pk_mul_f32 v[48:49], v[52:53], v[54:55]
  v_pk_mul_f32 v[50:51], v[56:57], v[58:59]
  v_pk_fma_f32 v[48:49], v[60:61], v[62:63], v[48:49]
  v_pk_fma_f32 v[50:51], v[64:65], v[66:67], v[50:51]
  v_pk_mul_f32 v[68:69], v[220:221], v[220:221]
  v_pk_mul_f32 v[72:73], v[236:237], v[236:237]
  v_pk_mul_f32 v[76:77], v[222:223], v[222:223]
  v_pk_mul_f32 v[80:81], v[238:239], v[238:239]
  v_pk_fma_f32 v[68:69], v[68:69], v[14:15], v[12:13]
  v_pk_fma_f32 v[72:73], v[72:73], v[14:15], v[12:13]
  v_pk_fma_f32 v[76:77], v[76:77], v[14:15], v[12:13]
  v_pk_fma_f32 v[80:81], v[80:81], v[14:15], v[12:13]
  v_pk_mul_f32 v[68:69], v[68:69], v[220:221]
  v_pk_mul_f32 v[72:73], v[72:73], v[236:237]
  v_pk_mul_f32 v[76:77], v[76:77], v[222:223]
  v_pk_mul_f32 v[80:81], v[80:81], v[238:239]
  v_exp_f32 v68, v68
  v_exp_f32 v69, v69
  v_exp_f32 v72, v72
  v_exp_f32 v73, v73
  v_exp_f32 v76, v76
  v_exp_f32 v77, v77
  v_exp_f32 v80, v80
  v_exp_f32 v81, v81
  v_pk_mul_f32 v[70:71], v[220:221], v[20:21]
  v_pk_mul_f32 v[74:75], v[236:237], v[20:21]
  v_pk_mul_f32 v[78:79], v[222:223], v[22:23]
  v_pk_mul_f32 v[82:83], v[238:239], v[22:23]
  v_pk_add_f32 v[68:69], v[68:69], v[248:249]
  v_pk_add_f32 v[72:73], v[72:73], v[248:249]
  v_pk_add_f32 v[76:77], v[76:77], v[248:249]
  v_pk_add_f32 v[80:81], v[80:81], v[248:249]
  v_rcp_f32 v68, v68
  v_rcp_f32 v69, v69
  v_rcp_f32 v72, v72
  v_rcp_f32 v73, v73
  v_rcp_f32 v76, v76
  v_rcp_f32 v77, v77
  v_rcp_f32 v80, v80
  v_rcp_f32 v81, v81
  v_pk_fma_f32 v[48:49], v[68:69], v[70:71], v[48:49]
  v_pk_fma_f32 v[50:51], v[72:73], v[74:75], v[50:51]
  v_pk_fma_f32 v[48:49], v[76:77], v[78:79], v[48:49]
  v_pk_fma_f32 v[50:51], v[80:81], v[82:83], v[50:51]
  v_pk_mul_f32 v[52:53], v[224:225], v[224:225]
  v_pk_mul_f32 v[56:57], v[240:241], v[240:241]
  v_pk_mul_f32 v[60:61], v[226:227], v[226:227]
  v_pk_mul_f32 v[64:65], v[242:243], v[242:243]
  v_pk_fma_f32 v[52:53], v[52:53], v[14:15], v[12:13]
  v_pk_fma_f32 v[56:57], v[56:57], v[14:15], v[12:13]
  v_pk_fma_f32 v[60:61], v[60:61], v[14:15], v[12:13]
  v_pk_fma_f32 v[64:65], v[64:65], v[14:15], v[12:13]
  v_pk_mul_f32 v[52:53], v[52:53], v[224:225]
  v_pk_mul_f32 v[56:57], v[56:57], v[240:241]
  v_pk_mul_f32 v[60:61], v[60:61], v[226:227]
  v_pk_mul_f32 v[64:65], v[64:65], v[242:243]
  v_exp_f32 v52, v52
  v_exp_f32 v53, v53
  v_exp_f32 v56, v56
  v_exp_f32 v57, v57
  v_exp_f32 v60, v60
  v_exp_f32 v61, v61
  v_exp_f32 v64, v64
  v_exp_f32 v65, v65
  v_pk_mul_f32 v[54:55], v[224:225], v[24:25]
  v_pk_mul_f32 v[58:59], v[240:241], v[24:25]
  v_pk_mul_f32 v[62:63], v[226:227], v[26:27]
  v_pk_mul_f32 v[66:67], v[242:243], v[26:27]
  v_pk_add_f32 v[52:53], v[52:53], v[248:249]
  v_pk_add_f32 v[56:57], v[56:57], v[248:249]
  v_pk_add_f32 v[60:61], v[60:61], v[248:249]
  v_pk_add_f32 v[64:65], v[64:65], v[248:249]
  v_rcp_f32 v52, v52
  v_rcp_f32 v53, v53
  v_rcp_f32 v56, v56
  v_rcp_f32 v57, v57
  v_rcp_f32 v60, v60
  v_rcp_f32 v61, v61
  v_rcp_f32 v64, v64
  v_rcp_f32 v65, v65
  v_pk_fma_f32 v[48:49], v[52:53], v[54:55], v[48:49]
  v_pk_fma_f32 v[50:51], v[56:57], v[58:59], v[50:51]
  v_pk_fma_f32 v[48:49], v[60:61], v[62:63], v[48:49]
  v_pk_fma_f32 v[50:51], v[64:65], v[66:67], v[50:51]
  v_pk_mul_f32 v[68:69], v[228:229], v[228:229]
  v_pk_mul_f32 v[72:73], v[244:245], v[244:245]
  v_pk_mul_f32 v[76:77], v[230:231], v[230:231]
  v_pk_mul_f32 v[80:81], v[246:247], v[246:247]
  v_pk_fma_f32 v[68:69], v[68:69], v[14:15], v[12:13]
  v_pk_fma_f32 v[72:73], v[72:73], v[14:15], v[12:13]
  v_pk_fma_f32 v[76:77], v[76:77], v[14:15], v[12:13]
  v_pk_fma_f32 v[80:81], v[80:81], v[14:15], v[12:13]
  v_pk_mul_f32 v[68:69], v[68:69], v[228:229]
  v_pk_mul_f32 v[72:73], v[72:73], v[244:245]
  v_pk_mul_f32 v[76:77], v[76:77], v[230:231]
  v_pk_mul_f32 v[80:81], v[80:81], v[246:247]
  v_exp_f32 v68, v68
  v_exp_f32 v69, v69
  v_exp_f32 v72, v72
  v_exp_f32 v73, v73
  v_exp_f32 v76, v76
  v_exp_f32 v77, v77
  v_exp_f32 v80, v80
  v_exp_f32 v81, v81
  v_pk_mul_f32 v[70:71], v[228:229], v[28:29]
  v_pk_mul_f32 v[74:75], v[244:245], v[28:29]
  v_pk_mul_f32 v[78:79], v[230:231], v[30:31]
  v_pk_mul_f32 v[82:83], v[246:247], v[30:31]
  v_pk_add_f32 v[68:69], v[68:69], v[248:249]
  v_pk_add_f32 v[72:73], v[72:73], v[248:249]
  v_pk_add_f32 v[76:77], v[76:77], v[248:249]
  v_pk_add_f32 v[80:81], v[80:81], v[248:249]
  v_rcp_f32 v68, v68
  v_rcp_f32 v69, v69
  v_rcp_f32 v72, v72
  v_rcp_f32 v73, v73
  v_rcp_f32 v76, v76
  v_rcp_f32 v77, v77
  v_rcp_f32 v80, v80
  v_rcp_f32 v81, v81
  v_pk_fma_f32 v[48:49], v[68:69], v[70:71], v[48:49]
  v_pk_fma_f32 v[50:51], v[72:73], v[74:75], v[50:51]
  v_pk_fma_f32 v[48:49], v[76:77], v[78:79], v[48:49]
  v_pk_fma_f32 v[50:51], v[80:81], v[82:83], v[50:51]
  v_add_f32 v32, v32, v33
  v_add_f32 v34, v34, v35
  v_add_f32 v36, v36, v37
  v_add_f32 v38, v38, v39
  v_add_f32 v40, v40, v41
  v_add_f32 v42, v42, v43
  v_add_f32 v44, v44, v45
  v_add_f32 v46, v46, v47
  v_add_f32 v48, v48, v49
  v_add_f32 v50, v50, v51
  v_permlane32_swap_b32 v32, v34
  v_permlane32_swap_b32 v36, v38
  v_permlane32_swap_b32 v40, v42
  v_permlane32_swap_b32 v44, v46
  v_permlane32_swap_b32 v48, v50
  v_add_f32 v48, v48, v50
  v_add_f32 v32, v32, v34
  v_add_f32 v36, v36, v38
  v_add_f32 v40, v40, v42
  v_add_f32 v44, v44, v46
  v_mov_b32 v50, v48
  v_permlane16_swap_b32 v32, v36
  v_permlane16_swap_b32 v40, v44
  v_permlane16_swap_b32 v48, v50
  v_add_f32 v32, v32, v36
  v_add_f32 v40, v40, v44
  v_add_f32 v48, v48, v50
  ds_write_b32 v10, v32
  ds_write_b32 v10, v40 offset:256
  s_mov_b32 exec_lo, 0xffff
  s_mov_b32 exec_hi, 0xffff
  ds_write_b32 v10, v48 offset:512
  s_mov_b64 exec, -1
  s_waitcnt lgkmcnt(0)
  s_barrier
  s_endpgm
L_ld_tail:
  s_barrier
  s_add_u32 m0, s75, 122880
  s_nop 0
  buffer_load_dwordx4 v4, s[44:47], s74 offen lds
  s_add_u32 m0, s75, 123904
  s_nop 0
  buffer_load_dwordx4 v5, s[44:47], s74 offen lds
  s_add_u32 s74, s74, 106496
  s_mov_b32 m0, 147712
  s_mov_b64 exec, 0xffff
  buffer_load_dwordx4 v11, s[52:55], s77 offen lds
  s_mov_b64 exec, -1
  s_mov_b32 s60, s24
  s_and_b32 s61, s25, 0xffff
  s_mov_b32 s62, 268435456
  s_mov_b32 s63, 0x20000
  s_mov_b32 s56, s20
  s_and_b32 s57, s21, 0xffff
  s_mov_b32 s58, 8192
  s_mov_b32 s59, 0x20000
  s_mov_b32 s64, s22
  s_and_b32 s65, s23, 0xffff
  s_mov_b32 s66, 256
  s_mov_b32 s67, 0x20000
  s_load_dword s80, s[18:19], 0
  v_mov_b32 v100, 0
  s_mov_b64 exec, 1
  s_mov_b32 s81, 0x80000
  buffer_load_dword v101, v100, s[60:63], s81 offen
  buffer_load_dword v102, v100, s[56:59], 0 offen
  s_mov_b64 exec, -1
  s_mov_b64 exec, 1
  buffer_load_dword v250, v100, s[64:67], 0 offen offset:240 sc1
  s_mov_b64 exec, -1
  s_waitcnt vmcnt(11)
  s_barrier
  s_waitcnt vmcnt(0)
  s_barrier
  s_cmp_lg_u32 s3, 4
  s_cbranch_scc1 L_end
  v_lshlrev_b32 v3, 4, v0
  v_lshlrev_b32 v4, 2, v0
  v_add_u32 v1, 147968, v3
  v_add_u32 v2, 148992, v4
  v_add_u32 v4, 1024, v4
  v_mov_b32 v5, 32
  v_mov_b32 v7, s26
  s_mul_i32 s68, s26, 1280
  s_mul_i32 s69, s27, 16640
  s_add_u32 s69, s69, s68
  s_setprio 3
  s_barrier
  ds_read_b128 v[64:67], v1
  ds_read_b128 v[72:75], v1 offset:1280
  ds_read2st64_b32 v[68:69], v2 offset0:0 offset1:5
  s_waitcnt lgkmcnt(0)
  v_pk_add_f32 v[64:65], v[64:65], v[72:73]
  v_pk_add_f32 v[66:67], v[66:67], v[74:75]
  v_add_f32 v68, v68, v69
  buffer_store_dwordx4 v[64:67], v3, s[60:63], s69 offen sc1
  buffer_store_dword v68, v4, s[60:63], s69 offen sc1
  s_mov_b64 exec, 1
L_pub:
  v_lshlrev_b32 v6, 4, v7
  v_cmp_eq_u32 vcc, 12, v7
  v_mov_b32 v8, 436
  v_mov_b32 v9, 434
  v_cndmask_b32 v8, v8, v9, vcc
  v_sub_u32 v8, v8, v5
  s_waitcnt vmcnt(0)
  buffer_atomic_add v5, v6, s[64:67], 0 offen sc0
  s_waitcnt vmcnt(0) lgkmcnt(0)
  v_cmp_eq_u32 s[82:83], v5, v8
  s_mov_b64 exec, -1
  s_lshl_b32 s80, s80, 16
L_fin:
  s_cmp_eq_u32 s82, 0
  s_cbranch_scc1 L_done
  s_ff1_i32_b32 s70, s82
  s_bitset0_b32 s82, s70
  v_readlane_b32 s71, v7, s70
  s_nop 0
  s_mul_i32 s68, s71, 1280
  s_mul_i32 s71, s71, 640
  buffer_load_dwordx4 v[64:67], v3, s[60:63], s68 offen sc1
  buffer_load_dword v68, v4, s[60:63], s68 offen sc1
  s_add_u32 s68, s68, 16640
  buffer_load_dwordx4 v[72:75], v3, s[60:63], s68 offen sc1
  buffer_load_dword v76, v4, s[60:63], s68 offen sc1
  s_add_u32 s68, s68, 16640
  buffer_load_dwordx4 v[80:83], v3, s[60:63], s68 offen sc1
  buffer_load_dword v84, v4, s[60:63], s68 offen sc1
  s_add_u32 s68, s68, 16640
  buffer_load_dwordx4 v[88:91], v3, s[60:63], s68 offen sc1
  buffer_load_dword v92, v4, s[60:63], s68 offen sc1
  s_add_u32 s68, s68, 16640
  buffer_load_dwordx4 v[96:99], v3, s[60:63], s68 offen sc1
  buffer_load_dword v100, v4, s[60:63], s68 offen sc1
  s_add_u32 s68, s68, 16640
  buffer_load_dwordx4 v[104:107], v3, s[60:63], s68 offen sc1
  buffer_load_dword v108, v4, s[60:63], s68 offen sc1
  s_add_u32 s68, s68, 16640
  buffer_load_dwordx4 v[112:115], v3, s[60:63], s68 offen sc1
  buffer_load_dword v116, v4, s[60:63], s68 offen sc1
  s_add_u32 s68, s68, 16640
  buffer_load_dwordx4 v[120:123], v3, s[60:63], s68 offen sc1
  buffer_load_dword v124, v4, s[60:63], s68 offen sc1
  s_add_u32 s68, s68, 16640
  buffer_load_dwordx4 v[128:131], v3, s[60:63], s68 offen sc1
  buffer_load_dword v132, v4, s[60:63], s68 offen sc1
  s_add_u32 s68, s68, 16640
  buffer_load_dwordx4 v[136:139], v3, s[60:63], s68 offen sc1
  buffer_load_dword v140, v4, s[60:63], s68 offen sc1
  s_add_u32 s68, s68, 16640
  buffer_load_dwordx4 v[144:147], v3, s[60:63], s68 offen sc1
  buffer_load_dword v148, v4, s[60:63], s68 offen sc1
  s_add_u32 s68, s68, 16640
  buffer_load_dwordx4 v[152:155], v3, s[60:63], s68 offen sc1
  buffer_load_dword v156, v4, s[60:63], s68 offen sc1
  s_add_u32 s68, s68, 16640
  buffer_load_dwordx4 v[160:163], v3, s[60:63], s68 offen sc1
  buffer_load_dword v164, v4, s[60:63], s68 offen sc1
  s_add_u32 s68, s68, 16640
  buffer_load_dwordx4 v[168:171], v3, s[60:63], s68 offen sc1
  buffer_load_dword v172, v4, s[60:63], s68 offen sc1
  s_add_u32 s68, s68, 16640
  v_lshrrev_b32 v1, 1, v3
  v_lshrrev_b32 v2, 1, v4
  s_waitcnt vmcnt(25)
  v_pk_add_f32 v[64:65], v[64:65], v[72:73]
  v_pk_add_f32 v[66:67], v[66:67], v[74:75]
  s_waitcnt vmcnt(24)
  v_add_f32 v68, v68, v76
  s_waitcnt vmcnt(23)
  v_pk_add_f32 v[64:65], v[64:65], v[80:81]
  v_pk_add_f32 v[66:67], v[66:67], v[82:83]
  s_waitcnt vmcnt(22)
  v_add_f32 v68, v68, v84
  s_waitcnt vmcnt(21)
  v_pk_add_f32 v[64:65], v[64:65], v[88:89]
  v_pk_add_f32 v[66:67], v[66:67], v[90:91]
  s_waitcnt vmcnt(20)
  v_add_f32 v68, v68, v92
  s_waitcnt vmcnt(19)
  v_pk_add_f32 v[64:65], v[64:65], v[96:97]
  v_pk_add_f32 v[66:67], v[66:67], v[98:99]
  s_waitcnt vmcnt(18)
  v_add_f32 v68, v68, v100
  s_waitcnt vmcnt(17)
  v_pk_add_f32 v[64:65], v[64:65], v[104:105]
  v_pk_add_f32 v[66:67], v[66:67], v[106:107]
  s_waitcnt vmcnt(16)
  v_add_f32 v68, v68, v108
  s_waitcnt vmcnt(15)
  v_pk_add_f32 v[64:65], v[64:65], v[112:113]
  v_pk_add_f32 v[66:67], v[66:67], v[114:115]
  s_waitcnt vmcnt(14)
  v_add_f32 v68, v68, v116
  s_waitcnt vmcnt(13)
  v_pk_add_f32 v[64:65], v[64:65], v[120:121]
  v_pk_add_f32 v[66:67], v[66:67], v[122:123]
  s_waitcnt vmcnt(12)
  v_add_f32 v68, v68, v124
  s_waitcnt vmcnt(11)
  v_pk_add_f32 v[64:65], v[64:65], v[128:129]
  v_pk_add_f32 v[66:67], v[66:67], v[130:131]
  s_waitcnt vmcnt(10)
  v_add_f32 v68, v68, v132
  s_waitcnt vmcnt(9)
  v_pk_add_f32 v[64:65], v[64:65], v[136:137]
  v_pk_add_f32 v[66:67], v[66:67], v[138:139]
  s_waitcnt vmcnt(8)
  v_add_f32 v68, v68, v140
  s_waitcnt vmcnt(7)
  v_pk_add_f32 v[64:65], v[64:65], v[144:145]
  v_pk_add_f32 v[66:67], v[66:67], v[146:147]
  s_waitcnt vmcnt(6)
  v_add_f32 v68, v68, v148
  s_waitcnt vmcnt(5)
  v_pk_add_f32 v[64:65], v[64:65], v[152:153]
  v_pk_add_f32 v[66:67], v[66:67], v[154:155]
  s_waitcnt vmcnt(4)
  v_add_f32 v68, v68, v156
  s_waitcnt vmcnt(3)
  v_pk_add_f32 v[64:65], v[64:65], v[160:161]
  v_pk_add_f32 v[66:67], v[66:67], v[162:163]
  s_waitcnt vmcnt(2)
  v_add_f32 v68, v68, v164
  s_waitcnt vmcnt(1)
  v_pk_add_f32 v[64:65], v[64:65], v[168:169]
  v_pk_add_f32 v[66:67], v[66:67], v[170:171]
  s_waitcnt vmcnt(0)
  v_add_f32 v68, v68, v172
  v_add_f32 v64, s80, v64
  v_add_f32 v65, s80, v65
  v_add_f32 v66, s80, v66
  v_add_f32 v67, s80, v67
  v_add_f32 v68, s80, v68
  v_cvt_pk_bf16_f32 v10, v64, v65
  v_cvt_pk_bf16_f32 v11, v66, v67
  v_cvt_pk_bf16_f32 v12, v68, v68
  buffer_store_dwordx2 v[10:11], v1, s[56:59], s71 offen
  buffer_store_short v12, v2, s[56:59], s71 offen
  s_branch L_fin
L_done:
  s_endpgm
L_cin_done:
  v_mul_f32 v116, v184, v192
  v_mul_f32 v117, v185, v193
  v_mul_f32 v118, v186, v194
  v_mul_f32 v119, v187, v195
  v_fmac_f32 v116, v188, v191
  v_fmac_f32 v117, v200, v208
  v_fmac_f32 v118, v201, v209
  v_fmac_f32 v119, v202, v210
  v_fmac_f32 v116, v203, v211
  v_fmac_f32 v117, v204, v207
  v_fmac_f32 v118, v216, v224
  v_fmac_f32 v119, v217, v225
  v_fmac_f32 v116, v218, v226
  v_fmac_f32 v117, v219, v227
  v_fmac_f32 v118, v220, v223
  v_fmac_f32 v119, v232, v240
  v_fmac_f32 v116, v233, v241
  v_fmac_f32 v117, v234, v242
  v_fmac_f32 v118, v235, v243
  v_fmac_f32 v119, v236, v239
  v_fmac_f32 v116, v189, v196
  v_fmac_f32 v117, v189, v197
  v_fmac_f32 v118, v190, v198
  v_fmac_f32 v119, v190, v199
  v_fmac_f32 v116, v205, v212
  v_fmac_f32 v117, v205, v213
  v_fmac_f32 v118, v206, v214
  v_fmac_f32 v119, v206, v215
  v_fmac_f32 v116, v221, v228
  v_fmac_f32 v117, v221, v229
  v_fmac_f32 v118, v222, v230
  v_fmac_f32 v119, v222, v231
  v_fmac_f32 v116, v237, v244
  v_fmac_f32 v117, v237, v245
  v_fmac_f32 v118, v238, v246
  v_fmac_f32 v119, v238, v247
  v_add_f32 v116, v116, v117
  v_add_f32 v118, v118, v119
  v_add_f32 v116, v116, v118
  v_mul_f32 v116, s74, v116
  v_mul_f32 v116, s75, v116
  ds_write_b32 v7, v116
  s_mul_i32 s98, s3, 1536
  s_add_u32 s98, s98, 116736
  v_lshlrev_b32 v116, 5, v0
  v_add_u32 v116, s98, v116
  ds_read_b128 v[60:63], v116
  ds_read_b128 v[64:67], v116 offset:16
  v_lshrrev_b32 v117, 3, v0
  v_cmp_gt_u32 vcc, 6, v117
  v_lshlrev_b32 v117, 5, v117
  v_add_u32 v117, s85, v117
  s_waitcnt lgkmcnt(1)
  v_pk_add_f32 v[60:61], v[60:61], v[62:63]
  s_waitcnt lgkmcnt(0)
  v_pk_add_f32 v[64:65], v[64:65], v[66:67]
  v_pk_add_f32 v[60:61], v[60:61], v[64:65]
  v_add_f32 v60, v60, v61
  s_nop 1
  v_add_f32_dpp v60, v60, v60 quad_perm:[1,0,3,2] row_mask:0xf bank_mask:0xf
  s_nop 1
  v_add_f32_dpp v60, v60, v60 quad_perm:[2,3,0,1] row_mask:0xf bank_mask:0xf
  s_nop 1
  v_add_f32_dpp v60, v60, v60 row_half_mirror row_mask:0xf bank_mask:0xf
  s_and_b64 exec, exec, vcc
  ds_write_b32 v117, v60
  s_mov_b64 exec, -1
  s_waitcnt lgkmcnt(0)
  s_barrier
  s_cmp_lg_u32 s3, 0
  s_cbranch_scc1 L_end
  v_lshlrev_b32 v4, 2, v0
  v_add_u32 v2, 129728, v4
  ds_read_b32 v64, v2
  s_mul_i32 s69, s26, 192
  s_add_u32 s69, s69, 216320
  s_mul_i32 s68, s26, 3
  s_mul_i32 s70, s68, 3277
  s_lshr_b32 s70, s70, 16
  v_add_u32 v7, s70, v0
  s_mul_i32 s70, s70, 20
  s_add_u32 s70, s70, 20
  s_sub_u32 s70, s70, s68
  s_min_u32 s70, s70, 3
  s_sub_u32 s68, 3, s70
  v_mov_b32 v5, s68
  v_writelane_b32 v5, s70, 0
  s_cmp_eq_u32 s68, 0
  s_cselect_b32 s68, 1, 3
  v_lshlrev_b32 v3, 4, v0
  s_mov_b32 exec_hi, 0xffff
  s_waitcnt lgkmcnt(0)
  buffer_store_dword v64, v4, s[60:63], s69 offen sc1
  s_mov_b32 exec_hi, -1
  v_add_u32 v4, 1024, v4
  s_mov_b32 exec_lo, s68
  s_mov_b32 exec_hi, 0
  s_branch L_pub
L_ld:
  s_mov_b32 s44, s12
  s_and_b32 s45, s13, 0xffff
  s_mov_b32 s46, 5537792
  s_mov_b32 s47, 0x20000
  s_and_b32 s70, s79, 1
  s_lshl_b32 s70, s70, 3
  v_lshlrev_b32 v117, 1, v116
  v_or_b32 v117, s70, v117
  v_xor_b32 v117, v117, v0
  v_and_b32 v117, 15, v117
  v_mul_u32_u24 v4, 3328, v116
  v_lshl_add_u32 v4, v117, 4, v4
  v_add_u32 v5, 13312, v4
  s_mul_i32 s74, s79, 26624
  s_add_u32 s74, s74, s77
  s_lshl_b32 s75, s79, 11
  s_add_u32 m0, s75, 122880
  s_nop 0
  buffer_load_dwordx4 v4, s[44:47], s74 offen lds
  s_add_u32 m0, s75, 123904
  s_nop 0
  buffer_load_dwordx4 v5, s[44:47], s74 offen lds
  s_add_u32 s74, s74, 106496
  s_mul_i32 s70, s79, 80
  s_add_u32 s70, s70, s71
  s_mul_i32 s73, s70, 104
  s_add_u32 s81, s73, 4160
  s_mul_i32 s76, s79, 10240
  v_and_b32 v118, 7, v0
  v_xor_b32 v118, v118, v116
  v_lshlrev_b32 v2, 4, v118
  v_xor_b32 v3, 64, v2
  v_mul_u32_u24 v118, 48, v116
  v_sub_u32 v12, v11, v118
  s_mov_b32 s72, 0
  s_mul_i32 s70, s79, 13
  s_add_u32 s70, s70, s27
  s_min_u32 s70, s70, 39
  s_lshl_b32 s70, s70, 3
  s_add_u32 s70, s70, s71
  s_mul_i32 s84, s70, 104
  v_lshrrev_b32 v118, 2, v0
  v_min_u32 v118, 7, v118
  v_mul_u32_u24 v118, 104, v118
  v_and_b32 v117, 3, v0
  v_lshl_add_u32 v7, v117, 2, v118
  s_lshl_b32 s70, s26, 2
  s_add_u32 s70, s70, s79
  s_add_u32 s70, s70, 384
  s_mul_i32 s85, s70, 3328
  s_add_u32 s85, s85, s77
  s_mov_b32 s70, 173056
  v_lshrrev_b32 v118, 1, v0
  v_mul_lo_u32 v118, s70, v118
  v_and_b32 v117, 1, v0
  v_lshl_add_u32 v76, v117, 7, v118
  s_mov_b32 s52, s16
  s_and_b32 s53, s17, 0xffff
  s_mov_b32 s54, 3328
  s_mov_b32 s55, 0x20000
  s_mul_i32 s70, s79, 2560
  s_add_u32 s70, s70, L_tail-L_pc
  v_lshlrev_b32 v8, 7, v0
  v_add_u32 v8, s70, v8
  v_mov_b32 v9, s93
  v_add_co_u32 v8, vcc, s92, v8
  s_nop 1
  v_addc_co_u32 v9, vcc, 0, v9, vcc
  s_waitcnt vmcnt(3)
  v_lshlrev_b32 v108, 7, v108
  buffer_load_dwordx4 v[16:19], v12, s[28:31], s73 offen offset:0
  buffer_load_dwordx4 v[20:23], v12, s[28:31], s73 offen offset:832
  buffer_load_dwordx4 v[24:27], v12, s[28:31], s73 offen offset:1664
  buffer_load_dwordx4 v[28:31], v12, s[28:31], s73 offen offset:2496
  buffer_load_dwordx4 v[32:35], v12, s[28:31], s73 offen offset:3328
  buffer_load_dwordx4 v[36:39], v12, s[28:31], s81 offen offset:0
  buffer_load_dwordx4 v[40:43], v12, s[28:31], s81 offen offset:832
  buffer_load_dwordx4 v[44:47], v12, s[28:31], s81 offen offset:1664
  buffer_load_dwordx4 v[48:51], v12, s[28:31], s81 offen offset:2496
  buffer_load_dwordx4 v[52:55], v12, s[28:31], s81 offen offset:3328
  buffer_load_dword v250, v108, s[32:35], 0 offen
  v_lshlrev_b32 v110, 7, v110
  buffer_load_dword v251, v110, s[32:35], 0 offen
  s_add_u32 m0, s75, 131072
  s_nop 0
  buffer_load_dwordx4 v4, s[44:47], s74 offen lds
  s_add_u32 m0, s75, 132096
  s_nop 0
  buffer_load_dwordx4 v5, s[44:47], s74 offen lds
  s_add_u32 s74, s74, 106496
  s_waitcnt vmcnt(13)
  v_lshlrev_b32 v16, 7, v16
  v_lshlrev_b32 v18, 7, v18
  v_lshlrev_b32 v17, 7, v17
  v_lshlrev_b32 v19, 7, v19
  v_add_u32_dpp v56, v16, v2 row_newbcast:0 row_mask:0xf bank_mask:0x3
  s_nop 1
  v_add_u32_dpp v56, v18, v2 row_newbcast:6 row_mask:0xf bank_mask:0xc
  s_add_u32 m0, s76, 0
  s_nop 0
  buffer_load_dwordx4 v56, s[32:35], 0 offen lds
  s_waitcnt vmcnt(13)
  v_lshlrev_b32 v20, 7, v20
  v_lshlrev_b32 v22, 7, v22
  v_lshlrev_b32 v21, 7, v21
  v_lshlrev_b32 v23, 7, v23
  v_add_u32_dpp v57, v20, v3 row_newbcast:0 row_mask:0xf bank_mask:0x3
  s_nop 1
  v_add_u32_dpp v57, v22, v3 row_newbcast:6 row_mask:0xf bank_mask:0xc
  s_add_u32 m0, s76, 1024
  s_nop 0
  buffer_load_dwordx4 v57, s[32:35], 0 offen lds
  s_waitcnt vmcnt(13)
  v_lshlrev_b32 v24, 7, v24
  v_lshlrev_b32 v26, 7, v26
  v_lshlrev_b32 v25, 7, v25
  v_lshlrev_b32 v27, 7, v27
  v_add_u32_dpp v58, v24, v2 row_newbcast:0 row_mask:0xf bank_mask:0x3
  s_nop 1
  v_add_u32_dpp v58, v26, v2 row_newbcast:6 row_mask:0xf bank_mask:0xc
  s_add_u32 m0, s76, 2048
  s_nop 0
  buffer_load_dwordx4 v58, s[32:35], 0 offen lds
  s_waitcnt vmcnt(13)
  v_lshlrev_b32 v28, 7, v28
  v_lshlrev_b32 v30, 7, v30
  v_lshlrev_b32 v29, 7, v29
  v_lshlrev_b32 v31, 7, v31
  v_add_u32_dpp v59, v28, v3 row_newbcast:0 row_mask:0xf bank_mask:0x3
  s_nop 1
  v_add_u32_dpp v59, v30, v3 row_newbcast:6 row_mask:0xf bank_mask:0xc
  s_add_u32 m0, s76, 3072
  s_nop 0
  buffer_load_dwordx4 v59, s[32:35], 0 offen lds
  s_waitcnt vmcnt(13)
  v_lshlrev_b32 v32, 7, v32
  v_lshlrev_b32 v34, 7, v34
  v_lshlrev_b32 v33, 7, v33
  v_lshlrev_b32 v35, 7, v35
  v_add_u32_dpp v60, v32, v2 row_newbcast:0 row_mask:0xf bank_mask:0x3
  s_nop 1
  v_add_u32_dpp v60, v34, v2 row_newbcast:6 row_mask:0xf bank_mask:0xc
  s_add_u32 m0, s76, 4096
  s_nop 0
  buffer_load_dwordx4 v60, s[32:35], 0 offen lds
  s_waitcnt vmcnt(13)
  v_lshlrev_b32 v36, 7, v36
  v_lshlrev_b32 v38, 7, v38
  v_lshlrev_b32 v37, 7, v37
  v_lshlrev_b32 v39, 7, v39
  v_add_u32_dpp v61, v36, v3 row_newbcast:0 row_mask:0xf bank_mask:0x3
  s_nop 1
  v_add_u32_dpp v61, v38, v3 row_newbcast:6 row_mask:0xf bank_mask:0xc
  s_add_u32 m0, s76, 5120
  s_nop 0
  buffer_load_dwordx4 v61, s[32:35], 0 offen lds
  s_waitcnt vmcnt(13)
  v_lshlrev_b32 v40, 7, v40
  v_lshlrev_b32 v42, 7, v42
  v_lshlrev_b32 v41, 7, v41
  v_lshlrev_b32 v43, 7, v43
  v_add_u32_dpp v62, v40, v2 row_newbcast:0 row_mask:0xf bank_mask:0x3
  s_nop 1
  v_add_u32_dpp v62, v42, v2 row_newbcast:6 row_mask:0xf bank_mask:0xc
  s_add_u32 m0, s76, 6144
  s_nop 0
  buffer_load_dwordx4 v62, s[32:35], 0 offen lds
  s_waitcnt vmcnt(13)
  v_lshlrev_b32 v44, 7, v44
  v_lshlrev_b32 v46, 7, v46
  v_lshlrev_b32 v45, 7, v45
  v_lshlrev_b32 v47, 7, v47
  v_add_u32_dpp v63, v44, v3 row_newbcast:0 row_mask:0xf bank_mask:0x3
  s_nop 1
  v_add_u32_dpp v63, v46, v3 row_newbcast:6 row_mask:0xf bank_mask:0xc
  s_add_u32 m0, s76, 7168
  s_nop 0
  buffer_load_dwordx4 v63, s[32:35], 0 offen lds
  s_waitcnt vmcnt(13)
  v_lshlrev_b32 v48, 7, v48
  v_lshlrev_b32 v50, 7, v50
  v_lshlrev_b32 v49, 7, v49
  v_lshlrev_b32 v51, 7, v51
  v_add_u32_dpp v64, v48, v2 row_newbcast:0 row_mask:0xf bank_mask:0x3
  s_nop 1
  v_add_u32_dpp v64, v50, v2 row_newbcast:6 row_mask:0xf bank_mask:0xc
  s_add_u32 m0, s76, 8192
  s_nop 0
  buffer_load_dwordx4 v64, s[32:35], 0 offen lds
  s_waitcnt vmcnt(13)
  v_lshlrev_b32 v52, 7, v52
  v_lshlrev_b32 v54, 7, v54
  v_lshlrev_b32 v53, 7, v53
  v_lshlrev_b32 v55, 7, v55
  v_add_u32_dpp v65, v52, v3 row_newbcast:0 row_mask:0xf bank_mask:0x3
  s_nop 1
  v_add_u32_dpp v65, v54, v3 row_newbcast:6 row_mask:0xf bank_mask:0xc
  s_add_u32 m0, s76, 9216
  s_nop 0
  buffer_load_dwordx4 v65, s[32:35], 0 offen lds
  v_add_u32_dpp v56, v17, v2 row_newbcast:0 row_mask:0xf bank_mask:0x3
  s_nop 1
  v_add_u32_dpp v56, v19, v2 row_newbcast:6 row_mask:0xf bank_mask:0xc
  s_add_u32 m0, s76, 40960
  s_nop 0
  buffer_load_dwordx4 v56, s[32:35], 0 offen lds
  v_add_u32_dpp v57, v21, v3 row_newbcast:0 row_mask:0xf bank_mask:0x3
  s_nop 1
  v_add_u32_dpp v57, v23, v3 row_newbcast:6 row_mask:0xf bank_mask:0xc
  s_add_u32 m0, s76, 41984
  s_nop 0
  buffer_load_dwordx4 v57, s[32:35], 0 offen lds
  v_add_u32_dpp v58, v25, v2 row_newbcast:0 row_mask:0xf bank_mask:0x3
  s_nop 1
  v_add_u32_dpp v58, v27, v2 row_newbcast:6 row_mask:0xf bank_mask:0xc
  s_add_u32 m0, s76, 43008
  s_nop 0
  buffer_load_dwordx4 v58, s[32:35], 0 offen lds
  v_add_u32_dpp v59, v29, v3 row_newbcast:0 row_mask:0xf bank_mask:0x3
  s_nop 1
  v_add_u32_dpp v59, v31, v3 row_newbcast:6 row_mask:0xf bank_mask:0xc
  s_add_u32 m0, s76, 44032
  s_nop 0
  buffer_load_dwordx4 v59, s[32:35], 0 offen lds
  s_waitcnt vmcnt(4)
  s_barrier
  v_add_u32_dpp v60, v33, v2 row_newbcast:0 row_mask:0xf bank_mask:0x3
  s_nop 1
  v_add_u32_dpp v60, v35, v2 row_newbcast:6 row_mask:0xf bank_mask:0xc
  s_add_u32 m0, s76, 45056
  s_nop 0
  buffer_load_dwordx4 v60, s[32:35], 0 offen lds
  v_add_u32_dpp v61, v37, v3 row_newbcast:0 row_mask:0xf bank_mask:0x3
  s_nop 1
  v_add_u32_dpp v61, v39, v3 row_newbcast:6 row_mask:0xf bank_mask:0xc
  s_add_u32 m0, s76, 46080
  s_nop 0
  buffer_load_dwordx4 v61, s[32:35], 0 offen lds
  v_add_u32_dpp v62, v41, v2 row_newbcast:0 row_mask:0xf bank_mask:0x3
  s_nop 1
  v_add_u32_dpp v62, v43, v2 row_newbcast:6 row_mask:0xf bank_mask:0xc
  s_add_u32 m0, s76, 47104
  s_nop 0
  buffer_load_dwordx4 v62, s[32:35], 0 offen lds
  s_barrier
  v_add_u32_dpp v63, v45, v3 row_newbcast:0 row_mask:0xf bank_mask:0x3
  s_nop 1
  v_add_u32_dpp v63, v47, v3 row_newbcast:6 row_mask:0xf bank_mask:0xc
  s_add_u32 m0, s76, 48128
  s_nop 0
  buffer_load_dwordx4 v63, s[32:35], 0 offen lds
  v_add_u32_dpp v64, v49, v2 row_newbcast:0 row_mask:0xf bank_mask:0x3
  s_nop 1
  v_add_u32_dpp v64, v51, v2 row_newbcast:6 row_mask:0xf bank_mask:0xc
  s_add_u32 m0, s76, 49152
  s_nop 0
  buffer_load_dwordx4 v64, s[32:35], 0 offen lds
  v_add_u32_dpp v65, v53, v3 row_newbcast:0 row_mask:0xf bank_mask:0x3
  s_nop 1
  v_add_u32_dpp v65, v55, v3 row_newbcast:6 row_mask:0xf bank_mask:0xc
  s_add_u32 m0, s76, 50176
  s_nop 0
  buffer_load_dwordx4 v65, s[32:35], 0 offen lds
  v_add_u32_dpp v56, v18, v2 row_newbcast:0 row_mask:0xf bank_mask:0x3
  v_add_u32_dpp v57, v22, v3 row_newbcast:0 row_mask:0xf bank_mask:0x3
  v_add_u32_dpp v58, v26, v2 row_newbcast:0 row_mask:0xf bank_mask:0x3
  v_add_u32_dpp v59, v30, v3 row_newbcast:0 row_mask:0xf bank_mask:0x3
  v_add_u32_dpp v60, v34, v2 row_newbcast:0 row_mask:0xf bank_mask:0x3
  v_add_u32_dpp v61, v38, v3 row_newbcast:0 row_mask:0xf bank_mask:0x3
  v_add_u32_dpp v62, v42, v2 row_newbcast:0 row_mask:0xf bank_mask:0x3
  v_add_u32_dpp v63, v46, v3 row_newbcast:0 row_mask:0xf bank_mask:0x3
  v_add_u32_dpp v64, v50, v2 row_newbcast:0 row_mask:0xf bank_mask:0x3
  v_add_u32_dpp v65, v54, v3 row_newbcast:0 row_mask:0xf bank_mask:0x3
  v_add_u32_dpp v56, v16, v2 row_newbcast:7 row_mask:0xf bank_mask:0xc
  v_add_u32_dpp v57, v20, v3 row_newbcast:7 row_mask:0xf bank_mask:0xc
  v_add_u32_dpp v58, v24, v2 row_newbcast:7 row_mask:0xf bank_mask:0xc
  v_add_u32_dpp v59, v28, v3 row_newbcast:7 row_mask:0xf bank_mask:0xc
  v_add_u32_dpp v60, v32, v2 row_newbcast:7 row_mask:0xf bank_mask:0xc
  v_add_u32_dpp v61, v36, v3 row_newbcast:7 row_mask:0xf bank_mask:0xc
  v_add_u32_dpp v62, v40, v2 row_newbcast:7 row_mask:0xf bank_mask:0xc
  v_add_u32_dpp v63, v44, v3 row_newbcast:7 row_mask:0xf bank_mask:0xc
  v_add_u32_dpp v64, v48, v2 row_newbcast:7 row_mask:0xf bank_mask:0xc
  v_add_u32_dpp v65, v52, v3 row_newbcast:7 row_mask:0xf bank_mask:0xc
  s_add_u32 m0, s75, 139264
  s_nop 0
  buffer_load_dwordx4 v4, s[44:47], s74 offen lds
  s_add_u32 m0, s75, 140288
  s_nop 0
  buffer_load_dwordx4 v5, s[44:47], s74 offen lds
  s_add_u32 s74, s74, 106496
  s_add_u32 m0, s76, 81920
  s_nop 0
  buffer_load_dwordx4 v56, s[32:35], 0 offen lds
  s_add_u32 m0, s76, 82944
  s_nop 0
  buffer_load_dwordx4 v57, s[32:35], 0 offen lds
  s_add_u32 m0, s76, 83968
  s_nop 0
  buffer_load_dwordx4 v58, s[32:35], 0 offen lds
  s_add_u32 m0, s76, 84992
  s_nop 0
  buffer_load_dwordx4 v59, s[32:35], 0 offen lds
  s_add_u32 m0, s76, 86016
  s_nop 0
  buffer_load_dwordx4 v60, s[32:35], 0 offen lds
  s_setprio 0
  s_branch L_ld_in
L_dnn_loop1:
  s_barrier
L_ld_in:
  s_add_u32 m0, s75, 122880
  v_add_u32_dpp v56, v19, v2 row_newbcast:0 row_mask:0xf bank_mask:0x3
  buffer_load_dwordx4 v4, s[44:47], s74 offen lds
  s_add_u32 m0, s75, 123904
  v_add_u32_dpp v57, v23, v3 row_newbcast:0 row_mask:0xf bank_mask:0x3
  buffer_load_dwordx4 v5, s[44:47], s74 offen lds
  s_add_u32 s74, s74, 106496
  s_add_u32 m0, s76, 87040
  v_add_u32_dpp v58, v27, v2 row_newbcast:0 row_mask:0xf bank_mask:0x3
  buffer_load_dwordx4 v61, s[32:35], 0 offen lds
  s_add_u32 m0, s76, 88064
  v_add_u32_dpp v59, v31, v3 row_newbcast:0 row_mask:0xf bank_mask:0x3
  buffer_load_dwordx4 v62, s[32:35], 0 offen lds
  s_add_u32 m0, s76, 89088
  v_add_u32_dpp v60, v35, v2 row_newbcast:0 row_mask:0xf bank_mask:0x3
  buffer_load_dwordx4 v63, s[32:35], 0 offen lds
  s_add_u32 m0, s76, 90112
  v_add_u32_dpp v56, v17, v2 row_newbcast:7 row_mask:0xf bank_mask:0xc
  buffer_load_dwordx4 v64, s[32:35], 0 offen lds
  s_add_u32 m0, s76, 91136
  v_add_u32_dpp v57, v21, v3 row_newbcast:7 row_mask:0xf bank_mask:0xc
  buffer_load_dwordx4 v65, s[32:35], 0 offen lds
  v_add_u32_dpp v58, v25, v2 row_newbcast:7 row_mask:0xf bank_mask:0xc
  v_add_u32_dpp v59, v29, v3 row_newbcast:7 row_mask:0xf bank_mask:0xc
  v_add_u32_dpp v60, v33, v2 row_newbcast:7 row_mask:0xf bank_mask:0xc
  s_waitcnt vmcnt(12)
  s_barrier
  s_add_u32 m0, s75, 131072
  v_add_u32_dpp v61, v39, v3 row_newbcast:0 row_mask:0xf bank_mask:0x3
  buffer_load_dwordx4 v4, s[44:47], s74 offen lds
  s_add_u32 m0, s75, 132096
  v_add_u32_dpp v62, v43, v2 row_newbcast:0 row_mask:0xf bank_mask:0x3
  buffer_load_dwordx4 v5, s[44:47], s74 offen lds
  s_add_u32 s74, s74, 106496
  s_add_u32 m0, s76, 0
  v_add_u32_dpp v63, v47, v3 row_newbcast:0 row_mask:0xf bank_mask:0x3
  buffer_load_dwordx4 v56, s[32:35], 0 offen lds
  s_add_u32 m0, s76, 1024
  v_add_u32_dpp v64, v51, v2 row_newbcast:0 row_mask:0xf bank_mask:0x3
  buffer_load_dwordx4 v57, s[32:35], 0 offen lds
  s_add_u32 m0, s76, 2048
  v_add_u32_dpp v65, v55, v3 row_newbcast:0 row_mask:0xf bank_mask:0x3
  buffer_load_dwordx4 v58, s[32:35], 0 offen lds
  s_add_u32 m0, s76, 3072
  v_add_u32_dpp v61, v37, v3 row_newbcast:7 row_mask:0xf bank_mask:0xc
  buffer_load_dwordx4 v59, s[32:35], 0 offen lds
  s_add_u32 m0, s76, 4096
  v_add_u32_dpp v62, v41, v2 row_newbcast:7 row_mask:0xf bank_mask:0xc
  buffer_load_dwordx4 v60, s[32:35], 0 offen lds
  v_add_u32_dpp v63, v45, v3 row_newbcast:7 row_mask:0xf bank_mask:0xc
  v_add_u32_dpp v64, v49, v2 row_newbcast:7 row_mask:0xf bank_mask:0xc
  v_add_u32_dpp v65, v53, v3 row_newbcast:7 row_mask:0xf bank_mask:0xc
  s_waitcnt vmcnt(12)
  s_barrier
  s_add_u32 m0, s75, 139264
  v_add_u32_dpp v56, v16, v2 row_newbcast:1 row_mask:0xf bank_mask:0x3
  buffer_load_dwordx4 v4, s[44:47], s74 offen lds
  s_add_u32 m0, s75, 140288
  v_add_u32_dpp v57, v20, v3 row_newbcast:1 row_mask:0xf bank_mask:0x3
  buffer_load_dwordx4 v5, s[44:47], s74 offen lds
  s_add_u32 s74, s74, 106496
  s_add_u32 m0, s76, 5120
  v_add_u32_dpp v58, v24, v2 row_newbcast:1 row_mask:0xf bank_mask:0x3
  buffer_load_dwordx4 v61, s[32:35], 0 offen lds
  s_add_u32 m0, s76, 6144
  v_add_u32_dpp v59, v28, v3 row_newbcast:1 row_mask:0xf bank_mask:0x3
  buffer_load_dwordx4 v62, s[32:35], 0 offen lds
  s_add_u32 m0, s76, 7168
  v_add_u32_dpp v60, v32, v2 row_newbcast:1 row_mask:0xf bank_mask:0x3
  buffer_load_dwordx4 v63, s[32:35], 0 offen lds
  s_add_u32 m0, s76, 8192
  v_add_u32_dpp v56, v18, v2 row_newbcast:7 row_mask:0xf bank_mask:0xc
  buffer_load_dwordx4 v64, s[32:35], 0 offen lds
  s_add_u32 m0, s76, 9216
  v_add_u32_dpp v57, v22, v3 row_newbcast:7 row_mask:0xf bank_mask:0xc
  buffer_load_dwordx4 v65, s[32:35], 0 offen lds
  v_add_u32_dpp v58, v26, v2 row_newbcast:7 row_mask:0xf bank_mask:0xc
  v_add_u32_dpp v59, v30, v3 row_newbcast:7 row_mask:0xf bank_mask:0xc
  v_add_u32_dpp v60, v34, v2 row_newbcast:7 row_mask:0xf bank_mask:0xc
  s_waitcnt vmcnt(12)
  s_barrier
  s_add_u32 m0, s75, 122880
  v_add_u32_dpp v61, v36, v3 row_newbcast:1 row_mask:0xf bank_mask:0x3
  buffer_load_dwordx4 v4, s[44:47], s74 offen lds
  s_add_u32 m0, s75, 123904
  v_add_u32_dpp v62, v40, v2 row_newbcast:1 row_mask:0xf bank_mask:0x3
  buffer_load_dwordx4 v5, s[44:47], s74 offen lds
  s_add_u32 s74, s74, 106496
  s_add_u32 m0, s76, 40960
  v_add_u32_dpp v63, v44, v3 row_newbcast:1 row_mask:0xf bank_mask:0x3
  buffer_load_dwordx4 v56, s[32:35], 0 offen lds
  s_add_u32 m0, s76, 41984
  v_add_u32_dpp v64, v48, v2 row_newbcast:1 row_mask:0xf bank_mask:0x3
  buffer_load_dwordx4 v57, s[32:35], 0 offen lds
  s_add_u32 m0, s76, 43008
  v_add_u32_dpp v65, v52, v3 row_newbcast:1 row_mask:0xf bank_mask:0x3
  buffer_load_dwordx4 v58, s[32:35], 0 offen lds
  s_add_u32 m0, s76, 44032
  v_add_u32_dpp v61, v38, v3 row_newbcast:7 row_mask:0xf bank_mask:0xc
  buffer_load_dwordx4 v59, s[32:35], 0 offen lds
  s_add_u32 m0, s76, 45056
  v_add_u32_dpp v62, v42, v2 row_newbcast:7 row_mask:0xf bank_mask:0xc
  buffer_load_dwordx4 v60, s[32:35], 0 offen lds
  v_add_u32_dpp v63, v46, v3 row_newbcast:7 row_mask:0xf bank_mask:0xc
  v_add_u32_dpp v64, v50, v2 row_newbcast:7 row_mask:0xf bank_mask:0xc
  v_add_u32_dpp v65, v54, v3 row_newbcast:7 row_mask:0xf bank_mask:0xc
  s_waitcnt vmcnt(12)
  s_barrier
  s_add_u32 m0, s75, 131072
  v_add_u32_dpp v56, v17, v2 row_newbcast:1 row_mask:0xf bank_mask:0x3
  buffer_load_dwordx4 v4, s[44:47], s74 offen lds
  s_add_u32 m0, s75, 132096
  v_add_u32_dpp v57, v21, v3 row_newbcast:1 row_mask:0xf bank_mask:0x3
  buffer_load_dwordx4 v5, s[44:47], s74 offen lds
  s_add_u32 s74, s74, 106496
  s_add_u32 m0, s76, 46080
  v_add_u32_dpp v58, v25, v2 row_newbcast:1 row_mask:0xf bank_mask:0x3
  buffer_load_dwordx4 v61, s[32:35], 0 offen lds
  s_add_u32 m0, s76, 47104
  v_add_u32_dpp v59, v29, v3 row_newbcast:1 row_mask:0xf bank_mask:0x3
  buffer_load_dwordx4 v62, s[32:35], 0 offen lds
  s_add_u32 m0, s76, 48128
  v_add_u32_dpp v60, v33, v2 row_newbcast:1 row_mask:0xf bank_mask:0x3
  buffer_load_dwordx4 v63, s[32:35], 0 offen lds
  s_add_u32 m0, s76, 49152
  v_add_u32_dpp v56, v19, v2 row_newbcast:7 row_mask:0xf bank_mask:0xc
  buffer_load_dwordx4 v64, s[32:35], 0 offen lds
  s_add_u32 m0, s76, 50176
  v_add_u32_dpp v57, v23, v3 row_newbcast:7 row_mask:0xf bank_mask:0xc
  buffer_load_dwordx4 v65, s[32:35], 0 offen lds
  v_add_u32_dpp v58, v27, v2 row_newbcast:7 row_mask:0xf bank_mask:0xc
  v_add_u32_dpp v59, v31, v3 row_newbcast:7 row_mask:0xf bank_mask:0xc
  v_add_u32_dpp v60, v35, v2 row_newbcast:7 row_mask:0xf bank_mask:0xc
  s_waitcnt vmcnt(12)
  s_barrier
  s_add_u32 m0, s75, 139264
  v_add_u32_dpp v61, v37, v3 row_newbcast:1 row_mask:0xf bank_mask:0x3
  buffer_load_dwordx4 v4, s[44:47], s74 offen lds
  s_add_u32 m0, s75, 140288
  v_add_u32_dpp v62, v41, v2 row_newbcast:1 row_mask:0xf bank_mask:0x3
  buffer_load_dwordx4 v5, s[44:47], s74 offen lds
  s_add_u32 s74, s74, 106496
  s_add_u32 m0, s76, 81920
  v_add_u32_dpp v63, v45, v3 row_newbcast:1 row_mask:0xf bank_mask:0x3
  buffer_load_dwordx4 v56, s[32:35], 0 offen lds
  s_add_u32 m0, s76, 82944
  v_add_u32_dpp v64, v49, v2 row_newbcast:1 row_mask:0xf bank_mask:0x3
  buffer_load_dwordx4 v57, s[32:35], 0 offen lds
  s_add_u32 m0, s76, 83968
  v_add_u32_dpp v65, v53, v3 row_newbcast:1 row_mask:0xf bank_mask:0x3
  buffer_load_dwordx4 v58, s[32:35], 0 offen lds
  s_add_u32 m0, s76, 84992
  v_add_u32_dpp v61, v39, v3 row_newbcast:7 row_mask:0xf bank_mask:0xc
  buffer_load_dwordx4 v59, s[32:35], 0 offen lds
  s_add_u32 m0, s76, 86016
  v_add_u32_dpp v62, v43, v2 row_newbcast:7 row_mask:0xf bank_mask:0xc
  buffer_load_dwordx4 v60, s[32:35], 0 offen lds
  v_add_u32_dpp v63, v47, v3 row_newbcast:7 row_mask:0xf bank_mask:0xc
  v_add_u32_dpp v64, v51, v2 row_newbcast:7 row_mask:0xf bank_mask:0xc
  v_add_u32_dpp v65, v55, v3 row_newbcast:7 row_mask:0xf bank_mask:0xc
  s_waitcnt vmcnt(12)
  s_barrier
  s_add_u32 m0, s75, 122880
  v_add_u32_dpp v56, v18, v2 row_newbcast:1 row_mask:0xf bank_mask:0x3
  buffer_load_dwordx4 v4, s[44:47], s74 offen lds
  s_add_u32 m0, s75, 123904
  v_add_u32_dpp v57, v22, v3 row_newbcast:1 row_mask:0xf bank_mask:0x3
  buffer_load_dwordx4 v5, s[44:47], s74 offen lds
  s_add_u32 s74, s74, 106496
  s_add_u32 m0, s76, 87040
  v_add_u32_dpp v58, v26, v2 row_newbcast:1 row_mask:0xf bank_mask:0x3
  buffer_load_dwordx4 v61, s[32:35], 0 offen lds
  s_add_u32 m0, s76, 88064
  v_add_u32_dpp v59, v30, v3 row_newbcast:1 row_mask:0xf bank_mask:0x3
  buffer_load_dwordx4 v62, s[32:35], 0 offen lds
  s_add_u32 m0, s76, 89088
  v_add_u32_dpp v60, v34, v2 row_newbcast:1 row_mask:0xf bank_mask:0x3
  buffer_load_dwordx4 v63, s[32:35], 0 offen lds
  s_add_u32 m0, s76, 90112
  v_add_u32_dpp v56, v16, v2 row_newbcast:8 row_mask:0xf bank_mask:0xc
  buffer_load_dwordx4 v64, s[32:35], 0 offen lds
  s_add_u32 m0, s76, 91136
  v_add_u32_dpp v57, v20, v3 row_newbcast:8 row_mask:0xf bank_mask:0xc
  buffer_load_dwordx4 v65, s[32:35], 0 offen lds
  v_add_u32_dpp v58, v24, v2 row_newbcast:8 row_mask:0xf bank_mask:0xc
  v_add_u32_dpp v59, v28, v3 row_newbcast:8 row_mask:0xf bank_mask:0xc
  v_add_u32_dpp v60, v32, v2 row_newbcast:8 row_mask:0xf bank_mask:0xc
  s_waitcnt vmcnt(12)
  s_barrier
  s_add_u32 m0, s75, 131072
  v_add_u32_dpp v61, v38, v3 row_newbcast:1 row_mask:0xf bank_mask:0x3
  buffer_load_dwordx4 v4, s[44:47], s74 offen lds
  s_add_u32 m0, s75, 132096
  v_add_u32_dpp v62, v42, v2 row_newbcast:1 row_mask:0xf bank_mask:0x3
  buffer_load_dwordx4 v5, s[44:47], s74 offen lds
  s_add_u32 s74, s74, 106496
  s_add_u32 m0, s76, 0
  v_add_u32_dpp v63, v46, v3 row_newbcast:1 row_mask:0xf bank_mask:0x3
  buffer_load_dwordx4 v56, s[32:35], 0 offen lds
  s_add_u32 m0, s76, 1024
  v_add_u32_dpp v64, v50, v2 row_newbcast:1 row_mask:0xf bank_mask:0x3
  buffer_load_dwordx4 v57, s[32:35], 0 offen lds
  s_add_u32 m0, s76, 2048
  v_add_u32_dpp v65, v54, v3 row_newbcast:1 row_mask:0xf bank_mask:0x3
  buffer_load_dwordx4 v58, s[32:35], 0 offen lds
  s_add_u32 m0, s76, 3072
  v_add_u32_dpp v61, v36, v3 row_newbcast:8 row_mask:0xf bank_mask:0xc
  buffer_load_dwordx4 v59, s[32:35], 0 offen lds
  s_add_u32 m0, s76, 4096
  v_add_u32_dpp v62, v40, v2 row_newbcast:8 row_mask:0xf bank_mask:0xc
  buffer_load_dwordx4 v60, s[32:35], 0 offen lds
  v_add_u32_dpp v63, v44, v3 row_newbcast:8 row_mask:0xf bank_mask:0xc
  v_add_u32_dpp v64, v48, v2 row_newbcast:8 row_mask:0xf bank_mask:0xc
  v_add_u32_dpp v65, v52, v3 row_newbcast:8 row_mask:0xf bank_mask:0xc
  s_waitcnt vmcnt(12)
  s_barrier
  s_add_u32 m0, s75, 139264
  v_add_u32_dpp v56, v19, v2 row_newbcast:1 row_mask:0xf bank_mask:0x3
  buffer_load_dwordx4 v4, s[44:47], s74 offen lds
  s_add_u32 m0, s75, 140288
  v_add_u32_dpp v57, v23, v3 row_newbcast:1 row_mask:0xf bank_mask:0x3
  buffer_load_dwordx4 v5, s[44:47], s74 offen lds
  s_add_u32 s74, s74, 106496
  s_add_u32 m0, s76, 5120
  v_add_u32_dpp v58, v27, v2 row_newbcast:1 row_mask:0xf bank_mask:0x3
  buffer_load_dwordx4 v61, s[32:35], 0 offen lds
  s_add_u32 m0, s76, 6144
  v_add_u32_dpp v59, v31, v3 row_newbcast:1 row_mask:0xf bank_mask:0x3
  buffer_load_dwordx4 v62, s[32:35], 0 offen lds
  s_add_u32 m0, s76, 7168
  v_add_u32_dpp v60, v35, v2 row_newbcast:1 row_mask:0xf bank_mask:0x3
  buffer_load_dwordx4 v63, s[32:35], 0 offen lds
  s_add_u32 m0, s76, 8192
  v_add_u32_dpp v56, v17, v2 row_newbcast:8 row_mask:0xf bank_mask:0xc
  buffer_load_dwordx4 v64, s[32:35], 0 offen lds
  s_add_u32 m0, s76, 9216
  v_add_u32_dpp v57, v21, v3 row_newbcast:8 row_mask:0xf bank_mask:0xc
  buffer_load_dwordx4 v65, s[32:35], 0 offen lds
  v_add_u32_dpp v58, v25, v2 row_newbcast:8 row_mask:0xf bank_mask:0xc
  v_add_u32_dpp v59, v29, v3 row_newbcast:8 row_mask:0xf bank_mask:0xc
  v_add_u32_dpp v60, v33, v2 row_newbcast:8 row_mask:0xf bank_mask:0xc
  s_waitcnt vmcnt(12)
  s_barrier
  s_add_u32 m0, s75, 122880
  v_add_u32_dpp v61, v39, v3 row_newbcast:1 row_mask:0xf bank_mask:0x3
  buffer_load_dwordx4 v4, s[44:47], s74 offen lds
  s_add_u32 m0, s75, 123904
  v_add_u32_dpp v62, v43, v2 row_newbcast:1 row_mask:0xf bank_mask:0x3
  buffer_load_dwordx4 v5, s[44:47], s74 offen lds
  s_add_u32 s74, s74, 106496
  s_add_u32 m0, s76, 40960
  v_add_u32_dpp v63, v47, v3 row_newbcast:1 row_mask:0xf bank_mask:0x3
  buffer_load_dwordx4 v56, s[32:35], 0 offen lds
  s_add_u32 m0, s76, 41984
  v_add_u32_dpp v64, v51, v2 row_newbcast:1 row_mask:0xf bank_mask:0x3
  buffer_load_dwordx4 v57, s[32:35], 0 offen lds
  s_add_u32 m0, s76, 43008
  v_add_u32_dpp v65, v55, v3 row_newbcast:1 row_mask:0xf bank_mask:0x3
  buffer_load_dwordx4 v58, s[32:35], 0 offen lds
  s_add_u32 m0, s76, 44032
  v_add_u32_dpp v61, v37, v3 row_newbcast:8 row_mask:0xf bank_mask:0xc
  buffer_load_dwordx4 v59, s[32:35], 0 offen lds
  s_add_u32 m0, s76, 45056
  v_add_u32_dpp v62, v41, v2 row_newbcast:8 row_mask:0xf bank_mask:0xc
  buffer_load_dwordx4 v60, s[32:35], 0 offen lds
  v_add_u32_dpp v63, v45, v3 row_newbcast:8 row_mask:0xf bank_mask:0xc
  v_add_u32_dpp v64, v49, v2 row_newbcast:8 row_mask:0xf bank_mask:0xc
  v_add_u32_dpp v65, v53, v3 row_newbcast:8 row_mask:0xf bank_mask:0xc
  s_waitcnt vmcnt(12)
  s_barrier
  s_add_u32 m0, s75, 131072
  v_add_u32_dpp v56, v16, v2 row_newbcast:2 row_mask:0xf bank_mask:0x3
  buffer_load_dwordx4 v4, s[44:47], s74 offen lds
  s_add_u32 m0, s75, 132096
  v_add_u32_dpp v57, v20, v3 row_newbcast:2 row_mask:0xf bank_mask:0x3
  buffer_load_dwordx4 v5, s[44:47], s74 offen lds
  s_add_u32 s74, s74, 106496
  s_add_u32 m0, s76, 46080
  v_add_u32_dpp v58, v24, v2 row_newbcast:2 row_mask:0xf bank_mask:0x3
  buffer_load_dwordx4 v61, s[32:35], 0 offen lds
  s_add_u32 m0, s76, 47104
  v_add_u32_dpp v59, v28, v3 row_newbcast:2 row_mask:0xf bank_mask:0x3
  buffer_load_dwordx4 v62, s[32:35], 0 offen lds
  s_add_u32 m0, s76, 48128
  v_add_u32_dpp v60, v32, v2 row_newbcast:2 row_mask:0xf bank_mask:0x3
  buffer_load_dwordx4 v63, s[32:35], 0 offen lds
  s_add_u32 m0, s76, 49152
  v_add_u32_dpp v56, v18, v2 row_newbcast:8 row_mask:0xf bank_mask:0xc
  buffer_load_dwordx4 v64, s[32:35], 0 offen lds
  s_add_u32 m0, s76, 50176
  v_add_u32_dpp v57, v22, v3 row_newbcast:8 row_mask:0xf bank_mask:0xc
  buffer_load_dwordx4 v65, s[32:35], 0 offen lds
  v_add_u32_dpp v58, v26, v2 row_newbcast:8 row_mask:0xf bank_mask:0xc
  v_add_u32_dpp v59, v30, v3 row_newbcast:8 row_mask:0xf bank_mask:0xc
  v_add_u32_dpp v60, v34, v2 row_newbcast:8 row_mask:0xf bank_mask:0xc
  s_waitcnt vmcnt(12)
  s_barrier
  s_add_u32 m0, s75, 139264
  v_add_u32_dpp v61, v36, v3 row_newbcast:2 row_mask:0xf bank_mask:0x3
  buffer_load_dwordx4 v4, s[44:47], s74 offen lds
  s_add_u32 m0, s75, 140288
  v_add_u32_dpp v62, v40, v2 row_newbcast:2 row_mask:0xf bank_mask:0x3
  buffer_load_dwordx4 v5, s[44:47], s74 offen lds
  s_add_u32 s74, s74, 106496
  s_add_u32 m0, s76, 81920
  v_add_u32_dpp v63, v44, v3 row_newbcast:2 row_mask:0xf bank_mask:0x3
  buffer_load_dwordx4 v56, s[32:35], 0 offen lds
  s_add_u32 m0, s76, 82944
  v_add_u32_dpp v64, v48, v2 row_newbcast:2 row_mask:0xf bank_mask:0x3
  buffer_load_dwordx4 v57, s[32:35], 0 offen lds
  s_add_u32 m0, s76, 83968
  v_add_u32_dpp v65, v52, v3 row_newbcast:2 row_mask:0xf bank_mask:0x3
  buffer_load_dwordx4 v58, s[32:35], 0 offen lds
  s_add_u32 m0, s76, 84992
  v_add_u32_dpp v61, v38, v3 row_newbcast:8 row_mask:0xf bank_mask:0xc
  buffer_load_dwordx4 v59, s[32:35], 0 offen lds
  s_add_u32 m0, s76, 86016
  v_add_u32_dpp v62, v42, v2 row_newbcast:8 row_mask:0xf bank_mask:0xc
  buffer_load_dwordx4 v60, s[32:35], 0 offen lds
  v_add_u32_dpp v63, v46, v3 row_newbcast:8 row_mask:0xf bank_mask:0xc
  v_add_u32_dpp v64, v50, v2 row_newbcast:8 row_mask:0xf bank_mask:0xc
  v_add_u32_dpp v65, v54, v3 row_newbcast:8 row_mask:0xf bank_mask:0xc
  s_waitcnt vmcnt(12)
  s_barrier
  s_add_u32 m0, s75, 122880
  v_add_u32_dpp v56, v17, v2 row_newbcast:2 row_mask:0xf bank_mask:0x3
  buffer_load_dwordx4 v4, s[44:47], s74 offen lds
  s_add_u32 m0, s75, 123904
  v_add_u32_dpp v57, v21, v3 row_newbcast:2 row_mask:0xf bank_mask:0x3
  buffer_load_dwordx4 v5, s[44:47], s74 offen lds
  s_add_u32 s74, s74, 106496
  s_add_u32 m0, s76, 87040
  v_add_u32_dpp v58, v25, v2 row_newbcast:2 row_mask:0xf bank_mask:0x3
  buffer_load_dwordx4 v61, s[32:35], 0 offen lds
  s_add_u32 m0, s76, 88064
  v_add_u32_dpp v59, v29, v3 row_newbcast:2 row_mask:0xf bank_mask:0x3
  buffer_load_dwordx4 v62, s[32:35], 0 offen lds
  s_add_u32 m0, s76, 89088
  v_add_u32_dpp v60, v33, v2 row_newbcast:2 row_mask:0xf bank_mask:0x3
  buffer_load_dwordx4 v63, s[32:35], 0 offen lds
  s_add_u32 m0, s76, 90112
  v_add_u32_dpp v56, v19, v2 row_newbcast:8 row_mask:0xf bank_mask:0xc
  buffer_load_dwordx4 v64, s[32:35], 0 offen lds
  s_add_u32 m0, s76, 91136
  v_add_u32_dpp v57, v23, v3 row_newbcast:8 row_mask:0xf bank_mask:0xc
  buffer_load_dwordx4 v65, s[32:35], 0 offen lds
  v_add_u32_dpp v58, v27, v2 row_newbcast:8 row_mask:0xf bank_mask:0xc
  v_add_u32_dpp v59, v31, v3 row_newbcast:8 row_mask:0xf bank_mask:0xc
  v_add_u32_dpp v60, v35, v2 row_newbcast:8 row_mask:0xf bank_mask:0xc
  s_waitcnt vmcnt(12)
  s_barrier
  s_add_u32 m0, s75, 131072
  v_add_u32_dpp v61, v37, v3 row_newbcast:2 row_mask:0xf bank_mask:0x3
  buffer_load_dwordx4 v4, s[44:47], s74 offen lds
  s_add_u32 m0, s75, 132096
  v_add_u32_dpp v62, v41, v2 row_newbcast:2 row_mask:0xf bank_mask:0x3
  buffer_load_dwordx4 v5, s[44:47], s74 offen lds
  s_add_u32 s74, s74, 106496
  s_add_u32 m0, s76, 0
  v_add_u32_dpp v63, v45, v3 row_newbcast:2 row_mask:0xf bank_mask:0x3
  buffer_load_dwordx4 v56, s[32:35], 0 offen lds
  s_add_u32 m0, s76, 1024
  v_add_u32_dpp v64, v49, v2 row_newbcast:2 row_mask:0xf bank_mask:0x3
  buffer_load_dwordx4 v57, s[32:35], 0 offen lds
  s_add_u32 m0, s76, 2048
  v_add_u32_dpp v65, v53, v3 row_newbcast:2 row_mask:0xf bank_mask:0x3
  buffer_load_dwordx4 v58, s[32:35], 0 offen lds
  s_add_u32 m0, s76, 3072
  v_add_u32_dpp v61, v39, v3 row_newbcast:8 row_mask:0xf bank_mask:0xc
  buffer_load_dwordx4 v59, s[32:35], 0 offen lds
  s_add_u32 m0, s76, 4096
  v_add_u32_dpp v62, v43, v2 row_newbcast:8 row_mask:0xf bank_mask:0xc
  buffer_load_dwordx4 v60, s[32:35], 0 offen lds
  v_add_u32_dpp v63, v47, v3 row_newbcast:8 row_mask:0xf bank_mask:0xc
  v_add_u32_dpp v64, v51, v2 row_newbcast:8 row_mask:0xf bank_mask:0xc
  v_add_u32_dpp v65, v55, v3 row_newbcast:8 row_mask:0xf bank_mask:0xc
  s_waitcnt vmcnt(12)
  s_barrier
  s_add_u32 m0, s75, 139264
  v_add_u32_dpp v56, v18, v2 row_newbcast:2 row_mask:0xf bank_mask:0x3
  buffer_load_dwordx4 v4, s[44:47], s74 offen lds
  s_add_u32 m0, s75, 140288
  v_add_u32_dpp v57, v22, v3 row_newbcast:2 row_mask:0xf bank_mask:0x3
  buffer_load_dwordx4 v5, s[44:47], s74 offen lds
  s_add_u32 s74, s74, 106496
  s_add_u32 m0, s76, 5120
  v_add_u32_dpp v58, v26, v2 row_newbcast:2 row_mask:0xf bank_mask:0x3
  buffer_load_dwordx4 v61, s[32:35], 0 offen lds
  s_add_u32 m0, s76, 6144
  v_add_u32_dpp v59, v30, v3 row_newbcast:2 row_mask:0xf bank_mask:0x3
  buffer_load_dwordx4 v62, s[32:35], 0 offen lds
  s_add_u32 m0, s76, 7168
  v_add_u32_dpp v60, v34, v2 row_newbcast:2 row_mask:0xf bank_mask:0x3
  buffer_load_dwordx4 v63, s[32:35], 0 offen lds
  s_add_u32 m0, s76, 8192
  v_add_u32_dpp v56, v16, v2 row_newbcast:9 row_mask:0xf bank_mask:0xc
  buffer_load_dwordx4 v64, s[32:35], 0 offen lds
  s_add_u32 m0, s76, 9216
  v_add_u32_dpp v57, v20, v3 row_newbcast:9 row_mask:0xf bank_mask:0xc
  buffer_load_dwordx4 v65, s[32:35], 0 offen lds
  v_add_u32_dpp v58, v24, v2 row_newbcast:9 row_mask:0xf bank_mask:0xc
  v_add_u32_dpp v59, v28, v3 row_newbcast:9 row_mask:0xf bank_mask:0xc
  v_add_u32_dpp v60, v32, v2 row_newbcast:9 row_mask:0xf bank_mask:0xc
  s_waitcnt vmcnt(12)
  s_cmp_lg_u32 s72, 1
  s_cbranch_scc1 L_nolpf
  s_mov_b64 exec, 1048575
  global_load_dword v10, v[8:9], off
  s_mov_b64 exec, -1
L_nolpf:
  s_barrier
  s_add_u32 m0, s75, 122880
  v_add_u32_dpp v61, v38, v3 row_newbcast:2 row_mask:0xf bank_mask:0x3
  buffer_load_dwordx4 v4, s[44:47], s74 offen lds
  s_add_u32 m0, s75, 123904
  v_add_u32_dpp v62, v42, v2 row_newbcast:2 row_mask:0xf bank_mask:0x3
  buffer_load_dwordx4 v5, s[44:47], s74 offen lds
  s_add_u32 s74, s74, 106496
  s_add_u32 m0, s76, 40960
  v_add_u32_dpp v63, v46, v3 row_newbcast:2 row_mask:0xf bank_mask:0x3
  buffer_load_dwordx4 v56, s[32:35], 0 offen lds
  s_add_u32 m0, s76, 41984
  v_add_u32_dpp v64, v50, v2 row_newbcast:2 row_mask:0xf bank_mask:0x3
  buffer_load_dwordx4 v57, s[32:35], 0 offen lds
  s_add_u32 m0, s76, 43008
  v_add_u32_dpp v65, v54, v3 row_newbcast:2 row_mask:0xf bank_mask:0x3
  buffer_load_dwordx4 v58, s[32:35], 0 offen lds
  s_add_u32 m0, s76, 44032
  v_add_u32_dpp v61, v36, v3 row_newbcast:9 row_mask:0xf bank_mask:0xc
  buffer_load_dwordx4 v59, s[32:35], 0 offen lds
  s_add_u32 m0, s76, 45056
  v_add_u32_dpp v62, v40, v2 row_newbcast:9 row_mask:0xf bank_mask:0xc
  buffer_load_dwordx4 v60, s[32:35], 0 offen lds
  v_add_u32_dpp v63, v44, v3 row_newbcast:9 row_mask:0xf bank_mask:0xc
  v_add_u32_dpp v64, v48, v2 row_newbcast:9 row_mask:0xf bank_mask:0xc
  v_add_u32_dpp v65, v52, v3 row_newbcast:9 row_mask:0xf bank_mask:0xc
  s_waitcnt vmcnt(12)
  s_barrier
  s_add_u32 m0, s75, 131072
  v_add_u32_dpp v56, v19, v2 row_newbcast:2 row_mask:0xf bank_mask:0x3
  buffer_load_dwordx4 v4, s[44:47], s74 offen lds
  s_add_u32 m0, s75, 132096
  v_add_u32_dpp v57, v23, v3 row_newbcast:2 row_mask:0xf bank_mask:0x3
  buffer_load_dwordx4 v5, s[44:47], s74 offen lds
  s_add_u32 s74, s74, 106496
  s_add_u32 m0, s76, 46080
  v_add_u32_dpp v58, v27, v2 row_newbcast:2 row_mask:0xf bank_mask:0x3
  buffer_load_dwordx4 v61, s[32:35], 0 offen lds
  s_add_u32 m0, s76, 47104
  v_add_u32_dpp v59, v31, v3 row_newbcast:2 row_mask:0xf bank_mask:0x3
  buffer_load_dwordx4 v62, s[32:35], 0 offen lds
  s_add_u32 m0, s76, 48128
  v_add_u32_dpp v60, v35, v2 row_newbcast:2 row_mask:0xf bank_mask:0x3
  buffer_load_dwordx4 v63, s[32:35], 0 offen lds
  s_add_u32 m0, s76, 49152
  v_add_u32_dpp v56, v17, v2 row_newbcast:9 row_mask:0xf bank_mask:0xc
  buffer_load_dwordx4 v64, s[32:35], 0 offen lds
  s_add_u32 m0, s76, 50176
  v_add_u32_dpp v57, v21, v3 row_newbcast:9 row_mask:0xf bank_mask:0xc
  buffer_load_dwordx4 v65, s[32:35], 0 offen lds
  v_add_u32_dpp v58, v25, v2 row_newbcast:9 row_mask:0xf bank_mask:0xc
  v_add_u32_dpp v59, v29, v3 row_newbcast:9 row_mask:0xf bank_mask:0xc
  v_add_u32_dpp v60, v33, v2 row_newbcast:9 row_mask:0xf bank_mask:0xc
  s_waitcnt vmcnt(12)
  s_barrier
  s_add_u32 m0, s75, 139264
  v_add_u32_dpp v61, v39, v3 row_newbcast:2 row_mask:0xf bank_mask:0x3
  buffer_load_dwordx4 v4, s[44:47], s74 offen lds
  s_add_u32 m0, s75, 140288
  v_add_u32_dpp v62, v43, v2 row_newbcast:2 row_mask:0xf bank_mask:0x3
  buffer_load_dwordx4 v5, s[44:47], s74 offen lds
  s_add_u32 s74, s74, 106496
  s_add_u32 m0, s76, 81920
  v_add_u32_dpp v63, v47, v3 row_newbcast:2 row_mask:0xf bank_mask:0x3
  buffer_load_dwordx4 v56, s[32:35], 0 offen lds
  s_add_u32 m0, s76, 82944
  v_add_u32_dpp v64, v51, v2 row_newbcast:2 row_mask:0xf bank_mask:0x3
  buffer_load_dwordx4 v57, s[32:35], 0 offen lds
  s_add_u32 m0, s76, 83968
  v_add_u32_dpp v65, v55, v3 row_newbcast:2 row_mask:0xf bank_mask:0x3
  buffer_load_dwordx4 v58, s[32:35], 0 offen lds
  s_add_u32 m0, s76, 84992
  v_add_u32_dpp v61, v37, v3 row_newbcast:9 row_mask:0xf bank_mask:0xc
  buffer_load_dwordx4 v59, s[32:35], 0 offen lds
  s_add_u32 m0, s76, 86016
  v_add_u32_dpp v62, v41, v2 row_newbcast:9 row_mask:0xf bank_mask:0xc
  buffer_load_dwordx4 v60, s[32:35], 0 offen lds
  v_add_u32_dpp v63, v45, v3 row_newbcast:9 row_mask:0xf bank_mask:0xc
  v_add_u32_dpp v64, v49, v2 row_newbcast:9 row_mask:0xf bank_mask:0xc
  v_add_u32_dpp v65, v53, v3 row_newbcast:9 row_mask:0xf bank_mask:0xc
  s_waitcnt vmcnt(12)
  s_barrier
  s_add_u32 m0, s75, 122880
  v_add_u32_dpp v56, v16, v2 row_newbcast:3 row_mask:0xf bank_mask:0x3
  buffer_load_dwordx4 v4, s[44:47], s74 offen lds
  s_add_u32 m0, s75, 123904
  v_add_u32_dpp v57, v20, v3 row_newbcast:3 row_mask:0xf bank_mask:0x3
  buffer_load_dwordx4 v5, s[44:47], s74 offen lds
  s_add_u32 s74, s74, 106496
  s_add_u32 m0, s76, 87040
  v_add_u32_dpp v58, v24, v2 row_newbcast:3 row_mask:0xf bank_mask:0x3
  buffer_load_dwordx4 v61, s[32:35], 0 offen lds
  s_add_u32 m0, s76, 88064
  v_add_u32_dpp v59, v28, v3 row_newbcast:3 row_mask:0xf bank_mask:0x3
  buffer_load_dwordx4 v62, s[32:35], 0 offen lds
  s_add_u32 m0, s76, 89088
  v_add_u32_dpp v60, v32, v2 row_newbcast:3 row_mask:0xf bank_mask:0x3
  buffer_load_dwordx4 v63, s[32:35], 0 offen lds
  s_add_u32 m0, s76, 90112
  v_add_u32_dpp v56, v18, v2 row_newbcast:9 row_mask:0xf bank_mask:0xc
  buffer_load_dwordx4 v64, s[32:35], 0 offen lds
  s_add_u32 m0, s76, 91136
  v_add_u32_dpp v57, v22, v3 row_newbcast:9 row_mask:0xf bank_mask:0xc
  buffer_load_dwordx4 v65, s[32:35], 0 offen lds
  v_add_u32_dpp v58, v26, v2 row_newbcast:9 row_mask:0xf bank_mask:0xc
  v_add_u32_dpp v59, v30, v3 row_newbcast:9 row_mask:0xf bank_mask:0xc
  v_add_u32_dpp v60, v34, v2 row_newbcast:9 row_mask:0xf bank_mask:0xc
  s_waitcnt vmcnt(12)
  s_barrier
  s_add_u32 m0, s75, 131072
  v_add_u32_dpp v61, v36, v3 row_newbcast:3 row_mask:0xf bank_mask:0x3
  buffer_load_dwordx4 v4, s[44:47], s74 offen lds
  s_add_u32 m0, s75, 132096
  v_add_u32_dpp v62, v40, v2 row_newbcast:3 row_mask:0xf bank_mask:0x3
  buffer_load_dwordx4 v5, s[44:47], s74 offen lds
  s_add_u32 s74, s74, 106496
  s_add_u32 m0, s76, 0
  v_add_u32_dpp v63, v44, v3 row_newbcast:3 row_mask:0xf bank_mask:0x3
  buffer_load_dwordx4 v56, s[32:35], 0 offen lds
  s_add_u32 m0, s76, 1024
  v_add_u32_dpp v64, v48, v2 row_newbcast:3 row_mask:0xf bank_mask:0x3
  buffer_load_dwordx4 v57, s[32:35], 0 offen lds
  s_add_u32 m0, s76, 2048
  v_add_u32_dpp v65, v52, v3 row_newbcast:3 row_mask:0xf bank_mask:0x3
  buffer_load_dwordx4 v58, s[32:35], 0 offen lds
  s_add_u32 m0, s76, 3072
  v_add_u32_dpp v61, v38, v3 row_newbcast:9 row_mask:0xf bank_mask:0xc
  buffer_load_dwordx4 v59, s[32:35], 0 offen lds
  s_add_u32 m0, s76, 4096
  v_add_u32_dpp v62, v42, v2 row_newbcast:9 row_mask:0xf bank_mask:0xc
  buffer_load_dwordx4 v60, s[32:35], 0 offen lds
  v_add_u32_dpp v63, v46, v3 row_newbcast:9 row_mask:0xf bank_mask:0xc
  v_add_u32_dpp v64, v50, v2 row_newbcast:9 row_mask:0xf bank_mask:0xc
  v_add_u32_dpp v65, v54, v3 row_newbcast:9 row_mask:0xf bank_mask:0xc
  s_waitcnt vmcnt(12)
  s_barrier
  s_add_u32 m0, s75, 139264
  v_add_u32_dpp v56, v17, v2 row_newbcast:3 row_mask:0xf bank_mask:0x3
  buffer_load_dwordx4 v4, s[44:47], s74 offen lds
  s_add_u32 m0, s75, 140288
  v_add_u32_dpp v57, v21, v3 row_newbcast:3 row_mask:0xf bank_mask:0x3
  buffer_load_dwordx4 v5, s[44:47], s74 offen lds
  s_add_u32 s74, s74, 106496
  s_add_u32 m0, s76, 5120
  v_add_u32_dpp v58, v25, v2 row_newbcast:3 row_mask:0xf bank_mask:0x3
  buffer_load_dwordx4 v61, s[32:35], 0 offen lds
  s_add_u32 m0, s76, 6144
  v_add_u32_dpp v59, v29, v3 row_newbcast:3 row_mask:0xf bank_mask:0x3
  buffer_load_dwordx4 v62, s[32:35], 0 offen lds
  s_add_u32 m0, s76, 7168
  v_add_u32_dpp v60, v33, v2 row_newbcast:3 row_mask:0xf bank_mask:0x3
  buffer_load_dwordx4 v63, s[32:35], 0 offen lds
  s_add_u32 m0, s76, 8192
  v_add_u32_dpp v56, v19, v2 row_newbcast:9 row_mask:0xf bank_mask:0xc
  buffer_load_dwordx4 v64, s[32:35], 0 offen lds
  s_add_u32 m0, s76, 9216
  v_add_u32_dpp v57, v23, v3 row_newbcast:9 row_mask:0xf bank_mask:0xc
  buffer_load_dwordx4 v65, s[32:35], 0 offen lds
  v_add_u32_dpp v58, v27, v2 row_newbcast:9 row_mask:0xf bank_mask:0xc
  v_add_u32_dpp v59, v31, v3 row_newbcast:9 row_mask:0xf bank_mask:0xc
  v_add_u32_dpp v60, v35, v2 row_newbcast:9 row_mask:0xf bank_mask:0xc
  s_waitcnt vmcnt(12)
  s_barrier
  s_add_u32 m0, s75, 122880
  v_add_u32_dpp v61, v37, v3 row_newbcast:3 row_mask:0xf bank_mask:0x3
  buffer_load_dwordx4 v4, s[44:47], s74 offen lds
  s_add_u32 m0, s75, 123904
  v_add_u32_dpp v62, v41, v2 row_newbcast:3 row_mask:0xf bank_mask:0x3
  buffer_load_dwordx4 v5, s[44:47], s74 offen lds
  s_add_u32 s74, s74, 106496
  s_add_u32 m0, s76, 40960
  v_add_u32_dpp v63, v45, v3 row_newbcast:3 row_mask:0xf bank_mask:0x3
  buffer_load_dwordx4 v56, s[32:35], 0 offen lds
  s_add_u32 m0, s76, 41984
  v_add_u32_dpp v64, v49, v2 row_newbcast:3 row_mask:0xf bank_mask:0x3
  buffer_load_dwordx4 v57, s[32:35], 0 offen lds
  s_add_u32 m0, s76, 43008
  v_add_u32_dpp v65, v53, v3 row_newbcast:3 row_mask:0xf bank_mask:0x3
  buffer_load_dwordx4 v58, s[32:35], 0 offen lds
  s_add_u32 m0, s76, 44032
  v_add_u32_dpp v61, v39, v3 row_newbcast:9 row_mask:0xf bank_mask:0xc
  buffer_load_dwordx4 v59, s[32:35], 0 offen lds
  s_add_u32 m0, s76, 45056
  v_add_u32_dpp v62, v43, v2 row_newbcast:9 row_mask:0xf bank_mask:0xc
  buffer_load_dwordx4 v60, s[32:35], 0 offen lds
  v_add_u32_dpp v63, v47, v3 row_newbcast:9 row_mask:0xf bank_mask:0xc
  v_add_u32_dpp v64, v51, v2 row_newbcast:9 row_mask:0xf bank_mask:0xc
  v_add_u32_dpp v65, v55, v3 row_newbcast:9 row_mask:0xf bank_mask:0xc
  s_waitcnt vmcnt(12)
  s_barrier
  s_add_u32 m0, s75, 131072
  v_add_u32_dpp v56, v18, v2 row_newbcast:3 row_mask:0xf bank_mask:0x3
  buffer_load_dwordx4 v4, s[44:47], s74 offen lds
  s_add_u32 m0, s75, 132096
  v_add_u32_dpp v57, v22, v3 row_newbcast:3 row_mask:0xf bank_mask:0x3
  buffer_load_dwordx4 v5, s[44:47], s74 offen lds
  s_add_u32 s74, s74, 106496
  s_add_u32 m0, s76, 46080
  v_add_u32_dpp v58, v26, v2 row_newbcast:3 row_mask:0xf bank_mask:0x3
  buffer_load_dwordx4 v61, s[32:35], 0 offen lds
  s_add_u32 m0, s76, 47104
  v_add_u32_dpp v59, v30, v3 row_newbcast:3 row_mask:0xf bank_mask:0x3
  buffer_load_dwordx4 v62, s[32:35], 0 offen lds
  s_add_u32 m0, s76, 48128
  v_add_u32_dpp v60, v34, v2 row_newbcast:3 row_mask:0xf bank_mask:0x3
  buffer_load_dwordx4 v63, s[32:35], 0 offen lds
  s_add_u32 m0, s76, 49152
  v_add_u32_dpp v56, v16, v2 row_newbcast:10 row_mask:0xf bank_mask:0xc
  buffer_load_dwordx4 v64, s[32:35], 0 offen lds
  s_add_u32 m0, s76, 50176
  v_add_u32_dpp v57, v20, v3 row_newbcast:10 row_mask:0xf bank_mask:0xc
  buffer_load_dwordx4 v65, s[32:35], 0 offen lds
  v_add_u32_dpp v58, v24, v2 row_newbcast:10 row_mask:0xf bank_mask:0xc
  v_add_u32_dpp v59, v28, v3 row_newbcast:10 row_mask:0xf bank_mask:0xc
  v_add_u32_dpp v60, v32, v2 row_newbcast:10 row_mask:0xf bank_mask:0xc
  v_mov_b32_dpp v16, v16 row_shl:3 row_mask:0xf bank_mask:0xf
  v_mov_b32_dpp v17, v17 row_shl:3 row_mask:0xf bank_mask:0xf
  v_mov_b32_dpp v18, v18 row_shl:3 row_mask:0xf bank_mask:0xf
  v_mov_b32_dpp v19, v19 row_shl:3 row_mask:0xf bank_mask:0xf
  v_mov_b32_dpp v20, v20 row_shl:3 row_mask:0xf bank_mask:0xf
  v_mov_b32_dpp v21, v21 row_shl:3 row_mask:0xf bank_mask:0xf
  v_mov_b32_dpp v22, v22 row_shl:3 row_mask:0xf bank_mask:0xf
  v_mov_b32_dpp v23, v23 row_shl:3 row_mask:0xf bank_mask:0xf
  v_mov_b32_dpp v24, v24 row_shl:3 row_mask:0xf bank_mask:0xf
  v_mov_b32_dpp v25, v25 row_shl:3 row_mask:0xf bank_mask:0xf
  v_mov_b32_dpp v26, v26 row_shl:3 row_mask:0xf bank_mask:0xf
  v_mov_b32_dpp v27, v27 row_shl:3 row_mask:0xf bank_mask:0xf
  v_mov_b32_dpp v28, v28 row_shl:3 row_mask:0xf bank_mask:0xf
  v_mov_b32_dpp v29, v29 row_shl:3 row_mask:0xf bank_mask:0xf
  v_mov_b32_dpp v30, v30 row_shl:3 row_mask:0xf bank_mask:0xf
  v_mov_b32_dpp v31, v31 row_shl:3 row_mask:0xf bank_mask:0xf
  v_mov_b32_dpp v32, v32 row_shl:3 row_mask:0xf bank_mask:0xf
  v_mov_b32_dpp v33, v33 row_shl:3 row_mask:0xf bank_mask:0xf
  v_mov_b32_dpp v34, v34 row_shl:3 row_mask:0xf bank_mask:0xf
  v_mov_b32_dpp v35, v35 row_shl:3 row_mask:0xf bank_mask:0xf
  s_waitcnt vmcnt(12)
  s_barrier
  s_add_u32 m0, s75, 139264
  v_add_u32_dpp v61, v38, v3 row_newbcast:3 row_mask:0xf bank_mask:0x3
  buffer_load_dwordx4 v4, s[44:47], s74 offen lds
  s_add_u32 m0, s75, 140288
  v_add_u32_dpp v62, v42, v2 row_newbcast:3 row_mask:0xf bank_mask:0x3
  buffer_load_dwordx4 v5, s[44:47], s74 offen lds
  s_add_u32 s74, s74, 106496
  s_add_u32 m0, s76, 81920
  v_add_u32_dpp v63, v46, v3 row_newbcast:3 row_mask:0xf bank_mask:0x3
  buffer_load_dwordx4 v56, s[32:35], 0 offen lds
  s_add_u32 m0, s76, 82944
  v_add_u32_dpp v64, v50, v2 row_newbcast:3 row_mask:0xf bank_mask:0x3
  buffer_load_dwordx4 v57, s[32:35], 0 offen lds
  s_add_u32 m0, s76, 83968
  v_add_u32_dpp v65, v54, v3 row_newbcast:3 row_mask:0xf bank_mask:0x3
  buffer_load_dwordx4 v58, s[32:35], 0 offen lds
  s_add_u32 m0, s76, 84992
  v_add_u32_dpp v61, v36, v3 row_newbcast:10 row_mask:0xf bank_mask:0xc
  buffer_load_dwordx4 v59, s[32:35], 0 offen lds
  s_add_u32 m0, s76, 86016
  v_add_u32_dpp v62, v40, v2 row_newbcast:10 row_mask:0xf bank_mask:0xc
  buffer_load_dwordx4 v60, s[32:35], 0 offen lds
  v_add_u32_dpp v63, v44, v3 row_newbcast:10 row_mask:0xf bank_mask:0xc
  v_add_u32_dpp v64, v48, v2 row_newbcast:10 row_mask:0xf bank_mask:0xc
  v_add_u32_dpp v65, v52, v3 row_newbcast:10 row_mask:0xf bank_mask:0xc
  v_mov_b32_dpp v36, v36 row_shl:3 row_mask:0xf bank_mask:0xf
  v_mov_b32_dpp v37, v37 row_shl:3 row_mask:0xf bank_mask:0xf
  v_mov_b32_dpp v38, v38 row_shl:3 row_mask:0xf bank_mask:0xf
  v_mov_b32_dpp v39, v39 row_shl:3 row_mask:0xf bank_mask:0xf
  v_mov_b32_dpp v40, v40 row_shl:3 row_mask:0xf bank_mask:0xf
  v_mov_b32_dpp v41, v41 row_shl:3 row_mask:0xf bank_mask:0xf
  v_mov_b32_dpp v42, v42 row_shl:3 row_mask:0xf bank_mask:0xf
  v_mov_b32_dpp v43, v43 row_shl:3 row_mask:0xf bank_mask:0xf
  v_mov_b32_dpp v44, v44 row_shl:3 row_mask:0xf bank_mask:0xf
  v_mov_b32_dpp v45, v45 row_shl:3 row_mask:0xf bank_mask:0xf
  v_mov_b32_dpp v46, v46 row_shl:3 row_mask:0xf bank_mask:0xf
  v_mov_b32_dpp v47, v47 row_shl:3 row_mask:0xf bank_mask:0xf
  v_mov_b32_dpp v48, v48 row_shl:3 row_mask:0xf bank_mask:0xf
  v_mov_b32_dpp v49, v49 row_shl:3 row_mask:0xf bank_mask:0xf
  v_mov_b32_dpp v50, v50 row_shl:3 row_mask:0xf bank_mask:0xf
  v_mov_b32_dpp v51, v51 row_shl:3 row_mask:0xf bank_mask:0xf
  v_mov_b32_dpp v52, v52 row_shl:3 row_mask:0xf bank_mask:0xf
  v_mov_b32_dpp v53, v53 row_shl:3 row_mask:0xf bank_mask:0xf
  v_mov_b32_dpp v54, v54 row_shl:3 row_mask:0xf bank_mask:0xf
  v_mov_b32_dpp v55, v55 row_shl:3 row_mask:0xf bank_mask:0xf
  s_add_u32 s72, s72, 1
  s_cmp_lt_u32 s72, 2
  s_waitcnt vmcnt(12)
  s_cbranch_scc1 L_dnn_loop1
  s_branch L_ld_tail
L_cin:
  s_and_b32 s79, s3, 3
  s_lshr_b32 s84, s3, 2
  s_mul_i32 s26, s68, 11
  s_add_u32 s26, s26, s69
  s_sub_u32 s26, s26, 22
  s_cmp_eq_u32 s26, 86
  s_cbranch_scc1 L_end
  s_sub_u32 s68, s71, 22
  s_lshl_b32 s68, s68, 3
  s_add_u32 s68, s68, s3
  s_mul_i32 s68, s68, 1408
  v_min_u32 v109, 10, v0
  v_lshlrev_b32 v109, 7, v109
  v_lshlrev_b32 v47, 4, v0
  s_lshl_b32 s95, s79, 10
  s_cmp_eq_u32 s79, 2
  s_cselect_b64 s[82:83], 0x1fffff, -1
  s_cmp_eq_u32 s79, 3
  s_cselect_b32 s96, 0, 32768
  s_add_u32 s96, s96, s95
  s_lshl_b32 s85, s3, 2
  s_add_u32 s85, s85, 129728
  s_mul_i32 s94, s26, 48
  s_add_u32 s94, s94, s3
  s_mul_i32 s94, s94, 104
  s_cmp_eq_u32 s26, 85
  s_cselect_b32 s72, 2, 6
  v_lshrrev_b32 v30, 3, v0
  v_lshlrev_b32 v6, 4, v30
  s_lshl_b32 s100, s26, 3
  s_add_u32 s100, s100, s3
  s_add_u32 s101, s100, 1664
  s_lshl_b32 s101, s101, 7
  s_mov_b32 s71, 88064
  v_min_u32 v11, 12, v0
  v_mul_lo_u32 v11, s71, v11
  v_mov_b32 v46, 129664
  v_lshlrev_b32 v45, 20, v0
  v_add_u32 v45, 129664, v45
  v_mov_b32 v48, 0
  ds_write_b32 v46, v48
  ds_write2_b32 v46, v48, v48 offset0:4 offset1:5
  ds_write2_b32 v46, v48, v48 offset0:6 offset1:7
  v_lshrrev_b32 v28, 5, v0
  v_and_b32 v29, 31, v0
  s_waitcnt lgkmcnt(0)
  v_mov_b32 v48, 1
  s_mov_b32 s32, s6
  s_and_b32 s33, s7, 0xffff
  s_mov_b32 s34, 12800000
  s_mov_b32 s35, 0x20000
  v_mov_b32 v108, s80
  buffer_load_dword v110, v108, s[32:35], 0 offen
  s_mov_b32 s36, s8
  s_and_b32 s37, s9, 0xffff
  s_mov_b32 s38, 105456
  s_mov_b32 s39, 0x20000
  buffer_load_dword v111, v109, s[36:39], s68 offen
  s_mov_b32 s44, s12
  s_and_b32 s45, s13, 0xffff
  s_mov_b32 s46, 5537792
  s_mov_b32 s47, 0x20000
  s_barrier
  s_mov_b64 exec, 8191
  buffer_load_dword v15, v11, s[44:47], s101 offen
  s_mov_b64 exec, -1
  s_add_u32 s101, s101, 1144832
  s_mov_b32 s28, s4
  s_and_b32 s29, s5, 0xffff
  s_mov_b32 s30, 425984
  s_mov_b32 s31, 0x20000
  s_cmp_lg_u32 s84, 0
  s_cbranch_scc1 L_g1a
  s_mov_b32 s40, s10
  s_and_b32 s41, s11, 0xffff
  s_mov_b32 s42, 156
  s_mov_b32 s43, 0x20000
  s_mov_b32 m0, 129472
  s_mov_b64 exec, 0x7ff
  buffer_load_dwordx4 v47, s[40:43], 0 offen lds
  s_mov_b64 exec, -1
  s_add_u32 m0, s95, 41984
  s_add_u32 s81, s95, 70304
  buffer_load_dwordx4 v47, s[36:39], s81 offen lds
  s_branch L_addrc
L_g1a:
  s_setprio 0
  s_lshl_b32 s68, s79, 6
  v_add_u32 v244, s68, v0
  v_mov_b32 v232, 0
  v_mov_b32 v233, 0
  v_lshlrev_b32 v30, 3, v0
  v_add_u32 v31, 1664, v30
  v_add_u32 v30, 129728, v30
  ds_write_b64 v30, v[232:233]
  s_mov_b32 exec_hi, 0xffff
  ds_write_b64 v31, v[232:233]
  s_mov_b32 exec_hi, -1
  v_mov_b32 v30, v244
  s_mov_b32 s69, 2521
  s_mov_b32 s70, 0
  v_mul_u32_u24 v31, s69, v30
  v_lshrrev_b32 v31, 16, v31
  v_mad_u32_u24 v31, v31, 12, s70
  v_lshl_add_u32 v32, v30, 1, v31
  v_add_u32 v30, 256, v30
  v_mul_u32_u24 v31, s69, v30
  v_lshrrev_b32 v31, 16, v31
  v_mad_u32_u24 v31, v31, 12, s70
  v_lshl_add_u32 v33, v30, 1, v31
  v_add_u32 v30, 256, v30
  v_mul_u32_u24 v31, s69, v30
  v_lshrrev_b32 v31, 16, v31
  v_mad_u32_u24 v31, v31, 12, s70
  v_lshl_add_u32 v34, v30, 1, v31
  v_mov_b32 v31, 676
  v_cmp_gt_u32 s[92:93], v31, v30
  v_lshlrev_b32 v35, 4, v28
  v_add_u32 v35, 129576, v35
  v_lshlrev_b32 v36, 1, v0
  v_add_u32 v36, 129472, v36
  v_lshlrev_b32 v37, 6, v0
  v_add_u32 v37, 52, v37
L_addrc:
  v_mov_b32 v232, 0
  v_mov_b32 v233, 0
  v_mov_b32 v234, 0
  v_mov_b32 v235, 0
  v_and_b32 v8, 7, v0
  v_lshlrev_b32 v8, 4, v8
  s_mul_i32 s76, s3, 4064
  s_add_u32 s76, s76, 131136
  ds_write_b128 v47, v[232:235] offset:5120
  v_lshlrev_b32 v30, 2, v0
  v_and_b32 v31, 60, v30
  v_add_u32 v31, 85248, v31
  ds_write_b32 v31, v232
  ds_write_b32 v31, v232 offset:43328
  v_mul_u32_u24 v30, 1056, v28
  v_lshl_add_u32 v30, v29, 2, v30
  v_add_u32 v2, s76, v30
  v_mov_b32 v31, 0x3f803f80
  v_cmp_gt_u32 vcc, 32, v0
  s_nop 1
  v_cndmask_b32 v7, 0, v31, vcc
  ds_write_b32 v2, v7 offset:2880
  v_bfe_u32 v30, v0, 2, 2
  v_lshl_add_u32 v30, v28, 3, v30
  v_bfe_u32 v31, v0, 4, 1
  v_lshlrev_b32 v31, 5, v31
  v_and_b32 v108, 3, v0
  v_lshl_add_u32 v31, v108, 3, v31
  v_lshl_add_u32 v56, v30, 6, v31
  v_add_u32 v56, 0, v56
  s_lshl_b32 s68, s3, 7
  s_add_u32 s68, s68, 6144
  v_add_u32 v31, s68, v31
  v_mul_u32_u24 v108, 1352, v30
  v_add_u32 v57, v31, v108
  v_add_u32 v108, 16, v30
  v_min_u32 v108, 25, v108
  v_mul_u32_u24 v108, 1352, v108
  v_add_u32 v58, v31, v108
  v_add_u32 v108, 20, v30
  v_min_u32 v108, 25, v108
  v_mul_u32_u24 v108, 1352, v108
  v_add_u32 v59, v31, v108
  v_mov_b32 v109, 1048576
  v_and_b32 v30, 7, v0
  v_bfe_u32 v31, v0, 3, 2
  v_lshl_add_u32 v108, v30, 2, v31
  v_cmp_gt_u32 vcc, 26, v108
  s_lshl_b32 s69, s3, 2
  s_add_u32 s69, s69, 85312
  v_mul_u32_u24 v38, 52, v108
  v_add_u32 v38, s69, v38
  v_cndmask_b32 v38, v109, v38, vcc
  v_lshl_add_u32 v39, v28, 20, v38
  v_mul_u32_u24 v31, 10816, v28
  v_add_u32 v38, v38, v31
  s_mov_b32 exec_lo, 0xf0f0f0f0
  s_mov_b32 exec_hi, 0xf0f0f0f0
  v_add_u32 v108, 4, v108
  v_and_or_b32 v108, v108, 15, 16
  s_mov_b64 exec, -1
  v_cmp_gt_u32 vcc, 26, v108
  s_nop 1
  v_cndmask_b32 v31, 63, v108, vcc
  v_lshlrev_b32 v108, 3, v28
  v_sub_u32 v31, v31, v108
  v_and_b32 v108, 1, v31
  v_lshlrev_b32 v108, 4, v108
  v_mov_b32 v30, 0xffff
  v_lshlrev_b32 v108, v108, v30
  v_lshrrev_b32 v31, 1, v31
  v_cmp_eq_u32 vcc, 0, v31
  s_nop 1
  v_cndmask_b32 v216, 0, v108, vcc
  v_cmp_eq_u32 vcc, 1, v31
  s_nop 1
  v_cndmask_b32 v217, 0, v108, vcc
  v_cmp_eq_u32 vcc, 2, v31
  s_nop 1
  v_cndmask_b32 v218, 0, v108, vcc
  v_cmp_eq_u32 vcc, 3, v31
  s_nop 1
  v_cndmask_b32 v219, 0, v108, vcc
  v_cmp_eq_u32 vcc, 8, v31
  s_nop 1
  v_cndmask_b32 v220, 0, v108, vcc
  v_cmp_eq_u32 vcc, 9, v31
  s_nop 1
  v_cndmask_b32 v221, 0, v108, vcc
  v_cmp_eq_u32 vcc, 10, v31
  s_nop 1
  v_cndmask_b32 v222, 0, v108, vcc
  v_cmp_eq_u32 vcc, 11, v31
  s_nop 1
  v_cndmask_b32 v223, 0, v108, vcc
  v_lshlrev_b32 v108, 1, v28
  v_bfe_u32 v30, v0, 1, 2
  v_xor_b32 v30, v30, v108
  v_lshlrev_b32 v30, 4, v30
  v_lshl_add_u32 v31, v29, 6, v30
  s_mul_i32 s69, s3, 3328
  s_add_u32 s69, s69, 41984
  v_add_u32 v41, s69, v31
  v_add_u32 v50, 16640, v41
  s_lshl_b32 s69, s3, 6
  s_add_u32 s69, s69, 128640
  s_mov_b32 exec_lo, 0x4000000
  s_mov_b32 exec_hi, 0x4000000
  v_add_u32 v41, s69, v30
  v_add_u32 v50, 320, v41
  s_mov_b32 exec_lo, 0xf8000000
  s_mov_b32 exec_hi, 0xf8000000
  v_mov_b32 v41, v109
  v_mov_b32 v50, v109
  s_mov_b64 exec, -1
  v_add_u32 v42, 1664, v41
  v_add_u32 v51, 1664, v50
  s_lshl_b32 s69, s3, 6
  v_add_u32 v30, s69, v29
  s_mov_b32 s69, 2521
  s_mov_b32 s70, 85312
  v_mul_u32_u24 v31, s69, v30
  v_lshrrev_b32 v31, 16, v31
  v_mul_u32_u24 v31, 26, v31
  v_sub_u32 v31, v30, v31
  v_bfe_u32 v31, v31, 1, 2
  v_xor_b32 v31, v31, v108
  v_lshl_add_u32 v31, v30, 2, v31
  v_lshl_add_u32 v43, v31, 4, s70
  v_add_u32 v30, 32, v30
  v_mul_u32_u24 v31, s69, v30
  v_lshrrev_b32 v31, 16, v31
  v_mul_u32_u24 v31, 26, v31
  v_sub_u32 v31, v30, v31
  v_bfe_u32 v31, v31, 1, 2
  v_xor_b32 v31, v31, v108
  v_lshl_add_u32 v31, v30, 2, v31
  v_lshl_add_u32 v44, v31, 4, s70
  s_cmp_ge_u32 s3, 3
  s_cbranch_scc1 L_nosq
  v_add_u32 v30, 480, v30
  v_mul_u32_u24 v31, s69, v30
  v_lshrrev_b32 v31, 16, v31
  v_mul_u32_u24 v31, 26, v31
  v_sub_u32 v31, v30, v31
  v_bfe_u32 v31, v31, 1, 2
  v_xor_b32 v31, v31, v108
  v_lshl_add_u32 v31, v30, 2, v31
  v_lshl_add_u32 v50, v31, 4, s70
  v_add_u32 v30, 32, v30
  v_mul_u32_u24 v31, s69, v30
  v_lshrrev_b32 v31, 16, v31
  v_mul_u32_u24 v31, 26, v31
  v_sub_u32 v31, v30, v31
  v_bfe_u32 v31, v31, 1, 2
  v_xor_b32 v31, v31, v108
  v_lshl_add_u32 v31, v30, 2, v31
  v_lshl_add_u32 v51, v31, 4, s70
  v_cmp_gt_u32 vcc, 676, v30
  s_nop 1
  v_cndmask_b32 v51, v109, v51, vcc
L_nosq:
  v_and_b32 v30, 12, v0
  v_and_b32 v31, 1, v0
  v_lshl_add_u32 v30, v31, 1, v30
  v_lshlrev_b32 v30, 4, v30
  v_and_b32 v31, 2, v0
  v_lshl_add_u32 v30, v31, 19, v30
  v_lshrrev_b32 v31, 4, v0
  v_lshl_add_u32 v231, v31, 8, v30
  v_lshl_add_u32 v30, v28, 8, v30
  v_bfe_u32 v31, v0, 4, 1
  v_lshl_add_u32 v230, v31, 3, v30
  s_and_b32 s98, s3, 1
  s_lshr_b32 s99, s3, 1
  s_mul_i32 s68, s99, 3072
  s_lshl_b32 s69, s98, 3
  s_add_u32 s68, s68, s69
  v_add_u32 v40, s68, v47
  v_add_u32 v231, s69, v231
  s_lshl_b32 s69, s99, 3
  s_lshr_b32 s69, 0x05030200, s69
  s_and_b32 s69, s69, 0xff
  s_lshl_b32 s69, s69, 9
  s_lshl_b32 s70, s98, 2
  s_add_u32 s69, s69, s70
  v_add_u32 v230, s69, v230
  v_mov_b32 v1, v47
  s_mul_i32 s68, s3, 5280
  s_add_u32 s68, s68, 41984
  v_mul_u32_u24 v30, 3200, v28
  v_lshl_add_u32 v30, v29, 2, v30
  v_add_u32 v3, s68, v30
  v_and_b32 v30, 1, v0
  v_mul_u32_u24 v30, 0xaaaa, v30
  v_add_u32 v9, 0x4444, v30
  v_and_b32 v108, 3, v0
  v_lshlrev_b32 v108, 3, v108
  v_lshrrev_b32 v30, 4, v0
  v_bfe_u32 v31, v0, 2, 2
  v_add_u32 v5, s76, v108
  v_lshl_add_u32 v4, v30, 7, v5
  v_mul_u32_u24 v30, 1056, v31
  v_add_u32 v4, v4, v30
  v_add_u32 v5, 3936, v5
  s_mov_b32 exec_hi, 0xffff
  v_add_u32 v5, 512, v4
  s_mov_b32 exec_hi, -1
  v_add_u32 v108, s68, v108
  v_lshlrev_b32 v31, 3, v31
  s_movk_i32 s69, 160
  s_mov_b32 exec_lo, 0xffff
  s_mov_b32 exec_hi, 0x0
  v_mov_b32 v20, 0xa090b
  v_mov_b32 v21, 0x7050c06
  v_mov_b32 v22, 0x8020301
  v_mov_b32 v23, 0xa090b
  v_mov_b32 v24, 0x7050c06
  v_mov_b32 v25, 0x8020301
  v_mov_b32 v26, 0x5040504
  v_mov_b32 v27, 0xc150c15
  s_mov_b32 exec_lo, 0xffff0000
  s_mov_b32 exec_hi, 0x0
  v_mov_b32 v20, 0x16141d1f
  v_mov_b32 v21, 0x1b19181a
  v_mov_b32 v22, 0x1e1c1715
  v_mov_b32 v23, 0x16141d1f
  v_mov_b32 v24, 0x1b19181a
  v_mov_b32 v25, 0x1e1c1715
  v_mov_b32 v26, 0x9200920
  v_mov_b32 v27, 0x2160216
  s_mov_b32 exec_lo, 0x0
  s_mov_b32 exec_hi, 0xffff
  v_mov_b32 v20, 0x1070500
  v_mov_b32 v21, 0xa040908
  v_mov_b32 v22, 0x20c0603
  v_mov_b32 v23, 0x16191a1c
  v_mov_b32 v24, 0x1f181e15
  v_mov_b32 v25, 0x17201b14
  v_mov_b32 v26, 0x1d001d
  v_mov_b32 v27, 0x18011801
  s_mov_b32 exec_lo, 0x0
  s_mov_b32 exec_hi, 0xffff0000
  v_mov_b32 v20, 0x60c020b
  v_mov_b32 v21, 0x9040a03
  v_mov_b32 v22, 0x5070108
  v_mov_b32 v23, 0x1b20171d
  v_mov_b32 v24, 0x1e181f14
  v_mov_b32 v25, 0x1a191615
  v_mov_b32 v26, 0x191c191c
  v_mov_b32 v27, 0x18180404
  s_mov_b64 exec, -1
  v_bfe_u32 v20, v20, v31, 8
  v_mad_u32_u24 v20, v20, s69, v108
  v_bfe_u32 v21, v21, v31, 8
  v_mad_u32_u24 v21, v21, s69, v108
  v_bfe_u32 v22, v22, v31, 8
  v_mad_u32_u24 v22, v22, s69, v108
  v_bfe_u32 v23, v23, v31, 8
  v_mad_u32_u24 v23, v23, s69, v108
  v_bfe_u32 v24, v24, v31, 8
  v_mad_u32_u24 v24, v24, s69, v108
  v_bfe_u32 v25, v25, v31, 8
  v_mad_u32_u24 v25, v25, s69, v108
  v_bfe_u32 v26, v26, v31, 8
  v_mad_u32_u24 v26, v26, s69, v108
  v_bfe_u32 v27, v27, v31, 8
  v_mad_u32_u24 v27, v27, s69, v108
  s_cmp_eq_u32 s3, 1
  s_cbranch_scc1 L_tab1
  s_cmp_eq_u32 s3, 2
  s_cbranch_scc1 L_tab2
  s_cmp_eq_u32 s3, 3
  s_cbranch_scc1 L_tab3
  s_cmp_eq_u32 s3, 4
  s_cbranch_scc1 L_tab4
  s_cmp_eq_u32 s3, 5
  s_cbranch_scc1 L_tab5
  s_cmp_eq_u32 s3, 6
  s_cbranch_scc1 L_tab6
  s_cmp_eq_u32 s3, 7
  s_cbranch_scc1 L_tab7
L_tab0:
  s_mov_b32 exec_lo, 0xffff
  s_mov_b32 exec_hi, 0x0
  v_mov_b32 v224, 0x12140016
  v_mov_b32 v225, 0x121614
  v_mov_b32 v226, 0x20614
  v_mov_b32 v227, 0x6001402
  v_mov_b32 v228, 0xe04100a
  v_mov_b32 v229, 0x100e0a04
  s_mov_b32 exec_lo, 0xffff0000
  s_mov_b32 exec_hi, 0x0
  v_mov_b32 v224, 0x13010517
  v_mov_b32 v225, 0x5131701
  v_mov_b32 v226, 0x5030701
  v_mov_b32 v227, 0x7050103
  v_mov_b32 v228, 0xf11150b
  v_mov_b32 v229, 0x150f0b11
  s_mov_b32 exec_lo, 0x0
  s_mov_b32 exec_hi, 0xffff
  v_mov_b32 v224, 0xa0b0500
  v_mov_b32 v225, 0x50a000b
  v_mov_b32 v226, 0x2010f0e
  v_mov_b32 v227, 0xf020e01
  v_mov_b32 v228, 0x14140719
  v_mov_b32 v229, 0x7190808
  s_mov_b32 exec_lo, 0x0
  s_mov_b32 exec_hi, 0xffff0000
  v_mov_b32 v224, 0x4190f16
  v_mov_b32 v225, 0xf041619
  v_mov_b32 v226, 0xc030518
  v_mov_b32 v227, 0x50c1803
  v_mov_b32 v228, 0x12120808
  v_mov_b32 v229, 0xd0b0d0b
  s_branch L_tabd
L_tab1:
  s_mov_b32 exec_lo, 0xffff
  s_mov_b32 exec_hi, 0x0
  v_mov_b32 v224, 0x120c1816
  v_mov_b32 v225, 0x1812160c
  v_mov_b32 v226, 0x1414
  v_mov_b32 v227, 0x10041004
  v_mov_b32 v228, 0xe080e0a
  v_mov_b32 v229, 0x80a0e0e
  s_mov_b32 exec_lo, 0xffff0000
  s_mov_b32 exec_hi, 0x0
  v_mov_b32 v224, 0x130d0917
  v_mov_b32 v225, 0x913170d
  v_mov_b32 v226, 0x5050101
  v_mov_b32 v227, 0x15111511
  v_mov_b32 v228, 0xf190f0b
  v_mov_b32 v229, 0x190b0f0f
  s_mov_b32 exec_lo, 0x0
  s_mov_b32 exec_hi, 0xffff
  v_mov_b32 v224, 0xa031500
  v_mov_b32 v225, 0x150a0003
  v_mov_b32 v226, 0x219070e
  v_mov_b32 v227, 0x7020e19
  v_mov_b32 v228, 0x14131417
  v_mov_b32 v229, 0x13081708
  s_mov_b32 exec_lo, 0x0
  s_mov_b32 exec_hi, 0xffff0000
  v_mov_b32 v224, 0x4011716
  v_mov_b32 v225, 0x17041601
  v_mov_b32 v226, 0xc0b0d18
  v_mov_b32 v227, 0xd0c180b
  v_mov_b32 v228, 0x12081208
  v_mov_b32 v229, 0x11111515
  s_branch L_tabd
L_tab2:
  s_mov_b32 exec_lo, 0xffff
  s_mov_b32 exec_hi, 0x0
  v_mov_b32 v224, 0x12121616
  v_mov_b32 v225, 0xe0a0e0a
  v_mov_b32 v226, 0x141400
  v_mov_b32 v227, 0x8081414
  v_mov_b32 v228, 0x6041002
  v_mov_b32 v229, 0x10060204
  s_mov_b32 exec_lo, 0xffff0000
  s_mov_b32 exec_hi, 0x0
  v_mov_b32 v224, 0x13131717
  v_mov_b32 v225, 0xf0b0f0b
  v_mov_b32 v226, 0x19010101
  v_mov_b32 v227, 0x5190105
  v_mov_b32 v228, 0x7111503
  v_mov_b32 v229, 0x15070311
  s_mov_b32 exec_lo, 0x0
  s_mov_b32 exec_hi, 0xffff
  v_mov_b32 v224, 0xa090009
  v_mov_b32 v225, 0x170a1700
  v_mov_b32 v226, 0x20e0b05
  v_mov_b32 v227, 0x13130e0e
  v_mov_b32 v228, 0xc190706
  v_mov_b32 v229, 0x70c0619
  s_mov_b32 exec_lo, 0x0
  s_mov_b32 exec_hi, 0xffff0000
  v_mov_b32 v224, 0x4041616
  v_mov_b32 v225, 0x15091509
  v_mov_b32 v226, 0xc18190f
  v_mov_b32 v227, 0x11111818
  v_mov_b32 v228, 0x20b0d10
  v_mov_b32 v229, 0xd02100b
  s_branch L_tabd
L_tab3:
  s_mov_b32 exec_lo, 0xffff
  s_mov_b32 exec_hi, 0x0
  v_mov_b32 v224, 0x12121616
  v_mov_b32 v225, 0x6020602
  v_mov_b32 v226, 0x180a0e0c
  v_mov_b32 v227, 0xe180c0a
  v_mov_b32 v228, 0x6080602
  v_mov_b32 v229, 0x8020606
  s_mov_b32 exec_lo, 0xffff0000
  s_mov_b32 exec_hi, 0x0
  v_mov_b32 v224, 0x13131717
  v_mov_b32 v225, 0x7030703
  v_mov_b32 v226, 0x90b0f0d
  v_mov_b32 v227, 0xf090d0b
  v_mov_b32 v228, 0x7190703
  v_mov_b32 v229, 0x19030707
  s_mov_b32 exec_lo, 0x0
  s_mov_b32 exec_hi, 0xffff
  v_mov_b32 v224, 0xa010f00
  v_mov_b32 v225, 0xf0a0001
  v_mov_b32 v226, 0x12091009
  v_mov_b32 v227, 0x17121710
  v_mov_b32 v228, 0xc130f06
  v_mov_b32 v229, 0x13060c0f
  s_mov_b32 exec_lo, 0x0
  s_mov_b32 exec_hi, 0xffff0000
  v_mov_b32 v224, 0x4030516
  v_mov_b32 v225, 0x5041603
  v_mov_b32 v226, 0x14140606
  v_mov_b32 v227, 0x15091509
  v_mov_b32 v228, 0x2110510
  v_mov_b32 v229, 0x11100205
  s_branch L_tabd
L_tab4:
  s_mov_b32 exec_lo, 0xffff
  s_mov_b32 exec_hi, 0x0
  v_mov_b32 v224, 0x12041016
  v_mov_b32 v225, 0x10121604
  v_mov_b32 v226, 0x1802060c
  v_mov_b32 v227, 0x6180c02
  v_mov_b32 v228, 0x10041010
  v_mov_b32 v229, 0x8081004
  s_mov_b32 exec_lo, 0xffff0000
  s_mov_b32 exec_hi, 0x0
  v_mov_b32 v224, 0x13111517
  v_mov_b32 v225, 0x15131711
  v_mov_b32 v226, 0x903070d
  v_mov_b32 v227, 0x7090d03
  v_mov_b32 v228, 0x15111511
  v_mov_b32 v229, 0x19191515
  s_mov_b32 exec_lo, 0x0
  s_mov_b32 exec_hi, 0xffff
  v_mov_b32 v224, 0xa190700
  v_mov_b32 v225, 0x70a0019
  v_mov_b32 v226, 0x12010f10
  v_mov_b32 v227, 0xf121001
  v_mov_b32 v228, 0x4130718
  v_mov_b32 v229, 0x13180407
  s_mov_b32 exec_lo, 0x0
  s_mov_b32 exec_hi, 0xffff0000
  v_mov_b32 v224, 0x40b0d16
  v_mov_b32 v225, 0xd04160b
  v_mov_b32 v226, 0x14030506
  v_mov_b32 v227, 0x5140603
  v_mov_b32 v228, 0xa110d0e
  v_mov_b32 v229, 0x110e0a0d
  s_branch L_tabd
L_tab5:
  s_mov_b32 exec_lo, 0xffff
  s_mov_b32 exec_hi, 0x0
  v_mov_b32 v224, 0x12081616
  v_mov_b32 v225, 0x8161612
  v_mov_b32 v226, 0x18180c0c
  v_mov_b32 v227, 0x10041004
  v_mov_b32 v228, 0x18030a08
  v_mov_b32 v229, 0x18030a08
  s_mov_b32 exec_lo, 0xffff0000
  s_mov_b32 exec_hi, 0x0
  v_mov_b32 v224, 0x13191717
  v_mov_b32 v225, 0x19171713
  v_mov_b32 v226, 0x9090d0d
  v_mov_b32 v227, 0x15111511
  v_mov_b32 v228, 0x4051219
  v_mov_b32 v229, 0x4051219
  s_mov_b32 exec_lo, 0x0
  s_mov_b32 exec_hi, 0xffff
  v_mov_b32 v224, 0xa00110d
  v_mov_b32 v225, 0x13130000
  v_mov_b32 v226, 0x12190710
  v_mov_b32 v227, 0x7121019
  v_mov_b32 v228, 0x9020013
  v_mov_b32 v229, 0x9020013
  s_mov_b32 exec_lo, 0x0
  s_mov_b32 exec_hi, 0xffff0000
  v_mov_b32 v224, 0x4161307
  v_mov_b32 v225, 0x11111616
  v_mov_b32 v226, 0x140b0d06
  v_mov_b32 v227, 0xd14060b
  v_mov_b32 v228, 0x1a090b11
  v_mov_b32 v229, 0x1a080b11
  s_branch L_tabd
L_tab6:
  s_mov_b32 exec_lo, 0xffff
  s_mov_b32 exec_hi, 0x0
  v_mov_b32 v224, 0x1414
  v_mov_b32 v225, 0x180c180c
  v_mov_b32 v226, 0x180c0c18
  v_mov_b32 v227, 0x8080c0c
  s_mov_b32 exec_lo, 0xffff0000
  s_mov_b32 exec_hi, 0x0
  v_mov_b32 v224, 0x5050101
  v_mov_b32 v225, 0x90d090d
  v_mov_b32 v226, 0x90d0d09
  v_mov_b32 v227, 0x19190d0d
  s_mov_b32 exec_lo, 0x0
  s_mov_b32 exec_hi, 0xffff
  v_mov_b32 v224, 0x203150e
  v_mov_b32 v225, 0x15020e03
  v_mov_b32 v226, 0x12100315
  v_mov_b32 v227, 0x13131010
  s_mov_b32 exec_lo, 0x0
  s_mov_b32 exec_hi, 0xffff0000
  v_mov_b32 v224, 0xc011718
  v_mov_b32 v225, 0x170c1801
  v_mov_b32 v226, 0x14060117
  v_mov_b32 v227, 0x11110606
  s_branch L_tabd
L_tab7:
  s_mov_b32 exec_lo, 0xffff
  s_mov_b32 exec_hi, 0x0
  v_mov_b32 v224, 0xa0e14
  v_mov_b32 v225, 0xe00140a
  v_mov_b32 v226, 0xe0e0a0a
  v_mov_b32 v227, 0x6020602
  s_mov_b32 exec_lo, 0xffff0000
  s_mov_b32 exec_hi, 0x0
  v_mov_b32 v224, 0x50b0f01
  v_mov_b32 v225, 0xf05010b
  v_mov_b32 v226, 0xf0f0b0b
  v_mov_b32 v227, 0x7030703
  s_mov_b32 exec_lo, 0x0
  s_mov_b32 exec_hi, 0xffff
  v_mov_b32 v224, 0x2090e09
  v_mov_b32 v225, 0x1702170e
  v_mov_b32 v226, 0x14140f01
  v_mov_b32 v227, 0xf010808
  s_mov_b32 exec_lo, 0x0
  s_mov_b32 exec_hi, 0xffff0000
  v_mov_b32 v224, 0xc0c1818
  v_mov_b32 v225, 0x15091509
  v_mov_b32 v226, 0x12120808
  v_mov_b32 v227, 0x5030503
L_tabd:
  s_mov_b64 exec, -1
  v_and_b32 v108, 3, v0
  s_movk_i32 s69, 676
  s_mov_b32 s70, 41984
  v_bfe_u32 v224, v224, v31, 8
  v_bfe_u32 v225, v225, v31, 8
  v_cmp_eq_u32 vcc, v224, v225
  v_mad_u32_u24 v30, v224, 26, v225
  v_min_u32 v30, s69, v30
  v_mad_u32_u24 v49, v225, 26, v224
  v_mov_b32 v54, s69
  v_cndmask_b32 v49, v49, v54, vcc
  v_and_b32 v225, 6, v225
  v_xor_b32 v225, v225, v108
  v_lshl_add_u32 v30, v30, 3, v225
  v_and_b32 v224, 6, v224
  v_xor_b32 v224, v224, v108
  v_lshl_add_u32 v49, v49, 3, v224
  v_lshl_add_u32 v224, v30, 3, s70
  v_lshl_add_u32 v225, v49, 3, s70
  v_xor_b32 v236, 32, v224
  v_xor_b32 v237, 32, v225
  v_bfe_u32 v226, v226, v31, 8
  v_bfe_u32 v227, v227, v31, 8
  v_cmp_eq_u32 vcc, v226, v227
  v_mad_u32_u24 v30, v226, 26, v227
  v_min_u32 v30, s69, v30
  v_mad_u32_u24 v49, v227, 26, v226
  v_mov_b32 v54, s69
  v_cndmask_b32 v49, v49, v54, vcc
  v_and_b32 v227, 6, v227
  v_xor_b32 v227, v227, v108
  v_lshl_add_u32 v30, v30, 3, v227
  v_and_b32 v226, 6, v226
  v_xor_b32 v226, v226, v108
  v_lshl_add_u32 v49, v49, 3, v226
  v_lshl_add_u32 v226, v30, 3, s70
  v_lshl_add_u32 v227, v49, 3, s70
  v_xor_b32 v238, 32, v226
  v_xor_b32 v239, 32, v227
  v_bfe_u32 v228, v228, v31, 8
  v_bfe_u32 v229, v229, v31, 8
  v_cmp_eq_u32 vcc, v228, v229
  v_mad_u32_u24 v30, v228, 26, v229
  v_min_u32 v30, s69, v30
  v_mad_u32_u24 v49, v229, 26, v228
  v_mov_b32 v54, s69
  v_cndmask_b32 v49, v49, v54, vcc
  v_and_b32 v229, 6, v229
  v_xor_b32 v229, v229, v108
  v_lshl_add_u32 v30, v30, 3, v229
  v_and_b32 v228, 6, v228
  v_xor_b32 v228, v228, v108
  v_lshl_add_u32 v49, v49, 3, v228
  v_lshl_add_u32 v228, v30, 3, s70
  v_lshl_add_u32 v229, v49, 3, s70
  v_xor_b32 v240, 32, v228
  v_xor_b32 v241, 32, v229
  s_and_b32 s68, s3, 1
  s_lshl_b32 s69, s68, 2
  s_xor_b32 s69, s69, 2
  v_xor_b32 v108, s69, v108
  v_lshlrev_b32 v108, 3, v108
  v_bfe_u32 v30, v0, 2, 1
  v_mul_u32_u24 v30, 1664, v30
  v_add_u32 v30, v30, v108
  v_bfe_u32 v31, v0, 3, 1
  v_lshl_add_u32 v30, v31, 6, v30
  v_lshrrev_b32 v31, 4, v0
  v_lshl_add_u32 v30, v31, 7, v30
  v_add_u32 v55, 128640, v30
  v_add_u32 v245, 512, v55
  s_mov_b32 exec_lo, 0
  s_mov_b32 exec_hi, 0xffffff00
  v_add_u32 v245, 85248, v108
  s_mov_b64 exec, -1
  v_and_b32 v30, 3, v0
  v_bfe_u32 v31, v0, 2, 2
  v_lshl_add_u32 v31, v30, 2, v31
  s_lshl_b32 s68, s68, 4
  v_add_u32 v31, s68, v31
  v_cmp_gt_u32 vcc, 26, v31
  v_lshlrev_b32 v31, 1, v31
  v_add_u32 v31, 129472, v31
  v_cndmask_b32 v53, v109, v31, vcc
  s_lshl_b32 s77, s26, 3
  s_add_u32 s77, s77, s3
  s_mul_i32 s77, s77, 624
  s_add_u32 s73, s77, 80
  s_add_u32 s77, s77, 16
  s_mov_b32 s71, 10923
  v_min_u32 v30, 35, v0
  v_mul_u32_u24 v31, s71, v30
  v_lshrrev_b32 v31, 16, v31
  v_mul_u32_u24 v31, 80, v31
  v_lshl_add_u32 v12, v30, 2, v31
  s_mov_b32 s60, s24
  s_and_b32 s61, s25, 0xffff
  s_mov_b32 s62, 268435456
  s_mov_b32 s63, 0x20000
  s_mov_b32 s56, s20
  s_and_b32 s57, s21, 0xffff
  s_mov_b32 s58, 8192
  s_mov_b32 s59, 0x20000
  s_mov_b32 s64, s22
  s_and_b32 s65, s23, 0xffff
  s_mov_b32 s66, 256
  s_mov_b32 s67, 0x20000
  buffer_load_dwordx4 v[16:19], v6, s[28:31], s94 offen
  s_add_u32 s94, s94, 832
  buffer_load_dword v13, v12, s[28:31], s77 offen
  s_cmp_eq_u32 s77, s73
  s_cselect_b32 s73, 0x7000000, s73
  s_cselect_b32 s77, 0x7000000, s77
  s_add_u32 s77, s77, 24
  s_min_u32 s77, s77, s73
  s_cmp_eq_u32 s84, 0
  s_cbranch_scc1 L_g0pf
L_csync1:
  ds_read_b32 v49, v46
  s_waitcnt lgkmcnt(0)
  v_cmp_gt_u32 vcc, 4, v49
  s_cbranch_vccnz L_csync1
  ds_read_b64 v[112:113], v35 offset:0
  ds_read_b64 v[114:115], v35 offset:8
  ds_read_b64 v[116:117], v35 offset:32
  ds_read_b64 v[118:119], v35 offset:40
  ds_read_u16 v108, v36 offset:52
  ds_read_b64_tr_b16 v[60:61], v57 offset:35328
  ds_read_b64_tr_b16 v[62:63], v57 offset:40736
  ds_read_b64_tr_b16 v[64:65], v58 offset:35328
  ds_read_b64_tr_b16 v[66:67], v59 offset:35328
  ds_read_b64_tr_b16 v[68:69], v57 offset:35392
  ds_read_b64_tr_b16 v[70:71], v57 offset:40800
  ds_read_b64_tr_b16 v[72:73], v58 offset:35392
  ds_read_b64_tr_b16 v[74:75], v59 offset:35392
  ds_read_b64_tr_b16 v[76:77], v57 offset:35840
  ds_read_b64_tr_b16 v[78:79], v57 offset:41248
  ds_read_b64_tr_b16 v[80:81], v58 offset:35840
  ds_read_b64_tr_b16 v[82:83], v59 offset:35840
  ds_read_b64_tr_b16 v[84:85], v57 offset:35904
  ds_read_b64_tr_b16 v[86:87], v57 offset:41312
  ds_read_b64_tr_b16 v[88:89], v58 offset:35904
  ds_read_b64_tr_b16 v[90:91], v59 offset:35904
  s_waitcnt lgkmcnt(14)
  v_mfma_f32_32x32x16_bf16 v[120:135], v[112:115], v[60:63], 0
  s_waitcnt lgkmcnt(12)
  v_mfma_f32_32x32x16_bf16 v[120:135], v[116:119], v[64:67], v[120:135]
  ds_read_b64_tr_b16 v[92:93], v57 offset:36352
  ds_read_b64_tr_b16 v[94:95], v57 offset:41760
  ds_read_b64_tr_b16 v[96:97], v58 offset:36352
  ds_read_b64_tr_b16 v[98:99], v59 offset:36352
  s_waitcnt lgkmcnt(14)
  v_mfma_f32_32x32x16_bf16 v[136:151], v[112:115], v[68:71], 0
  s_waitcnt lgkmcnt(12)
  v_mfma_f32_32x32x16_bf16 v[136:151], v[116:119], v[72:75], v[136:151]
  ds_read_b64_tr_b16 v[100:101], v57 offset:36416
  ds_read_b64_tr_b16 v[102:103], v57 offset:41824
  ds_read_b64_tr_b16 v[104:105], v58 offset:36416
  ds_read_b64_tr_b16 v[106:107], v59 offset:36416
  s_waitcnt lgkmcnt(14)
  v_mfma_f32_32x32x16_bf16 v[152:167], v[112:115], v[76:79], 0
  s_waitcnt lgkmcnt(12)
  v_mfma_f32_32x32x16_bf16 v[152:167], v[116:119], v[80:83], v[152:167]
  s_waitcnt lgkmcnt(10)
  v_mfma_f32_32x32x16_bf16 v[168:183], v[112:115], v[84:87], 0
  s_waitcnt lgkmcnt(8)
  v_mfma_f32_32x32x16_bf16 v[168:183], v[116:119], v[88:91], v[168:183]
  s_waitcnt lgkmcnt(6)
  v_mfma_f32_32x32x16_bf16 v[184:199], v[112:115], v[92:95], 0
  s_waitcnt lgkmcnt(4)
  v_mfma_f32_32x32x16_bf16 v[184:199], v[116:119], v[96:99], v[184:199]
  s_waitcnt lgkmcnt(2)
  v_mfma_f32_32x32x16_bf16 v[200:215], v[112:115], v[100:103], 0
  s_waitcnt lgkmcnt(0)
  v_mfma_f32_32x32x16_bf16 v[200:215], v[116:119], v[104:107], v[200:215]
  v_mov_b32 v247, 0
  v_mov_b32 v30, 0
  s_mov_b64 exec, 0x3ffffff
  ds_write_b16 v37, v108
  v_lshlrev_b32 v30, 17, v108
  v_lshrrev_b32 v30, 1, v30
  s_mov_b64 exec, -1
  s_mov_b32 exec_lo, 0
  v_mov_b32 v120, v136
  s_mov_b32 exec_lo, -1
  v_cvt_pk_bf16_f32 v60, 0, v120
  ds_write_b16_d16_hi v32, v60
  v_max_f32 v247, |v60|, v247
  s_mov_b32 exec_lo, 0
  v_mov_b32 v152, v168
  s_mov_b32 exec_lo, -1
  v_cvt_pk_bf16_f32 v61, 0, v152
  ds_write_b16_d16_hi v33, v61
  v_max_f32 v247, |v61|, v247
  s_mov_b32 exec_lo, 0
  v_mov_b32 v184, v200
  s_mov_b32 exec_lo, -1
  v_cvt_pk_bf16_f32 v62, 0, v184
  s_mov_b64 exec, s[92:93]
  ds_write_b16_d16_hi v34, v62
  v_max_f32 v247, |v62|, v247
  s_mov_b64 exec, -1
  s_nop 0
  v_max_u32_dpp v247, v247, v247 row_shr:1 row_mask:0xf bank_mask:0xf
  v_max_u32_dpp v30, v30, v30 row_shr:1 row_mask:0xf bank_mask:0xf
  s_nop 0
  v_max_u32_dpp v247, v247, v247 row_shr:2 row_mask:0xf bank_mask:0xf
  v_max_u32_dpp v30, v30, v30 row_shr:2 row_mask:0xf bank_mask:0xf
  s_nop 0
  v_max_u32_dpp v247, v247, v247 row_shr:4 row_mask:0xf bank_mask:0xf
  v_max_u32_dpp v30, v30, v30 row_shr:4 row_mask:0xf bank_mask:0xf
  s_nop 0
  v_max_u32_dpp v247, v247, v247 row_shr:8 row_mask:0xf bank_mask:0xf
  v_max_u32_dpp v30, v30, v30 row_shr:8 row_mask:0xf bank_mask:0xf
  s_nop 0
  v_max_u32_dpp v247, v247, v247 row_bcast:15 row_mask:0xa bank_mask:0xf
  v_max_u32_dpp v30, v30, v30 row_bcast:15 row_mask:0xa bank_mask:0xf
  s_nop 0
  v_max_u32_dpp v247, v247, v247 row_bcast:31 row_mask:0xc bank_mask:0xf
  v_max_u32_dpp v30, v30, v30 row_bcast:31 row_mask:0xc bank_mask:0xf
  s_mov_b32 exec_lo, 0
  s_mov_b32 exec_hi, 0x80000000
  ds_max_u32 v46, v247 offset:24
  ds_max_u32 v46, v30 offset:28
  s_mov_b64 exec, -1
  s_waitcnt vmcnt(1)
  v_lshl_add_u32 v16, v16, 7, v8
  v_lshl_add_u32 v17, v17, 7, v8
  v_lshl_add_u32 v18, v18, 7, v8
  v_lshl_add_u32 v19, v19, 7, v8
  s_add_u32 m0, s76, 0
  s_mov_b32 exec_hi, 0xffffff
  buffer_load_dwordx4 v16, s[32:35], 0 offen lds
  s_add_u32 m0, s76, 1056
  s_nop 0
  buffer_load_dwordx4 v17, s[32:35], 0 offen lds
  s_add_u32 m0, s76, 2112
  s_mov_b32 exec_hi, 0xffff
  buffer_load_dwordx4 v18, s[32:35], 0 offen lds
  s_add_u32 m0, s76, 3168
  s_nop 0
  buffer_load_dwordx4 v19, s[32:35], 0 offen lds
  s_mov_b32 exec_hi, -1
  s_branch L_b1
L_g0pf:
  s_add_u32 m0, s95, 46080
  s_add_u32 s81, s95, 74400
  buffer_load_dwordx4 v47, s[36:39], s81 offen lds
  s_add_u32 m0, s95, 50176
  s_add_u32 s81, s95, 78496
  buffer_load_dwordx4 v47, s[36:39], s81 offen lds
  s_add_u32 m0, s95, 54272
  s_add_u32 s81, s95, 82592
  buffer_load_dwordx4 v47, s[36:39], s81 offen lds
  s_add_u32 m0, s95, 58368
  s_add_u32 s81, s95, 86688
  buffer_load_dwordx4 v47, s[36:39], s81 offen lds
  s_add_u32 m0, s95, 62464
  s_add_u32 s81, s95, 90784
  buffer_load_dwordx4 v47, s[36:39], s81 offen lds
  s_add_u32 m0, s95, 66560
  s_add_u32 s81, s95, 94880
  buffer_load_dwordx4 v47, s[36:39], s81 offen lds
  s_add_u32 m0, s95, 70656
  s_add_u32 s81, s95, 98976
  buffer_load_dwordx4 v47, s[36:39], s81 offen lds
  s_add_u32 m0, s96, 41984
  s_add_u32 s81, s96, 70304
  s_mov_b64 exec, s[82:83]
  buffer_load_dwordx4 v47, s[36:39], s81 offen lds
  s_mov_b64 exec, -1
  s_add_u32 m0, s95, 85312
  s_add_u32 s81, s95, 35152
  buffer_load_dwordx4 v47, s[36:39], s81 offen lds
  s_add_u32 m0, s95, 89408
  s_add_u32 s81, s95, 39248
  buffer_load_dwordx4 v47, s[36:39], s81 offen lds
  s_add_u32 m0, s95, 93504
  s_add_u32 s81, s95, 43344
  buffer_load_dwordx4 v47, s[36:39], s81 offen lds
  s_add_u32 m0, s95, 97600
  s_add_u32 s81, s95, 47440
  buffer_load_dwordx4 v47, s[36:39], s81 offen lds
  s_waitcnt vmcnt(4)
  ds_add_u32 v45, v48
  s_add_u32 m0, s95, 101696
  s_add_u32 s81, s95, 51536
  buffer_load_dwordx4 v47, s[36:39], s81 offen lds
  s_add_u32 m0, s95, 105792
  s_add_u32 s81, s95, 55632
  buffer_load_dwordx4 v47, s[36:39], s81 offen lds
  s_add_u32 m0, s95, 109888
  s_add_u32 s81, s95, 59728
  buffer_load_dwordx4 v47, s[36:39], s81 offen lds
  s_add_u32 m0, s95, 113984
  s_add_u32 s81, s95, 63824
  buffer_load_dwordx4 v47, s[36:39], s81 offen lds
  s_add_u32 m0, s96, 85312
  s_add_u32 s81, s96, 35152
  s_mov_b64 exec, s[82:83]
  buffer_load_dwordx4 v47, s[36:39], s81 offen lds
  s_mov_b64 exec, -1
  v_add_u32 v30, s95, v47
  v_add_u32 v30, 85312, v30
  v_add_u32 v31, s96, v47
  v_add_u32 v31, 85312, v31
  v_cndmask_b32 v31, v30, v31, s[82:83]
  v_mov_b32 v247, 0
  v_mov_b32 v246, 0
  s_add_u32 m0, s95, 6144
  s_add_u32 s81, s95, 0
  buffer_load_dwordx4 v47, s[36:39], s81 offen lds
  s_add_u32 m0, s95, 10240
  s_add_u32 s81, s95, 4096
  buffer_load_dwordx4 v47, s[36:39], s81 offen lds
  s_add_u32 m0, s95, 14336
  s_add_u32 s81, s95, 8192
  buffer_load_dwordx4 v47, s[36:39], s81 offen lds
  s_waitcnt vmcnt(9)
  ds_read_b128 v[60:63], v30 offset:0
  ds_read_b128 v[64:67], v30 offset:4096
  ds_read_b128 v[68:71], v30 offset:8192
  s_add_u32 m0, s95, 18432
  s_add_u32 s81, s95, 12288
  buffer_load_dwordx4 v47, s[36:39], s81 offen lds
  s_add_u32 m0, s95, 22528
  s_add_u32 s81, s95, 16384
  buffer_load_dwordx4 v47, s[36:39], s81 offen lds
  s_add_u32 m0, s95, 26624
  s_add_u32 s81, s95, 20480
  buffer_load_dwordx4 v47, s[36:39], s81 offen lds
  s_waitcnt vmcnt(9)
  ds_read_b128 v[72:75], v30 offset:12288
  ds_read_b128 v[76:79], v30 offset:16384
  ds_read_b128 v[80:83], v30 offset:20480
  s_waitcnt lgkmcnt(5)
  v_pk_maximum3_f16 v247, v247, v60, v61
  v_pk_minimum3_f16 v246, v246, v60, v61
  v_pk_maximum3_f16 v247, v247, v62, v63
  v_pk_minimum3_f16 v246, v246, v62, v63
  s_waitcnt lgkmcnt(4)
  v_pk_maximum3_f16 v247, v247, v64, v65
  v_pk_minimum3_f16 v246, v246, v64, v65
  v_pk_maximum3_f16 v247, v247, v66, v67
  v_pk_minimum3_f16 v246, v246, v66, v67
  s_waitcnt lgkmcnt(3)
  v_pk_maximum3_f16 v247, v247, v68, v69
  v_pk_minimum3_f16 v246, v246, v68, v69
  v_pk_maximum3_f16 v247, v247, v70, v71
  v_pk_minimum3_f16 v246, v246, v70, v71
  s_add_u32 m0, s95, 30720
  s_add_u32 s81, s95, 24576
  buffer_load_dwordx4 v47, s[36:39], s81 offen lds
  s_add_u32 m0, s95, 34816
  s_add_u32 s81, s95, 28672
  buffer_load_dwordx4 v47, s[36:39], s81 offen lds
  s_add_u32 m0, s96, 6144
  s_add_u32 s81, s96, 0
  s_mov_b64 exec, s[82:83]
  buffer_load_dwordx4 v47, s[36:39], s81 offen lds
  s_mov_b64 exec, -1
  s_waitcnt vmcnt(9)
  ds_read_b128 v[84:87], v30 offset:24576
  ds_read_b128 v[88:91], v30 offset:28672
  ds_read_b128 v[92:95], v31
  s_waitcnt lgkmcnt(5)
  v_pk_maximum3_f16 v247, v247, v72, v73
  v_pk_minimum3_f16 v246, v246, v72, v73
  v_pk_maximum3_f16 v247, v247, v74, v75
  v_pk_minimum3_f16 v246, v246, v74, v75
  s_waitcnt lgkmcnt(4)
  v_pk_maximum3_f16 v247, v247, v76, v77
  v_pk_minimum3_f16 v246, v246, v76, v77
  v_pk_maximum3_f16 v247, v247, v78, v79
  v_pk_minimum3_f16 v246, v246, v78, v79
  s_waitcnt lgkmcnt(3)
  v_pk_maximum3_f16 v247, v247, v80, v81
  v_pk_minimum3_f16 v246, v246, v80, v81
  v_pk_maximum3_f16 v247, v247, v82, v83
  v_pk_minimum3_f16 v246, v246, v82, v83
  s_waitcnt lgkmcnt(2)
  v_pk_maximum3_f16 v247, v247, v84, v85
  v_pk_minimum3_f16 v246, v246, v84, v85
  v_pk_maximum3_f16 v247, v247, v86, v87
  v_pk_minimum3_f16 v246, v246, v86, v87
  s_waitcnt lgkmcnt(1)
  v_pk_maximum3_f16 v247, v247, v88, v89
  v_pk_minimum3_f16 v246, v246, v88, v89
  v_pk_maximum3_f16 v247, v247, v90, v91
  v_pk_minimum3_f16 v246, v246, v90, v91
  s_waitcnt lgkmcnt(0)
  v_pk_maximum3_f16 v247, v247, v92, v93
  v_pk_minimum3_f16 v246, v246, v92, v93
  v_pk_maximum3_f16 v247, v247, v94, v95
  v_pk_minimum3_f16 v246, v246, v94, v95
  v_and_b32 v246, 0x7fff7fff, v246
  v_and_b32 v247, 0x7fff7fff, v247
  v_pk_max_u16 v247, v247, v246
  v_lshlrev_b32 v30, 16, v247
  v_max_u32 v247, v247, v30
  s_nop 1
  v_max_u32_dpp v247, v247, v247 row_shr:1 row_mask:0xf bank_mask:0xf
  s_nop 1
  v_max_u32_dpp v247, v247, v247 row_shr:2 row_mask:0xf bank_mask:0xf
  s_nop 1
  v_max_u32_dpp v247, v247, v247 row_shr:4 row_mask:0xf bank_mask:0xf
  s_nop 1
  v_max_u32_dpp v247, v247, v247 row_shr:8 row_mask:0xf bank_mask:0xf
  s_nop 1
  v_max_u32_dpp v247, v247, v247 row_bcast:15 row_mask:0xa bank_mask:0xf
  s_nop 1
  v_max_u32_dpp v247, v247, v247 row_bcast:31 row_mask:0xc bank_mask:0xf
  s_mov_b32 exec_lo, 0
  s_mov_b32 exec_hi, 0x80000000
  ds_max_u32 v46, v247 offset:20
  s_mov_b64 exec, -1
  v_lshl_add_u32 v16, v16, 7, v8
  v_lshl_add_u32 v17, v17, 7, v8
  v_lshl_add_u32 v18, v18, 7, v8
  v_lshl_add_u32 v19, v19, 7, v8
  s_add_u32 m0, s76, 0
  s_mov_b32 exec_hi, 0xffffff
  buffer_load_dwordx4 v16, s[32:35], 0 offen lds
  s_add_u32 m0, s76, 1056
  s_nop 0
  buffer_load_dwordx4 v17, s[32:35], 0 offen lds
  s_add_u32 m0, s76, 2112
  s_mov_b32 exec_hi, 0xffff
  buffer_load_dwordx4 v18, s[32:35], 0 offen lds
  s_add_u32 m0, s76, 3168
  s_nop 0
  buffer_load_dwordx4 v19, s[32:35], 0 offen lds
  s_mov_b32 exec_hi, -1
  v_add_u32 v30, s95, v47
  v_add_u32 v30, 6144, v30
  v_add_u32 v31, s96, v47
  v_add_u32 v31, 6144, v31
  v_cndmask_b32 v31, v30, v31, s[82:83]
  v_mov_b32 v247, 0
  v_mov_b32 v246, 0
  s_waitcnt vmcnt(10)
  ds_read_b128 v[60:63], v30 offset:0
  ds_read_b128 v[64:67], v30 offset:4096
  ds_read_b128 v[68:71], v30 offset:8192
  s_waitcnt vmcnt(7)
  ds_read_b128 v[72:75], v30 offset:12288
  ds_read_b128 v[76:79], v30 offset:16384
  ds_read_b128 v[80:83], v30 offset:20480
  s_waitcnt lgkmcnt(5)
  v_pk_maximum3_f16 v247, v247, v60, v61
  v_pk_minimum3_f16 v246, v246, v60, v61
  v_pk_maximum3_f16 v247, v247, v62, v63
  v_pk_minimum3_f16 v246, v246, v62, v63
  s_waitcnt lgkmcnt(4)
  v_pk_maximum3_f16 v247, v247, v64, v65
  v_pk_minimum3_f16 v246, v246, v64, v65
  v_pk_maximum3_f16 v247, v247, v66, v67
  v_pk_minimum3_f16 v246, v246, v66, v67
  s_waitcnt lgkmcnt(3)
  v_pk_maximum3_f16 v247, v247, v68, v69
  v_pk_minimum3_f16 v246, v246, v68, v69
  v_pk_maximum3_f16 v247, v247, v70, v71
  v_pk_minimum3_f16 v246, v246, v70, v71
  s_waitcnt vmcnt(4)
  ds_read_b128 v[84:87], v30 offset:24576
  ds_read_b128 v[88:91], v30 offset:28672
  ds_read_b128 v[92:95], v31
  s_waitcnt lgkmcnt(5)
  v_pk_maximum3_f16 v247, v247, v72, v73
  v_pk_minimum3_f16 v246, v246, v72, v73
  v_pk_maximum3_f16 v247, v247, v74, v75
  v_pk_minimum3_f16 v246, v246, v74, v75
  s_waitcnt lgkmcnt(4)
  v_pk_maximum3_f16 v247, v247, v76, v77
  v_pk_minimum3_f16 v246, v246, v76, v77
  v_pk_maximum3_f16 v247, v247, v78, v79
  v_pk_minimum3_f16 v246, v246, v78, v79
  s_waitcnt lgkmcnt(3)
  v_pk_maximum3_f16 v247, v247, v80, v81
  v_pk_minimum3_f16 v246, v246, v80, v81
  v_pk_maximum3_f16 v247, v247, v82, v83
  v_pk_minimum3_f16 v246, v246, v82, v83
  s_waitcnt lgkmcnt(2)
  v_pk_maximum3_f16 v247, v247, v84, v85
  v_pk_minimum3_f16 v246, v246, v84, v85
  v_pk_maximum3_f16 v247, v247, v86, v87
  v_pk_minimum3_f16 v246, v246, v86, v87
  s_waitcnt lgkmcnt(1)
  v_pk_maximum3_f16 v247, v247, v88, v89
  v_pk_minimum3_f16 v246, v246, v88, v89
  v_pk_maximum3_f16 v247, v247, v90, v91
  v_pk_minimum3_f16 v246, v246, v90, v91
  s_waitcnt lgkmcnt(0)
  v_pk_maximum3_f16 v247, v247, v92, v93
  v_pk_minimum3_f16 v246, v246, v92, v93
  v_pk_maximum3_f16 v247, v247, v94, v95
  v_pk_minimum3_f16 v246, v246, v94, v95
  v_and_b32 v246, 0x7fff7fff, v246
  v_and_b32 v247, 0x7fff7fff, v247
  v_pk_max_u16 v247, v247, v246
  v_lshlrev_b32 v30, 16, v247
  v_max_u32 v247, v247, v30
  s_nop 1
  v_max_u32_dpp v247, v247, v247 row_shr:1 row_mask:0xf bank_mask:0xf
  s_nop 1
  v_max_u32_dpp v247, v247, v247 row_shr:2 row_mask:0xf bank_mask:0xf
  s_nop 1
  v_max_u32_dpp v247, v247, v247 row_shr:4 row_mask:0xf bank_mask:0xf
  s_nop 1
  v_max_u32_dpp v247, v247, v247 row_shr:8 row_mask:0xf bank_mask:0xf
  s_nop 1
  v_max_u32_dpp v247, v247, v247 row_bcast:15 row_mask:0xa bank_mask:0xf
  s_nop 1
  v_max_u32_dpp v247, v247, v247 row_bcast:31 row_mask:0xc bank_mask:0xf
  s_mov_b32 exec_lo, 0
  s_mov_b32 exec_hi, 0x80000000
  ds_max_u32 v46, v247 offset:16
  s_mov_b64 exec, -1
L_b1:
  s_waitcnt lgkmcnt(0)
  s_barrier
  ds_read_b128 v[108:111], v46 offset:16
  ds_read_b64_tr_b16 v[76:77], v57 offset:0
  ds_read_b64_tr_b16 v[78:79], v57 offset:5408
  ds_read_b64_tr_b16 v[80:81], v58 offset:0
  ds_read_b64_tr_b16 v[82:83], v59 offset:0
  ds_read_b64_tr_b16 v[84:85], v57 offset:64
  ds_read_b64_tr_b16 v[86:87], v57 offset:5472
  ds_read_b64_tr_b16 v[88:89], v58 offset:64
  ds_read_b64_tr_b16 v[90:91], v59 offset:64
  ds_read_b64_tr_b16 v[112:113], v56 offset:0
  ds_read_b64_tr_b16 v[114:115], v56 offset:256
  ds_read_b64_tr_b16 v[116:117], v56 offset:1024
  ds_read_b64_tr_b16 v[118:119], v56 offset:1280
  s_waitcnt lgkmcnt(12)
  v_lshrrev_b32 v108, 23, v108
  v_sub_u32 v108, 267, v108
  v_min_u32 v108, 167, v108
  s_nop 0
  v_readfirstlane_b32 s74, v108
  v_mul_u32_u24 v108, 0x800080, v108
  ds_read_b32 v60, v38 offset:0
  v_and_b32 v216, v216, v108
  ds_read_b32 v61, v38 offset:1352
  v_and_b32 v217, v217, v108
  ds_read_b32 v62, v38 offset:2704
  v_and_b32 v218, v218, v108
  ds_read_b32 v63, v38 offset:4056
  ds_read_b32 v64, v38 offset:5408
  v_and_b32 v219, v219, v108
  ds_read_b32 v65, v38 offset:6760
  v_and_b32 v220, v220, v108
  ds_read_b32 v66, v38 offset:8112
  v_and_b32 v221, v221, v108
  ds_read_b32 v67, v38 offset:9464
  ds_read_b32 v68, v38 offset:21632
  v_and_b32 v222, v222, v108
  ds_read_b32 v69, v38 offset:22984
  v_and_b32 v223, v223, v108
  ds_read_b32 v70, v39 offset:24336
  s_waitcnt lgkmcnt(14)
  v_mfma_f32_32x32x16_bf16 v[152:167], v[216:219], v[76:79], 0
  ds_read_b32 v71, v39 offset:25688
  ds_read_b32 v72, v39 offset:27040
  v_mfma_f32_32x32x16_bf16 v[152:167], v[220:223], v[80:83], v[152:167]
  ds_read_b32 v73, v39 offset:28392
  v_mfma_f32_32x32x16_bf16 v[168:183], v[216:219], v[84:87], 0
  ds_read_b32 v74, v39 offset:29744
  v_mfma_f32_32x32x16_bf16 v[168:183], v[220:223], v[88:91], v[168:183]
  ds_read_b32 v75, v39 offset:31096
  s_cmp_lt_u32 s3, 3
  s_cbranch_scc1 L_u0
  ds_read_b32 v92, v38 offset:20
  ds_read_b32 v93, v38 offset:1372
  ds_read_b32 v94, v38 offset:2724
  ds_read_b32 v95, v38 offset:4076
  ds_read_b32 v96, v38 offset:5428
  ds_read_b32 v97, v38 offset:6780
  ds_read_b32 v98, v38 offset:8132
  ds_read_b32 v99, v38 offset:9484
  ds_read_b32 v100, v38 offset:21652
  ds_read_b32 v101, v38 offset:23004
  ds_read_b32 v102, v39 offset:24356
  ds_read_b32 v103, v39 offset:25708
  ds_read_b32 v104, v39 offset:27060
  ds_read_b32 v105, v39 offset:28412
  ds_read_b32 v106, v39 offset:29764
  ds_read_b32 v107, v39 offset:31116
  s_branch L_u1
L_u0:
  ds_read_b64_tr_b16 v[92:93], v57 offset:1024
  ds_read_b64_tr_b16 v[94:95], v57 offset:6432
  ds_read_b64_tr_b16 v[96:97], v58 offset:1024
  ds_read_b64_tr_b16 v[98:99], v59 offset:1024
  ds_read_b64_tr_b16 v[100:101], v57 offset:1088
  ds_read_b64_tr_b16 v[102:103], v57 offset:6496
  ds_read_b64_tr_b16 v[104:105], v58 offset:1088
  ds_read_b64_tr_b16 v[106:107], v59 offset:1088
L_u1:
  v_lshrrev_b32 v109, 23, v109
  v_lshrrev_b32 v110, 23, v110
  v_lshrrev_b32 v111, 23, v111
  v_cmp_eq_u32 vcc, 26, v29
  s_nop 1
  v_cndmask_b32 v54, v110, v111, vcc
  v_add_u32 v54, v54, v109
  v_sub_u32 v54, 388, v54
  s_movk_i32 s98, 167
  v_med3_i32 v54, v54, 1, s98
  v_subrev_u32 v110, 127, v54
  v_lshlrev_b32 v54, 23, v54
  v_cmp_gt_i32 vcc, 0, v110
  s_mov_b32 s99, 0x05040100
  s_mov_b32 s100, 0x07060302
  v_mul_u32_u24 v110, 0x800080, v110
  s_cbranch_vccnz L_sdown
  v_add_u32 v112, v112, v110
  v_add_u32 v113, v113, v110
  s_waitcnt lgkmcnt(14)
  v_add_u32 v114, v114, v110
  v_add_u32 v115, v115, v110
  v_add_u32 v116, v116, v110
  v_add_u32 v117, v117, v110
  v_add_u32 v118, v118, v110
  v_add_u32 v119, v119, v110
L_scaled:
  v_perm_b32 v184, v61, v60, s99
  v_perm_b32 v185, v63, v62, s99
  v_perm_b32 v186, v65, v64, s99
  v_perm_b32 v187, v67, v66, s99
  v_perm_b32 v188, v69, v68, s99
  s_waitcnt lgkmcnt(12)
  v_perm_b32 v189, v71, v70, s99
  s_waitcnt lgkmcnt(10)
  v_perm_b32 v190, v73, v72, s99
  s_waitcnt lgkmcnt(8)
  v_perm_b32 v191, v75, v74, s99
  v_mfma_f32_32x32x16_bf16 v[120:135], v[184:187], v[112:115], 0
  s_nop 0
  v_mfma_f32_32x32x16_bf16 v[120:135], v[188:191], v[116:119], v[120:135]
  v_perm_b32 v192, v61, v60, s100
  v_perm_b32 v193, v63, v62, s100
  v_perm_b32 v194, v65, v64, s100
  v_perm_b32 v195, v67, v66, s100
  v_perm_b32 v196, v69, v68, s100
  v_perm_b32 v197, v71, v70, s100
  v_perm_b32 v198, v73, v72, s100
  v_perm_b32 v199, v75, v74, s100
  v_mfma_f32_32x32x16_bf16 v[136:151], v[192:195], v[112:115], 0
  s_nop 0
  v_mfma_f32_32x32x16_bf16 v[136:151], v[196:199], v[116:119], v[136:151]
  s_waitcnt lgkmcnt(0)
  s_barrier
  s_cmp_lt_u32 s3, 3
  s_cbranch_scc1 L_u2
  v_perm_b32 v60, v93, v92, s99
  v_perm_b32 v61, v95, v94, s99
  v_perm_b32 v62, v97, v96, s99
  v_perm_b32 v63, v99, v98, s99
  v_perm_b32 v64, v101, v100, s99
  v_perm_b32 v65, v103, v102, s99
  v_perm_b32 v66, v105, v104, s99
  v_perm_b32 v67, v107, v106, s99
  v_mfma_f32_32x32x16_bf16 v[184:199], v[60:63], v[112:115], 0
  s_nop 0
  v_mfma_f32_32x32x16_bf16 v[184:199], v[64:67], v[116:119], v[184:199]
  v_perm_b32 v68, v93, v92, s100
  v_perm_b32 v69, v95, v94, s100
  v_perm_b32 v70, v97, v96, s100
  v_perm_b32 v71, v99, v98, s100
  v_perm_b32 v72, v101, v100, s100
  v_perm_b32 v73, v103, v102, s100
  v_perm_b32 v74, v105, v104, s100
  v_perm_b32 v75, v107, v106, s100
  v_mfma_f32_32x32x16_bf16 v[200:215], v[68:71], v[112:115], 0
  s_nop 0
  v_mfma_f32_32x32x16_bf16 v[200:215], v[72:75], v[116:119], v[200:215]
  s_branch L_u3
L_u2:
  v_mfma_f32_32x32x16_bf16 v[184:199], v[216:219], v[92:95], 0
  v_mfma_f32_32x32x16_bf16 v[184:199], v[220:223], v[96:99], v[184:199]
  v_mfma_f32_32x32x16_bf16 v[200:215], v[216:219], v[100:103], 0
  v_mfma_f32_32x32x16_bf16 v[200:215], v[220:223], v[104:107], v[200:215]
L_u3:
  v_cvt_pk_f16_f32 v76, v152, v153
  v_cvt_pk_f16_f32 v77, v154, v155
  v_cvt_pk_f16_f32 v78, v156, v157
  v_cvt_pk_f16_f32 v79, v158, v159
  ds_write_b128 v43, v[76:79]
  v_xor_b32 v43, 16, v43
  v_cvt_pk_f16_f32 v80, v160, v161
  v_cvt_pk_f16_f32 v81, v162, v163
  v_cvt_pk_f16_f32 v82, v164, v165
  v_cvt_pk_f16_f32 v83, v166, v167
  ds_write_b128 v43, v[80:83]
  v_cvt_pk_f16_f32 v84, v168, v169
  v_cvt_pk_f16_f32 v85, v170, v171
  v_cvt_pk_f16_f32 v86, v172, v173
  v_cvt_pk_f16_f32 v87, v174, v175
  ds_write_b128 v44, v[84:87]
  v_xor_b32 v44, 16, v44
  v_cvt_pk_f16_f32 v88, v176, v177
  v_cvt_pk_f16_f32 v89, v178, v179
  v_cvt_pk_f16_f32 v90, v180, v181
  v_cvt_pk_f16_f32 v91, v182, v183
  ds_write_b128 v44, v[88:91]
  v_cvt_pk_f16_f32 v60, v120, v121
  v_cvt_pk_f16_f32 v61, v122, v123
  v_cvt_pk_f16_f32 v62, v124, v125
  v_cvt_pk_f16_f32 v63, v126, v127
  ds_write_b128 v41, v[60:63]
  v_xor_b32 v41, 16, v41
  v_cvt_pk_f16_f32 v64, v128, v129
  v_cvt_pk_f16_f32 v65, v130, v131
  v_cvt_pk_f16_f32 v66, v132, v133
  v_cvt_pk_f16_f32 v67, v134, v135
  ds_write_b128 v41, v[64:67]
  v_cvt_pk_f16_f32 v68, v136, v137
  v_cvt_pk_f16_f32 v69, v138, v139
  v_cvt_pk_f16_f32 v70, v140, v141
  v_cvt_pk_f16_f32 v71, v142, v143
  ds_write_b128 v42, v[68:71]
  v_xor_b32 v42, 16, v42
  v_cvt_pk_f16_f32 v72, v144, v145
  v_cvt_pk_f16_f32 v73, v146, v147
  v_cvt_pk_f16_f32 v74, v148, v149
  v_cvt_pk_f16_f32 v75, v150, v151
  ds_write_b128 v42, v[72:75]
  v_cvt_pk_f16_f32 v92, v184, v185
  v_cvt_pk_f16_f32 v93, v186, v187
  v_cvt_pk_f16_f32 v94, v188, v189
  v_cvt_pk_f16_f32 v95, v190, v191
  ds_write_b128 v50, v[92:95]
  v_xor_b32 v50, 16, v50
  v_cvt_pk_f16_f32 v96, v192, v193
  v_cvt_pk_f16_f32 v97, v194, v195
  v_cvt_pk_f16_f32 v98, v196, v197
  v_cvt_pk_f16_f32 v99, v198, v199
  ds_write_b128 v50, v[96:99]
  v_cvt_pk_f16_f32 v100, v200, v201
  v_cvt_pk_f16_f32 v101, v202, v203
  v_cvt_pk_f16_f32 v102, v204, v205
  v_cvt_pk_f16_f32 v103, v206, v207
  ds_write_b128 v51, v[100:103]
  v_xor_b32 v51, 16, v51
  v_cvt_pk_f16_f32 v104, v208, v209
  v_cvt_pk_f16_f32 v105, v210, v211
  v_cvt_pk_f16_f32 v106, v212, v213
  v_cvt_pk_f16_f32 v107, v214, v215
  ds_write_b128 v51, v[104:107]
  v_readlane_b32 s0, v54, 0
  v_readlane_b32 s1, v54, 26
  s_sub_u32 s75, 0x7f000000, s0
  s_sub_u32 s1, 0x7f000000, s1
  s_sub_u32 s74, 254, s74
  s_lshl_b32 s74, s74, 23
  s_mov_b32 s92, 0x88888888
  s_mov_b32 s93, 0x88888888
  buffer_load_dwordx4 v[16:19], v6, s[28:31], s94 offen
  s_add_u32 s94, s94, 832
  s_waitcnt vmcnt(5)
  v_lshlrev_b32 v13, 7, v13
  buffer_load_dword v15, v13, s[32:35], 0 offen
  buffer_load_dword v13, v12, s[28:31], s77 offen
  s_cmp_eq_u32 s77, s73
  s_cselect_b32 s73, 0x7000000, s73
  s_cselect_b32 s77, 0x7000000, s77
  s_add_u32 s77, s77, 24
  s_min_u32 s77, s77, s73
  s_waitcnt lgkmcnt(0)
  s_barrier
  ds_read_b64_tr_b16 v[60:61], v224 offset:0
  ds_read_b64_tr_b16 v[62:63], v225 offset:0
  ds_read_b64_tr_b16 v[64:65], v236 offset:0
  ds_read_b64_tr_b16 v[66:67], v237 offset:0
  ds_read_b64_tr_b16 v[68:69], v224 offset:43328
  ds_read_b64_tr_b16 v[70:71], v225 offset:43328
  ds_read_b64_tr_b16 v[72:73], v236 offset:43328
  ds_read_b64_tr_b16 v[74:75], v237 offset:43328
  ds_read_b64_tr_b16 v[76:77], v226 offset:0
  ds_read_b64_tr_b16 v[78:79], v227 offset:0
  ds_read_b64_tr_b16 v[80:81], v238 offset:0
  ds_read_b64_tr_b16 v[82:83], v239 offset:0
  ds_read_b64_tr_b16 v[84:85], v226 offset:43328
  ds_read_b64_tr_b16 v[86:87], v227 offset:43328
  ds_read_b64_tr_b16 v[88:89], v238 offset:43328
  ds_read_b64_tr_b16 v[90:91], v239 offset:43328
  s_cmp_ge_u32 s3, 6
  s_cbranch_scc1 L_lin
  ds_read_b64_tr_b16 v[92:93], v228 offset:0
  ds_read_b64_tr_b16 v[94:95], v229 offset:0
  ds_read_b64_tr_b16 v[96:97], v240 offset:0
  ds_read_b64_tr_b16 v[98:99], v241 offset:0
  ds_read_b64_tr_b16 v[100:101], v228 offset:43328
  ds_read_b64_tr_b16 v[102:103], v229 offset:43328
  ds_read_b64_tr_b16 v[104:105], v240 offset:43328
  ds_read_b64_tr_b16 v[106:107], v241 offset:43328
  s_waitcnt lgkmcnt(6)
  v_pk_add_f16 v92, v92, v94
  v_pk_add_f16 v93, v93, v95
  ds_write_b64 v40, v[92:93] offset:30720
  s_waitcnt lgkmcnt(5)
  v_pk_add_f16 v96, v96, v98
  v_pk_add_f16 v97, v97, v99
  s_waitcnt lgkmcnt(3)
  v_pk_add_f16 v100, v100, v102
  v_pk_add_f16 v101, v101, v103
  ds_write_b64 v40, v[100:101] offset:32768
  s_waitcnt lgkmcnt(2)
  v_pk_add_f16 v104, v104, v106
  v_pk_add_f16 v105, v105, v107
  v_cndmask_b32 v96, v96, v104, s[92:93]
  v_cndmask_b32 v97, v97, v105, s[92:93]
  ds_write_b64 v40, v[96:97] offset:31744
  ds_write_b32 v230, v104 offset:3072
  ds_write_b32 v230, v105 offset:3088
  s_branch L_p2
L_lin:
  ds_read_b64_tr_b16 v[92:93], v55
  ds_read_b64_tr_b16 v[94:95], v245
  ds_read_u16_d16_hi v232, v53
  s_and_b32 s98, s3, 1
  s_lshl_b32 s98, s98, 10
  v_add_u32 v30, s98, v47
  s_waitcnt lgkmcnt(2)
  v_cvt_f32_f16 v96, v92
  v_cvt_f32_f16_sdwa v97, v92 dst_sel:DWORD dst_unused:UNUSED_PAD src0_sel:WORD_1
  v_mul_f32 v96, s1, v96
  v_mul_f32 v97, s1, v97
  v_mul_f32 v96, s0, v96
  v_mul_f32 v97, s0, v97
  v_cvt_pk_bf16_f32 v92, v96, v97
  v_cvt_f32_f16 v98, v93
  v_cvt_f32_f16_sdwa v99, v93 dst_sel:DWORD dst_unused:UNUSED_PAD src0_sel:WORD_1
  v_mul_f32 v98, s1, v98
  v_mul_f32 v99, s1, v99
  v_mul_f32 v98, s0, v98
  v_mul_f32 v99, s0, v99
  v_cvt_pk_bf16_f32 v93, v98, v99
  s_waitcnt lgkmcnt(1)
  v_cvt_f32_f16 v100, v94
  v_cvt_f32_f16_sdwa v101, v94 dst_sel:DWORD dst_unused:UNUSED_PAD src0_sel:WORD_1
  v_mul_f32 v100, s1, v100
  v_mul_f32 v101, s1, v101
  v_mul_f32 v100, s0, v100
  v_mul_f32 v101, s0, v101
  v_cvt_pk_bf16_f32 v94, v100, v101
  v_cvt_f32_f16 v102, v95
  v_cvt_f32_f16_sdwa v103, v95 dst_sel:DWORD dst_unused:UNUSED_PAD src0_sel:WORD_1
  v_mul_f32 v102, s1, v102
  v_mul_f32 v103, s1, v103
  s_mov_b32 exec_lo, 0
  s_mov_b32 exec_hi, 0xffff
  s_waitcnt lgkmcnt(0)
  v_mov_b32 v102, v232
  s_mov_b64 exec, -1
  v_mul_f32 v102, s0, v102
  v_mul_f32 v103, s0, v103
  v_cvt_pk_bf16_f32 v95, v102, v103
  ds_write_b128 v30, v[92:95] offset:39936
L_p2:
  v_pk_add_f16 v76, v76, v78
  v_pk_add_f16 v77, v77, v79
  ds_write_b64 v40, v[76:77] offset:18432
  v_pk_add_f16 v80, v80, v82
  v_pk_add_f16 v81, v81, v83
  v_pk_add_f16 v84, v84, v86
  v_pk_add_f16 v85, v85, v87
  ds_write_b64 v40, v[84:85] offset:20480
  v_pk_add_f16 v88, v88, v90
  v_pk_add_f16 v89, v89, v91
  v_cndmask_b32 v80, v80, v88, s[92:93]
  v_cndmask_b32 v81, v81, v89, s[92:93]
  ds_write_b64 v40, v[80:81] offset:19456
  ds_write_b32 v230, v88 offset:1024
  ds_write_b32 v230, v89 offset:1040
  v_pk_add_f16 v60, v60, v62
  v_pk_add_f16 v61, v61, v63
  ds_write_b64 v40, v[60:61] offset:6144
  v_pk_add_f16 v64, v64, v66
  v_pk_add_f16 v65, v65, v67
  v_pk_add_f16 v68, v68, v70
  v_pk_add_f16 v69, v69, v71
  ds_write_b64 v40, v[68:69] offset:8192
  v_pk_add_f16 v72, v72, v74
  v_pk_add_f16 v73, v73, v75
  v_cndmask_b32 v64, v64, v72, s[92:93]
  v_cndmask_b32 v65, v65, v73, s[92:93]
  ds_write_b64 v40, v[64:65] offset:7168
  s_cmp_lt_u32 s3, 2
  s_cbranch_scc1 L_p2d
  v_subrev_u32 v230, 1024, v230
  ds_write_b32 v230, v72 offset:0
  ds_write_b32 v230, v73 offset:16
  s_branch L_built
L_p2d:
  ds_write_b64 v231, v[72:73] offset:5120
L_built:
  s_mov_b32 s0, s74
  s_mov_b32 s1, s75
  s_mov_b32 s96, 0x3e000000
  s_mov_b32 s97, 0x43000000
  v_mov_b64 v[32:33], 0
  v_mov_b64 v[34:35], 0
  v_mov_b64 v[36:37], 0
  v_mov_b64 v[38:39], 0
  v_mov_b64 v[40:41], 0
  v_mov_b64 v[42:43], 0
  v_mov_b64 v[44:45], 0
  v_mov_b64 v[46:47], 0
  v_mov_b64 v[48:49], 0
  v_mov_b64 v[50:51], 0
  v_mov_b64 v[52:53], 0
  v_mov_b64 v[54:55], 0
  v_mov_b64 v[56:57], 0
  s_waitcnt vmcnt(3)
  ds_read_u16_d16_hi v32, v2 offset:0
  ds_read_u16_d16_hi v33, v2 offset:2
  ds_read_u16_d16_hi v34, v2 offset:2112
  ds_read_u16_d16_hi v35, v2 offset:2114
  ds_read_u16_d16_hi v36, v2 offset:128
  ds_read_u16_d16_hi v37, v2 offset:130
  ds_read_u16_d16_hi v38, v2 offset:2240
  ds_read_u16_d16_hi v39, v2 offset:2242
  ds_read_u16_d16_hi v40, v2 offset:256
  ds_read_u16_d16_hi v41, v2 offset:258
  ds_read_u16_d16_hi v42, v2 offset:2368
  ds_read_u16_d16_hi v43, v2 offset:2370
  ds_read_u16_d16_hi v44, v2 offset:384
  ds_read_u16_d16_hi v45, v2 offset:386
  ds_read_u16_d16_hi v46, v2 offset:2496
  ds_read_u16_d16_hi v47, v2 offset:2498
  ds_read_u16_d16_hi v48, v2 offset:512
  ds_read_u16_d16_hi v49, v2 offset:514
  ds_read_u16_d16_hi v50, v2 offset:2624
  ds_read_u16_d16_hi v51, v2 offset:2626
  ds_read_u16_d16_hi v52, v2 offset:640
  ds_read_u16_d16_hi v53, v2 offset:642
  ds_read_u16_d16_hi v54, v2 offset:2752
  ds_read_u16_d16_hi v55, v2 offset:2754
  ds_read_u16_d16_hi v56, v2 offset:768
  ds_read_u16_d16_hi v57, v2 offset:770
  s_waitcnt lgkmcnt(14)
  v_max3_f32 v58, |v32|, |v33|, 0
  v_max3_f32 v58, |v34|, |v35|, v58
  v_max3_f32 v58, |v36|, |v37|, v58
  v_max3_f32 v58, |v38|, |v39|, v58
  v_max3_f32 v58, |v40|, |v41|, v58
  v_max3_f32 v58, |v42|, |v43|, v58
  s_waitcnt lgkmcnt(12)
  v_max3_f32 v58, |v44|, |v45|, v58
  s_waitcnt lgkmcnt(10)
  v_max3_f32 v58, |v46|, |v47|, v58
  s_waitcnt lgkmcnt(8)
  v_max3_f32 v58, |v48|, |v49|, v58
  s_waitcnt lgkmcnt(6)
  v_max3_f32 v58, |v50|, |v51|, v58
  s_waitcnt lgkmcnt(4)
  v_max3_f32 v58, |v52|, |v53|, v58
  s_waitcnt lgkmcnt(2)
  v_max3_f32 v58, |v54|, |v55|, v58
  s_waitcnt lgkmcnt(0)
  v_max3_f32 v58, |v56|, |v57|, v58
  v_add_u32 v59, -46912, v2
  s_add_u32 s76, s76, -46912
  s_waitcnt lgkmcnt(0)
  s_barrier
  v_cvt_pk_f16_f32 v28, v32, v33
  ds_write_b32 v3, v28 offset:0
  v_cvt_pk_f16_f32 v29, v34, v35
  ds_write_b32 v3, v29 offset:160
  v_cvt_pk_f16_f32 v30, v36, v37
  ds_write_b32 v3, v30 offset:320
  v_cvt_pk_f16_f32 v31, v38, v39
  ds_write_b32 v3, v31 offset:480
  v_cvt_pk_f16_f32 v28, v40, v41
  ds_write_b32 v3, v28 offset:640
  v_cvt_pk_f16_f32 v29, v42, v43
  ds_write_b32 v3, v29 offset:800
  v_cvt_pk_f16_f32 v30, v44, v45
  ds_write_b32 v3, v30 offset:960
  v_cvt_pk_f16_f32 v31, v46, v47
  ds_write_b32 v3, v31 offset:1120
  v_cvt_pk_f16_f32 v28, v48, v49
  ds_write_b32 v3, v28 offset:1280
  v_cvt_pk_f16_f32 v29, v50, v51
  ds_write_b32 v3, v29 offset:1440
  v_cvt_pk_f16_f32 v30, v52, v53
  ds_write_b32 v3, v30 offset:1600
  v_cvt_pk_f16_f32 v31, v54, v55
  ds_write_b32 v3, v31 offset:1760
  v_cvt_pk_f16_f32 v28, v56, v57
  ds_write_b32 v3, v28 offset:1920
  ds_write_b32 v59, v7 offset:2880
  s_cmp_lg_u32 s3, 0
  s_cbranch_scc1 L_cin_go
  s_mov_b32 s60, s24
  s_and_b32 s61, s25, 0xffff
  s_mov_b32 s62, 268435456
  s_mov_b32 s63, 0x20000
  s_mov_b32 s56, s20
  s_and_b32 s57, s21, 0xffff
  s_mov_b32 s58, 8192
  s_mov_b32 s59, 0x20000
  s_mov_b32 s64, s22
  s_and_b32 s65, s23, 0xffff
  s_mov_b32 s66, 256
  s_mov_b32 s67, 0x20000
  s_load_dword s80, s[18:19], 0
  v_mov_b32 v248, 0
  s_mov_b64 exec, 1
  s_mov_b32 s81, 0x80000
  buffer_load_dword v249, v248, s[60:63], s81 offen
  buffer_load_dword v250, v248, s[56:59], 0 offen
  s_mov_b64 exec, -1
  s_mov_b64 exec, 1
  buffer_load_dword v59, v248, s[64:67], 0 offen offset:240 sc1
  s_mov_b64 exec, -1
  s_mov_b32 s52, s16
  s_and_b32 s53, s17, 0xffff
  s_mov_b32 s54, 3328
  s_mov_b32 s55, 0x20000
  v_lshlrev_b32 v248, 7, v0
  buffer_load_dword v251, v248, s[52:55], 0 offen
L_cin_go:
  s_mov_b32 s81, -46912
  s_mul_i32 s98, s3, 1536
  s_add_u32 s98, s98, 1165312
  v_lshlrev_b32 v7, 2, v0
  v_add_u32 v7, s98, v7
  s_mov_b32 s48, -1048576
L_cin_loop:
  v_cmp_le_f32 s[90:91], s97, v58
  v_cmp_le_f32 vcc, s96, v58
  s_mov_b32 s49, s74
  s_mov_b32 s50, s75
  s_cmp_lg_u64 s[90:91], 0
  s_cbranch_scc1 L_cslow
  s_cbranch_vccz L_cslow
L_cconv:
  ds_read_b64_tr_b16 v[60:61], v20 offset:0
  v_mul_f32 v116, v184, v192
  v_mul_f32 v117, v185, v193
  ds_read_b64_tr_b16 v[74:75], v20 offset:32
  v_mul_f32 v118, v186, v194
  ds_read_b64_tr_b16 v[88:89], v20 offset:64
  v_mul_f32 v119, v187, v195
  ds_read_b64_tr_b16 v[102:103], v20 offset:96
  v_fmac_f32 v116, v188, v191
  ds_read_b64_tr_b16 v[66:67], v23 offset:0
  v_fmac_f32 v117, v200, v208
  ds_read_b64_tr_b16 v[80:81], v23 offset:32
  v_fmac_f32 v118, v201, v209
  ds_read_b64_tr_b16 v[94:95], v23 offset:64
  v_fmac_f32 v119, v202, v210
  ds_read_b64_tr_b16 v[108:109], v23 offset:96
  v_fmac_f32 v116, v203, v211
  ds_read_b64_tr_b16 v[68:69], v24 offset:0
  v_fmac_f32 v117, v204, v207
  ds_read_b64_tr_b16 v[82:83], v24 offset:32
  v_fmac_f32 v118, v216, v224
  ds_read_b64_tr_b16 v[96:97], v24 offset:64
  v_fmac_f32 v119, v217, v225
  v_fmac_f32 v116, v218, v226
  ds_read_b64_tr_b16 v[110:111], v24 offset:96
  v_fmac_f32 v117, v219, v227
  ds_read_b64_tr_b16 v[124:125], v4 offset:0
  v_fmac_f32 v118, v220, v223
  ds_read_b64_tr_b16 v[126:127], v5 offset:0
  v_fmac_f32 v119, v232, v240
  ds_read_b64_tr_b16 v[136:137], v4 offset:32
  v_fmac_f32 v116, v233, v241
  ds_read_b64_tr_b16 v[138:139], v5 offset:32
  v_fmac_f32 v117, v234, v242
  ds_read_b64_tr_b16 v[148:149], v4 offset:64
  v_fmac_f32 v118, v235, v243
  ds_read_b64_tr_b16 v[150:151], v5 offset:64
  v_fmac_f32 v119, v236, v239
  ds_read_b64_tr_b16 v[160:161], v4 offset:96
  v_fmac_f32 v116, v189, v196
  ds_read_b64_tr_b16 v[162:163], v5 offset:96
  v_fmac_f32 v117, v189, v197
  ds_read_b128 v[164:167], v1 offset:39936
  v_fmac_f32 v118, v190, v198
  v_fmac_f32 v119, v190, v199
  ds_read_b128 v[168:171], v1 offset:40960
  v_fmac_f32 v116, v205, v212
  ds_read_b128 v[172:175], v1 offset:8192
  v_fmac_f32 v117, v205, v213
  ds_read_b128 v[176:179], v1 offset:6144
  v_fmac_f32 v118, v206, v214
  ds_read_b64_tr_b16 v[70:71], v25 offset:0
  v_fmac_f32 v119, v206, v215
  ds_read_b64_tr_b16 v[84:85], v25 offset:32
  v_fmac_f32 v116, v221, v228
  ds_read_b64_tr_b16 v[98:99], v25 offset:64
  v_fmac_f32 v117, v221, v229
  ds_read_b64_tr_b16 v[112:113], v25 offset:96
  v_fmac_f32 v118, v222, v230
  ds_read_b64_tr_b16 v[72:73], v26 offset:0
  v_fmac_f32 v119, v222, v231
  ds_read_b64_tr_b16 v[86:87], v26 offset:32
  v_fmac_f32 v116, v237, v244
  ds_read_b64_tr_b16 v[100:101], v26 offset:64
  v_fmac_f32 v117, v237, v245
  v_fmac_f32 v118, v238, v246
  ds_read_b64_tr_b16 v[114:115], v26 offset:96
  v_fmac_f32 v119, v238, v247
  ds_read_b64_tr_b16 v[62:63], v21 offset:0
  v_add_f32 v116, v116, v117
  ds_read_b64_tr_b16 v[76:77], v21 offset:32
  v_add_f32 v118, v118, v119
  ds_read_b64_tr_b16 v[90:91], v21 offset:64
  v_add_f32 v116, v116, v118
  ds_read_b64_tr_b16 v[104:105], v21 offset:96
  v_mul_f32 v116, s49, v116
  ds_read_b64_tr_b16 v[64:65], v22 offset:0
  v_mul_f32 v116, s50, v116
  ds_read_b64_tr_b16 v[78:79], v22 offset:32
  ds_write_b32 v7, v116
  ds_read_b64_tr_b16 v[92:93], v22 offset:64
  v_add_u32 v7, s48, v7
  ds_read_b64_tr_b16 v[106:107], v22 offset:96
  s_movk_i32 s48, 256
  s_waitcnt lgkmcnt(0)
  v_pk_mul_f16 v120, v60, v67 op_sel:[0,0] op_sel_hi:[0,1]
  v_pk_mul_f16 v121, v60, v67 op_sel:[1,0] op_sel_hi:[1,1]
  v_pk_mul_f16 v122, v60, v68 op_sel:[0,0] op_sel_hi:[0,1]
  v_pk_mul_f16 v123, v60, v68 op_sel:[1,0] op_sel_hi:[1,1]
  v_pk_mul_f16 v132, v74, v81 op_sel:[0,0] op_sel_hi:[0,1]
  v_pk_mul_f16 v133, v74, v81 op_sel:[1,0] op_sel_hi:[1,1]
  v_pk_mul_f16 v134, v74, v82 op_sel:[0,0] op_sel_hi:[0,1]
  v_pk_mul_f16 v135, v74, v82 op_sel:[1,0] op_sel_hi:[1,1]
  v_pk_mul_f16 v144, v88, v95 op_sel:[0,0] op_sel_hi:[0,1]
  v_pk_mul_f16 v145, v88, v95 op_sel:[1,0] op_sel_hi:[1,1]
  v_pk_mul_f16 v146, v88, v96 op_sel:[0,0] op_sel_hi:[0,1]
  v_pk_mul_f16 v147, v88, v96 op_sel:[1,0] op_sel_hi:[1,1]
  v_pk_mul_f16 v156, v102, v109 op_sel:[0,0] op_sel_hi:[0,1]
  v_pk_mul_f16 v157, v102, v109 op_sel:[1,0] op_sel_hi:[1,1]
  v_pk_mul_f16 v158, v102, v110 op_sel:[0,0] op_sel_hi:[0,1]
  v_pk_mul_f16 v159, v102, v110 op_sel:[1,0] op_sel_hi:[1,1]
  s_waitcnt vmcnt(2)
  v_lshl_add_u32 v16, v16, 7, v8
  v_lshl_add_u32 v17, v17, 7, v8
  v_lshl_add_u32 v18, v18, 7, v8
  v_lshl_add_u32 v19, v19, 7, v8
  s_add_u32 m0, s76, 0
  s_mov_b32 exec_hi, 0xffffff
  buffer_load_dwordx4 v16, s[32:35], 0 offen lds
  s_add_u32 m0, s76, 1056
  s_nop 0
  buffer_load_dwordx4 v17, s[32:35], 0 offen lds
  s_add_u32 m0, s76, 2112
  s_mov_b32 exec_hi, 0xffff
  buffer_load_dwordx4 v18, s[32:35], 0 offen lds
  s_add_u32 m0, s76, 3168
  s_nop 0
  buffer_load_dwordx4 v19, s[32:35], 0 offen lds
  s_mov_b32 exec_hi, -1
  buffer_load_dwordx4 v[16:19], v6, s[28:31], s94 offen
  s_add_u32 s94, s94, 832
  s_sub_u32 s76, s76, s81
  s_waitcnt vmcnt(5)
  v_lshlrev_b32 v13, 7, v13
  buffer_load_dword v15, v13, s[32:35], 0 offen
  buffer_load_dword v13, v12, s[28:31], s77 offen
  s_cmp_eq_u32 s77, s73
  s_cselect_b32 s73, 0x7000000, s73
  s_cselect_b32 s77, 0x7000000, s77
  s_add_u32 s77, s77, 24
  s_min_u32 s77, s77, s73
  s_waitcnt vmcnt(7)
  buffer_load_dword v14, v11, s[44:47], s101 offen
  s_add_u32 s101, s101, 1144832
  v_add_u32 v2, s81, v2
  v_add_u32 v4, s81, v4
  v_add_u32 v5, s81, v5
  s_sub_u32 s81, 0, s81
  s_setprio 1
  v_mfma_f32_16x16x32_bf16 v[184:187], v[164:167], v[124:127], 0
  ds_read_b128 v[180:183], v1 offset:7168
  v_pk_mul_f16 v116, v60, v69 op_sel:[0,0] op_sel_hi:[0,1]
  v_mfma_f32_16x16x32_bf16 v[200:203], v[164:167], v[136:139], 0
  v_pk_mul_f16 v117, v60, v69 op_sel:[1,0] op_sel_hi:[1,1]
  v_mfma_f32_16x16x32_bf16 v[216:219], v[164:167], v[148:151], 0
  v_pk_mul_f16 v118, v60, v70 op_sel:[0,0] op_sel_hi:[0,1]
  v_mfma_f32_16x16x32_bf16 v[232:235], v[164:167], v[160:163], 0
  v_pk_mul_f16 v119, v60, v70 op_sel:[1,0] op_sel_hi:[1,1]
  v_mfma_f32_16x16x32_bf16 v[188:191], v[168:171], v[124:127], 0
  ds_read_b128 v[164:167], v1 offset:5120
  v_pk_mul_f16 v128, v74, v83 op_sel:[0,0] op_sel_hi:[0,1]
  v_mfma_f32_16x16x32_bf16 v[204:207], v[168:171], v[136:139], 0
  v_pk_mul_f16 v129, v74, v83 op_sel:[1,0] op_sel_hi:[1,1]
  v_mfma_f32_16x16x32_bf16 v[220:223], v[168:171], v[148:151], 0
  v_pk_mul_f16 v130, v74, v84 op_sel:[0,0] op_sel_hi:[0,1]
  v_mfma_f32_16x16x32_bf16 v[236:239], v[168:171], v[160:163], 0
  v_pk_mul_f16 v131, v74, v84 op_sel:[1,0] op_sel_hi:[1,1]
  v_mfma_f32_16x16x32_f16 v[192:195], v[172:175], v[120:123], 0
  ds_read_b128 v[168:171], v1 offset:11264
  v_pk_mul_f16 v140, v88, v97 op_sel:[0,0] op_sel_hi:[0,1]
  v_mfma_f32_16x16x32_f16 v[208:211], v[172:175], v[132:135], 0
  v_pk_mul_f16 v141, v88, v97 op_sel:[1,0] op_sel_hi:[1,1]
  v_mfma_f32_16x16x32_f16 v[224:227], v[172:175], v[144:147], 0
  v_pk_mul_f16 v142, v88, v98 op_sel:[0,0] op_sel_hi:[0,1]
  v_mfma_f32_16x16x32_f16 v[240:243], v[172:175], v[156:159], 0
  v_pk_mul_f16 v143, v88, v98 op_sel:[1,0] op_sel_hi:[1,1]
  v_mfma_f32_16x16x32_f16 v[184:187], v[176:179], v[120:123], v[184:187]
  ds_read_b128 v[172:175], v1 offset:9216
  v_pk_mul_f16 v152, v102, v111 op_sel:[0,0] op_sel_hi:[0,1]
  v_mfma_f32_16x16x32_f16 v[200:203], v[176:179], v[132:135], v[200:203]
  v_pk_mul_f16 v153, v102, v111 op_sel:[1,0] op_sel_hi:[1,1]
  v_mfma_f32_16x16x32_f16 v[216:219], v[176:179], v[144:147], v[216:219]
  s_setprio 2
  s_waitcnt lgkmcnt(14)
  v_pk_mul_f16 v154, v102, v112 op_sel:[0,0] op_sel_hi:[0,1]
  v_mfma_f32_16x16x32_f16 v[232:235], v[176:179], v[156:159], v[232:235]
  s_waitcnt lgkmcnt(3)
  v_pk_mul_f16 v155, v102, v112 op_sel:[1,0] op_sel_hi:[1,1]
  v_mfma_f32_16x16x32_f16 v[188:191], v[180:183], v[120:123], v[188:191]
  ds_read_b128 v[176:179], v1 offset:10240
  v_pk_mul_f16 v124, v61, v68 op_sel:[0,0] op_sel_hi:[0,1]
  v_mfma_f32_16x16x32_f16 v[204:207], v[180:183], v[132:135], v[204:207]
  v_pk_mul_f16 v125, v61, v68 op_sel:[1,0] op_sel_hi:[1,1]
  v_mfma_f32_16x16x32_f16 v[220:223], v[180:183], v[144:147], v[220:223]
  v_pk_mul_f16 v126, v61, v69 op_sel:[0,0] op_sel_hi:[0,1]
  v_mfma_f32_16x16x32_f16 v[236:239], v[180:183], v[156:159], v[236:239]
  s_waitcnt lgkmcnt(3)
  v_pk_mul_f16 v127, v61, v69 op_sel:[1,0] op_sel_hi:[1,1]
  v_mfma_f32_16x16x32_f16 v[196:199], v[164:167], v[120:123], 0
  ds_read_b128 v[180:183], v1 offset:14336
  v_pk_mul_f16 v136, v75, v82 op_sel:[0,0] op_sel_hi:[0,1]
  v_mfma_f32_16x16x32_f16 v[212:215], v[164:167], v[132:135], 0
  v_pk_mul_f16 v120, v60, v71 op_sel:[0,0] op_sel_hi:[0,1]
  v_mfma_f32_16x16x32_f16 v[228:231], v[164:167], v[144:147], 0
  v_pk_mul_f16 v121, v60, v71 op_sel:[1,0] op_sel_hi:[1,1]
  v_mfma_f32_16x16x32_f16 v[244:247], v[164:167], v[156:159], 0
  s_waitcnt lgkmcnt(3)
  v_pk_mul_f16 v122, v60, v66 op_sel:[0,1] op_sel_hi:[0,0]
  v_mfma_f32_16x16x32_f16 v[192:195], v[168:171], v[116:119], v[192:195]
  ds_read_b128 v[164:167], v1 offset:12288
  v_pk_mul_f16 v123, v60, v72 op_sel:[0,0] op_sel_hi:[1,0]
  v_mfma_f32_16x16x32_f16 v[208:211], v[168:171], v[128:131], v[208:211]
  v_pk_mul_f16 v132, v74, v85 op_sel:[0,0] op_sel_hi:[0,1]
  v_mfma_f32_16x16x32_f16 v[224:227], v[168:171], v[140:143], v[224:227]
  v_pk_mul_f16 v133, v74, v85 op_sel:[1,0] op_sel_hi:[1,1]
  v_mfma_f32_16x16x32_f16 v[240:243], v[168:171], v[152:155], v[240:243]
  s_waitcnt lgkmcnt(3)
  v_pk_mul_f16 v134, v74, v80 op_sel:[0,1] op_sel_hi:[0,0]
  v_mfma_f32_16x16x32_f16 v[184:187], v[172:175], v[116:119], v[184:187]
  ds_read_b128 v[168:171], v1 offset:13312
  v_pk_mul_f16 v135, v74, v86 op_sel:[0,0] op_sel_hi:[1,0]
  v_mfma_f32_16x16x32_f16 v[200:203], v[172:175], v[128:131], v[200:203]
  v_pk_mul_f16 v144, v88, v99 op_sel:[0,0] op_sel_hi:[0,1]
  v_mfma_f32_16x16x32_f16 v[216:219], v[172:175], v[140:143], v[216:219]
  v_pk_mul_f16 v145, v88, v99 op_sel:[1,0] op_sel_hi:[1,1]
  v_mfma_f32_16x16x32_f16 v[232:235], v[172:175], v[152:155], v[232:235]
  s_waitcnt lgkmcnt(3)
  v_pk_mul_f16 v146, v88, v94 op_sel:[0,1] op_sel_hi:[0,0]
  v_mfma_f32_16x16x32_f16 v[188:191], v[176:179], v[116:119], v[188:191]
  ds_read_b128 v[172:175], v1 offset:0
  v_pk_mul_f16 v147, v88, v100 op_sel:[0,0] op_sel_hi:[1,0]
  v_mfma_f32_16x16x32_f16 v[204:207], v[176:179], v[128:131], v[204:207]
  v_pk_mul_f16 v156, v102, v113 op_sel:[0,0] op_sel_hi:[0,1]
  v_mfma_f32_16x16x32_f16 v[220:223], v[176:179], v[140:143], v[220:223]
  v_pk_mul_f16 v157, v102, v113 op_sel:[1,0] op_sel_hi:[1,1]
  v_mfma_f32_16x16x32_f16 v[236:239], v[176:179], v[152:155], v[236:239]
  s_waitcnt lgkmcnt(3)
  v_pk_mul_f16 v158, v102, v108 op_sel:[0,1] op_sel_hi:[0,0]
  v_mfma_f32_16x16x32_f16 v[192:195], v[180:183], v[120:123], v[192:195]
  ds_read_b128 v[176:179], v1 offset:17408
  v_pk_mul_f16 v159, v102, v114 op_sel:[0,0] op_sel_hi:[1,0]
  v_mfma_f32_16x16x32_f16 v[208:211], v[180:183], v[132:135], v[208:211]
  v_pk_mul_f16 v137, v75, v82 op_sel:[1,0] op_sel_hi:[1,1]
  v_mfma_f32_16x16x32_f16 v[224:227], v[180:183], v[144:147], v[224:227]
  v_pk_mul_f16 v138, v75, v83 op_sel:[0,0] op_sel_hi:[0,1]
  v_mfma_f32_16x16x32_f16 v[240:243], v[180:183], v[156:159], v[240:243]
  s_waitcnt lgkmcnt(3)
  v_pk_mul_f16 v139, v75, v83 op_sel:[1,0] op_sel_hi:[1,1]
  v_mfma_f32_16x16x32_f16 v[184:187], v[164:167], v[120:123], v[184:187]
  ds_read_b128 v[180:183], v1 offset:15360
  v_pk_mul_f16 v148, v89, v96 op_sel:[0,0] op_sel_hi:[0,1]
  v_mfma_f32_16x16x32_f16 v[200:203], v[164:167], v[132:135], v[200:203]
  v_pk_mul_f16 v149, v89, v96 op_sel:[1,0] op_sel_hi:[1,1]
  v_mfma_f32_16x16x32_f16 v[216:219], v[164:167], v[144:147], v[216:219]
  v_pk_mul_f16 v150, v89, v97 op_sel:[0,0] op_sel_hi:[0,1]
  v_mfma_f32_16x16x32_f16 v[232:235], v[164:167], v[156:159], v[232:235]
  s_waitcnt lgkmcnt(3)
  v_pk_mul_f16 v151, v89, v97 op_sel:[1,0] op_sel_hi:[1,1]
  v_mfma_f32_16x16x32_f16 v[188:191], v[168:171], v[120:123], v[188:191]
  ds_read_b128 v[164:167], v1 offset:16384
  v_pk_mul_f16 v160, v103, v110 op_sel:[0,0] op_sel_hi:[0,1]
  v_mfma_f32_16x16x32_f16 v[204:207], v[168:171], v[132:135], v[204:207]
  v_pk_mul_f16 v161, v103, v110 op_sel:[1,0] op_sel_hi:[1,1]
  v_mfma_f32_16x16x32_f16 v[220:223], v[168:171], v[144:147], v[220:223]
  v_pk_mul_f16 v162, v103, v111 op_sel:[0,0] op_sel_hi:[0,1]
  v_mfma_f32_16x16x32_f16 v[236:239], v[168:171], v[156:159], v[236:239]
  s_waitcnt lgkmcnt(3)
  v_pk_mul_f16 v163, v103, v111 op_sel:[1,0] op_sel_hi:[1,1]
  v_smfmac_f32_16x16x64_f16 v[196:199], v[172:175], v[116:123], v9
  ds_read_b128 v[168:171], v1 offset:20480
  v_smfmac_f32_16x16x64_f16 v[212:215], v[172:175], v[128:135], v9
  v_pk_mul_f16 v120, v61, v70 op_sel:[0,0] op_sel_hi:[0,1]
  v_smfmac_f32_16x16x64_f16 v[228:231], v[172:175], v[140:147], v9
  v_pk_mul_f16 v121, v61, v70 op_sel:[1,0] op_sel_hi:[1,1]
  v_smfmac_f32_16x16x64_f16 v[244:247], v[172:175], v[152:159], v9
  s_waitcnt lgkmcnt(3)
  v_pk_mul_f16 v122, v61, v71 op_sel:[0,0] op_sel_hi:[0,1]
  v_mfma_f32_16x16x32_f16 v[192:195], v[176:179], v[124:127], v[192:195]
  ds_read_b128 v[172:175], v1 offset:18432
  v_pk_mul_f16 v123, v61, v71 op_sel:[1,0] op_sel_hi:[1,1]
  v_mfma_f32_16x16x32_f16 v[208:211], v[176:179], v[136:139], v[208:211]
  v_pk_mul_f16 v132, v75, v84 op_sel:[0,0] op_sel_hi:[0,1]
  v_mfma_f32_16x16x32_f16 v[224:227], v[176:179], v[148:151], v[224:227]
  v_pk_mul_f16 v133, v75, v84 op_sel:[1,0] op_sel_hi:[1,1]
  v_mfma_f32_16x16x32_f16 v[240:243], v[176:179], v[160:163], v[240:243]
  s_waitcnt lgkmcnt(3)
  v_pk_mul_f16 v134, v75, v85 op_sel:[0,0] op_sel_hi:[0,1]
  v_mfma_f32_16x16x32_f16 v[184:187], v[180:183], v[124:127], v[184:187]
  ds_read_b128 v[176:179], v1 offset:19456
  v_pk_mul_f16 v135, v75, v85 op_sel:[1,0] op_sel_hi:[1,1]
  v_mfma_f32_16x16x32_f16 v[200:203], v[180:183], v[136:139], v[200:203]
  v_pk_mul_f16 v144, v89, v98 op_sel:[0,0] op_sel_hi:[0,1]
  v_mfma_f32_16x16x32_f16 v[216:219], v[180:183], v[148:151], v[216:219]
  v_pk_mul_f16 v145, v89, v98 op_sel:[1,0] op_sel_hi:[1,1]
  v_mfma_f32_16x16x32_f16 v[232:235], v[180:183], v[160:163], v[232:235]
  s_waitcnt lgkmcnt(3)
  v_pk_mul_f16 v146, v89, v99 op_sel:[0,0] op_sel_hi:[0,1]
  v_mfma_f32_16x16x32_f16 v[188:191], v[164:167], v[124:127], v[188:191]
  ds_read_b128 v[180:183], v1 offset:1024
  v_pk_mul_f16 v147, v89, v99 op_sel:[1,0] op_sel_hi:[1,1]
  v_mfma_f32_16x16x32_f16 v[204:207], v[164:167], v[136:139], v[204:207]
  s_waitcnt vmcnt(4)
  ds_read_u16_d16_hi v32, v2 offset:0
  v_pk_mul_f16 v156, v103, v112 op_sel:[0,0] op_sel_hi:[0,1]
  v_mfma_f32_16x16x32_f16 v[220:223], v[164:167], v[148:151], v[220:223]
  ds_read_u16_d16_hi v33, v2 offset:2
  v_pk_mul_f16 v157, v103, v112 op_sel:[1,0] op_sel_hi:[1,1]
  v_mfma_f32_16x16x32_f16 v[236:239], v[164:167], v[160:163], v[236:239]
  s_waitcnt lgkmcnt(5)
  v_pk_mul_f16 v158, v103, v113 op_sel:[0,0] op_sel_hi:[0,1]
  v_mfma_f32_16x16x32_f16 v[192:195], v[168:171], v[120:123], v[192:195]
  ds_read_b128 v[164:167], v1 offset:23552
  v_pk_mul_f16 v159, v103, v113 op_sel:[1,0] op_sel_hi:[1,1]
  v_mfma_f32_16x16x32_f16 v[208:211], v[168:171], v[132:135], v[208:211]
  ds_read_u16_d16_hi v34, v2 offset:2112
  v_pk_mul_f16 v116, v61, v67 op_sel:[0,1] op_sel_hi:[0,0]
  v_mfma_f32_16x16x32_f16 v[224:227], v[168:171], v[144:147], v[224:227]
  ds_read_u16_d16_hi v35, v2 offset:2114
  v_pk_mul_f16 v117, v61, v72 op_sel:[0,0] op_sel_hi:[1,0]
  v_mfma_f32_16x16x32_f16 v[240:243], v[168:171], v[156:159], v[240:243]
  s_waitcnt lgkmcnt(7)
  v_pk_mul_f16 v118, v62, v69 op_sel:[0,0] op_sel_hi:[0,1]
  v_mfma_f32_16x16x32_f16 v[184:187], v[172:175], v[120:123], v[184:187]
  ds_read_b128 v[168:171], v1 offset:21504
  v_pk_mul_f16 v119, v62, v69 op_sel:[1,0] op_sel_hi:[1,1]
  v_mfma_f32_16x16x32_f16 v[200:203], v[172:175], v[132:135], v[200:203]
  ds_read_b64_tr_b16 v[60:61], v27 offset:0
  v_pk_mul_f16 v128, v75, v81 op_sel:[0,1] op_sel_hi:[0,0]
  v_mfma_f32_16x16x32_f16 v[216:219], v[172:175], v[144:147], v[216:219]
  ds_read_u16_d16_hi v36, v2 offset:128
  v_pk_mul_f16 v129, v75, v86 op_sel:[0,0] op_sel_hi:[1,0]
  v_mfma_f32_16x16x32_f16 v[232:235], v[172:175], v[156:159], v[232:235]
  s_waitcnt lgkmcnt(9)
  v_pk_mul_f16 v130, v76, v83 op_sel:[0,0] op_sel_hi:[0,1]
  v_pk_mul_f16 v131, v76, v83 op_sel:[1,0] op_sel_hi:[1,1]
  v_mfma_f32_16x16x32_f16 v[188:191], v[176:179], v[120:123], v[188:191]
  ds_read_b128 v[172:175], v1 offset:22528
  v_pk_mul_f16 v140, v89, v95 op_sel:[0,1] op_sel_hi:[0,0]
  v_mfma_f32_16x16x32_f16 v[204:207], v[176:179], v[132:135], v[204:207]
  ds_read_b64_tr_b16 v[74:75], v27 offset:32
  v_pk_mul_f16 v141, v89, v100 op_sel:[0,0] op_sel_hi:[1,0]
  v_mfma_f32_16x16x32_f16 v[220:223], v[176:179], v[144:147], v[220:223]
  ds_read_b64_tr_b16 v[88:89], v27 offset:64
  v_pk_mul_f16 v142, v90, v97 op_sel:[0,0] op_sel_hi:[0,1]
  v_mfma_f32_16x16x32_f16 v[236:239], v[176:179], v[156:159], v[236:239]
  s_waitcnt lgkmcnt(11)
  v_pk_mul_f16 v143, v90, v97 op_sel:[1,0] op_sel_hi:[1,1]
  v_pk_mul_f16 v152, v103, v109 op_sel:[0,1] op_sel_hi:[0,0]
  v_smfmac_f32_16x16x64_f16 v[196:199], v[180:183], v[120:127], v9
  ds_read_b128 v[176:179], v1 offset:26624
  v_pk_mul_f16 v153, v103, v114 op_sel:[0,0] op_sel_hi:[1,0]
  v_smfmac_f32_16x16x64_f16 v[212:215], v[180:183], v[132:139], v9
  ds_read_b64_tr_b16 v[102:103], v27 offset:96
  v_pk_mul_f16 v154, v104, v111 op_sel:[0,0] op_sel_hi:[0,1]
  v_smfmac_f32_16x16x64_f16 v[228:231], v[180:183], v[144:151], v9
  ds_read_u16_d16_hi v37, v2 offset:130
  v_pk_mul_f16 v155, v104, v111 op_sel:[1,0] op_sel_hi:[1,1]
  v_smfmac_f32_16x16x64_f16 v[244:247], v[180:183], v[156:163], v9
  s_waitcnt lgkmcnt(11)
  v_pk_mul_f16 v120, v62, v70 op_sel:[0,0] op_sel_hi:[0,1]
  v_mfma_f32_16x16x32_f16 v[192:195], v[164:167], v[116:119], v[192:195]
  ds_read_b128 v[180:183], v1 offset:24576
  v_pk_mul_f16 v121, v62, v70 op_sel:[1,0] op_sel_hi:[1,1]
  v_mfma_f32_16x16x32_f16 v[208:211], v[164:167], v[128:131], v[208:211]
  ds_read_u16_d16_hi v38, v2 offset:2240
  v_pk_mul_f16 v122, v62, v71 op_sel:[0,0] op_sel_hi:[0,1]
  v_mfma_f32_16x16x32_f16 v[224:227], v[164:167], v[140:143], v[224:227]
  ds_read_u16_d16_hi v39, v2 offset:2242
  v_pk_mul_f16 v123, v62, v71 op_sel:[1,0] op_sel_hi:[1,1]
  v_mfma_f32_16x16x32_f16 v[240:243], v[164:167], v[152:155], v[240:243]
  s_waitcnt lgkmcnt(11)
  v_pk_mul_f16 v132, v76, v84 op_sel:[0,0] op_sel_hi:[0,1]
  v_max3_f32 v58, |v32|, |v33|, 0
  v_mfma_f32_16x16x32_f16 v[184:187], v[168:171], v[116:119], v[184:187]
  ds_read_b128 v[164:167], v1 offset:25600
  v_pk_mul_f16 v133, v76, v84 op_sel:[1,0] op_sel_hi:[1,1]
  v_mfma_f32_16x16x32_f16 v[200:203], v[168:171], v[128:131], v[200:203]
  ds_read_u16_d16_hi v40, v2 offset:256
  v_pk_mul_f16 v134, v76, v85 op_sel:[0,0] op_sel_hi:[0,1]
  v_mfma_f32_16x16x32_f16 v[216:219], v[168:171], v[140:143], v[216:219]
  ds_read_u16_d16_hi v41, v2 offset:258
  v_pk_mul_f16 v135, v76, v85 op_sel:[1,0] op_sel_hi:[1,1]
  v_mfma_f32_16x16x32_f16 v[232:235], v[168:171], v[152:155], v[232:235]
  s_waitcnt lgkmcnt(11)
  v_pk_mul_f16 v144, v90, v98 op_sel:[0,0] op_sel_hi:[0,1]
  v_max3_f32 v58, |v34|, |v35|, v58
  v_mfma_f32_16x16x32_f16 v[188:191], v[172:175], v[116:119], v[188:191]
  ds_read_b128 v[168:171], v1 offset:2048
  v_pk_mul_f16 v145, v90, v98 op_sel:[1,0] op_sel_hi:[1,1]
  v_mfma_f32_16x16x32_f16 v[204:207], v[172:175], v[128:131], v[204:207]
  ds_read_u16_d16_hi v42, v2 offset:2368
  v_pk_mul_f16 v146, v90, v99 op_sel:[0,0] op_sel_hi:[0,1]
  v_mfma_f32_16x16x32_f16 v[220:223], v[172:175], v[140:143], v[220:223]
  ds_read_u16_d16_hi v43, v2 offset:2370
  v_pk_mul_f16 v147, v90, v99 op_sel:[1,0] op_sel_hi:[1,1]
  v_mfma_f32_16x16x32_f16 v[236:239], v[172:175], v[152:155], v[236:239]
  s_waitcnt lgkmcnt(11)
  v_pk_mul_f16 v156, v104, v112 op_sel:[0,0] op_sel_hi:[0,1]
  v_mfma_f32_16x16x32_f16 v[192:195], v[176:179], v[120:123], v[192:195]
  ds_read_b128 v[172:175], v1 offset:29696
  v_pk_mul_f16 v157, v104, v112 op_sel:[1,0] op_sel_hi:[1,1]
  v_mfma_f32_16x16x32_f16 v[208:211], v[176:179], v[132:135], v[208:211]
  ds_read_u16_d16_hi v44, v2 offset:384
  v_pk_mul_f16 v158, v104, v113 op_sel:[0,0] op_sel_hi:[0,1]
  v_mfma_f32_16x16x32_f16 v[224:227], v[176:179], v[144:147], v[224:227]
  ds_read_u16_d16_hi v45, v2 offset:386
  v_pk_mul_f16 v159, v104, v113 op_sel:[1,0] op_sel_hi:[1,1]
  s_nop 1
  v_mfma_f32_16x16x32_f16 v[240:243], v[176:179], v[156:159], v[240:243]
  s_waitcnt lgkmcnt(11)
  v_pk_mul_f16 v124, v62, v68 op_sel:[0,1] op_sel_hi:[0,0]
  v_mfma_f32_16x16x32_f16 v[184:187], v[180:183], v[120:123], v[184:187]
  ds_read_b128 v[176:179], v1 offset:27648
  v_pk_mul_f16 v125, v62, v72 op_sel:[0,0] op_sel_hi:[1,0]
  v_mfma_f32_16x16x32_f16 v[200:203], v[180:183], v[132:135], v[200:203]
  ds_read_u16_d16_hi v46, v2 offset:2496
  v_pk_mul_f16 v126, v63, v70 op_sel:[0,0] op_sel_hi:[0,1]
  v_mfma_f32_16x16x32_f16 v[216:219], v[180:183], v[144:147], v[216:219]
  ds_read_u16_d16_hi v47, v2 offset:2498
  v_pk_mul_f16 v127, v63, v70 op_sel:[1,0] op_sel_hi:[1,1]
  v_mfma_f32_16x16x32_f16 v[232:235], v[180:183], v[156:159], v[232:235]
  s_waitcnt lgkmcnt(11)
  v_pk_mul_f16 v136, v76, v82 op_sel:[0,1] op_sel_hi:[0,0]
  v_pk_mul_f16 v137, v76, v86 op_sel:[0,0] op_sel_hi:[1,0]
  v_mfma_f32_16x16x32_f16 v[188:191], v[164:167], v[120:123], v[188:191]
  ds_read_b128 v[180:183], v1 offset:28672
  v_pk_mul_f16 v138, v77, v84 op_sel:[0,0] op_sel_hi:[0,1]
  v_mfma_f32_16x16x32_f16 v[204:207], v[164:167], v[132:135], v[204:207]
  ds_read_u16_d16_hi v48, v2 offset:512
  v_pk_mul_f16 v139, v77, v84 op_sel:[1,0] op_sel_hi:[1,1]
  v_mfma_f32_16x16x32_f16 v[220:223], v[164:167], v[144:147], v[220:223]
  ds_read_u16_d16_hi v49, v2 offset:514
  v_pk_mul_f16 v148, v90, v96 op_sel:[0,1] op_sel_hi:[0,0]
  v_mfma_f32_16x16x32_f16 v[236:239], v[164:167], v[156:159], v[236:239]
  s_waitcnt lgkmcnt(11)
  v_pk_mul_f16 v149, v90, v100 op_sel:[0,0] op_sel_hi:[1,0]
  v_pk_mul_f16 v150, v91, v98 op_sel:[0,0] op_sel_hi:[0,1]
  v_smfmac_f32_16x16x64_f16 v[196:199], v[168:171], v[116:123], v9
  ds_read_b128 v[164:167], v1 offset:32768
  v_pk_mul_f16 v151, v91, v98 op_sel:[1,0] op_sel_hi:[1,1]
  v_smfmac_f32_16x16x64_f16 v[212:215], v[168:171], v[128:135], v9
  ds_read_u16_d16_hi v50, v2 offset:2624
  v_pk_mul_f16 v160, v104, v110 op_sel:[0,1] op_sel_hi:[0,0]
  v_smfmac_f32_16x16x64_f16 v[228:231], v[168:171], v[140:147], v9
  ds_read_u16_d16_hi v51, v2 offset:2626
  v_pk_mul_f16 v161, v104, v114 op_sel:[0,0] op_sel_hi:[1,0]
  v_smfmac_f32_16x16x64_f16 v[244:247], v[168:171], v[152:159], v9
  s_waitcnt lgkmcnt(11)
  v_pk_mul_f16 v162, v105, v112 op_sel:[0,0] op_sel_hi:[0,1]
  v_mfma_f32_16x16x32_f16 v[192:195], v[172:175], v[124:127], v[192:195]
  ds_read_b128 v[168:171], v1 offset:30720
  v_pk_mul_f16 v163, v105, v112 op_sel:[1,0] op_sel_hi:[1,1]
  v_mfma_f32_16x16x32_f16 v[208:211], v[172:175], v[136:139], v[208:211]
  ds_read_u16_d16_hi v52, v2 offset:640
  v_pk_mul_f16 v120, v63, v71 op_sel:[0,0] op_sel_hi:[0,1]
  v_mfma_f32_16x16x32_f16 v[224:227], v[172:175], v[148:151], v[224:227]
  ds_read_u16_d16_hi v53, v2 offset:642
  v_pk_mul_f16 v121, v63, v71 op_sel:[1,0] op_sel_hi:[1,1]
  v_mfma_f32_16x16x32_f16 v[240:243], v[172:175], v[160:163], v[240:243]
  s_waitcnt lgkmcnt(11)
  v_pk_mul_f16 v122, v63, v69 op_sel:[0,1] op_sel_hi:[1,1]
  v_pk_mul_f16 v123, v63, v72 op_sel:[0,0] op_sel_hi:[1,0]
  v_mfma_f32_16x16x32_f16 v[184:187], v[176:179], v[124:127], v[184:187]
  ds_read_b128 v[172:175], v1 offset:31744
  v_pk_mul_f16 v132, v77, v85 op_sel:[0,0] op_sel_hi:[0,1]
  v_mfma_f32_16x16x32_f16 v[200:203], v[176:179], v[136:139], v[200:203]
  ds_read_u16_d16_hi v54, v2 offset:2752
  v_pk_mul_f16 v133, v77, v85 op_sel:[1,0] op_sel_hi:[1,1]
  v_mfma_f32_16x16x32_f16 v[216:219], v[176:179], v[148:151], v[216:219]
  ds_read_u16_d16_hi v55, v2 offset:2754
  v_pk_mul_f16 v134, v77, v83 op_sel:[0,1] op_sel_hi:[1,1]
  v_mfma_f32_16x16x32_f16 v[232:235], v[176:179], v[160:163], v[232:235]
  s_waitcnt lgkmcnt(11)
  v_pk_mul_f16 v135, v77, v86 op_sel:[0,0] op_sel_hi:[1,0]
  v_pk_mul_f16 v144, v91, v99 op_sel:[0,0] op_sel_hi:[0,1]
  v_mfma_f32_16x16x32_f16 v[188:191], v[180:183], v[124:127], v[188:191]
  ds_read_b128 v[176:179], v1 offset:3072
  v_pk_mul_f16 v145, v91, v99 op_sel:[1,0] op_sel_hi:[1,1]
  v_mfma_f32_16x16x32_f16 v[204:207], v[180:183], v[136:139], v[204:207]
  ds_read_u16_d16_hi v56, v2 offset:768
  v_pk_mul_f16 v146, v91, v97 op_sel:[0,1] op_sel_hi:[1,1]
  v_mfma_f32_16x16x32_f16 v[220:223], v[180:183], v[148:151], v[220:223]
  ds_read_u16_d16_hi v57, v2 offset:770
  v_pk_mul_f16 v147, v91, v100 op_sel:[0,0] op_sel_hi:[1,0]
  v_mfma_f32_16x16x32_f16 v[236:239], v[180:183], v[160:163], v[236:239]
  s_waitcnt lgkmcnt(11)
  v_pk_mul_f16 v156, v105, v113 op_sel:[0,0] op_sel_hi:[0,1]
  v_max3_f32 v58, |v36|, |v37|, v58
  v_mfma_f32_16x16x32_f16 v[192:195], v[164:167], v[120:123], v[192:195]
  ds_read_b128 v[180:183], v1 offset:35840
  v_pk_mul_f16 v157, v105, v113 op_sel:[1,0] op_sel_hi:[1,1]
  v_mfma_f32_16x16x32_f16 v[208:211], v[164:167], v[132:135], v[208:211]
  v_pk_mul_f16 v158, v105, v111 op_sel:[0,1] op_sel_hi:[1,1]
  v_max3_f32 v58, |v38|, |v39|, v58
  v_mfma_f32_16x16x32_f16 v[224:227], v[164:167], v[144:147], v[224:227]
  v_pk_mul_f16 v159, v105, v114 op_sel:[0,0] op_sel_hi:[1,0]
  v_max3_f32 v58, |v40|, |v41|, v58
  s_nop 0
  v_mfma_f32_16x16x32_f16 v[240:243], v[164:167], v[156:159], v[240:243]
  s_waitcnt lgkmcnt(9)
  v_pk_mul_f16 v116, v64, v71 op_sel:[0,0] op_sel_hi:[0,1]
  v_mfma_f32_16x16x32_f16 v[184:187], v[168:171], v[120:123], v[184:187]
  ds_read_b128 v[164:167], v1 offset:33792
  v_pk_mul_f16 v117, v64, v71 op_sel:[1,0] op_sel_hi:[1,1]
  v_mfma_f32_16x16x32_f16 v[200:203], v[168:171], v[132:135], v[200:203]
  v_pk_mul_f16 v118, v64, v70 op_sel:[0,1] op_sel_hi:[1,1]
  v_max3_f32 v58, |v42|, |v43|, v58
  v_mfma_f32_16x16x32_f16 v[216:219], v[168:171], v[144:147], v[216:219]
  v_pk_mul_f16 v119, v64, v72 op_sel:[0,0] op_sel_hi:[1,0]
  v_pk_mul_f16 v128, v78, v85 op_sel:[0,0] op_sel_hi:[0,1]
  v_mfma_f32_16x16x32_f16 v[232:235], v[168:171], v[156:159], v[232:235]
  s_waitcnt lgkmcnt(7)
  v_pk_mul_f16 v129, v78, v85 op_sel:[1,0] op_sel_hi:[1,1]
  v_pk_mul_f16 v130, v78, v84 op_sel:[0,1] op_sel_hi:[1,1]
  v_mfma_f32_16x16x32_f16 v[188:191], v[172:175], v[120:123], v[188:191]
  ds_read_b128 v[168:171], v1 offset:34816
  v_pk_mul_f16 v131, v78, v86 op_sel:[0,0] op_sel_hi:[1,0]
  v_mfma_f32_16x16x32_f16 v[204:207], v[172:175], v[132:135], v[204:207]
  v_pk_mul_f16 v140, v92, v99 op_sel:[0,0] op_sel_hi:[0,1]
  v_pk_mul_f16 v141, v92, v99 op_sel:[1,0] op_sel_hi:[1,1]
  v_mfma_f32_16x16x32_f16 v[220:223], v[172:175], v[144:147], v[220:223]
  v_pk_mul_f16 v142, v92, v98 op_sel:[0,1] op_sel_hi:[1,1]
  v_pk_mul_f16 v143, v92, v100 op_sel:[0,0] op_sel_hi:[1,0]
  v_mfma_f32_16x16x32_f16 v[236:239], v[172:175], v[156:159], v[236:239]
  s_waitcnt lgkmcnt(5)
  v_pk_mul_f16 v152, v106, v113 op_sel:[0,0] op_sel_hi:[0,1]
  v_smfmac_f32_16x16x64_f16 v[196:199], v[176:179], v[120:127], v9
  ds_read_b128 v[172:175], v1 offset:38912
  v_pk_mul_f16 v153, v106, v113 op_sel:[1,0] op_sel_hi:[1,1]
  v_smfmac_f32_16x16x64_f16 v[212:215], v[176:179], v[132:139], v9
  v_pk_mul_f16 v154, v106, v112 op_sel:[0,1] op_sel_hi:[1,1]
  v_smfmac_f32_16x16x64_f16 v[228:231], v[176:179], v[144:151], v9
  v_pk_mul_f16 v155, v106, v114 op_sel:[0,0] op_sel_hi:[1,0]
  v_smfmac_f32_16x16x64_f16 v[244:247], v[176:179], v[156:163], v9
  s_waitcnt lgkmcnt(3)
  v_pk_mul_f16 v120, v65, v71 op_sel:[0,1] op_sel_hi:[1,1]
  v_mfma_f32_16x16x32_f16 v[192:195], v[180:183], v[116:119], v[192:195]
  ds_read_b128 v[176:179], v1 offset:36864
  v_pk_mul_f16 v121, v65, v72 op_sel:[0,0] op_sel_hi:[1,0]
  v_mfma_f32_16x16x32_f16 v[208:211], v[180:183], v[128:131], v[208:211]
  v_pk_mul_f16 v122, v72, v72 op_sel:[0,0] op_sel_hi:[1,1]
  v_max3_f32 v58, |v44|, |v45|, v58
  v_mfma_f32_16x16x32_f16 v[224:227], v[180:183], v[140:143], v[224:227]
  v_pk_mul_f16 v123, v60, v61 op_sel:[0,0] op_sel_hi:[1,1]
  v_max3_f32 v58, |v46|, |v47|, v58
  v_mfma_f32_16x16x32_f16 v[240:243], v[180:183], v[152:155], v[240:243]
  s_waitcnt lgkmcnt(3)
  v_pk_mul_f16 v132, v79, v85 op_sel:[0,1] op_sel_hi:[1,1]
  v_mfma_f32_16x16x32_f16 v[184:187], v[164:167], v[116:119], v[184:187]
  ds_read_b128 v[180:183], v1 offset:37888
  v_pk_mul_f16 v133, v79, v86 op_sel:[0,0] op_sel_hi:[1,0]
  v_mfma_f32_16x16x32_f16 v[200:203], v[164:167], v[128:131], v[200:203]
  v_pk_mul_f16 v134, v86, v86 op_sel:[0,0] op_sel_hi:[1,1]
  v_max3_f32 v58, |v48|, |v49|, v58
  v_mfma_f32_16x16x32_f16 v[216:219], v[164:167], v[140:143], v[216:219]
  v_pk_mul_f16 v135, v74, v75 op_sel:[0,0] op_sel_hi:[1,1]
  v_max3_f32 v58, |v50|, |v51|, v58
  v_mfma_f32_16x16x32_f16 v[232:235], v[164:167], v[152:155], v[232:235]
  s_waitcnt lgkmcnt(3)
  v_pk_mul_f16 v144, v93, v99 op_sel:[0,1] op_sel_hi:[1,1]
  v_mfma_f32_16x16x32_f16 v[188:191], v[168:171], v[116:119], v[188:191]
  ds_read_b128 v[164:167], v1 offset:4096
  v_pk_mul_f16 v145, v93, v100 op_sel:[0,0] op_sel_hi:[1,0]
  v_mfma_f32_16x16x32_f16 v[204:207], v[168:171], v[128:131], v[204:207]
  v_pk_mul_f16 v146, v100, v100 op_sel:[0,0] op_sel_hi:[1,1]
  v_max3_f32 v58, |v52|, |v53|, v58
  v_mfma_f32_16x16x32_f16 v[220:223], v[168:171], v[140:143], v[220:223]
  v_pk_mul_f16 v147, v88, v89 op_sel:[0,0] op_sel_hi:[1,1]
  v_max3_f32 v58, |v54|, |v55|, v58
  v_mfma_f32_16x16x32_f16 v[236:239], v[168:171], v[152:155], v[236:239]
  s_waitcnt lgkmcnt(3)
  v_pk_mul_f16 v156, v107, v113 op_sel:[0,1] op_sel_hi:[1,1]
  v_mfma_f32_16x16x32_f16 v[192:195], v[172:175], v[120:123], v[192:195]
  v_pk_mul_f16 v157, v107, v114 op_sel:[0,0] op_sel_hi:[1,0]
  v_max3_f32 v58, |v56|, |v57|, v58
  v_mfma_f32_16x16x32_f16 v[208:211], v[172:175], v[132:135], v[208:211]
  v_pk_mul_f16 v158, v114, v114 op_sel:[0,0] op_sel_hi:[1,1]
  v_cvt_pk_f16_f32 v62, v32, v33
  v_mfma_f32_16x16x32_f16 v[224:227], v[172:175], v[144:147], v[224:227]
  v_pk_mul_f16 v159, v102, v103 op_sel:[0,0] op_sel_hi:[1,1]
  s_nop 1
  v_mfma_f32_16x16x32_f16 v[240:243], v[172:175], v[156:159], v[240:243]
  s_waitcnt lgkmcnt(2)
  v_cvt_pk_f16_f32 v76, v34, v35
  v_cvt_pk_f16_f32 v90, v36, v37
  v_mfma_f32_16x16x32_f16 v[184:187], v[176:179], v[120:123], v[184:187]
  ds_write_b32 v3, v62 offset:0
  v_mfma_f32_16x16x32_f16 v[200:203], v[176:179], v[132:135], v[200:203]
  ds_write_b32 v3, v76 offset:160
  v_mfma_f32_16x16x32_f16 v[216:219], v[176:179], v[144:147], v[216:219]
  ds_write_b32 v3, v90 offset:320
  v_mfma_f32_16x16x32_f16 v[232:235], v[176:179], v[156:159], v[232:235]
  s_waitcnt lgkmcnt(4)
  v_cvt_pk_f16_f32 v104, v38, v39
  v_cvt_pk_f16_f32 v63, v40, v41
  v_mfma_f32_16x16x32_f16 v[188:191], v[180:183], v[120:123], v[188:191]
  ds_write_b32 v3, v104 offset:480
  v_mfma_f32_16x16x32_f16 v[204:207], v[180:183], v[132:135], v[204:207]
  ds_write_b32 v3, v63 offset:640
  v_mfma_f32_16x16x32_f16 v[220:223], v[180:183], v[144:147], v[220:223]
  v_cvt_pk_f16_f32 v77, v42, v43
  v_cvt_pk_f16_f32 v91, v44, v45
  v_mfma_f32_16x16x32_f16 v[236:239], v[180:183], v[156:159], v[236:239]
  s_waitcnt lgkmcnt(5)
  v_cvt_pk_f16_f32 v105, v46, v47
  v_cvt_pk_f16_f32 v66, v48, v49
  v_smfmac_f32_16x16x64_f16 v[196:199], v[164:167], v[116:123], v9
  ds_write_b32 v3, v77 offset:800
  v_smfmac_f32_16x16x64_f16 v[212:215], v[164:167], v[128:135], v9
  ds_write_b32 v3, v91 offset:960
  v_smfmac_f32_16x16x64_f16 v[228:231], v[164:167], v[140:147], v9
  ds_write_b32 v3, v105 offset:1120
  v_smfmac_f32_16x16x64_f16 v[244:247], v[164:167], v[152:159], v9
  ds_write_b32 v3, v66 offset:1280
  s_setprio 0
  v_cvt_pk_f16_f32 v80, v50, v51
  v_cvt_pk_f16_f32 v94, v52, v53
  v_cvt_pk_f16_f32 v108, v54, v55
  v_cvt_pk_f16_f32 v67, v56, v57
  ds_write_b32 v3, v80 offset:1440
  ds_write_b32 v3, v94 offset:1600
  ds_write_b32 v3, v108 offset:1760
  ds_write_b32 v3, v67 offset:1920
  s_sub_u32 s72, s72, 1
  s_cmp_lg_u32 s72, 0
  s_cbranch_scc1 L_cin_loop
  s_branch L_cin_done
L_cslow:
  v_max_f32_dpp v58, v58, v58 row_shr:1 row_mask:0xf bank_mask:0xf
  s_nop 1
  v_max_f32_dpp v58, v58, v58 row_shr:2 row_mask:0xf bank_mask:0xf
  s_nop 1
  v_max_f32_dpp v58, v58, v58 row_shr:4 row_mask:0xf bank_mask:0xf
  s_nop 1
  v_max_f32_dpp v58, v58, v58 row_shr:8 row_mask:0xf bank_mask:0xf
  s_nop 1
  v_max_f32_dpp v58, v58, v58 row_bcast:15 row_mask:0xa bank_mask:0xf
  s_nop 1
  v_max_f32_dpp v58, v58, v58 row_bcast:31 row_mask:0xc bank_mask:0xf
  s_nop 0
  v_readlane_b32 s98, v58, 63
  s_mov_b32 s97, 0
  s_lshr_b32 s98, s98, 23
  s_max_u32 s98, s98, 72
  s_min_u32 s98, s98, 182
  s_sub_u32 s99, 258, s98
  s_lshl_b32 s100, s99, 1
  s_sub_u32 s100, s100, 127
  s_sub_u32 s95, 254, s100
  s_lshl_b32 s95, s95, 23
  v_mov_b32 v60, s95
  v_mul_f32 v61, s0, v60
  v_mul_f32 v60, s1, v60
  v_readfirstlane_b32 s74, v61
  v_readfirstlane_b32 s75, v60
  s_lshl_b32 s99, s99, 23
  s_lshl_b32 s100, s100, 23
  v_mul_f32 v60, s99, v32
  v_mul_f32 v61, s99, v33
  v_mul_f32 v62, s100, v32
  v_mul_f32 v63, s100, v33
  v_cvt_pk_f16_f32 v80, v60, v61
  v_cvt_pk_bf16_f32 v64, v62, v63
  ds_write_b32 v3, v80 offset:0
  ds_write_b32 v2, v64 offset:0
  v_mul_f32 v60, s99, v34
  v_mul_f32 v61, s99, v35
  v_mul_f32 v62, s100, v34
  v_mul_f32 v63, s100, v35
  v_cvt_pk_f16_f32 v81, v60, v61
  v_cvt_pk_bf16_f32 v65, v62, v63
  ds_write_b32 v3, v81 offset:160
  ds_write_b32 v2, v65 offset:2112
  v_mul_f32 v60, s99, v36
  v_mul_f32 v61, s99, v37
  v_mul_f32 v62, s100, v36
  v_mul_f32 v63, s100, v37
  v_cvt_pk_f16_f32 v82, v60, v61
  v_cvt_pk_bf16_f32 v66, v62, v63
  ds_write_b32 v3, v82 offset:320
  ds_write_b32 v2, v66 offset:128
  v_mul_f32 v60, s99, v38
  v_mul_f32 v61, s99, v39
  v_mul_f32 v62, s100, v38
  v_mul_f32 v63, s100, v39
  v_cvt_pk_f16_f32 v83, v60, v61
  v_cvt_pk_bf16_f32 v67, v62, v63
  ds_write_b32 v3, v83 offset:480
  ds_write_b32 v2, v67 offset:2240
  v_mul_f32 v60, s99, v40
  v_mul_f32 v61, s99, v41
  v_mul_f32 v62, s100, v40
  v_mul_f32 v63, s100, v41
  v_cvt_pk_f16_f32 v84, v60, v61
  v_cvt_pk_bf16_f32 v68, v62, v63
  ds_write_b32 v3, v84 offset:640
  ds_write_b32 v2, v68 offset:256
  v_mul_f32 v60, s99, v42
  v_mul_f32 v61, s99, v43
  v_mul_f32 v62, s100, v42
  v_mul_f32 v63, s100, v43
  v_cvt_pk_f16_f32 v85, v60, v61
  v_cvt_pk_bf16_f32 v69, v62, v63
  ds_write_b32 v3, v85 offset:800
  ds_write_b32 v2, v69 offset:2368
  v_mul_f32 v60, s99, v44
  v_mul_f32 v61, s99, v45
  v_mul_f32 v62, s100, v44
  v_mul_f32 v63, s100, v45
  v_cvt_pk_f16_f32 v86, v60, v61
  v_cvt_pk_bf16_f32 v70, v62, v63
  ds_write_b32 v3, v86 offset:960
  ds_write_b32 v2, v70 offset:384
  v_mul_f32 v60, s99, v46
  v_mul_f32 v61, s99, v47
  v_mul_f32 v62, s100, v46
  v_mul_f32 v63, s100, v47
  v_cvt_pk_f16_f32 v87, v60, v61
  v_cvt_pk_bf16_f32 v71, v62, v63
  ds_write_b32 v3, v87 offset:1120
  ds_write_b32 v2, v71 offset:2496
  v_mul_f32 v60, s99, v48
  v_mul_f32 v61, s99, v49
  v_mul_f32 v62, s100, v48
  v_mul_f32 v63, s100, v49
  v_cvt_pk_f16_f32 v88, v60, v61
  v_cvt_pk_bf16_f32 v72, v62, v63
  ds_write_b32 v3, v88 offset:1280
  ds_write_b32 v2, v72 offset:512
  v_mul_f32 v60, s99, v50
  v_mul_f32 v61, s99, v51
  v_mul_f32 v62, s100, v50
  v_mul_f32 v63, s100, v51
  v_cvt_pk_f16_f32 v89, v60, v61
  v_cvt_pk_bf16_f32 v73, v62, v63
  ds_write_b32 v3, v89 offset:1440
  ds_write_b32 v2, v73 offset:2624
  v_mul_f32 v60, s99, v52
  v_mul_f32 v61, s99, v53
  v_mul_f32 v62, s100, v52
  v_mul_f32 v63, s100, v53
  v_cvt_pk_f16_f32 v90, v60, v61
  v_cvt_pk_bf16_f32 v74, v62, v63
  ds_write_b32 v3, v90 offset:1600
  ds_write_b32 v2, v74 offset:640
  v_mul_f32 v60, s99, v54
  v_mul_f32 v61, s99, v55
  v_mul_f32 v62, s100, v54
  v_mul_f32 v63, s100, v55
  v_cvt_pk_f16_f32 v91, v60, v61
  v_cvt_pk_bf16_f32 v75, v62, v63
  ds_write_b32 v3, v91 offset:1760
  ds_write_b32 v2, v75 offset:2752
  v_mul_f32 v60, s99, v56
  v_mul_f32 v61, s99, v57
  v_mul_f32 v62, s100, v56
  v_mul_f32 v63, s100, v57
  v_cvt_pk_f16_f32 v92, v60, v61
  v_cvt_pk_bf16_f32 v76, v62, v63
  ds_write_b32 v3, v92 offset:1920
  ds_write_b32 v2, v76 offset:768
  v_mov_b32 v60, s100
  v_cvt_pk_bf16_f32 v60, v60, v60
  s_mov_b32 exec_hi, 0
  ds_write_b32 v2, v60 offset:2880
  s_mov_b32 exec_hi, -1
  s_waitcnt lgkmcnt(0)
  s_branch L_cconv
L_sdown:
  v_lshlrev_b32 v108, 16, v112
  v_and_b32 v109, 0xffff0000, v112
  v_mul_f32 v108, v108, v54
  v_mul_f32 v109, v109, v54
  v_cvt_pk_bf16_f32 v112, v108, v109
  v_lshlrev_b32 v108, 16, v113
  v_and_b32 v109, 0xffff0000, v113
  v_mul_f32 v108, v108, v54
  v_mul_f32 v109, v109, v54
  v_cvt_pk_bf16_f32 v113, v108, v109
  s_waitcnt lgkmcnt(14)
  v_lshlrev_b32 v108, 16, v114
  v_and_b32 v109, 0xffff0000, v114
  v_mul_f32 v108, v108, v54
  v_mul_f32 v109, v109, v54
  v_cvt_pk_bf16_f32 v114, v108, v109
  v_lshlrev_b32 v108, 16, v115
  v_and_b32 v109, 0xffff0000, v115
  v_mul_f32 v108, v108, v54
  v_mul_f32 v109, v109, v54
  v_cvt_pk_bf16_f32 v115, v108, v109
  v_lshlrev_b32 v108, 16, v116
  v_and_b32 v109, 0xffff0000, v116
  v_mul_f32 v108, v108, v54
  v_mul_f32 v109, v109, v54
  v_cvt_pk_bf16_f32 v116, v108, v109
  v_lshlrev_b32 v108, 16, v117
  v_and_b32 v109, 0xffff0000, v117
  v_mul_f32 v108, v108, v54
  v_mul_f32 v109, v109, v54
  v_cvt_pk_bf16_f32 v117, v108, v109
  v_lshlrev_b32 v108, 16, v118
  v_and_b32 v109, 0xffff0000, v118
  v_mul_f32 v108, v108, v54
  v_mul_f32 v109, v109, v54
  v_cvt_pk_bf16_f32 v118, v108, v109
  v_lshlrev_b32 v108, 16, v119
  v_and_b32 v109, 0xffff0000, v119
  v_mul_f32 v108, v108, v54
  v_mul_f32 v109, v109, v54
  v_cvt_pk_bf16_f32 v119, v108, v109
  s_branch L_scaled
L_end:
  s_endpgm
.section .rodata,"a"
.p2align 6
.amdhsa_kernel standalone__deep_cross_xdeepfm__recsys_kernel
  .amdhsa_next_free_vgpr 256
  .amdhsa_next_free_sgpr 102
  .amdhsa_accum_offset 256
  .amdhsa_group_segment_fixed_size 0
  .amdhsa_kernarg_size 88
  .amdhsa_user_sgpr_count 2
  .amdhsa_user_sgpr_kernarg_segment_ptr 1
  .amdhsa_system_sgpr_workgroup_id_x 1
  .amdhsa_float_denorm_mode_32 3
.end_amdhsa_kernel
```

```asm
; @launch grid=(256,1,1) block=(512,1,1) lds=163840
.amdgcn_target "amdgcn-amd-amdhsa--gfx950"
.text
.globl standalone__deep_cross_xdeepfm__recsys_kernel
.p2align 8
.type standalone__deep_cross_xdeepfm__recsys_kernel,@function
standalone__deep_cross_xdeepfm__recsys_kernel:
  s_cmp_ge_u32 s2, 256
  s_cbranch_scc1 L_end
  s_load_dwordx16 s[4:19], s[0:1], 0
  s_load_dwordx4 s[20:23], s[0:1], 64
  s_load_dwordx2 s[24:25], s[0:1], 80
  v_lshrrev_b32 v1, 6, v0
  s_getpc_b64 s[92:93]
L_pc:
  s_and_b32 s68, s2, 0xf8
  v_add_u32 v2, s68, v1
  v_and_b32_e64 v3, 32, v0
  v_lshl_add_u32 v2, v3, 3, v2
  v_lshlrev_b32 v2, 7, v2
  v_min_u32 v2, L_end-L_pc, v2
  v_mov_b32 v3, s93
  v_add_co_u32 v2, vcc, s92, v2
  s_nop 1
  v_addc_co_u32 v3, vcc, 0, v3, vcc
  global_load_dword v251, v[2:3], off
  v_and_b32_e64 v0, 63, v0
  v_readfirstlane_b32 s3, v1
  s_and_b32 s68, s2, 7
  s_lshr_b32 s69, s2, 3
  s_and_b32 s80, s2, 0xf8
  s_add_u32 s80, s80, s3
  s_lshl_b32 s80, s80, 21
  s_min_u32 s70, s68, 1
  s_add_u32 s71, s69, s70
  s_cmp_ge_u32 s71, 22
  s_cbranch_scc1 L_cin
  s_mul_i32 s68, s68, 21
  s_add_u32 s68, s68, s71
  s_mul_i32 s26, s68, 5042
  s_lshr_b32 s26, s26, 16
  s_mul_i32 s69, s26, 13
  s_sub_u32 s27, s68, s69
  s_lshl_b32 s77, s27, 8
  s_mul_i32 s71, s26, 320
  v_lshrrev_b32 v116, 4, v0
  v_lshlrev_b32 v11, 4, v0
  s_and_b32 s79, s3, 3
  s_cmp_lt_u32 s3, 4
  s_cbranch_scc1 L_cmp
  s_mul_i32 s68, s27, 13
  s_lshr_b32 s68, s68, 4
  s_mul_i32 s69, s79, 10
  s_mul_i32 s78, s71, 104
  v_mul_u32_u24 v118, 48, v116
  v_sub_u32 v12, v11, v118
  s_add_u32 s70, s68, 0
  s_sub_u32 s81, s70, 10
  s_min_u32 s70, s70, s81
  s_add_u32 s70, s70, s69
  s_lshl_b32 s36, s70, 10
  s_mul_i32 s70, s70, 832
  s_add_u32 s94, s70, s78
  s_and_b32 s70, s79, 1
  s_lshl_b32 s70, s70, 3
  v_lshlrev_b32 v117, 1, v116
  v_or_b32 v117, s70, v117
  v_xor_b32 v117, v117, v0
  v_and_b32 v117, 15, v117
  v_mul_u32_u24 v4, 3328, v116
  v_lshl_add_u32 v4, v117, 4, v4
  v_add_u32 v5, 13312, v4
  s_mul_i32 s74, s79, 26624
  s_add_u32 s74, s74, s77
  s_lshl_b32 s75, s79, 11
  s_waitcnt lgkmcnt(0)
  s_mov_b32 s28, s4
  s_and_b32 s29, s5, 0xffff
  s_mov_b32 s30, 425984
  s_mov_b32 s31, 0x20000
  buffer_load_dwordx4 v[16:19], v12, s[28:31], s94 offen
  s_mov_b32 s32, s6
  s_and_b32 s33, s7, 0xffff
  s_mov_b32 s34, 12800000
  s_mov_b32 s35, 0x20000
  v_mov_b32_e64 v114, s80
  buffer_load_dword v115, v114, s[32:35], 0 offen
  s_mov_b32 s44, s12
  s_and_b32 s45, s13, 0xffff
  s_mov_b32 s46, 5537792
  s_mov_b32 s47, 0x20000
  s_add_u32 m0, s75, 122880
  s_nop 0
  buffer_load_dwordx4 v4, s[44:47], s74 offen lds
  s_add_u32 m0, s75, 123904
  s_nop 0
  buffer_load_dwordx4 v5, s[44:47], s74 offen lds
  s_add_u32 s74, s74, 106496
  s_add_u32 s70, s68, 1
  s_sub_u32 s81, s70, 10
  s_min_u32 s70, s70, s81
  s_add_u32 s70, s70, s69
  s_lshl_b32 s37, s70, 10
  s_mul_i32 s70, s70, 832
  s_add_u32 s95, s70, s78
  buffer_load_dwordx4 v[20:23], v12, s[28:31], s95 offen
  s_add_u32 s70, s68, 2
  s_sub_u32 s81, s70, 10
  s_min_u32 s70, s70, s81
  s_add_u32 s70, s70, s69
  s_lshl_b32 s38, s70, 10
  s_mul_i32 s70, s70, 832
  s_add_u32 s96, s70, s78
  buffer_load_dwordx4 v[24:27], v12, s[28:31], s96 offen
  s_add_u32 s70, s68, 3
  s_sub_u32 s81, s70, 10
  s_min_u32 s70, s70, s81
  s_add_u32 s70, s70, s69
  s_lshl_b32 s39, s70, 10
  s_mul_i32 s70, s70, 832
  s_add_u32 s97, s70, s78
  buffer_load_dwordx4 v[28:31], v12, s[28:31], s97 offen
  s_add_u32 s70, s68, 4
  s_sub_u32 s81, s70, 10
  s_min_u32 s70, s70, s81
  s_add_u32 s70, s70, s69
  s_lshl_b32 s40, s70, 10
  s_mul_i32 s70, s70, 832
  s_add_u32 s98, s70, s78
  buffer_load_dwordx4 v[32:35], v12, s[28:31], s98 offen
  s_add_u32 s70, s68, 5
  s_sub_u32 s81, s70, 10
  s_min_u32 s70, s70, s81
  s_add_u32 s70, s70, s69
  s_lshl_b32 s41, s70, 10
  s_mul_i32 s70, s70, 832
  s_add_u32 s99, s70, s78
  buffer_load_dwordx4 v[36:39], v12, s[28:31], s99 offen
  s_add_u32 s70, s68, 6
  s_sub_u32 s81, s70, 10
  s_min_u32 s70, s70, s81
  s_add_u32 s70, s70, s69
  s_lshl_b32 s42, s70, 10
  s_mul_i32 s70, s70, 832
  s_add_u32 s100, s70, s78
  buffer_load_dwordx4 v[40:43], v12, s[28:31], s100 offen
  s_add_u32 s70, s68, 7
  s_sub_u32 s81, s70, 10
  s_min_u32 s70, s70, s81
  s_add_u32 s70, s70, s69
  s_lshl_b32 s43, s70, 10
  s_mul_i32 s70, s70, 832
  s_add_u32 s101, s70, s78
  buffer_load_dwordx4 v[44:47], v12, s[28:31], s101 offen
  s_add_u32 s70, s68, 8
  s_sub_u32 s81, s70, 10
  s_min_u32 s70, s70, s81
  s_add_u32 s70, s70, s69
  s_lshl_b32 s48, s70, 10
  s_mul_i32 s70, s70, 832
  s_add_u32 s82, s70, s78
  buffer_load_dwordx4 v[48:51], v12, s[28:31], s82 offen
  s_add_u32 s70, s68, 9
  s_sub_u32 s81, s70, 10
  s_min_u32 s70, s70, s81
  s_add_u32 s70, s70, s69
  s_lshl_b32 s49, s70, 10
  s_mul_i32 s70, s70, 832
  s_add_u32 s83, s70, s78
  buffer_load_dwordx4 v[52:55], v12, s[28:31], s83 offen
  s_and_b32 s70, s68, 1
  s_lshl_b32 s70, s70, 6
  v_and_b32 v118, 7, v0
  v_xor_b32 v118, v118, v116
  v_lshlrev_b32 v118, 4, v118
  v_xor_b32 v2, s70, v118
  v_xor_b32 v3, 64, v2
  s_mov_b32 s72, 0
  s_mul_i32 s70, s79, 13
  s_add_u32 s70, s70, s27
  s_min_u32 s70, s70, 39
  s_lshl_b32 s70, s70, 3
  s_add_u32 s70, s70, s71
  s_mul_i32 s84, s70, 104
  v_lshrrev_b32 v118, 2, v0
  v_min_u32 v118, 7, v118
  v_mul_u32_u24 v118, 104, v118
  v_and_b32 v117, 3, v0
  v_lshl_add_u32 v7, v117, 2, v118
  s_lshl_b32 s70, s26, 2
  s_add_u32 s70, s70, s79
  s_add_u32 s70, s70, 384
  s_mul_i32 s85, s70, 3328
  s_add_u32 s85, s85, s77
  s_mov_b32 s70, 173056
  v_lshrrev_b32 v118, 1, v0
  v_mul_lo_u32 v118, s70, v118
  v_and_b32 v117, 1, v0
  v_lshl_add_u32 v76, v117, 7, v118
  s_mov_b32 s52, s16
  s_and_b32 s53, s17, 0xffff
  s_mov_b32 s54, 3328
  s_mov_b32 s55, 0x20000
  s_mul_i32 s70, s79, 2560
  s_add_u32 s70, s70, L_tail-L_pc
  v_lshlrev_b32 v8, 7, v0
  v_add_u32 v8, s70, v8
  v_mov_b32 v9, s93
  v_add_co_u32 v8, vcc, s92, v8
  s_nop 1
  v_addc_co_u32 v9, vcc, 0, v9, vcc
  s_waitcnt vmcnt(12)
  v_lshlrev_b32 v16, 7, v16
  v_lshlrev_b32 v18, 7, v18
  v_lshlrev_b32 v17, 7, v17
  v_lshlrev_b32_e64 v19, 7, v19
  v_add_u32_dpp v56, v16, v2 row_newbcast:0 row_mask:0xf bank_mask:0x3
  s_nop 1
  v_add_u32_dpp v56, v18, v2 row_newbcast:6 row_mask:0xf bank_mask:0xc
  s_add_u32 m0, s36, 0
  s_nop 0
  buffer_load_dwordx4 v56, s[32:35], 0 offen lds
  s_add_u32 m0, s75, 131072
  s_nop 0
  buffer_load_dwordx4 v4, s[44:47], s74 offen lds
  s_add_u32 m0, s75, 132096
  s_nop 0
  buffer_load_dwordx4 v5, s[44:47], s74 offen lds
  s_add_u32 s74, s74, 106496
  s_waitcnt vmcnt(11)
  v_lshlrev_b32 v20, 7, v20
  v_lshlrev_b32 v22, 7, v22
  v_lshlrev_b32 v21, 7, v21
  v_lshlrev_b32 v23, 7, v23
  v_add_u32_dpp v57, v20, v3 row_newbcast:0 row_mask:0xf bank_mask:0x3
  s_nop 1
  v_add_u32_dpp v57, v22, v3 row_newbcast:6 row_mask:0xf bank_mask:0xc
  s_add_u32 m0, s37, 0
  s_nop 0
  buffer_load_dwordx4 v57, s[32:35], 0 offen lds
  s_waitcnt vmcnt(11)
  v_lshlrev_b32 v24, 7, v24
  v_lshlrev_b32 v26, 7, v26
  v_lshlrev_b32 v25, 7, v25
  v_lshlrev_b32_e64 v27, 7, v27
  v_add_u32_dpp v58, v24, v2 row_newbcast:0 row_mask:0xf bank_mask:0x3
  s_nop 1
  v_add_u32_dpp v58, v26, v2 row_newbcast:6 row_mask:0xf bank_mask:0xc
  s_add_u32 m0, s38, 0
  s_nop 0
  buffer_load_dwordx4 v58, s[32:35], 0 offen lds
  s_waitcnt vmcnt(11)
  v_lshlrev_b32 v28, 7, v28
  v_lshlrev_b32 v30, 7, v30
  v_lshlrev_b32 v29, 7, v29
  v_lshlrev_b32 v31, 7, v31
  v_add_u32_dpp v59, v28, v3 row_newbcast:0 row_mask:0xf bank_mask:0x3
  s_nop 1
  v_add_u32_dpp v59, v30, v3 row_newbcast:6 row_mask:0xf bank_mask:0xc
  s_add_u32 m0, s39, 0
  s_nop 0
  buffer_load_dwordx4 v59, s[32:35], 0 offen lds
  s_waitcnt vmcnt(11)
  v_lshlrev_b32 v32, 7, v32
  v_lshlrev_b32 v34, 7, v34
  v_lshlrev_b32 v33, 7, v33
  v_lshlrev_b32 v35, 7, v35
  v_add_u32_dpp v60, v32, v2 row_newbcast:0 row_mask:0xf bank_mask:0x3
  s_nop 1
  v_add_u32_dpp v60, v34, v2 row_newbcast:6 row_mask:0xf bank_mask:0xc
  s_add_u32 m0, s40, 0
  s_nop 0
  buffer_load_dwordx4 v60, s[32:35], 0 offen lds
  s_waitcnt vmcnt(11)
  v_lshlrev_b32 v36, 7, v36
  v_lshlrev_b32 v38, 7, v38
  v_lshlrev_b32 v37, 7, v37
  v_lshlrev_b32 v39, 7, v39
  v_add_u32_dpp v61, v36, v3 row_newbcast:0 row_mask:0xf bank_mask:0x3
  s_nop 1
  v_add_u32_dpp v61, v38, v3 row_newbcast:6 row_mask:0xf bank_mask:0xc
  s_add_u32 m0, s41, 0
  s_nop 0
  buffer_load_dwordx4 v61, s[32:35], 0 offen lds
  s_waitcnt vmcnt(11)
  v_lshlrev_b32 v40, 7, v40
  v_lshlrev_b32 v42, 7, v42
  v_lshlrev_b32 v41, 7, v41
  v_lshlrev_b32 v43, 7, v43
  v_add_u32_dpp v62, v40, v2 row_newbcast:0 row_mask:0xf bank_mask:0x3
  s_nop 1
  v_add_u32_dpp v62, v42, v2 row_newbcast:6 row_mask:0xf bank_mask:0xc
  s_add_u32 m0, s42, 0
  s_nop 0
  buffer_load_dwordx4 v62, s[32:35], 0 offen lds
  s_waitcnt vmcnt(11)
  v_lshlrev_b32 v44, 7, v44
  v_lshlrev_b32 v46, 7, v46
  v_lshlrev_b32 v45, 7, v45
  v_lshlrev_b32 v47, 7, v47
  v_add_u32_dpp v63, v44, v3 row_newbcast:0 row_mask:0xf bank_mask:0x3
  s_nop 1
  v_add_u32_dpp v63, v46, v3 row_newbcast:6 row_mask:0xf bank_mask:0xc
  s_add_u32 m0, s43, 0
  s_nop 0
  buffer_load_dwordx4 v63, s[32:35], 0 offen lds
  s_waitcnt vmcnt(11)
  v_lshlrev_b32 v48, 7, v48
  v_lshlrev_b32 v50, 7, v50
  v_lshlrev_b32 v49, 7, v49
  v_lshlrev_b32 v51, 7, v51
  v_add_u32_dpp v64, v48, v2 row_newbcast:0 row_mask:0xf bank_mask:0x3
  s_nop 1
  v_add_u32_dpp v64, v50, v2 row_newbcast:6 row_mask:0xf bank_mask:0xc
  s_add_u32 m0, s48, 0
  s_nop 0
  buffer_load_dwordx4 v64, s[32:35], 0 offen lds
  s_waitcnt vmcnt(11)
  v_lshlrev_b32 v52, 7, v52
  v_lshlrev_b32 v54, 7, v54
  v_lshlrev_b32 v53, 7, v53
  v_lshlrev_b32_e64 v55, 7, v55
  v_add_u32_dpp v65, v52, v3 row_newbcast:0 row_mask:0xf bank_mask:0x3
  s_nop 1
  v_add_u32_dpp v65, v54, v3 row_newbcast:6 row_mask:0xf bank_mask:0xc
  s_add_u32 m0, s49, 0
  s_nop 0
  buffer_load_dwordx4 v65, s[32:35], 0 offen lds
  v_add_u32_dpp v56, v17, v2 row_newbcast:0 row_mask:0xf bank_mask:0x3
  s_nop 1
  v_add_u32_dpp v56, v19, v2 row_newbcast:6 row_mask:0xf bank_mask:0xc
  s_add_u32 m0, s36, 40960
  s_nop 0
  buffer_load_dwordx4 v56, s[32:35], 0 offen lds
  v_add_u32_dpp v57, v21, v3 row_newbcast:0 row_mask:0xf bank_mask:0x3
  s_nop 1
  v_add_u32_dpp v57, v23, v3 row_newbcast:6 row_mask:0xf bank_mask:0xc
  s_add_u32 m0, s37, 40960
  s_nop 0
  buffer_load_dwordx4 v57, s[32:35], 0 offen lds
  v_add_u32_dpp v58, v25, v2 row_newbcast:0 row_mask:0xf bank_mask:0x3
  s_nop 1
  v_add_u32_dpp v58, v27, v2 row_newbcast:6 row_mask:0xf bank_mask:0xc
  s_add_u32 m0, s38, 40960
  s_nop 0
  buffer_load_dwordx4 v58, s[32:35], 0 offen lds
  v_add_u32_dpp v59, v29, v3 row_newbcast:0 row_mask:0xf bank_mask:0x3
  s_nop 1
  v_add_u32_dpp v59, v31, v3 row_newbcast:6 row_mask:0xf bank_mask:0xc
  s_add_u32 m0, s39, 40960
  s_nop 0
  buffer_load_dwordx4 v59, s[32:35], 0 offen lds
  s_waitcnt vmcnt(4)
  s_barrier
  v_add_u32_dpp v60, v33, v2 row_newbcast:0 row_mask:0xf bank_mask:0x3
  s_nop 1
  v_add_u32_dpp v60, v35, v2 row_newbcast:6 row_mask:0xf bank_mask:0xc
  s_add_u32 m0, s40, 40960
  s_nop 0
  buffer_load_dwordx4 v60, s[32:35], 0 offen lds
  v_add_u32_dpp v61, v37, v3 row_newbcast:0 row_mask:0xf bank_mask:0x3
  s_nop 1
  v_add_u32_dpp v61, v39, v3 row_newbcast:6 row_mask:0xf bank_mask:0xc
  s_add_u32 m0, s41, 40960
  s_nop 0
  buffer_load_dwordx4 v61, s[32:35], 0 offen lds
  v_add_u32_dpp v62, v41, v2 row_newbcast:0 row_mask:0xf bank_mask:0x3
  s_nop 1
  v_add_u32_dpp v62, v43, v2 row_newbcast:6 row_mask:0xf bank_mask:0xc
  s_add_u32 m0, s42, 40960
  s_nop 0
  buffer_load_dwordx4 v62, s[32:35], 0 offen lds
  s_barrier
  v_add_u32_dpp v63, v45, v3 row_newbcast:0 row_mask:0xf bank_mask:0x3
  s_nop 1
  v_add_u32_dpp v63, v47, v3 row_newbcast:6 row_mask:0xf bank_mask:0xc
  s_add_u32 m0, s43, 40960
  s_nop 0
  buffer_load_dwordx4 v63, s[32:35], 0 offen lds
  v_add_u32_dpp v64, v49, v2 row_newbcast:0 row_mask:0xf bank_mask:0x3
  s_nop 1
  v_add_u32_dpp v64, v51, v2 row_newbcast:6 row_mask:0xf bank_mask:0xc
  s_add_u32 m0, s48, 40960
  s_nop 0
  buffer_load_dwordx4 v64, s[32:35], 0 offen lds
  v_add_u32_dpp v65, v53, v3 row_newbcast:0 row_mask:0xf bank_mask:0x3
  s_nop 1
  v_add_u32_dpp v65, v55, v3 row_newbcast:6 row_mask:0xf bank_mask:0xc
  s_add_u32 m0, s49, 40960
  s_nop 0
  buffer_load_dwordx4 v65, s[32:35], 0 offen lds
  v_add_u32_dpp v56, v18, v2 row_newbcast:0 row_mask:0xf bank_mask:0x3
  v_add_u32_dpp v57, v22, v3 row_newbcast:0 row_mask:0xf bank_mask:0x3
  v_add_u32_dpp v58, v26, v2 row_newbcast:0 row_mask:0xf bank_mask:0x3
  v_add_u32_dpp v59, v30, v3 row_newbcast:0 row_mask:0xf bank_mask:0x3
  v_add_u32_dpp v60, v34, v2 row_newbcast:0 row_mask:0xf bank_mask:0x3
  v_add_u32_dpp v61, v38, v3 row_newbcast:0 row_mask:0xf bank_mask:0x3
  v_add_u32_dpp v62, v42, v2 row_newbcast:0 row_mask:0xf bank_mask:0x3
  v_add_u32_dpp v63, v46, v3 row_newbcast:0 row_mask:0xf bank_mask:0x3
  v_add_u32_dpp v64, v50, v2 row_newbcast:0 row_mask:0xf bank_mask:0x3
  v_add_u32_dpp v65, v54, v3 row_newbcast:0 row_mask:0xf bank_mask:0x3
  v_add_u32_dpp v56, v16, v2 row_newbcast:7 row_mask:0xf bank_mask:0xc
  v_add_u32_dpp v57, v20, v3 row_newbcast:7 row_mask:0xf bank_mask:0xc
  v_add_u32_dpp v58, v24, v2 row_newbcast:7 row_mask:0xf bank_mask:0xc
  v_add_u32_dpp v59, v28, v3 row_newbcast:7 row_mask:0xf bank_mask:0xc
  v_add_u32_dpp v60, v32, v2 row_newbcast:7 row_mask:0xf bank_mask:0xc
  v_add_u32_dpp v61, v36, v3 row_newbcast:7 row_mask:0xf bank_mask:0xc
  v_add_u32_dpp v62, v40, v2 row_newbcast:7 row_mask:0xf bank_mask:0xc
  v_add_u32_dpp v63, v44, v3 row_newbcast:7 row_mask:0xf bank_mask:0xc
  v_add_u32_dpp v64, v48, v2 row_newbcast:7 row_mask:0xf bank_mask:0xc
  v_add_u32_dpp v65, v52, v3 row_newbcast:7 row_mask:0xf bank_mask:0xc
  s_add_u32 m0, s75, 139264
  s_nop 0
  buffer_load_dwordx4 v4, s[44:47], s74 offen lds
  s_add_u32 m0, s75, 140288
  s_nop 0
  buffer_load_dwordx4 v5, s[44:47], s74 offen lds
  s_add_u32 s74, s74, 106496
  s_add_u32 m0, s36, 81920
  s_nop 0
  buffer_load_dwordx4 v56, s[32:35], 0 offen lds
  s_add_u32 m0, s37, 81920
  s_nop 0
  buffer_load_dwordx4 v57, s[32:35], 0 offen lds
  s_add_u32 m0, s38, 81920
  s_nop 0
  buffer_load_dwordx4 v58, s[32:35], 0 offen lds
  s_add_u32 m0, s39, 81920
  s_nop 0
  buffer_load_dwordx4 v59, s[32:35], 0 offen lds
  s_add_u32 m0, s40, 81920
  s_nop 0
  buffer_load_dwordx4 v60, s[32:35], 0 offen lds
  s_setprio 0
  s_branch L_ld_in
L_cmp:
  s_mul_i32 s70, s3, 13
  v_min_u32 v118, 12, v0
  v_add_u32 v118, s70, v118
  v_lshrrev_b32_e64 v117, 1, v118
  v_mul_u32_u24 v117, 96, v117
  v_lshl_add_u32 v118, v118, 2, v117
  s_mul_i32 s78, s27, 25
  s_min_u32 s78, s78, 294
  s_add_u32 s78, s78, s71
  s_mul_i32 s78, s78, 104
  s_waitcnt lgkmcnt(0)
  s_mov_b32 s28, s4
  s_and_b32 s29, s5, 0xffff
  s_mov_b32 s30, 425984
  s_mov_b32 s31, 0x20000
  buffer_load_dwordx4 v[100:103], v118, s[28:31], s78 offen
  s_mov_b32 s32, s6
  s_and_b32 s33, s7, 0xffff
  s_mov_b32 s34, 12800000
  s_mov_b32 s35, 0x20000
  v_mov_b32 v114, s80
  buffer_load_dword v115, v114, s[32:35], 0 offen
  s_mov_b32 s48, s14
  s_and_b32 s49, s15, 0xffff
  s_mov_b32 s50, 3328
  s_mov_b32 s51, 0x20000
  s_mov_b32 m0, 147456
  s_mov_b64 exec, 0xffff
  buffer_load_dwordx4 v11, s[48:51], s77 offen lds
  s_mov_b64 exec, -1
  s_and_b32 s68, s3, 1
  s_lshr_b32 s69, s3, 1
  v_bfe_u32 v117, v0, 2, 2
  v_lshl_add_u32 v118, v116, 3, v117
  v_lshlrev_b32 v118, 8, v118
  v_bfe_u32 v117, v0, 2, 3
  s_lshl_b32 s70, s69, 2
  v_xor_b32 v117, s70, v117
  v_lshl_add_u32 v118, v117, 5, v118
  v_and_b32 v117, 3, v0
  v_lshl_add_u32 v118, v117, 3, v118
  v_add_u32 v1, 122880, v118
  v_xor_b32 v2, 32, v1
  v_xor_b32 v3, 64, v1
  v_xor_b32 v4, 96, v1
  s_lshl_b32 s70, s69, 7
  s_add_u32 s70, s70, 147456
  v_lshlrev_b32 v118, 3, v116
  v_add_u32 v9, s70, v118
  v_and_b32 v118, 15, v0
  v_lshlrev_b32 v118, 7, v118
  v_bfe_u32 v117, v0, 1, 3
  v_xor_b32 v117, v117, v116
  v_lshl_add_u32 v118, v117, 4, v118
  s_mul_i32 s70, s68, 20480
  v_add_u32 v5, s70, v118
  v_xor_b32 v7, 64, v5
  v_add_u32 v6, 81920, v5
  v_add_u32 v8, 81920, v7
  s_mul_i32 s70, s3, 640
  s_add_u32 s70, s70, 147968
  v_and_b32 v118, 15, v0
  v_lshlrev_b32 v118, 2, v118
  v_add_u32 v118, s70, v118
  v_lshrrev_b32_e64 v117, 5, v0
  v_lshl_add_u32 v118, v117, 6, v118
  v_bfe_u32 v117, v0, 4, 1
  v_lshl_add_u32 v10, v117, 7, v118
  s_mov_b32 s72, 0
  v_mov_b32 v12, 0xc0135761
  v_mov_b32 v13, 0xc0135761
  v_mov_b32 v14, 0xbdd2d3e8
  v_mov_b32 v15, 0xbdd2d3e8
  v_mov_b32 v248, 1.0
  v_mov_b32 v249, 1.0
  s_waitcnt vmcnt(2)
  v_lshlrev_b32_e64 v102, 7, v102
  buffer_load_dword v50, v102, s[32:35], 0 offen
  s_waitcnt vmcnt(1)
  ds_read_b64 v[18:19], v9 offset:0
  ds_read_b64 v[22:23], v9 offset:32
  ds_read_b64 v[26:27], v9 offset:64
  ds_read_b64 v[30:31], v9 offset:96
  s_waitcnt lgkmcnt(3)
  v_lshlrev_b32 v16, 16, v18
  v_and_b32 v17, 0xffff0000, v18
  v_lshlrev_b32 v18, 16, v19
  v_and_b32 v19, 0xffff0000, v19
  s_waitcnt lgkmcnt(2)
  v_lshlrev_b32 v20, 16, v22
  v_and_b32 v21, 0xffff0000, v22
  v_lshlrev_b32 v22, 16, v23
  v_and_b32 v23, 0xffff0000, v23
  s_waitcnt lgkmcnt(1)
  v_lshlrev_b32 v24, 16, v26
  v_and_b32 v25, 0xffff0000, v26
  v_lshlrev_b32 v26, 16, v27
  v_and_b32 v27, 0xffff0000, v27
  s_waitcnt lgkmcnt(0)
  v_lshlrev_b32 v28, 16, v30
  v_and_b32 v29, 0xffff0000, v30
  v_lshlrev_b32 v30, 16, v31
  v_and_b32 v31, 0xffff0000, v31
  v_mov_b64 v[88:89], v[16:17]
  v_mov_b64 v[90:91], v[18:19]
  v_mov_b64 v[92:93], v[20:21]
  v_mov_b64 v[94:95], v[22:23]
  v_mov_b64 v[96:97], v[24:25]
  v_mov_b64 v[98:99], v[26:27]
  v_mov_b64 v[100:101], v[28:29]
  v_mov_b64 v[102:103], v[30:31]
  v_mov_b64 v[104:105], v[16:17]
  v_mov_b64 v[106:107], v[18:19]
  v_mov_b64 v[108:109], v[20:21]
  v_mov_b64 v[110:111], v[22:23]
  v_mov_b64 v[112:113], v[24:25]
  v_mov_b64 v[114:115], v[26:27]
  v_mov_b64 v[116:117], v[28:29]
  v_mov_b64 v[118:119], v[30:31]
  v_mov_b64 v[120:121], v[16:17]
  v_mov_b64 v[122:123], v[18:19]
  v_mov_b64 v[124:125], v[20:21]
  v_mov_b64 v[126:127], v[22:23]
  v_mov_b64 v[128:129], v[24:25]
  v_mov_b64 v[130:131], v[26:27]
  v_mov_b64 v[132:133], v[28:29]
  v_mov_b64 v[134:135], v[30:31]
  v_mov_b64 v[136:137], v[16:17]
  v_mov_b64 v[138:139], v[18:19]
  v_mov_b64 v[140:141], v[20:21]
  v_mov_b64 v[142:143], v[22:23]
  v_mov_b64 v[144:145], v[24:25]
  v_mov_b64 v[146:147], v[26:27]
  v_mov_b64 v[148:149], v[28:29]
  v_mov_b64 v[150:151], v[30:31]
  v_mov_b64 v[152:153], v[16:17]
  v_mov_b64 v[154:155], v[18:19]
  v_mov_b64 v[156:157], v[20:21]
  v_mov_b64 v[158:159], v[22:23]
  v_mov_b64 v[160:161], v[24:25]
  v_mov_b64 v[162:163], v[26:27]
  v_mov_b64 v[164:165], v[28:29]
  v_mov_b64 v[166:167], v[30:31]
  v_mov_b64 v[168:169], v[16:17]
  v_mov_b64 v[170:171], v[18:19]
  v_mov_b64 v[172:173], v[20:21]
  v_mov_b64 v[174:175], v[22:23]
  v_mov_b64 v[176:177], v[24:25]
  v_mov_b64 v[178:179], v[26:27]
  v_mov_b64 v[180:181], v[28:29]
  v_mov_b64 v[182:183], v[30:31]
  v_mov_b64 v[184:185], v[16:17]
  v_mov_b64 v[186:187], v[18:19]
  v_mov_b64 v[188:189], v[20:21]
  v_mov_b64 v[190:191], v[22:23]
  v_mov_b64 v[192:193], v[24:25]
  v_mov_b64 v[194:195], v[26:27]
  v_mov_b64 v[196:197], v[28:29]
  v_mov_b64 v[198:199], v[30:31]
  v_mov_b64 v[200:201], v[16:17]
  v_mov_b64 v[202:203], v[18:19]
  v_mov_b64 v[204:205], v[20:21]
  v_mov_b64 v[206:207], v[22:23]
  v_mov_b64 v[208:209], v[24:25]
  v_mov_b64 v[210:211], v[26:27]
  v_mov_b64 v[212:213], v[28:29]
  v_mov_b64 v[214:215], v[30:31]
  v_mov_b64 v[216:217], v[16:17]
  v_mov_b64 v[218:219], v[18:19]
  v_mov_b64 v[220:221], v[20:21]
  v_mov_b64 v[222:223], v[22:23]
  v_mov_b64 v[224:225], v[24:25]
  v_mov_b64 v[226:227], v[26:27]
  v_mov_b64 v[228:229], v[28:29]
  v_mov_b64 v[230:231], v[30:31]
  v_mov_b64 v[232:233], v[16:17]
  v_mov_b64 v[234:235], v[18:19]
  v_mov_b64 v[236:237], v[20:21]
  v_mov_b64 v[238:239], v[22:23]
  v_mov_b64 v[240:241], v[24:25]
  v_mov_b64 v[242:243], v[26:27]
  v_mov_b64 v[244:245], v[28:29]
  v_mov_b64 v[246:247], v[30:31]
  s_barrier
  s_setprio 1
  ds_read_b64_tr_b16 v[16:17], v1 offset:0
  ds_read_b64_tr_b16 v[18:19], v1 offset:1024
  s_waitcnt vmcnt(0)
  ds_read_b128 v[48:51], v5 offset:0
  ds_read_b64_tr_b16 v[20:21], v2 offset:0
  ds_read_b64_tr_b16 v[22:23], v2 offset:1024
  ds_read_b64_tr_b16 v[24:25], v3 offset:0
  ds_read_b64_tr_b16 v[26:27], v3 offset:1024
  ds_read_b64_tr_b16 v[28:29], v4 offset:0
  ds_read_b64_tr_b16 v[30:31], v4 offset:1024
  ds_read_b128 v[52:55], v5 offset:2048
  ds_read_b128 v[56:59], v5 offset:4096
  ds_read_b128 v[60:63], v5 offset:6144
  ds_read_b128 v[64:67], v5 offset:8192
  ds_read_b128 v[68:71], v5 offset:10240
  ds_read_b128 v[72:75], v5 offset:12288
  ds_read_b128 v[76:79], v5 offset:14336
  ds_read_b128 v[80:83], v5 offset:16384
  ds_read_b128 v[84:87], v5 offset:18432
L_dnn_loop0:
  s_waitcnt lgkmcnt(14)
  v_mfma_f32_16x16x32_bf16 v[88:91], v[16:19], v[48:51], v[88:91]
  s_waitcnt lgkmcnt(13)
  v_mfma_f32_16x16x32_bf16 v[92:95], v[20:23], v[48:51], v[92:95]
  s_waitcnt lgkmcnt(11)
  v_mfma_f32_16x16x32_bf16 v[96:99], v[24:27], v[48:51], v[96:99]
  s_nop 0
  s_waitcnt lgkmcnt(9)
  v_mfma_f32_16x16x32_bf16 v[100:103], v[28:31], v[48:51], v[100:103]
  s_waitcnt lgkmcnt(8)
  v_mfma_f32_16x16x32_bf16 v[116:119], v[28:31], v[52:55], v[116:119]
  v_mfma_f32_16x16x32_bf16 v[112:115], v[24:27], v[52:55], v[112:115]
  v_mfma_f32_16x16x32_bf16 v[108:111], v[20:23], v[52:55], v[108:111]
  v_mfma_f32_16x16x32_bf16 v[104:107], v[16:19], v[52:55], v[104:107]
  s_waitcnt lgkmcnt(0)
  s_barrier
  v_mfma_f32_16x16x32_bf16 v[120:123], v[16:19], v[56:59], v[120:123]
  s_nop 0
  ds_read_b128 v[48:51], v7 offset:0
  v_mfma_f32_16x16x32_bf16 v[124:127], v[20:23], v[56:59], v[124:127]
  ds_read_b128 v[52:55], v7 offset:2048
  v_mfma_f32_16x16x32_bf16 v[128:131], v[24:27], v[56:59], v[128:131]
  ds_read_b64_tr_b16 v[32:33], v1 offset:8192
  v_mfma_f32_16x16x32_bf16 v[132:135], v[28:31], v[56:59], v[132:135]
  ds_read_b128 v[56:59], v7 offset:4096
  v_mfma_f32_16x16x32_bf16 v[148:151], v[28:31], v[60:63], v[148:151]
  ds_read_b64_tr_b16 v[34:35], v1 offset:9216
  v_mfma_f32_16x16x32_bf16 v[144:147], v[24:27], v[60:63], v[144:147]
  ds_read_b64_tr_b16 v[36:37], v2 offset:8192
  v_mfma_f32_16x16x32_bf16 v[140:143], v[20:23], v[60:63], v[140:143]
  ds_read_b64_tr_b16 v[38:39], v2 offset:9216
  v_mfma_f32_16x16x32_bf16 v[136:139], v[16:19], v[60:63], v[136:139]
  ds_read_b128 v[60:63], v7 offset:6144
  v_mfma_f32_16x16x32_bf16 v[152:155], v[16:19], v[64:67], v[152:155]
  ds_read_b64_tr_b16 v[40:41], v3 offset:8192
  v_mfma_f32_16x16x32_bf16 v[156:159], v[20:23], v[64:67], v[156:159]
  ds_read_b64_tr_b16 v[42:43], v3 offset:9216
  v_mfma_f32_16x16x32_bf16 v[160:163], v[24:27], v[64:67], v[160:163]
  ds_read_b64_tr_b16 v[44:45], v4 offset:8192
  v_mfma_f32_16x16x32_bf16 v[164:167], v[28:31], v[64:67], v[164:167]
  ds_read_b128 v[64:67], v7 offset:8192
  v_mfma_f32_16x16x32_bf16 v[180:183], v[28:31], v[68:71], v[180:183]
  ds_read_b64_tr_b16 v[46:47], v4 offset:9216
  v_mfma_f32_16x16x32_bf16 v[176:179], v[24:27], v[68:71], v[176:179]
  v_mfma_f32_16x16x32_bf16 v[172:175], v[20:23], v[68:71], v[172:175]
  v_mfma_f32_16x16x32_bf16 v[168:171], v[16:19], v[68:71], v[168:171]
  ds_read_b128 v[68:71], v7 offset:10240
  v_mfma_f32_16x16x32_bf16 v[184:187], v[16:19], v[72:75], v[184:187]
  v_mfma_f32_16x16x32_bf16 v[188:191], v[20:23], v[72:75], v[188:191]
  v_mfma_f32_16x16x32_bf16 v[192:195], v[24:27], v[72:75], v[192:195]
  v_mfma_f32_16x16x32_bf16 v[196:199], v[28:31], v[72:75], v[196:199]
  ds_read_b128 v[72:75], v7 offset:12288
  v_mfma_f32_16x16x32_bf16 v[212:215], v[28:31], v[76:79], v[212:215]
  v_mfma_f32_16x16x32_bf16 v[208:211], v[24:27], v[76:79], v[208:211]
  v_mfma_f32_16x16x32_bf16 v[204:207], v[20:23], v[76:79], v[204:207]
  v_mfma_f32_16x16x32_bf16 v[200:203], v[16:19], v[76:79], v[200:203]
  ds_read_b128 v[76:79], v7 offset:14336
  v_mfma_f32_16x16x32_bf16 v[216:219], v[16:19], v[80:83], v[216:219]
  v_mfma_f32_16x16x32_bf16 v[220:223], v[20:23], v[80:83], v[220:223]
  v_mfma_f32_16x16x32_bf16 v[224:227], v[24:27], v[80:83], v[224:227]
  v_mfma_f32_16x16x32_bf16 v[228:231], v[28:31], v[80:83], v[228:231]
  ds_read_b128 v[80:83], v7 offset:16384
  v_mfma_f32_16x16x32_bf16 v[244:247], v[28:31], v[84:87], v[244:247]
  s_waitcnt lgkmcnt(4)
  v_mfma_f32_16x16x32_bf16 v[240:243], v[24:27], v[84:87], v[240:243]
  v_mfma_f32_16x16x32_bf16 v[236:239], v[20:23], v[84:87], v[236:239]
  s_nop 0
  v_mfma_f32_16x16x32_bf16 v[232:235], v[16:19], v[84:87], v[232:235]
  ds_read_b128 v[84:87], v7 offset:18432
  v_mfma_f32_16x16x32_bf16 v[88:91], v[32:35], v[48:51], v[88:91]
  v_mfma_f32_16x16x32_bf16 v[92:95], v[36:39], v[48:51], v[92:95]
  v_mfma_f32_16x16x32_bf16 v[96:99], v[40:43], v[48:51], v[96:99]
  v_mfma_f32_16x16x32_bf16 v[100:103], v[44:47], v[48:51], v[100:103]
  v_mfma_f32_16x16x32_bf16 v[116:119], v[44:47], v[52:55], v[116:119]
  v_mfma_f32_16x16x32_bf16 v[112:115], v[40:43], v[52:55], v[112:115]
  v_mfma_f32_16x16x32_bf16 v[108:111], v[36:39], v[52:55], v[108:111]
  v_mfma_f32_16x16x32_bf16 v[104:107], v[32:35], v[52:55], v[104:107]
  s_waitcnt lgkmcnt(0)
  s_barrier
  v_mfma_f32_16x16x32_bf16 v[120:123], v[32:35], v[56:59], v[120:123]
  ds_read_b128 v[48:51], v5 offset:40960
  v_mfma_f32_16x16x32_bf16 v[124:127], v[36:39], v[56:59], v[124:127]
  ds_read_b128 v[52:55], v5 offset:43008
  v_mfma_f32_16x16x32_bf16 v[128:131], v[40:43], v[56:59], v[128:131]
  ds_read_b64_tr_b16 v[16:17], v1 offset:16384
  v_mfma_f32_16x16x32_bf16 v[132:135], v[44:47], v[56:59], v[132:135]
  ds_read_b128 v[56:59], v5 offset:45056
  v_mfma_f32_16x16x32_bf16 v[148:151], v[44:47], v[60:63], v[148:151]
  ds_read_b64_tr_b16 v[18:19], v1 offset:17408
  v_mfma_f32_16x16x32_bf16 v[144:147], v[40:43], v[60:63], v[144:147]
  ds_read_b64_tr_b16 v[20:21], v2 offset:16384
  v_mfma_f32_16x16x32_bf16 v[140:143], v[36:39], v[60:63], v[140:143]
  ds_read_b64_tr_b16 v[22:23], v2 offset:17408
  v_mfma_f32_16x16x32_bf16 v[136:139], v[32:35], v[60:63], v[136:139]
  ds_read_b128 v[60:63], v5 offset:47104
  v_mfma_f32_16x16x32_bf16 v[152:155], v[32:35], v[64:67], v[152:155]
  ds_read_b64_tr_b16 v[24:25], v3 offset:16384
  v_mfma_f32_16x16x32_bf16 v[156:159], v[36:39], v[64:67], v[156:159]
  ds_read_b64_tr_b16 v[26:27], v3 offset:17408
  v_mfma_f32_16x16x32_bf16 v[160:163], v[40:43], v[64:67], v[160:163]
  ds_read_b64_tr_b16 v[28:29], v4 offset:16384
  v_mfma_f32_16x16x32_bf16 v[164:167], v[44:47], v[64:67], v[164:167]
  ds_read_b128 v[64:67], v5 offset:49152
  v_mfma_f32_16x16x32_bf16 v[180:183], v[44:47], v[68:71], v[180:183]
  ds_read_b64_tr_b16 v[30:31], v4 offset:17408
  v_mfma_f32_16x16x32_bf16 v[176:179], v[40:43], v[68:71], v[176:179]
  v_mfma_f32_16x16x32_bf16 v[172:175], v[36:39], v[68:71], v[172:175]
  v_mfma_f32_16x16x32_bf16 v[168:171], v[32:35], v[68:71], v[168:171]
  ds_read_b128 v[68:71], v5 offset:51200
  v_mfma_f32_16x16x32_bf16 v[184:187], v[32:35], v[72:75], v[184:187]
  v_mfma_f32_16x16x32_bf16 v[188:191], v[36:39], v[72:75], v[188:191]
  v_mfma_f32_16x16x32_bf16 v[192:195], v[40:43], v[72:75], v[192:195]
  v_mfma_f32_16x16x32_bf16 v[196:199], v[44:47], v[72:75], v[196:199]
  ds_read_b128 v[72:75], v5 offset:53248
  v_mfma_f32_16x16x32_bf16 v[212:215], v[44:47], v[76:79], v[212:215]
  v_mfma_f32_16x16x32_bf16 v[208:211], v[40:43], v[76:79], v[208:211]
  v_mfma_f32_16x16x32_bf16 v[204:207], v[36:39], v[76:79], v[204:207]
  v_mfma_f32_16x16x32_bf16 v[200:203], v[32:35], v[76:79], v[200:203]
  ds_read_b128 v[76:79], v5 offset:55296
  v_mfma_f32_16x16x32_bf16 v[216:219], v[32:35], v[80:83], v[216:219]
  v_mfma_f32_16x16x32_bf16 v[220:223], v[36:39], v[80:83], v[220:223]
  v_mfma_f32_16x16x32_bf16 v[224:227], v[40:43], v[80:83], v[224:227]
  v_mfma_f32_16x16x32_bf16 v[228:231], v[44:47], v[80:83], v[228:231]
  ds_read_b128 v[80:83], v5 offset:57344
  v_mfma_f32_16x16x32_bf16 v[244:247], v[44:47], v[84:87], v[244:247]
  s_waitcnt lgkmcnt(4)
  v_mfma_f32_16x16x32_bf16 v[240:243], v[40:43], v[84:87], v[240:243]
  v_mfma_f32_16x16x32_bf16 v[236:239], v[36:39], v[84:87], v[236:239]
  v_mfma_f32_16x16x32_bf16 v[232:235], v[32:35], v[84:87], v[232:235]
  ds_read_b128 v[84:87], v5 offset:59392
  v_mfma_f32_16x16x32_bf16 v[88:91], v[16:19], v[48:51], v[88:91]
  v_mfma_f32_16x16x32_bf16 v[92:95], v[20:23], v[48:51], v[92:95]
  s_nop 0
  v_mfma_f32_16x16x32_bf16 v[96:99], v[24:27], v[48:51], v[96:99]
  v_mfma_f32_16x16x32_bf16 v[100:103], v[28:31], v[48:51], v[100:103]
  v_mfma_f32_16x16x32_bf16 v[116:119], v[28:31], v[52:55], v[116:119]
  v_mfma_f32_16x16x32_bf16 v[112:115], v[24:27], v[52:55], v[112:115]
  v_mfma_f32_16x16x32_bf16 v[108:111], v[20:23], v[52:55], v[108:111]
  v_mfma_f32_16x16x32_bf16 v[104:107], v[16:19], v[52:55], v[104:107]
  s_waitcnt lgkmcnt(0)
  s_barrier
  v_mfma_f32_16x16x32_bf16 v[120:123], v[16:19], v[56:59], v[120:123]
  ds_read_b128 v[48:51], v7 offset:40960
  v_mfma_f32_16x16x32_bf16 v[124:127], v[20:23], v[56:59], v[124:127]
  ds_read_b128 v[52:55], v7 offset:43008
  v_mfma_f32_16x16x32_bf16 v[128:131], v[24:27], v[56:59], v[128:131]
  ds_read_b64_tr_b16 v[32:33], v1 offset:0
  v_mfma_f32_16x16x32_bf16 v[132:135], v[28:31], v[56:59], v[132:135]
  ds_read_b128 v[56:59], v7 offset:45056
  v_mfma_f32_16x16x32_bf16 v[148:151], v[28:31], v[60:63], v[148:151]
  ds_read_b64_tr_b16 v[34:35], v1 offset:1024
  v_mfma_f32_16x16x32_bf16 v[144:147], v[24:27], v[60:63], v[144:147]
  ds_read_b64_tr_b16 v[36:37], v2 offset:0
  v_mfma_f32_16x16x32_bf16 v[140:143], v[20:23], v[60:63], v[140:143]
  ds_read_b64_tr_b16 v[38:39], v2 offset:1024
  v_mfma_f32_16x16x32_bf16 v[136:139], v[16:19], v[60:63], v[136:139]
  ds_read_b128 v[60:63], v7 offset:47104
  v_mfma_f32_16x16x32_bf16 v[152:155], v[16:19], v[64:67], v[152:155]
  ds_read_b64_tr_b16 v[40:41], v3 offset:0
  v_mfma_f32_16x16x32_bf16 v[156:159], v[20:23], v[64:67], v[156:159]
  ds_read_b64_tr_b16 v[42:43], v3 offset:1024
  v_mfma_f32_16x16x32_bf16 v[160:163], v[24:27], v[64:67], v[160:163]
  ds_read_b64_tr_b16 v[44:45], v4 offset:0
  v_mfma_f32_16x16x32_bf16 v[164:167], v[28:31], v[64:67], v[164:167]
  ds_read_b128 v[64:67], v7 offset:49152
  v_mfma_f32_16x16x32_bf16 v[180:183], v[28:31], v[68:71], v[180:183]
  ds_read_b64_tr_b16 v[46:47], v4 offset:1024
  v_mfma_f32_16x16x32_bf16 v[176:179], v[24:27], v[68:71], v[176:179]
  v_mfma_f32_16x16x32_bf16 v[172:175], v[20:23], v[68:71], v[172:175]
  v_mfma_f32_16x16x32_bf16 v[168:171], v[16:19], v[68:71], v[168:171]
  ds_read_b128 v[68:71], v7 offset:51200
  v_mfma_f32_16x16x32_bf16 v[184:187], v[16:19], v[72:75], v[184:187]
  v_mfma_f32_16x16x32_bf16 v[188:191], v[20:23], v[72:75], v[188:191]
  v_mfma_f32_16x16x32_bf16 v[192:195], v[24:27], v[72:75], v[192:195]
  v_mfma_f32_16x16x32_bf16 v[196:199], v[28:31], v[72:75], v[196:199]
  ds_read_b128 v[72:75], v7 offset:53248
  v_mfma_f32_16x16x32_bf16 v[212:215], v[28:31], v[76:79], v[212:215]
  v_mfma_f32_16x16x32_bf16 v[208:211], v[24:27], v[76:79], v[208:211]
  v_mfma_f32_16x16x32_bf16 v[204:207], v[20:23], v[76:79], v[204:207]
  v_mfma_f32_16x16x32_bf16 v[200:203], v[16:19], v[76:79], v[200:203]
  ds_read_b128 v[76:79], v7 offset:55296
  v_mfma_f32_16x16x32_bf16 v[216:219], v[16:19], v[80:83], v[216:219]
  v_mfma_f32_16x16x32_bf16 v[220:223], v[20:23], v[80:83], v[220:223]
  v_mfma_f32_16x16x32_bf16 v[224:227], v[24:27], v[80:83], v[224:227]
  v_mfma_f32_16x16x32_bf16 v[228:231], v[28:31], v[80:83], v[228:231]
  ds_read_b128 v[80:83], v7 offset:57344
  v_mfma_f32_16x16x32_bf16 v[244:247], v[28:31], v[84:87], v[244:247]
  s_waitcnt lgkmcnt(4)
  v_mfma_f32_16x16x32_bf16 v[240:243], v[24:27], v[84:87], v[240:243]
  v_mfma_f32_16x16x32_bf16 v[236:239], v[20:23], v[84:87], v[236:239]
  s_nop 0
  v_mfma_f32_16x16x32_bf16 v[232:235], v[16:19], v[84:87], v[232:235]
  ds_read_b128 v[84:87], v7 offset:59392
  v_mfma_f32_16x16x32_bf16 v[88:91], v[32:35], v[48:51], v[88:91]
  v_mfma_f32_16x16x32_bf16 v[92:95], v[36:39], v[48:51], v[92:95]
  v_mfma_f32_16x16x32_bf16 v[96:99], v[40:43], v[48:51], v[96:99]
  v_mfma_f32_16x16x32_bf16 v[100:103], v[44:47], v[48:51], v[100:103]
  v_mfma_f32_16x16x32_bf16 v[116:119], v[44:47], v[52:55], v[116:119]
  v_mfma_f32_16x16x32_bf16 v[112:115], v[40:43], v[52:55], v[112:115]
  v_mfma_f32_16x16x32_bf16 v[108:111], v[36:39], v[52:55], v[108:111]
  v_mfma_f32_16x16x32_bf16 v[104:107], v[32:35], v[52:55], v[104:107]
  s_waitcnt lgkmcnt(0)
  s_barrier
  v_mfma_f32_16x16x32_bf16 v[120:123], v[32:35], v[56:59], v[120:123]
  ds_read_b128 v[48:51], v6 offset:0
  v_mfma_f32_16x16x32_bf16 v[124:127], v[36:39], v[56:59], v[124:127]
  ds_read_b128 v[52:55], v6 offset:2048
  v_mfma_f32_16x16x32_bf16 v[128:131], v[40:43], v[56:59], v[128:131]
  ds_read_b64_tr_b16 v[16:17], v1 offset:8192
  v_mfma_f32_16x16x32_bf16 v[132:135], v[44:47], v[56:59], v[132:135]
  ds_read_b128 v[56:59], v6 offset:4096
  v_mfma_f32_16x16x32_bf16 v[148:151], v[44:47], v[60:63], v[148:151]
  ds_read_b64_tr_b16 v[18:19], v1 offset:9216
  v_mfma_f32_16x16x32_bf16 v[144:147], v[40:43], v[60:63], v[144:147]
  ds_read_b64_tr_b16 v[20:21], v2 offset:8192
  v_mfma_f32_16x16x32_bf16 v[140:143], v[36:39], v[60:63], v[140:143]
  ds_read_b64_tr_b16 v[22:23], v2 offset:9216
  v_mfma_f32_16x16x32_bf16 v[136:139], v[32:35], v[60:63], v[136:139]
  ds_read_b128 v[60:63], v6 offset:6144
  v_mfma_f32_16x16x32_bf16 v[152:155], v[32:35], v[64:67], v[152:155]
  ds_read_b64_tr_b16 v[24:25], v3 offset:8192
  v_mfma_f32_16x16x32_bf16 v[156:159], v[36:39], v[64:67], v[156:159]
  ds_read_b64_tr_b16 v[26:27], v3 offset:9216
  v_mfma_f32_16x16x32_bf16 v[160:163], v[40:43], v[64:67], v[160:163]
  ds_read_b64_tr_b16 v[28:29], v4 offset:8192
  v_mfma_f32_16x16x32_bf16 v[164:167], v[44:47], v[64:67], v[164:167]
  ds_read_b128 v[64:67], v6 offset:8192
  v_mfma_f32_16x16x32_bf16 v[180:183], v[44:47], v[68:71], v[180:183]
  ds_read_b64_tr_b16 v[30:31], v4 offset:9216
  v_mfma_f32_16x16x32_bf16 v[176:179], v[40:43], v[68:71], v[176:179]
  v_mfma_f32_16x16x32_bf16 v[172:175], v[36:39], v[68:71], v[172:175]
  v_mfma_f32_16x16x32_bf16 v[168:171], v[32:35], v[68:71], v[168:171]
  ds_read_b128 v[68:71], v6 offset:10240
  v_mfma_f32_16x16x32_bf16 v[184:187], v[32:35], v[72:75], v[184:187]
  v_mfma_f32_16x16x32_bf16 v[188:191], v[36:39], v[72:75], v[188:191]
  v_mfma_f32_16x16x32_bf16 v[192:195], v[40:43], v[72:75], v[192:195]
  v_mfma_f32_16x16x32_bf16 v[196:199], v[44:47], v[72:75], v[196:199]
  ds_read_b128 v[72:75], v6 offset:12288
  v_mfma_f32_16x16x32_bf16 v[212:215], v[44:47], v[76:79], v[212:215]
  v_mfma_f32_16x16x32_bf16 v[208:211], v[40:43], v[76:79], v[208:211]
  v_mfma_f32_16x16x32_bf16 v[204:207], v[36:39], v[76:79], v[204:207]
  v_mfma_f32_16x16x32_bf16 v[200:203], v[32:35], v[76:79], v[200:203]
  ds_read_b128 v[76:79], v6 offset:14336
  v_mfma_f32_16x16x32_bf16 v[216:219], v[32:35], v[80:83], v[216:219]
  v_mfma_f32_16x16x32_bf16 v[220:223], v[36:39], v[80:83], v[220:223]
  v_mfma_f32_16x16x32_bf16 v[224:227], v[40:43], v[80:83], v[224:227]
  v_mfma_f32_16x16x32_bf16 v[228:231], v[44:47], v[80:83], v[228:231]
  ds_read_b128 v[80:83], v6 offset:16384
  v_mfma_f32_16x16x32_bf16 v[244:247], v[44:47], v[84:87], v[244:247]
  s_waitcnt lgkmcnt(4)
  v_mfma_f32_16x16x32_bf16 v[240:243], v[40:43], v[84:87], v[240:243]
  v_mfma_f32_16x16x32_bf16 v[236:239], v[36:39], v[84:87], v[236:239]
  v_mfma_f32_16x16x32_bf16 v[232:235], v[32:35], v[84:87], v[232:235]
  ds_read_b128 v[84:87], v6 offset:18432
  v_mfma_f32_16x16x32_bf16 v[88:91], v[16:19], v[48:51], v[88:91]
  v_mfma_f32_16x16x32_bf16 v[92:95], v[20:23], v[48:51], v[92:95]
  s_nop 0
  v_mfma_f32_16x16x32_bf16 v[96:99], v[24:27], v[48:51], v[96:99]
  v_mfma_f32_16x16x32_bf16 v[100:103], v[28:31], v[48:51], v[100:103]
  v_mfma_f32_16x16x32_bf16 v[116:119], v[28:31], v[52:55], v[116:119]
  v_mfma_f32_16x16x32_bf16 v[112:115], v[24:27], v[52:55], v[112:115]
  v_mfma_f32_16x16x32_bf16 v[108:111], v[20:23], v[52:55], v[108:111]
  v_mfma_f32_16x16x32_bf16 v[104:107], v[16:19], v[52:55], v[104:107]
  s_waitcnt lgkmcnt(0)
  s_barrier
  v_mfma_f32_16x16x32_bf16 v[120:123], v[16:19], v[56:59], v[120:123]
  ds_read_b128 v[48:51], v8 offset:0
  v_mfma_f32_16x16x32_bf16 v[124:127], v[20:23], v[56:59], v[124:127]
  ds_read_b128 v[52:55], v8 offset:2048
  v_mfma_f32_16x16x32_bf16 v[128:131], v[24:27], v[56:59], v[128:131]
  ds_read_b64_tr_b16 v[32:33], v1 offset:16384
  v_mfma_f32_16x16x32_bf16 v[132:135], v[28:31], v[56:59], v[132:135]
  ds_read_b128 v[56:59], v8 offset:4096
  v_mfma_f32_16x16x32_bf16 v[148:151], v[28:31], v[60:63], v[148:151]
  ds_read_b64_tr_b16 v[34:35], v1 offset:17408
  v_mfma_f32_16x16x32_bf16 v[144:147], v[24:27], v[60:63], v[144:147]
  ds_read_b64_tr_b16 v[36:37], v2 offset:16384
  v_mfma_f32_16x16x32_bf16 v[140:143], v[20:23], v[60:63], v[140:143]
  ds_read_b64_tr_b16 v[38:39], v2 offset:17408
  v_mfma_f32_16x16x32_bf16 v[136:139], v[16:19], v[60:63], v[136:139]
  ds_read_b128 v[60:63], v8 offset:6144
  v_mfma_f32_16x16x32_bf16 v[152:155], v[16:19], v[64:67], v[152:155]
  ds_read_b64_tr_b16 v[40:41], v3 offset:16384
  v_mfma_f32_16x16x32_bf16 v[156:159], v[20:23], v[64:67], v[156:159]
  ds_read_b64_tr_b16 v[42:43], v3 offset:17408
  v_mfma_f32_16x16x32_bf16 v[160:163], v[24:27], v[64:67], v[160:163]
  ds_read_b64_tr_b16 v[44:45], v4 offset:16384
  v_mfma_f32_16x16x32_bf16 v[164:167], v[28:31], v[64:67], v[164:167]
  ds_read_b128 v[64:67], v8 offset:8192
  v_mfma_f32_16x16x32_bf16 v[180:183], v[28:31], v[68:71], v[180:183]
  ds_read_b64_tr_b16 v[46:47], v4 offset:17408
  v_mfma_f32_16x16x32_bf16 v[176:179], v[24:27], v[68:71], v[176:179]
  v_mfma_f32_16x16x32_bf16 v[172:175], v[20:23], v[68:71], v[172:175]
  v_mfma_f32_16x16x32_bf16 v[168:171], v[16:19], v[68:71], v[168:171]
  ds_read_b128 v[68:71], v8 offset:10240
  v_mfma_f32_16x16x32_bf16 v[184:187], v[16:19], v[72:75], v[184:187]
  v_mfma_f32_16x16x32_bf16 v[188:191], v[20:23], v[72:75], v[188:191]
  v_mfma_f32_16x16x32_bf16 v[192:195], v[24:27], v[72:75], v[192:195]
  v_mfma_f32_16x16x32_bf16 v[196:199], v[28:31], v[72:75], v[196:199]
  ds_read_b128 v[72:75], v8 offset:12288
  v_mfma_f32_16x16x32_bf16 v[212:215], v[28:31], v[76:79], v[212:215]
  v_mfma_f32_16x16x32_bf16 v[208:211], v[24:27], v[76:79], v[208:211]
  v_mfma_f32_16x16x32_bf16 v[204:207], v[20:23], v[76:79], v[204:207]
  v_mfma_f32_16x16x32_bf16 v[200:203], v[16:19], v[76:79], v[200:203]
  ds_read_b128 v[76:79], v8 offset:14336
  v_mfma_f32_16x16x32_bf16 v[216:219], v[16:19], v[80:83], v[216:219]
  v_mfma_f32_16x16x32_bf16 v[220:223], v[20:23], v[80:83], v[220:223]
  v_mfma_f32_16x16x32_bf16 v[224:227], v[24:27], v[80:83], v[224:227]
  v_mfma_f32_16x16x32_bf16 v[228:231], v[28:31], v[80:83], v[228:231]
  ds_read_b128 v[80:83], v8 offset:16384
  v_mfma_f32_16x16x32_bf16 v[244:247], v[28:31], v[84:87], v[244:247]
  s_waitcnt lgkmcnt(4)
  v_mfma_f32_16x16x32_bf16 v[240:243], v[24:27], v[84:87], v[240:243]
  v_mfma_f32_16x16x32_bf16 v[236:239], v[20:23], v[84:87], v[236:239]
  s_nop 0
  v_mfma_f32_16x16x32_bf16 v[232:235], v[16:19], v[84:87], v[232:235]
  ds_read_b128 v[84:87], v8 offset:18432
  v_mfma_f32_16x16x32_bf16 v[88:91], v[32:35], v[48:51], v[88:91]
  v_mfma_f32_16x16x32_bf16 v[92:95], v[36:39], v[48:51], v[92:95]
  v_mfma_f32_16x16x32_bf16 v[96:99], v[40:43], v[48:51], v[96:99]
  v_mfma_f32_16x16x32_bf16 v[100:103], v[44:47], v[48:51], v[100:103]
  v_mfma_f32_16x16x32_bf16 v[116:119], v[44:47], v[52:55], v[116:119]
  v_mfma_f32_16x16x32_bf16 v[112:115], v[40:43], v[52:55], v[112:115]
  v_mfma_f32_16x16x32_bf16 v[108:111], v[36:39], v[52:55], v[108:111]
  v_mfma_f32_16x16x32_bf16 v[104:107], v[32:35], v[52:55], v[104:107]
  s_waitcnt lgkmcnt(0)
  s_barrier
  v_mfma_f32_16x16x32_bf16 v[120:123], v[32:35], v[56:59], v[120:123]
  ds_read_b128 v[48:51], v5 offset:0
  v_mfma_f32_16x16x32_bf16 v[124:127], v[36:39], v[56:59], v[124:127]
  ds_read_b128 v[52:55], v5 offset:2048
  v_mfma_f32_16x16x32_bf16 v[128:131], v[40:43], v[56:59], v[128:131]
  ds_read_b64_tr_b16 v[16:17], v1 offset:0
  v_mfma_f32_16x16x32_bf16 v[132:135], v[44:47], v[56:59], v[132:135]
  ds_read_b128 v[56:59], v5 offset:4096
  v_mfma_f32_16x16x32_bf16 v[148:151], v[44:47], v[60:63], v[148:151]
  ds_read_b64_tr_b16 v[18:19], v1 offset:1024
  v_mfma_f32_16x16x32_bf16 v[144:147], v[40:43], v[60:63], v[144:147]
  ds_read_b64_tr_b16 v[20:21], v2 offset:0
  v_mfma_f32_16x16x32_bf16 v[140:143], v[36:39], v[60:63], v[140:143]
  ds_read_b64_tr_b16 v[22:23], v2 offset:1024
  v_mfma_f32_16x16x32_bf16 v[136:139], v[32:35], v[60:63], v[136:139]
  ds_read_b128 v[60:63], v5 offset:6144
  v_mfma_f32_16x16x32_bf16 v[152:155], v[32:35], v[64:67], v[152:155]
  ds_read_b64_tr_b16 v[24:25], v3 offset:0
  v_mfma_f32_16x16x32_bf16 v[156:159], v[36:39], v[64:67], v[156:159]
  ds_read_b64_tr_b16 v[26:27], v3 offset:1024
  v_mfma_f32_16x16x32_bf16 v[160:163], v[40:43], v[64:67], v[160:163]
  ds_read_b64_tr_b16 v[28:29], v4 offset:0
  v_mfma_f32_16x16x32_bf16 v[164:167], v[44:47], v[64:67], v[164:167]
  ds_read_b128 v[64:67], v5 offset:8192
  v_mfma_f32_16x16x32_bf16 v[180:183], v[44:47], v[68:71], v[180:183]
  ds_read_b64_tr_b16 v[30:31], v4 offset:1024
  v_mfma_f32_16x16x32_bf16 v[176:179], v[40:43], v[68:71], v[176:179]
  v_mfma_f32_16x16x32_bf16 v[172:175], v[36:39], v[68:71], v[172:175]
  v_mfma_f32_16x16x32_bf16 v[168:171], v[32:35], v[68:71], v[168:171]
  ds_read_b128 v[68:71], v5 offset:10240
  v_mfma_f32_16x16x32_bf16 v[184:187], v[32:35], v[72:75], v[184:187]
  v_mfma_f32_16x16x32_bf16 v[188:191], v[36:39], v[72:75], v[188:191]
  v_mfma_f32_16x16x32_bf16 v[192:195], v[40:43], v[72:75], v[192:195]
  v_mfma_f32_16x16x32_bf16 v[196:199], v[44:47], v[72:75], v[196:199]
  ds_read_b128 v[72:75], v5 offset:12288
  v_mfma_f32_16x16x32_bf16 v[212:215], v[44:47], v[76:79], v[212:215]
  v_mfma_f32_16x16x32_bf16 v[208:211], v[40:43], v[76:79], v[208:211]
  v_mfma_f32_16x16x32_bf16 v[204:207], v[36:39], v[76:79], v[204:207]
  v_mfma_f32_16x16x32_bf16 v[200:203], v[32:35], v[76:79], v[200:203]
  ds_read_b128 v[76:79], v5 offset:14336
  v_mfma_f32_16x16x32_bf16 v[216:219], v[32:35], v[80:83], v[216:219]
  v_mfma_f32_16x16x32_bf16 v[220:223], v[36:39], v[80:83], v[220:223]
  v_mfma_f32_16x16x32_bf16 v[224:227], v[40:43], v[80:83], v[224:227]
  v_mfma_f32_16x16x32_bf16 v[228:231], v[44:47], v[80:83], v[228:231]
  ds_read_b128 v[80:83], v5 offset:16384
  v_mfma_f32_16x16x32_bf16 v[244:247], v[44:47], v[84:87], v[244:247]
  s_waitcnt lgkmcnt(4)
  v_mfma_f32_16x16x32_bf16 v[240:243], v[40:43], v[84:87], v[240:243]
  s_add_u32 s72, s72, 1
  s_cmp_lt_u32 s72, 8
  v_mfma_f32_16x16x32_bf16 v[236:239], v[36:39], v[84:87], v[236:239]
  v_mfma_f32_16x16x32_bf16 v[232:235], v[32:35], v[84:87], v[232:235]
  ds_read_b128 v[84:87], v5 offset:18432
  s_cbranch_scc1 L_dnn_loop0
L_tail:
  v_mfma_f32_16x16x32_bf16 v[88:91], v[16:19], v[48:51], v[88:91]
  v_mfma_f32_16x16x32_bf16 v[92:95], v[20:23], v[48:51], v[92:95]
  v_mfma_f32_16x16x32_bf16 v[96:99], v[24:27], v[48:51], v[96:99]
  v_mfma_f32_16x16x32_bf16 v[100:103], v[28:31], v[48:51], v[100:103]
  v_mfma_f32_16x16x32_bf16 v[116:119], v[28:31], v[52:55], v[116:119]
  v_mfma_f32_16x16x32_bf16 v[112:115], v[24:27], v[52:55], v[112:115]
  v_mfma_f32_16x16x32_bf16 v[108:111], v[20:23], v[52:55], v[108:111]
  v_mfma_f32_16x16x32_bf16 v[104:107], v[16:19], v[52:55], v[104:107]
  s_waitcnt lgkmcnt(0)
  s_barrier
  v_mfma_f32_16x16x32_bf16 v[120:123], v[16:19], v[56:59], v[120:123]
  ds_read_b128 v[48:51], v7 offset:0
  v_mfma_f32_16x16x32_bf16 v[124:127], v[20:23], v[56:59], v[124:127]
  ds_read_b128 v[52:55], v7 offset:2048
  v_mfma_f32_16x16x32_bf16 v[128:131], v[24:27], v[56:59], v[128:131]
  ds_read_b64_tr_b16 v[32:33], v1 offset:8192
  v_mfma_f32_16x16x32_bf16 v[132:135], v[28:31], v[56:59], v[132:135]
  ds_read_b128 v[56:59], v7 offset:4096
  v_mfma_f32_16x16x32_bf16 v[148:151], v[28:31], v[60:63], v[148:151]
  ds_read_b64_tr_b16 v[34:35], v1 offset:9216
  v_mfma_f32_16x16x32_bf16 v[144:147], v[24:27], v[60:63], v[144:147]
  ds_read_b64_tr_b16 v[36:37], v2 offset:8192
  v_mfma_f32_16x16x32_bf16 v[140:143], v[20:23], v[60:63], v[140:143]
  ds_read_b64_tr_b16 v[38:39], v2 offset:9216
  v_mfma_f32_16x16x32_bf16 v[136:139], v[16:19], v[60:63], v[136:139]
  ds_read_b128 v[60:63], v7 offset:6144
  v_mfma_f32_16x16x32_bf16 v[152:155], v[16:19], v[64:67], v[152:155]
  ds_read_b64_tr_b16 v[40:41], v3 offset:8192
  v_mfma_f32_16x16x32_bf16 v[156:159], v[20:23], v[64:67], v[156:159]
  ds_read_b64_tr_b16 v[42:43], v3 offset:9216
  v_mfma_f32_16x16x32_bf16 v[160:163], v[24:27], v[64:67], v[160:163]
  ds_read_b64_tr_b16 v[44:45], v4 offset:8192
  v_mfma_f32_16x16x32_bf16 v[164:167], v[28:31], v[64:67], v[164:167]
  ds_read_b128 v[64:67], v7 offset:8192
  v_mfma_f32_16x16x32_bf16 v[180:183], v[28:31], v[68:71], v[180:183]
  ds_read_b64_tr_b16 v[46:47], v4 offset:9216
  v_mfma_f32_16x16x32_bf16 v[176:179], v[24:27], v[68:71], v[176:179]
  v_mfma_f32_16x16x32_bf16 v[172:175], v[20:23], v[68:71], v[172:175]
  v_mfma_f32_16x16x32_bf16 v[168:171], v[16:19], v[68:71], v[168:171]
  ds_read_b128 v[68:71], v7 offset:10240
  v_mfma_f32_16x16x32_bf16 v[184:187], v[16:19], v[72:75], v[184:187]
  v_mfma_f32_16x16x32_bf16 v[188:191], v[20:23], v[72:75], v[188:191]
  v_mfma_f32_16x16x32_bf16 v[192:195], v[24:27], v[72:75], v[192:195]
  v_mfma_f32_16x16x32_bf16 v[196:199], v[28:31], v[72:75], v[196:199]
  ds_read_b128 v[72:75], v7 offset:12288
  v_mfma_f32_16x16x32_bf16 v[212:215], v[28:31], v[76:79], v[212:215]
  v_mfma_f32_16x16x32_bf16 v[208:211], v[24:27], v[76:79], v[208:211]
  v_mfma_f32_16x16x32_bf16 v[204:207], v[20:23], v[76:79], v[204:207]
  v_mfma_f32_16x16x32_bf16 v[200:203], v[16:19], v[76:79], v[200:203]
  ds_read_b128 v[76:79], v7 offset:14336
  v_mfma_f32_16x16x32_bf16 v[216:219], v[16:19], v[80:83], v[216:219]
  v_mfma_f32_16x16x32_bf16 v[220:223], v[20:23], v[80:83], v[220:223]
  v_mfma_f32_16x16x32_bf16 v[224:227], v[24:27], v[80:83], v[224:227]
  v_mfma_f32_16x16x32_bf16 v[228:231], v[28:31], v[80:83], v[228:231]
  ds_read_b128 v[80:83], v7 offset:16384
  v_mfma_f32_16x16x32_bf16 v[244:247], v[28:31], v[84:87], v[244:247]
  s_waitcnt lgkmcnt(4)
  v_mfma_f32_16x16x32_bf16 v[240:243], v[24:27], v[84:87], v[240:243]
  s_nop 0
  v_mfma_f32_16x16x32_bf16 v[236:239], v[20:23], v[84:87], v[236:239]
  v_mfma_f32_16x16x32_bf16 v[232:235], v[16:19], v[84:87], v[232:235]
  ds_read_b128 v[84:87], v7 offset:18432
  v_mfma_f32_16x16x32_bf16 v[88:91], v[32:35], v[48:51], v[88:91]
  v_mfma_f32_16x16x32_bf16 v[92:95], v[36:39], v[48:51], v[92:95]
  v_mfma_f32_16x16x32_bf16 v[96:99], v[40:43], v[48:51], v[96:99]
  v_mfma_f32_16x16x32_bf16 v[100:103], v[44:47], v[48:51], v[100:103]
  v_mfma_f32_16x16x32_bf16 v[116:119], v[44:47], v[52:55], v[116:119]
  v_mfma_f32_16x16x32_bf16 v[112:115], v[40:43], v[52:55], v[112:115]
  v_mfma_f32_16x16x32_bf16 v[108:111], v[36:39], v[52:55], v[108:111]
  v_mfma_f32_16x16x32_bf16 v[104:107], v[32:35], v[52:55], v[104:107]
  s_waitcnt lgkmcnt(0)
  s_barrier
  v_mfma_f32_16x16x32_bf16 v[120:123], v[32:35], v[56:59], v[120:123]
  ds_read_b128 v[48:51], v5 offset:40960
  v_mfma_f32_16x16x32_bf16 v[124:127], v[36:39], v[56:59], v[124:127]
  ds_read_b128 v[52:55], v5 offset:43008
  v_mfma_f32_16x16x32_bf16 v[128:131], v[40:43], v[56:59], v[128:131]
  ds_read_b64_tr_b16 v[16:17], v1 offset:16384
  v_mfma_f32_16x16x32_bf16 v[132:135], v[44:47], v[56:59], v[132:135]
  ds_read_b128 v[56:59], v5 offset:45056
  v_mfma_f32_16x16x32_bf16 v[148:151], v[44:47], v[60:63], v[148:151]
  ds_read_b64_tr_b16 v[18:19], v1 offset:17408
  v_mfma_f32_16x16x32_bf16 v[144:147], v[40:43], v[60:63], v[144:147]
  ds_read_b64_tr_b16 v[20:21], v2 offset:16384
  v_mfma_f32_16x16x32_bf16 v[140:143], v[36:39], v[60:63], v[140:143]
  ds_read_b64_tr_b16 v[22:23], v2 offset:17408
  v_mfma_f32_16x16x32_bf16 v[136:139], v[32:35], v[60:63], v[136:139]
  ds_read_b128 v[60:63], v5 offset:47104
  v_mfma_f32_16x16x32_bf16 v[152:155], v[32:35], v[64:67], v[152:155]
  ds_read_b64_tr_b16 v[24:25], v3 offset:16384
  v_mfma_f32_16x16x32_bf16 v[156:159], v[36:39], v[64:67], v[156:159]
  ds_read_b64_tr_b16 v[26:27], v3 offset:17408
  v_mfma_f32_16x16x32_bf16 v[160:163], v[40:43], v[64:67], v[160:163]
  ds_read_b64_tr_b16 v[28:29], v4 offset:16384
  v_mfma_f32_16x16x32_bf16 v[164:167], v[44:47], v[64:67], v[164:167]
  ds_read_b128 v[64:67], v5 offset:49152
  v_mfma_f32_16x16x32_bf16 v[180:183], v[44:47], v[68:71], v[180:183]
  ds_read_b64_tr_b16 v[30:31], v4 offset:17408
  v_mfma_f32_16x16x32_bf16 v[176:179], v[40:43], v[68:71], v[176:179]
  v_mfma_f32_16x16x32_bf16 v[172:175], v[36:39], v[68:71], v[172:175]
  v_mfma_f32_16x16x32_bf16 v[168:171], v[32:35], v[68:71], v[168:171]
  ds_read_b128 v[68:71], v5 offset:51200
  v_mfma_f32_16x16x32_bf16 v[184:187], v[32:35], v[72:75], v[184:187]
  v_mfma_f32_16x16x32_bf16 v[188:191], v[36:39], v[72:75], v[188:191]
  v_mfma_f32_16x16x32_bf16 v[192:195], v[40:43], v[72:75], v[192:195]
  v_mfma_f32_16x16x32_bf16 v[196:199], v[44:47], v[72:75], v[196:199]
  ds_read_b128 v[72:75], v5 offset:53248
  v_mfma_f32_16x16x32_bf16 v[212:215], v[44:47], v[76:79], v[212:215]
  v_mfma_f32_16x16x32_bf16 v[208:211], v[40:43], v[76:79], v[208:211]
  v_mfma_f32_16x16x32_bf16 v[204:207], v[36:39], v[76:79], v[204:207]
  v_mfma_f32_16x16x32_bf16 v[200:203], v[32:35], v[76:79], v[200:203]
  ds_read_b128 v[76:79], v5 offset:55296
  v_mfma_f32_16x16x32_bf16 v[216:219], v[32:35], v[80:83], v[216:219]
  v_mfma_f32_16x16x32_bf16 v[220:223], v[36:39], v[80:83], v[220:223]
  v_mfma_f32_16x16x32_bf16 v[224:227], v[40:43], v[80:83], v[224:227]
  v_mfma_f32_16x16x32_bf16 v[228:231], v[44:47], v[80:83], v[228:231]
  ds_read_b128 v[80:83], v5 offset:57344
  v_mfma_f32_16x16x32_bf16 v[244:247], v[44:47], v[84:87], v[244:247]
  s_waitcnt lgkmcnt(4)
  v_mfma_f32_16x16x32_bf16 v[240:243], v[40:43], v[84:87], v[240:243]
  v_mfma_f32_16x16x32_bf16 v[236:239], v[36:39], v[84:87], v[236:239]
  v_mfma_f32_16x16x32_bf16 v[232:235], v[32:35], v[84:87], v[232:235]
  ds_read_b128 v[84:87], v5 offset:59392
  v_mfma_f32_16x16x32_bf16 v[88:91], v[16:19], v[48:51], v[88:91]
  s_nop 0
  v_mfma_f32_16x16x32_bf16 v[92:95], v[20:23], v[48:51], v[92:95]
  v_mfma_f32_16x16x32_bf16 v[96:99], v[24:27], v[48:51], v[96:99]
  v_mfma_f32_16x16x32_bf16 v[100:103], v[28:31], v[48:51], v[100:103]
  v_mfma_f32_16x16x32_bf16 v[116:119], v[28:31], v[52:55], v[116:119]
  v_mfma_f32_16x16x32_bf16 v[112:115], v[24:27], v[52:55], v[112:115]
  v_mfma_f32_16x16x32_bf16 v[108:111], v[20:23], v[52:55], v[108:111]
  v_mfma_f32_16x16x32_bf16 v[104:107], v[16:19], v[52:55], v[104:107]
  s_waitcnt lgkmcnt(0)
  s_barrier
  v_mfma_f32_16x16x32_bf16 v[120:123], v[16:19], v[56:59], v[120:123]
  ds_read_b128 v[48:51], v7 offset:40960
  v_mfma_f32_16x16x32_bf16 v[124:127], v[20:23], v[56:59], v[124:127]
  ds_read_b128 v[52:55], v7 offset:43008
  v_mfma_f32_16x16x32_bf16 v[128:131], v[24:27], v[56:59], v[128:131]
  ds_read_b64_tr_b16 v[32:33], v1 offset:0
  v_mfma_f32_16x16x32_bf16 v[132:135], v[28:31], v[56:59], v[132:135]
  ds_read_b128 v[56:59], v7 offset:45056
  v_mfma_f32_16x16x32_bf16 v[148:151], v[28:31], v[60:63], v[148:151]
  ds_read_b64_tr_b16 v[34:35], v1 offset:1024
  v_mfma_f32_16x16x32_bf16 v[144:147], v[24:27], v[60:63], v[144:147]
  ds_read_b64_tr_b16 v[36:37], v2 offset:0
  v_mfma_f32_16x16x32_bf16 v[140:143], v[20:23], v[60:63], v[140:143]
  ds_read_b64_tr_b16 v[38:39], v2 offset:1024
  v_mfma_f32_16x16x32_bf16 v[136:139], v[16:19], v[60:63], v[136:139]
  ds_read_b128 v[60:63], v7 offset:47104
  v_mfma_f32_16x16x32_bf16 v[152:155], v[16:19], v[64:67], v[152:155]
  ds_read_b64_tr_b16 v[40:41], v3 offset:0
  v_mfma_f32_16x16x32_bf16 v[156:159], v[20:23], v[64:67], v[156:159]
  ds_read_b64_tr_b16 v[42:43], v3 offset:1024
  v_mfma_f32_16x16x32_bf16 v[160:163], v[24:27], v[64:67], v[160:163]
  ds_read_b64_tr_b16 v[44:45], v4 offset:0
  v_mfma_f32_16x16x32_bf16 v[164:167], v[28:31], v[64:67], v[164:167]
  ds_read_b128 v[64:67], v7 offset:49152
  v_mfma_f32_16x16x32_bf16 v[180:183], v[28:31], v[68:71], v[180:183]
  ds_read_b64_tr_b16 v[46:47], v4 offset:1024
  v_mfma_f32_16x16x32_bf16 v[176:179], v[24:27], v[68:71], v[176:179]
  v_mfma_f32_16x16x32_bf16 v[172:175], v[20:23], v[68:71], v[172:175]
  v_mfma_f32_16x16x32_bf16 v[168:171], v[16:19], v[68:71], v[168:171]
  ds_read_b128 v[68:71], v7 offset:51200
  v_mfma_f32_16x16x32_bf16 v[184:187], v[16:19], v[72:75], v[184:187]
  v_mfma_f32_16x16x32_bf16 v[188:191], v[20:23], v[72:75], v[188:191]
  v_mfma_f32_16x16x32_bf16 v[192:195], v[24:27], v[72:75], v[192:195]
  v_mfma_f32_16x16x32_bf16 v[196:199], v[28:31], v[72:75], v[196:199]
  ds_read_b128 v[72:75], v7 offset:53248
  v_mfma_f32_16x16x32_bf16 v[212:215], v[28:31], v[76:79], v[212:215]
  v_mfma_f32_16x16x32_bf16 v[208:211], v[24:27], v[76:79], v[208:211]
  v_mfma_f32_16x16x32_bf16 v[204:207], v[20:23], v[76:79], v[204:207]
  v_mfma_f32_16x16x32_bf16 v[200:203], v[16:19], v[76:79], v[200:203]
  ds_read_b128 v[76:79], v7 offset:55296
  v_mfma_f32_16x16x32_bf16 v[216:219], v[16:19], v[80:83], v[216:219]
  v_mfma_f32_16x16x32_bf16 v[220:223], v[20:23], v[80:83], v[220:223]
  v_mfma_f32_16x16x32_bf16 v[224:227], v[24:27], v[80:83], v[224:227]
  v_mfma_f32_16x16x32_bf16 v[228:231], v[28:31], v[80:83], v[228:231]
  ds_read_b128 v[80:83], v7 offset:57344
  v_mfma_f32_16x16x32_bf16 v[244:247], v[28:31], v[84:87], v[244:247]
  s_waitcnt lgkmcnt(4)
  v_mfma_f32_16x16x32_bf16 v[240:243], v[24:27], v[84:87], v[240:243]
  s_nop 0
  v_mfma_f32_16x16x32_bf16 v[236:239], v[20:23], v[84:87], v[236:239]
  v_mfma_f32_16x16x32_bf16 v[232:235], v[16:19], v[84:87], v[232:235]
  ds_read_b128 v[84:87], v7 offset:59392
  v_mfma_f32_16x16x32_bf16 v[88:91], v[32:35], v[48:51], v[88:91]
  ds_read_b64 v[18:19], v9 offset:256
  v_mfma_f32_16x16x32_bf16 v[92:95], v[36:39], v[48:51], v[92:95]
  ds_read_b64 v[22:23], v9 offset:288
  v_mfma_f32_16x16x32_bf16 v[96:99], v[40:43], v[48:51], v[96:99]
  ds_read_b64 v[26:27], v9 offset:320
  v_mfma_f32_16x16x32_bf16 v[100:103], v[44:47], v[48:51], v[100:103]
  ds_read_b64 v[30:31], v9 offset:352
  v_mfma_f32_16x16x32_bf16 v[116:119], v[44:47], v[52:55], v[116:119]
  v_mfma_f32_16x16x32_bf16 v[112:115], v[40:43], v[52:55], v[112:115]
  v_mfma_f32_16x16x32_bf16 v[108:111], v[36:39], v[52:55], v[108:111]
  v_mfma_f32_16x16x32_bf16 v[104:107], v[32:35], v[52:55], v[104:107]
  v_mfma_f32_16x16x32_bf16 v[120:123], v[32:35], v[56:59], v[120:123]
  v_mfma_f32_16x16x32_bf16 v[124:127], v[36:39], v[56:59], v[124:127]
  v_mfma_f32_16x16x32_bf16 v[128:131], v[40:43], v[56:59], v[128:131]
  v_mfma_f32_16x16x32_bf16 v[132:135], v[44:47], v[56:59], v[132:135]
  v_mfma_f32_16x16x32_bf16 v[148:151], v[44:47], v[60:63], v[148:151]
  v_mfma_f32_16x16x32_bf16 v[144:147], v[40:43], v[60:63], v[144:147]
  v_mfma_f32_16x16x32_bf16 v[140:143], v[36:39], v[60:63], v[140:143]
  v_mfma_f32_16x16x32_bf16 v[136:139], v[32:35], v[60:63], v[136:139]
  v_mfma_f32_16x16x32_bf16 v[152:155], v[32:35], v[64:67], v[152:155]
  s_waitcnt lgkmcnt(3)
  v_lshlrev_b32 v16, 16, v18
  v_mfma_f32_16x16x32_bf16 v[156:159], v[36:39], v[64:67], v[156:159]
  v_and_b32 v17, 0xffff0000, v18
  v_mfma_f32_16x16x32_bf16 v[160:163], v[40:43], v[64:67], v[160:163]
  v_lshlrev_b32 v18, 16, v19
  v_mfma_f32_16x16x32_bf16 v[164:167], v[44:47], v[64:67], v[164:167]
  v_and_b32 v19, 0xffff0000, v19
  v_mfma_f32_16x16x32_bf16 v[180:183], v[44:47], v[68:71], v[180:183]
  s_waitcnt lgkmcnt(2)
  v_lshlrev_b32 v20, 16, v22
  v_mfma_f32_16x16x32_bf16 v[176:179], v[40:43], v[68:71], v[176:179]
  v_and_b32 v21, 0xffff0000, v22
  v_mfma_f32_16x16x32_bf16 v[172:175], v[36:39], v[68:71], v[172:175]
  v_lshlrev_b32 v22, 16, v23
  v_mfma_f32_16x16x32_bf16 v[168:171], v[32:35], v[68:71], v[168:171]
  v_and_b32 v23, 0xffff0000, v23
  v_mfma_f32_16x16x32_bf16 v[184:187], v[32:35], v[72:75], v[184:187]
  s_waitcnt lgkmcnt(1)
  v_lshlrev_b32 v24, 16, v26
  v_mfma_f32_16x16x32_bf16 v[188:191], v[36:39], v[72:75], v[188:191]
  v_and_b32 v25, 0xffff0000, v26
  v_mfma_f32_16x16x32_bf16 v[192:195], v[40:43], v[72:75], v[192:195]
  v_lshlrev_b32 v26, 16, v27
  v_mfma_f32_16x16x32_bf16 v[196:199], v[44:47], v[72:75], v[196:199]
  v_and_b32 v27, 0xffff0000, v27
  v_mfma_f32_16x16x32_bf16 v[212:215], v[44:47], v[76:79], v[212:215]
  s_waitcnt lgkmcnt(0)
  v_lshlrev_b32_e64 v28, 16, v30
  v_mfma_f32_16x16x32_bf16 v[208:211], v[40:43], v[76:79], v[208:211]
  v_and_b32 v29, 0xffff0000, v30
  v_mfma_f32_16x16x32_bf16 v[204:207], v[36:39], v[76:79], v[204:207]
  v_lshlrev_b32_e64 v30, 16, v31
  v_mfma_f32_16x16x32_bf16 v[200:203], v[32:35], v[76:79], v[200:203]
  v_and_b32 v31, 0xffff0000, v31
  v_mfma_f32_16x16x32_bf16 v[216:219], v[32:35], v[80:83], v[216:219]
  v_mfma_f32_16x16x32_bf16 v[220:223], v[36:39], v[80:83], v[220:223]
  v_mfma_f32_16x16x32_bf16 v[224:227], v[40:43], v[80:83], v[224:227]
  v_mfma_f32_16x16x32_bf16 v[228:231], v[44:47], v[80:83], v[228:231]
  v_mfma_f32_16x16x32_bf16 v[244:247], v[44:47], v[84:87], v[244:247]
  v_mfma_f32_16x16x32_bf16 v[240:243], v[40:43], v[84:87], v[240:243]
  v_mfma_f32_16x16x32_bf16 v[236:239], v[36:39], v[84:87], v[236:239]
  v_mfma_f32_16x16x32_bf16 v[232:235], v[32:35], v[84:87], v[232:235]
L_epi:
  v_pk_mul_f32 v[52:53], v[88:89], v[88:89]
  v_pk_mul_f32 v[56:57], v[104:105], v[104:105]
  v_pk_mul_f32 v[60:61], v[90:91], v[90:91]
  v_pk_mul_f32 v[64:65], v[106:107], v[106:107]
  v_pk_fma_f32 v[52:53], v[52:53], v[14:15], v[12:13]
  v_pk_fma_f32 v[56:57], v[56:57], v[14:15], v[12:13]
  v_pk_fma_f32 v[60:61], v[60:61], v[14:15], v[12:13]
  v_pk_fma_f32 v[64:65], v[64:65], v[14:15], v[12:13]
  v_pk_mul_f32 v[52:53], v[52:53], v[88:89]
  v_pk_mul_f32 v[56:57], v[56:57], v[104:105]
  v_pk_mul_f32 v[60:61], v[60:61], v[90:91]
  v_pk_mul_f32 v[64:65], v[64:65], v[106:107]
  v_exp_f32 v52, v52
  v_exp_f32 v53, v53
  v_exp_f32 v56, v56
  v_exp_f32 v57, v57
  v_exp_f32 v60, v60
  v_exp_f32 v61, v61
  v_exp_f32 v64, v64
  v_exp_f32 v65, v65
  v_pk_mul_f32 v[54:55], v[88:89], v[16:17]
  v_pk_mul_f32 v[58:59], v[104:105], v[16:17]
  v_pk_mul_f32 v[62:63], v[90:91], v[18:19]
  v_pk_mul_f32 v[66:67], v[106:107], v[18:19]
  v_pk_add_f32 v[52:53], v[52:53], v[248:249]
  v_pk_add_f32 v[56:57], v[56:57], v[248:249]
  v_pk_add_f32 v[60:61], v[60:61], v[248:249]
  v_pk_add_f32 v[64:65], v[64:65], v[248:249]
  v_rcp_f32 v52, v52
  v_rcp_f32 v53, v53
  v_rcp_f32 v56, v56
  v_rcp_f32 v57, v57
  v_rcp_f32 v60, v60
  v_rcp_f32 v61, v61
  v_rcp_f32 v64, v64
  v_rcp_f32 v65, v65
  v_pk_mul_f32 v[32:33], v[52:53], v[54:55]
  v_pk_mul_f32 v[34:35], v[56:57], v[58:59]
  v_pk_fma_f32 v[32:33], v[60:61], v[62:63], v[32:33]
  v_pk_fma_f32 v[34:35], v[64:65], v[66:67], v[34:35]
  v_pk_mul_f32 v[68:69], v[92:93], v[92:93]
  v_pk_mul_f32 v[72:73], v[108:109], v[108:109]
  v_pk_mul_f32 v[76:77], v[94:95], v[94:95]
  v_pk_mul_f32 v[80:81], v[110:111], v[110:111]
  v_pk_fma_f32 v[68:69], v[68:69], v[14:15], v[12:13]
  v_pk_fma_f32 v[72:73], v[72:73], v[14:15], v[12:13]
  v_pk_fma_f32 v[76:77], v[76:77], v[14:15], v[12:13]
  v_pk_fma_f32 v[80:81], v[80:81], v[14:15], v[12:13]
  v_pk_mul_f32 v[68:69], v[68:69], v[92:93]
  v_pk_mul_f32 v[72:73], v[72:73], v[108:109]
  v_pk_mul_f32 v[76:77], v[76:77], v[94:95]
  v_pk_mul_f32 v[80:81], v[80:81], v[110:111]
  v_exp_f32 v68, v68
  v_exp_f32 v69, v69
  v_exp_f32 v72, v72
  v_exp_f32 v73, v73
  v_exp_f32 v76, v76
  v_exp_f32 v77, v77
  v_exp_f32 v80, v80
  v_exp_f32 v81, v81
  v_pk_mul_f32 v[70:71], v[92:93], v[20:21]
  v_pk_mul_f32 v[74:75], v[108:109], v[20:21]
  v_pk_mul_f32 v[78:79], v[94:95], v[22:23]
  v_pk_mul_f32 v[82:83], v[110:111], v[22:23]
  v_pk_add_f32 v[68:69], v[68:69], v[248:249]
  v_pk_add_f32 v[72:73], v[72:73], v[248:249]
  v_pk_add_f32 v[76:77], v[76:77], v[248:249]
  v_pk_add_f32 v[80:81], v[80:81], v[248:249]
  v_rcp_f32 v68, v68
  v_rcp_f32 v69, v69
  v_rcp_f32 v72, v72
  v_rcp_f32 v73, v73
  v_rcp_f32 v76, v76
  v_rcp_f32 v77, v77
  v_rcp_f32 v80, v80
  v_rcp_f32 v81, v81
  v_pk_fma_f32 v[32:33], v[68:69], v[70:71], v[32:33]
  v_pk_fma_f32 v[34:35], v[72:73], v[74:75], v[34:35]
  v_pk_fma_f32 v[32:33], v[76:77], v[78:79], v[32:33]
  v_pk_fma_f32 v[34:35], v[80:81], v[82:83], v[34:35]
  v_pk_mul_f32 v[52:53], v[96:97], v[96:97]
  v_pk_mul_f32 v[56:57], v[112:113], v[112:113]
  v_pk_mul_f32 v[60:61], v[98:99], v[98:99]
  v_pk_mul_f32 v[64:65], v[114:115], v[114:115]
  v_pk_fma_f32 v[52:53], v[52:53], v[14:15], v[12:13]
  v_pk_fma_f32 v[56:57], v[56:57], v[14:15], v[12:13]
  v_pk_fma_f32 v[60:61], v[60:61], v[14:15], v[12:13]
  v_pk_fma_f32 v[64:65], v[64:65], v[14:15], v[12:13]
  v_pk_mul_f32 v[52:53], v[52:53], v[96:97]
  v_pk_mul_f32 v[56:57], v[56:57], v[112:113]
  v_pk_mul_f32 v[60:61], v[60:61], v[98:99]
  v_pk_mul_f32 v[64:65], v[64:65], v[114:115]
  v_exp_f32 v52, v52
  v_exp_f32 v53, v53
  v_exp_f32 v56, v56
  v_exp_f32 v57, v57
  v_exp_f32 v60, v60
  v_exp_f32 v61, v61
  v_exp_f32 v64, v64
  v_exp_f32 v65, v65
  v_pk_mul_f32 v[54:55], v[96:97], v[24:25]
  v_pk_mul_f32 v[58:59], v[112:113], v[24:25]
  v_pk_mul_f32 v[62:63], v[98:99], v[26:27]
  v_pk_mul_f32 v[66:67], v[114:115], v[26:27]
  v_pk_add_f32 v[52:53], v[52:53], v[248:249]
  v_pk_add_f32 v[56:57], v[56:57], v[248:249]
  v_pk_add_f32 v[60:61], v[60:61], v[248:249]
  v_pk_add_f32 v[64:65], v[64:65], v[248:249]
  v_rcp_f32 v52, v52
  v_rcp_f32 v53, v53
  v_rcp_f32 v56, v56
  v_rcp_f32 v57, v57
  v_rcp_f32 v60, v60
  v_rcp_f32 v61, v61
  v_rcp_f32 v64, v64
  v_rcp_f32 v65, v65
  v_pk_fma_f32 v[32:33], v[52:53], v[54:55], v[32:33]
  v_pk_fma_f32 v[34:35], v[56:57], v[58:59], v[34:35]
  v_pk_fma_f32 v[32:33], v[60:61], v[62:63], v[32:33]
  v_pk_fma_f32 v[34:35], v[64:65], v[66:67], v[34:35]
  v_pk_mul_f32 v[68:69], v[100:101], v[100:101]
  v_pk_mul_f32 v[72:73], v[116:117], v[116:117]
  v_pk_mul_f32 v[76:77], v[102:103], v[102:103]
  v_pk_mul_f32 v[80:81], v[118:119], v[118:119]
  v_pk_fma_f32 v[68:69], v[68:69], v[14:15], v[12:13]
  v_pk_fma_f32 v[72:73], v[72:73], v[14:15], v[12:13]
  v_pk_fma_f32 v[76:77], v[76:77], v[14:15], v[12:13]
  v_pk_fma_f32 v[80:81], v[80:81], v[14:15], v[12:13]
  v_pk_mul_f32 v[68:69], v[68:69], v[100:101]
  v_pk_mul_f32 v[72:73], v[72:73], v[116:117]
  v_pk_mul_f32 v[76:77], v[76:77], v[102:103]
  v_pk_mul_f32 v[80:81], v[80:81], v[118:119]
  v_exp_f32 v68, v68
  v_exp_f32 v69, v69
  v_exp_f32 v72, v72
  v_exp_f32 v73, v73
  v_exp_f32 v76, v76
  v_exp_f32 v77, v77
  v_exp_f32 v80, v80
  v_exp_f32 v81, v81
  v_pk_mul_f32 v[70:71], v[100:101], v[28:29]
  v_pk_mul_f32 v[74:75], v[116:117], v[28:29]
  v_pk_mul_f32 v[78:79], v[102:103], v[30:31]
  v_pk_mul_f32 v[82:83], v[118:119], v[30:31]
  v_pk_add_f32 v[68:69], v[68:69], v[248:249]
  v_pk_add_f32 v[72:73], v[72:73], v[248:249]
  v_pk_add_f32 v[76:77], v[76:77], v[248:249]
  v_pk_add_f32 v[80:81], v[80:81], v[248:249]
  v_rcp_f32 v68, v68
  v_rcp_f32 v69, v69
  v_rcp_f32 v72, v72
  v_rcp_f32 v73, v73
  v_rcp_f32 v76, v76
  v_rcp_f32 v77, v77
  v_rcp_f32 v80, v80
  v_rcp_f32 v81, v81
  v_pk_fma_f32 v[32:33], v[68:69], v[70:71], v[32:33]
  v_pk_fma_f32 v[34:35], v[72:73], v[74:75], v[34:35]
  v_pk_fma_f32 v[32:33], v[76:77], v[78:79], v[32:33]
  v_pk_fma_f32 v[34:35], v[80:81], v[82:83], v[34:35]
  v_pk_mul_f32 v[52:53], v[120:121], v[120:121]
  v_pk_mul_f32 v[56:57], v[136:137], v[136:137]
  v_pk_mul_f32 v[60:61], v[122:123], v[122:123]
  v_pk_mul_f32 v[64:65], v[138:139], v[138:139]
  v_pk_fma_f32 v[52:53], v[52:53], v[14:15], v[12:13]
  v_pk_fma_f32 v[56:57], v[56:57], v[14:15], v[12:13]
  v_pk_fma_f32 v[60:61], v[60:61], v[14:15], v[12:13]
  v_pk_fma_f32 v[64:65], v[64:65], v[14:15], v[12:13]
  v_pk_mul_f32 v[52:53], v[52:53], v[120:121]
  v_pk_mul_f32 v[56:57], v[56:57], v[136:137]
  v_pk_mul_f32 v[60:61], v[60:61], v[122:123]
  v_pk_mul_f32 v[64:65], v[64:65], v[138:139]
  v_exp_f32 v52, v52
  v_exp_f32 v53, v53
  v_exp_f32 v56, v56
  v_exp_f32 v57, v57
  v_exp_f32 v60, v60
  v_exp_f32 v61, v61
  v_exp_f32 v64, v64
  v_exp_f32 v65, v65
  v_pk_mul_f32 v[54:55], v[120:121], v[16:17]
  v_pk_mul_f32 v[58:59], v[136:137], v[16:17]
  v_pk_mul_f32 v[62:63], v[122:123], v[18:19]
  v_pk_mul_f32 v[66:67], v[138:139], v[18:19]
  v_pk_add_f32 v[52:53], v[52:53], v[248:249]
  v_pk_add_f32 v[56:57], v[56:57], v[248:249]
  v_pk_add_f32 v[60:61], v[60:61], v[248:249]
  v_pk_add_f32 v[64:65], v[64:65], v[248:249]
  v_rcp_f32 v52, v52
  v_rcp_f32 v53, v53
  v_rcp_f32 v56, v56
  v_rcp_f32 v57, v57
  v_rcp_f32 v60, v60
  v_rcp_f32 v61, v61
  v_rcp_f32 v64, v64
  v_rcp_f32 v65, v65
  v_pk_mul_f32 v[36:37], v[52:53], v[54:55]
  v_pk_mul_f32 v[38:39], v[56:57], v[58:59]
  v_pk_fma_f32 v[36:37], v[60:61], v[62:63], v[36:37]
  v_pk_fma_f32 v[38:39], v[64:65], v[66:67], v[38:39]
  v_pk_mul_f32 v[68:69], v[124:125], v[124:125]
  v_pk_mul_f32 v[72:73], v[140:141], v[140:141]
  v_pk_mul_f32 v[76:77], v[126:127], v[126:127]
  v_pk_mul_f32 v[80:81], v[142:143], v[142:143]
  v_pk_fma_f32 v[68:69], v[68:69], v[14:15], v[12:13]
  v_pk_fma_f32 v[72:73], v[72:73], v[14:15], v[12:13]
  v_pk_fma_f32 v[76:77], v[76:77], v[14:15], v[12:13]
  v_pk_fma_f32 v[80:81], v[80:81], v[14:15], v[12:13]
  v_pk_mul_f32 v[68:69], v[68:69], v[124:125]
  v_pk_mul_f32 v[72:73], v[72:73], v[140:141]
  v_pk_mul_f32 v[76:77], v[76:77], v[126:127]
  v_pk_mul_f32 v[80:81], v[80:81], v[142:143]
  v_exp_f32 v68, v68
  v_exp_f32 v69, v69
  v_exp_f32 v72, v72
  v_exp_f32 v73, v73
  v_exp_f32 v76, v76
  v_exp_f32 v77, v77
  v_exp_f32 v80, v80
  v_exp_f32 v81, v81
  v_pk_mul_f32 v[70:71], v[124:125], v[20:21]
  v_pk_mul_f32 v[74:75], v[140:141], v[20:21]
  v_pk_mul_f32 v[78:79], v[126:127], v[22:23]
  v_pk_mul_f32 v[82:83], v[142:143], v[22:23]
  v_pk_add_f32 v[68:69], v[68:69], v[248:249]
  v_pk_add_f32 v[72:73], v[72:73], v[248:249]
  v_pk_add_f32 v[76:77], v[76:77], v[248:249]
  v_pk_add_f32 v[80:81], v[80:81], v[248:249]
  v_rcp_f32 v68, v68
  v_rcp_f32 v69, v69
  v_rcp_f32 v72, v72
  v_rcp_f32 v73, v73
  v_rcp_f32 v76, v76
  v_rcp_f32 v77, v77
  v_rcp_f32 v80, v80
  v_rcp_f32 v81, v81
  v_pk_fma_f32 v[36:37], v[68:69], v[70:71], v[36:37]
  v_pk_fma_f32 v[38:39], v[72:73], v[74:75], v[38:39]
  v_pk_fma_f32 v[36:37], v[76:77], v[78:79], v[36:37]
  v_pk_fma_f32 v[38:39], v[80:81], v[82:83], v[38:39]
  v_pk_mul_f32 v[52:53], v[128:129], v[128:129]
  v_pk_mul_f32 v[56:57], v[144:145], v[144:145]
  v_pk_mul_f32 v[60:61], v[130:131], v[130:131]
  v_pk_mul_f32 v[64:65], v[146:147], v[146:147]
  v_pk_fma_f32 v[52:53], v[52:53], v[14:15], v[12:13]
  v_pk_fma_f32 v[56:57], v[56:57], v[14:15], v[12:13]
  v_pk_fma_f32 v[60:61], v[60:61], v[14:15], v[12:13]
  v_pk_fma_f32 v[64:65], v[64:65], v[14:15], v[12:13]
  v_pk_mul_f32 v[52:53], v[52:53], v[128:129]
  v_pk_mul_f32 v[56:57], v[56:57], v[144:145]
  v_pk_mul_f32 v[60:61], v[60:61], v[130:131]
  v_pk_mul_f32 v[64:65], v[64:65], v[146:147]
  v_exp_f32 v52, v52
  v_exp_f32 v53, v53
  v_exp_f32 v56, v56
  v_exp_f32 v57, v57
  v_exp_f32 v60, v60
  v_exp_f32 v61, v61
  v_exp_f32 v64, v64
  v_exp_f32 v65, v65
  v_pk_mul_f32 v[54:55], v[128:129], v[24:25]
  v_pk_mul_f32 v[58:59], v[144:145], v[24:25]
  v_pk_mul_f32 v[62:63], v[130:131], v[26:27]
  v_pk_mul_f32 v[66:67], v[146:147], v[26:27]
  v_pk_add_f32 v[52:53], v[52:53], v[248:249]
  v_pk_add_f32 v[56:57], v[56:57], v[248:249]
  v_pk_add_f32 v[60:61], v[60:61], v[248:249]
  v_pk_add_f32 v[64:65], v[64:65], v[248:249]
  v_rcp_f32 v52, v52
  v_rcp_f32 v53, v53
  v_rcp_f32 v56, v56
  v_rcp_f32 v57, v57
  v_rcp_f32 v60, v60
  v_rcp_f32 v61, v61
  v_rcp_f32 v64, v64
  v_rcp_f32 v65, v65
  v_pk_fma_f32 v[36:37], v[52:53], v[54:55], v[36:37]
  v_pk_fma_f32 v[38:39], v[56:57], v[58:59], v[38:39]
  v_pk_fma_f32 v[36:37], v[60:61], v[62:63], v[36:37]
  v_pk_fma_f32 v[38:39], v[64:65], v[66:67], v[38:39]
  v_pk_mul_f32 v[68:69], v[132:133], v[132:133]
  v_pk_mul_f32 v[72:73], v[148:149], v[148:149]
  v_pk_mul_f32 v[76:77], v[134:135], v[134:135]
  v_pk_mul_f32 v[80:81], v[150:151], v[150:151]
  v_pk_fma_f32 v[68:69], v[68:69], v[14:15], v[12:13]
  v_pk_fma_f32 v[72:73], v[72:73], v[14:15], v[12:13]
  v_pk_fma_f32 v[76:77], v[76:77], v[14:15], v[12:13]
  v_pk_fma_f32 v[80:81], v[80:81], v[14:15], v[12:13]
  v_pk_mul_f32 v[68:69], v[68:69], v[132:133]
  v_pk_mul_f32 v[72:73], v[72:73], v[148:149]
  v_pk_mul_f32 v[76:77], v[76:77], v[134:135]
  v_pk_mul_f32 v[80:81], v[80:81], v[150:151]
  v_exp_f32 v68, v68
  v_exp_f32 v69, v69
  v_exp_f32 v72, v72
  v_exp_f32 v73, v73
  v_exp_f32 v76, v76
  v_exp_f32 v77, v77
  v_exp_f32 v80, v80
  v_exp_f32 v81, v81
  v_pk_mul_f32 v[70:71], v[132:133], v[28:29]
  v_pk_mul_f32 v[74:75], v[148:149], v[28:29]
  v_pk_mul_f32 v[78:79], v[134:135], v[30:31]
  v_pk_mul_f32 v[82:83], v[150:151], v[30:31]
  v_pk_add_f32 v[68:69], v[68:69], v[248:249]
  v_pk_add_f32 v[72:73], v[72:73], v[248:249]
  v_pk_add_f32 v[76:77], v[76:77], v[248:249]
  v_pk_add_f32 v[80:81], v[80:81], v[248:249]
  v_rcp_f32 v68, v68
  v_rcp_f32 v69, v69
  v_rcp_f32 v72, v72
  v_rcp_f32 v73, v73
  v_rcp_f32 v76, v76
  v_rcp_f32 v77, v77
  v_rcp_f32 v80, v80
  v_rcp_f32 v81, v81
  v_pk_fma_f32 v[36:37], v[68:69], v[70:71], v[36:37]
  v_pk_fma_f32 v[38:39], v[72:73], v[74:75], v[38:39]
  v_pk_fma_f32 v[36:37], v[76:77], v[78:79], v[36:37]
  v_pk_fma_f32 v[38:39], v[80:81], v[82:83], v[38:39]
  v_pk_mul_f32 v[52:53], v[152:153], v[152:153]
  v_pk_mul_f32 v[56:57], v[168:169], v[168:169]
  v_pk_mul_f32 v[60:61], v[154:155], v[154:155]
  v_pk_mul_f32 v[64:65], v[170:171], v[170:171]
  v_pk_fma_f32 v[52:53], v[52:53], v[14:15], v[12:13]
  v_pk_fma_f32 v[56:57], v[56:57], v[14:15], v[12:13]
  v_pk_fma_f32 v[60:61], v[60:61], v[14:15], v[12:13]
  v_pk_fma_f32 v[64:65], v[64:65], v[14:15], v[12:13]
  v_pk_mul_f32 v[52:53], v[52:53], v[152:153]
  v_pk_mul_f32 v[56:57], v[56:57], v[168:169]
  v_pk_mul_f32 v[60:61], v[60:61], v[154:155]
  v_pk_mul_f32 v[64:65], v[64:65], v[170:171]
  v_exp_f32 v52, v52
  v_exp_f32 v53, v53
  v_exp_f32 v56, v56
  v_exp_f32 v57, v57
  v_exp_f32 v60, v60
  v_exp_f32 v61, v61
  v_exp_f32 v64, v64
  v_exp_f32 v65, v65
  v_pk_mul_f32 v[54:55], v[152:153], v[16:17]
  v_pk_mul_f32 v[58:59], v[168:169], v[16:17]
  v_pk_mul_f32 v[62:63], v[154:155], v[18:19]
  v_pk_mul_f32 v[66:67], v[170:171], v[18:19]
  v_pk_add_f32 v[52:53], v[52:53], v[248:249]
  v_pk_add_f32 v[56:57], v[56:57], v[248:249]
  v_pk_add_f32 v[60:61], v[60:61], v[248:249]
  v_pk_add_f32 v[64:65], v[64:65], v[248:249]
  v_rcp_f32 v52, v52
  v_rcp_f32 v53, v53
  v_rcp_f32 v56, v56
  v_rcp_f32 v57, v57
  v_rcp_f32 v60, v60
  v_rcp_f32 v61, v61
  v_rcp_f32 v64, v64
  v_rcp_f32 v65, v65
  v_pk_mul_f32 v[40:41], v[52:53], v[54:55]
  v_pk_mul_f32 v[42:43], v[56:57], v[58:59]
  v_pk_fma_f32 v[40:41], v[60:61], v[62:63], v[40:41]
  v_pk_fma_f32 v[42:43], v[64:65], v[66:67], v[42:43]
  v_pk_mul_f32 v[68:69], v[156:157], v[156:157]
  v_pk_mul_f32 v[72:73], v[172:173], v[172:173]
  v_pk_mul_f32 v[76:77], v[158:159], v[158:159]
  v_pk_mul_f32 v[80:81], v[174:175], v[174:175]
  v_pk_fma_f32 v[68:69], v[68:69], v[14:15], v[12:13]
  v_pk_fma_f32 v[72:73], v[72:73], v[14:15], v[12:13]
  v_pk_fma_f32 v[76:77], v[76:77], v[14:15], v[12:13]
  v_pk_fma_f32 v[80:81], v[80:81], v[14:15], v[12:13]
  v_pk_mul_f32 v[68:69], v[68:69], v[156:157]
  v_pk_mul_f32 v[72:73], v[72:73], v[172:173]
  v_pk_mul_f32 v[76:77], v[76:77], v[158:159]
  v_pk_mul_f32 v[80:81], v[80:81], v[174:175]
  v_exp_f32 v68, v68
  v_exp_f32 v69, v69
  v_exp_f32 v72, v72
  v_exp_f32 v73, v73
  v_exp_f32 v76, v76
  v_exp_f32 v77, v77
  v_exp_f32 v80, v80
  v_exp_f32 v81, v81
  v_pk_mul_f32 v[70:71], v[156:157], v[20:21]
  v_pk_mul_f32 v[74:75], v[172:173], v[20:21]
  v_pk_mul_f32 v[78:79], v[158:159], v[22:23]
  v_pk_mul_f32 v[82:83], v[174:175], v[22:23]
  v_pk_add_f32 v[68:69], v[68:69], v[248:249]
  v_pk_add_f32 v[72:73], v[72:73], v[248:249]
  v_pk_add_f32 v[76:77], v[76:77], v[248:249]
  v_pk_add_f32 v[80:81], v[80:81], v[248:249]
  v_rcp_f32 v68, v68
  v_rcp_f32 v69, v69
  v_rcp_f32 v72, v72
  v_rcp_f32 v73, v73
  v_rcp_f32 v76, v76
  v_rcp_f32 v77, v77
  v_rcp_f32 v80, v80
  v_rcp_f32 v81, v81
  v_pk_fma_f32 v[40:41], v[68:69], v[70:71], v[40:41]
  v_pk_fma_f32 v[42:43], v[72:73], v[74:75], v[42:43]
  v_pk_fma_f32 v[40:41], v[76:77], v[78:79], v[40:41]
  v_pk_fma_f32 v[42:43], v[80:81], v[82:83], v[42:43]
  v_pk_mul_f32 v[52:53], v[160:161], v[160:161]
  v_pk_mul_f32 v[56:57], v[176:177], v[176:177]
  v_pk_mul_f32 v[60:61], v[162:163], v[162:163]
  v_pk_mul_f32 v[64:65], v[178:179], v[178:179]
  v_pk_fma_f32 v[52:53], v[52:53], v[14:15], v[12:13]
  v_pk_fma_f32 v[56:57], v[56:57], v[14:15], v[12:13]
  v_pk_fma_f32 v[60:61], v[60:61], v[14:15], v[12:13]
  v_pk_fma_f32 v[64:65], v[64:65], v[14:15], v[12:13]
  v_pk_mul_f32 v[52:53], v[52:53], v[160:161]
  v_pk_mul_f32 v[56:57], v[56:57], v[176:177]
  v_pk_mul_f32 v[60:61], v[60:61], v[162:163]
  v_pk_mul_f32 v[64:65], v[64:65], v[178:179]
  v_exp_f32 v52, v52
  v_exp_f32 v53, v53
  v_exp_f32 v56, v56
  v_exp_f32 v57, v57
  v_exp_f32 v60, v60
  v_exp_f32 v61, v61
  v_exp_f32 v64, v64
  v_exp_f32 v65, v65
  v_pk_mul_f32 v[54:55], v[160:161], v[24:25]
  v_pk_mul_f32 v[58:59], v[176:177], v[24:25]
  v_pk_mul_f32 v[62:63], v[162:163], v[26:27]
  v_pk_mul_f32 v[66:67], v[178:179], v[26:27]
  v_pk_add_f32 v[52:53], v[52:53], v[248:249]
  v_pk_add_f32 v[56:57], v[56:57], v[248:249]
  v_pk_add_f32 v[60:61], v[60:61], v[248:249]
  v_pk_add_f32 v[64:65], v[64:65], v[248:249]
  v_rcp_f32 v52, v52
  v_rcp_f32 v53, v53
  v_rcp_f32 v56, v56
  v_rcp_f32 v57, v57
  v_rcp_f32 v60, v60
  v_rcp_f32 v61, v61
  v_rcp_f32 v64, v64
  v_rcp_f32 v65, v65
  v_pk_fma_f32 v[40:41], v[52:53], v[54:55], v[40:41]
  v_pk_fma_f32 v[42:43], v[56:57], v[58:59], v[42:43]
  v_pk_fma_f32 v[40:41], v[60:61], v[62:63], v[40:41]
  v_pk_fma_f32 v[42:43], v[64:65], v[66:67], v[42:43]
  v_pk_mul_f32 v[68:69], v[164:165], v[164:165]
  v_pk_mul_f32 v[72:73], v[180:181], v[180:181]
  v_pk_mul_f32 v[76:77], v[166:167], v[166:167]
  v_pk_mul_f32 v[80:81], v[182:183], v[182:183]
  v_pk_fma_f32 v[68:69], v[68:69], v[14:15], v[12:13]
  v_pk_fma_f32 v[72:73], v[72:73], v[14:15], v[12:13]
  v_pk_fma_f32 v[76:77], v[76:77], v[14:15], v[12:13]
  v_pk_fma_f32 v[80:81], v[80:81], v[14:15], v[12:13]
  v_pk_mul_f32 v[68:69], v[68:69], v[164:165]
  v_pk_mul_f32 v[72:73], v[72:73], v[180:181]
  v_pk_mul_f32 v[76:77], v[76:77], v[166:167]
  v_pk_mul_f32 v[80:81], v[80:81], v[182:183]
  v_exp_f32 v68, v68
  v_exp_f32 v69, v69
  v_exp_f32 v72, v72
  v_exp_f32 v73, v73
  v_exp_f32 v76, v76
  v_exp_f32 v77, v77
  v_exp_f32 v80, v80
  v_exp_f32 v81, v81
  v_pk_mul_f32 v[70:71], v[164:165], v[28:29]
  v_pk_mul_f32 v[74:75], v[180:181], v[28:29]
  v_pk_mul_f32 v[78:79], v[166:167], v[30:31]
  v_pk_mul_f32 v[82:83], v[182:183], v[30:31]
  v_pk_add_f32 v[68:69], v[68:69], v[248:249]
  v_pk_add_f32 v[72:73], v[72:73], v[248:249]
  v_pk_add_f32 v[76:77], v[76:77], v[248:249]
  v_pk_add_f32 v[80:81], v[80:81], v[248:249]
  v_rcp_f32 v68, v68
  v_rcp_f32 v69, v69
  v_rcp_f32 v72, v72
  v_rcp_f32 v73, v73
  v_rcp_f32 v76, v76
  v_rcp_f32 v77, v77
  v_rcp_f32 v80, v80
  v_rcp_f32 v81, v81
  v_pk_fma_f32 v[40:41], v[68:69], v[70:71], v[40:41]
  v_pk_fma_f32 v[42:43], v[72:73], v[74:75], v[42:43]
  v_pk_fma_f32 v[40:41], v[76:77], v[78:79], v[40:41]
  v_pk_fma_f32 v[42:43], v[80:81], v[82:83], v[42:43]
  v_pk_mul_f32 v[52:53], v[184:185], v[184:185]
  v_pk_mul_f32 v[56:57], v[200:201], v[200:201]
  v_pk_mul_f32 v[60:61], v[186:187], v[186:187]
  v_pk_mul_f32 v[64:65], v[202:203], v[202:203]
  v_pk_fma_f32 v[52:53], v[52:53], v[14:15], v[12:13]
  v_pk_fma_f32 v[56:57], v[56:57], v[14:15], v[12:13]
  v_pk_fma_f32 v[60:61], v[60:61], v[14:15], v[12:13]
  v_pk_fma_f32 v[64:65], v[64:65], v[14:15], v[12:13]
  v_pk_mul_f32 v[52:53], v[52:53], v[184:185]
  v_pk_mul_f32 v[56:57], v[56:57], v[200:201]
  v_pk_mul_f32 v[60:61], v[60:61], v[186:187]
  v_pk_mul_f32 v[64:65], v[64:65], v[202:203]
  v_exp_f32 v52, v52
  v_exp_f32 v53, v53
  v_exp_f32 v56, v56
  v_exp_f32 v57, v57
  v_exp_f32 v60, v60
  v_exp_f32 v61, v61
  v_exp_f32 v64, v64
  v_exp_f32 v65, v65
  v_pk_mul_f32 v[54:55], v[184:185], v[16:17]
  v_pk_mul_f32 v[58:59], v[200:201], v[16:17]
  v_pk_mul_f32 v[62:63], v[186:187], v[18:19]
  v_pk_mul_f32 v[66:67], v[202:203], v[18:19]
  v_pk_add_f32 v[52:53], v[52:53], v[248:249]
  v_pk_add_f32 v[56:57], v[56:57], v[248:249]
  v_pk_add_f32 v[60:61], v[60:61], v[248:249]
  v_pk_add_f32 v[64:65], v[64:65], v[248:249]
  v_rcp_f32 v52, v52
  v_rcp_f32 v53, v53
  v_rcp_f32 v56, v56
  v_rcp_f32 v57, v57
  v_rcp_f32 v60, v60
  v_rcp_f32 v61, v61
  v_rcp_f32 v64, v64
  v_rcp_f32 v65, v65
  v_pk_mul_f32 v[44:45], v[52:53], v[54:55]
  v_pk_mul_f32 v[46:47], v[56:57], v[58:59]
  v_pk_fma_f32 v[44:45], v[60:61], v[62:63], v[44:45]
  v_pk_fma_f32 v[46:47], v[64:65], v[66:67], v[46:47]
  v_pk_mul_f32 v[68:69], v[188:189], v[188:189]
  v_pk_mul_f32 v[72:73], v[204:205], v[204:205]
  v_pk_mul_f32 v[76:77], v[190:191], v[190:191]
  v_pk_mul_f32 v[80:81], v[206:207], v[206:207]
  v_pk_fma_f32 v[68:69], v[68:69], v[14:15], v[12:13]
  v_pk_fma_f32 v[72:73], v[72:73], v[14:15], v[12:13]
  v_pk_fma_f32 v[76:77], v[76:77], v[14:15], v[12:13]
  v_pk_fma_f32 v[80:81], v[80:81], v[14:15], v[12:13]
  v_pk_mul_f32 v[68:69], v[68:69], v[188:189]
  v_pk_mul_f32 v[72:73], v[72:73], v[204:205]
  v_pk_mul_f32 v[76:77], v[76:77], v[190:191]
  v_pk_mul_f32 v[80:81], v[80:81], v[206:207]
  v_exp_f32 v68, v68
  v_exp_f32 v69, v69
  v_exp_f32 v72, v72
  v_exp_f32 v73, v73
  v_exp_f32 v76, v76
  v_exp_f32 v77, v77
  v_exp_f32 v80, v80
  v_exp_f32 v81, v81
  v_pk_mul_f32 v[70:71], v[188:189], v[20:21]
  v_pk_mul_f32 v[74:75], v[204:205], v[20:21]
  v_pk_mul_f32 v[78:79], v[190:191], v[22:23]
  v_pk_mul_f32 v[82:83], v[206:207], v[22:23]
  v_pk_add_f32 v[68:69], v[68:69], v[248:249]
  v_pk_add_f32 v[72:73], v[72:73], v[248:249]
  v_pk_add_f32 v[76:77], v[76:77], v[248:249]
  v_pk_add_f32 v[80:81], v[80:81], v[248:249]
  v_rcp_f32 v68, v68
  v_rcp_f32 v69, v69
  v_rcp_f32 v72, v72
  v_rcp_f32 v73, v73
  v_rcp_f32 v76, v76
  v_rcp_f32 v77, v77
  v_rcp_f32 v80, v80
  v_rcp_f32 v81, v81
  v_pk_fma_f32 v[44:45], v[68:69], v[70:71], v[44:45]
  v_pk_fma_f32 v[46:47], v[72:73], v[74:75], v[46:47]
  v_pk_fma_f32 v[44:45], v[76:77], v[78:79], v[44:45]
  v_pk_fma_f32 v[46:47], v[80:81], v[82:83], v[46:47]
  v_pk_mul_f32 v[52:53], v[192:193], v[192:193]
  v_pk_mul_f32 v[56:57], v[208:209], v[208:209]
  v_pk_mul_f32 v[60:61], v[194:195], v[194:195]
  v_pk_mul_f32 v[64:65], v[210:211], v[210:211]
  v_pk_fma_f32 v[52:53], v[52:53], v[14:15], v[12:13]
  v_pk_fma_f32 v[56:57], v[56:57], v[14:15], v[12:13]
  v_pk_fma_f32 v[60:61], v[60:61], v[14:15], v[12:13]
  v_pk_fma_f32 v[64:65], v[64:65], v[14:15], v[12:13]
  v_pk_mul_f32 v[52:53], v[52:53], v[192:193]
  v_pk_mul_f32 v[56:57], v[56:57], v[208:209]
  v_pk_mul_f32 v[60:61], v[60:61], v[194:195]
  v_pk_mul_f32 v[64:65], v[64:65], v[210:211]
  v_exp_f32 v52, v52
  v_exp_f32 v53, v53
  v_exp_f32 v56, v56
  v_exp_f32 v57, v57
  v_exp_f32 v60, v60
  v_exp_f32 v61, v61
  v_exp_f32 v64, v64
  v_exp_f32 v65, v65
  v_pk_mul_f32 v[54:55], v[192:193], v[24:25]
  v_pk_mul_f32 v[58:59], v[208:209], v[24:25]
  v_pk_mul_f32 v[62:63], v[194:195], v[26:27]
  v_pk_mul_f32 v[66:67], v[210:211], v[26:27]
  v_pk_add_f32 v[52:53], v[52:53], v[248:249]
  v_pk_add_f32 v[56:57], v[56:57], v[248:249]
  v_pk_add_f32 v[60:61], v[60:61], v[248:249]
  v_pk_add_f32 v[64:65], v[64:65], v[248:249]
  v_rcp_f32 v52, v52
  v_rcp_f32 v53, v53
  v_rcp_f32 v56, v56
  v_rcp_f32 v57, v57
  v_rcp_f32 v60, v60
  v_rcp_f32 v61, v61
  v_rcp_f32 v64, v64
  v_rcp_f32 v65, v65
  v_pk_fma_f32 v[44:45], v[52:53], v[54:55], v[44:45]
  v_pk_fma_f32 v[46:47], v[56:57], v[58:59], v[46:47]
  v_pk_fma_f32 v[44:45], v[60:61], v[62:63], v[44:45]
  v_pk_fma_f32 v[46:47], v[64:65], v[66:67], v[46:47]
  v_pk_mul_f32 v[68:69], v[196:197], v[196:197]
  v_pk_mul_f32 v[72:73], v[212:213], v[212:213]
  v_pk_mul_f32 v[76:77], v[198:199], v[198:199]
  v_pk_mul_f32 v[80:81], v[214:215], v[214:215]
  v_pk_fma_f32 v[68:69], v[68:69], v[14:15], v[12:13]
  v_pk_fma_f32 v[72:73], v[72:73], v[14:15], v[12:13]
  v_pk_fma_f32 v[76:77], v[76:77], v[14:15], v[12:13]
  v_pk_fma_f32 v[80:81], v[80:81], v[14:15], v[12:13]
  v_pk_mul_f32 v[68:69], v[68:69], v[196:197]
  v_pk_mul_f32 v[72:73], v[72:73], v[212:213]
  v_pk_mul_f32 v[76:77], v[76:77], v[198:199]
  v_pk_mul_f32 v[80:81], v[80:81], v[214:215]
  v_exp_f32 v68, v68
  v_exp_f32 v69, v69
  v_exp_f32 v72, v72
  v_exp_f32 v73, v73
  v_exp_f32 v76, v76
  v_exp_f32 v77, v77
  v_exp_f32 v80, v80
  v_exp_f32 v81, v81
  v_pk_mul_f32 v[70:71], v[196:197], v[28:29]
  v_pk_mul_f32 v[74:75], v[212:213], v[28:29]
  v_pk_mul_f32 v[78:79], v[198:199], v[30:31]
  v_pk_mul_f32 v[82:83], v[214:215], v[30:31]
  v_pk_add_f32 v[68:69], v[68:69], v[248:249]
  v_pk_add_f32 v[72:73], v[72:73], v[248:249]
  v_pk_add_f32 v[76:77], v[76:77], v[248:249]
  v_pk_add_f32 v[80:81], v[80:81], v[248:249]
  v_rcp_f32 v68, v68
  v_rcp_f32 v69, v69
  v_rcp_f32 v72, v72
  v_rcp_f32 v73, v73
  v_rcp_f32 v76, v76
  v_rcp_f32 v77, v77
  v_rcp_f32 v80, v80
  v_rcp_f32 v81, v81
  v_pk_fma_f32 v[44:45], v[68:69], v[70:71], v[44:45]
  v_pk_fma_f32 v[46:47], v[72:73], v[74:75], v[46:47]
  v_pk_fma_f32 v[44:45], v[76:77], v[78:79], v[44:45]
  v_pk_fma_f32 v[46:47], v[80:81], v[82:83], v[46:47]
  v_pk_mul_f32 v[52:53], v[216:217], v[216:217]
  v_pk_mul_f32 v[56:57], v[232:233], v[232:233]
  v_pk_mul_f32 v[60:61], v[218:219], v[218:219]
  v_pk_mul_f32 v[64:65], v[234:235], v[234:235]
  v_pk_fma_f32 v[52:53], v[52:53], v[14:15], v[12:13]
  v_pk_fma_f32 v[56:57], v[56:57], v[14:15], v[12:13]
  v_pk_fma_f32 v[60:61], v[60:61], v[14:15], v[12:13]
  v_pk_fma_f32 v[64:65], v[64:65], v[14:15], v[12:13]
  v_pk_mul_f32 v[52:53], v[52:53], v[216:217]
  v_pk_mul_f32 v[56:57], v[56:57], v[232:233]
  v_pk_mul_f32 v[60:61], v[60:61], v[218:219]
  v_pk_mul_f32 v[64:65], v[64:65], v[234:235]
  v_exp_f32 v52, v52
  v_exp_f32 v53, v53
  v_exp_f32 v56, v56
  v_exp_f32 v57, v57
  v_exp_f32 v60, v60
  v_exp_f32 v61, v61
  v_exp_f32 v64, v64
  v_exp_f32 v65, v65
  v_pk_mul_f32 v[54:55], v[216:217], v[16:17]
  v_pk_mul_f32 v[58:59], v[232:233], v[16:17]
  v_pk_mul_f32 v[62:63], v[218:219], v[18:19]
  v_pk_mul_f32 v[66:67], v[234:235], v[18:19]
  v_pk_add_f32 v[52:53], v[52:53], v[248:249]
  v_pk_add_f32 v[56:57], v[56:57], v[248:249]
  v_pk_add_f32 v[60:61], v[60:61], v[248:249]
  v_pk_add_f32 v[64:65], v[64:65], v[248:249]
  v_rcp_f32 v52, v52
  v_rcp_f32 v53, v53
  v_rcp_f32 v56, v56
  v_rcp_f32 v57, v57
  v_rcp_f32 v60, v60
  v_rcp_f32 v61, v61
  v_rcp_f32 v64, v64
  v_rcp_f32 v65, v65
  v_pk_mul_f32 v[48:49], v[52:53], v[54:55]
  v_pk_mul_f32 v[50:51], v[56:57], v[58:59]
  v_pk_fma_f32 v[48:49], v[60:61], v[62:63], v[48:49]
  v_pk_fma_f32 v[50:51], v[64:65], v[66:67], v[50:51]
  v_pk_mul_f32 v[68:69], v[220:221], v[220:221]
  v_pk_mul_f32 v[72:73], v[236:237], v[236:237]
  v_pk_mul_f32 v[76:77], v[222:223], v[222:223]
  v_pk_mul_f32 v[80:81], v[238:239], v[238:239]
  v_pk_fma_f32 v[68:69], v[68:69], v[14:15], v[12:13]
  v_pk_fma_f32 v[72:73], v[72:73], v[14:15], v[12:13]
  v_pk_fma_f32 v[76:77], v[76:77], v[14:15], v[12:13]
  v_pk_fma_f32 v[80:81], v[80:81], v[14:15], v[12:13]
  v_pk_mul_f32 v[68:69], v[68:69], v[220:221]
  v_pk_mul_f32 v[72:73], v[72:73], v[236:237]
  v_pk_mul_f32 v[76:77], v[76:77], v[222:223]
  v_pk_mul_f32 v[80:81], v[80:81], v[238:239]
  v_exp_f32 v68, v68
  v_exp_f32 v69, v69
  v_exp_f32 v72, v72
  v_exp_f32 v73, v73
  v_exp_f32 v76, v76
  v_exp_f32 v77, v77
  v_exp_f32 v80, v80
  v_exp_f32 v81, v81
  v_pk_mul_f32 v[70:71], v[220:221], v[20:21]
  v_pk_mul_f32 v[74:75], v[236:237], v[20:21]
  v_pk_mul_f32 v[78:79], v[222:223], v[22:23]
  v_pk_mul_f32 v[82:83], v[238:239], v[22:23]
  v_pk_add_f32 v[68:69], v[68:69], v[248:249]
  v_pk_add_f32 v[72:73], v[72:73], v[248:249]
  v_pk_add_f32 v[76:77], v[76:77], v[248:249]
  v_pk_add_f32 v[80:81], v[80:81], v[248:249]
  v_rcp_f32 v68, v68
  v_rcp_f32 v69, v69
  v_rcp_f32 v72, v72
  v_rcp_f32 v73, v73
  v_rcp_f32 v76, v76
  v_rcp_f32 v77, v77
  v_rcp_f32 v80, v80
  v_rcp_f32 v81, v81
  v_pk_fma_f32 v[48:49], v[68:69], v[70:71], v[48:49]
  v_pk_fma_f32 v[50:51], v[72:73], v[74:75], v[50:51]
  v_pk_fma_f32 v[48:49], v[76:77], v[78:79], v[48:49]
  v_pk_fma_f32 v[50:51], v[80:81], v[82:83], v[50:51]
  v_pk_mul_f32 v[52:53], v[224:225], v[224:225]
  v_pk_mul_f32 v[56:57], v[240:241], v[240:241]
  v_pk_mul_f32 v[60:61], v[226:227], v[226:227]
  v_pk_mul_f32 v[64:65], v[242:243], v[242:243]
  v_pk_fma_f32 v[52:53], v[52:53], v[14:15], v[12:13]
  v_pk_fma_f32 v[56:57], v[56:57], v[14:15], v[12:13]
  v_pk_fma_f32 v[60:61], v[60:61], v[14:15], v[12:13]
  v_pk_fma_f32 v[64:65], v[64:65], v[14:15], v[12:13]
  v_pk_mul_f32 v[52:53], v[52:53], v[224:225]
  v_pk_mul_f32 v[56:57], v[56:57], v[240:241]
  v_pk_mul_f32 v[60:61], v[60:61], v[226:227]
  v_pk_mul_f32 v[64:65], v[64:65], v[242:243]
  v_exp_f32 v52, v52
  v_exp_f32 v53, v53
  v_exp_f32 v56, v56
  v_exp_f32 v57, v57
  v_exp_f32 v60, v60
  v_exp_f32 v61, v61
  v_exp_f32 v64, v64
  v_exp_f32 v65, v65
  v_pk_mul_f32 v[54:55], v[224:225], v[24:25]
  v_pk_mul_f32 v[58:59], v[240:241], v[24:25]
  v_pk_mul_f32 v[62:63], v[226:227], v[26:27]
  v_pk_mul_f32 v[66:67], v[242:243], v[26:27]
  v_pk_add_f32 v[52:53], v[52:53], v[248:249]
  v_pk_add_f32 v[56:57], v[56:57], v[248:249]
  v_pk_add_f32 v[60:61], v[60:61], v[248:249]
  v_pk_add_f32 v[64:65], v[64:65], v[248:249]
  v_rcp_f32 v52, v52
  v_rcp_f32 v53, v53
  v_rcp_f32 v56, v56
  v_rcp_f32 v57, v57
  v_rcp_f32 v60, v60
  v_rcp_f32 v61, v61
  v_rcp_f32 v64, v64
  v_rcp_f32 v65, v65
  v_pk_fma_f32 v[48:49], v[52:53], v[54:55], v[48:49]
  v_pk_fma_f32 v[50:51], v[56:57], v[58:59], v[50:51]
  v_pk_fma_f32 v[48:49], v[60:61], v[62:63], v[48:49]
  v_pk_fma_f32 v[50:51], v[64:65], v[66:67], v[50:51]
  v_pk_mul_f32 v[68:69], v[228:229], v[228:229]
  v_pk_mul_f32 v[72:73], v[244:245], v[244:245]
  v_pk_mul_f32 v[76:77], v[230:231], v[230:231]
  v_pk_mul_f32 v[80:81], v[246:247], v[246:247]
  v_pk_fma_f32 v[68:69], v[68:69], v[14:15], v[12:13]
  v_pk_fma_f32 v[72:73], v[72:73], v[14:15], v[12:13]
  v_pk_fma_f32 v[76:77], v[76:77], v[14:15], v[12:13]
  v_pk_fma_f32 v[80:81], v[80:81], v[14:15], v[12:13]
  v_pk_mul_f32 v[68:69], v[68:69], v[228:229]
  v_pk_mul_f32 v[72:73], v[72:73], v[244:245]
  v_pk_mul_f32 v[76:77], v[76:77], v[230:231]
  v_pk_mul_f32 v[80:81], v[80:81], v[246:247]
  v_exp_f32 v68, v68
  v_exp_f32 v69, v69
  v_exp_f32 v72, v72
  v_exp_f32 v73, v73
  v_exp_f32 v76, v76
  v_exp_f32 v77, v77
  v_exp_f32 v80, v80
  v_exp_f32 v81, v81
  v_pk_mul_f32 v[70:71], v[228:229], v[28:29]
  v_pk_mul_f32 v[74:75], v[244:245], v[28:29]
  v_pk_mul_f32 v[78:79], v[230:231], v[30:31]
  v_pk_mul_f32 v[82:83], v[246:247], v[30:31]
  v_pk_add_f32 v[68:69], v[68:69], v[248:249]
  v_pk_add_f32 v[72:73], v[72:73], v[248:249]
  v_pk_add_f32 v[76:77], v[76:77], v[248:249]
  v_pk_add_f32 v[80:81], v[80:81], v[248:249]
  v_rcp_f32 v68, v68
  v_rcp_f32 v69, v69
  v_rcp_f32 v72, v72
  v_rcp_f32 v73, v73
  v_rcp_f32 v76, v76
  v_rcp_f32 v77, v77
  v_rcp_f32 v80, v80
  v_rcp_f32 v81, v81
  v_pk_fma_f32 v[48:49], v[68:69], v[70:71], v[48:49]
  v_pk_fma_f32 v[50:51], v[72:73], v[74:75], v[50:51]
  v_pk_fma_f32 v[48:49], v[76:77], v[78:79], v[48:49]
  v_pk_fma_f32 v[50:51], v[80:81], v[82:83], v[50:51]
  v_add_f32 v32, v32, v33
  v_add_f32 v34, v34, v35
  v_add_f32 v36, v36, v37
  v_add_f32 v38, v38, v39
  v_add_f32 v40, v40, v41
  v_add_f32 v42, v42, v43
  v_add_f32 v44, v44, v45
  v_add_f32 v46, v46, v47
  v_add_f32 v48, v48, v49
  v_add_f32 v50, v50, v51
  v_permlane32_swap_b32 v32, v34
  v_permlane32_swap_b32 v36, v38
  v_permlane32_swap_b32 v40, v42
  v_permlane32_swap_b32 v44, v46
  v_permlane32_swap_b32 v48, v50
  v_add_f32 v48, v48, v50
  v_add_f32 v32, v32, v34
  v_add_f32 v36, v36, v38
  v_add_f32 v40, v40, v42
  v_add_f32 v44, v44, v46
  v_mov_b32 v50, v48
  v_permlane16_swap_b32 v32, v36
  v_permlane16_swap_b32 v40, v44
  v_permlane16_swap_b32 v48, v50
  v_add_f32 v32, v32, v36
  v_add_f32 v40, v40, v44
  v_add_f32_e64 v48, v48, v50
  ds_write_b32 v10, v32
  ds_write_b32 v10, v40 offset:256
  s_mov_b32 exec_lo, 0xffff
  s_mov_b32 exec_hi, 0xffff
  ds_write_b32 v10, v48 offset:512
  s_mov_b64 exec, -1
  s_waitcnt lgkmcnt(0)
  s_barrier
  s_endpgm
L_ld_tail:
  s_barrier
  s_add_u32 m0, s75, 122880
  s_nop 0
  buffer_load_dwordx4 v4, s[44:47], s74 offen lds
  s_add_u32 m0, s75, 123904
  s_nop 0
  buffer_load_dwordx4 v5, s[44:47], s74 offen lds
  s_add_u32 s74, s74, 106496
  s_mov_b32 m0, 147712
  s_mov_b64 exec, 0xffff
  buffer_load_dwordx4 v11, s[52:55], s77 offen lds
  s_mov_b64 exec, -1
  s_mov_b32 s60, s24
  s_and_b32 s61, s25, 0xffff
  s_mov_b32 s62, 268435456
  s_mov_b32 s63, 0x20000
  s_mov_b32 s56, s20
  s_and_b32 s57, s21, 0xffff
  s_mov_b32 s58, 8192
  s_mov_b32 s59, 0x20000
  s_mov_b32 s64, s22
  s_and_b32 s65, s23, 0xffff
  s_mov_b32 s66, 256
  s_mov_b32 s67, 0x20000
  s_load_dword s80, s[18:19], 0
  v_mov_b32 v100, 0
  s_mov_b64 exec, 1
  s_mov_b32 s81, 0x80000
  buffer_load_dword v101, v100, s[60:63], s81 offen
  buffer_load_dword v102, v100, s[56:59], 0 offen
  s_mov_b64 exec, -1
  s_mov_b64 exec, 1
  buffer_load_dword v250, v100, s[64:67], 0 offen offset:240 sc1
  s_mov_b64 exec, -1
  s_waitcnt vmcnt(11)
  s_barrier
  s_waitcnt vmcnt(0)
  s_barrier
  s_cmp_lg_u32 s3, 4
  s_cbranch_scc1 L_end
  v_lshlrev_b32 v3, 4, v0
  v_lshlrev_b32 v4, 2, v0
  v_add_u32 v1, 147968, v3
  v_add_u32 v2, 148992, v4
  v_add_u32 v4, 1024, v4
  v_mov_b32 v5, 32
  v_mov_b32 v7, s26
  s_mul_i32 s68, s26, 1280
  s_mul_i32 s69, s27, 16640
  s_add_u32 s69, s69, s68
  s_setprio 3
  s_barrier
  ds_read_b128 v[64:67], v1
  ds_read_b128 v[72:75], v1 offset:1280
  ds_read2st64_b32 v[68:69], v2 offset0:0 offset1:5
  s_waitcnt lgkmcnt(0)
  v_pk_add_f32 v[64:65], v[64:65], v[72:73]
  v_pk_add_f32 v[66:67], v[66:67], v[74:75]
  v_add_f32 v68, v68, v69
  buffer_store_dwordx4 v[64:67], v3, s[60:63], s69 offen sc1
  buffer_store_dword v68, v4, s[60:63], s69 offen sc1
  s_mov_b64 exec, 1
L_pub:
  v_lshlrev_b32 v6, 4, v7
  v_cmp_eq_u32 vcc, 12, v7
  v_mov_b32 v8, 436
  v_mov_b32 v9, 434
  v_cndmask_b32 v8, v8, v9, vcc
  v_sub_u32_e64 v8, v8, v5
  s_waitcnt vmcnt(0)
  buffer_atomic_add v5, v6, s[64:67], 0 offen sc0
  s_waitcnt vmcnt(0) lgkmcnt(0)
  v_cmp_eq_u32 s[82:83], v5, v8
  s_mov_b64 exec, -1
  s_lshl_b32 s80, s80, 16
L_fin:
  s_cmp_eq_u32 s82, 0
  s_cbranch_scc1 L_done
  s_ff1_i32_b32 s70, s82
  s_bitset0_b32 s82, s70
  v_readlane_b32 s71, v7, s70
  s_nop 0
  s_mul_i32 s68, s71, 1280
  s_mul_i32 s71, s71, 640
  buffer_load_dwordx4 v[64:67], v3, s[60:63], s68 offen sc1
  buffer_load_dword v68, v4, s[60:63], s68 offen sc1
  s_add_u32 s68, s68, 16640
  buffer_load_dwordx4 v[72:75], v3, s[60:63], s68 offen sc1
  buffer_load_dword v76, v4, s[60:63], s68 offen sc1
  s_add_u32 s68, s68, 16640
  buffer_load_dwordx4 v[80:83], v3, s[60:63], s68 offen sc1
  buffer_load_dword v84, v4, s[60:63], s68 offen sc1
  s_add_u32 s68, s68, 16640
  buffer_load_dwordx4 v[88:91], v3, s[60:63], s68 offen sc1
  buffer_load_dword v92, v4, s[60:63], s68 offen sc1
  s_add_u32 s68, s68, 16640
  buffer_load_dwordx4 v[96:99], v3, s[60:63], s68 offen sc1
  buffer_load_dword v100, v4, s[60:63], s68 offen sc1
  s_add_u32 s68, s68, 16640
  buffer_load_dwordx4 v[104:107], v3, s[60:63], s68 offen sc1
  buffer_load_dword v108, v4, s[60:63], s68 offen sc1
  s_add_u32 s68, s68, 16640
  buffer_load_dwordx4 v[112:115], v3, s[60:63], s68 offen sc1
  buffer_load_dword v116, v4, s[60:63], s68 offen sc1
  s_add_u32 s68, s68, 16640
  buffer_load_dwordx4 v[120:123], v3, s[60:63], s68 offen sc1
  buffer_load_dword v124, v4, s[60:63], s68 offen sc1
  s_add_u32 s68, s68, 16640
  buffer_load_dwordx4 v[128:131], v3, s[60:63], s68 offen sc1
  buffer_load_dword v132, v4, s[60:63], s68 offen sc1
  s_add_u32 s68, s68, 16640
  buffer_load_dwordx4 v[136:139], v3, s[60:63], s68 offen sc1
  buffer_load_dword v140, v4, s[60:63], s68 offen sc1
  s_add_u32 s68, s68, 16640
  buffer_load_dwordx4 v[144:147], v3, s[60:63], s68 offen sc1
  buffer_load_dword v148, v4, s[60:63], s68 offen sc1
  s_add_u32 s68, s68, 16640
  buffer_load_dwordx4 v[152:155], v3, s[60:63], s68 offen sc1
  buffer_load_dword v156, v4, s[60:63], s68 offen sc1
  s_add_u32 s68, s68, 16640
  buffer_load_dwordx4 v[160:163], v3, s[60:63], s68 offen sc1
  buffer_load_dword v164, v4, s[60:63], s68 offen sc1
  s_add_u32 s68, s68, 16640
  buffer_load_dwordx4 v[168:171], v3, s[60:63], s68 offen sc1
  buffer_load_dword v172, v4, s[60:63], s68 offen sc1
  s_add_u32 s68, s68, 16640
  v_lshrrev_b32 v1, 1, v3
  v_lshrrev_b32 v2, 1, v4
  s_waitcnt vmcnt(25)
  v_pk_add_f32 v[64:65], v[64:65], v[72:73]
  v_pk_add_f32 v[66:67], v[66:67], v[74:75]
  s_waitcnt vmcnt(24)
  v_add_f32 v68, v68, v76
  s_waitcnt vmcnt(23)
  v_pk_add_f32 v[64:65], v[64:65], v[80:81]
  v_pk_add_f32 v[66:67], v[66:67], v[82:83]
  s_waitcnt vmcnt(22)
  v_add_f32 v68, v68, v84
  s_waitcnt vmcnt(21)
  v_pk_add_f32 v[64:65], v[64:65], v[88:89]
  v_pk_add_f32 v[66:67], v[66:67], v[90:91]
  s_waitcnt vmcnt(20)
  v_add_f32 v68, v68, v92
  s_waitcnt vmcnt(19)
  v_pk_add_f32 v[64:65], v[64:65], v[96:97]
  v_pk_add_f32 v[66:67], v[66:67], v[98:99]
  s_waitcnt vmcnt(18)
  v_add_f32 v68, v68, v100
  s_waitcnt vmcnt(17)
  v_pk_add_f32 v[64:65], v[64:65], v[104:105]
  v_pk_add_f32 v[66:67], v[66:67], v[106:107]
  s_waitcnt vmcnt(16)
  v_add_f32 v68, v68, v108
  s_waitcnt vmcnt(15)
  v_pk_add_f32 v[64:65], v[64:65], v[112:113]
  v_pk_add_f32 v[66:67], v[66:67], v[114:115]
  s_waitcnt vmcnt(14)
  v_add_f32 v68, v68, v116
  s_waitcnt vmcnt(13)
  v_pk_add_f32 v[64:65], v[64:65], v[120:121]
  v_pk_add_f32 v[66:67], v[66:67], v[122:123]
  s_waitcnt vmcnt(12)
  v_add_f32 v68, v68, v124
  s_waitcnt vmcnt(11)
  v_pk_add_f32 v[64:65], v[64:65], v[128:129]
  v_pk_add_f32 v[66:67], v[66:67], v[130:131]
  s_waitcnt vmcnt(10)
  v_add_f32 v68, v68, v132
  s_waitcnt vmcnt(9)
  v_pk_add_f32 v[64:65], v[64:65], v[136:137]
  v_pk_add_f32 v[66:67], v[66:67], v[138:139]
  s_waitcnt vmcnt(8)
  v_add_f32 v68, v68, v140
  s_waitcnt vmcnt(7)
  v_pk_add_f32 v[64:65], v[64:65], v[144:145]
  v_pk_add_f32 v[66:67], v[66:67], v[146:147]
  s_waitcnt vmcnt(6)
  v_add_f32_e64 v68, v68, v148
  s_waitcnt vmcnt(5)
  v_pk_add_f32 v[64:65], v[64:65], v[152:153]
  v_pk_add_f32 v[66:67], v[66:67], v[154:155]
  s_waitcnt vmcnt(4)
  v_add_f32 v68, v68, v156
  s_waitcnt vmcnt(3)
  v_pk_add_f32 v[64:65], v[64:65], v[160:161]
  v_pk_add_f32 v[66:67], v[66:67], v[162:163]
  s_waitcnt vmcnt(2)
  v_add_f32 v68, v68, v164
  s_waitcnt vmcnt(1)
  v_pk_add_f32 v[64:65], v[64:65], v[168:169]
  v_pk_add_f32 v[66:67], v[66:67], v[170:171]
  s_waitcnt vmcnt(0)
  v_add_f32 v68, v68, v172
  v_add_f32 v64, s80, v64
  v_add_f32 v65, s80, v65
  v_add_f32 v66, s80, v66
  v_add_f32 v67, s80, v67
  v_add_f32_e64 v68, s80, v68
  v_cvt_pk_bf16_f32 v10, v64, v65
  v_cvt_pk_bf16_f32 v11, v66, v67
  v_cvt_pk_bf16_f32 v12, v68, v68
  buffer_store_dwordx2 v[10:11], v1, s[56:59], s71 offen
  buffer_store_short v12, v2, s[56:59], s71 offen
  s_branch L_fin
L_done:
  s_endpgm
L_cin_done:
  v_mul_f32 v116, v184, v192
  v_mul_f32 v117, v185, v193
  v_mul_f32 v118, v186, v194
  v_mul_f32 v119, v187, v195
  v_fmac_f32 v116, v188, v191
  v_fmac_f32 v117, v200, v208
  v_fmac_f32 v118, v201, v209
  v_fmac_f32 v119, v202, v210
  v_fmac_f32 v116, v203, v211
  v_fmac_f32 v117, v204, v207
  v_fmac_f32 v118, v216, v224
  v_fmac_f32 v119, v217, v225
  v_fmac_f32 v116, v218, v226
  v_fmac_f32 v117, v219, v227
  v_fmac_f32 v118, v220, v223
  v_fmac_f32 v119, v232, v240
  v_fmac_f32 v116, v233, v241
  v_fmac_f32 v117, v234, v242
  v_fmac_f32 v118, v235, v243
  v_fmac_f32 v119, v236, v239
  v_fmac_f32 v116, v189, v196
  v_fmac_f32 v117, v189, v197
  v_fmac_f32 v118, v190, v198
  v_fmac_f32 v119, v190, v199
  v_fmac_f32 v116, v205, v212
  v_fmac_f32 v117, v205, v213
  v_fmac_f32 v118, v206, v214
  v_fmac_f32 v119, v206, v215
  v_fmac_f32 v116, v221, v228
  v_fmac_f32 v117, v221, v229
  v_fmac_f32 v118, v222, v230
  v_fmac_f32 v119, v222, v231
  v_fmac_f32 v116, v237, v244
  v_fmac_f32 v117, v237, v245
  v_fmac_f32 v118, v238, v246
  v_fmac_f32 v119, v238, v247
  v_add_f32 v116, v116, v117
  v_add_f32 v118, v118, v119
  v_add_f32 v116, v116, v118
  v_mul_f32 v116, s74, v116
  v_mul_f32_e64 v116, s75, v116
  ds_write_b32 v7, v116
  s_mul_i32 s98, s3, 1536
  s_add_u32 s98, s98, 116736
  v_lshlrev_b32 v116, 5, v0
  v_add_u32 v116, s98, v116
  ds_read_b128 v[60:63], v116
  ds_read_b128 v[64:67], v116 offset:16
  v_lshrrev_b32 v117, 3, v0
  v_cmp_gt_u32 vcc, 6, v117
  v_lshlrev_b32 v117, 4, v117
  v_add_u32 v117, s85, v117
  s_waitcnt lgkmcnt(1)
  v_pk_add_f32 v[60:61], v[60:61], v[62:63]
  s_waitcnt lgkmcnt(0)
  v_pk_add_f32 v[64:65], v[64:65], v[66:67]
  v_pk_add_f32 v[60:61], v[60:61], v[64:65]
  v_add_f32 v60, v60, v61
  s_nop 1
  v_add_f32_dpp v60, v60, v60 quad_perm:[1,0,3,2] row_mask:0xf bank_mask:0xf
  s_nop 1
  v_add_f32_dpp v60, v60, v60 quad_perm:[2,3,0,1] row_mask:0xf bank_mask:0xf
  s_nop 1
  v_add_f32_dpp v60, v60, v60 row_half_mirror row_mask:0xf bank_mask:0xf
  s_and_b64 exec, exec, vcc
  ds_write_b32 v117, v60
  s_mov_b64 exec, -1
  s_waitcnt lgkmcnt(0)
  s_barrier
  s_cmp_lg_u32 s3, 4
  s_cbranch_scc1 L_end
  v_lshlrev_b32_e64 v4, 2, v0
  v_add_u32 v2, 129728, v4
  ds_read_b32 v64, v2
  s_mul_i32 s69, s26, 192
  s_add_u32 s69, s69, 216320
  s_mul_i32 s68, s26, 3
  s_mul_i32 s70, s68, 3277
  s_lshr_b32 s70, s70, 16
  v_add_u32 v7, s70, v0
  s_mul_i32 s70, s70, 20
  s_add_u32 s70, s70, 20
  s_sub_u32 s70, s70, s68
  s_min_u32 s70, s70, 3
  s_sub_u32 s68, 3, s70
  v_mov_b32_e64 v5, s68
  v_writelane_b32 v5, s70, 0
  s_cmp_eq_u32 s68, 0
  s_cselect_b32 s68, 1, 3
  s_waitcnt vmcnt(1)
  v_lshlrev_b32 v3, 4, v0
  s_mov_b32 exec_hi, 0xffff
  s_waitcnt lgkmcnt(0)
  buffer_store_dword v64, v4, s[60:63], s69 offen sc1
  s_mov_b32 exec_hi, -1
  v_add_u32 v4, 1024, v4
  s_mov_b32 exec_lo, s68
  s_mov_b32 exec_hi, 0
  s_branch L_pub
L_dnn_loop1:
  s_barrier
L_ld_in:
  s_add_u32 m0, s75, 122880
  v_add_u32_dpp v56, v19, v2 row_newbcast:0 row_mask:0xf bank_mask:0x3
  buffer_load_dwordx4 v4, s[44:47], s74 offen lds
  s_add_u32 m0, s75, 123904
  v_add_u32_dpp v57, v23, v3 row_newbcast:0 row_mask:0xf bank_mask:0x3
  buffer_load_dwordx4 v5, s[44:47], s74 offen lds
  s_add_u32 s74, s74, 106496
  s_add_u32 m0, s41, 81920
  v_add_u32_dpp v58, v27, v2 row_newbcast:0 row_mask:0xf bank_mask:0x3
  buffer_load_dwordx4 v61, s[32:35], 0 offen lds
  s_add_u32 m0, s42, 81920
  v_add_u32_dpp v59, v31, v3 row_newbcast:0 row_mask:0xf bank_mask:0x3
  buffer_load_dwordx4 v62, s[32:35], 0 offen lds
  s_add_u32 m0, s43, 81920
  v_add_u32_dpp v60, v35, v2 row_newbcast:0 row_mask:0xf bank_mask:0x3
  buffer_load_dwordx4 v63, s[32:35], 0 offen lds
  s_add_u32 m0, s48, 81920
  v_add_u32_dpp v56, v17, v2 row_newbcast:7 row_mask:0xf bank_mask:0xc
  buffer_load_dwordx4 v64, s[32:35], 0 offen lds
  s_add_u32 m0, s49, 81920
  v_add_u32_dpp v57, v21, v3 row_newbcast:7 row_mask:0xf bank_mask:0xc
  buffer_load_dwordx4 v65, s[32:35], 0 offen lds
  v_add_u32_dpp v58, v25, v2 row_newbcast:7 row_mask:0xf bank_mask:0xc
  v_add_u32_dpp v59, v29, v3 row_newbcast:7 row_mask:0xf bank_mask:0xc
  v_add_u32_dpp v60, v33, v2 row_newbcast:7 row_mask:0xf bank_mask:0xc
  s_waitcnt vmcnt(12)
  s_barrier
  s_add_u32 m0, s75, 131072
  v_add_u32_dpp v61, v39, v3 row_newbcast:0 row_mask:0xf bank_mask:0x3
  buffer_load_dwordx4 v4, s[44:47], s74 offen lds
  s_add_u32 m0, s75, 132096
  v_add_u32_dpp v62, v43, v2 row_newbcast:0 row_mask:0xf bank_mask:0x3
  buffer_load_dwordx4 v5, s[44:47], s74 offen lds
  s_add_u32 s74, s74, 106496
  s_add_u32 m0, s36, 0
  v_add_u32_dpp v63, v47, v3 row_newbcast:0 row_mask:0xf bank_mask:0x3
  buffer_load_dwordx4 v56, s[32:35], 0 offen lds
  s_add_u32 m0, s37, 0
  v_add_u32_dpp v64, v51, v2 row_newbcast:0 row_mask:0xf bank_mask:0x3
  buffer_load_dwordx4 v57, s[32:35], 0 offen lds
  s_add_u32 m0, s38, 0
  v_add_u32_dpp v65, v55, v3 row_newbcast:0 row_mask:0xf bank_mask:0x3
  buffer_load_dwordx4 v58, s[32:35], 0 offen lds
  s_add_u32 m0, s39, 0
  v_add_u32_dpp v61, v37, v3 row_newbcast:7 row_mask:0xf bank_mask:0xc
  buffer_load_dwordx4 v59, s[32:35], 0 offen lds
  s_add_u32 m0, s40, 0
  v_add_u32_dpp v62, v41, v2 row_newbcast:7 row_mask:0xf bank_mask:0xc
  buffer_load_dwordx4 v60, s[32:35], 0 offen lds
  v_add_u32_dpp v63, v45, v3 row_newbcast:7 row_mask:0xf bank_mask:0xc
  v_add_u32_dpp v64, v49, v2 row_newbcast:7 row_mask:0xf bank_mask:0xc
  v_add_u32_dpp v65, v53, v3 row_newbcast:7 row_mask:0xf bank_mask:0xc
  s_waitcnt vmcnt(12)
  s_barrier
  s_add_u32 m0, s75, 139264
  v_add_u32_dpp v56, v16, v2 row_newbcast:1 row_mask:0xf bank_mask:0x3
  buffer_load_dwordx4 v4, s[44:47], s74 offen lds
  s_add_u32 m0, s75, 140288
  v_add_u32_dpp v57, v20, v3 row_newbcast:1 row_mask:0xf bank_mask:0x3
  buffer_load_dwordx4 v5, s[44:47], s74 offen lds
  s_add_u32 s74, s74, 106496
  s_add_u32 m0, s41, 0
  v_add_u32_dpp v58, v24, v2 row_newbcast:1 row_mask:0xf bank_mask:0x3
  buffer_load_dwordx4 v61, s[32:35], 0 offen lds
  s_add_u32 m0, s42, 0
  v_add_u32_dpp v59, v28, v3 row_newbcast:1 row_mask:0xf bank_mask:0x3
  buffer_load_dwordx4 v62, s[32:35], 0 offen lds
  s_add_u32 m0, s43, 0
  v_add_u32_dpp v60, v32, v2 row_newbcast:1 row_mask:0xf bank_mask:0x3
  buffer_load_dwordx4 v63, s[32:35], 0 offen lds
  s_add_u32 m0, s48, 0
  v_add_u32_dpp v56, v18, v2 row_newbcast:7 row_mask:0xf bank_mask:0xc
  buffer_load_dwordx4 v64, s[32:35], 0 offen lds
  s_add_u32 m0, s49, 0
  v_add_u32_dpp v57, v22, v3 row_newbcast:7 row_mask:0xf bank_mask:0xc
  buffer_load_dwordx4 v65, s[32:35], 0 offen lds
  v_add_u32_dpp v58, v26, v2 row_newbcast:7 row_mask:0xf bank_mask:0xc
  v_add_u32_dpp v59, v30, v3 row_newbcast:7 row_mask:0xf bank_mask:0xc
  v_add_u32_dpp v60, v34, v2 row_newbcast:7 row_mask:0xf bank_mask:0xc
  s_waitcnt vmcnt(12)
  s_barrier
  s_add_u32 m0, s75, 122880
  v_add_u32_dpp v61, v36, v3 row_newbcast:1 row_mask:0xf bank_mask:0x3
  buffer_load_dwordx4 v4, s[44:47], s74 offen lds
  s_add_u32 m0, s75, 123904
  v_add_u32_dpp v62, v40, v2 row_newbcast:1 row_mask:0xf bank_mask:0x3
  buffer_load_dwordx4 v5, s[44:47], s74 offen lds
  s_add_u32 s74, s74, 106496
  s_add_u32 m0, s36, 40960
  v_add_u32_dpp v63, v44, v3 row_newbcast:1 row_mask:0xf bank_mask:0x3
  buffer_load_dwordx4 v56, s[32:35], 0 offen lds
  s_add_u32 m0, s37, 40960
  v_add_u32_dpp v64, v48, v2 row_newbcast:1 row_mask:0xf bank_mask:0x3
  buffer_load_dwordx4 v57, s[32:35], 0 offen lds
  s_add_u32 m0, s38, 40960
  v_add_u32_dpp v65, v52, v3 row_newbcast:1 row_mask:0xf bank_mask:0x3
  buffer_load_dwordx4 v58, s[32:35], 0 offen lds
  s_add_u32 m0, s39, 40960
  v_add_u32_dpp v61, v38, v3 row_newbcast:7 row_mask:0xf bank_mask:0xc
  buffer_load_dwordx4 v59, s[32:35], 0 offen lds
  s_add_u32 m0, s40, 40960
  v_add_u32_dpp v62, v42, v2 row_newbcast:7 row_mask:0xf bank_mask:0xc
  buffer_load_dwordx4 v60, s[32:35], 0 offen lds
  v_add_u32_dpp v63, v46, v3 row_newbcast:7 row_mask:0xf bank_mask:0xc
  v_add_u32_dpp v64, v50, v2 row_newbcast:7 row_mask:0xf bank_mask:0xc
  v_add_u32_dpp v65, v54, v3 row_newbcast:7 row_mask:0xf bank_mask:0xc
  s_waitcnt vmcnt(12)
  s_barrier
  s_add_u32 m0, s75, 131072
  v_add_u32_dpp v56, v17, v2 row_newbcast:1 row_mask:0xf bank_mask:0x3
  buffer_load_dwordx4 v4, s[44:47], s74 offen lds
  s_add_u32 m0, s75, 132096
  v_add_u32_dpp v57, v21, v3 row_newbcast:1 row_mask:0xf bank_mask:0x3
  buffer_load_dwordx4 v5, s[44:47], s74 offen lds
  s_add_u32 s74, s74, 106496
  s_add_u32 m0, s41, 40960
  v_add_u32_dpp v58, v25, v2 row_newbcast:1 row_mask:0xf bank_mask:0x3
  buffer_load_dwordx4 v61, s[32:35], 0 offen lds
  s_add_u32 m0, s42, 40960
  v_add_u32_dpp v59, v29, v3 row_newbcast:1 row_mask:0xf bank_mask:0x3
  buffer_load_dwordx4 v62, s[32:35], 0 offen lds
  s_add_u32 m0, s43, 40960
  v_add_u32_dpp v60, v33, v2 row_newbcast:1 row_mask:0xf bank_mask:0x3
  buffer_load_dwordx4 v63, s[32:35], 0 offen lds
  s_add_u32 m0, s48, 40960
  v_add_u32_dpp v56, v19, v2 row_newbcast:7 row_mask:0xf bank_mask:0xc
  buffer_load_dwordx4 v64, s[32:35], 0 offen lds
  s_add_u32 m0, s49, 40960
  v_add_u32_dpp v57, v23, v3 row_newbcast:7 row_mask:0xf bank_mask:0xc
  buffer_load_dwordx4 v65, s[32:35], 0 offen lds
  v_add_u32_dpp v58, v27, v2 row_newbcast:7 row_mask:0xf bank_mask:0xc
  v_add_u32_dpp v59, v31, v3 row_newbcast:7 row_mask:0xf bank_mask:0xc
  v_add_u32_dpp v60, v35, v2 row_newbcast:7 row_mask:0xf bank_mask:0xc
  s_waitcnt vmcnt(12)
  s_barrier
  s_add_u32 m0, s75, 139264
  v_add_u32_dpp v61, v37, v3 row_newbcast:1 row_mask:0xf bank_mask:0x3
  buffer_load_dwordx4 v4, s[44:47], s74 offen lds
  s_add_u32 m0, s75, 140288
  v_add_u32_dpp v62, v41, v2 row_newbcast:1 row_mask:0xf bank_mask:0x3
  buffer_load_dwordx4 v5, s[44:47], s74 offen lds
  s_add_u32 s74, s74, 106496
  s_add_u32 m0, s36, 81920
  v_add_u32_dpp v63, v45, v3 row_newbcast:1 row_mask:0xf bank_mask:0x3
  buffer_load_dwordx4 v56, s[32:35], 0 offen lds
  s_add_u32 m0, s37, 81920
  v_add_u32_dpp v64, v49, v2 row_newbcast:1 row_mask:0xf bank_mask:0x3
  buffer_load_dwordx4 v57, s[32:35], 0 offen lds
  s_add_u32 m0, s38, 81920
  v_add_u32_dpp v65, v53, v3 row_newbcast:1 row_mask:0xf bank_mask:0x3
  buffer_load_dwordx4 v58, s[32:35], 0 offen lds
  s_add_u32 m0, s39, 81920
  v_add_u32_dpp v61, v39, v3 row_newbcast:7 row_mask:0xf bank_mask:0xc
  buffer_load_dwordx4 v59, s[32:35], 0 offen lds
  s_add_u32 m0, s40, 81920
  v_add_u32_dpp v62, v43, v2 row_newbcast:7 row_mask:0xf bank_mask:0xc
  buffer_load_dwordx4 v60, s[32:35], 0 offen lds
  v_add_u32_dpp v63, v47, v3 row_newbcast:7 row_mask:0xf bank_mask:0xc
  v_add_u32_dpp v64, v51, v2 row_newbcast:7 row_mask:0xf bank_mask:0xc
  v_add_u32_dpp v65, v55, v3 row_newbcast:7 row_mask:0xf bank_mask:0xc
  s_waitcnt vmcnt(12)
  s_barrier
  s_add_u32 m0, s75, 122880
  v_add_u32_dpp v56, v18, v2 row_newbcast:1 row_mask:0xf bank_mask:0x3
  buffer_load_dwordx4 v4, s[44:47], s74 offen lds
  s_add_u32 m0, s75, 123904
  v_add_u32_dpp v57, v22, v3 row_newbcast:1 row_mask:0xf bank_mask:0x3
  buffer_load_dwordx4 v5, s[44:47], s74 offen lds
  s_add_u32 s74, s74, 106496
  s_add_u32 m0, s41, 81920
  v_add_u32_dpp v58, v26, v2 row_newbcast:1 row_mask:0xf bank_mask:0x3
  buffer_load_dwordx4 v61, s[32:35], 0 offen lds
  s_add_u32 m0, s42, 81920
  v_add_u32_dpp v59, v30, v3 row_newbcast:1 row_mask:0xf bank_mask:0x3
  buffer_load_dwordx4 v62, s[32:35], 0 offen lds
  s_add_u32 m0, s43, 81920
  v_add_u32_dpp v60, v34, v2 row_newbcast:1 row_mask:0xf bank_mask:0x3
  buffer_load_dwordx4 v63, s[32:35], 0 offen lds
  s_add_u32 m0, s48, 81920
  v_add_u32_dpp v56, v16, v2 row_newbcast:8 row_mask:0xf bank_mask:0xc
  buffer_load_dwordx4 v64, s[32:35], 0 offen lds
  s_add_u32 m0, s49, 81920
  v_add_u32_dpp v57, v20, v3 row_newbcast:8 row_mask:0xf bank_mask:0xc
  buffer_load_dwordx4 v65, s[32:35], 0 offen lds
  v_add_u32_dpp v58, v24, v2 row_newbcast:8 row_mask:0xf bank_mask:0xc
  v_add_u32_dpp v59, v28, v3 row_newbcast:8 row_mask:0xf bank_mask:0xc
  v_add_u32_dpp v60, v32, v2 row_newbcast:8 row_mask:0xf bank_mask:0xc
  s_waitcnt vmcnt(12)
  s_barrier
  s_add_u32 m0, s75, 131072
  v_add_u32_dpp v61, v38, v3 row_newbcast:1 row_mask:0xf bank_mask:0x3
  buffer_load_dwordx4 v4, s[44:47], s74 offen lds
  s_add_u32 m0, s75, 132096
  v_add_u32_dpp v62, v42, v2 row_newbcast:1 row_mask:0xf bank_mask:0x3
  buffer_load_dwordx4 v5, s[44:47], s74 offen lds
  s_add_u32 s74, s74, 106496
  s_add_u32 m0, s36, 0
  v_add_u32_dpp v63, v46, v3 row_newbcast:1 row_mask:0xf bank_mask:0x3
  buffer_load_dwordx4 v56, s[32:35], 0 offen lds
  s_add_u32 m0, s37, 0
  v_add_u32_dpp v64, v50, v2 row_newbcast:1 row_mask:0xf bank_mask:0x3
  buffer_load_dwordx4 v57, s[32:35], 0 offen lds
  s_add_u32 m0, s38, 0
  v_add_u32_dpp v65, v54, v3 row_newbcast:1 row_mask:0xf bank_mask:0x3
  buffer_load_dwordx4 v58, s[32:35], 0 offen lds
  s_add_u32 m0, s39, 0
  v_add_u32_dpp v61, v36, v3 row_newbcast:8 row_mask:0xf bank_mask:0xc
  buffer_load_dwordx4 v59, s[32:35], 0 offen lds
  s_add_u32 m0, s40, 0
  v_add_u32_dpp v62, v40, v2 row_newbcast:8 row_mask:0xf bank_mask:0xc
  buffer_load_dwordx4 v60, s[32:35], 0 offen lds
  v_add_u32_dpp v63, v44, v3 row_newbcast:8 row_mask:0xf bank_mask:0xc
  v_add_u32_dpp v64, v48, v2 row_newbcast:8 row_mask:0xf bank_mask:0xc
  v_add_u32_dpp v65, v52, v3 row_newbcast:8 row_mask:0xf bank_mask:0xc
  s_waitcnt vmcnt(12)
  s_barrier
  s_add_u32 m0, s75, 139264
  v_add_u32_dpp v56, v19, v2 row_newbcast:1 row_mask:0xf bank_mask:0x3
  buffer_load_dwordx4 v4, s[44:47], s74 offen lds
  s_add_u32 m0, s75, 140288
  v_add_u32_dpp v57, v23, v3 row_newbcast:1 row_mask:0xf bank_mask:0x3
  buffer_load_dwordx4 v5, s[44:47], s74 offen lds
  s_add_u32 s74, s74, 106496
  s_add_u32 m0, s41, 0
  v_add_u32_dpp v58, v27, v2 row_newbcast:1 row_mask:0xf bank_mask:0x3
  buffer_load_dwordx4 v61, s[32:35], 0 offen lds
  s_add_u32 m0, s42, 0
  v_add_u32_dpp v59, v31, v3 row_newbcast:1 row_mask:0xf bank_mask:0x3
  buffer_load_dwordx4 v62, s[32:35], 0 offen lds
  s_add_u32 m0, s43, 0
  v_add_u32_dpp v60, v35, v2 row_newbcast:1 row_mask:0xf bank_mask:0x3
  buffer_load_dwordx4 v63, s[32:35], 0 offen lds
  s_add_u32 m0, s48, 0
  v_add_u32_dpp v56, v17, v2 row_newbcast:8 row_mask:0xf bank_mask:0xc
  buffer_load_dwordx4 v64, s[32:35], 0 offen lds
  s_add_u32 m0, s49, 0
  v_add_u32_dpp v57, v21, v3 row_newbcast:8 row_mask:0xf bank_mask:0xc
  buffer_load_dwordx4 v65, s[32:35], 0 offen lds
  v_add_u32_dpp v58, v25, v2 row_newbcast:8 row_mask:0xf bank_mask:0xc
  v_add_u32_dpp v59, v29, v3 row_newbcast:8 row_mask:0xf bank_mask:0xc
  v_add_u32_dpp v60, v33, v2 row_newbcast:8 row_mask:0xf bank_mask:0xc
  s_waitcnt vmcnt(12)
  s_barrier
  s_add_u32 m0, s75, 122880
  v_add_u32_dpp v61, v39, v3 row_newbcast:1 row_mask:0xf bank_mask:0x3
  buffer_load_dwordx4 v4, s[44:47], s74 offen lds
  s_add_u32 m0, s75, 123904
  v_add_u32_dpp v62, v43, v2 row_newbcast:1 row_mask:0xf bank_mask:0x3
  buffer_load_dwordx4 v5, s[44:47], s74 offen lds
  s_add_u32 s74, s74, 106496
  s_add_u32 m0, s36, 40960
  v_add_u32_dpp v63, v47, v3 row_newbcast:1 row_mask:0xf bank_mask:0x3
  buffer_load_dwordx4 v56, s[32:35], 0 offen lds
  s_add_u32 m0, s37, 40960
  v_add_u32_dpp v64, v51, v2 row_newbcast:1 row_mask:0xf bank_mask:0x3
  buffer_load_dwordx4 v57, s[32:35], 0 offen lds
  s_add_u32 m0, s38, 40960
  v_add_u32_dpp v65, v55, v3 row_newbcast:1 row_mask:0xf bank_mask:0x3
  buffer_load_dwordx4 v58, s[32:35], 0 offen lds
  s_add_u32 m0, s39, 40960
  v_add_u32_dpp v61, v37, v3 row_newbcast:8 row_mask:0xf bank_mask:0xc
  buffer_load_dwordx4 v59, s[32:35], 0 offen lds
  s_add_u32 m0, s40, 40960
  v_add_u32_dpp v62, v41, v2 row_newbcast:8 row_mask:0xf bank_mask:0xc
  buffer_load_dwordx4 v60, s[32:35], 0 offen lds
  v_add_u32_dpp v63, v45, v3 row_newbcast:8 row_mask:0xf bank_mask:0xc
  v_add_u32_dpp v64, v49, v2 row_newbcast:8 row_mask:0xf bank_mask:0xc
  v_add_u32_dpp v65, v53, v3 row_newbcast:8 row_mask:0xf bank_mask:0xc
  s_waitcnt vmcnt(12)
  s_barrier
  s_add_u32 m0, s75, 131072
  v_add_u32_dpp v56, v16, v2 row_newbcast:2 row_mask:0xf bank_mask:0x3
  buffer_load_dwordx4 v4, s[44:47], s74 offen lds
  s_add_u32 m0, s75, 132096
  v_add_u32_dpp v57, v20, v3 row_newbcast:2 row_mask:0xf bank_mask:0x3
  buffer_load_dwordx4 v5, s[44:47], s74 offen lds
  s_add_u32 s74, s74, 106496
  s_add_u32 m0, s41, 40960
  v_add_u32_dpp v58, v24, v2 row_newbcast:2 row_mask:0xf bank_mask:0x3
  buffer_load_dwordx4 v61, s[32:35], 0 offen lds
  s_add_u32 m0, s42, 40960
  v_add_u32_dpp v59, v28, v3 row_newbcast:2 row_mask:0xf bank_mask:0x3
  buffer_load_dwordx4 v62, s[32:35], 0 offen lds
  s_add_u32 m0, s43, 40960
  v_add_u32_dpp v60, v32, v2 row_newbcast:2 row_mask:0xf bank_mask:0x3
  buffer_load_dwordx4 v63, s[32:35], 0 offen lds
  s_add_u32 m0, s48, 40960
  v_add_u32_dpp v56, v18, v2 row_newbcast:8 row_mask:0xf bank_mask:0xc
  buffer_load_dwordx4 v64, s[32:35], 0 offen lds
  s_add_u32 m0, s49, 40960
  v_add_u32_dpp v57, v22, v3 row_newbcast:8 row_mask:0xf bank_mask:0xc
  buffer_load_dwordx4 v65, s[32:35], 0 offen lds
  v_add_u32_dpp v58, v26, v2 row_newbcast:8 row_mask:0xf bank_mask:0xc
  v_add_u32_dpp v59, v30, v3 row_newbcast:8 row_mask:0xf bank_mask:0xc
  v_add_u32_dpp v60, v34, v2 row_newbcast:8 row_mask:0xf bank_mask:0xc
  s_waitcnt vmcnt(12)
  s_barrier
  s_add_u32 m0, s75, 139264
  v_add_u32_dpp v61, v36, v3 row_newbcast:2 row_mask:0xf bank_mask:0x3
  buffer_load_dwordx4 v4, s[44:47], s74 offen lds
  s_add_u32 m0, s75, 140288
  v_add_u32_dpp v62, v40, v2 row_newbcast:2 row_mask:0xf bank_mask:0x3
  buffer_load_dwordx4 v5, s[44:47], s74 offen lds
  s_add_u32 s74, s74, 106496
  s_add_u32 m0, s36, 81920
  v_add_u32_dpp v63, v44, v3 row_newbcast:2 row_mask:0xf bank_mask:0x3
  buffer_load_dwordx4 v56, s[32:35], 0 offen lds
  s_add_u32 m0, s37, 81920
  v_add_u32_dpp v64, v48, v2 row_newbcast:2 row_mask:0xf bank_mask:0x3
  buffer_load_dwordx4 v57, s[32:35], 0 offen lds
  s_add_u32 m0, s38, 81920
  v_add_u32_dpp v65, v52, v3 row_newbcast:2 row_mask:0xf bank_mask:0x3
  buffer_load_dwordx4 v58, s[32:35], 0 offen lds
  s_add_u32 m0, s39, 81920
  v_add_u32_dpp v61, v38, v3 row_newbcast:8 row_mask:0xf bank_mask:0xc
  buffer_load_dwordx4 v59, s[32:35], 0 offen lds
  s_add_u32 m0, s40, 81920
  v_add_u32_dpp v62, v42, v2 row_newbcast:8 row_mask:0xf bank_mask:0xc
  buffer_load_dwordx4 v60, s[32:35], 0 offen lds
  v_add_u32_dpp v63, v46, v3 row_newbcast:8 row_mask:0xf bank_mask:0xc
  v_add_u32_dpp v64, v50, v2 row_newbcast:8 row_mask:0xf bank_mask:0xc
  v_add_u32_dpp v65, v54, v3 row_newbcast:8 row_mask:0xf bank_mask:0xc
  s_waitcnt vmcnt(12)
  s_barrier
  s_add_u32 m0, s75, 122880
  v_add_u32_dpp v56, v17, v2 row_newbcast:2 row_mask:0xf bank_mask:0x3
  buffer_load_dwordx4 v4, s[44:47], s74 offen lds
  s_add_u32 m0, s75, 123904
  v_add_u32_dpp v57, v21, v3 row_newbcast:2 row_mask:0xf bank_mask:0x3
  buffer_load_dwordx4 v5, s[44:47], s74 offen lds
  s_add_u32 s74, s74, 106496
  s_add_u32 m0, s41, 81920
  v_add_u32_dpp v58, v25, v2 row_newbcast:2 row_mask:0xf bank_mask:0x3
  buffer_load_dwordx4 v61, s[32:35], 0 offen lds
  s_add_u32 m0, s42, 81920
  v_add_u32_dpp v59, v29, v3 row_newbcast:2 row_mask:0xf bank_mask:0x3
  buffer_load_dwordx4 v62, s[32:35], 0 offen lds
  s_add_u32 m0, s43, 81920
  v_add_u32_dpp v60, v33, v2 row_newbcast:2 row_mask:0xf bank_mask:0x3
  buffer_load_dwordx4 v63, s[32:35], 0 offen lds
  s_add_u32 m0, s48, 81920
  v_add_u32_dpp v56, v19, v2 row_newbcast:8 row_mask:0xf bank_mask:0xc
  buffer_load_dwordx4 v64, s[32:35], 0 offen lds
  s_add_u32 m0, s49, 81920
  v_add_u32_dpp v57, v23, v3 row_newbcast:8 row_mask:0xf bank_mask:0xc
  buffer_load_dwordx4 v65, s[32:35], 0 offen lds
  v_add_u32_dpp v58, v27, v2 row_newbcast:8 row_mask:0xf bank_mask:0xc
  v_add_u32_dpp v59, v31, v3 row_newbcast:8 row_mask:0xf bank_mask:0xc
  v_add_u32_dpp v60, v35, v2 row_newbcast:8 row_mask:0xf bank_mask:0xc
  s_waitcnt vmcnt(12)
  s_barrier
  s_add_u32 m0, s75, 131072
  v_add_u32_dpp v61, v37, v3 row_newbcast:2 row_mask:0xf bank_mask:0x3
  buffer_load_dwordx4 v4, s[44:47], s74 offen lds
  s_add_u32 m0, s75, 132096
  v_add_u32_dpp v62, v41, v2 row_newbcast:2 row_mask:0xf bank_mask:0x3
  buffer_load_dwordx4 v5, s[44:47], s74 offen lds
  s_add_u32 s74, s74, 106496
  s_add_u32 m0, s36, 0
  v_add_u32_dpp v63, v45, v3 row_newbcast:2 row_mask:0xf bank_mask:0x3
  buffer_load_dwordx4 v56, s[32:35], 0 offen lds
  s_add_u32 m0, s37, 0
  v_add_u32_dpp v64, v49, v2 row_newbcast:2 row_mask:0xf bank_mask:0x3
  buffer_load_dwordx4 v57, s[32:35], 0 offen lds
  s_add_u32 m0, s38, 0
  v_add_u32_dpp v65, v53, v3 row_newbcast:2 row_mask:0xf bank_mask:0x3
  buffer_load_dwordx4 v58, s[32:35], 0 offen lds
  s_add_u32 m0, s39, 0
  v_add_u32_dpp v61, v39, v3 row_newbcast:8 row_mask:0xf bank_mask:0xc
  buffer_load_dwordx4 v59, s[32:35], 0 offen lds
  s_add_u32 m0, s40, 0
  v_add_u32_dpp v62, v43, v2 row_newbcast:8 row_mask:0xf bank_mask:0xc
  buffer_load_dwordx4 v60, s[32:35], 0 offen lds
  v_add_u32_dpp v63, v47, v3 row_newbcast:8 row_mask:0xf bank_mask:0xc
  v_add_u32_dpp v64, v51, v2 row_newbcast:8 row_mask:0xf bank_mask:0xc
  v_add_u32_dpp v65, v55, v3 row_newbcast:8 row_mask:0xf bank_mask:0xc
  s_waitcnt vmcnt(12)
  s_barrier
  s_add_u32 m0, s75, 139264
  v_add_u32_dpp v56, v18, v2 row_newbcast:2 row_mask:0xf bank_mask:0x3
  buffer_load_dwordx4 v4, s[44:47], s74 offen lds
  s_add_u32 m0, s75, 140288
  v_add_u32_dpp v57, v22, v3 row_newbcast:2 row_mask:0xf bank_mask:0x3
  buffer_load_dwordx4 v5, s[44:47], s74 offen lds
  s_add_u32 s74, s74, 106496
  s_add_u32 m0, s41, 0
  v_add_u32_dpp v58, v26, v2 row_newbcast:2 row_mask:0xf bank_mask:0x3
  buffer_load_dwordx4 v61, s[32:35], 0 offen lds
  s_add_u32 m0, s42, 0
  v_add_u32_dpp v59, v30, v3 row_newbcast:2 row_mask:0xf bank_mask:0x3
  buffer_load_dwordx4 v62, s[32:35], 0 offen lds
  s_add_u32 m0, s43, 0
  v_add_u32_dpp v60, v34, v2 row_newbcast:2 row_mask:0xf bank_mask:0x3
  buffer_load_dwordx4 v63, s[32:35], 0 offen lds
  s_add_u32 m0, s48, 0
  v_add_u32_dpp v56, v16, v2 row_newbcast:9 row_mask:0xf bank_mask:0xc
  buffer_load_dwordx4 v64, s[32:35], 0 offen lds
  s_add_u32 m0, s49, 0
  v_add_u32_dpp v57, v20, v3 row_newbcast:9 row_mask:0xf bank_mask:0xc
  buffer_load_dwordx4 v65, s[32:35], 0 offen lds
  v_add_u32_dpp v58, v24, v2 row_newbcast:9 row_mask:0xf bank_mask:0xc
  v_add_u32_dpp v59, v28, v3 row_newbcast:9 row_mask:0xf bank_mask:0xc
  v_add_u32_dpp v60, v32, v2 row_newbcast:9 row_mask:0xf bank_mask:0xc
  s_waitcnt vmcnt(12)
  s_cmp_lg_u32 s72, 1
  s_cbranch_scc1 L_nolpf
  s_mov_b64 exec, 1048575
  global_load_dword v10, v[8:9], off
  s_mov_b64 exec, -1
L_nolpf:
  s_barrier
  s_add_u32 m0, s75, 122880
  v_add_u32_dpp v61, v38, v3 row_newbcast:2 row_mask:0xf bank_mask:0x3
  buffer_load_dwordx4 v4, s[44:47], s74 offen lds
  s_add_u32 m0, s75, 123904
  v_add_u32_dpp v62, v42, v2 row_newbcast:2 row_mask:0xf bank_mask:0x3
  buffer_load_dwordx4 v5, s[44:47], s74 offen lds
  s_add_u32 s74, s74, 106496
  s_add_u32 m0, s36, 40960
  v_add_u32_dpp v63, v46, v3 row_newbcast:2 row_mask:0xf bank_mask:0x3
  buffer_load_dwordx4 v56, s[32:35], 0 offen lds
  s_add_u32 m0, s37, 40960
  v_add_u32_dpp v64, v50, v2 row_newbcast:2 row_mask:0xf bank_mask:0x3
  buffer_load_dwordx4 v57, s[32:35], 0 offen lds
  s_add_u32 m0, s38, 40960
  v_add_u32_dpp v65, v54, v3 row_newbcast:2 row_mask:0xf bank_mask:0x3
  buffer_load_dwordx4 v58, s[32:35], 0 offen lds
  s_add_u32 m0, s39, 40960
  v_add_u32_dpp v61, v36, v3 row_newbcast:9 row_mask:0xf bank_mask:0xc
  buffer_load_dwordx4 v59, s[32:35], 0 offen lds
  s_add_u32 m0, s40, 40960
  v_add_u32_dpp v62, v40, v2 row_newbcast:9 row_mask:0xf bank_mask:0xc
  buffer_load_dwordx4 v60, s[32:35], 0 offen lds
  v_add_u32_dpp v63, v44, v3 row_newbcast:9 row_mask:0xf bank_mask:0xc
  v_add_u32_dpp v64, v48, v2 row_newbcast:9 row_mask:0xf bank_mask:0xc
  v_add_u32_dpp v65, v52, v3 row_newbcast:9 row_mask:0xf bank_mask:0xc
  s_waitcnt vmcnt(12)
  s_barrier
  s_add_u32 m0, s75, 131072
  v_add_u32_dpp v56, v19, v2 row_newbcast:2 row_mask:0xf bank_mask:0x3
  buffer_load_dwordx4 v4, s[44:47], s74 offen lds
  s_add_u32 m0, s75, 132096
  v_add_u32_dpp v57, v23, v3 row_newbcast:2 row_mask:0xf bank_mask:0x3
  buffer_load_dwordx4 v5, s[44:47], s74 offen lds
  s_add_u32 s74, s74, 106496
  s_add_u32 m0, s41, 40960
  v_add_u32_dpp v58, v27, v2 row_newbcast:2 row_mask:0xf bank_mask:0x3
  buffer_load_dwordx4 v61, s[32:35], 0 offen lds
  s_add_u32 m0, s42, 40960
  v_add_u32_dpp v59, v31, v3 row_newbcast:2 row_mask:0xf bank_mask:0x3
  buffer_load_dwordx4 v62, s[32:35], 0 offen lds
  s_add_u32 m0, s43, 40960
  v_add_u32_dpp v60, v35, v2 row_newbcast:2 row_mask:0xf bank_mask:0x3
  buffer_load_dwordx4 v63, s[32:35], 0 offen lds
  s_add_u32 m0, s48, 40960
  v_add_u32_dpp v56, v17, v2 row_newbcast:9 row_mask:0xf bank_mask:0xc
  buffer_load_dwordx4 v64, s[32:35], 0 offen lds
  s_add_u32 m0, s49, 40960
  v_add_u32_dpp v57, v21, v3 row_newbcast:9 row_mask:0xf bank_mask:0xc
  buffer_load_dwordx4 v65, s[32:35], 0 offen lds
  v_add_u32_dpp v58, v25, v2 row_newbcast:9 row_mask:0xf bank_mask:0xc
  v_add_u32_dpp v59, v29, v3 row_newbcast:9 row_mask:0xf bank_mask:0xc
  v_add_u32_dpp v60, v33, v2 row_newbcast:9 row_mask:0xf bank_mask:0xc
  s_waitcnt vmcnt(12)
  s_barrier
  s_add_u32 m0, s75, 139264
  v_add_u32_dpp v61, v39, v3 row_newbcast:2 row_mask:0xf bank_mask:0x3
  buffer_load_dwordx4 v4, s[44:47], s74 offen lds
  s_add_u32 m0, s75, 140288
  v_add_u32_dpp v62, v43, v2 row_newbcast:2 row_mask:0xf bank_mask:0x3
  buffer_load_dwordx4 v5, s[44:47], s74 offen lds
  s_add_u32 s74, s74, 106496
  s_add_u32 m0, s36, 81920
  v_add_u32_dpp v63, v47, v3 row_newbcast:2 row_mask:0xf bank_mask:0x3
  buffer_load_dwordx4 v56, s[32:35], 0 offen lds
  s_add_u32 m0, s37, 81920
  v_add_u32_dpp v64, v51, v2 row_newbcast:2 row_mask:0xf bank_mask:0x3
  buffer_load_dwordx4 v57, s[32:35], 0 offen lds
  s_add_u32 m0, s38, 81920
  v_add_u32_dpp v65, v55, v3 row_newbcast:2 row_mask:0xf bank_mask:0x3
  buffer_load_dwordx4 v58, s[32:35], 0 offen lds
  s_add_u32 m0, s39, 81920
  v_add_u32_dpp v61, v37, v3 row_newbcast:9 row_mask:0xf bank_mask:0xc
  buffer_load_dwordx4 v59, s[32:35], 0 offen lds
  s_add_u32 m0, s40, 81920
  v_add_u32_dpp v62, v41, v2 row_newbcast:9 row_mask:0xf bank_mask:0xc
  buffer_load_dwordx4 v60, s[32:35], 0 offen lds
  v_add_u32_dpp v63, v45, v3 row_newbcast:9 row_mask:0xf bank_mask:0xc
  v_add_u32_dpp v64, v49, v2 row_newbcast:9 row_mask:0xf bank_mask:0xc
  v_add_u32_dpp v65, v53, v3 row_newbcast:9 row_mask:0xf bank_mask:0xc
  s_waitcnt vmcnt(12)
  s_barrier
  s_add_u32 m0, s75, 122880
  v_add_u32_dpp v56, v16, v2 row_newbcast:3 row_mask:0xf bank_mask:0x3
  buffer_load_dwordx4 v4, s[44:47], s74 offen lds
  s_add_u32 m0, s75, 123904
  v_add_u32_dpp v57, v20, v3 row_newbcast:3 row_mask:0xf bank_mask:0x3
  buffer_load_dwordx4 v5, s[44:47], s74 offen lds
  s_add_u32 s74, s74, 106496
  s_add_u32 m0, s41, 81920
  v_add_u32_dpp v58, v24, v2 row_newbcast:3 row_mask:0xf bank_mask:0x3
  buffer_load_dwordx4 v61, s[32:35], 0 offen lds
  s_add_u32 m0, s42, 81920
  v_add_u32_dpp v59, v28, v3 row_newbcast:3 row_mask:0xf bank_mask:0x3
  buffer_load_dwordx4 v62, s[32:35], 0 offen lds
  s_add_u32 m0, s43, 81920
  v_add_u32_dpp v60, v32, v2 row_newbcast:3 row_mask:0xf bank_mask:0x3
  buffer_load_dwordx4 v63, s[32:35], 0 offen lds
  s_add_u32 m0, s48, 81920
  v_add_u32_dpp v56, v18, v2 row_newbcast:9 row_mask:0xf bank_mask:0xc
  buffer_load_dwordx4 v64, s[32:35], 0 offen lds
  s_add_u32 m0, s49, 81920
  v_add_u32_dpp v57, v22, v3 row_newbcast:9 row_mask:0xf bank_mask:0xc
  buffer_load_dwordx4 v65, s[32:35], 0 offen lds
  v_add_u32_dpp v58, v26, v2 row_newbcast:9 row_mask:0xf bank_mask:0xc
  v_add_u32_dpp v59, v30, v3 row_newbcast:9 row_mask:0xf bank_mask:0xc
  v_add_u32_dpp v60, v34, v2 row_newbcast:9 row_mask:0xf bank_mask:0xc
  s_waitcnt vmcnt(12)
  s_barrier
  s_add_u32 m0, s75, 131072
  v_add_u32_dpp v61, v36, v3 row_newbcast:3 row_mask:0xf bank_mask:0x3
  buffer_load_dwordx4 v4, s[44:47], s74 offen lds
  s_add_u32 m0, s75, 132096
  v_add_u32_dpp v62, v40, v2 row_newbcast:3 row_mask:0xf bank_mask:0x3
  buffer_load_dwordx4 v5, s[44:47], s74 offen lds
  s_add_u32 s74, s74, 106496
  s_add_u32 m0, s36, 0
  v_add_u32_dpp v63, v44, v3 row_newbcast:3 row_mask:0xf bank_mask:0x3
  buffer_load_dwordx4 v56, s[32:35], 0 offen lds
  s_add_u32 m0, s37, 0
  v_add_u32_dpp v64, v48, v2 row_newbcast:3 row_mask:0xf bank_mask:0x3
  buffer_load_dwordx4 v57, s[32:35], 0 offen lds
  s_add_u32 m0, s38, 0
  v_add_u32_dpp v65, v52, v3 row_newbcast:3 row_mask:0xf bank_mask:0x3
  buffer_load_dwordx4 v58, s[32:35], 0 offen lds
  s_add_u32 m0, s39, 0
  v_add_u32_dpp v61, v38, v3 row_newbcast:9 row_mask:0xf bank_mask:0xc
  buffer_load_dwordx4 v59, s[32:35], 0 offen lds
  s_add_u32 m0, s40, 0
  v_add_u32_dpp v62, v42, v2 row_newbcast:9 row_mask:0xf bank_mask:0xc
  buffer_load_dwordx4 v60, s[32:35], 0 offen lds
  v_add_u32_dpp v63, v46, v3 row_newbcast:9 row_mask:0xf bank_mask:0xc
  v_add_u32_dpp v64, v50, v2 row_newbcast:9 row_mask:0xf bank_mask:0xc
  v_add_u32_dpp v65, v54, v3 row_newbcast:9 row_mask:0xf bank_mask:0xc
  s_waitcnt vmcnt(12)
  s_barrier
  s_add_u32 m0, s75, 139264
  v_add_u32_dpp v56, v17, v2 row_newbcast:3 row_mask:0xf bank_mask:0x3
  buffer_load_dwordx4 v4, s[44:47], s74 offen lds
  s_add_u32 m0, s75, 140288
  v_add_u32_dpp v57, v21, v3 row_newbcast:3 row_mask:0xf bank_mask:0x3
  buffer_load_dwordx4 v5, s[44:47], s74 offen lds
  s_add_u32 s74, s74, 106496
  s_add_u32 m0, s41, 0
  v_add_u32_dpp v58, v25, v2 row_newbcast:3 row_mask:0xf bank_mask:0x3
  buffer_load_dwordx4 v61, s[32:35], 0 offen lds
  s_add_u32 m0, s42, 0
  v_add_u32_dpp v59, v29, v3 row_newbcast:3 row_mask:0xf bank_mask:0x3
  buffer_load_dwordx4 v62, s[32:35], 0 offen lds
  s_add_u32 m0, s43, 0
  v_add_u32_dpp v60, v33, v2 row_newbcast:3 row_mask:0xf bank_mask:0x3
  buffer_load_dwordx4 v63, s[32:35], 0 offen lds
  s_add_u32 m0, s48, 0
  v_add_u32_dpp v56, v19, v2 row_newbcast:9 row_mask:0xf bank_mask:0xc
  buffer_load_dwordx4 v64, s[32:35], 0 offen lds
  s_add_u32 m0, s49, 0
  v_add_u32_dpp v57, v23, v3 row_newbcast:9 row_mask:0xf bank_mask:0xc
  buffer_load_dwordx4 v65, s[32:35], 0 offen lds
  v_add_u32_dpp v58, v27, v2 row_newbcast:9 row_mask:0xf bank_mask:0xc
  v_add_u32_dpp v59, v31, v3 row_newbcast:9 row_mask:0xf bank_mask:0xc
  v_add_u32_dpp v60, v35, v2 row_newbcast:9 row_mask:0xf bank_mask:0xc
  s_waitcnt vmcnt(12)
  s_barrier
  s_add_u32 m0, s75, 122880
  v_add_u32_dpp v61, v37, v3 row_newbcast:3 row_mask:0xf bank_mask:0x3
  buffer_load_dwordx4 v4, s[44:47], s74 offen lds
  s_add_u32 m0, s75, 123904
  v_add_u32_dpp v62, v41, v2 row_newbcast:3 row_mask:0xf bank_mask:0x3
  buffer_load_dwordx4 v5, s[44:47], s74 offen lds
  s_add_u32 s74, s74, 106496
  s_add_u32 m0, s36, 40960
  v_add_u32_dpp v63, v45, v3 row_newbcast:3 row_mask:0xf bank_mask:0x3
  buffer_load_dwordx4 v56, s[32:35], 0 offen lds
  s_add_u32 m0, s37, 40960
  v_add_u32_dpp v64, v49, v2 row_newbcast:3 row_mask:0xf bank_mask:0x3
  buffer_load_dwordx4 v57, s[32:35], 0 offen lds
  s_add_u32 m0, s38, 40960
  v_add_u32_dpp v65, v53, v3 row_newbcast:3 row_mask:0xf bank_mask:0x3
  buffer_load_dwordx4 v58, s[32:35], 0 offen lds
  s_add_u32 m0, s39, 40960
  v_add_u32_dpp v61, v39, v3 row_newbcast:9 row_mask:0xf bank_mask:0xc
  buffer_load_dwordx4 v59, s[32:35], 0 offen lds
  s_add_u32 m0, s40, 40960
  v_add_u32_dpp v62, v43, v2 row_newbcast:9 row_mask:0xf bank_mask:0xc
  buffer_load_dwordx4 v60, s[32:35], 0 offen lds
  v_add_u32_dpp v63, v47, v3 row_newbcast:9 row_mask:0xf bank_mask:0xc
  v_add_u32_dpp v64, v51, v2 row_newbcast:9 row_mask:0xf bank_mask:0xc
  v_add_u32_dpp v65, v55, v3 row_newbcast:9 row_mask:0xf bank_mask:0xc
  s_waitcnt vmcnt(12)
  s_barrier
  s_add_u32 m0, s75, 131072
  v_add_u32_dpp v56, v18, v2 row_newbcast:3 row_mask:0xf bank_mask:0x3
  buffer_load_dwordx4 v4, s[44:47], s74 offen lds
  s_add_u32 m0, s75, 132096
  v_add_u32_dpp v57, v22, v3 row_newbcast:3 row_mask:0xf bank_mask:0x3
  buffer_load_dwordx4 v5, s[44:47], s74 offen lds
  s_add_u32 s74, s74, 106496
  s_add_u32 m0, s41, 40960
  v_add_u32_dpp v58, v26, v2 row_newbcast:3 row_mask:0xf bank_mask:0x3
  buffer_load_dwordx4 v61, s[32:35], 0 offen lds
  s_add_u32 m0, s42, 40960
  v_add_u32_dpp v59, v30, v3 row_newbcast:3 row_mask:0xf bank_mask:0x3
  buffer_load_dwordx4 v62, s[32:35], 0 offen lds
  s_add_u32 m0, s43, 40960
  v_add_u32_dpp v60, v34, v2 row_newbcast:3 row_mask:0xf bank_mask:0x3
  buffer_load_dwordx4 v63, s[32:35], 0 offen lds
  s_add_u32 m0, s48, 40960
  v_add_u32_dpp v56, v16, v2 row_newbcast:10 row_mask:0xf bank_mask:0xc
  buffer_load_dwordx4 v64, s[32:35], 0 offen lds
  s_add_u32 m0, s49, 40960
  v_add_u32_dpp v57, v20, v3 row_newbcast:10 row_mask:0xf bank_mask:0xc
  buffer_load_dwordx4 v65, s[32:35], 0 offen lds
  v_add_u32_dpp v58, v24, v2 row_newbcast:10 row_mask:0xf bank_mask:0xc
  v_add_u32_dpp v59, v28, v3 row_newbcast:10 row_mask:0xf bank_mask:0xc
  v_add_u32_dpp v60, v32, v2 row_newbcast:10 row_mask:0xf bank_mask:0xc
  v_mov_b32_dpp v16, v16 row_shl:3 row_mask:0xf bank_mask:0xf
  v_mov_b32_dpp v17, v17 row_shl:3 row_mask:0xf bank_mask:0xf
  v_mov_b32_dpp v18, v18 row_shl:3 row_mask:0xf bank_mask:0xf
  v_mov_b32_dpp v19, v19 row_shl:3 row_mask:0xf bank_mask:0xf
  v_mov_b32_dpp v20, v20 row_shl:3 row_mask:0xf bank_mask:0xf
  v_mov_b32_dpp v21, v21 row_shl:3 row_mask:0xf bank_mask:0xf
  v_mov_b32_dpp v22, v22 row_shl:3 row_mask:0xf bank_mask:0xf
  v_mov_b32_dpp v23, v23 row_shl:3 row_mask:0xf bank_mask:0xf
  v_mov_b32_dpp v24, v24 row_shl:3 row_mask:0xf bank_mask:0xf
  v_mov_b32_dpp v25, v25 row_shl:3 row_mask:0xf bank_mask:0xf
  v_mov_b32_dpp v26, v26 row_shl:3 row_mask:0xf bank_mask:0xf
  v_mov_b32_dpp v27, v27 row_shl:3 row_mask:0xf bank_mask:0xf
  v_mov_b32_dpp v28, v28 row_shl:3 row_mask:0xf bank_mask:0xf
  v_mov_b32_dpp v29, v29 row_shl:3 row_mask:0xf bank_mask:0xf
  v_mov_b32_dpp v30, v30 row_shl:3 row_mask:0xf bank_mask:0xf
  v_mov_b32_dpp v31, v31 row_shl:3 row_mask:0xf bank_mask:0xf
  v_mov_b32_dpp v32, v32 row_shl:3 row_mask:0xf bank_mask:0xf
  v_mov_b32_dpp v33, v33 row_shl:3 row_mask:0xf bank_mask:0xf
  v_mov_b32_dpp v34, v34 row_shl:3 row_mask:0xf bank_mask:0xf
  v_mov_b32_dpp v35, v35 row_shl:3 row_mask:0xf bank_mask:0xf
  s_waitcnt vmcnt(12)
  s_barrier
  s_add_u32 m0, s75, 139264
  v_add_u32_dpp v61, v38, v3 row_newbcast:3 row_mask:0xf bank_mask:0x3
  buffer_load_dwordx4 v4, s[44:47], s74 offen lds
  s_add_u32 m0, s75, 140288
  v_add_u32_dpp v62, v42, v2 row_newbcast:3 row_mask:0xf bank_mask:0x3
  buffer_load_dwordx4 v5, s[44:47], s74 offen lds
  s_add_u32 s74, s74, 106496
  s_add_u32 m0, s36, 81920
  v_add_u32_dpp v63, v46, v3 row_newbcast:3 row_mask:0xf bank_mask:0x3
  buffer_load_dwordx4 v56, s[32:35], 0 offen lds
  s_add_u32 m0, s37, 81920
  v_add_u32_dpp v64, v50, v2 row_newbcast:3 row_mask:0xf bank_mask:0x3
  buffer_load_dwordx4 v57, s[32:35], 0 offen lds
  s_add_u32 m0, s38, 81920
  v_add_u32_dpp v65, v54, v3 row_newbcast:3 row_mask:0xf bank_mask:0x3
  buffer_load_dwordx4 v58, s[32:35], 0 offen lds
  s_add_u32 m0, s39, 81920
  v_add_u32_dpp v61, v36, v3 row_newbcast:10 row_mask:0xf bank_mask:0xc
  buffer_load_dwordx4 v59, s[32:35], 0 offen lds
  s_add_u32 m0, s40, 81920
  v_add_u32_dpp v62, v40, v2 row_newbcast:10 row_mask:0xf bank_mask:0xc
  buffer_load_dwordx4 v60, s[32:35], 0 offen lds
  v_add_u32_dpp v63, v44, v3 row_newbcast:10 row_mask:0xf bank_mask:0xc
  v_add_u32_dpp v64, v48, v2 row_newbcast:10 row_mask:0xf bank_mask:0xc
  v_add_u32_dpp v65, v52, v3 row_newbcast:10 row_mask:0xf bank_mask:0xc
  v_mov_b32_dpp v36, v36 row_shl:3 row_mask:0xf bank_mask:0xf
  v_mov_b32_dpp v37, v37 row_shl:3 row_mask:0xf bank_mask:0xf
  v_mov_b32_dpp v38, v38 row_shl:3 row_mask:0xf bank_mask:0xf
  v_mov_b32_dpp v39, v39 row_shl:3 row_mask:0xf bank_mask:0xf
  v_mov_b32_dpp v40, v40 row_shl:3 row_mask:0xf bank_mask:0xf
  v_mov_b32_dpp v41, v41 row_shl:3 row_mask:0xf bank_mask:0xf
  v_mov_b32_dpp v42, v42 row_shl:3 row_mask:0xf bank_mask:0xf
  v_mov_b32_dpp v43, v43 row_shl:3 row_mask:0xf bank_mask:0xf
  v_mov_b32_dpp v44, v44 row_shl:3 row_mask:0xf bank_mask:0xf
  v_mov_b32_dpp v45, v45 row_shl:3 row_mask:0xf bank_mask:0xf
  v_mov_b32_dpp v46, v46 row_shl:3 row_mask:0xf bank_mask:0xf
  v_mov_b32_dpp v47, v47 row_shl:3 row_mask:0xf bank_mask:0xf
  v_mov_b32_dpp v48, v48 row_shl:3 row_mask:0xf bank_mask:0xf
  v_mov_b32_dpp v49, v49 row_shl:3 row_mask:0xf bank_mask:0xf
  v_mov_b32_dpp v50, v50 row_shl:3 row_mask:0xf bank_mask:0xf
  v_mov_b32_dpp v51, v51 row_shl:3 row_mask:0xf bank_mask:0xf
  v_mov_b32_dpp v52, v52 row_shl:3 row_mask:0xf bank_mask:0xf
  v_mov_b32_dpp v53, v53 row_shl:3 row_mask:0xf bank_mask:0xf
  v_mov_b32_dpp v54, v54 row_shl:3 row_mask:0xf bank_mask:0xf
  v_mov_b32_dpp v55, v55 row_shl:3 row_mask:0xf bank_mask:0xf
  s_add_u32 s72, s72, 1
  s_cmp_lt_u32 s72, 2
  s_waitcnt vmcnt(12)
  s_cbranch_scc1 L_dnn_loop1
  s_branch L_ld_tail
L_cin:
  v_lshlrev_b32 v1, 4, v0
  s_lshl_b32 s95, s3, 10
  s_mul_i32 s26, s68, 11
  s_add_u32 s26, s26, s69
  s_sub_u32 s26, s26, 22
  s_cmp_eq_u32 s26, 86
  s_cbranch_scc1 L_end
  s_add_u32 s70, s95, L_tables-L_pc
  v_add_u32 v2, s70, v1
  v_mov_b32 v3, s93
  v_add_co_u32 v2, vcc, s92, v2
  s_nop 1
  v_addc_co_u32 v3, vcc, 0, v3, vcc
  s_cmp_lt_u32 s3, 6
  s_mov_b32 s70, 115008
  s_cselect_b32 s70, 77824, s70
  s_add_u32 m0, s70, s95
  s_nop 0
  global_load_lds_dwordx4 v[2:3], off
  v_add_co_u32 v2, vcc, 0x2000, v2
  s_nop 1
  v_addc_co_u32 v3, vcc, 0, v3, vcc
  s_cmp_lt_u32 s3, 3
  s_mov_b32 s70, -1024
  s_cselect_b32 s70, 123200, s70
  s_add_u32 m0, s70, s95
  s_cmp_eq_u32 s3, 7
  s_cbranch_scc1 L_notab
  global_load_lds_dwordx4 v[2:3], off
L_notab:
  s_and_b32 s79, s3, 3
  s_lshr_b32 s84, s3, 2
  s_sub_u32 s68, s71, 22
  s_lshl_b32 s68, s68, 3
  s_add_u32 s68, s68, s3
  s_mul_i32 s68, s68, 1408
  v_min_u32 v29, 10, v0
  v_lshlrev_b32 v29, 7, v29
  s_mul_i32 s94, s26, 48
  s_add_u32 s94, s94, s3
  s_mul_i32 s94, s94, 104
  v_lshrrev_b32 v30, 3, v0
  v_lshlrev_b32 v30, 4, v30
  v_mov_b32 v2, 129664
  v_mov_b64 v[32:33], 0
  v_mov_b64 v[34:35], 0
  v_mov_b64 v[36:37], 0
  v_mov_b64 v[38:39], 0
  v_mov_b64 v[40:41], 0
  v_mov_b64 v[42:43], 0
  v_mov_b64 v[44:45], 0
  v_mov_b64 v[46:47], 0
  v_mov_b64 v[48:49], 0
  v_mov_b64 v[50:51], 0
  v_mov_b64 v[52:53], 0
  v_mov_b64 v[54:55], 0
  v_mov_b64 v[56:57], 0
  ds_write_b128 v2, v[32:35] offset:16
  s_waitcnt lgkmcnt(0)
  s_mov_b32 s36, s8
  s_and_b32 s37, s9, 0xffff
  s_mov_b32 s38, 105456
  s_mov_b32 s39, 0x20000
  buffer_load_dword v108, v29, s[36:39], s68 offen
  s_mov_b32 s28, s4
  s_and_b32 s29, s5, 0xffff
  s_mov_b32 s30, 425984
  s_mov_b32 s31, 0x20000
  buffer_load_dwordx4 v[16:19], v30, s[28:31], s94 offen
  s_cmp_lt_u32 s3, 3
  s_cselect_b32 s96, 32768, 0
  s_cselect_b64 s[82:83], -1, 1
  s_add_u32 s96, s96, s95
  s_mov_b32 s40, s10
  s_and_b32 s41, s11, 0xffff
  s_mov_b32 s42, 156
  s_mov_b32 s43, 0x20000
  s_mov_b32 m0, 129472
  s_mov_b64 exec, 0x7ff
  buffer_load_dwordx4 v1, s[40:43], 0 offen lds
  s_mov_b64 exec, -1
  s_add_u32 m0, s95, 41984
  s_add_u32 s81, s95, 70304
  buffer_load_dwordx4 v1, s[36:39], s81 offen lds
  s_add_u32 m0, s95, 50176
  s_add_u32 s81, s95, 78496
  buffer_load_dwordx4 v1, s[36:39], s81 offen lds
  s_add_u32 m0, s95, 58368
  s_add_u32 s81, s95, 86688
  buffer_load_dwordx4 v1, s[36:39], s81 offen lds
  s_add_u32 m0, s95, 66560
  s_add_u32 s81, s95, 94880
  buffer_load_dwordx4 v1, s[36:39], s81 offen lds
  s_add_u32 m0, s96, 41984
  s_add_u32 s81, s96, 70304
  s_mov_b64 exec, s[82:83]
  buffer_load_dwordx4 v1, s[36:39], s81 offen lds
  s_mov_b64 exec, -1
  s_mov_b32 s32, s6
  s_and_b32 s33, s7, 0xffff
  s_mov_b32 s34, 12800000
  s_mov_b32 s35, 0x20000
  v_mov_b32 v31, s80
  buffer_load_dword v109, v31, s[32:35], 0 offen
  v_add_u32 v29, 77824, v1
  v_add_u32 v30, 121152, v1
  s_waitcnt vmcnt(9)
  s_barrier
  ds_read_b128 v[224:227], v29 offset:4096
  s_add_u32 m0, s95, 85312
  s_add_u32 s81, s95, 35152
  buffer_load_dwordx4 v1, s[36:39], s81 offen lds
  ds_read_b128 v[240:243], v30 offset:4096
  ds_read_b128 v[4:7], v29 offset:0
  s_add_u32 m0, s95, 93504
  s_add_u32 s81, s95, 43344
  buffer_load_dwordx4 v1, s[36:39], s81 offen lds
  ds_read_b128 v[8:11], v29 offset:1024
  ds_read_b128 v[228:231], v30 offset:1024
  s_add_u32 m0, s95, 101696
  s_add_u32 s81, s95, 51536
  buffer_load_dwordx4 v1, s[36:39], s81 offen lds
  ds_read_b128 v[232:235], v30 offset:2048
  ds_read_b128 v[216:219], v29 offset:5120
  s_add_u32 m0, s95, 109888
  s_add_u32 s81, s95, 59728
  buffer_load_dwordx4 v1, s[36:39], s81 offen lds
  ds_read_b128 v[220:223], v30 offset:0
  ds_read_b128 v[236:239], v30 offset:3072
  s_add_u32 m0, s96, 85312
  s_add_u32 s81, s96, 35152
  s_mov_b64 exec, s[82:83]
  buffer_load_dwordx4 v1, s[36:39], s81 offen lds
  s_mov_b64 exec, -1
  ds_read_b128 v[20:23], v29 offset:2048
  ds_read_b128 v[24:27], v29 offset:3072
  s_lshl_b32 s68, s3, 7
  s_mul_i32 s76, s3, 4064
  s_add_u32 s76, s76, 131136
  s_mul_i32 s69, s3, 5280
  s_lshl_b32 s70, s3, 2
  s_waitcnt lgkmcnt(10)
  v_add_u32 v225, s68, v225
  v_add_u32 v226, s68, v226
  v_add_u32 v227, s68, v227
  s_lshl_b32 s68, s3, 6
  v_add_u32 v29, s68, v0
  v_mul_u32_u24 v30, 2521, v29
  v_lshrrev_b32 v30, 16, v30
  v_mul_u32_u24 v30, 12, v30
  v_lshl_add_u32 v28, v29, 1, v30
  v_add_u32 v29, 512, v29
  v_mul_u32_u24 v30, 2521, v29
  v_lshrrev_b32 v30, 16, v30
  v_mul_u32_u24 v30, 12, v30
  v_lshl_add_u32 v58, v29, 1, v30
  v_cmp_gt_u32 vcc, 676, v29
  s_nop 0
  s_mov_b64 s[92:93], vcc
  v_lshlrev_b32_e64 v29, 3, v0
  s_mov_b32 exec_hi, 0xffff
  ds_write_b64 v29, v[32:33] offset:1664
  s_mov_b32 exec_hi, -1
  s_waitcnt lgkmcnt(10)
  ds_write_b32 v243, v32
  ds_write_b32 v243, v32 offset:43328
  s_waitcnt lgkmcnt(10)
  v_add_u32 v10, s76, v10
  v_add_u32 v4, s76, v4
  v_add_u32 v5, s76, v5
  ds_write_b32 v10, v7 offset:2880
  s_waitcnt vmcnt(6) lgkmcnt(0)
  s_barrier
  ds_read_b64 v[112:113], v240 offset:0
  ds_read_b64 v[114:115], v240 offset:8
  ds_read_b64 v[116:117], v240 offset:32
  ds_read_b64 v[118:119], v240 offset:40
  ds_read_u16 v110, v241
  ds_read_b64_tr_b16 v[60:61], v225 offset:35840
  ds_read_b64_tr_b16 v[62:63], v225 offset:41248
  ds_read_b64_tr_b16 v[64:65], v226 offset:35840
  ds_read_b64_tr_b16 v[66:67], v227 offset:35840
  ds_read_b64_tr_b16 v[68:69], v225 offset:35904
  ds_read_b64_tr_b16 v[70:71], v225 offset:41312
  ds_read_b64_tr_b16 v[72:73], v226 offset:35904
  ds_read_b64_tr_b16 v[74:75], v227 offset:35904
  s_cmp_ge_u32 s3, 3
  s_cbranch_scc1 L_v3a
  ds_read_b64_tr_b16 v[76:77], v225 offset:36864
  ds_read_b64_tr_b16 v[78:79], v225 offset:42272
  ds_read_b64_tr_b16 v[80:81], v226 offset:36864
  ds_read_b64_tr_b16 v[82:83], v227 offset:36864
  ds_read_b64_tr_b16 v[84:85], v225 offset:36928
  ds_read_b64_tr_b16 v[86:87], v225 offset:42336
  ds_read_b64_tr_b16 v[88:89], v226 offset:36928
  ds_read_b64_tr_b16 v[90:91], v227 offset:36928
  s_waitcnt lgkmcnt(6)
  v_mfma_f32_32x32x16_bf16 v[152:167], v[112:115], v[76:79], 0
  s_waitcnt lgkmcnt(4)
  v_mfma_f32_32x32x16_bf16 v[152:167], v[116:119], v[80:83], v[152:167]
  s_waitcnt lgkmcnt(2)
  v_mfma_f32_32x32x16_bf16 v[168:183], v[112:115], v[84:87], 0
  s_waitcnt lgkmcnt(0)
  v_mfma_f32_32x32x16_bf16 v[168:183], v[116:119], v[88:91], v[168:183]
L_v3a:
  s_waitcnt lgkmcnt(6)
  v_mfma_f32_32x32x16_bf16 v[120:135], v[112:115], v[60:63], 0
  s_waitcnt lgkmcnt(4)
  v_mfma_f32_32x32x16_bf16 v[120:135], v[116:119], v[64:67], v[120:135]
  s_waitcnt lgkmcnt(2)
  v_mfma_f32_32x32x16_bf16 v[136:151], v[112:115], v[68:71], 0
  s_waitcnt lgkmcnt(0)
  v_mfma_f32_32x32x16_bf16 v[136:151], v[116:119], v[72:75], v[136:151]
  s_add_u32 m0, s95, 6144
  s_add_u32 s81, s95, 0
  buffer_load_dwordx4 v1, s[36:39], s81 offen lds
  v_add_u32 v11, s69, v11
  v_add_u32 v20, s69, v20
  v_add_u32 v21, s69, v21
  v_add_u32 v22, s69, v22
  v_add_u32 v23, s69, v23
  v_add_u32 v24, s69, v24
  v_add_u32 v25, s69, v25
  v_add_u32 v26, s69, v26
  v_add_u32 v27, s69, v27
  v_add_u32 v228, s70, v228
  v_add_u32 v229, s70, v229
  v_mad_u32_u24 v232, v233, s3, v232
  s_lshl_b32 s68, s3, 1
  v_add_u32 v234, s68, v234
  v_mad_u32_u24 v233, v233, 5, v232
  s_lshl_b32 s68, s3, 12
  v_add_u32 v246, s68, v235
  v_add_u32 v247, 2048, v246
  s_add_u32 m0, s95, 14336
  s_add_u32 s81, s95, 8192
  buffer_load_dwordx4 v1, s[36:39], s81 offen lds
  v_add_u32 v31, 0, v234
  v_and_b32 v31, 3, v31
  v_lshl_add_u32 v244, v31, 4, v232
  v_add_u32 v31, 1, v234
  v_and_b32 v31, 3, v31
  v_lshl_add_u32 v245, v31, 4, v232
  v_add_u32 v245, 1664, v245
  v_add_u32 v31, 2, v234
  v_and_b32 v31, 3, v31
  v_lshl_add_u32 v248, v31, 4, v233
  v_add_u32 v31, 3, v234
  v_and_b32 v31, 3, v31
  v_lshl_add_u32 v249, v31, 4, v233
  v_add_u32 v249, 1664, v249
  s_and_b32 s98, s3, 1
  s_lshr_b32 s99, s3, 1
  s_mul_i32 s68, s99, 3072
  s_lshl_b32 s69, s98, 3
  s_add_u32 m0, s95, 22528
  s_add_u32 s81, s95, 16384
  buffer_load_dwordx4 v1, s[36:39], s81 offen lds
  s_add_u32 s68, s68, s69
  v_add_u32 v59, s68, v1
  v_add_u32 v231, s69, v231
  s_lshl_b32 s69, s99, 3
  s_lshr_b32 s69, 0x05030200, s69
  s_and_b32 s69, s69, 0xff
  s_lshl_b32 s69, s69, 9
  s_lshl_b32 s70, s98, 2
  s_add_u32 s69, s69, s70
  v_add_u32 v230, s69, v230
  s_mul_i32 s85, s84, 20
  s_add_u32 s85, s85, s3
  s_lshl_b32 s85, s85, 2
  s_add_u32 s85, s85, 129728
  s_mul_i32 s72, s84, 3
  s_sub_u32 s72, 4, s72
  s_cmp_eq_u32 s26, 85
  s_cselect_b32 s72, s72, 6
  s_mul_i32 s68, s84, 1248
  s_add_u32 m0, s95, 30720
  s_add_u32 s81, s95, 24576
  buffer_load_dwordx4 v1, s[36:39], s81 offen lds
  s_add_u32 s68, s68, 832
  s_add_u32 s94, s94, s68
  s_mov_b32 s60, s24
  s_and_b32 s61, s25, 0xffff
  s_mov_b32 s62, 268435456
  s_mov_b32 s63, 0x20000
  s_mov_b32 s56, s20
  s_and_b32 s57, s21, 0xffff
  s_mov_b32 s58, 8192
  s_mov_b32 s59, 0x20000
  s_mov_b32 s64, s22
  s_and_b32 s65, s23, 0xffff
  s_mov_b32 s66, 256
  s_mov_b32 s67, 0x20000
  s_mov_b32 s44, s12
  s_and_b32 s45, s13, 0xffff
  s_mov_b32 s46, 5537792
  s_mov_b32 s47, 0x20000
  s_add_u32 m0, s96, 6144
  s_add_u32 s81, s96, 0
  s_mov_b64 exec, s[82:83]
  buffer_load_dwordx4 v1, s[36:39], s81 offen lds
  s_mov_b64 exec, -1
  s_lshl_b32 s101, s26, 3
  s_add_u32 s101, s101, s3
  s_add_u32 s101, s101, 1664
  s_lshl_b32 s101, s101, 7
  s_mov_b32 s71, 88064
  v_min_u32_e64 v12, 12, v0
  v_mul_lo_u32 v12, s71, v12
  s_lshl_b32 s77, s26, 3
  s_add_u32 s77, s77, s3
  s_mul_i32 s77, s77, 624
  s_add_u32 s73, s77, 80
  s_add_u32 s77, s77, 16
  v_min_u32 v31, 35, v0
  v_mul_u32_u24 v13, 10923, v31
  v_lshrrev_b32_e64 v13, 16, v13
  v_mul_u32_u24 v13, 80, v13
  v_lshl_add_u32 v13, v31, 2, v13
  s_cmp_ge_u32 s3, 3
  s_cbranch_scc1 L_nosq
  v_add_u32 v248, 32768, v246
  v_add_u32 v249, 32768, v247
  s_cmp_lg_u32 s3, 2
  s_cbranch_scc1 L_nosq
  s_mov_b32 exec_lo, 0xfffffff0
  s_mov_b32 exec_hi, 0xfffffff0
  v_mov_b32 v249, 1048576
  s_mov_b64 exec, -1
L_nosq:
  v_add_u32 v29, s95, v1
  v_add_u32 v30, s96, v1
  v_add_u32 v29, 85312, v29
  v_add_u32 v30, 85312, v30
  s_waitcnt vmcnt(5)
  ds_read_b128 v[60:63], v29 offset:0
  ds_read_b128 v[64:67], v29 offset:8192
  ds_read_b128 v[68:71], v29 offset:16384
  ds_read_b128 v[72:75], v29 offset:24576
  ds_read_b128 v[76:79], v30 offset:0
  v_mov_b32 v109, 0
  v_mov_b32 v108, 0
  s_mov_b64 exec, 0x3ffffff
  ds_write_b16 v242, v110
  v_lshlrev_b32 v109, 17, v110
  v_lshrrev_b32 v109, 1, v109
  s_mov_b64 exec, -1
  s_mov_b32 exec_lo, 0
  v_mov_b32 v120, v136
  s_mov_b32 exec_lo, -1
  v_cvt_pk_bf16_f32 v31, 0, v120
  ds_write_b16_d16_hi v28, v31
  v_max_f32 v108, |v31|, v108
  s_mov_b32 exec_lo, 0
  v_mov_b32_e64 v152, v168
  s_mov_b32 exec_lo, -1
  v_cvt_pk_bf16_f32 v31, 0, v152
  s_mov_b64 exec, s[92:93]
  ds_write_b16_d16_hi v58, v31
  v_max_f32 v108, |v31|, v108
  s_mov_b64 exec, -1
  v_lshl_add_u32 v16, v16, 7, v8
  v_lshl_add_u32 v17, v17, 7, v8
  v_lshl_add_u32 v18, v18, 7, v8
  v_lshl_add_u32 v19, v19, 7, v8
  s_add_u32 m0, s76, 0
  s_mov_b32 exec_hi, 0xffffff
  buffer_load_dwordx4 v16, s[32:35], 0 offen lds
  s_add_u32 m0, s76, 1056
  s_nop 0
  buffer_load_dwordx4 v17, s[32:35], 0 offen lds
  s_add_u32 m0, s76, 2112
  s_mov_b32 exec_hi, 0xffff
  buffer_load_dwordx4 v18, s[32:35], 0 offen lds
  s_add_u32 m0, s76, 3168
  s_nop 0
  buffer_load_dwordx4 v19, s[32:35], 0 offen lds
  s_mov_b32 exec_hi, -1
  buffer_load_dword v3, v13, s[28:31], s77 offen
  s_cmp_eq_u32 s77, s73
  s_cselect_b32 s73, 0x7000000, s73
  s_cselect_b32 s77, 0x7000000, s77
  s_add_u32 s77, s77, 24
  s_min_u32 s77, s77, s73
  buffer_load_dword v14, v12, s[44:47], s101 offen
  s_add_u32 s101, s101, 1144832
  v_subrev_u32 v29, 79168, v29
  v_subrev_u32 v30, 79168, v30
  s_waitcnt lgkmcnt(7)
  v_pk_maximum3_f16 v110, v60, v61, 0
  v_pk_minimum3_f16 v60, v60, v61, 0
  v_pk_maximum3_f16 v110, v110, v62, v63
  v_pk_minimum3_f16 v60, v60, v62, v63
  s_waitcnt lgkmcnt(6)
  v_pk_maximum3_f16 v110, v110, v64, v65
  v_pk_minimum3_f16 v60, v60, v64, v65
  v_pk_maximum3_f16 v110, v110, v66, v67
  v_pk_minimum3_f16 v60, v60, v66, v67
  s_waitcnt lgkmcnt(5)
  v_pk_maximum3_f16 v110, v110, v68, v69
  v_pk_minimum3_f16 v60, v60, v68, v69
  v_pk_maximum3_f16 v110, v110, v70, v71
  v_pk_minimum3_f16 v60, v60, v70, v71
  s_waitcnt lgkmcnt(4)
  v_pk_maximum3_f16 v110, v110, v72, v73
  v_pk_minimum3_f16 v60, v60, v72, v73
  v_pk_maximum3_f16 v110, v110, v74, v75
  v_pk_minimum3_f16 v60, v60, v74, v75
  s_waitcnt lgkmcnt(3)
  v_pk_maximum3_f16 v110, v110, v76, v77
  v_pk_minimum3_f16 v60, v60, v76, v77
  v_pk_maximum3_f16 v110, v110, v78, v79
  v_pk_minimum3_f16 v60, v60, v78, v79
  v_and_b32 v60, 0x7fff7fff, v60
  v_and_b32 v110, 0x7fff7fff, v110
  v_pk_max_u16 v110, v110, v60
  v_lshlrev_b32 v60, 16, v110
  v_max_u32_e64 v110, v110, v60
  s_waitcnt vmcnt(6)
  ds_read_b128 v[80:83], v29 offset:0
  ds_read_b128 v[84:87], v29 offset:8192
  ds_read_b128 v[88:91], v29 offset:16384
  ds_read_b128 v[92:95], v29 offset:24576
  ds_read_b128 v[96:99], v30 offset:0
  s_waitcnt lgkmcnt(4)
  v_pk_maximum3_f16 v111, v80, v81, 0
  v_pk_minimum3_f16 v80, v80, v81, 0
  v_pk_maximum3_f16 v111, v111, v82, v83
  v_pk_minimum3_f16 v80, v80, v82, v83
  s_waitcnt lgkmcnt(3)
  v_pk_maximum3_f16 v111, v111, v84, v85
  v_pk_minimum3_f16 v80, v80, v84, v85
  v_pk_maximum3_f16 v111, v111, v86, v87
  v_pk_minimum3_f16 v80, v80, v86, v87
  s_waitcnt lgkmcnt(2)
  v_pk_maximum3_f16 v111, v111, v88, v89
  v_pk_minimum3_f16 v80, v80, v88, v89
  v_pk_maximum3_f16 v111, v111, v90, v91
  v_pk_minimum3_f16 v80, v80, v90, v91
  s_waitcnt lgkmcnt(1)
  v_pk_maximum3_f16 v111, v111, v92, v93
  v_pk_minimum3_f16 v80, v80, v92, v93
  v_pk_maximum3_f16 v111, v111, v94, v95
  v_pk_minimum3_f16 v80, v80, v94, v95
  s_waitcnt lgkmcnt(0)
  v_pk_maximum3_f16 v111, v111, v96, v97
  v_pk_minimum3_f16 v80, v80, v96, v97
  v_pk_maximum3_f16 v111, v111, v98, v99
  v_pk_minimum3_f16 v80, v80, v98, v99
  v_and_b32 v80, 0x7fff7fff, v80
  v_and_b32 v111, 0x7fff7fff, v111
  v_pk_max_u16 v111, v111, v80
  v_lshlrev_b32 v80, 16, v111
  v_max_u32 v111, v111, v80
  s_nop 1
  v_max_u32_dpp v111, v111, v111 row_shr:1 row_mask:0xf bank_mask:0xf
  v_max_u32_dpp v110, v110, v110 row_shr:1 row_mask:0xf bank_mask:0xf
  v_max_u32_dpp v108, v108, v108 row_shr:1 row_mask:0xf bank_mask:0xf
  v_max_u32_dpp v109, v109, v109 row_shr:1 row_mask:0xf bank_mask:0xf
  v_max_u32_dpp v111, v111, v111 row_shr:2 row_mask:0xf bank_mask:0xf
  v_max_u32_dpp v110, v110, v110 row_shr:2 row_mask:0xf bank_mask:0xf
  v_max_u32_dpp v108, v108, v108 row_shr:2 row_mask:0xf bank_mask:0xf
  v_max_u32_dpp v109, v109, v109 row_shr:2 row_mask:0xf bank_mask:0xf
  v_max_u32_dpp v111, v111, v111 row_shr:4 row_mask:0xf bank_mask:0xf
  v_max_u32_dpp v110, v110, v110 row_shr:4 row_mask:0xf bank_mask:0xf
  v_max_u32_dpp v108, v108, v108 row_shr:4 row_mask:0xf bank_mask:0xf
  v_max_u32_dpp v109, v109, v109 row_shr:4 row_mask:0xf bank_mask:0xf
  v_max_u32_dpp v111, v111, v111 row_shr:8 row_mask:0xf bank_mask:0xf
  v_max_u32_dpp v110, v110, v110 row_shr:8 row_mask:0xf bank_mask:0xf
  v_max_u32_dpp v108, v108, v108 row_shr:8 row_mask:0xf bank_mask:0xf
  v_max_u32_dpp v109, v109, v109 row_shr:8 row_mask:0xf bank_mask:0xf
  v_max_u32_dpp v111, v111, v111 row_bcast:15 row_mask:0xa bank_mask:0xf
  v_max_u32_dpp v110, v110, v110 row_bcast:15 row_mask:0xa bank_mask:0xf
  v_max_u32_dpp v108, v108, v108 row_bcast:15 row_mask:0xa bank_mask:0xf
  v_max_u32_dpp v109, v109, v109 row_bcast:15 row_mask:0xa bank_mask:0xf
  v_max_u32_dpp v111, v111, v111 row_bcast:31 row_mask:0xc bank_mask:0xf
  v_max_u32_dpp v110, v110, v110 row_bcast:31 row_mask:0xc bank_mask:0xf
  v_max_u32_dpp v108, v108, v108 row_bcast:31 row_mask:0xc bank_mask:0xf
  v_max_u32_dpp v109, v109, v109 row_bcast:31 row_mask:0xc bank_mask:0xf
  s_mov_b32 exec_lo, 0
  s_mov_b32 exec_hi, 0x80000000
  ds_max_u32 v2, v111 offset:16
  ds_max_u32 v2, v110 offset:20
  ds_max_u32 v2, v108 offset:24
  ds_max_u32 v2, v109 offset:28
  s_mov_b64 exec, -1
L_b1:
  s_waitcnt lgkmcnt(0)
  s_barrier
  ds_read_b128 v[108:111], v2 offset:16
  ds_read_b64_tr_b16 v[76:77], v225 offset:0
  ds_read_b64_tr_b16 v[78:79], v225 offset:5408
  ds_read_b64_tr_b16 v[80:81], v226 offset:0
  ds_read_b64_tr_b16 v[82:83], v227 offset:0
  ds_read_b64_tr_b16 v[84:85], v225 offset:64
  ds_read_b64_tr_b16 v[86:87], v225 offset:5472
  ds_read_b64_tr_b16 v[88:89], v226 offset:64
  ds_read_b64_tr_b16 v[90:91], v227 offset:64
  ds_read_b64_tr_b16 v[112:113], v224 offset:0
  ds_read_b64_tr_b16 v[114:115], v224 offset:256
  ds_read_b64_tr_b16 v[116:117], v224 offset:1024
  ds_read_b64_tr_b16 v[118:119], v224 offset:1280
  s_waitcnt lgkmcnt(12)
  v_lshrrev_b32 v108, 23, v108
  v_sub_u32 v108, 267, v108
  v_min_u32 v108, 167, v108
  s_nop 0
  v_readfirstlane_b32 s74, v108
  v_mul_u32_u24 v108, 0x800080, v108
  ds_read_b32 v60, v228 offset:0
  v_and_b32 v216, v216, v108
  ds_read_b32 v61, v228 offset:1352
  v_and_b32 v217, v217, v108
  ds_read_b32 v62, v228 offset:2704
  v_and_b32 v218, v218, v108
  ds_read_b32 v63, v228 offset:4056
  ds_read_b32 v64, v228 offset:5408
  v_and_b32 v219, v219, v108
  ds_read_b32 v65, v228 offset:6760
  v_and_b32 v220, v220, v108
  ds_read_b32 v66, v228 offset:8112
  v_and_b32 v221, v221, v108
  ds_read_b32 v67, v228 offset:9464
  ds_read_b32 v68, v228 offset:21632
  v_and_b32 v222, v222, v108
  ds_read_b32 v69, v228 offset:22984
  v_and_b32_e64 v223, v223, v108
  ds_read_b32 v70, v229 offset:24336
  s_waitcnt lgkmcnt(14)
  v_mfma_f32_32x32x16_bf16 v[152:167], v[216:219], v[76:79], 0
  ds_read_b32 v71, v229 offset:25688
  ds_read_b32 v72, v229 offset:27040
  v_mfma_f32_32x32x16_bf16 v[152:167], v[220:223], v[80:83], v[152:167]
  ds_read_b32 v73, v229 offset:28392
  v_mfma_f32_32x32x16_bf16 v[168:183], v[216:219], v[84:87], 0
  ds_read_b32 v74, v229 offset:29744
  v_mfma_f32_32x32x16_bf16 v[168:183], v[220:223], v[88:91], v[168:183]
  ds_read_b32 v75, v229 offset:31096
  s_cmp_lt_u32 s3, 3
  s_cbranch_scc1 L_u0
  ds_read_b32 v92, v228 offset:20
  ds_read_b32 v93, v228 offset:1372
  ds_read_b32 v94, v228 offset:2724
  ds_read_b32 v95, v228 offset:4076
  ds_read_b32 v96, v228 offset:5428
  ds_read_b32 v97, v228 offset:6780
  ds_read_b32 v98, v228 offset:8132
  ds_read_b32 v99, v228 offset:9484
  ds_read_b32 v100, v228 offset:21652
  ds_read_b32 v101, v228 offset:23004
  ds_read_b32 v102, v229 offset:24356
  ds_read_b32 v103, v229 offset:25708
  ds_read_b32 v104, v229 offset:27060
  ds_read_b32 v105, v229 offset:28412
  ds_read_b32 v106, v229 offset:29764
  ds_read_b32 v107, v229 offset:31116
  s_branch L_u1
L_u0:
  ds_read_b64_tr_b16 v[92:93], v225 offset:1024
  ds_read_b64_tr_b16 v[94:95], v225 offset:6432
  ds_read_b64_tr_b16 v[96:97], v226 offset:1024
  ds_read_b64_tr_b16 v[98:99], v227 offset:1024
  ds_read_b64_tr_b16 v[100:101], v225 offset:1088
  ds_read_b64_tr_b16 v[102:103], v225 offset:6496
  ds_read_b64_tr_b16 v[104:105], v226 offset:1088
  ds_read_b64_tr_b16 v[106:107], v227 offset:1088
L_u1:
  v_lshrrev_b32 v109, 23, v109
  v_lshrrev_b32 v110, 23, v110
  v_lshrrev_b32 v111, 23, v111
  s_mov_b32 vcc_lo, 0x4000000
  s_mov_b32 vcc_hi, 0x4000000
  v_cndmask_b32 v250, v110, v111, vcc
  v_add_u32 v250, v250, v109
  v_sub_u32 v250, 388, v250
  s_movk_i32 s98, 167
  v_med3_i32 v250, v250, 1, s98
  v_subrev_u32 v110, 127, v250
  v_lshlrev_b32 v250, 23, v250
  v_cmp_gt_i32 vcc, 0, v110
  s_mov_b32 s99, 0x05040100
  s_mov_b32 s100, 0x07060302
  v_mul_u32_u24 v110, 0x800080, v110
  s_cbranch_vccnz L_sdown
  v_add_u32 v112, v112, v110
  v_add_u32 v113, v113, v110
  s_waitcnt lgkmcnt(14)
  v_add_u32 v114, v114, v110
  v_add_u32 v115, v115, v110
  v_add_u32 v116, v116, v110
  v_add_u32 v117, v117, v110
  v_add_u32 v118, v118, v110
  v_add_u32_e64 v119, v119, v110
L_scaled:
  v_perm_b32 v184, v61, v60, s99
  v_perm_b32 v185, v63, v62, s99
  v_perm_b32 v186, v65, v64, s99
  v_perm_b32 v187, v67, v66, s99
  v_perm_b32 v188, v69, v68, s99
  s_waitcnt lgkmcnt(12)
  v_perm_b32 v189, v71, v70, s99
  s_waitcnt lgkmcnt(10)
  v_perm_b32 v190, v73, v72, s99
  s_waitcnt lgkmcnt(8)
  v_perm_b32 v191, v75, v74, s99
  v_mfma_f32_32x32x16_bf16 v[120:135], v[184:187], v[112:115], 0
  s_nop 0
  v_mfma_f32_32x32x16_bf16 v[120:135], v[188:191], v[116:119], v[120:135]
  v_perm_b32 v192, v61, v60, s100
  v_perm_b32 v193, v63, v62, s100
  v_perm_b32 v194, v65, v64, s100
  v_perm_b32 v195, v67, v66, s100
  v_perm_b32 v196, v69, v68, s100
  v_perm_b32 v197, v71, v70, s100
  v_perm_b32 v198, v73, v72, s100
  v_perm_b32 v199, v75, v74, s100
  v_mfma_f32_32x32x16_bf16 v[136:151], v[192:195], v[112:115], 0
  s_nop 0
  v_mfma_f32_32x32x16_bf16 v[136:151], v[196:199], v[116:119], v[136:151]
  s_waitcnt lgkmcnt(0)
  s_barrier
  s_cmp_lt_u32 s3, 3
  s_cbranch_scc1 L_u2
  v_perm_b32 v60, v93, v92, s99
  v_perm_b32 v61, v95, v94, s99
  v_perm_b32 v62, v97, v96, s99
  v_perm_b32 v63, v99, v98, s99
  v_perm_b32 v64, v101, v100, s99
  v_perm_b32 v65, v103, v102, s99
  v_perm_b32 v66, v105, v104, s99
  v_perm_b32 v67, v107, v106, s99
  v_mfma_f32_32x32x16_bf16 v[184:199], v[60:63], v[112:115], 0
  s_nop 0
  v_mfma_f32_32x32x16_bf16 v[184:199], v[64:67], v[116:119], v[184:199]
  v_perm_b32 v68, v93, v92, s100
  v_perm_b32 v69, v95, v94, s100
  v_perm_b32 v70, v97, v96, s100
  v_perm_b32 v71, v99, v98, s100
  v_perm_b32 v72, v101, v100, s100
  v_perm_b32 v73, v103, v102, s100
  v_perm_b32 v74, v105, v104, s100
  v_perm_b32 v75, v107, v106, s100
  v_mfma_f32_32x32x16_bf16 v[200:215], v[68:71], v[112:115], 0
  s_nop 0
  v_mfma_f32_32x32x16_bf16 v[200:215], v[72:75], v[116:119], v[200:215]
  s_branch L_u3
L_u2:
  v_mfma_f32_32x32x16_bf16 v[184:199], v[216:219], v[92:95], 0
  v_mfma_f32_32x32x16_bf16 v[184:199], v[220:223], v[96:99], v[184:199]
  v_mfma_f32_32x32x16_bf16 v[200:215], v[216:219], v[100:103], 0
  v_mfma_f32_32x32x16_bf16 v[200:215], v[220:223], v[104:107], v[200:215]
L_u3:
  v_cvt_pk_f16_f32 v76, v152, v153
  v_cvt_pk_f16_f32 v77, v154, v155
  v_cvt_pk_f16_f32 v78, v156, v157
  v_cvt_pk_f16_f32 v79, v158, v159
  ds_write_b128 v246, v[76:79]
  v_xor_b32_e64 v246, 16, v246
  v_cvt_pk_f16_f32 v80, v160, v161
  v_cvt_pk_f16_f32 v81, v162, v163
  v_cvt_pk_f16_f32 v82, v164, v165
  v_cvt_pk_f16_f32 v83, v166, v167
  ds_write_b128 v246, v[80:83]
  v_cvt_pk_f16_f32 v84, v168, v169
  v_cvt_pk_f16_f32 v85, v170, v171
  v_cvt_pk_f16_f32 v86, v172, v173
  v_cvt_pk_f16_f32 v87, v174, v175
  ds_write_b128 v247, v[84:87]
  v_xor_b32_e64 v247, 16, v247
  v_cvt_pk_f16_f32 v88, v176, v177
  v_cvt_pk_f16_f32 v89, v178, v179
  v_cvt_pk_f16_f32 v90, v180, v181
  v_cvt_pk_f16_f32 v91, v182, v183
  ds_write_b128 v247, v[88:91]
  v_cvt_pk_f16_f32 v60, v120, v121
  v_cvt_pk_f16_f32 v61, v122, v123
  v_cvt_pk_f16_f32 v62, v124, v125
  v_cvt_pk_f16_f32 v63, v126, v127
  ds_write_b128 v244, v[60:63]
  v_xor_b32_e64 v244, 16, v244
  v_cvt_pk_f16_f32 v64, v128, v129
  v_cvt_pk_f16_f32 v65, v130, v131
  v_cvt_pk_f16_f32 v66, v132, v133
  v_cvt_pk_f16_f32 v67, v134, v135
  ds_write_b128 v244, v[64:67]
  v_cvt_pk_f16_f32 v68, v136, v137
  v_cvt_pk_f16_f32 v69, v138, v139
  v_cvt_pk_f16_f32 v70, v140, v141
  v_cvt_pk_f16_f32 v71, v142, v143
  ds_write_b128 v245, v[68:71]
  v_xor_b32_e64 v245, 16, v245
  v_cvt_pk_f16_f32 v72, v144, v145
  v_cvt_pk_f16_f32 v73, v146, v147
  v_cvt_pk_f16_f32 v74, v148, v149
  v_cvt_pk_f16_f32 v75, v150, v151
  ds_write_b128 v245, v[72:75]
  v_cvt_pk_f16_f32 v92, v184, v185
  v_cvt_pk_f16_f32 v93, v186, v187
  v_cvt_pk_f16_f32 v94, v188, v189
  v_cvt_pk_f16_f32 v95, v190, v191
  ds_write_b128 v248, v[92:95]
  v_xor_b32_e64 v248, 16, v248
  v_cvt_pk_f16_f32 v96, v192, v193
  v_cvt_pk_f16_f32 v97, v194, v195
  v_cvt_pk_f16_f32 v98, v196, v197
  v_cvt_pk_f16_f32 v99, v198, v199
  ds_write_b128 v248, v[96:99]
  v_cvt_pk_f16_f32 v100, v200, v201
  v_cvt_pk_f16_f32 v101, v202, v203
  v_cvt_pk_f16_f32 v102, v204, v205
  v_cvt_pk_f16_f32 v103, v206, v207
  ds_write_b128 v249, v[100:103]
  v_xor_b32_e64 v249, 16, v249
  v_cvt_pk_f16_f32 v104, v208, v209
  v_cvt_pk_f16_f32 v105, v210, v211
  v_cvt_pk_f16_f32 v106, v212, v213
  v_cvt_pk_f16_f32 v107, v214, v215
  ds_write_b128 v249, v[104:107]
  v_readlane_b32 s0, v250, 0
  v_readlane_b32 s1, v250, 26
  s_sub_u32 s75, 0x7f000000, s0
  s_sub_u32 s1, 0x7f000000, s1
  s_sub_u32 s74, 254, s74
  s_lshl_b32 s74, s74, 23
  s_mov_b32 s92, 0x88888888
  s_mov_b32 s93, 0x88888888
  s_mul_i32 s68, s3, 384
  v_lshrrev_b32 v29, 2, v0
  v_mul_u32_u24 v29, 24, v29
  v_add_u32 v29, s68, v29
  v_and_b32 v30, 3, v0
  v_lshlrev_b32 v30, 3, v30
  ds_read_b64 v[120:121], v29 offset:2048
  ds_read_b64 v[122:123], v29 offset:2056
  ds_read_b64 v[124:125], v29 offset:2064
  buffer_load_dwordx4 v[16:19], v6, s[28:31], s94 offen
  s_add_u32 s94, s94, 416
  buffer_load_dwordx4 v[216:219], v6, s[28:31], s94 offen
  s_add_u32 s94, s94, 416
  s_waitcnt vmcnt(3)
  v_lshlrev_b32 v3, 7, v3
  buffer_load_dword v15, v3, s[32:35], 0 offen
  buffer_load_dword v3, v13, s[28:31], s77 offen
  s_cmp_eq_u32 s77, s73
  s_cselect_b32 s73, 0x7000000, s73
  s_cselect_b32 s77, 0x7000000, s77
  s_add_u32 s77, s77, 24
  s_min_u32 s77, s77, s73
  s_waitcnt lgkmcnt(2)
  v_xor_b32 v120, v120, v30
  v_xor_b32 v126, 32, v120
  v_xor_b32 v121, v121, v30
  v_xor_b32 v127, 32, v121
  s_waitcnt lgkmcnt(1)
  v_xor_b32 v122, v122, v30
  v_xor_b32 v128, 32, v122
  v_xor_b32 v123, v123, v30
  v_xor_b32 v129, 32, v123
  s_waitcnt lgkmcnt(0)
  v_xor_b32 v124, v124, v30
  v_xor_b32 v130, 32, v124
  v_xor_b32 v125, v125, v30
  v_xor_b32 v131, 32, v125
  s_waitcnt lgkmcnt(0)
  s_barrier
  ds_read_b64_tr_b16 v[60:61], v120 offset:0
  ds_read_b64_tr_b16 v[62:63], v121 offset:0
  ds_read_b64_tr_b16 v[64:65], v126 offset:0
  ds_read_b64_tr_b16 v[66:67], v127 offset:0
  ds_read_b64_tr_b16 v[68:69], v120 offset:43328
  ds_read_b64_tr_b16 v[70:71], v121 offset:43328
  ds_read_b64_tr_b16 v[72:73], v126 offset:43328
  ds_read_b64_tr_b16 v[74:75], v127 offset:43328
  ds_read_b64_tr_b16 v[76:77], v122 offset:0
  ds_read_b64_tr_b16 v[78:79], v123 offset:0
  ds_read_b64_tr_b16 v[80:81], v128 offset:0
  ds_read_b64_tr_b16 v[82:83], v129 offset:0
  ds_read_b64_tr_b16 v[84:85], v122 offset:43328
  ds_read_b64_tr_b16 v[86:87], v123 offset:43328
  ds_read_b64_tr_b16 v[88:89], v128 offset:43328
  ds_read_b64_tr_b16 v[90:91], v129 offset:43328
  s_cmp_ge_u32 s3, 6
  s_cbranch_scc1 L_lin
  ds_read_b64_tr_b16 v[92:93], v124 offset:0
  ds_read_b64_tr_b16 v[94:95], v125 offset:0
  ds_read_b64_tr_b16 v[96:97], v130 offset:0
  ds_read_b64_tr_b16 v[98:99], v131 offset:0
  ds_read_b64_tr_b16 v[100:101], v124 offset:43328
  ds_read_b64_tr_b16 v[102:103], v125 offset:43328
  ds_read_b64_tr_b16 v[104:105], v130 offset:43328
  ds_read_b64_tr_b16 v[106:107], v131 offset:43328
  s_waitcnt lgkmcnt(6)
  v_pk_add_f16 v92, v92, v94
  v_pk_add_f16 v93, v93, v95
  ds_write_b64 v59, v[92:93] offset:30720
  s_waitcnt lgkmcnt(5)
  v_pk_add_f16 v96, v96, v98
  v_pk_add_f16 v97, v97, v99
  s_waitcnt lgkmcnt(3)
  v_pk_add_f16 v100, v100, v102
  v_pk_add_f16 v101, v101, v103
  ds_write_b64 v59, v[100:101] offset:32768
  s_waitcnt lgkmcnt(2)
  v_pk_add_f16 v104, v104, v106
  v_pk_add_f16 v105, v105, v107
  v_cndmask_b32 v96, v96, v104, s[92:93]
  v_cndmask_b32 v97, v97, v105, s[92:93]
  ds_write_b64 v59, v[96:97] offset:31744
  ds_write_b32 v230, v104 offset:3072
  ds_write_b32 v230, v105 offset:3088
  s_branch L_p2
L_lin:
  s_and_b32 s98, s3, 1
  s_cselect_b64 vcc, -1, 0
  s_lshl_b32 s99, s98, 5
  v_mov_b32 v31, 0
  v_xor_b32 v236, s99, v236
  v_xor_b32 v237, s99, v237
  v_cndmask_b32 v238, v238, v239, vcc
  ds_read_b64_tr_b16 v[92:93], v236
  ds_read_b64_tr_b16 v[94:95], v237
  ds_read_u16_d16_hi v31, v238
  s_lshl_b32 s98, s98, 10
  v_add_u32 v29, s98, v1
  s_waitcnt lgkmcnt(2)
  v_cvt_f32_f16 v96, v92
  v_cvt_f32_f16_sdwa v97, v92 dst_sel:DWORD dst_unused:UNUSED_PAD src0_sel:WORD_1
  v_mul_f32 v96, s1, v96
  v_mul_f32 v97, s1, v97
  v_mul_f32 v96, s0, v96
  v_mul_f32 v97, s0, v97
  v_cvt_pk_bf16_f32 v92, v96, v97
  v_cvt_f32_f16 v98, v93
  v_cvt_f32_f16_sdwa v99, v93 dst_sel:DWORD dst_unused:UNUSED_PAD src0_sel:WORD_1
  v_mul_f32 v98, s1, v98
  v_mul_f32 v99, s1, v99
  v_mul_f32 v98, s0, v98
  v_mul_f32 v99, s0, v99
  v_cvt_pk_bf16_f32 v93, v98, v99
  s_waitcnt lgkmcnt(1)
  v_cvt_f32_f16 v100, v94
  v_cvt_f32_f16_sdwa v101, v94 dst_sel:DWORD dst_unused:UNUSED_PAD src0_sel:WORD_1
  v_mul_f32 v100, s1, v100
  v_mul_f32 v101, s1, v101
  v_mul_f32 v100, s0, v100
  v_mul_f32 v101, s0, v101
  v_cvt_pk_bf16_f32 v94, v100, v101
  v_cvt_f32_f16 v102, v95
  v_cvt_f32_f16_sdwa v103, v95 dst_sel:DWORD dst_unused:UNUSED_PAD src0_sel:WORD_1
  v_mul_f32 v102, s1, v102
  v_mul_f32 v103, s1, v103
  s_mov_b32 exec_lo, 0
  s_mov_b32 exec_hi, 0xffff
  s_waitcnt lgkmcnt(0)
  v_mov_b32 v102, v31
  s_mov_b64 exec, -1
  v_mul_f32 v102, s0, v102
  v_mul_f32 v103, s0, v103
  v_cvt_pk_bf16_f32 v95, v102, v103
  ds_write_b128 v29, v[92:95] offset:39936
L_p2:
  v_pk_add_f16 v76, v76, v78
  v_pk_add_f16 v77, v77, v79
  ds_write_b64 v59, v[76:77] offset:18432
  v_pk_add_f16 v80, v80, v82
  v_pk_add_f16 v81, v81, v83
  v_pk_add_f16 v84, v84, v86
  v_pk_add_f16 v85, v85, v87
  ds_write_b64 v59, v[84:85] offset:20480
  v_pk_add_f16 v88, v88, v90
  v_pk_add_f16 v89, v89, v91
  v_cndmask_b32 v80, v80, v88, s[92:93]
  v_cndmask_b32 v81, v81, v89, s[92:93]
  ds_write_b64 v59, v[80:81] offset:19456
  ds_write_b32 v230, v88 offset:1024
  ds_write_b32 v230, v89 offset:1040
  v_pk_add_f16 v60, v60, v62
  v_pk_add_f16 v61, v61, v63
  ds_write_b64 v59, v[60:61] offset:6144
  v_pk_add_f16 v64, v64, v66
  v_pk_add_f16 v65, v65, v67
  v_pk_add_f16 v68, v68, v70
  v_pk_add_f16 v69, v69, v71
  ds_write_b64 v59, v[68:69] offset:8192
  v_pk_add_f16 v72, v72, v74
  v_pk_add_f16 v73, v73, v75
  v_cndmask_b32 v64, v64, v72, s[92:93]
  v_cndmask_b32 v65, v65, v73, s[92:93]
  ds_write_b64 v59, v[64:65] offset:7168
  s_cmp_lt_u32 s3, 2
  s_cbranch_scc1 L_p2d
  v_subrev_u32 v230, 1024, v230
  ds_write_b32 v230, v72 offset:0
  ds_write_b32 v230, v73 offset:16
  s_branch L_built
L_p2d:
  ds_write_b64 v231, v[72:73] offset:5120
L_built:
  s_mov_b32 s0, s74
  s_mov_b32 s1, s75
  s_mov_b32 s96, 0x3e000000
  s_mov_b32 s97, 0x43000000
  s_mov_b32 s51, 1
  s_mul_i32 s98, s3, 1536
  s_add_u32 s98, s98, 1165312
  s_mov_b32 s48, -1048576
  s_cmp_lg_u32 s84, 0
  s_cbranch_scc1 L_g1c
  s_sub_u32 s94, s94, 416
  ds_read_u16_d16_hi v32, v10 offset:0
  ds_read_u16_d16_hi v33, v10 offset:2
  ds_read_u16_d16_hi v34, v10 offset:2112
  ds_read_u16_d16_hi v35, v10 offset:2114
  ds_read_u16_d16_hi v36, v10 offset:128
  ds_read_u16_d16_hi v37, v10 offset:130
  ds_read_u16_d16_hi v38, v10 offset:2240
  ds_read_u16_d16_hi v39, v10 offset:2242
  ds_read_u16_d16_hi v40, v10 offset:256
  ds_read_u16_d16_hi v41, v10 offset:258
  ds_read_u16_d16_hi v42, v10 offset:2368
  ds_read_u16_d16_hi v43, v10 offset:2370
  ds_read_u16_d16_hi v44, v10 offset:384
  ds_read_u16_d16_hi v45, v10 offset:386
  ds_read_u16_d16_hi v46, v10 offset:2496
  ds_read_u16_d16_hi v47, v10 offset:2498
  ds_read_u16_d16_hi v48, v10 offset:512
  ds_read_u16_d16_hi v49, v10 offset:514
  ds_read_u16_d16_hi v50, v10 offset:2624
  ds_read_u16_d16_hi v51, v10 offset:2626
  ds_read_u16_d16_hi v52, v10 offset:640
  ds_read_u16_d16_hi v53, v10 offset:642
  ds_read_u16_d16_hi v54, v10 offset:2752
  ds_read_u16_d16_hi v55, v10 offset:2754
  ds_read_u16_d16_hi v56, v10 offset:768
  ds_read_u16_d16_hi v57, v10 offset:770
  s_waitcnt lgkmcnt(14)
  v_max3_f32 v58, |v32|, |v33|, 0
  v_cvt_pk_f16_f32 v184, v32, v33
  v_max3_f32 v58, |v34|, |v35|, v58
  v_cvt_pk_f16_f32 v185, v34, v35
  v_max3_f32 v58, |v36|, |v37|, v58
  v_cvt_pk_f16_f32 v186, v36, v37
  v_max3_f32 v58, |v38|, |v39|, v58
  v_cvt_pk_f16_f32 v187, v38, v39
  v_max3_f32 v58, |v40|, |v41|, v58
  v_cvt_pk_f16_f32 v188, v40, v41
  v_max3_f32 v58, |v42|, |v43|, v58
  v_cvt_pk_f16_f32 v189, v42, v43
  s_waitcnt lgkmcnt(12)
  v_max3_f32 v58, |v44|, |v45|, v58
  v_cvt_pk_f16_f32 v190, v44, v45
  s_waitcnt lgkmcnt(10)
  v_max3_f32 v58, |v46|, |v47|, v58
  v_cvt_pk_f16_f32 v191, v46, v47
  s_waitcnt lgkmcnt(8)
  v_max3_f32 v58, |v48|, |v49|, v58
  v_cvt_pk_f16_f32 v192, v48, v49
  s_waitcnt lgkmcnt(6)
  v_max3_f32 v58, |v50|, |v51|, v58
  v_cvt_pk_f16_f32 v193, v50, v51
  s_waitcnt lgkmcnt(4)
  v_max3_f32 v58, |v52|, |v53|, v58
  v_cvt_pk_f16_f32 v194, v52, v53
  s_waitcnt lgkmcnt(2)
  v_max3_f32 v58, |v54|, |v55|, v58
  v_cvt_pk_f16_f32 v195, v54, v55
  s_waitcnt lgkmcnt(0)
  v_max3_f32 v58, |v56|, |v57|, v58
  v_cvt_pk_f16_f32 v196, v56, v57
  s_waitcnt lgkmcnt(0)
  s_barrier
  s_branch L_cin_go
L_g1c:
  s_waitcnt lgkmcnt(0)
  s_barrier
  s_add_u32 s76, s76, -63168
  s_waitcnt vmcnt(3)
  v_lshl_add_u32 v16, v16, 7, v8
  v_lshl_add_u32 v17, v17, 7, v8
  v_lshl_add_u32 v18, v18, 7, v8
  v_lshl_add_u32 v19, v19, 7, v8
  s_add_u32 m0, s76, 0
  s_mov_b32 exec_hi, 0xffffff
  buffer_load_dwordx4 v16, s[32:35], 0 offen lds
  s_add_u32 m0, s76, 1056
  s_nop 0
  buffer_load_dwordx4 v17, s[32:35], 0 offen lds
  s_add_u32 m0, s76, 2112
  s_mov_b32 exec_hi, 0xffff
  buffer_load_dwordx4 v18, s[32:35], 0 offen lds
  s_add_u32 m0, s76, 3168
  s_nop 0
  buffer_load_dwordx4 v19, s[32:35], 0 offen lds
  s_mov_b32 exec_hi, -1
  s_waitcnt vmcnt(6)
  v_lshl_add_u32 v216, v216, 7, v8
  v_lshl_add_u32 v217, v217, 7, v8
  v_lshl_add_u32 v218, v218, 7, v8
  v_lshl_add_u32 v219, v219, 7, v8
  s_add_u32 m0, s76, 16256
  s_mov_b32 exec_hi, 0xffffff
  buffer_load_dwordx4 v216, s[32:35], 0 offen lds
  s_add_u32 m0, s76, 17312
  s_nop 0
  buffer_load_dwordx4 v217, s[32:35], 0 offen lds
  s_add_u32 m0, s76, 18368
  s_mov_b32 exec_hi, 0xffff
  buffer_load_dwordx4 v218, s[32:35], 0 offen lds
  s_add_u32 m0, s76, 19424
  s_nop 0
  buffer_load_dwordx4 v219, s[32:35], 0 offen lds
  s_mov_b32 exec_hi, -1
  buffer_load_dwordx4 v[16:19], v6, s[28:31], s94 offen
  s_add_u32 s94, s94, 416
  s_waitcnt vmcnt(9)
  v_lshlrev_b32_e64 v3, 7, v3
  buffer_load_dword v15, v3, s[32:35], 0 offen
  buffer_load_dword v3, v13, s[28:31], s77 offen
  s_cmp_eq_u32 s77, s73
  s_cselect_b32 s73, 0x7000000, s73
  s_cselect_b32 s77, 0x7000000, s77
  s_add_u32 s77, s77, 24
  s_min_u32 s77, s77, s73
  buffer_load_dword v14, v12, s[44:47], s101 offen
  s_add_u32 s101, s101, 1144832
  v_add_u32 v10, -63168, v10
  v_add_u32 v4, -63168, v4
  v_add_u32 v5, -63168, v5
  ds_write_b32 v10, v7 offset:2880
  ds_write_b32 v10, v7 offset:19136
  s_cmp_lg_u32 s3, 4
  s_cbranch_scc1 L_g1d
  s_mov_b32 s60, s24
  s_and_b32 s61, s25, 0xffff
  s_mov_b32 s62, 268435456
  s_mov_b32 s63, 0x20000
  s_mov_b32 s56, s20
  s_and_b32 s57, s21, 0xffff
  s_mov_b32 s58, 8192
  s_mov_b32 s59, 0x20000
  s_mov_b32 s64, s22
  s_and_b32 s65, s23, 0xffff
  s_mov_b32 s66, 256
  s_mov_b32 s67, 0x20000
  s_load_dword s80, s[18:19], 0
  v_mov_b32 v248, 0
  s_mov_b64 exec, 1
  s_mov_b32 s81, 0x80000
  buffer_load_dword v249, v248, s[60:63], s81 offen
  buffer_load_dword v250, v248, s[56:59], 0 offen
  s_mov_b64 exec, -1
  s_mov_b64 exec, 1
  buffer_load_dword v59, v248, s[64:67], 0 offen offset:240 sc1
  s_mov_b64 exec, -1
  s_mov_b32 s52, s16
  s_and_b32 s53, s17, 0xffff
  s_mov_b32 s54, 3328
  s_mov_b32 s55, 0x20000
  v_lshlrev_b32_e64 v248, 7, v0
  buffer_load_dword v251, v248, s[52:55], 0 offen
L_g1d:
  s_waitcnt vmcnt(8)
  ds_read_u16_d16_hi v32, v10 offset:0
  ds_read_u16_d16_hi v33, v10 offset:2
  ds_read_u16_d16_hi v34, v10 offset:2112
  ds_read_u16_d16_hi v35, v10 offset:2114
  ds_read_u16_d16_hi v36, v10 offset:128
  ds_read_u16_d16_hi v37, v10 offset:130
  ds_read_u16_d16_hi v38, v10 offset:2240
  ds_read_u16_d16_hi v39, v10 offset:2242
  ds_read_u16_d16_hi v40, v10 offset:256
  ds_read_u16_d16_hi v41, v10 offset:258
  ds_read_u16_d16_hi v42, v10 offset:2368
  ds_read_u16_d16_hi v43, v10 offset:2370
  ds_read_u16_d16_hi v44, v10 offset:384
  ds_read_u16_d16_hi v45, v10 offset:386
  ds_read_u16_d16_hi v46, v10 offset:2496
  ds_read_u16_d16_hi v47, v10 offset:2498
  ds_read_u16_d16_hi v48, v10 offset:512
  ds_read_u16_d16_hi v49, v10 offset:514
  ds_read_u16_d16_hi v50, v10 offset:2624
  ds_read_u16_d16_hi v51, v10 offset:2626
  ds_read_u16_d16_hi v52, v10 offset:640
  ds_read_u16_d16_hi v53, v10 offset:642
  ds_read_u16_d16_hi v54, v10 offset:2752
  ds_read_u16_d16_hi v55, v10 offset:2754
  ds_read_u16_d16_hi v56, v10 offset:768
  ds_read_u16_d16_hi v57, v10 offset:770
  s_waitcnt lgkmcnt(0)
  v_max3_f32 v58, |v32|, |v33|, 0
  v_cvt_pk_f16_f32 v184, v32, v33
  v_max3_f32 v58, |v34|, |v35|, v58
  v_cvt_pk_f16_f32 v185, v34, v35
  v_max3_f32 v58, |v36|, |v37|, v58
  v_cvt_pk_f16_f32 v186, v36, v37
  v_max3_f32 v58, |v38|, |v39|, v58
  v_cvt_pk_f16_f32 v187, v38, v39
  v_max3_f32 v58, |v40|, |v41|, v58
  v_cvt_pk_f16_f32 v188, v40, v41
  v_max3_f32 v58, |v42|, |v43|, v58
  v_cvt_pk_f16_f32 v189, v42, v43
  s_waitcnt lgkmcnt(12)
  v_max3_f32 v58, |v44|, |v45|, v58
  v_cvt_pk_f16_f32 v190, v44, v45
  s_waitcnt lgkmcnt(10)
  v_max3_f32 v58, |v46|, |v47|, v58
  v_cvt_pk_f16_f32 v191, v46, v47
  s_waitcnt lgkmcnt(8)
  v_max3_f32 v58, |v48|, |v49|, v58
  v_cvt_pk_f16_f32 v192, v48, v49
  s_waitcnt lgkmcnt(6)
  v_max3_f32 v58, |v50|, |v51|, v58
  v_cvt_pk_f16_f32 v193, v50, v51
  s_waitcnt lgkmcnt(4)
  v_max3_f32 v58, |v52|, |v53|, v58
  v_cvt_pk_f16_f32 v194, v52, v53
  s_waitcnt lgkmcnt(2)
  v_max3_f32 v58, |v54|, |v55|, v58
  v_cvt_pk_f16_f32 v195, v54, v55
  s_waitcnt lgkmcnt(0)
  v_max3_f32 v58, |v56|, |v57|, v58
  v_cvt_pk_f16_f32 v196, v56, v57
L_cin_go:
  ds_write_b32 v11, v184 offset:0
  ds_write_b32 v11, v185 offset:160
  ds_write_b32 v11, v186 offset:320
  ds_write_b32 v11, v187 offset:480
  ds_write_b32 v11, v188 offset:640
  ds_write_b32 v11, v189 offset:800
  ds_write_b32 v11, v190 offset:960
  ds_write_b32 v11, v191 offset:1120
  ds_write_b32 v11, v192 offset:1280
  ds_write_b32 v11, v193 offset:1440
  ds_write_b32 v11, v194 offset:1600
  ds_write_b32 v11, v195 offset:1760
  ds_write_b32 v11, v196 offset:1920
  s_mov_b32 s81, 16256
  s_add_u32 s76, s76, 16256
  v_lshlrev_b32 v7, 2, v0
  v_add_u32 v7, s98, v7
L_cin_loop:
  v_cmp_le_f32 s[90:91], s97, v58
  v_cmp_le_f32 vcc, s96, v58
  s_mov_b32 s49, s74
  s_mov_b32 s50, s75
  s_cmp_lg_u64 s[90:91], 0
  s_cbranch_scc1 L_cslow
  s_cbranch_vccz L_cslow
L_cconv:
  ds_read_b64_tr_b16 v[60:61], v20 offset:0
  v_mul_f32 v116, v184, v192
  v_mul_f32 v117, v185, v193
  ds_read_b64_tr_b16 v[74:75], v20 offset:32
  v_mul_f32_e64 v118, v186, v194
  ds_read_b64_tr_b16 v[88:89], v20 offset:64
  v_mul_f32 v119, v187, v195
  ds_read_b64_tr_b16 v[102:103], v20 offset:96
  v_fmac_f32 v116, v188, v191
  ds_read_b64_tr_b16 v[66:67], v23 offset:0
  v_fmac_f32 v117, v200, v208
  ds_read_b64_tr_b16 v[80:81], v23 offset:32
  v_fmac_f32 v118, v201, v209
  ds_read_b64_tr_b16 v[94:95], v23 offset:64
  v_fmac_f32_e64 v119, v202, v210
  ds_read_b64_tr_b16 v[108:109], v23 offset:96
  v_fmac_f32 v116, v203, v211
  ds_read_b64_tr_b16 v[68:69], v24 offset:0
  v_fmac_f32 v117, v204, v207
  ds_read_b64_tr_b16 v[82:83], v24 offset:32
  s_waitcnt vmcnt(2)
  v_fmac_f32 v118, v216, v224
  ds_read_b64_tr_b16 v[96:97], v24 offset:64
  v_fmac_f32 v119, v217, v225
  v_fmac_f32 v116, v218, v226
  ds_read_b64_tr_b16 v[110:111], v24 offset:96
  v_fmac_f32 v117, v219, v227
  ds_read_b64_tr_b16 v[124:125], v4 offset:0
  v_fmac_f32 v118, v220, v223
  ds_read_b64_tr_b16 v[126:127], v5 offset:0
  v_fmac_f32 v119, v232, v240
  ds_read_b64_tr_b16 v[136:137], v4 offset:32
  v_fmac_f32 v116, v233, v241
  ds_read_b64_tr_b16 v[138:139], v5 offset:32
  v_fmac_f32 v117, v234, v242
  ds_read_b64_tr_b16 v[148:149], v4 offset:64
  v_fmac_f32 v118, v235, v243
  ds_read_b64_tr_b16 v[150:151], v5 offset:64
  v_fmac_f32 v119, v236, v239
  ds_read_b64_tr_b16 v[160:161], v4 offset:96
  v_fmac_f32 v116, v189, v196
  ds_read_b64_tr_b16 v[162:163], v5 offset:96
  v_fmac_f32 v117, v189, v197
  ds_read_b128 v[164:167], v1 offset:39936
  v_fmac_f32 v118, v190, v198
  v_fmac_f32 v119, v190, v199
  ds_read_b128 v[168:171], v1 offset:40960
  v_fmac_f32 v116, v205, v212
  ds_read_b128 v[172:175], v1 offset:8192
  v_fmac_f32 v117, v205, v213
  ds_read_b128 v[176:179], v1 offset:6144
  v_fmac_f32 v118, v206, v214
  ds_read_b64_tr_b16 v[70:71], v25 offset:0
  v_fmac_f32 v119, v206, v215
  ds_read_b64_tr_b16 v[84:85], v25 offset:32
  v_fmac_f32 v116, v221, v228
  ds_read_b64_tr_b16 v[98:99], v25 offset:64
  v_fmac_f32_e64 v117, v221, v229
  ds_read_b64_tr_b16 v[112:113], v25 offset:96
  v_fmac_f32 v118, v222, v230
  ds_read_b64_tr_b16 v[72:73], v26 offset:0
  v_fmac_f32 v119, v222, v231
  ds_read_b64_tr_b16 v[86:87], v26 offset:32
  v_fmac_f32 v116, v237, v244
  ds_read_b64_tr_b16 v[100:101], v26 offset:64
  v_fmac_f32 v117, v237, v245
  v_fmac_f32 v118, v238, v246
  ds_read_b64_tr_b16 v[114:115], v26 offset:96
  v_fmac_f32 v119, v238, v247
  ds_read_b64_tr_b16 v[62:63], v21 offset:0
  v_add_f32 v116, v116, v117
  ds_read_b64_tr_b16 v[76:77], v21 offset:32
  v_add_f32 v118, v118, v119
  ds_read_b64_tr_b16 v[90:91], v21 offset:64
  v_add_f32 v116, v116, v118
  ds_read_b64_tr_b16 v[104:105], v21 offset:96
  v_mul_f32 v116, s49, v116
  ds_read_b64_tr_b16 v[64:65], v22 offset:0
  v_mul_f32_e64 v116, s50, v116
  ds_read_b64_tr_b16 v[78:79], v22 offset:32
  ds_write_b32 v7, v116
  ds_read_b64_tr_b16 v[92:93], v22 offset:64
  v_add_u32_e64 v7, s48, v7
  ds_read_b64_tr_b16 v[106:107], v22 offset:96
  s_movk_i32 s48, 256
  s_waitcnt lgkmcnt(14)
  v_pk_mul_f16 v120, v60, v67 op_sel:[0,0] op_sel_hi:[0,1]
  v_pk_mul_f16 v121, v60, v67 op_sel:[1,0] op_sel_hi:[1,1]
  v_pk_mul_f16 v122, v60, v68 op_sel:[0,0] op_sel_hi:[0,1]
  v_pk_mul_f16 v123, v60, v68 op_sel:[1,0] op_sel_hi:[1,1]
  v_pk_mul_f16 v132, v74, v81 op_sel:[0,0] op_sel_hi:[0,1]
  v_pk_mul_f16 v133, v74, v81 op_sel:[1,0] op_sel_hi:[1,1]
  v_pk_mul_f16 v134, v74, v82 op_sel:[0,0] op_sel_hi:[0,1]
  v_pk_mul_f16 v135, v74, v82 op_sel:[1,0] op_sel_hi:[1,1]
  v_pk_mul_f16 v144, v88, v95 op_sel:[0,0] op_sel_hi:[0,1]
  v_pk_mul_f16 v145, v88, v95 op_sel:[1,0] op_sel_hi:[1,1]
  v_pk_mul_f16 v146, v88, v96 op_sel:[0,0] op_sel_hi:[0,1]
  v_pk_mul_f16 v147, v88, v96 op_sel:[1,0] op_sel_hi:[1,1]
  v_pk_mul_f16 v156, v102, v109 op_sel:[0,0] op_sel_hi:[0,1]
  v_pk_mul_f16 v157, v102, v109 op_sel:[1,0] op_sel_hi:[1,1]
  v_pk_mul_f16 v158, v102, v110 op_sel:[0,0] op_sel_hi:[0,1]
  v_pk_mul_f16 v159, v102, v110 op_sel:[1,0] op_sel_hi:[1,1]
  s_cmp_lg_u32 s51, 0
  s_cbranch_scc1 L_novm
  s_waitcnt vmcnt(3)
  v_lshl_add_u32 v16, v16, 7, v8
  v_lshl_add_u32 v17, v17, 7, v8
  v_lshl_add_u32 v18, v18, 7, v8
  v_lshl_add_u32 v19, v19, 7, v8
  s_add_u32 m0, s76, 0
  s_mov_b32 exec_hi, 0xffffff
  buffer_load_dwordx4 v16, s[32:35], 0 offen lds
  s_add_u32 m0, s76, 1056
  s_nop 0
  buffer_load_dwordx4 v17, s[32:35], 0 offen lds
  s_add_u32 m0, s76, 2112
  s_mov_b32 exec_hi, 0xffff
  buffer_load_dwordx4 v18, s[32:35], 0 offen lds
  s_add_u32 m0, s76, 3168
  s_nop 0
  buffer_load_dwordx4 v19, s[32:35], 0 offen lds
  s_mov_b32 exec_hi, -1
  buffer_load_dwordx4 v[16:19], v6, s[28:31], s94 offen
  s_add_u32 s94, s94, 416
  s_waitcnt vmcnt(5)
  v_lshlrev_b32_e64 v3, 7, v3
  buffer_load_dword v15, v3, s[32:35], 0 offen
  buffer_load_dword v3, v13, s[28:31], s77 offen
  s_cmp_eq_u32 s77, s73
  s_cselect_b32 s73, 0x7000000, s73
  s_cselect_b32 s77, 0x7000000, s77
  s_add_u32 s77, s77, 24
  s_min_u32 s77, s77, s73
  s_waitcnt vmcnt(7)
  buffer_load_dword v14, v12, s[44:47], s101 offen
  s_add_u32 s101, s101, 1144832
L_novm:
  v_add_u32 v10, s81, v10
  v_add_u32 v4, s81, v4
  v_add_u32_e64 v5, s81, v5
  s_sub_u32 s76, s76, s81
  s_sub_u32 s81, 0, s81
  s_mov_b32 s51, 0
  s_setprio 1
  v_mfma_f32_16x16x32_bf16 v[184:187], v[164:167], v[124:127], 0
  ds_read_b128 v[180:183], v1 offset:7168
  v_pk_mul_f16 v116, v60, v69 op_sel:[0,0] op_sel_hi:[0,1]
  v_mfma_f32_16x16x32_bf16 v[200:203], v[164:167], v[136:139], 0
  v_pk_mul_f16 v117, v60, v69 op_sel:[1,0] op_sel_hi:[1,1]
  v_mfma_f32_16x16x32_bf16 v[216:219], v[164:167], v[148:151], 0
  v_pk_mul_f16 v118, v60, v70 op_sel:[0,0] op_sel_hi:[0,1]
  v_mfma_f32_16x16x32_bf16 v[232:235], v[164:167], v[160:163], 0
  v_pk_mul_f16 v119, v60, v70 op_sel:[1,0] op_sel_hi:[1,1]
  v_mfma_f32_16x16x32_bf16 v[188:191], v[168:171], v[124:127], 0
  ds_read_b128 v[164:167], v1 offset:5120
  v_pk_mul_f16 v128, v74, v83 op_sel:[0,0] op_sel_hi:[0,1]
  v_mfma_f32_16x16x32_bf16 v[204:207], v[168:171], v[136:139], 0
  v_pk_mul_f16 v129, v74, v83 op_sel:[1,0] op_sel_hi:[1,1]
  v_mfma_f32_16x16x32_bf16 v[220:223], v[168:171], v[148:151], 0
  v_pk_mul_f16 v130, v74, v84 op_sel:[0,0] op_sel_hi:[0,1]
  v_mfma_f32_16x16x32_bf16 v[236:239], v[168:171], v[160:163], 0
  v_pk_mul_f16 v131, v74, v84 op_sel:[1,0] op_sel_hi:[1,1]
  v_mfma_f32_16x16x32_f16 v[192:195], v[172:175], v[120:123], 0
  ds_read_b128 v[168:171], v1 offset:11264
  v_pk_mul_f16 v140, v88, v97 op_sel:[0,0] op_sel_hi:[0,1]
  v_mfma_f32_16x16x32_f16 v[208:211], v[172:175], v[132:135], 0
  v_pk_mul_f16 v141, v88, v97 op_sel:[1,0] op_sel_hi:[1,1]
  v_mfma_f32_16x16x32_f16 v[224:227], v[172:175], v[144:147], 0
  v_pk_mul_f16 v142, v88, v98 op_sel:[0,0] op_sel_hi:[0,1]
  v_mfma_f32_16x16x32_f16 v[240:243], v[172:175], v[156:159], 0
  v_pk_mul_f16 v143, v88, v98 op_sel:[1,0] op_sel_hi:[1,1]
  v_mfma_f32_16x16x32_f16 v[184:187], v[176:179], v[120:123], v[184:187]
  ds_read_b128 v[172:175], v1 offset:9216
  v_pk_mul_f16 v152, v102, v111 op_sel:[0,0] op_sel_hi:[0,1]
  v_mfma_f32_16x16x32_f16 v[200:203], v[176:179], v[132:135], v[200:203]
  v_pk_mul_f16 v153, v102, v111 op_sel:[1,0] op_sel_hi:[1,1]
  v_mfma_f32_16x16x32_f16 v[216:219], v[176:179], v[144:147], v[216:219]
  s_setprio 2
  s_waitcnt lgkmcnt(14)
  v_pk_mul_f16 v154, v102, v112 op_sel:[0,0] op_sel_hi:[0,1]
  v_mfma_f32_16x16x32_f16 v[232:235], v[176:179], v[156:159], v[232:235]
  s_waitcnt lgkmcnt(3)
  v_pk_mul_f16 v155, v102, v112 op_sel:[1,0] op_sel_hi:[1,1]
  v_mfma_f32_16x16x32_f16 v[188:191], v[180:183], v[120:123], v[188:191]
  ds_read_b128 v[176:179], v1 offset:10240
  v_pk_mul_f16 v124, v61, v68 op_sel:[0,0] op_sel_hi:[0,1]
  v_mfma_f32_16x16x32_f16 v[204:207], v[180:183], v[132:135], v[204:207]
  s_nop 0
  v_pk_mul_f16 v125, v61, v68 op_sel:[1,0] op_sel_hi:[1,1]
  v_mfma_f32_16x16x32_f16 v[220:223], v[180:183], v[144:147], v[220:223]
  v_pk_mul_f16 v126, v61, v69 op_sel:[0,0] op_sel_hi:[0,1]
  v_mfma_f32_16x16x32_f16 v[236:239], v[180:183], v[156:159], v[236:239]
  s_nop 0
  s_waitcnt lgkmcnt(3)
  v_pk_mul_f16 v127, v61, v69 op_sel:[1,0] op_sel_hi:[1,1]
  v_mfma_f32_16x16x32_f16 v[196:199], v[164:167], v[120:123], 0
  ds_read_b128 v[180:183], v1 offset:14336
  v_pk_mul_f16 v136, v75, v82 op_sel:[0,0] op_sel_hi:[0,1]
  v_mfma_f32_16x16x32_f16 v[212:215], v[164:167], v[132:135], 0
  v_pk_mul_f16 v120, v60, v71 op_sel:[0,0] op_sel_hi:[0,1]
  v_mfma_f32_16x16x32_f16 v[228:231], v[164:167], v[144:147], 0
  v_pk_mul_f16 v121, v60, v71 op_sel:[1,0] op_sel_hi:[1,1]
  v_mfma_f32_16x16x32_f16 v[244:247], v[164:167], v[156:159], 0
  s_nop 0
  s_waitcnt lgkmcnt(3)
  v_pk_mul_f16 v122, v60, v66 op_sel:[0,1] op_sel_hi:[0,0]
  v_mfma_f32_16x16x32_f16 v[192:195], v[168:171], v[116:119], v[192:195]
  ds_read_b128 v[164:167], v1 offset:12288
  v_pk_mul_f16 v123, v60, v72 op_sel:[0,0] op_sel_hi:[1,0]
  v_mfma_f32_16x16x32_f16 v[208:211], v[168:171], v[128:131], v[208:211]
  v_pk_mul_f16 v132, v74, v85 op_sel:[0,0] op_sel_hi:[0,1]
  v_mfma_f32_16x16x32_f16 v[224:227], v[168:171], v[140:143], v[224:227]
  v_pk_mul_f16 v133, v74, v85 op_sel:[1,0] op_sel_hi:[1,1]
  v_mfma_f32_16x16x32_f16 v[240:243], v[168:171], v[152:155], v[240:243]
  s_waitcnt lgkmcnt(3)
  v_pk_mul_f16 v134, v74, v80 op_sel:[0,1] op_sel_hi:[0,0]
  v_mfma_f32_16x16x32_f16 v[184:187], v[172:175], v[116:119], v[184:187]
  ds_read_b128 v[168:171], v1 offset:13312
  v_pk_mul_f16 v135, v74, v86 op_sel:[0,0] op_sel_hi:[1,0]
  v_mfma_f32_16x16x32_f16 v[200:203], v[172:175], v[128:131], v[200:203]
  v_pk_mul_f16 v144, v88, v99 op_sel:[0,0] op_sel_hi:[0,1]
  v_mfma_f32_16x16x32_f16 v[216:219], v[172:175], v[140:143], v[216:219]
  s_nop 0
  v_pk_mul_f16 v145, v88, v99 op_sel:[1,0] op_sel_hi:[1,1]
  v_mfma_f32_16x16x32_f16 v[232:235], v[172:175], v[152:155], v[232:235]
  s_waitcnt lgkmcnt(3)
  v_pk_mul_f16 v146, v88, v94 op_sel:[0,1] op_sel_hi:[0,0]
  v_mfma_f32_16x16x32_f16 v[188:191], v[176:179], v[116:119], v[188:191]
  ds_read_b128 v[172:175], v1 offset:0
  v_pk_mul_f16 v147, v88, v100 op_sel:[0,0] op_sel_hi:[1,0]
  v_mfma_f32_16x16x32_f16 v[204:207], v[176:179], v[128:131], v[204:207]
  s_nop 0
  v_pk_mul_f16 v156, v102, v113 op_sel:[0,0] op_sel_hi:[0,1]
  v_mfma_f32_16x16x32_f16 v[220:223], v[176:179], v[140:143], v[220:223]
  v_pk_mul_f16 v157, v102, v113 op_sel:[1,0] op_sel_hi:[1,1]
  v_mfma_f32_16x16x32_f16 v[236:239], v[176:179], v[152:155], v[236:239]
  s_nop 0
  s_waitcnt lgkmcnt(3)
  v_pk_mul_f16 v158, v102, v108 op_sel:[0,1] op_sel_hi:[0,0]
  v_mfma_f32_16x16x32_f16 v[192:195], v[180:183], v[120:123], v[192:195]
  ds_read_b128 v[176:179], v1 offset:17408
  v_pk_mul_f16 v159, v102, v114 op_sel:[0,0] op_sel_hi:[1,0]
  v_mfma_f32_16x16x32_f16 v[208:211], v[180:183], v[132:135], v[208:211]
  v_pk_mul_f16 v137, v75, v82 op_sel:[1,0] op_sel_hi:[1,1]
  v_mfma_f32_16x16x32_f16 v[224:227], v[180:183], v[144:147], v[224:227]
  v_pk_mul_f16 v138, v75, v83 op_sel:[0,0] op_sel_hi:[0,1]
  v_mfma_f32_16x16x32_f16 v[240:243], v[180:183], v[156:159], v[240:243]
  s_nop 0
  s_waitcnt lgkmcnt(3)
  v_pk_mul_f16 v139, v75, v83 op_sel:[1,0] op_sel_hi:[1,1]
  v_mfma_f32_16x16x32_f16 v[184:187], v[164:167], v[120:123], v[184:187]
  ds_read_b128 v[180:183], v1 offset:15360
  v_pk_mul_f16 v148, v89, v96 op_sel:[0,0] op_sel_hi:[0,1]
  v_mfma_f32_16x16x32_f16 v[200:203], v[164:167], v[132:135], v[200:203]
  v_pk_mul_f16 v149, v89, v96 op_sel:[1,0] op_sel_hi:[1,1]
  v_mfma_f32_16x16x32_f16 v[216:219], v[164:167], v[144:147], v[216:219]
  v_pk_mul_f16 v150, v89, v97 op_sel:[0,0] op_sel_hi:[0,1]
  v_mfma_f32_16x16x32_f16 v[232:235], v[164:167], v[156:159], v[232:235]
  s_waitcnt lgkmcnt(3)
  v_pk_mul_f16 v151, v89, v97 op_sel:[1,0] op_sel_hi:[1,1]
  v_mfma_f32_16x16x32_f16 v[188:191], v[168:171], v[120:123], v[188:191]
  ds_read_b128 v[164:167], v1 offset:16384
  v_pk_mul_f16 v160, v103, v110 op_sel:[0,0] op_sel_hi:[0,1]
  v_mfma_f32_16x16x32_f16 v[204:207], v[168:171], v[132:135], v[204:207]
  v_pk_mul_f16 v161, v103, v110 op_sel:[1,0] op_sel_hi:[1,1]
  v_mfma_f32_16x16x32_f16 v[220:223], v[168:171], v[144:147], v[220:223]
  s_nop 0
  v_pk_mul_f16 v162, v103, v111 op_sel:[0,0] op_sel_hi:[0,1]
  v_mfma_f32_16x16x32_f16 v[236:239], v[168:171], v[156:159], v[236:239]
  s_waitcnt lgkmcnt(3)
  v_pk_mul_f16 v163, v103, v111 op_sel:[1,0] op_sel_hi:[1,1]
  v_smfmac_f32_16x16x64_f16 v[196:199], v[172:175], v[116:123], v9
  ds_read_b128 v[168:171], v1 offset:20480
  v_smfmac_f32_16x16x64_f16 v[212:215], v[172:175], v[128:135], v9
  s_nop 0
  v_pk_mul_f16 v120, v61, v70 op_sel:[0,0] op_sel_hi:[0,1]
  v_smfmac_f32_16x16x64_f16 v[228:231], v[172:175], v[140:147], v9
  v_pk_mul_f16 v121, v61, v70 op_sel:[1,0] op_sel_hi:[1,1]
  v_smfmac_f32_16x16x64_f16 v[244:247], v[172:175], v[152:159], v9
  s_nop 0
  s_waitcnt lgkmcnt(3)
  v_pk_mul_f16 v122, v61, v71 op_sel:[0,0] op_sel_hi:[0,1]
  v_mfma_f32_16x16x32_f16 v[192:195], v[176:179], v[124:127], v[192:195]
  ds_read_b128 v[172:175], v1 offset:18432
  v_pk_mul_f16 v123, v61, v71 op_sel:[1,0] op_sel_hi:[1,1]
  v_mfma_f32_16x16x32_f16 v[208:211], v[176:179], v[136:139], v[208:211]
  v_pk_mul_f16 v132, v75, v84 op_sel:[0,0] op_sel_hi:[0,1]
  v_mfma_f32_16x16x32_f16 v[224:227], v[176:179], v[148:151], v[224:227]
  v_pk_mul_f16 v133, v75, v84 op_sel:[1,0] op_sel_hi:[1,1]
  v_mfma_f32_16x16x32_f16 v[240:243], v[176:179], v[160:163], v[240:243]
  s_nop 0
  s_waitcnt lgkmcnt(3)
  v_pk_mul_f16 v134, v75, v85 op_sel:[0,0] op_sel_hi:[0,1]
  v_mfma_f32_16x16x32_f16 v[184:187], v[180:183], v[124:127], v[184:187]
  ds_read_b128 v[176:179], v1 offset:19456
  v_pk_mul_f16 v135, v75, v85 op_sel:[1,0] op_sel_hi:[1,1]
  v_mfma_f32_16x16x32_f16 v[200:203], v[180:183], v[136:139], v[200:203]
  v_pk_mul_f16 v144, v89, v98 op_sel:[0,0] op_sel_hi:[0,1]
  v_mfma_f32_16x16x32_f16 v[216:219], v[180:183], v[148:151], v[216:219]
  v_pk_mul_f16 v145, v89, v98 op_sel:[1,0] op_sel_hi:[1,1]
  v_mfma_f32_16x16x32_f16 v[232:235], v[180:183], v[160:163], v[232:235]
  s_nop 0
  s_waitcnt lgkmcnt(3)
  v_pk_mul_f16 v146, v89, v99 op_sel:[0,0] op_sel_hi:[0,1]
  v_mfma_f32_16x16x32_f16 v[188:191], v[164:167], v[124:127], v[188:191]
  ds_read_b128 v[180:183], v1 offset:1024
  v_pk_mul_f16 v147, v89, v99 op_sel:[1,0] op_sel_hi:[1,1]
  v_mfma_f32_16x16x32_f16 v[204:207], v[164:167], v[136:139], v[204:207]
  s_waitcnt vmcnt(4)
  ds_read_u16_d16_hi v32, v10 offset:0
  v_pk_mul_f16 v156, v103, v112 op_sel:[0,0] op_sel_hi:[0,1]
  v_mfma_f32_16x16x32_f16 v[220:223], v[164:167], v[148:151], v[220:223]
  ds_read_u16_d16_hi v33, v10 offset:2
  v_pk_mul_f16 v157, v103, v112 op_sel:[1,0] op_sel_hi:[1,1]
  v_mfma_f32_16x16x32_f16 v[236:239], v[164:167], v[160:163], v[236:239]
  s_waitcnt lgkmcnt(5)
  v_pk_mul_f16 v158, v103, v113 op_sel:[0,0] op_sel_hi:[0,1]
  v_mfma_f32_16x16x32_f16 v[192:195], v[168:171], v[120:123], v[192:195]
  ds_read_b128 v[164:167], v1 offset:23552
  v_pk_mul_f16 v159, v103, v113 op_sel:[1,0] op_sel_hi:[1,1]
  v_mfma_f32_16x16x32_f16 v[208:211], v[168:171], v[132:135], v[208:211]
  ds_read_u16_d16_hi v34, v10 offset:2112
  v_pk_mul_f16 v116, v61, v67 op_sel:[0,1] op_sel_hi:[0,0]
  v_mfma_f32_16x16x32_f16 v[224:227], v[168:171], v[144:147], v[224:227]
  ds_read_u16_d16_hi v35, v10 offset:2114
  v_pk_mul_f16 v117, v61, v72 op_sel:[0,0] op_sel_hi:[1,0]
  v_mfma_f32_16x16x32_f16 v[240:243], v[168:171], v[156:159], v[240:243]
  s_nop 0
  s_waitcnt lgkmcnt(7)
  v_pk_mul_f16 v118, v62, v69 op_sel:[0,0] op_sel_hi:[0,1]
  v_mfma_f32_16x16x32_f16 v[184:187], v[172:175], v[120:123], v[184:187]
  ds_read_b128 v[168:171], v1 offset:21504
  v_pk_mul_f16 v119, v62, v69 op_sel:[1,0] op_sel_hi:[1,1]
  v_mfma_f32_16x16x32_f16 v[200:203], v[172:175], v[132:135], v[200:203]
  ds_read_b64_tr_b16 v[60:61], v27 offset:0
  v_pk_mul_f16 v128, v75, v81 op_sel:[0,1] op_sel_hi:[0,0]
  v_mfma_f32_16x16x32_f16 v[216:219], v[172:175], v[144:147], v[216:219]
  ds_read_u16_d16_hi v36, v10 offset:128
  v_pk_mul_f16 v129, v75, v86 op_sel:[0,0] op_sel_hi:[1,0]
  v_mfma_f32_16x16x32_f16 v[232:235], v[172:175], v[156:159], v[232:235]
  s_waitcnt lgkmcnt(9)
  v_pk_mul_f16 v130, v76, v83 op_sel:[0,0] op_sel_hi:[0,1]
  v_pk_mul_f16 v131, v76, v83 op_sel:[1,0] op_sel_hi:[1,1]
  v_mfma_f32_16x16x32_f16 v[188:191], v[176:179], v[120:123], v[188:191]
  ds_read_b128 v[172:175], v1 offset:22528
  v_pk_mul_f16 v140, v89, v95 op_sel:[0,1] op_sel_hi:[0,0]
  v_mfma_f32_16x16x32_f16 v[204:207], v[176:179], v[132:135], v[204:207]
  ds_read_b64_tr_b16 v[74:75], v27 offset:32
  v_pk_mul_f16 v141, v89, v100 op_sel:[0,0] op_sel_hi:[1,0]
  v_mfma_f32_16x16x32_f16 v[220:223], v[176:179], v[144:147], v[220:223]
  ds_read_b64_tr_b16 v[88:89], v27 offset:64
  v_pk_mul_f16 v142, v90, v97 op_sel:[0,0] op_sel_hi:[0,1]
  v_mfma_f32_16x16x32_f16 v[236:239], v[176:179], v[156:159], v[236:239]
  s_waitcnt lgkmcnt(11)
  v_pk_mul_f16 v143, v90, v97 op_sel:[1,0] op_sel_hi:[1,1]
  v_pk_mul_f16 v152, v103, v109 op_sel:[0,1] op_sel_hi:[0,0]
  v_smfmac_f32_16x16x64_f16 v[196:199], v[180:183], v[120:127], v9
  ds_read_b128 v[176:179], v1 offset:26624
  v_pk_mul_f16 v153, v103, v114 op_sel:[0,0] op_sel_hi:[1,0]
  v_smfmac_f32_16x16x64_f16 v[212:215], v[180:183], v[132:139], v9
  ds_read_b64_tr_b16 v[102:103], v27 offset:96
  v_pk_mul_f16 v154, v104, v111 op_sel:[0,0] op_sel_hi:[0,1]
  v_smfmac_f32_16x16x64_f16 v[228:231], v[180:183], v[144:151], v9
  ds_read_u16_d16_hi v37, v10 offset:130
  v_pk_mul_f16 v155, v104, v111 op_sel:[1,0] op_sel_hi:[1,1]
  v_smfmac_f32_16x16x64_f16 v[244:247], v[180:183], v[156:163], v9
  s_nop 0
  s_waitcnt lgkmcnt(11)
  v_pk_mul_f16 v120, v62, v70 op_sel:[0,0] op_sel_hi:[0,1]
  v_mfma_f32_16x16x32_f16 v[192:195], v[164:167], v[116:119], v[192:195]
  ds_read_b128 v[180:183], v1 offset:24576
  v_pk_mul_f16 v121, v62, v70 op_sel:[1,0] op_sel_hi:[1,1]
  v_mfma_f32_16x16x32_f16 v[208:211], v[164:167], v[128:131], v[208:211]
  ds_read_u16_d16_hi v38, v10 offset:2240
  v_pk_mul_f16 v122, v62, v71 op_sel:[0,0] op_sel_hi:[0,1]
  v_mfma_f32_16x16x32_f16 v[224:227], v[164:167], v[140:143], v[224:227]
  ds_read_u16_d16_hi v39, v10 offset:2242
  v_pk_mul_f16 v123, v62, v71 op_sel:[1,0] op_sel_hi:[1,1]
  v_mfma_f32_16x16x32_f16 v[240:243], v[164:167], v[152:155], v[240:243]
  s_waitcnt lgkmcnt(11)
  v_pk_mul_f16 v132, v76, v84 op_sel:[0,0] op_sel_hi:[0,1]
  v_max3_f32 v58, |v32|, |v33|, 0
  v_mfma_f32_16x16x32_f16 v[184:187], v[168:171], v[116:119], v[184:187]
  ds_read_b128 v[164:167], v1 offset:25600
  v_pk_mul_f16 v133, v76, v84 op_sel:[1,0] op_sel_hi:[1,1]
  v_mfma_f32_16x16x32_f16 v[200:203], v[168:171], v[128:131], v[200:203]
  ds_read_u16_d16_hi v40, v10 offset:256
  v_pk_mul_f16 v134, v76, v85 op_sel:[0,0] op_sel_hi:[0,1]
  v_mfma_f32_16x16x32_f16 v[216:219], v[168:171], v[140:143], v[216:219]
  ds_read_u16_d16_hi v41, v10 offset:258
  v_pk_mul_f16 v135, v76, v85 op_sel:[1,0] op_sel_hi:[1,1]
  v_mfma_f32_16x16x32_f16 v[232:235], v[168:171], v[152:155], v[232:235]
  s_waitcnt lgkmcnt(11)
  v_pk_mul_f16 v144, v90, v98 op_sel:[0,0] op_sel_hi:[0,1]
  v_max3_f32 v58, |v34|, |v35|, v58
  v_mfma_f32_16x16x32_f16 v[188:191], v[172:175], v[116:119], v[188:191]
  ds_read_b128 v[168:171], v1 offset:2048
  v_pk_mul_f16 v145, v90, v98 op_sel:[1,0] op_sel_hi:[1,1]
  v_mfma_f32_16x16x32_f16 v[204:207], v[172:175], v[128:131], v[204:207]
  ds_read_u16_d16_hi v42, v10 offset:2368
  v_pk_mul_f16 v146, v90, v99 op_sel:[0,0] op_sel_hi:[0,1]
  v_mfma_f32_16x16x32_f16 v[220:223], v[172:175], v[140:143], v[220:223]
  ds_read_u16_d16_hi v43, v10 offset:2370
  v_pk_mul_f16 v147, v90, v99 op_sel:[1,0] op_sel_hi:[1,1]
  v_mfma_f32_16x16x32_f16 v[236:239], v[172:175], v[152:155], v[236:239]
  s_nop 0
  s_waitcnt lgkmcnt(11)
  v_pk_mul_f16 v156, v104, v112 op_sel:[0,0] op_sel_hi:[0,1]
  v_mfma_f32_16x16x32_f16 v[192:195], v[176:179], v[120:123], v[192:195]
  ds_read_b128 v[172:175], v1 offset:29696
  v_pk_mul_f16 v157, v104, v112 op_sel:[1,0] op_sel_hi:[1,1]
  v_mfma_f32_16x16x32_f16 v[208:211], v[176:179], v[132:135], v[208:211]
  ds_read_u16_d16_hi v44, v10 offset:384
  v_pk_mul_f16 v158, v104, v113 op_sel:[0,0] op_sel_hi:[0,1]
  v_mfma_f32_16x16x32_f16 v[224:227], v[176:179], v[144:147], v[224:227]
  ds_read_u16_d16_hi v45, v10 offset:386
  v_pk_mul_f16 v159, v104, v113 op_sel:[1,0] op_sel_hi:[1,1]
  s_nop 1
  v_mfma_f32_16x16x32_f16 v[240:243], v[176:179], v[156:159], v[240:243]
  s_waitcnt lgkmcnt(11)
  v_pk_mul_f16 v124, v62, v68 op_sel:[0,1] op_sel_hi:[0,0]
  v_mfma_f32_16x16x32_f16 v[184:187], v[180:183], v[120:123], v[184:187]
  ds_read_b128 v[176:179], v1 offset:27648
  v_pk_mul_f16 v125, v62, v72 op_sel:[0,0] op_sel_hi:[1,0]
  v_mfma_f32_16x16x32_f16 v[200:203], v[180:183], v[132:135], v[200:203]
  ds_read_u16_d16_hi v46, v10 offset:2496
  v_pk_mul_f16 v126, v63, v70 op_sel:[0,0] op_sel_hi:[0,1]
  v_mfma_f32_16x16x32_f16 v[216:219], v[180:183], v[144:147], v[216:219]
  ds_read_u16_d16_hi v47, v10 offset:2498
  v_pk_mul_f16 v127, v63, v70 op_sel:[1,0] op_sel_hi:[1,1]
  v_mfma_f32_16x16x32_f16 v[232:235], v[180:183], v[156:159], v[232:235]
  s_waitcnt lgkmcnt(11)
  v_pk_mul_f16 v136, v76, v82 op_sel:[0,1] op_sel_hi:[0,0]
  v_pk_mul_f16 v137, v76, v86 op_sel:[0,0] op_sel_hi:[1,0]
  v_mfma_f32_16x16x32_f16 v[188:191], v[164:167], v[120:123], v[188:191]
  ds_read_b128 v[180:183], v1 offset:28672
  v_pk_mul_f16 v138, v77, v84 op_sel:[0,0] op_sel_hi:[0,1]
  v_mfma_f32_16x16x32_f16 v[204:207], v[164:167], v[132:135], v[204:207]
  ds_read_u16_d16_hi v48, v10 offset:512
  v_pk_mul_f16 v139, v77, v84 op_sel:[1,0] op_sel_hi:[1,1]
  v_mfma_f32_16x16x32_f16 v[220:223], v[164:167], v[144:147], v[220:223]
  ds_read_u16_d16_hi v49, v10 offset:514
  v_pk_mul_f16 v148, v90, v96 op_sel:[0,1] op_sel_hi:[0,0]
  v_mfma_f32_16x16x32_f16 v[236:239], v[164:167], v[156:159], v[236:239]
  s_waitcnt lgkmcnt(11)
  v_pk_mul_f16 v149, v90, v100 op_sel:[0,0] op_sel_hi:[1,0]
  v_pk_mul_f16 v150, v91, v98 op_sel:[0,0] op_sel_hi:[0,1]
  v_smfmac_f32_16x16x64_f16 v[196:199], v[168:171], v[116:123], v9
  ds_read_b128 v[164:167], v1 offset:32768
  v_pk_mul_f16 v151, v91, v98 op_sel:[1,0] op_sel_hi:[1,1]
  v_smfmac_f32_16x16x64_f16 v[212:215], v[168:171], v[128:135], v9
  ds_read_u16_d16_hi v50, v10 offset:2624
  v_pk_mul_f16 v160, v104, v110 op_sel:[0,1] op_sel_hi:[0,0]
  v_smfmac_f32_16x16x64_f16 v[228:231], v[168:171], v[140:147], v9
  ds_read_u16_d16_hi v51, v10 offset:2626
  v_pk_mul_f16 v161, v104, v114 op_sel:[0,0] op_sel_hi:[1,0]
  v_smfmac_f32_16x16x64_f16 v[244:247], v[168:171], v[152:159], v9
  s_nop 0
  s_waitcnt lgkmcnt(11)
  v_pk_mul_f16 v162, v105, v112 op_sel:[0,0] op_sel_hi:[0,1]
  v_mfma_f32_16x16x32_f16 v[192:195], v[172:175], v[124:127], v[192:195]
  ds_read_b128 v[168:171], v1 offset:30720
  v_pk_mul_f16 v163, v105, v112 op_sel:[1,0] op_sel_hi:[1,1]
  v_mfma_f32_16x16x32_f16 v[208:211], v[172:175], v[136:139], v[208:211]
  ds_read_u16_d16_hi v52, v10 offset:640
  v_pk_mul_f16 v120, v63, v71 op_sel:[0,0] op_sel_hi:[0,1]
  v_mfma_f32_16x16x32_f16 v[224:227], v[172:175], v[148:151], v[224:227]
  ds_read_u16_d16_hi v53, v10 offset:642
  v_pk_mul_f16 v121, v63, v71 op_sel:[1,0] op_sel_hi:[1,1]
  v_mfma_f32_16x16x32_f16 v[240:243], v[172:175], v[160:163], v[240:243]
  s_waitcnt lgkmcnt(11)
  v_pk_mul_f16 v122, v63, v69 op_sel:[0,1] op_sel_hi:[1,1]
  v_pk_mul_f16 v123, v63, v72 op_sel:[0,0] op_sel_hi:[1,0]
  v_mfma_f32_16x16x32_f16 v[184:187], v[176:179], v[124:127], v[184:187]
  ds_read_b128 v[172:175], v1 offset:31744
  v_pk_mul_f16 v132, v77, v85 op_sel:[0,0] op_sel_hi:[0,1]
  v_mfma_f32_16x16x32_f16 v[200:203], v[176:179], v[136:139], v[200:203]
  ds_read_u16_d16_hi v54, v10 offset:2752
  v_pk_mul_f16 v133, v77, v85 op_sel:[1,0] op_sel_hi:[1,1]
  v_mfma_f32_16x16x32_f16 v[216:219], v[176:179], v[148:151], v[216:219]
  ds_read_u16_d16_hi v55, v10 offset:2754
  v_pk_mul_f16 v134, v77, v83 op_sel:[0,1] op_sel_hi:[1,1]
  v_mfma_f32_16x16x32_f16 v[232:235], v[176:179], v[160:163], v[232:235]
  s_waitcnt lgkmcnt(11)
  v_pk_mul_f16 v135, v77, v86 op_sel:[0,0] op_sel_hi:[1,0]
  v_pk_mul_f16 v144, v91, v99 op_sel:[0,0] op_sel_hi:[0,1]
  v_mfma_f32_16x16x32_f16 v[188:191], v[180:183], v[124:127], v[188:191]
  ds_read_b128 v[176:179], v1 offset:3072
  v_pk_mul_f16 v145, v91, v99 op_sel:[1,0] op_sel_hi:[1,1]
  v_mfma_f32_16x16x32_f16 v[204:207], v[180:183], v[136:139], v[204:207]
  ds_read_u16_d16_hi v56, v10 offset:768
  v_pk_mul_f16 v146, v91, v97 op_sel:[0,1] op_sel_hi:[1,1]
  v_mfma_f32_16x16x32_f16 v[220:223], v[180:183], v[148:151], v[220:223]
  ds_read_u16_d16_hi v57, v10 offset:770
  v_pk_mul_f16 v147, v91, v100 op_sel:[0,0] op_sel_hi:[1,0]
  v_mfma_f32_16x16x32_f16 v[236:239], v[180:183], v[160:163], v[236:239]
  s_waitcnt lgkmcnt(11)
  v_pk_mul_f16 v156, v105, v113 op_sel:[0,0] op_sel_hi:[0,1]
  v_max3_f32 v58, |v36|, |v37|, v58
  v_mfma_f32_16x16x32_f16 v[192:195], v[164:167], v[120:123], v[192:195]
  ds_read_b128 v[180:183], v1 offset:35840
  v_pk_mul_f16 v157, v105, v113 op_sel:[1,0] op_sel_hi:[1,1]
  v_mfma_f32_16x16x32_f16 v[208:211], v[164:167], v[132:135], v[208:211]
  s_nop 0
  v_pk_mul_f16 v158, v105, v111 op_sel:[0,1] op_sel_hi:[1,1]
  v_max3_f32 v58, |v38|, |v39|, v58
  v_mfma_f32_16x16x32_f16 v[224:227], v[164:167], v[144:147], v[224:227]
  v_pk_mul_f16 v159, v105, v114 op_sel:[0,0] op_sel_hi:[1,0]
  v_max3_f32 v58, |v40|, |v41|, v58
  s_nop 0
  v_mfma_f32_16x16x32_f16 v[240:243], v[164:167], v[156:159], v[240:243]
  s_waitcnt lgkmcnt(9)
  v_pk_mul_f16 v116, v64, v71 op_sel:[0,0] op_sel_hi:[0,1]
  v_mfma_f32_16x16x32_f16 v[184:187], v[168:171], v[120:123], v[184:187]
  ds_read_b128 v[164:167], v1 offset:33792
  v_pk_mul_f16 v117, v64, v71 op_sel:[1,0] op_sel_hi:[1,1]
  v_mfma_f32_16x16x32_f16 v[200:203], v[168:171], v[132:135], v[200:203]
  v_pk_mul_f16 v118, v64, v70 op_sel:[0,1] op_sel_hi:[1,1]
  v_max3_f32 v58, |v42|, |v43|, v58
  v_mfma_f32_16x16x32_f16 v[216:219], v[168:171], v[144:147], v[216:219]
  v_pk_mul_f16 v119, v64, v72 op_sel:[0,0] op_sel_hi:[1,0]
  v_pk_mul_f16 v128, v78, v85 op_sel:[0,0] op_sel_hi:[0,1]
  v_mfma_f32_16x16x32_f16 v[232:235], v[168:171], v[156:159], v[232:235]
  s_waitcnt lgkmcnt(7)
  v_pk_mul_f16 v129, v78, v85 op_sel:[1,0] op_sel_hi:[1,1]
  v_pk_mul_f16 v130, v78, v84 op_sel:[0,1] op_sel_hi:[1,1]
  v_mfma_f32_16x16x32_f16 v[188:191], v[172:175], v[120:123], v[188:191]
  ds_read_b128 v[168:171], v1 offset:34816
  v_pk_mul_f16 v131, v78, v86 op_sel:[0,0] op_sel_hi:[1,0]
  v_mfma_f32_16x16x32_f16 v[204:207], v[172:175], v[132:135], v[204:207]
  s_nop 0
  v_pk_mul_f16 v140, v92, v99 op_sel:[0,0] op_sel_hi:[0,1]
  v_pk_mul_f16 v141, v92, v99 op_sel:[1,0] op_sel_hi:[1,1]
  v_mfma_f32_16x16x32_f16 v[220:223], v[172:175], v[144:147], v[220:223]
  v_pk_mul_f16 v142, v92, v98 op_sel:[0,1] op_sel_hi:[1,1]
  v_pk_mul_f16 v143, v92, v100 op_sel:[0,0] op_sel_hi:[1,0]
  v_mfma_f32_16x16x32_f16 v[236:239], v[172:175], v[156:159], v[236:239]
  s_nop 0
  s_waitcnt lgkmcnt(5)
  v_pk_mul_f16 v152, v106, v113 op_sel:[0,0] op_sel_hi:[0,1]
  v_smfmac_f32_16x16x64_f16 v[196:199], v[176:179], v[120:127], v9
  ds_read_b128 v[172:175], v1 offset:38912
  v_pk_mul_f16 v153, v106, v113 op_sel:[1,0] op_sel_hi:[1,1]
  v_smfmac_f32_16x16x64_f16 v[212:215], v[176:179], v[132:139], v9
  v_pk_mul_f16 v154, v106, v112 op_sel:[0,1] op_sel_hi:[1,1]
  v_smfmac_f32_16x16x64_f16 v[228:231], v[176:179], v[144:151], v9
  v_pk_mul_f16 v155, v106, v114 op_sel:[0,0] op_sel_hi:[1,0]
  v_smfmac_f32_16x16x64_f16 v[244:247], v[176:179], v[156:163], v9
  s_nop 0
  s_waitcnt lgkmcnt(3)
  v_pk_mul_f16 v120, v65, v71 op_sel:[0,1] op_sel_hi:[1,1]
  v_mfma_f32_16x16x32_f16 v[192:195], v[180:183], v[116:119], v[192:195]
  ds_read_b128 v[176:179], v1 offset:36864
  v_pk_mul_f16 v121, v65, v72 op_sel:[0,0] op_sel_hi:[1,0]
  v_mfma_f32_16x16x32_f16 v[208:211], v[180:183], v[128:131], v[208:211]
  v_pk_mul_f16 v122, v72, v72 op_sel:[0,0] op_sel_hi:[1,1]
  v_max3_f32 v58, |v44|, |v45|, v58
  v_mfma_f32_16x16x32_f16 v[224:227], v[180:183], v[140:143], v[224:227]
  v_pk_mul_f16 v123, v60, v61 op_sel:[0,0] op_sel_hi:[1,1]
  v_max3_f32 v58, |v46|, |v47|, v58
  v_mfma_f32_16x16x32_f16 v[240:243], v[180:183], v[152:155], v[240:243]
  s_nop 0
  s_waitcnt lgkmcnt(3)
  v_pk_mul_f16 v132, v79, v85 op_sel:[0,1] op_sel_hi:[1,1]
  v_mfma_f32_16x16x32_f16 v[184:187], v[164:167], v[116:119], v[184:187]
  ds_read_b128 v[180:183], v1 offset:37888
  v_pk_mul_f16 v133, v79, v86 op_sel:[0,0] op_sel_hi:[1,0]
  v_mfma_f32_16x16x32_f16 v[200:203], v[164:167], v[128:131], v[200:203]
  v_pk_mul_f16 v134, v86, v86 op_sel:[0,0] op_sel_hi:[1,1]
  v_max3_f32 v58, |v48|, |v49|, v58
  v_mfma_f32_16x16x32_f16 v[216:219], v[164:167], v[140:143], v[216:219]
  v_pk_mul_f16 v135, v74, v75 op_sel:[0,0] op_sel_hi:[1,1]
  v_max3_f32 v58, |v50|, |v51|, v58
  v_mfma_f32_16x16x32_f16 v[232:235], v[164:167], v[152:155], v[232:235]
  s_nop 0
  s_waitcnt lgkmcnt(3)
  v_pk_mul_f16 v144, v93, v99 op_sel:[0,1] op_sel_hi:[1,1]
  v_mfma_f32_16x16x32_f16 v[188:191], v[168:171], v[116:119], v[188:191]
  ds_read_b128 v[164:167], v1 offset:4096
  v_pk_mul_f16 v145, v93, v100 op_sel:[0,0] op_sel_hi:[1,0]
  v_mfma_f32_16x16x32_f16 v[204:207], v[168:171], v[128:131], v[204:207]
  v_pk_mul_f16 v146, v100, v100 op_sel:[0,0] op_sel_hi:[1,1]
  v_max3_f32 v58, |v52|, |v53|, v58
  v_mfma_f32_16x16x32_f16 v[220:223], v[168:171], v[140:143], v[220:223]
  v_pk_mul_f16 v147, v88, v89 op_sel:[0,0] op_sel_hi:[1,1]
  v_max3_f32 v58, |v54|, |v55|, v58
  v_mfma_f32_16x16x32_f16 v[236:239], v[168:171], v[152:155], v[236:239]
  s_waitcnt lgkmcnt(3)
  v_pk_mul_f16 v156, v107, v113 op_sel:[0,1] op_sel_hi:[1,1]
  v_mfma_f32_16x16x32_f16 v[192:195], v[172:175], v[120:123], v[192:195]
  s_nop 0
  v_pk_mul_f16 v157, v107, v114 op_sel:[0,0] op_sel_hi:[1,0]
  v_max3_f32 v58, |v56|, |v57|, v58
  v_mfma_f32_16x16x32_f16 v[208:211], v[172:175], v[132:135], v[208:211]
  v_pk_mul_f16 v158, v114, v114 op_sel:[0,0] op_sel_hi:[1,1]
  v_cvt_pk_f16_f32 v62, v32, v33
  v_mfma_f32_16x16x32_f16 v[224:227], v[172:175], v[144:147], v[224:227]
  v_pk_mul_f16 v159, v102, v103 op_sel:[0,0] op_sel_hi:[1,1]
  s_nop 1
  v_mfma_f32_16x16x32_f16 v[240:243], v[172:175], v[156:159], v[240:243]
  s_waitcnt lgkmcnt(2)
  v_cvt_pk_f16_f32 v76, v34, v35
  v_cvt_pk_f16_f32 v90, v36, v37
  v_mfma_f32_16x16x32_f16 v[184:187], v[176:179], v[120:123], v[184:187]
  ds_write_b32 v11, v62 offset:0
  v_mfma_f32_16x16x32_f16 v[200:203], v[176:179], v[132:135], v[200:203]
  ds_write_b32 v11, v76 offset:160
  v_mfma_f32_16x16x32_f16 v[216:219], v[176:179], v[144:147], v[216:219]
  ds_write_b32 v11, v90 offset:320
  v_mfma_f32_16x16x32_f16 v[232:235], v[176:179], v[156:159], v[232:235]
  s_waitcnt lgkmcnt(4)
  v_cvt_pk_f16_f32 v104, v38, v39
  v_cvt_pk_f16_f32 v63, v40, v41
  v_mfma_f32_16x16x32_f16 v[188:191], v[180:183], v[120:123], v[188:191]
  ds_write_b32 v11, v104 offset:480
  v_mfma_f32_16x16x32_f16 v[204:207], v[180:183], v[132:135], v[204:207]
  ds_write_b32 v11, v63 offset:640
  v_mfma_f32_16x16x32_f16 v[220:223], v[180:183], v[144:147], v[220:223]
  s_nop 0
  v_cvt_pk_f16_f32 v77, v42, v43
  v_cvt_pk_f16_f32 v91, v44, v45
  v_mfma_f32_16x16x32_f16 v[236:239], v[180:183], v[156:159], v[236:239]
  s_waitcnt lgkmcnt(5)
  v_cvt_pk_f16_f32 v105, v46, v47
  v_cvt_pk_f16_f32 v66, v48, v49
  v_smfmac_f32_16x16x64_f16 v[196:199], v[164:167], v[116:123], v9
  ds_write_b32 v11, v77 offset:800
  v_smfmac_f32_16x16x64_f16 v[212:215], v[164:167], v[128:135], v9
  ds_write_b32 v11, v91 offset:960
  v_smfmac_f32_16x16x64_f16 v[228:231], v[164:167], v[140:147], v9
  ds_write_b32 v11, v105 offset:1120
  v_smfmac_f32_16x16x64_f16 v[244:247], v[164:167], v[152:159], v9
  ds_write_b32 v11, v66 offset:1280
  s_setprio 0
  v_cvt_pk_f16_f32 v80, v50, v51
  v_cvt_pk_f16_f32 v94, v52, v53
  v_cvt_pk_f16_f32 v108, v54, v55
  v_cvt_pk_f16_f32 v67, v56, v57
  ds_write_b32 v11, v80 offset:1440
  ds_write_b32 v11, v94 offset:1600
  ds_write_b32 v11, v108 offset:1760
  ds_write_b32 v11, v67 offset:1920
  s_sub_u32 s72, s72, 1
  s_cmp_lg_u32 s72, 0
  s_cbranch_scc1 L_cin_loop
  s_branch L_cin_done
L_cslow:
  v_max_f32_dpp v58, v58, v58 row_shr:1 row_mask:0xf bank_mask:0xf
  s_nop 1
  v_max_f32_dpp v58, v58, v58 row_shr:2 row_mask:0xf bank_mask:0xf
  s_nop 1
  v_max_f32_dpp v58, v58, v58 row_shr:4 row_mask:0xf bank_mask:0xf
  s_nop 1
  v_max_f32_dpp v58, v58, v58 row_shr:8 row_mask:0xf bank_mask:0xf
  s_nop 1
  v_max_f32_dpp v58, v58, v58 row_bcast:15 row_mask:0xa bank_mask:0xf
  s_nop 1
  v_max_f32_dpp v58, v58, v58 row_bcast:31 row_mask:0xc bank_mask:0xf
  s_nop 0
  v_readlane_b32 s98, v58, 63
  s_mov_b32 s97, 0
  s_lshr_b32 s98, s98, 23
  s_max_u32 s98, s98, 72
  s_min_u32 s98, s98, 182
  s_sub_u32 s99, 258, s98
  s_lshl_b32 s100, s99, 1
  s_sub_u32 s100, s100, 127
  s_sub_u32 s95, 254, s100
  s_lshl_b32 s95, s95, 23
  v_mov_b32 v60, s95
  v_mul_f32 v61, s0, v60
  v_mul_f32 v60, s1, v60
  v_readfirstlane_b32 s74, v61
  v_readfirstlane_b32 s75, v60
  s_lshl_b32 s99, s99, 23
  s_lshl_b32 s100, s100, 23
  v_mul_f32 v60, s99, v32
  v_mul_f32 v61, s99, v33
  v_mul_f32 v62, s100, v32
  v_mul_f32_e64 v63, s100, v33
  v_cvt_pk_f16_f32 v80, v60, v61
  v_cvt_pk_bf16_f32 v64, v62, v63
  ds_write_b32 v11, v80 offset:0
  ds_write_b32 v10, v64 offset:0
  v_mul_f32 v60, s99, v34
  v_mul_f32 v61, s99, v35
  v_mul_f32 v62, s100, v34
  v_mul_f32 v63, s100, v35
  v_cvt_pk_f16_f32 v81, v60, v61
  v_cvt_pk_bf16_f32 v65, v62, v63
  ds_write_b32 v11, v81 offset:160
  ds_write_b32 v10, v65 offset:2112
  v_mul_f32 v60, s99, v36
  v_mul_f32 v61, s99, v37
  v_mul_f32 v62, s100, v36
  v_mul_f32 v63, s100, v37
  v_cvt_pk_f16_f32 v82, v60, v61
  v_cvt_pk_bf16_f32 v66, v62, v63
  ds_write_b32 v11, v82 offset:320
  ds_write_b32 v10, v66 offset:128
  v_mul_f32 v60, s99, v38
  v_mul_f32 v61, s99, v39
  v_mul_f32 v62, s100, v38
  v_mul_f32 v63, s100, v39
  v_cvt_pk_f16_f32 v83, v60, v61
  v_cvt_pk_bf16_f32 v67, v62, v63
  ds_write_b32 v11, v83 offset:480
  ds_write_b32 v10, v67 offset:2240
  v_mul_f32 v60, s99, v40
  v_mul_f32 v61, s99, v41
  v_mul_f32 v62, s100, v40
  v_mul_f32 v63, s100, v41
  v_cvt_pk_f16_f32 v84, v60, v61
  v_cvt_pk_bf16_f32 v68, v62, v63
  ds_write_b32 v11, v84 offset:640
  ds_write_b32 v10, v68 offset:256
  v_mul_f32 v60, s99, v42
  v_mul_f32 v61, s99, v43
  v_mul_f32 v62, s100, v42
  v_mul_f32 v63, s100, v43
  v_cvt_pk_f16_f32 v85, v60, v61
  v_cvt_pk_bf16_f32 v69, v62, v63
  ds_write_b32 v11, v85 offset:800
  ds_write_b32 v10, v69 offset:2368
  v_mul_f32 v60, s99, v44
  v_mul_f32 v61, s99, v45
  v_mul_f32 v62, s100, v44
  v_mul_f32 v63, s100, v45
  v_cvt_pk_f16_f32 v86, v60, v61
  v_cvt_pk_bf16_f32 v70, v62, v63
  ds_write_b32 v11, v86 offset:960
  ds_write_b32 v10, v70 offset:384
  v_mul_f32 v60, s99, v46
  v_mul_f32 v61, s99, v47
  v_mul_f32 v62, s100, v46
  v_mul_f32 v63, s100, v47
  v_cvt_pk_f16_f32 v87, v60, v61
  v_cvt_pk_bf16_f32 v71, v62, v63
  ds_write_b32 v11, v87 offset:1120
  ds_write_b32 v10, v71 offset:2496
  v_mul_f32 v60, s99, v48
  v_mul_f32 v61, s99, v49
  v_mul_f32 v62, s100, v48
  v_mul_f32 v63, s100, v49
  v_cvt_pk_f16_f32 v88, v60, v61
  v_cvt_pk_bf16_f32 v72, v62, v63
  ds_write_b32 v11, v88 offset:1280
  ds_write_b32 v10, v72 offset:512
  v_mul_f32 v60, s99, v50
  v_mul_f32 v61, s99, v51
  v_mul_f32 v62, s100, v50
  v_mul_f32 v63, s100, v51
  v_cvt_pk_f16_f32 v89, v60, v61
  v_cvt_pk_bf16_f32 v73, v62, v63
  ds_write_b32 v11, v89 offset:1440
  ds_write_b32 v10, v73 offset:2624
  v_mul_f32 v60, s99, v52
  v_mul_f32 v61, s99, v53
  v_mul_f32 v62, s100, v52
  v_mul_f32 v63, s100, v53
  v_cvt_pk_f16_f32 v90, v60, v61
  v_cvt_pk_bf16_f32 v74, v62, v63
  ds_write_b32 v11, v90 offset:1600
  ds_write_b32 v10, v74 offset:640
  v_mul_f32 v60, s99, v54
  v_mul_f32 v61, s99, v55
  v_mul_f32 v62, s100, v54
  v_mul_f32 v63, s100, v55
  v_cvt_pk_f16_f32 v91, v60, v61
  v_cvt_pk_bf16_f32 v75, v62, v63
  ds_write_b32 v11, v91 offset:1760
  ds_write_b32 v10, v75 offset:2752
  v_mul_f32 v60, s99, v56
  v_mul_f32 v61, s99, v57
  v_mul_f32 v62, s100, v56
  v_mul_f32 v63, s100, v57
  v_cvt_pk_f16_f32 v92, v60, v61
  v_cvt_pk_bf16_f32 v76, v62, v63
  ds_write_b32 v11, v92 offset:1920
  ds_write_b32 v10, v76 offset:768
  v_mov_b32 v60, s100
  v_cvt_pk_bf16_f32 v60, v60, v60
  s_mov_b32 exec_hi, 0
  ds_write_b32 v10, v60 offset:2880
  s_mov_b32 exec_hi, -1
  s_waitcnt lgkmcnt(0)
  s_branch L_cconv
L_sdown:
  v_lshlrev_b32 v108, 16, v112
  v_and_b32 v109, 0xffff0000, v112
  v_mul_f32 v108, v108, v250
  v_mul_f32 v109, v109, v250
  v_cvt_pk_bf16_f32 v112, v108, v109
  v_lshlrev_b32 v108, 16, v113
  v_and_b32 v109, 0xffff0000, v113
  v_mul_f32 v108, v108, v250
  v_mul_f32 v109, v109, v250
  v_cvt_pk_bf16_f32 v113, v108, v109
  s_waitcnt lgkmcnt(14)
  v_lshlrev_b32_e64 v108, 16, v114
  v_and_b32 v109, 0xffff0000, v114
  v_mul_f32 v108, v108, v250
  v_mul_f32 v109, v109, v250
  v_cvt_pk_bf16_f32 v114, v108, v109
  v_lshlrev_b32 v108, 16, v115
  v_and_b32 v109, 0xffff0000, v115
  v_mul_f32 v108, v108, v250
  v_mul_f32 v109, v109, v250
  v_cvt_pk_bf16_f32 v115, v108, v109
  v_lshlrev_b32 v108, 16, v116
  v_and_b32 v109, 0xffff0000, v116
  v_mul_f32 v108, v108, v250
  v_mul_f32 v109, v109, v250
  v_cvt_pk_bf16_f32 v116, v108, v109
  v_lshlrev_b32 v108, 16, v117
  v_and_b32 v109, 0xffff0000, v117
  v_mul_f32 v108, v108, v250
  v_mul_f32 v109, v109, v250
  v_cvt_pk_bf16_f32 v117, v108, v109
  v_lshlrev_b32 v108, 16, v118
  v_and_b32 v109, 0xffff0000, v118
  v_mul_f32 v108, v108, v250
  v_mul_f32 v109, v109, v250
  v_cvt_pk_bf16_f32 v118, v108, v109
  v_lshlrev_b32 v108, 16, v119
  v_and_b32 v109, 0xffff0000, v119
  v_mul_f32 v108, v108, v250
  v_mul_f32 v109, v109, v250
  v_cvt_pk_bf16_f32 v119, v108, v109
  s_branch L_scaled
L_end:
  s_endpgm
.p2align 8
L_tables:
.long 0x0, 0x200, 0x0, 0x3f803f80, 0x8, 0x208, 0x0, 0x3f803f80
.long 0x10, 0x210, 0x0, 0x3f803f80, 0x18, 0x218, 0x0, 0x3f803f80
.long 0x420, 0x620, 0x0, 0x3f803f80, 0x428, 0x628, 0x0, 0x3f803f80
.long 0x430, 0x630, 0x0, 0x3f803f80, 0x438, 0x638, 0x0, 0x3f803f80
.long 0x840, 0xa40, 0x10, 0x3f803f80, 0x848, 0xa48, 0x10, 0x3f803f80
.long 0x850, 0xa50, 0x10, 0x3f803f80, 0x858, 0xa58, 0x10, 0x3f803f80
.long 0xc60, 0xe60, 0x10, 0x3f803f80, 0xc68, 0xe68, 0x10, 0x3f803f80
.long 0xc70, 0xe70, 0x10, 0x3f803f80, 0xc78, 0xe78, 0x10, 0x3f803f80
.long 0x80, 0x280, 0x20, 0x3f803f80, 0x88, 0x288, 0x20, 0x3f803f80
.long 0x90, 0x290, 0x20, 0x3f803f80, 0x98, 0x298, 0x20, 0x3f803f80
.long 0x4a0, 0x6a0, 0x20, 0x3f803f80, 0x4a8, 0x6a8, 0x20, 0x3f803f80
.long 0x4b0, 0x6b0, 0x20, 0x3f803f80, 0x4b8, 0x6b8, 0x20, 0x3f803f80
.long 0x8c0, 0xac0, 0x30, 0x3f803f80, 0x8c8, 0xac8, 0x30, 0x3f803f80
.long 0x8d0, 0xad0, 0x30, 0x3f803f80, 0x8d8, 0xad8, 0x30, 0x3f803f80
.long 0xce0, 0xee0, 0x30, 0x3f803f80, 0xce8, 0xee8, 0x30, 0x3f803f80
.long 0xcf0, 0xef0, 0x30, 0x3f803f80, 0xcf8, 0xef8, 0x30, 0x3f803f80
.long 0x100, 0x300, 0x40, 0x0, 0x108, 0x308, 0x40, 0x0
.long 0x110, 0x310, 0x40, 0x0, 0x118, 0x318, 0x40, 0x0
.long 0x520, 0x720, 0x40, 0x0, 0x528, 0x728, 0x40, 0x0
.long 0x530, 0x730, 0x40, 0x0, 0x538, 0x738, 0x40, 0x0
.long 0x940, 0xb40, 0x50, 0x0, 0x948, 0xb48, 0x50, 0x0
.long 0x950, 0xb50, 0x50, 0x0, 0x958, 0xb58, 0x50, 0x0
.long 0xd60, 0xf60, 0x50, 0x0, 0xd68, 0xf68, 0x50, 0x0
.long 0xd70, 0xf70, 0x50, 0x0, 0xd78, 0xf78, 0x50, 0x0
.long 0x180, 0xf60, 0x60, 0x0, 0x188, 0xf68, 0x60, 0x0
.long 0x190, 0xf70, 0x60, 0x0, 0x198, 0xf78, 0x60, 0x0
.long 0x5a0, 0xf60, 0x60, 0x0, 0x5a8, 0xf68, 0x60, 0x0
.long 0x5b0, 0xf70, 0x60, 0x0, 0x5b8, 0xf78, 0x60, 0x0
.long 0x9c0, 0xf60, 0x70, 0x0, 0x9c8, 0xf68, 0x70, 0x0
.long 0x9d0, 0xf70, 0x70, 0x0, 0x9d8, 0xf78, 0x70, 0x0
.long 0xde0, 0xf60, 0x70, 0x0, 0xde8, 0xf68, 0x70, 0x0
.long 0xdf0, 0xf70, 0x70, 0x0, 0xdf8, 0xf78, 0x70, 0x0
.long 0x0, 0x4444, 0x0, 0xa400, 0x10, 0xeeee, 0x4, 0xa404
.long 0x20, 0x4444, 0x8, 0xa408, 0x30, 0xeeee, 0xc, 0xa40c
.long 0x40, 0x4444, 0x10, 0xa410, 0x50, 0xeeee, 0x14, 0xa414
.long 0x60, 0x4444, 0x18, 0xa418, 0x70, 0xeeee, 0x1c, 0xa41c
.long 0x0, 0x4444, 0x20, 0xa420, 0x10, 0xeeee, 0x24, 0xa424
.long 0x20, 0x4444, 0x28, 0xa428, 0x30, 0xeeee, 0x2c, 0xa42c
.long 0x40, 0x4444, 0x30, 0xa430, 0x50, 0xeeee, 0x34, 0xa434
.long 0x60, 0x4444, 0x38, 0xa438, 0x70, 0xeeee, 0x3c, 0xa43c
.long 0x0, 0x4444, 0x40, 0xa440, 0x10, 0xeeee, 0x44, 0xa444
.long 0x20, 0x4444, 0x48, 0xa448, 0x30, 0xeeee, 0x4c, 0xa44c
.long 0x40, 0x4444, 0x50, 0xa450, 0x50, 0xeeee, 0x54, 0xa454
.long 0x60, 0x4444, 0x58, 0xa458, 0x70, 0xeeee, 0x5c, 0xa45c
.long 0x0, 0x4444, 0x60, 0xa460, 0x10, 0xeeee, 0x64, 0xa464
.long 0x20, 0x4444, 0x68, 0xa468, 0x30, 0xeeee, 0x6c, 0xa46c
.long 0x40, 0x4444, 0x70, 0xa470, 0x50, 0xeeee, 0x74, 0xa474
.long 0x60, 0x4444, 0x78, 0xa478, 0x70, 0xeeee, 0x7c, 0xa47c
.long 0x0, 0x4444, 0x420, 0xb080, 0x10, 0xeeee, 0x424, 0xb084
.long 0x20, 0x4444, 0x428, 0xb088, 0x30, 0xeeee, 0x42c, 0xb08c
.long 0x40, 0x4444, 0x430, 0xb090, 0x50, 0xeeee, 0x434, 0xb094
.long 0x60, 0x4444, 0x438, 0xb098, 0x70, 0xeeee, 0x43c, 0xb09c
.long 0x0, 0x4444, 0x440, 0xb0a0, 0x10, 0xeeee, 0x444, 0xb0a4
.long 0x20, 0x4444, 0x448, 0xb0a8, 0x30, 0xeeee, 0x44c, 0xb0ac
.long 0x40, 0x4444, 0x450, 0xb0b0, 0x50, 0xeeee, 0x454, 0xb0b4
.long 0x60, 0x4444, 0x458, 0xb0b8, 0x70, 0xeeee, 0x45c, 0xb0bc
.long 0x0, 0x4444, 0x460, 0xb0c0, 0x10, 0xeeee, 0x464, 0xb0c4
.long 0x20, 0x4444, 0x468, 0xb0c8, 0x30, 0xeeee, 0x46c, 0xb0cc
.long 0x40, 0x4444, 0x470, 0xb0d0, 0x50, 0xeeee, 0x474, 0xb0d4
.long 0x60, 0x4444, 0x478, 0xb0d8, 0x70, 0xeeee, 0x47c, 0xb0dc
.long 0x0, 0x4444, 0x480, 0xb0e0, 0x10, 0xeeee, 0x484, 0xb0e4
.long 0x20, 0x4444, 0x488, 0xb0e8, 0x30, 0xeeee, 0x48c, 0xb0ec
.long 0x40, 0x4444, 0x490, 0xb0f0, 0x50, 0xeeee, 0x494, 0xb0f4
.long 0x60, 0x4444, 0x498, 0xb0f8, 0x70, 0xeeee, 0x49c, 0xb0fc
.long 0xaae0, 0xa680, 0xa900, 0xaae0, 0xaae8, 0xa688, 0xa908, 0xaae8
.long 0xaaf0, 0xa690, 0xa910, 0xaaf0, 0xaaf8, 0xa698, 0xa918, 0xaaf8
.long 0xaa40, 0xa860, 0xa9a0, 0xaa40, 0xaa48, 0xa868, 0xa9a8, 0xaa48
.long 0xaa50, 0xa870, 0xa9b0, 0xaa50, 0xaa58, 0xa878, 0xa9b8, 0xaa58
.long 0xa400, 0xa7c0, 0xa540, 0xa400, 0xa408, 0xa7c8, 0xa548, 0xa408
.long 0xa410, 0xa7d0, 0xa550, 0xa410, 0xa418, 0xa7d8, 0xa558, 0xa418
.long 0xa4a0, 0xa720, 0xa5e0, 0xa4a0, 0xa4a8, 0xa728, 0xa5e8, 0xa4a8
.long 0xa4b0, 0xa730, 0xa5f0, 0xa4b0, 0xa4b8, 0xa738, 0xa5f8, 0xa4b8
.long 0xb260, 0xb4e0, 0xb6c0, 0xb260, 0xb268, 0xb4e8, 0xb6c8, 0xb268
.long 0xb270, 0xb4f0, 0xb6d0, 0xb270, 0xb278, 0xb4f8, 0xb6d8, 0xb278
.long 0xb1c0, 0xb300, 0xb760, 0xb1c0, 0xb1c8, 0xb308, 0xb768, 0xb1c8
.long 0xb1d0, 0xb310, 0xb770, 0xb1d0, 0xb1d8, 0xb318, 0xb778, 0xb1d8
.long 0xb580, 0xb440, 0xb080, 0xb580, 0xb588, 0xb448, 0xb088, 0xb588
.long 0xb590, 0xb450, 0xb090, 0xb590, 0xb598, 0xb458, 0xb098, 0xb598
.long 0xb620, 0xb3a0, 0xb120, 0xb620, 0xb628, 0xb3a8, 0xb128, 0xb628
.long 0xb630, 0xb3b0, 0xb130, 0xb630, 0xb638, 0xb3b8, 0xb138, 0xb638
.long 0xa900, 0xa400, 0xaae0, 0xb620, 0xa908, 0xa408, 0xaae8, 0xb628
.long 0xa910, 0xa410, 0xaaf0, 0xb630, 0xa918, 0xa418, 0xaaf8, 0xb638
.long 0xa9a0, 0xa4a0, 0xab80, 0xb800, 0xa9a8, 0xa4a8, 0xab88, 0xb808
.long 0xa9b0, 0xa4b0, 0xab90, 0xb810, 0xa9b8, 0xa4b8, 0xab98, 0xb818
.long 0xaa40, 0xa680, 0xa860, 0xb3a0, 0xaa48, 0xa688, 0xa868, 0xb3a8
.long 0xaa50, 0xa690, 0xa870, 0xb3b0, 0xaa58, 0xa698, 0xa878, 0xb3b8
.long 0xa720, 0xa540, 0xa7c0, 0xb1c0, 0xa728, 0xa548, 0xa7c8, 0xb1c8
.long 0xa730, 0xa550, 0xa7d0, 0xb1d0, 0xa738, 0xa558, 0xa7d8, 0xb1d8
.long 0xa5e0, 0xaae0, 0xa400, 0xb080, 0xa5e8, 0xaae8, 0xa408, 0xb088
.long 0xa5f0, 0xaaf0, 0xa410, 0xb090, 0xa5f8, 0xaaf8, 0xa418, 0xb098
.long 0xa7c0, 0xa540, 0xa720, 0xb760, 0xa7c8, 0xa548, 0xa728, 0xb768
.long 0xa7d0, 0xa550, 0xa730, 0xb770, 0xa7d8, 0xa558, 0xa738, 0xb778
.long 0xa860, 0xa680, 0xaa40, 0xb440, 0xa868, 0xa688, 0xaa48, 0xb448
.long 0xa870, 0xa690, 0xaa50, 0xb450, 0xa878, 0xa698, 0xaa58, 0xb458
.long 0xab80, 0xa4a0, 0xa9a0, 0xb4e0, 0xab88, 0xa4a8, 0xa9a8, 0xb4e8
.long 0xab90, 0xa4b0, 0xa9b0, 0xb4f0, 0xab98, 0xa4b8, 0xa9b8, 0xb4f8
.long 0xa680, 0xa900, 0xab80, 0xa4a0, 0xa688, 0xa908, 0xab88, 0xa4a8
.long 0xa690, 0xa910, 0xab90, 0xa4b0, 0xa698, 0xa918, 0xab98, 0xa4b8
.long 0xa860, 0xa9a0, 0xb1c0, 0xb440, 0xa868, 0xa9a8, 0xb1c8, 0xb448
.long 0xa870, 0xa9b0, 0xb1d0, 0xb450, 0xa878, 0xa9b8, 0xb1d8, 0xb458
.long 0xa7c0, 0xa540, 0xab80, 0xa4a0, 0xa7c8, 0xa548, 0xab88, 0xa4a8
.long 0xa7d0, 0xa550, 0xab90, 0xa4b0, 0xa7d8, 0xa558, 0xab98, 0xa4b8
.long 0xa720, 0xa5e0, 0xb1c0, 0xb440, 0xa728, 0xa5e8, 0xb1c8, 0xb448
.long 0xa730, 0xa5f0, 0xb1d0, 0xb450, 0xa738, 0xa5f8, 0xb1d8, 0xb458
.long 0xb4e0, 0xb6c0, 0xb800, 0xa860, 0xb4e8, 0xb6c8, 0xb808, 0xa868
.long 0xb4f0, 0xb6d0, 0xb810, 0xa870, 0xb4f8, 0xb6d8, 0xb818, 0xa878
.long 0xb300, 0xb760, 0xa540, 0xa900, 0xb308, 0xb768, 0xa548, 0xa908
.long 0xb310, 0xb770, 0xa550, 0xa910, 0xb318, 0xb778, 0xa558, 0xa918
.long 0xb440, 0xb080, 0xb800, 0xa860, 0xb448, 0xb088, 0xb808, 0xa868
.long 0xb450, 0xb090, 0xb810, 0xa870, 0xb458, 0xb098, 0xb818, 0xa878
.long 0xb3a0, 0xb120, 0xa540, 0xa900, 0xb3a8, 0xb128, 0xa548, 0xa908
.long 0xb3b0, 0xb130, 0xa550, 0xa910, 0xb3b8, 0xb138, 0xa558, 0xa918
.long 0xb120, 0xb580, 0xb080, 0xb300, 0xb128, 0xb588, 0xb088, 0xb308
.long 0xb130, 0xb590, 0xb090, 0xb310, 0xb138, 0xb598, 0xb098, 0xb318
.long 0xb6c0, 0xb4e0, 0xaa40, 0xb6c0, 0xb6c8, 0xb4e8, 0xaa48, 0xb6c8
.long 0xb6d0, 0xb4f0, 0xaa50, 0xb6d0, 0xb6d8, 0xb4f8, 0xaa58, 0xb6d8
.long 0xb300, 0xb440, 0xb080, 0xb300, 0xb308, 0xb448, 0xb088, 0xb308
.long 0xb310, 0xb450, 0xb090, 0xb310, 0xb318, 0xb458, 0xb098, 0xb318
.long 0xb260, 0xb760, 0xaa40, 0xb6c0, 0xb268, 0xb768, 0xaa48, 0xb6c8
.long 0xb270, 0xb770, 0xaa50, 0xb6d0, 0xb278, 0xb778, 0xaa58, 0xb6d8
.long 0xb580, 0xb120, 0xb620, 0xa680, 0xb588, 0xb128, 0xb628, 0xa688
.long 0xb590, 0xb130, 0xb630, 0xa690, 0xb598, 0xb138, 0xb638, 0xa698
.long 0xb260, 0xb1c0, 0xa7c0, 0xa680, 0xb268, 0xb1c8, 0xa7c8, 0xa688
.long 0xb270, 0xb1d0, 0xa7d0, 0xa690, 0xb278, 0xb1d8, 0xa7d8, 0xa698
.long 0xb300, 0xb3a0, 0xb620, 0xb300, 0xb308, 0xb3a8, 0xb628, 0xb308
.long 0xb310, 0xb3b0, 0xb630, 0xb310, 0xb318, 0xb3b8, 0xb638, 0xb318
.long 0xb6c0, 0xb800, 0xa7c0, 0xb300, 0xb6c8, 0xb808, 0xa7c8, 0xb308
.long 0xb6d0, 0xb810, 0xa7d0, 0xb310, 0xb6d8, 0xb818, 0xa7d8, 0xb318
.long 0x0, 0x1800, 0x6c80, 0x81a0, 0x8, 0x1808, 0x6c88, 0x81a8
.long 0x10, 0x1810, 0x6c90, 0x81b0, 0x18, 0x1818, 0x6c98, 0x81b8
.long 0x40, 0x1d48, 0x71c8, 0x86e8, 0x48, 0x1d50, 0x71d0, 0x86f0
.long 0x50, 0x1d58, 0x71d8, 0x86f8, 0x58, 0x1d60, 0x71e0, 0x8700
.long 0x80, 0x2290, 0x7710, 0x8c30, 0x88, 0x2298, 0x7718, 0x8c38
.long 0x90, 0x22a0, 0x7720, 0x8c40, 0x98, 0x22a8, 0x7728, 0x8c48
.long 0xc0, 0x27d8, 0x7c58, 0x9178, 0xc8, 0x27e0, 0x7c60, 0x9180
.long 0xd0, 0x27e8, 0x7c68, 0x9188, 0xd8, 0x27f0, 0x7c70, 0x9190
.long 0x20, 0x1820, 0x6ca0, 0x81c0, 0x28, 0x1828, 0x6ca8, 0x81c8
.long 0x30, 0x1830, 0x6cb0, 0x81d0, 0x38, 0x1838, 0x6cb8, 0x81d8
.long 0x60, 0x1d68, 0x71e8, 0x8708, 0x68, 0x1d70, 0x71f0, 0x8710
.long 0x70, 0x1d78, 0x71f8, 0x8718, 0x78, 0x1d80, 0x7200, 0x8720
.long 0xa0, 0x22b0, 0x7730, 0x8c50, 0xa8, 0x22b8, 0x7738, 0x8c58
.long 0xb0, 0x22c0, 0x7740, 0x8c60, 0xb8, 0x22c8, 0x7748, 0x8c68
.long 0xe0, 0x27f8, 0x7c78, 0x9198, 0xe8, 0x2800, 0x7c80, 0x91a0
.long 0xf0, 0x2808, 0x7c88, 0x91a8, 0xf8, 0x2810, 0x7c90, 0x91b0
.long 0x200, 0x4240, 0x96c0, 0x9c08, 0x208, 0x4248, 0x96c8, 0x9c10
.long 0x210, 0x4250, 0x96d0, 0x9c18, 0x218, 0x4258, 0x96d8, 0x9c20
.long 0x240, 0x4788, 0x9c08, 0x9c08, 0x248, 0x4790, 0x9c10, 0x9c10
.long 0x250, 0x4798, 0x9c18, 0x9c18, 0x258, 0x47a0, 0x9c20, 0x9c20
.long 0x280, 0x4cd0, 0x9c08, 0x9c08, 0x288, 0x4cd8, 0x9c10, 0x9c10
.long 0x290, 0x4ce0, 0x9c18, 0x9c18, 0x298, 0x4ce8, 0x9c20, 0x9c20
.long 0x2c0, 0x5218, 0x9c08, 0x9c08, 0x2c8, 0x5220, 0x9c10, 0x9c10
.long 0x2d0, 0x5228, 0x9c18, 0x9c18, 0x2d8, 0x5230, 0x9c20, 0x9c20
.long 0x220, 0x4260, 0x96e0, 0x9c28, 0x228, 0x4268, 0x96e8, 0x9c30
.long 0x230, 0x4270, 0x96f0, 0x9c38, 0x238, 0x4278, 0x96f8, 0x9c40
.long 0x260, 0x47a8, 0x9c28, 0x9c28, 0x268, 0x47b0, 0x9c30, 0x9c30
.long 0x270, 0x47b8, 0x9c38, 0x9c38, 0x278, 0x47c0, 0x9c40, 0x9c40
.long 0x2a0, 0x4cf0, 0x9c28, 0x9c28, 0x2a8, 0x4cf8, 0x9c30, 0x9c30
.long 0x2b0, 0x4d00, 0x9c38, 0x9c38, 0x2b8, 0x4d08, 0x9c40, 0x9c40
.long 0x2e0, 0x5238, 0x9c28, 0x9c28, 0x2e8, 0x5240, 0x9c30, 0x9c30
.long 0x2f0, 0x5248, 0x9c38, 0x9c38, 0x2f8, 0x5250, 0x9c40, 0x9c40
.long 0xffff, 0x0, 0x0, 0x0, 0x0, 0x0, 0xffff, 0x0
.long 0x0, 0x0, 0x0, 0x0, 0x0, 0x0, 0x0, 0x0
.long 0x0, 0x0, 0x0, 0x0, 0x0, 0x0, 0x0, 0x0
.long 0x0, 0x0, 0x0, 0x0, 0x0, 0x0, 0x0, 0x0
.long 0xffff0000, 0x0, 0x0, 0x0, 0x0, 0x0, 0xffff0000, 0x0
.long 0x0, 0x0, 0x0, 0x0, 0x0, 0x0, 0x0, 0x0
.long 0x0, 0x0, 0x0, 0x0, 0x0, 0x0, 0x0, 0x0
.long 0x0, 0x0, 0x0, 0x0, 0x0, 0x0, 0x0, 0x0
.long 0x0, 0xffff, 0x0, 0x0, 0x0, 0x0, 0x0, 0xffff
.long 0x0, 0x0, 0x0, 0x0, 0x0, 0x0, 0x0, 0x0
.long 0x0, 0x0, 0x0, 0x0, 0x0, 0x0, 0x0, 0x0
.long 0x0, 0x0, 0x0, 0x0, 0x0, 0x0, 0x0, 0x0
.long 0x0, 0xffff0000, 0x0, 0x0, 0x0, 0x0, 0x0, 0xffff0000
.long 0x0, 0x0, 0x0, 0x0, 0x0, 0x0, 0x0, 0x0
.long 0x0, 0x0, 0x0, 0x0, 0x0, 0x0, 0x0, 0x0
.long 0x0, 0x0, 0x0, 0x0, 0x0, 0x0, 0x0, 0x0
.long 0x0, 0x0, 0x0, 0x0, 0x0, 0x0, 0x0, 0x0
.long 0xffff, 0x0, 0x0, 0x0, 0x0, 0x0, 0xffff, 0x0
.long 0x0, 0x0, 0x0, 0x0, 0x0, 0x0, 0x0, 0x0
.long 0x0, 0x0, 0x0, 0x0, 0x0, 0x0, 0x0, 0x0
.long 0x0, 0x0, 0x0, 0x0, 0x0, 0x0, 0x0, 0x0
.long 0xffff0000, 0x0, 0x0, 0x0, 0x0, 0x0, 0xffff0000, 0x0
.long 0x0, 0x0, 0x0, 0x0, 0x0, 0x0, 0x0, 0x0
.long 0x0, 0x0, 0x0, 0x0, 0x0, 0x0, 0x0, 0x0
.long 0x0, 0x0, 0x0, 0x0, 0x0, 0x0, 0x0, 0x0
.long 0x0, 0xffff, 0x0, 0x0, 0x0, 0x0, 0x0, 0xffff
.long 0x0, 0x0, 0x0, 0x0, 0x0, 0x0, 0x0, 0x0
.long 0x0, 0x0, 0x0, 0x0, 0x0, 0x0, 0x0, 0x0
.long 0x0, 0x0, 0x0, 0x0, 0x0, 0x0, 0x0, 0x0
.long 0x0, 0xffff0000, 0x0, 0x0, 0x0, 0x0, 0x0, 0xffff0000
.long 0x0, 0x0, 0x0, 0x0, 0x0, 0x0, 0x0, 0x0
.long 0x0, 0x0, 0x0, 0x0, 0x0, 0x0, 0x0, 0x0
.long 0x0, 0x0, 0x0, 0x0, 0x0, 0x0, 0x0, 0x0
.long 0x0, 0x0, 0x0, 0x0, 0x0, 0x0, 0x0, 0x0
.long 0x0, 0x0, 0xffff, 0x0, 0x0, 0x0, 0x0, 0x0
.long 0x0, 0x0, 0x0, 0x0, 0xffff, 0x0, 0x0, 0x0
.long 0x0, 0x0, 0x0, 0x0, 0x0, 0x0, 0x0, 0x0
.long 0x0, 0x0, 0x0, 0x0, 0x0, 0x0, 0x0, 0x0
.long 0x0, 0x0, 0xffff0000, 0x0, 0x0, 0x0, 0x0, 0x0
.long 0x0, 0x0, 0x0, 0x0, 0xffff0000, 0x0, 0x0, 0x0
.long 0x0, 0x0, 0x0, 0x0, 0x0, 0x0, 0x0, 0x0
.long 0x0, 0x0, 0x0, 0x0, 0x0, 0x0, 0x0, 0x0
.long 0x0, 0x0, 0x0, 0xffff, 0x0, 0x0, 0x0, 0x0
.long 0x0, 0x0, 0x0, 0x0, 0x0, 0xffff, 0x0, 0x0
.long 0x0, 0x0, 0x0, 0x0, 0x0, 0x0, 0x0, 0x0
.long 0x0, 0x0, 0x0, 0x0, 0x0, 0x0, 0x0, 0x0
.long 0x0, 0x0, 0x0, 0xffff0000, 0x0, 0x0, 0x0, 0x0
.long 0x0, 0x0, 0x0, 0x0, 0x0, 0xffff0000, 0x0, 0x0
.long 0x0, 0x0, 0x0, 0x0, 0x0, 0x0, 0x0, 0x0
.long 0x0, 0x0, 0x0, 0x0, 0x0, 0x0, 0x0, 0x0
.long 0x0, 0x0, 0x0, 0x0, 0xffff, 0x0, 0x0, 0x0
.long 0x0, 0x0, 0x0, 0x0, 0x0, 0x0, 0x0, 0x0
.long 0x0, 0x0, 0x0, 0x0, 0x0, 0x0, 0x0, 0x0
.long 0x0, 0x0, 0x0, 0x0, 0x0, 0x0, 0x0, 0x0
.long 0x0, 0x0, 0x0, 0x0, 0xffff0000, 0x0, 0x0, 0x0
.long 0x0, 0x0, 0x0, 0x0, 0x0, 0x0, 0x0, 0x0
.long 0x0, 0x0, 0x0, 0x0, 0x0, 0x0, 0x0, 0x0
.long 0x0, 0x0, 0x0, 0x0, 0x0, 0x0, 0x0, 0x0
.long 0x0, 0x0, 0x0, 0x0, 0x0, 0x0, 0x0, 0x0
.long 0x0, 0x0, 0x0, 0x0, 0x0, 0x0, 0x0, 0x0
.long 0x0, 0x0, 0x0, 0x0, 0x0, 0x0, 0x0, 0x0
.long 0x0, 0x0, 0x0, 0x0, 0x0, 0x0, 0x0, 0x0
.long 0x0, 0x0, 0x0, 0x0, 0x0, 0x0, 0x0, 0x0
.long 0x0, 0x0, 0x0, 0x0, 0x0, 0x0, 0x0, 0x0
.long 0x14d40, 0x14d40, 0x0, 0x0, 0x14e10, 0x14e10, 0x20, 0x20
.long 0x14ee0, 0x14ee0, 0x100000, 0x100000, 0x14fb0, 0x14fb0, 0x100020, 0x100020
.long 0x15080, 0x15080, 0x40, 0x40, 0x15150, 0x15150, 0x60, 0x60
.long 0x15220, 0x15220, 0x100040, 0x100040, 0x100000, 0x100000, 0x100060, 0x100060
.long 0x14d74, 0x14d74, 0x80, 0x80, 0x14e44, 0x14e44, 0xa0, 0xa0
.long 0x14f14, 0x14f14, 0x100080, 0x100080, 0x14fe4, 0x14fe4, 0x1000a0, 0x1000a0
.long 0x150b4, 0x150b4, 0xc0, 0xc0, 0x15184, 0x15184, 0xe0, 0xe0
.long 0x15254, 0x15254, 0x1000c0, 0x1000c0, 0x100000, 0x100000, 0x1000e0, 0x1000e0
.long 0x14da8, 0x14da8, 0x8, 0x100, 0x14e78, 0x14e78, 0x28, 0x120
.long 0x14f48, 0x14f48, 0x100008, 0x100100, 0x15018, 0x15018, 0x100028, 0x100120
.long 0x150e8, 0x150e8, 0x48, 0x140, 0x151b8, 0x151b8, 0x68, 0x160
.long 0x100000, 0x100000, 0x100048, 0x100140, 0x100000, 0x100000, 0x100068, 0x100160
.long 0x14ddc, 0x14ddc, 0x88, 0x180, 0x14eac, 0x14eac, 0xa8, 0x1a0
.long 0x14f7c, 0x14f7c, 0x100088, 0x100180, 0x1504c, 0x1504c, 0x1000a8, 0x1001a0
.long 0x1511c, 0x1511c, 0xc8, 0x1c0, 0x151ec, 0x151ec, 0xe8, 0x1e0
.long 0x100000, 0x100000, 0x1000c8, 0x1001c0, 0x100000, 0x100000, 0x1000e8, 0x1001e0
.long 0x17780, 0x114d40, 0x100, 0x200, 0x17850, 0x114e10, 0x120, 0x220
.long 0x17920, 0x114ee0, 0x100100, 0x100200, 0x179f0, 0x114fb0, 0x100120, 0x100220
.long 0x17ac0, 0x115080, 0x140, 0x240, 0x17b90, 0x115150, 0x160, 0x260
.long 0x17c60, 0x115220, 0x100140, 0x100240, 0x102a40, 0x200000, 0x100160, 0x100260
.long 0x177b4, 0x114d74, 0x180, 0x280, 0x17884, 0x114e44, 0x1a0, 0x2a0
.long 0x17954, 0x114f14, 0x100180, 0x100280, 0x17a24, 0x114fe4, 0x1001a0, 0x1002a0
.long 0x17af4, 0x1150b4, 0x1c0, 0x2c0, 0x17bc4, 0x115184, 0x1e0, 0x2e0
.long 0x17c94, 0x115254, 0x1001c0, 0x1002c0, 0x102a40, 0x200000, 0x1001e0, 0x1002e0
.long 0x177e8, 0x114da8, 0x108, 0x300, 0x178b8, 0x114e78, 0x128, 0x320
.long 0x17988, 0x114f48, 0x100108, 0x100300, 0x17a58, 0x115018, 0x100128, 0x100320
.long 0x17b28, 0x1150e8, 0x148, 0x340, 0x17bf8, 0x1151b8, 0x168, 0x360
.long 0x102a40, 0x200000, 0x100148, 0x100340, 0x102a40, 0x200000, 0x100168, 0x100360
.long 0x1781c, 0x114ddc, 0x188, 0x380, 0x178ec, 0x114eac, 0x1a8, 0x3a0
.long 0x179bc, 0x114f7c, 0x100188, 0x100380, 0x17a8c, 0x11504c, 0x1001a8, 0x1003a0
.long 0x17b5c, 0x11511c, 0x1c8, 0x3c0, 0x17c2c, 0x1151ec, 0x1e8, 0x3e0
.long 0x102a40, 0x200000, 0x1001c8, 0x1003c0, 0x102a40, 0x200000, 0x1001e8, 0x1003e0
.long 0xa400, 0xd00, 0x0, 0x14d40, 0xa440, 0xd00, 0x0, 0x14d80
.long 0xa480, 0xd00, 0x1, 0x14dd0, 0xa4c0, 0xd00, 0x1, 0x14e10
.long 0xa500, 0xd00, 0x2, 0x14e60, 0xa540, 0xd00, 0x2, 0x14ea0
.long 0xa580, 0xd00, 0x3, 0x14ef0, 0xa5c0, 0xd00, 0x3, 0x14f30
.long 0xa600, 0xd00, 0x4, 0x14f40, 0xa640, 0xd00, 0x4, 0x14f80
.long 0xa680, 0xd00, 0x5, 0x14fd0, 0xa6c0, 0xd00, 0x5, 0x15010
.long 0xa700, 0xd00, 0x6, 0x15060, 0xa740, 0xd00, 0x6, 0x150a0
.long 0xa780, 0xd00, 0x7, 0x150f0, 0xa7c0, 0xd00, 0x7, 0x15130
.long 0xa800, 0xd00, 0x8, 0x15140, 0xa840, 0xd00, 0x8, 0x15180
.long 0xa880, 0xd00, 0x9, 0x151d0, 0xa8c0, 0xd00, 0x9, 0x15210
.long 0xa900, 0xd00, 0xa, 0x15260, 0xa940, 0xd00, 0xa, 0x152a0
.long 0xa980, 0xd00, 0xb, 0x152f0, 0xa9c0, 0xd00, 0xb, 0x15330
.long 0xaa00, 0xd00, 0xc, 0x15340, 0xaa40, 0xd00, 0xc, 0x15380
.long 0x1f680, 0x40, 0xd, 0x153d0, 0x100000, 0xd00, 0xd, 0x15410
.long 0x100000, 0xd00, 0xe, 0x15460, 0x100000, 0xd00, 0xe, 0x154a0
.long 0x100000, 0xd00, 0xf, 0x154f0, 0x100000, 0xd00, 0xf, 0x15530
.long 0xa400, 0xd00, 0x2, 0x14d60, 0xa440, 0xd00, 0x2, 0x14da0
.long 0xa480, 0xd00, 0x3, 0x14df0, 0xa4c0, 0xd00, 0x3, 0x14e30
.long 0xa500, 0xd00, 0x4, 0x14e40, 0xa540, 0xd00, 0x4, 0x14e80
.long 0xa580, 0xd00, 0x5, 0x14ed0, 0xa5c0, 0xd00, 0x5, 0x14f10
.long 0xa600, 0xd00, 0x6, 0x14f60, 0xa640, 0xd00, 0x6, 0x14fa0
.long 0xa680, 0xd00, 0x7, 0x14ff0, 0xa6c0, 0xd00, 0x7, 0x15030
.long 0xa700, 0xd00, 0x8, 0x15040, 0xa740, 0xd00, 0x8, 0x15080
.long 0xa780, 0xd00, 0x9, 0x150d0, 0xa7c0, 0xd00, 0x9, 0x15110
.long 0xa800, 0xd00, 0xa, 0x15160, 0xa840, 0xd00, 0xa, 0x151a0
.long 0xa880, 0xd00, 0xb, 0x151f0, 0xa8c0, 0xd00, 0xb, 0x15230
.long 0xa900, 0xd00, 0xc, 0x15240, 0xa940, 0xd00, 0xc, 0x15280
.long 0xa980, 0xd00, 0xd, 0x152d0, 0xa9c0, 0xd00, 0xd, 0x15310
.long 0xaa00, 0xd00, 0xe, 0x15360, 0xaa40, 0xd00, 0xe, 0x153a0
.long 0x1f680, 0x40, 0xf, 0x153f0, 0x100000, 0xd00, 0xf, 0x15430
.long 0x100000, 0xd00, 0x10, 0x15440, 0x100000, 0xd00, 0x10, 0x15480
.long 0x100000, 0xd00, 0x11, 0x154d0, 0x100000, 0xd00, 0x11, 0x15510
.long 0x1f690, 0x1f890, 0x1f9c0, 0x1f9e0, 0x1f698, 0x1f898, 0x1f9c8, 0x1f9e8
.long 0x1f680, 0x1f880, 0x1f9d0, 0x1f9f0, 0x1f688, 0x1f888, 0x1f9d8, 0x100000
.long 0x1fd20, 0x1ff20, 0x1f9c2, 0x1f9e2, 0x1fd28, 0x1ff28, 0x1f9ca, 0x1f9ea
.long 0x1fd30, 0x1ff30, 0x1f9d2, 0x1f9f2, 0x1fd38, 0x1ff38, 0x1f9da, 0x100000
.long 0x1f6f0, 0x1f8f0, 0x1f9c4, 0x1f9e4, 0x1f6f8, 0x1f8f8, 0x1f9cc, 0x1f9ec
.long 0x1f6e0, 0x1f8e0, 0x1f9d4, 0x100000, 0x1f6e8, 0x1f8e8, 0x1f9dc, 0x100000
.long 0x1fd40, 0x1ff40, 0x1f9c6, 0x1f9e6, 0x1fd48, 0x1ff48, 0x1f9ce, 0x1f9ee
.long 0x1fd50, 0x1ff50, 0x1f9d6, 0x100000, 0x1fd58, 0x1ff58, 0x1f9de, 0x100000
.long 0x1f710, 0x1f910, 0x1f9c0, 0x1f9e0, 0x1f718, 0x1f918, 0x1f9c8, 0x1f9e8
.long 0x1f700, 0x1f900, 0x1f9d0, 0x1f9f0, 0x1f708, 0x1f908, 0x1f9d8, 0x100000
.long 0x1fda0, 0x1ffa0, 0x1f9c2, 0x1f9e2, 0x1fda8, 0x1ffa8, 0x1f9ca, 0x1f9ea
.long 0x1fdb0, 0x1ffb0, 0x1f9d2, 0x1f9f2, 0x1fdb8, 0x1ffb8, 0x1f9da, 0x100000
.long 0x1f770, 0x1f970, 0x1f9c4, 0x1f9e4, 0x1f778, 0x1f978, 0x1f9cc, 0x1f9ec
.long 0x1f760, 0x1f960, 0x1f9d4, 0x100000, 0x1f768, 0x1f968, 0x1f9dc, 0x100000
.long 0x1fdc0, 0x1ffc0, 0x1f9c6, 0x1f9e6, 0x1fdc8, 0x1ffc8, 0x1f9ce, 0x1f9ee
.long 0x1fdd0, 0x1ffd0, 0x1f9d6, 0x100000, 0x1fdd8, 0x1ffd8, 0x1f9de, 0x100000
.long 0x1f790, 0x1f990, 0x1f9c0, 0x1f9e0, 0x1f798, 0x1f998, 0x1f9c8, 0x1f9e8
.long 0x1f780, 0x1f980, 0x1f9d0, 0x1f9f0, 0x1f788, 0x1f988, 0x1f9d8, 0x100000
.long 0x1fe20, 0x20020, 0x1f9c2, 0x1f9e2, 0x1fe28, 0x20028, 0x1f9ca, 0x1f9ea
.long 0x1fe30, 0x20030, 0x1f9d2, 0x1f9f2, 0x1fe38, 0x20038, 0x1f9da, 0x100000
.long 0x1f7f0, 0x14d00, 0x1f9c4, 0x1f9e4, 0x1f7f8, 0x14d08, 0x1f9cc, 0x1f9ec
.long 0x1f7e0, 0x14d10, 0x1f9d4, 0x100000, 0x1f7e8, 0x14d18, 0x1f9dc, 0x100000
.long 0x1fe40, 0x14d00, 0x1f9c6, 0x1f9e6, 0x1fe48, 0x14d08, 0x1f9ce, 0x1f9ee
.long 0x1fe50, 0x14d10, 0x1f9d6, 0x100000, 0x1fe58, 0x14d18, 0x1f9de, 0x100000
.long 0x1f810, 0x14d00, 0x1f9c0, 0x1f9e0, 0x1f818, 0x14d08, 0x1f9c8, 0x1f9e8
.long 0x1f800, 0x14d10, 0x1f9d0, 0x1f9f0, 0x1f808, 0x14d18, 0x1f9d8, 0x100000
.long 0x1fea0, 0x14d00, 0x1f9c2, 0x1f9e2, 0x1fea8, 0x14d08, 0x1f9ca, 0x1f9ea
.long 0x1feb0, 0x14d10, 0x1f9d2, 0x1f9f2, 0x1feb8, 0x14d18, 0x1f9da, 0x100000
.long 0x1f870, 0x14d00, 0x1f9c4, 0x1f9e4, 0x1f878, 0x14d08, 0x1f9cc, 0x1f9ec
.long 0x1f860, 0x14d10, 0x1f9d4, 0x100000, 0x1f868, 0x14d18, 0x1f9dc, 0x100000
.long 0x1fec0, 0x14d00, 0x1f9c6, 0x1f9e6, 0x1fec8, 0x14d08, 0x1f9ce, 0x1f9ee
.long 0x1fed0, 0x14d10, 0x1f9d6, 0x100000, 0x1fed8, 0x14d18, 0x1f9de, 0x100000
.long 0x1fa28, 0x1f9f4, 0x34, 0x14d00, 0x1fa28, 0x1f9f6, 0x74, 0x14d04
.long 0x1fa28, 0x1f9f8, 0xb4, 0x14d08, 0x1fa28, 0x1f9fa, 0xf4, 0x14d0c
.long 0x1fa28, 0x1f9fc, 0x134, 0x14d10, 0x1fa28, 0x1f9fe, 0x174, 0x14d14
.long 0x1fa28, 0x1fa00, 0x1b4, 0x14d18, 0x1fa28, 0x1fa02, 0x1f4, 0x14d1c
.long 0x1fa28, 0x1fa04, 0x234, 0x14d20, 0x1fa28, 0x1fa06, 0x274, 0x14d24
.long 0x1fa28, 0x1fa08, 0x2b4, 0x14d28, 0x1fa28, 0x1fa0a, 0x2f4, 0x14d2c
.long 0x1fa28, 0x1fa0c, 0x334, 0x14d30, 0x1fa28, 0x1fa0e, 0x374, 0x14d34
.long 0x1fa28, 0x1fa10, 0x3b4, 0x14d38, 0x1fa28, 0x1fa12, 0x3f4, 0x14d3c
.long 0x1fa28, 0x1fa14, 0x434, 0x14d00, 0x1fa28, 0x1fa16, 0x474, 0x14d04
.long 0x1fa28, 0x1fa18, 0x4b4, 0x14d08, 0x1fa28, 0x1fa1a, 0x4f4, 0x14d0c
.long 0x1fa28, 0x1fa1c, 0x534, 0x14d10, 0x1fa28, 0x1fa1e, 0x574, 0x14d14
.long 0x1fa28, 0x1fa20, 0x5b4, 0x14d18, 0x1fa28, 0x1fa22, 0x5f4, 0x14d1c
.long 0x1fa28, 0x1fa24, 0x634, 0x14d20, 0x1fa28, 0x1fa26, 0x674, 0x14d24
.long 0x1fa28, 0x1fa28, 0x6b4, 0x14d28, 0x1fa28, 0x1fa2a, 0x6f4, 0x14d2c
.long 0x1fa28, 0x1fa2c, 0x734, 0x14d30, 0x1fa28, 0x1fa2e, 0x774, 0x14d34
.long 0x1fa28, 0x1fa30, 0x7b4, 0x14d38, 0x1fa28, 0x1fa32, 0x7f4, 0x14d3c
.long 0x1fa38, 0x1fa34, 0x834, 0x14d00, 0x1fa38, 0x1fa36, 0x874, 0x14d04
.long 0x1fa38, 0x1fa38, 0x8b4, 0x14d08, 0x1fa38, 0x1fa3a, 0x8f4, 0x14d0c
.long 0x1fa38, 0x1fa3c, 0x934, 0x14d10, 0x1fa38, 0x1fa3e, 0x974, 0x14d14
.long 0x1fa38, 0x1fa40, 0x9b4, 0x14d18, 0x1fa38, 0x1fa42, 0x9f4, 0x14d1c
.long 0x1fa38, 0x1fa44, 0xa34, 0x14d20, 0x1fa38, 0x1fa46, 0xa74, 0x14d24
.long 0x1fa38, 0x1fa48, 0xab4, 0x14d28, 0x1fa38, 0x1fa4a, 0xaf4, 0x14d2c
.long 0x1fa38, 0x1fa4c, 0xb34, 0x14d30, 0x1fa38, 0x1fa4e, 0xb74, 0x14d34
.long 0x1fa38, 0x1fa50, 0xbb4, 0x14d38, 0x1fa38, 0x1fa52, 0xbf4, 0x14d3c
.long 0x1fa38, 0x1fa54, 0xc34, 0x14d00, 0x1fa38, 0x1fa56, 0xc74, 0x14d04
.long 0x1fa38, 0x1fa58, 0xcb4, 0x14d08, 0x1fa38, 0x1fa5a, 0xcf4, 0x14d0c
.long 0x1fa38, 0x1fa5c, 0xd34, 0x14d10, 0x1fa38, 0x1fa5e, 0xd74, 0x14d14
.long 0x1fa38, 0x1fa60, 0xdb4, 0x14d18, 0x1fa38, 0x1fa62, 0xdf4, 0x14d1c
.long 0x1fa38, 0x1fa64, 0xe34, 0x14d20, 0x1fa38, 0x1fa66, 0xe74, 0x14d24
.long 0x1fa38, 0x1fa68, 0xeb4, 0x14d28, 0x1fa38, 0x1fa6a, 0xef4, 0x14d2c
.long 0x1fa38, 0x1fa6c, 0xf34, 0x14d30, 0x1fa38, 0x1fa6e, 0xf74, 0x14d34
.long 0x1fa38, 0x1fa70, 0xfb4, 0x14d38, 0x1fa38, 0x1fa72, 0xff4, 0x14d3c
.long 0x13320, 0xa9b0, 0xa800, 0x10c00, 0xf320, 0xc120, 0x133b0, 0xb690
.long 0xa890, 0x11920, 0xf3b0, 0xce00, 0x12600, 0xa920, 0xb520, 0x10c90
.long 0xe600, 0xc090, 0x12690, 0xb600, 0xb5b0, 0x119b0, 0xe690, 0xcdb0
.long 0xd5f0, 0x11440, 0x117f0, 0x130d0, 0xf8d0, 0xadf0, 0xd640, 0x12160
.long 0x11840, 0x13df0, 0xf960, 0xbad0, 0xc8d0, 0x113f0, 0x124d0, 0x13160
.long 0xebf0, 0xad60, 0xc960, 0x120d0, 0x12560, 0x13e40, 0xec40, 0xba40
.long 0xefb0, 0x10ed0, 0x117b0, 0x12a40, 0xfa90, 0xdb60, 0xc890, 0x10d60
.long 0x10a90, 0x129f0, 0x13bb0, 0xddf0, 0xf000, 0x11bf0, 0x11520, 0xe960
.long 0xc160, 0xf9b0, 0xc920, 0x11a40, 0x10800, 0xe8d0, 0xc3f0, 0x13a90
.long 0xce40, 0xfa00, 0xfff0, 0xbb20, 0xedb0, 0xdad0, 0xced0, 0x10720
.long 0x10040, 0xc800, 0x14890, 0xde40, 0xf560, 0xfbb0, 0x140d0, 0xbdb0
.long 0xb3f0, 0xec00, 0xf5f0, 0x10890, 0x14160, 0xca90, 0xb760, 0x14720
.long 0x13520, 0xddb0, 0xa520, 0xbe00, 0xf490, 0xe800, 0x13690, 0x10490
.long 0xa5b0, 0xcb20, 0xe7b0, 0x14d00, 0x12800, 0xdd20, 0xb200, 0xbe90
.long 0xf800, 0x14320, 0x129b0, 0x10400, 0xb290, 0xcbb0, 0xeb20, 0x14290
.long 0xd560, 0x10760, 0x112d0, 0xaed0, 0xfb60, 0xeed0, 0xd3f0, 0xe040
.long 0x11360, 0xbbf0, 0xee40, 0x14d00, 0xc840, 0x106d0, 0x11ff0, 0xaf60
.long 0xfed0, 0x149f0, 0xc6d0, 0xdff0, 0x12040, 0xbc40, 0xf1f0, 0x14960
.long 0xbbb0, 0x10cd0, 0xfdb0, 0x12960, 0xd3b0, 0xd9f0, 0x13090, 0x11160
.long 0x13e90, 0x12bf0, 0xbff0, 0xd290, 0xbc00, 0x119f0, 0xfb20, 0xe840
.long 0xac90, 0xd840, 0x13120, 0x11e40, 0x13c00, 0xead0, 0xbe40, 0xabb0
.long 0xcf60, 0x11400, 0x101f0, 0xef20, 0x12e90, 0xdd60, 0xccd0, 0xd320
.long 0x10560, 0x14a00, 0xb640, 0x12d20, 0xf640, 0x115b0, 0x142d0, 0xf1b0
.long 0x121b0, 0xdcd0, 0xf3f0, 0xd490, 0x14640, 0x14c90, 0xb5f0, 0x12000
.long 0x13600, 0xf7b0, 0xa490, 0xb120, 0x10d20, 0xc200, 0x135b0, 0xea90
.long 0xa400, 0x14d00, 0x10db0, 0xcf20, 0x12920, 0xf720, 0xaa00, 0x14000
.long 0x11a00, 0xc290, 0x12890, 0xea00, 0xb720, 0x14090, 0x11a90, 0xcfb0
.long 0xd4d0, 0xfa40, 0x11760, 0x123f0, 0x12cd0, 0xaff0, 0xd440, 0xed60
.long 0x116d0, 0x14d00, 0x12d60, 0xbcd0, 0xc7f0, 0xf9f0, 0x118d0, 0x14ad0
.long 0x139f0, 0xb040, 0xc760, 0xecd0, 0x125f0, 0x14b60, 0x13a40, 0xbd60
.long 0xe290, 0x10e40, 0xc9b0, 0x12760, 0xfe00, 0x13640, 0x10df0, 0xd5b0
.long 0xf090, 0x128d0, 0x13f20, 0x138d0, 0xe320, 0x11b60, 0x12640, 0xafb0
.long 0xfe90, 0x14360, 0x11ad0, 0xd600, 0xe560, 0xad20, 0x13fb0, 0x145f0
.long 0xe000, 0xcd60, 0x10920, 0x102d0, 0xa6d0, 0xebb0, 0xd040, 0x12e00
.long 0xfc00, 0x10240, 0xaa40, 0x14690, 0xe1b0, 0xf440, 0x103f0, 0x12320
.long 0xe7f0, 0xee00, 0xf760, 0x12fb0, 0x144d0, 0x125b0, 0xeb60, 0x14920
.long 0x13720, 0x111b0, 0xdb20, 0xf400, 0x11090, 0x11d20, 0x137b0, 0x11e90
.long 0xda90, 0xe720, 0x11db0, 0x14d00, 0x12a00, 0x11120, 0x10200, 0xf5b0
.long 0x11200, 0x14400, 0x12a90, 0x11e00, 0x101b0, 0xe890, 0x11f20, 0x14490
.long 0xd6d0, 0x12e40, 0x108d0, 0xfc40, 0x13240, 0x13ed0, 0xd760, 0x13b60
.long 0x10840, 0xef60, 0x13f60, 0x14d00, 0xc9f0, 0x12df0, 0xe1f0, 0xfad0
.long 0x132d0, 0x14bf0, 0xca40, 0x13ad0, 0xe160, 0xedf0, 0x13ff0, 0x14c40
.long 0x11690, 0x11040, 0xde90, 0xa640, 0x10b20, 0x136d0, 0x109b0, 0x10ff0
.long 0xa5f0, 0xd1b0, 0x10bb0, 0x143f0, 0x11720, 0x11d60, 0xdf20, 0xb360
.long 0xb000, 0x13360, 0x10a00, 0x11cd0, 0xb2d0, 0xd200, 0xb090, 0x14040
.long 0xcbf0, 0xb920, 0xe400, 0x13560, 0xa560, 0xc490, 0xcc40, 0xc600
.long 0x13840, 0x13200, 0xe640, 0xc720, 0xf2d0, 0xba90, 0xdfb0, 0xc040
.long 0xa8d0, 0x11fb0, 0xf360, 0xc7b0, 0xc360, 0x12db0, 0xe9f0, 0x12200
.long 0x13400, 0xc3b0, 0xdc00, 0x10e00, 0xbfb0, 0xcc00, 0x13490, 0xd090
.long 0xdc90, 0x11b20, 0xcc90, 0x14d00, 0x12720, 0xc320, 0x10320, 0x10fb0
.long 0xc400, 0x14120, 0x127b0, 0xd000, 0x103b0, 0x11c90, 0xd120, 0x141b0
.long 0xd1f0, 0xac40, 0x10ad0, 0x13040, 0xab60, 0xb7f0, 0xd240, 0xb960
.long 0x10b60, 0x13d60, 0xb840, 0x14d00, 0xc4d0, 0xabf0, 0xe3f0, 0x12ed0
.long 0xb0d0, 0x146d0, 0xc560, 0xb8d0, 0xe440, 0x13bf0, 0xbdf0, 0x14760
.long 0xfc90, 0x10f60, 0x11290, 0xa840, 0x13d20, 0x104d0, 0x13db0, 0x111f0
.long 0x105b0, 0xa7f0, 0x13c90, 0xf7f0, 0xfd20, 0x11c40, 0x11320, 0xb560
.long 0xae00, 0xff60, 0x13e00, 0x11ed0, 0x10600, 0xb4d0, 0xadb0, 0xf240
.long 0xcdf0, 0xed20, 0x133f0, 0xbd20, 0x12c40, 0x14bb0, 0xd160, 0x14800
.long 0x13440, 0xca00, 0x11f60, 0x14b20, 0xf4d0, 0xee90, 0xbed0, 0xb890
.long 0x12ad0, 0x12490, 0xf840, 0x149b0, 0xbf60, 0xc5b0, 0x11df0, 0x12400
.long 0x12bb0, 0x13800, 0xd920, 0xc000, 0x14600, 0x14d00, 0x13890, 0x14d00
.long 0xd9b0, 0xcd20, 0xc5f0, 0x14d00, 0x13920, 0x145b0, 0x10000, 0xc1b0
.long 0xb1b0, 0x14d00, 0x12c00, 0x14520, 0x10090, 0xce90, 0xfbf0, 0x14d00
.long 0xc640, 0xd2d0, 0x105f0, 0xae40, 0x14cd0, 0x14d00, 0xd360, 0x14d00
.long 0x10640, 0xbb60, 0xbf20, 0x14d00, 0xd7f0, 0x14840, 0xded0, 0xacd0
.long 0x10290, 0x14d00, 0xcad0, 0x147f0, 0xdf60, 0xb9f0, 0x11000, 0x14d00
.long 0x14a90, 0x11240, 0xf890, 0xa760, 0x14d00, 0xaad0, 0x123b0, 0x110d0
.long 0x139b0, 0xa9f0, 0x14d00, 0x12b20, 0x10c40, 0xae90, 0xf920, 0xb440
.long 0xe0d0, 0x14d00, 0x11960, 0xaf20, 0x13a00, 0xb6d0, 0x131f0, 0x14d00
.long 0x13b20, 0xd0d0, 0x135f0, 0xf120, 0x14d00, 0x12440, 0xac00, 0xcb60
.long 0x13960, 0x14c00, 0xf520, 0x14d00, 0xcff0, 0x12120, 0xc0d0, 0xec90
.long 0xda40, 0xe090, 0xf6d0, 0x12290, 0xc440, 0x147b0, 0x14d00, 0x14d00
.long 0xa600, 0xd800, 0xdbb0, 0x10120, 0x0, 0x0, 0xa7b0, 0xff20
.long 0xda00, 0x14d00, 0x0, 0x0, 0xb320, 0xd890, 0xde00, 0x14200
.long 0x0, 0x0, 0xb490, 0xffb0, 0x10520, 0x143b0, 0x0, 0x0
.long 0x11640, 0x109f0, 0x107f0, 0xe240, 0x0, 0x0, 0x114d0, 0xe2d0
.long 0x10960, 0x14d00, 0x0, 0x0, 0x12360, 0x10a40, 0x10bf0, 0x14a40
.long 0x0, 0x0, 0x121f0, 0xe360, 0xe4d0, 0x148d0, 0x0, 0x0
.long 0xbc90, 0x126d0, 0x12c90, 0xa960, 0x0, 0x0, 0x131b0, 0x12b60
.long 0xb7b0, 0xa4d0, 0x0, 0x0, 0xba00, 0xe5f0, 0xa440, 0xaa90
.long 0x0, 0x0, 0x12f20, 0xea40, 0xb160, 0xab20, 0x0, 0x0
.long 0x10360, 0x11600, 0xd720, 0x134d0, 0x0, 0x0, 0x100d0, 0xd520
.long 0x11800, 0x13760, 0x0, 0x0, 0x14440, 0x11890, 0x137f0, 0x12520
.long 0x0, 0x0, 0x141f0, 0xd7b0, 0xc2d0, 0x12090, 0x0, 0x0
.long 0xa720, 0xf200, 0xf600, 0x10f20, 0x0, 0x0, 0xa690, 0xe520
.long 0xf690, 0x11c00, 0x0, 0x0, 0xb400, 0xf290, 0xe920, 0x10e90
.long 0x0, 0x0, 0xb3b0, 0xe5b0, 0xe9b0, 0x11bb0, 0x0, 0x0
.long 0x115f0, 0xfcd0, 0xfdf0, 0x12ff0, 0x0, 0x0, 0x11560, 0xeff0
.long 0xfe40, 0x13cd0, 0x0, 0x0, 0x122d0, 0xfd60, 0xf0d0, 0x12f60
.long 0x0, 0x0, 0x12240, 0xf040, 0xf160, 0x13c40, 0x0, 0x0
.long 0xe3b0, 0x12840, 0x11490, 0xdc40, 0x0, 0x0, 0x127f0, 0xd690
.long 0x107b0, 0xdbf0, 0x0, 0x0, 0xe120, 0xe760, 0xc240, 0x113b0
.long 0x0, 0x0, 0xe6d0, 0xd400, 0xc1f0, 0x10690, 0x0, 0x0
.long 0xe200, 0x10160, 0xb9b0, 0xd8d0, 0x0, 0x0, 0x10440, 0x13000
.long 0xc690, 0xd960, 0x0, 0x0, 0xe490, 0x14240, 0xb1f0, 0xb800
.long 0x0, 0x0, 0x14560, 0x13290, 0xb240, 0xc520, 0x0, 0x0
.long 0x0, 0x0, 0x0, 0x0, 0x0, 0x0, 0x0, 0x0
.long 0x0, 0x0, 0x0, 0x0, 0x0, 0x0, 0x0, 0x0
.long 0x0, 0x0, 0x0, 0x0, 0x0, 0x0, 0x0, 0x0
.long 0x0, 0x0, 0x0, 0x0, 0x0, 0x0, 0x0, 0x0
.long 0x0, 0x0, 0x0, 0x0, 0x0, 0x0, 0x0, 0x0
.long 0x0, 0x0, 0x0, 0x0, 0x0, 0x0, 0x0, 0x0
.long 0x0, 0x0, 0x0, 0x0, 0x0, 0x0, 0x0, 0x0
.long 0x0, 0x0, 0x0, 0x0, 0x0, 0x0, 0x0, 0x0
.long 0x0, 0x0, 0x0, 0x0, 0x0, 0x0, 0x0, 0x0
.long 0x0, 0x0, 0x0, 0x0, 0x0, 0x0, 0x0, 0x0
.long 0x0, 0x0, 0x0, 0x0, 0x0, 0x0, 0x0, 0x0
.long 0x0, 0x0, 0x0, 0x0, 0x0, 0x0, 0x0, 0x0
.long 0x0, 0x0, 0x0, 0x0, 0x0, 0x0, 0x0, 0x0
.long 0x0, 0x0, 0x0, 0x0, 0x0, 0x0, 0x0, 0x0
.long 0x0, 0x0, 0x0, 0x0, 0x0, 0x0, 0x0, 0x0
.long 0x0, 0x0, 0x0, 0x0, 0x0, 0x0, 0x0, 0x0
.long 0x0, 0x0, 0x0, 0x0, 0x0, 0x0, 0x0, 0x0
.long 0x0, 0x0, 0x0, 0x0, 0x0, 0x0, 0x0, 0x0
.long 0x0, 0x0, 0x0, 0x0, 0x0, 0x0, 0x0, 0x0
.long 0x0, 0x0, 0x0, 0x0, 0x0, 0x0, 0x0, 0x0
.long 0x0, 0x0, 0x0, 0x0, 0x0, 0x0, 0x0, 0x0
.long 0x0, 0x0, 0x0, 0x0, 0x0, 0x0, 0x0, 0x0
.long 0x0, 0x0, 0x0, 0x0, 0x0, 0x0, 0x0, 0x0
.long 0x0, 0x0, 0x0, 0x0, 0x0, 0x0, 0x0, 0x0
.long 0x0, 0x0, 0x0, 0x0, 0x0, 0x0, 0x0, 0x0
.long 0x0, 0x0, 0x0, 0x0, 0x0, 0x0, 0x0, 0x0
.long 0x0, 0x0, 0x0, 0x0, 0x0, 0x0, 0x0, 0x0
.long 0x0, 0x0, 0x0, 0x0, 0x0, 0x0, 0x0, 0x0
.long 0x0, 0x0, 0x0, 0x0, 0x0, 0x0, 0x0, 0x0
.long 0x0, 0x0, 0x0, 0x0, 0x0, 0x0, 0x0, 0x0
.long 0x0, 0x0, 0x0, 0x0, 0x0, 0x0, 0x0, 0x0
.long 0x0, 0x0, 0x0, 0x0, 0x0, 0x0, 0x0, 0x0
.section .rodata,"a"
.p2align 6
.amdhsa_kernel standalone__deep_cross_xdeepfm__recsys_kernel
  .amdhsa_next_free_vgpr 256
  .amdhsa_next_free_sgpr 102
  .amdhsa_accum_offset 256
  .amdhsa_group_segment_fixed_size 0
  .amdhsa_kernarg_size 88
  .amdhsa_user_sgpr_count 2
  .amdhsa_user_sgpr_kernarg_segment_ptr 1
  .amdhsa_system_sgpr_workgroup_id_x 1
  .amdhsa_float_denorm_mode_32 3
.end_amdhsa_kernel
```

```asm
; @launch grid=(256,1,1) block=(512,1,1) lds=163840
.amdgcn_target "amdgcn-amd-amdhsa--gfx950"
.text
.globl standalone__deep_cross_xdeepfm__recsys_kernel
.p2align 8
.type standalone__deep_cross_xdeepfm__recsys_kernel,@function
standalone__deep_cross_xdeepfm__recsys_kernel:
  s_cmp_ge_u32 s2, 256
  s_cbranch_scc1 L_end
  s_load_dwordx16 s[4:19], s[0:1], 0
  s_load_dwordx4 s[20:23], s[0:1], 64
  s_load_dwordx2 s[24:25], s[0:1], 80
  v_lshrrev_b32 v1, 6, v0
  s_getpc_b64 s[92:93]
L_pc:
  s_and_b32 s68, s2, 0xf8
  v_add_u32 v2, s68, v1
  v_and_b32_e64 v3, 32, v0
  v_lshl_add_u32 v2, v3, 3, v2
  v_lshlrev_b32 v2, 7, v2
  v_min_u32 v2, L_end-L_pc, v2
  v_mov_b32 v3, s93
  v_add_co_u32 v2, vcc, s92, v2
  s_nop 1
  v_addc_co_u32 v3, vcc, 0, v3, vcc
  global_load_dword v251, v[2:3], off
  v_and_b32_e64 v0, 63, v0
  v_readfirstlane_b32 s3, v1
  s_and_b32 s68, s2, 7
  s_lshr_b32 s69, s2, 3
  s_and_b32 s80, s2, 0xf8
  s_add_u32 s80, s80, s3
  s_lshl_b32 s80, s80, 0
  s_min_u32 s70, s68, 1
  s_add_u32 s71, s69, s70
  s_cmp_ge_u32 s71, 22
  s_cbranch_scc1 L_cin
  s_mul_i32 s68, s68, 21
  s_add_u32 s68, s68, s71
  s_mul_i32 s26, s68, 5042
  s_lshr_b32 s26, s26, 16
  s_mul_i32 s69, s26, 13
  s_sub_u32 s27, s68, s69
  s_lshl_b32 s77, s27, 8
  s_mul_i32 s71, s26, 320
  v_lshrrev_b32 v116, 4, v0
  v_lshlrev_b32 v11, 4, v0
  s_and_b32 s79, s3, 3
  s_cmp_lt_u32 s3, 4
  s_cbranch_scc1 L_cmp
  s_mul_i32 s68, s27, 13
  s_lshr_b32 s68, s68, 4
  s_mul_i32 s69, s79, 10
  s_mul_i32 s78, s71, 104
  v_mul_u32_u24 v118, 48, v116
  v_sub_u32 v12, v11, v118
  s_add_u32 s70, s68, 0
  s_sub_u32 s81, s70, 10
  s_min_u32 s70, s70, s81
  s_add_u32 s70, s70, s69
  s_lshl_b32 s36, s70, 10
  s_mul_i32 s70, s70, 832
  s_add_u32 s94, s70, s78
  s_and_b32 s70, s79, 1
  s_lshl_b32 s70, s70, 3
  v_lshlrev_b32 v117, 1, v116
  v_or_b32 v117, s70, v117
  v_xor_b32 v117, v117, v0
  v_and_b32 v117, 15, v117
  v_mul_u32_u24 v4, 3328, v116
  v_lshl_add_u32 v4, v117, 4, v4
  v_add_u32 v5, 13312, v4
  s_mul_i32 s74, s79, 26624
  s_add_u32 s74, s74, s77
  s_lshl_b32 s75, s79, 11
  s_waitcnt lgkmcnt(0)
  s_mov_b32 s28, s4
  s_and_b32 s29, s5, 0xffff
  s_mov_b32 s30, 425984
  s_mov_b32 s31, 0x20000
  buffer_load_dwordx4 v[16:19], v12, s[28:31], s94 offen
  s_mov_b32 s32, s6
  s_and_b32 s33, s7, 0xffff
  s_mov_b32 s34, 12800000
  s_mov_b32 s35, 0x20000
  s_mov_b32 s44, s12
  s_and_b32 s45, s13, 0xffff
  s_mov_b32 s46, 5537792
  s_mov_b32 s47, 0x20000
  s_add_u32 m0, s75, 122880
  s_nop 0
  buffer_load_dwordx4 v4, s[44:47], s74 offen lds
  s_add_u32 m0, s75, 123904
  s_nop 0
  buffer_load_dwordx4 v5, s[44:47], s74 offen lds
  s_add_u32 s74, s74, 106496
  s_add_u32 s70, s68, 1
  s_sub_u32 s81, s70, 10
  s_min_u32 s70, s70, s81
  s_add_u32 s70, s70, s69
  s_lshl_b32 s37, s70, 10
  s_mul_i32 s70, s70, 832
  s_add_u32 s95, s70, s78
  buffer_load_dwordx4 v[20:23], v12, s[28:31], s95 offen
  s_add_u32 s70, s68, 2
  s_sub_u32 s81, s70, 10
  s_min_u32 s70, s70, s81
  s_add_u32 s70, s70, s69
  s_lshl_b32 s38, s70, 10
  s_mul_i32 s70, s70, 832
  s_add_u32 s96, s70, s78
  buffer_load_dwordx4 v[24:27], v12, s[28:31], s96 offen
  s_add_u32 s70, s68, 3
  s_sub_u32 s81, s70, 10
  s_min_u32 s70, s70, s81
  s_add_u32 s70, s70, s69
  s_lshl_b32 s39, s70, 10
  s_mul_i32 s70, s70, 832
  s_add_u32 s97, s70, s78
  buffer_load_dwordx4 v[28:31], v12, s[28:31], s97 offen
  s_add_u32 s70, s68, 4
  s_sub_u32 s81, s70, 10
  s_min_u32 s70, s70, s81
  s_add_u32 s70, s70, s69
  s_lshl_b32 s40, s70, 10
  s_mul_i32 s70, s70, 832
  s_add_u32 s98, s70, s78
  buffer_load_dwordx4 v[32:35], v12, s[28:31], s98 offen
  s_add_u32 s70, s68, 5
  s_sub_u32 s81, s70, 10
  s_min_u32 s70, s70, s81
  s_add_u32 s70, s70, s69
  s_lshl_b32 s41, s70, 10
  s_mul_i32 s70, s70, 832
  s_add_u32 s99, s70, s78
  buffer_load_dwordx4 v[36:39], v12, s[28:31], s99 offen
  s_add_u32 s70, s68, 6
  s_sub_u32 s81, s70, 10
  s_min_u32 s70, s70, s81
  s_add_u32 s70, s70, s69
  s_lshl_b32 s42, s70, 10
  s_mul_i32 s70, s70, 832
  s_add_u32 s100, s70, s78
  buffer_load_dwordx4 v[40:43], v12, s[28:31], s100 offen
  s_add_u32 s70, s68, 7
  s_sub_u32 s81, s70, 10
  s_min_u32 s70, s70, s81
  s_add_u32 s70, s70, s69
  s_lshl_b32 s43, s70, 10
  s_mul_i32 s70, s70, 832
  s_add_u32 s101, s70, s78
  buffer_load_dwordx4 v[44:47], v12, s[28:31], s101 offen
  s_add_u32 s70, s68, 8
  s_sub_u32 s81, s70, 10
  s_min_u32 s70, s70, s81
  s_add_u32 s70, s70, s69
  s_lshl_b32 s48, s70, 10
  s_mul_i32 s70, s70, 832
  s_add_u32 s82, s70, s78
  buffer_load_dwordx4 v[48:51], v12, s[28:31], s82 offen
  s_add_u32 s70, s68, 9
  s_sub_u32 s81, s70, 10
  s_min_u32 s70, s70, s81
  s_add_u32 s70, s70, s69
  s_lshl_b32 s49, s70, 10
  s_mul_i32 s70, s70, 832
  s_add_u32 s83, s70, s78
  buffer_load_dwordx4 v[52:55], v12, s[28:31], s83 offen
  s_and_b32 s70, s68, 1
  s_lshl_b32 s70, s70, 6
  v_and_b32 v118, 7, v0
  v_xor_b32 v118, v118, v116
  v_lshlrev_b32 v118, 4, v118
  v_xor_b32 v2, s70, v118
  v_xor_b32 v3, 64, v2
  s_mov_b32 s72, 0
  s_mul_i32 s70, s79, 13
  s_add_u32 s70, s70, s27
  s_min_u32 s70, s70, 39
  s_lshl_b32 s70, s70, 3
  s_add_u32 s70, s70, s71
  s_mul_i32 s84, s70, 104
  v_lshrrev_b32 v118, 2, v0
  v_min_u32 v118, 7, v118
  v_mul_u32_u24 v118, 104, v118
  v_and_b32 v117, 3, v0
  v_lshl_add_u32 v7, v117, 2, v118
  s_lshl_b32 s70, s26, 2
  s_add_u32 s70, s70, s79
  s_add_u32 s70, s70, 384
  s_mul_i32 s85, s70, 3328
  s_add_u32 s85, s85, s77
  s_mov_b32 s70, 173056
  v_lshrrev_b32 v118, 1, v0
  v_mul_lo_u32 v118, s70, v118
  v_and_b32 v117, 1, v0
  v_lshl_add_u32 v76, v117, 7, v118
  s_mov_b32 s52, s16
  s_and_b32 s53, s17, 0xffff
  s_mov_b32 s54, 3328
  s_mov_b32 s55, 0x20000
  s_mul_i32 s70, s79, 2560
  s_add_u32 s70, s70, L_tail-L_pc
  v_lshlrev_b32 v8, 7, v0
  v_add_u32 v8, s70, v8
  v_mov_b32 v9, s93
  v_add_co_u32 v8, vcc, s92, v8
  s_nop 1
  v_addc_co_u32 v9, vcc, 0, v9, vcc
  s_waitcnt vmcnt(11)
  v_lshlrev_b32 v16, 7, v16
  v_lshlrev_b32 v18, 7, v18
  v_lshlrev_b32 v17, 7, v17
  v_lshlrev_b32_e64 v19, 7, v19
  v_add_u32_dpp v56, v16, v2 row_newbcast:0 row_mask:0xf bank_mask:0x3
  s_nop 1
  v_add_u32_dpp v56, v18, v2 row_newbcast:6 row_mask:0xf bank_mask:0xc
  s_add_u32 m0, s36, 0
  s_nop 0
  buffer_load_dwordx4 v56, s[32:35], 0 offen lds
  s_add_u32 m0, s75, 131072
  s_nop 0
  buffer_load_dwordx4 v4, s[44:47], s74 offen lds
  s_add_u32 m0, s75, 132096
  s_nop 0
  buffer_load_dwordx4 v5, s[44:47], s74 offen lds
  s_add_u32 s74, s74, 106496
  s_waitcnt vmcnt(11)
  v_lshlrev_b32 v20, 7, v20
  v_lshlrev_b32 v22, 7, v22
  v_lshlrev_b32 v21, 7, v21
  v_lshlrev_b32 v23, 7, v23
  v_add_u32_dpp v57, v20, v3 row_newbcast:0 row_mask:0xf bank_mask:0x3
  s_nop 1
  v_add_u32_dpp v57, v22, v3 row_newbcast:6 row_mask:0xf bank_mask:0xc
  s_add_u32 m0, s37, 0
  s_nop 0
  buffer_load_dwordx4 v57, s[32:35], 0 offen lds
  s_waitcnt vmcnt(11)
  v_lshlrev_b32 v24, 7, v24
  v_lshlrev_b32 v26, 7, v26
  v_lshlrev_b32 v25, 7, v25
  v_lshlrev_b32_e64 v27, 7, v27
  v_add_u32_dpp v58, v24, v2 row_newbcast:0 row_mask:0xf bank_mask:0x3
  s_nop 1
  v_add_u32_dpp v58, v26, v2 row_newbcast:6 row_mask:0xf bank_mask:0xc
  s_add_u32 m0, s38, 0
  s_nop 0
  buffer_load_dwordx4 v58, s[32:35], 0 offen lds
  s_waitcnt vmcnt(11)
  v_lshlrev_b32 v28, 7, v28
  v_lshlrev_b32 v30, 7, v30
  v_lshlrev_b32 v29, 7, v29
  v_lshlrev_b32 v31, 7, v31
  v_add_u32_dpp v59, v28, v3 row_newbcast:0 row_mask:0xf bank_mask:0x3
  s_nop 1
  v_add_u32_dpp v59, v30, v3 row_newbcast:6 row_mask:0xf bank_mask:0xc
  s_add_u32 m0, s39, 0
  s_nop 0
  buffer_load_dwordx4 v59, s[32:35], 0 offen lds
  s_waitcnt vmcnt(11)
  v_lshlrev_b32 v32, 7, v32
  v_lshlrev_b32 v34, 7, v34
  v_lshlrev_b32 v33, 7, v33
  v_lshlrev_b32 v35, 7, v35
  v_add_u32_dpp v60, v32, v2 row_newbcast:0 row_mask:0xf bank_mask:0x3
  s_nop 1
  v_add_u32_dpp v60, v34, v2 row_newbcast:6 row_mask:0xf bank_mask:0xc
  s_add_u32 m0, s40, 0
  s_nop 0
  buffer_load_dwordx4 v60, s[32:35], 0 offen lds
  s_waitcnt vmcnt(11)
  v_lshlrev_b32 v36, 7, v36
  v_lshlrev_b32 v38, 7, v38
  v_lshlrev_b32 v37, 7, v37
  v_lshlrev_b32 v39, 7, v39
  v_add_u32_dpp v61, v36, v3 row_newbcast:0 row_mask:0xf bank_mask:0x3
  s_nop 1
  v_add_u32_dpp v61, v38, v3 row_newbcast:6 row_mask:0xf bank_mask:0xc
  s_add_u32 m0, s41, 0
  s_nop 0
  buffer_load_dwordx4 v61, s[32:35], 0 offen lds
  s_waitcnt vmcnt(11)
  v_lshlrev_b32 v40, 7, v40
  v_lshlrev_b32 v42, 7, v42
  v_lshlrev_b32 v41, 7, v41
  v_lshlrev_b32 v43, 7, v43
  v_add_u32_dpp v62, v40, v2 row_newbcast:0 row_mask:0xf bank_mask:0x3
  s_nop 1
  v_add_u32_dpp v62, v42, v2 row_newbcast:6 row_mask:0xf bank_mask:0xc
  s_add_u32 m0, s42, 0
  s_nop 0
  buffer_load_dwordx4 v62, s[32:35], 0 offen lds
  s_waitcnt vmcnt(11)
  v_lshlrev_b32 v44, 7, v44
  v_lshlrev_b32 v46, 7, v46
  v_lshlrev_b32 v45, 7, v45
  v_lshlrev_b32_e64 v47, 7, v47
  v_add_u32_dpp v63, v44, v3 row_newbcast:0 row_mask:0xf bank_mask:0x3
  s_nop 1
  v_add_u32_dpp v63, v46, v3 row_newbcast:6 row_mask:0xf bank_mask:0xc
  s_add_u32 m0, s43, 0
  s_nop 0
  buffer_load_dwordx4 v63, s[32:35], 0 offen lds
  s_waitcnt vmcnt(11)
  v_lshlrev_b32 v48, 7, v48
  v_lshlrev_b32 v50, 7, v50
  v_lshlrev_b32 v49, 7, v49
  v_lshlrev_b32 v51, 7, v51
  v_add_u32_dpp v64, v48, v2 row_newbcast:0 row_mask:0xf bank_mask:0x3
  s_nop 1
  v_add_u32_dpp v64, v50, v2 row_newbcast:6 row_mask:0xf bank_mask:0xc
  s_add_u32 m0, s48, 0
  s_nop 0
  buffer_load_dwordx4 v64, s[32:35], 0 offen lds
  s_waitcnt vmcnt(11)
  v_lshlrev_b32 v52, 7, v52
  v_lshlrev_b32 v54, 7, v54
  v_lshlrev_b32 v53, 7, v53
  v_lshlrev_b32_e64 v55, 7, v55
  v_add_u32_dpp v65, v52, v3 row_newbcast:0 row_mask:0xf bank_mask:0x3
  s_nop 1
  v_add_u32_dpp v65, v54, v3 row_newbcast:6 row_mask:0xf bank_mask:0xc
  s_add_u32 m0, s49, 0
  s_nop 0
  buffer_load_dwordx4 v65, s[32:35], 0 offen lds
  v_add_u32_dpp v56, v17, v2 row_newbcast:0 row_mask:0xf bank_mask:0x3
  s_nop 1
  v_add_u32_dpp v56, v19, v2 row_newbcast:6 row_mask:0xf bank_mask:0xc
  s_add_u32 m0, s36, 40960
  s_nop 0
  buffer_load_dwordx4 v56, s[32:35], 0 offen lds
  v_add_u32_dpp v57, v21, v3 row_newbcast:0 row_mask:0xf bank_mask:0x3
  s_nop 1
  v_add_u32_dpp v57, v23, v3 row_newbcast:6 row_mask:0xf bank_mask:0xc
  s_add_u32 m0, s37, 40960
  s_nop 0
  buffer_load_dwordx4 v57, s[32:35], 0 offen lds
  v_add_u32_dpp v58, v25, v2 row_newbcast:0 row_mask:0xf bank_mask:0x3
  s_nop 1
  v_add_u32_dpp v58, v27, v2 row_newbcast:6 row_mask:0xf bank_mask:0xc
  s_add_u32 m0, s38, 40960
  s_nop 0
  buffer_load_dwordx4 v58, s[32:35], 0 offen lds
  v_add_u32_dpp v59, v29, v3 row_newbcast:0 row_mask:0xf bank_mask:0x3
  s_nop 1
  v_add_u32_dpp v59, v31, v3 row_newbcast:6 row_mask:0xf bank_mask:0xc
  s_add_u32 m0, s39, 40960
  s_nop 0
  buffer_load_dwordx4 v59, s[32:35], 0 offen lds
  s_waitcnt vmcnt(4)
  s_barrier
  v_add_u32_dpp v60, v33, v2 row_newbcast:0 row_mask:0xf bank_mask:0x3
  s_nop 1
  v_add_u32_dpp v60, v35, v2 row_newbcast:6 row_mask:0xf bank_mask:0xc
  s_add_u32 m0, s40, 40960
  s_nop 0
  buffer_load_dwordx4 v60, s[32:35], 0 offen lds
  v_add_u32_dpp v61, v37, v3 row_newbcast:0 row_mask:0xf bank_mask:0x3
  s_nop 1
  v_add_u32_dpp v61, v39, v3 row_newbcast:6 row_mask:0xf bank_mask:0xc
  s_add_u32 m0, s41, 40960
  s_nop 0
  buffer_load_dwordx4 v61, s[32:35], 0 offen lds
  v_add_u32_dpp v62, v41, v2 row_newbcast:0 row_mask:0xf bank_mask:0x3
  s_nop 1
  v_add_u32_dpp v62, v43, v2 row_newbcast:6 row_mask:0xf bank_mask:0xc
  s_add_u32 m0, s42, 40960
  s_nop 0
  buffer_load_dwordx4 v62, s[32:35], 0 offen lds
  s_barrier
  v_add_u32_dpp v63, v45, v3 row_newbcast:0 row_mask:0xf bank_mask:0x3
  s_nop 1
  v_add_u32_dpp v63, v47, v3 row_newbcast:6 row_mask:0xf bank_mask:0xc
  s_add_u32 m0, s43, 40960
  s_nop 0
  buffer_load_dwordx4 v63, s[32:35], 0 offen lds
  v_add_u32_dpp v64, v49, v2 row_newbcast:0 row_mask:0xf bank_mask:0x3
  s_nop 1
  v_add_u32_dpp v64, v51, v2 row_newbcast:6 row_mask:0xf bank_mask:0xc
  s_add_u32 m0, s48, 40960
  s_nop 0
  buffer_load_dwordx4 v64, s[32:35], 0 offen lds
  v_add_u32_dpp v65, v53, v3 row_newbcast:0 row_mask:0xf bank_mask:0x3
  s_nop 1
  v_add_u32_dpp v65, v55, v3 row_newbcast:6 row_mask:0xf bank_mask:0xc
  s_add_u32 m0, s49, 40960
  s_nop 0
  buffer_load_dwordx4 v65, s[32:35], 0 offen lds
  v_add_u32_dpp v56, v18, v2 row_newbcast:0 row_mask:0xf bank_mask:0x3
  v_add_u32_dpp v57, v22, v3 row_newbcast:0 row_mask:0xf bank_mask:0x3
  v_add_u32_dpp v58, v26, v2 row_newbcast:0 row_mask:0xf bank_mask:0x3
  v_add_u32_dpp v59, v30, v3 row_newbcast:0 row_mask:0xf bank_mask:0x3
  v_add_u32_dpp v60, v34, v2 row_newbcast:0 row_mask:0xf bank_mask:0x3
  v_add_u32_dpp v61, v38, v3 row_newbcast:0 row_mask:0xf bank_mask:0x3
  v_add_u32_dpp v62, v42, v2 row_newbcast:0 row_mask:0xf bank_mask:0x3
  v_add_u32_dpp v63, v46, v3 row_newbcast:0 row_mask:0xf bank_mask:0x3
  v_add_u32_dpp v64, v50, v2 row_newbcast:0 row_mask:0xf bank_mask:0x3
  v_add_u32_dpp v65, v54, v3 row_newbcast:0 row_mask:0xf bank_mask:0x3
  v_add_u32_dpp v56, v16, v2 row_newbcast:7 row_mask:0xf bank_mask:0xc
  v_add_u32_dpp v57, v20, v3 row_newbcast:7 row_mask:0xf bank_mask:0xc
  v_add_u32_dpp v58, v24, v2 row_newbcast:7 row_mask:0xf bank_mask:0xc
  v_add_u32_dpp v59, v28, v3 row_newbcast:7 row_mask:0xf bank_mask:0xc
  v_add_u32_dpp v60, v32, v2 row_newbcast:7 row_mask:0xf bank_mask:0xc
  v_add_u32_dpp v61, v36, v3 row_newbcast:7 row_mask:0xf bank_mask:0xc
  v_add_u32_dpp v62, v40, v2 row_newbcast:7 row_mask:0xf bank_mask:0xc
  v_add_u32_dpp v63, v44, v3 row_newbcast:7 row_mask:0xf bank_mask:0xc
  v_add_u32_dpp v64, v48, v2 row_newbcast:7 row_mask:0xf bank_mask:0xc
  v_add_u32_dpp v65, v52, v3 row_newbcast:7 row_mask:0xf bank_mask:0xc
  s_add_u32 m0, s75, 139264
  s_nop 0
  buffer_load_dwordx4 v4, s[44:47], s74 offen lds
  s_add_u32 m0, s75, 140288
  s_nop 0
  buffer_load_dwordx4 v5, s[44:47], s74 offen lds
  s_add_u32 s74, s74, 106496
  s_add_u32 m0, s36, 81920
  s_nop 0
  buffer_load_dwordx4 v56, s[32:35], 0 offen lds
  s_add_u32 m0, s37, 81920
  s_nop 0
  buffer_load_dwordx4 v57, s[32:35], 0 offen lds
  s_add_u32 m0, s38, 81920
  s_nop 0
  buffer_load_dwordx4 v58, s[32:35], 0 offen lds
  s_add_u32 m0, s39, 81920
  s_nop 0
  buffer_load_dwordx4 v59, s[32:35], 0 offen lds
  s_add_u32 m0, s40, 81920
  s_nop 0
  buffer_load_dwordx4 v60, s[32:35], 0 offen lds
  s_setprio 0
  s_branch L_ld_in
L_cmp:
  s_mul_i32 s70, s3, 13
  v_min_u32 v118, 12, v0
  v_add_u32 v118, s70, v118
  v_lshrrev_b32 v117, 1, v118
  v_mul_u32_u24 v117, 96, v117
  v_lshl_add_u32 v118, v118, 2, v117
  s_mul_i32 s78, s27, 25
  s_min_u32 s78, s78, 294
  s_add_u32 s78, s78, s71
  s_mul_i32 s78, s78, 104
  s_waitcnt lgkmcnt(0)
  s_mov_b32 s28, s4
  s_and_b32 s29, s5, 0xffff
  s_mov_b32 s30, 425984
  s_mov_b32 s31, 0x20000
  s_mov_b32 s32, s6
  s_and_b32 s33, s7, 0xffff
  s_mov_b32 s34, 12800000
  s_mov_b32 s35, 0x20000
  s_mov_b32 s48, s14
  s_and_b32 s49, s15, 0xffff
  s_mov_b32 s50, 3328
  s_mov_b32 s51, 0x20000
  s_mov_b32 m0, 147456
  s_mov_b64 exec, 0xffff
  buffer_load_dwordx4 v11, s[48:51], s77 offen lds
  s_mov_b64 exec, -1
  s_and_b32 s68, s3, 1
  s_lshr_b32 s69, s3, 1
  v_bfe_u32 v117, v0, 2, 2
  v_lshl_add_u32 v118, v116, 3, v117
  v_lshlrev_b32 v118, 8, v118
  v_bfe_u32 v117, v0, 2, 3
  s_lshl_b32 s70, s69, 2
  v_xor_b32 v117, s70, v117
  v_lshl_add_u32 v118, v117, 5, v118
  v_and_b32 v117, 3, v0
  v_lshl_add_u32 v118, v117, 3, v118
  v_add_u32 v1, 122880, v118
  v_xor_b32 v2, 32, v1
  v_xor_b32 v3, 64, v1
  v_xor_b32 v4, 96, v1
  s_lshl_b32 s70, s69, 7
  s_add_u32 s70, s70, 147456
  v_lshlrev_b32 v118, 3, v116
  v_add_u32 v9, s70, v118
  v_and_b32 v118, 15, v0
  v_lshlrev_b32 v118, 7, v118
  v_bfe_u32 v117, v0, 1, 3
  v_xor_b32 v117, v117, v116
  v_lshl_add_u32 v118, v117, 4, v118
  s_mul_i32 s70, s68, 20480
  v_add_u32 v5, s70, v118
  v_xor_b32_e64 v7, 64, v5
  v_add_u32 v6, 81920, v5
  v_add_u32 v8, 81920, v7
  s_mul_i32 s70, s3, 640
  s_add_u32 s70, s70, 147968
  v_and_b32 v118, 15, v0
  v_lshlrev_b32 v118, 2, v118
  v_add_u32 v118, s70, v118
  v_lshrrev_b32 v117, 5, v0
  v_lshl_add_u32 v118, v117, 6, v118
  v_bfe_u32 v117, v0, 4, 1
  v_lshl_add_u32 v10, v117, 7, v118
  s_mov_b32 s72, 0
  v_mov_b32 v12, 0xc0135761
  v_mov_b32 v13, 0xc0135761
  v_mov_b32 v14, 0xbdd2d3e8
  v_mov_b32 v15, 0xbdd2d3e8
  v_mov_b32 v248, 1.0
  v_mov_b32 v249, 1.0
  s_waitcnt vmcnt(0)
  ds_read_b64 v[18:19], v9 offset:0
  ds_read_b64 v[22:23], v9 offset:32
  ds_read_b64 v[26:27], v9 offset:64
  ds_read_b64 v[30:31], v9 offset:96
  s_waitcnt lgkmcnt(3)
  v_lshlrev_b32 v16, 16, v18
  v_and_b32 v17, 0xffff0000, v18
  v_lshlrev_b32 v18, 16, v19
  v_and_b32 v19, 0xffff0000, v19
  s_waitcnt lgkmcnt(2)
  v_lshlrev_b32 v20, 16, v22
  v_and_b32 v21, 0xffff0000, v22
  v_lshlrev_b32 v22, 16, v23
  v_and_b32 v23, 0xffff0000, v23
  s_waitcnt lgkmcnt(1)
  v_lshlrev_b32 v24, 16, v26
  v_and_b32 v25, 0xffff0000, v26
  v_lshlrev_b32 v26, 16, v27
  v_and_b32 v27, 0xffff0000, v27
  s_waitcnt lgkmcnt(0)
  v_lshlrev_b32 v28, 16, v30
  v_and_b32 v29, 0xffff0000, v30
  v_lshlrev_b32 v30, 16, v31
  v_and_b32 v31, 0xffff0000, v31
  v_mov_b64 v[88:89], v[16:17]
  v_mov_b64 v[90:91], v[18:19]
  v_mov_b64 v[92:93], v[20:21]
  v_mov_b64 v[94:95], v[22:23]
  v_mov_b64 v[96:97], v[24:25]
  v_mov_b64 v[98:99], v[26:27]
  v_mov_b64 v[100:101], v[28:29]
  v_mov_b64 v[102:103], v[30:31]
  v_mov_b64 v[104:105], v[16:17]
  v_mov_b64 v[106:107], v[18:19]
  v_mov_b64 v[108:109], v[20:21]
  v_mov_b64 v[110:111], v[22:23]
  v_mov_b64 v[112:113], v[24:25]
  v_mov_b64 v[114:115], v[26:27]
  v_mov_b64 v[116:117], v[28:29]
  v_mov_b64 v[118:119], v[30:31]
  v_mov_b64 v[120:121], v[16:17]
  v_mov_b64 v[122:123], v[18:19]
  v_mov_b64 v[124:125], v[20:21]
  v_mov_b64 v[126:127], v[22:23]
  v_mov_b64 v[128:129], v[24:25]
  v_mov_b64 v[130:131], v[26:27]
  v_mov_b64 v[132:133], v[28:29]
  v_mov_b64 v[134:135], v[30:31]
  v_mov_b64 v[136:137], v[16:17]
  v_mov_b64 v[138:139], v[18:19]
  v_mov_b64 v[140:141], v[20:21]
  v_mov_b64 v[142:143], v[22:23]
  v_mov_b64 v[144:145], v[24:25]
  v_mov_b64 v[146:147], v[26:27]
  v_mov_b64 v[148:149], v[28:29]
  v_mov_b64 v[150:151], v[30:31]
  v_mov_b64 v[152:153], v[16:17]
  v_mov_b64 v[154:155], v[18:19]
  v_mov_b64 v[156:157], v[20:21]
  v_mov_b64 v[158:159], v[22:23]
  v_mov_b64 v[160:161], v[24:25]
  v_mov_b64 v[162:163], v[26:27]
  v_mov_b64 v[164:165], v[28:29]
  v_mov_b64 v[166:167], v[30:31]
  v_mov_b64 v[168:169], v[16:17]
  v_mov_b64 v[170:171], v[18:19]
  v_mov_b64 v[172:173], v[20:21]
  v_mov_b64 v[174:175], v[22:23]
  v_mov_b64 v[176:177], v[24:25]
  v_mov_b64 v[178:179], v[26:27]
  v_mov_b64 v[180:181], v[28:29]
  v_mov_b64 v[182:183], v[30:31]
  v_mov_b64 v[184:185], v[16:17]
  v_mov_b64 v[186:187], v[18:19]
  v_mov_b64 v[188:189], v[20:21]
  v_mov_b64 v[190:191], v[22:23]
  v_mov_b64 v[192:193], v[24:25]
  v_mov_b64 v[194:195], v[26:27]
  v_mov_b64 v[196:197], v[28:29]
  v_mov_b64 v[198:199], v[30:31]
  v_mov_b64 v[200:201], v[16:17]
  v_mov_b64 v[202:203], v[18:19]
  v_mov_b64 v[204:205], v[20:21]
  v_mov_b64 v[206:207], v[22:23]
  v_mov_b64 v[208:209], v[24:25]
  v_mov_b64 v[210:211], v[26:27]
  v_mov_b64 v[212:213], v[28:29]
  v_mov_b64 v[214:215], v[30:31]
  v_mov_b64 v[216:217], v[16:17]
  v_mov_b64 v[218:219], v[18:19]
  v_mov_b64 v[220:221], v[20:21]
  v_mov_b64 v[222:223], v[22:23]
  v_mov_b64 v[224:225], v[24:25]
  v_mov_b64 v[226:227], v[26:27]
  v_mov_b64 v[228:229], v[28:29]
  v_mov_b64 v[230:231], v[30:31]
  v_mov_b64 v[232:233], v[16:17]
  v_mov_b64 v[234:235], v[18:19]
  v_mov_b64 v[236:237], v[20:21]
  v_mov_b64 v[238:239], v[22:23]
  v_mov_b64 v[240:241], v[24:25]
  v_mov_b64 v[242:243], v[26:27]
  v_mov_b64 v[244:245], v[28:29]
  v_mov_b64 v[246:247], v[30:31]
  s_barrier
  s_setprio 1
  ds_read_b64_tr_b16 v[16:17], v1 offset:0
  ds_read_b64_tr_b16 v[18:19], v1 offset:1024
  ds_read_b128 v[48:51], v5 offset:0
  ds_read_b64_tr_b16 v[20:21], v2 offset:0
  ds_read_b64_tr_b16 v[22:23], v2 offset:1024
  ds_read_b64_tr_b16 v[24:25], v3 offset:0
  ds_read_b64_tr_b16 v[26:27], v3 offset:1024
  ds_read_b64_tr_b16 v[28:29], v4 offset:0
  ds_read_b64_tr_b16 v[30:31], v4 offset:1024
  ds_read_b128 v[52:55], v5 offset:2048
  ds_read_b128 v[56:59], v5 offset:4096
  ds_read_b128 v[60:63], v5 offset:6144
  ds_read_b128 v[64:67], v5 offset:8192
  ds_read_b128 v[68:71], v5 offset:10240
  ds_read_b128 v[72:75], v5 offset:12288
  ds_read_b128 v[76:79], v5 offset:14336
  ds_read_b128 v[80:83], v5 offset:16384
  ds_read_b128 v[84:87], v5 offset:18432
L_dnn_loop0:
  s_waitcnt lgkmcnt(14)
  v_mfma_f32_16x16x32_bf16 v[88:91], v[16:19], v[48:51], v[88:91]
  s_waitcnt lgkmcnt(13)
  v_mfma_f32_16x16x32_bf16 v[92:95], v[20:23], v[48:51], v[92:95]
  s_waitcnt lgkmcnt(11)
  v_mfma_f32_16x16x32_bf16 v[96:99], v[24:27], v[48:51], v[96:99]
  s_waitcnt lgkmcnt(9)
  v_mfma_f32_16x16x32_bf16 v[100:103], v[28:31], v[48:51], v[100:103]
  s_waitcnt lgkmcnt(8)
  v_mfma_f32_16x16x32_bf16 v[116:119], v[28:31], v[52:55], v[116:119]
  v_mfma_f32_16x16x32_bf16 v[112:115], v[24:27], v[52:55], v[112:115]
  v_mfma_f32_16x16x32_bf16 v[108:111], v[20:23], v[52:55], v[108:111]
  v_mfma_f32_16x16x32_bf16 v[104:107], v[16:19], v[52:55], v[104:107]
  s_waitcnt lgkmcnt(0)
  s_barrier
  v_mfma_f32_16x16x32_bf16 v[120:123], v[16:19], v[56:59], v[120:123]
  s_nop 0
  ds_read_b128 v[48:51], v7 offset:0
  v_mfma_f32_16x16x32_bf16 v[124:127], v[20:23], v[56:59], v[124:127]
  ds_read_b128 v[52:55], v7 offset:2048
  v_mfma_f32_16x16x32_bf16 v[128:131], v[24:27], v[56:59], v[128:131]
  ds_read_b64_tr_b16 v[32:33], v1 offset:8192
  v_mfma_f32_16x16x32_bf16 v[132:135], v[28:31], v[56:59], v[132:135]
  ds_read_b128 v[56:59], v7 offset:4096
  v_mfma_f32_16x16x32_bf16 v[148:151], v[28:31], v[60:63], v[148:151]
  ds_read_b64_tr_b16 v[34:35], v1 offset:9216
  v_mfma_f32_16x16x32_bf16 v[144:147], v[24:27], v[60:63], v[144:147]
  ds_read_b64_tr_b16 v[36:37], v2 offset:8192
  v_mfma_f32_16x16x32_bf16 v[140:143], v[20:23], v[60:63], v[140:143]
  ds_read_b64_tr_b16 v[38:39], v2 offset:9216
  v_mfma_f32_16x16x32_bf16 v[136:139], v[16:19], v[60:63], v[136:139]
  ds_read_b128 v[60:63], v7 offset:6144
  v_mfma_f32_16x16x32_bf16 v[152:155], v[16:19], v[64:67], v[152:155]
  ds_read_b64_tr_b16 v[40:41], v3 offset:8192
  v_mfma_f32_16x16x32_bf16 v[156:159], v[20:23], v[64:67], v[156:159]
  ds_read_b64_tr_b16 v[42:43], v3 offset:9216
  v_mfma_f32_16x16x32_bf16 v[160:163], v[24:27], v[64:67], v[160:163]
  ds_read_b64_tr_b16 v[44:45], v4 offset:8192
  v_mfma_f32_16x16x32_bf16 v[164:167], v[28:31], v[64:67], v[164:167]
  ds_read_b128 v[64:67], v7 offset:8192
  v_mfma_f32_16x16x32_bf16 v[180:183], v[28:31], v[68:71], v[180:183]
  ds_read_b64_tr_b16 v[46:47], v4 offset:9216
  v_mfma_f32_16x16x32_bf16 v[176:179], v[24:27], v[68:71], v[176:179]
  v_mfma_f32_16x16x32_bf16 v[172:175], v[20:23], v[68:71], v[172:175]
  v_mfma_f32_16x16x32_bf16 v[168:171], v[16:19], v[68:71], v[168:171]
  ds_read_b128 v[68:71], v7 offset:10240
  v_mfma_f32_16x16x32_bf16 v[184:187], v[16:19], v[72:75], v[184:187]
  v_mfma_f32_16x16x32_bf16 v[188:191], v[20:23], v[72:75], v[188:191]
  v_mfma_f32_16x16x32_bf16 v[192:195], v[24:27], v[72:75], v[192:195]
  v_mfma_f32_16x16x32_bf16 v[196:199], v[28:31], v[72:75], v[196:199]
  ds_read_b128 v[72:75], v7 offset:12288
  v_mfma_f32_16x16x32_bf16 v[212:215], v[28:31], v[76:79], v[212:215]
  v_mfma_f32_16x16x32_bf16 v[208:211], v[24:27], v[76:79], v[208:211]
  v_mfma_f32_16x16x32_bf16 v[204:207], v[20:23], v[76:79], v[204:207]
  v_mfma_f32_16x16x32_bf16 v[200:203], v[16:19], v[76:79], v[200:203]
  ds_read_b128 v[76:79], v7 offset:14336
  v_mfma_f32_16x16x32_bf16 v[216:219], v[16:19], v[80:83], v[216:219]
  v_mfma_f32_16x16x32_bf16 v[220:223], v[20:23], v[80:83], v[220:223]
  v_mfma_f32_16x16x32_bf16 v[224:227], v[24:27], v[80:83], v[224:227]
  v_mfma_f32_16x16x32_bf16 v[228:231], v[28:31], v[80:83], v[228:231]
  ds_read_b128 v[80:83], v7 offset:16384
  v_mfma_f32_16x16x32_bf16 v[244:247], v[28:31], v[84:87], v[244:247]
  s_waitcnt lgkmcnt(4)
  v_mfma_f32_16x16x32_bf16 v[240:243], v[24:27], v[84:87], v[240:243]
  v_mfma_f32_16x16x32_bf16 v[236:239], v[20:23], v[84:87], v[236:239]
  s_nop 0
  v_mfma_f32_16x16x32_bf16 v[232:235], v[16:19], v[84:87], v[232:235]
  ds_read_b128 v[84:87], v7 offset:18432
  v_mfma_f32_16x16x32_bf16 v[88:91], v[32:35], v[48:51], v[88:91]
  v_mfma_f32_16x16x32_bf16 v[92:95], v[36:39], v[48:51], v[92:95]
  v_mfma_f32_16x16x32_bf16 v[96:99], v[40:43], v[48:51], v[96:99]
  v_mfma_f32_16x16x32_bf16 v[100:103], v[44:47], v[48:51], v[100:103]
  v_mfma_f32_16x16x32_bf16 v[116:119], v[44:47], v[52:55], v[116:119]
  v_mfma_f32_16x16x32_bf16 v[112:115], v[40:43], v[52:55], v[112:115]
  v_mfma_f32_16x16x32_bf16 v[108:111], v[36:39], v[52:55], v[108:111]
  v_mfma_f32_16x16x32_bf16 v[104:107], v[32:35], v[52:55], v[104:107]
  s_waitcnt lgkmcnt(0)
  s_barrier
  v_mfma_f32_16x16x32_bf16 v[120:123], v[32:35], v[56:59], v[120:123]
  ds_read_b128 v[48:51], v5 offset:40960
  v_mfma_f32_16x16x32_bf16 v[124:127], v[36:39], v[56:59], v[124:127]
  ds_read_b128 v[52:55], v5 offset:43008
  v_mfma_f32_16x16x32_bf16 v[128:131], v[40:43], v[56:59], v[128:131]
  ds_read_b64_tr_b16 v[16:17], v1 offset:16384
  v_mfma_f32_16x16x32_bf16 v[132:135], v[44:47], v[56:59], v[132:135]
  ds_read_b128 v[56:59], v5 offset:45056
  v_mfma_f32_16x16x32_bf16 v[148:151], v[44:47], v[60:63], v[148:151]
  ds_read_b64_tr_b16 v[18:19], v1 offset:17408
  v_mfma_f32_16x16x32_bf16 v[144:147], v[40:43], v[60:63], v[144:147]
  ds_read_b64_tr_b16 v[20:21], v2 offset:16384
  v_mfma_f32_16x16x32_bf16 v[140:143], v[36:39], v[60:63], v[140:143]
  ds_read_b64_tr_b16 v[22:23], v2 offset:17408
  v_mfma_f32_16x16x32_bf16 v[136:139], v[32:35], v[60:63], v[136:139]
  ds_read_b128 v[60:63], v5 offset:47104
  v_mfma_f32_16x16x32_bf16 v[152:155], v[32:35], v[64:67], v[152:155]
  ds_read_b64_tr_b16 v[24:25], v3 offset:16384
  v_mfma_f32_16x16x32_bf16 v[156:159], v[36:39], v[64:67], v[156:159]
  ds_read_b64_tr_b16 v[26:27], v3 offset:17408
  v_mfma_f32_16x16x32_bf16 v[160:163], v[40:43], v[64:67], v[160:163]
  ds_read_b64_tr_b16 v[28:29], v4 offset:16384
  v_mfma_f32_16x16x32_bf16 v[164:167], v[44:47], v[64:67], v[164:167]
  ds_read_b128 v[64:67], v5 offset:49152
  v_mfma_f32_16x16x32_bf16 v[180:183], v[44:47], v[68:71], v[180:183]
  ds_read_b64_tr_b16 v[30:31], v4 offset:17408
  v_mfma_f32_16x16x32_bf16 v[176:179], v[40:43], v[68:71], v[176:179]
  v_mfma_f32_16x16x32_bf16 v[172:175], v[36:39], v[68:71], v[172:175]
  v_mfma_f32_16x16x32_bf16 v[168:171], v[32:35], v[68:71], v[168:171]
  ds_read_b128 v[68:71], v5 offset:51200
  v_mfma_f32_16x16x32_bf16 v[184:187], v[32:35], v[72:75], v[184:187]
  v_mfma_f32_16x16x32_bf16 v[188:191], v[36:39], v[72:75], v[188:191]
  v_mfma_f32_16x16x32_bf16 v[192:195], v[40:43], v[72:75], v[192:195]
  v_mfma_f32_16x16x32_bf16 v[196:199], v[44:47], v[72:75], v[196:199]
  ds_read_b128 v[72:75], v5 offset:53248
  v_mfma_f32_16x16x32_bf16 v[212:215], v[44:47], v[76:79], v[212:215]
  v_mfma_f32_16x16x32_bf16 v[208:211], v[40:43], v[76:79], v[208:211]
  v_mfma_f32_16x16x32_bf16 v[204:207], v[36:39], v[76:79], v[204:207]
  v_mfma_f32_16x16x32_bf16 v[200:203], v[32:35], v[76:79], v[200:203]
  ds_read_b128 v[76:79], v5 offset:55296
  v_mfma_f32_16x16x32_bf16 v[216:219], v[32:35], v[80:83], v[216:219]
  v_mfma_f32_16x16x32_bf16 v[220:223], v[36:39], v[80:83], v[220:223]
  v_mfma_f32_16x16x32_bf16 v[224:227], v[40:43], v[80:83], v[224:227]
  v_mfma_f32_16x16x32_bf16 v[228:231], v[44:47], v[80:83], v[228:231]
  ds_read_b128 v[80:83], v5 offset:57344
  v_mfma_f32_16x16x32_bf16 v[244:247], v[44:47], v[84:87], v[244:247]
  s_waitcnt lgkmcnt(4)
  v_mfma_f32_16x16x32_bf16 v[240:243], v[40:43], v[84:87], v[240:243]
  v_mfma_f32_16x16x32_bf16 v[236:239], v[36:39], v[84:87], v[236:239]
  v_mfma_f32_16x16x32_bf16 v[232:235], v[32:35], v[84:87], v[232:235]
  ds_read_b128 v[84:87], v5 offset:59392
  v_mfma_f32_16x16x32_bf16 v[88:91], v[16:19], v[48:51], v[88:91]
  v_mfma_f32_16x16x32_bf16 v[92:95], v[20:23], v[48:51], v[92:95]
  s_nop 0
  v_mfma_f32_16x16x32_bf16 v[96:99], v[24:27], v[48:51], v[96:99]
  v_mfma_f32_16x16x32_bf16 v[100:103], v[28:31], v[48:51], v[100:103]
  v_mfma_f32_16x16x32_bf16 v[116:119], v[28:31], v[52:55], v[116:119]
  v_mfma_f32_16x16x32_bf16 v[112:115], v[24:27], v[52:55], v[112:115]
  v_mfma_f32_16x16x32_bf16 v[108:111], v[20:23], v[52:55], v[108:111]
  v_mfma_f32_16x16x32_bf16 v[104:107], v[16:19], v[52:55], v[104:107]
  s_waitcnt lgkmcnt(0)
  s_barrier
  v_mfma_f32_16x16x32_bf16 v[120:123], v[16:19], v[56:59], v[120:123]
  ds_read_b128 v[48:51], v7 offset:40960
  v_mfma_f32_16x16x32_bf16 v[124:127], v[20:23], v[56:59], v[124:127]
  ds_read_b128 v[52:55], v7 offset:43008
  v_mfma_f32_16x16x32_bf16 v[128:131], v[24:27], v[56:59], v[128:131]
  ds_read_b64_tr_b16 v[32:33], v1 offset:0
  v_mfma_f32_16x16x32_bf16 v[132:135], v[28:31], v[56:59], v[132:135]
  ds_read_b128 v[56:59], v7 offset:45056
  v_mfma_f32_16x16x32_bf16 v[148:151], v[28:31], v[60:63], v[148:151]
  ds_read_b64_tr_b16 v[34:35], v1 offset:1024
  v_mfma_f32_16x16x32_bf16 v[144:147], v[24:27], v[60:63], v[144:147]
  ds_read_b64_tr_b16 v[36:37], v2 offset:0
  v_mfma_f32_16x16x32_bf16 v[140:143], v[20:23], v[60:63], v[140:143]
  ds_read_b64_tr_b16 v[38:39], v2 offset:1024
  v_mfma_f32_16x16x32_bf16 v[136:139], v[16:19], v[60:63], v[136:139]
  ds_read_b128 v[60:63], v7 offset:47104
  v_mfma_f32_16x16x32_bf16 v[152:155], v[16:19], v[64:67], v[152:155]
  ds_read_b64_tr_b16 v[40:41], v3 offset:0
  v_mfma_f32_16x16x32_bf16 v[156:159], v[20:23], v[64:67], v[156:159]
  ds_read_b64_tr_b16 v[42:43], v3 offset:1024
  v_mfma_f32_16x16x32_bf16 v[160:163], v[24:27], v[64:67], v[160:163]
  ds_read_b64_tr_b16 v[44:45], v4 offset:0
  v_mfma_f32_16x16x32_bf16 v[164:167], v[28:31], v[64:67], v[164:167]
  ds_read_b128 v[64:67], v7 offset:49152
  v_mfma_f32_16x16x32_bf16 v[180:183], v[28:31], v[68:71], v[180:183]
  ds_read_b64_tr_b16 v[46:47], v4 offset:1024
  v_mfma_f32_16x16x32_bf16 v[176:179], v[24:27], v[68:71], v[176:179]
  v_mfma_f32_16x16x32_bf16 v[172:175], v[20:23], v[68:71], v[172:175]
  v_mfma_f32_16x16x32_bf16 v[168:171], v[16:19], v[68:71], v[168:171]
  ds_read_b128 v[68:71], v7 offset:51200
  v_mfma_f32_16x16x32_bf16 v[184:187], v[16:19], v[72:75], v[184:187]
  v_mfma_f32_16x16x32_bf16 v[188:191], v[20:23], v[72:75], v[188:191]
  v_mfma_f32_16x16x32_bf16 v[192:195], v[24:27], v[72:75], v[192:195]
  v_mfma_f32_16x16x32_bf16 v[196:199], v[28:31], v[72:75], v[196:199]
  ds_read_b128 v[72:75], v7 offset:53248
  v_mfma_f32_16x16x32_bf16 v[212:215], v[28:31], v[76:79], v[212:215]
  v_mfma_f32_16x16x32_bf16 v[208:211], v[24:27], v[76:79], v[208:211]
  v_mfma_f32_16x16x32_bf16 v[204:207], v[20:23], v[76:79], v[204:207]
  v_mfma_f32_16x16x32_bf16 v[200:203], v[16:19], v[76:79], v[200:203]
  ds_read_b128 v[76:79], v7 offset:55296
  v_mfma_f32_16x16x32_bf16 v[216:219], v[16:19], v[80:83], v[216:219]
  v_mfma_f32_16x16x32_bf16 v[220:223], v[20:23], v[80:83], v[220:223]
  v_mfma_f32_16x16x32_bf16 v[224:227], v[24:27], v[80:83], v[224:227]
  v_mfma_f32_16x16x32_bf16 v[228:231], v[28:31], v[80:83], v[228:231]
  ds_read_b128 v[80:83], v7 offset:57344
  v_mfma_f32_16x16x32_bf16 v[244:247], v[28:31], v[84:87], v[244:247]
  s_waitcnt lgkmcnt(4)
  v_mfma_f32_16x16x32_bf16 v[240:243], v[24:27], v[84:87], v[240:243]
  v_mfma_f32_16x16x32_bf16 v[236:239], v[20:23], v[84:87], v[236:239]
  s_nop 0
  v_mfma_f32_16x16x32_bf16 v[232:235], v[16:19], v[84:87], v[232:235]
  ds_read_b128 v[84:87], v7 offset:59392
  v_mfma_f32_16x16x32_bf16 v[88:91], v[32:35], v[48:51], v[88:91]
  v_mfma_f32_16x16x32_bf16 v[92:95], v[36:39], v[48:51], v[92:95]
  v_mfma_f32_16x16x32_bf16 v[96:99], v[40:43], v[48:51], v[96:99]
  v_mfma_f32_16x16x32_bf16 v[100:103], v[44:47], v[48:51], v[100:103]
  v_mfma_f32_16x16x32_bf16 v[116:119], v[44:47], v[52:55], v[116:119]
  v_mfma_f32_16x16x32_bf16 v[112:115], v[40:43], v[52:55], v[112:115]
  v_mfma_f32_16x16x32_bf16 v[108:111], v[36:39], v[52:55], v[108:111]
  v_mfma_f32_16x16x32_bf16 v[104:107], v[32:35], v[52:55], v[104:107]
  s_waitcnt lgkmcnt(0)
  s_barrier
  v_mfma_f32_16x16x32_bf16 v[120:123], v[32:35], v[56:59], v[120:123]
  ds_read_b128 v[48:51], v6 offset:0
  v_mfma_f32_16x16x32_bf16 v[124:127], v[36:39], v[56:59], v[124:127]
  ds_read_b128 v[52:55], v6 offset:2048
  v_mfma_f32_16x16x32_bf16 v[128:131], v[40:43], v[56:59], v[128:131]
  ds_read_b64_tr_b16 v[16:17], v1 offset:8192
  v_mfma_f32_16x16x32_bf16 v[132:135], v[44:47], v[56:59], v[132:135]
  ds_read_b128 v[56:59], v6 offset:4096
  v_mfma_f32_16x16x32_bf16 v[148:151], v[44:47], v[60:63], v[148:151]
  ds_read_b64_tr_b16 v[18:19], v1 offset:9216
  v_mfma_f32_16x16x32_bf16 v[144:147], v[40:43], v[60:63], v[144:147]
  ds_read_b64_tr_b16 v[20:21], v2 offset:8192
  v_mfma_f32_16x16x32_bf16 v[140:143], v[36:39], v[60:63], v[140:143]
  ds_read_b64_tr_b16 v[22:23], v2 offset:9216
  v_mfma_f32_16x16x32_bf16 v[136:139], v[32:35], v[60:63], v[136:139]
  ds_read_b128 v[60:63], v6 offset:6144
  v_mfma_f32_16x16x32_bf16 v[152:155], v[32:35], v[64:67], v[152:155]
  ds_read_b64_tr_b16 v[24:25], v3 offset:8192
  v_mfma_f32_16x16x32_bf16 v[156:159], v[36:39], v[64:67], v[156:159]
  ds_read_b64_tr_b16 v[26:27], v3 offset:9216
  v_mfma_f32_16x16x32_bf16 v[160:163], v[40:43], v[64:67], v[160:163]
  ds_read_b64_tr_b16 v[28:29], v4 offset:8192
  v_mfma_f32_16x16x32_bf16 v[164:167], v[44:47], v[64:67], v[164:167]
  ds_read_b128 v[64:67], v6 offset:8192
  v_mfma_f32_16x16x32_bf16 v[180:183], v[44:47], v[68:71], v[180:183]
  ds_read_b64_tr_b16 v[30:31], v4 offset:9216
  v_mfma_f32_16x16x32_bf16 v[176:179], v[40:43], v[68:71], v[176:179]
  v_mfma_f32_16x16x32_bf16 v[172:175], v[36:39], v[68:71], v[172:175]
  v_mfma_f32_16x16x32_bf16 v[168:171], v[32:35], v[68:71], v[168:171]
  ds_read_b128 v[68:71], v6 offset:10240
  v_mfma_f32_16x16x32_bf16 v[184:187], v[32:35], v[72:75], v[184:187]
  v_mfma_f32_16x16x32_bf16 v[188:191], v[36:39], v[72:75], v[188:191]
  v_mfma_f32_16x16x32_bf16 v[192:195], v[40:43], v[72:75], v[192:195]
  v_mfma_f32_16x16x32_bf16 v[196:199], v[44:47], v[72:75], v[196:199]
  ds_read_b128 v[72:75], v6 offset:12288
  v_mfma_f32_16x16x32_bf16 v[212:215], v[44:47], v[76:79], v[212:215]
  v_mfma_f32_16x16x32_bf16 v[208:211], v[40:43], v[76:79], v[208:211]
  v_mfma_f32_16x16x32_bf16 v[204:207], v[36:39], v[76:79], v[204:207]
  v_mfma_f32_16x16x32_bf16 v[200:203], v[32:35], v[76:79], v[200:203]
  ds_read_b128 v[76:79], v6 offset:14336
  v_mfma_f32_16x16x32_bf16 v[216:219], v[32:35], v[80:83], v[216:219]
  v_mfma_f32_16x16x32_bf16 v[220:223], v[36:39], v[80:83], v[220:223]
  v_mfma_f32_16x16x32_bf16 v[224:227], v[40:43], v[80:83], v[224:227]
  v_mfma_f32_16x16x32_bf16 v[228:231], v[44:47], v[80:83], v[228:231]
  ds_read_b128 v[80:83], v6 offset:16384
  v_mfma_f32_16x16x32_bf16 v[244:247], v[44:47], v[84:87], v[244:247]
  s_waitcnt lgkmcnt(4)
  v_mfma_f32_16x16x32_bf16 v[240:243], v[40:43], v[84:87], v[240:243]
  v_mfma_f32_16x16x32_bf16 v[236:239], v[36:39], v[84:87], v[236:239]
  v_mfma_f32_16x16x32_bf16 v[232:235], v[32:35], v[84:87], v[232:235]
  ds_read_b128 v[84:87], v6 offset:18432
  v_mfma_f32_16x16x32_bf16 v[88:91], v[16:19], v[48:51], v[88:91]
  v_mfma_f32_16x16x32_bf16 v[92:95], v[20:23], v[48:51], v[92:95]
  s_nop 0
  v_mfma_f32_16x16x32_bf16 v[96:99], v[24:27], v[48:51], v[96:99]
  v_mfma_f32_16x16x32_bf16 v[100:103], v[28:31], v[48:51], v[100:103]
  v_mfma_f32_16x16x32_bf16 v[116:119], v[28:31], v[52:55], v[116:119]
  v_mfma_f32_16x16x32_bf16 v[112:115], v[24:27], v[52:55], v[112:115]
  v_mfma_f32_16x16x32_bf16 v[108:111], v[20:23], v[52:55], v[108:111]
  v_mfma_f32_16x16x32_bf16 v[104:107], v[16:19], v[52:55], v[104:107]
  s_waitcnt lgkmcnt(0)
  s_barrier
  v_mfma_f32_16x16x32_bf16 v[120:123], v[16:19], v[56:59], v[120:123]
  ds_read_b128 v[48:51], v8 offset:0
  v_mfma_f32_16x16x32_bf16 v[124:127], v[20:23], v[56:59], v[124:127]
  ds_read_b128 v[52:55], v8 offset:2048
  v_mfma_f32_16x16x32_bf16 v[128:131], v[24:27], v[56:59], v[128:131]
  ds_read_b64_tr_b16 v[32:33], v1 offset:16384
  v_mfma_f32_16x16x32_bf16 v[132:135], v[28:31], v[56:59], v[132:135]
  ds_read_b128 v[56:59], v8 offset:4096
  v_mfma_f32_16x16x32_bf16 v[148:151], v[28:31], v[60:63], v[148:151]
  ds_read_b64_tr_b16 v[34:35], v1 offset:17408
  v_mfma_f32_16x16x32_bf16 v[144:147], v[24:27], v[60:63], v[144:147]
  ds_read_b64_tr_b16 v[36:37], v2 offset:16384
  v_mfma_f32_16x16x32_bf16 v[140:143], v[20:23], v[60:63], v[140:143]
  ds_read_b64_tr_b16 v[38:39], v2 offset:17408
  v_mfma_f32_16x16x32_bf16 v[136:139], v[16:19], v[60:63], v[136:139]
  ds_read_b128 v[60:63], v8 offset:6144
  v_mfma_f32_16x16x32_bf16 v[152:155], v[16:19], v[64:67], v[152:155]
  ds_read_b64_tr_b16 v[40:41], v3 offset:16384
  v_mfma_f32_16x16x32_bf16 v[156:159], v[20:23], v[64:67], v[156:159]
  ds_read_b64_tr_b16 v[42:43], v3 offset:17408
  v_mfma_f32_16x16x32_bf16 v[160:163], v[24:27], v[64:67], v[160:163]
  ds_read_b64_tr_b16 v[44:45], v4 offset:16384
  v_mfma_f32_16x16x32_bf16 v[164:167], v[28:31], v[64:67], v[164:167]
  ds_read_b128 v[64:67], v8 offset:8192
  v_mfma_f32_16x16x32_bf16 v[180:183], v[28:31], v[68:71], v[180:183]
  ds_read_b64_tr_b16 v[46:47], v4 offset:17408
  v_mfma_f32_16x16x32_bf16 v[176:179], v[24:27], v[68:71], v[176:179]
  v_mfma_f32_16x16x32_bf16 v[172:175], v[20:23], v[68:71], v[172:175]
  v_mfma_f32_16x16x32_bf16 v[168:171], v[16:19], v[68:71], v[168:171]
  ds_read_b128 v[68:71], v8 offset:10240
  v_mfma_f32_16x16x32_bf16 v[184:187], v[16:19], v[72:75], v[184:187]
  v_mfma_f32_16x16x32_bf16 v[188:191], v[20:23], v[72:75], v[188:191]
  v_mfma_f32_16x16x32_bf16 v[192:195], v[24:27], v[72:75], v[192:195]
  v_mfma_f32_16x16x32_bf16 v[196:199], v[28:31], v[72:75], v[196:199]
  ds_read_b128 v[72:75], v8 offset:12288
  v_mfma_f32_16x16x32_bf16 v[212:215], v[28:31], v[76:79], v[212:215]
  v_mfma_f32_16x16x32_bf16 v[208:211], v[24:27], v[76:79], v[208:211]
  v_mfma_f32_16x16x32_bf16 v[204:207], v[20:23], v[76:79], v[204:207]
  v_mfma_f32_16x16x32_bf16 v[200:203], v[16:19], v[76:79], v[200:203]
  ds_read_b128 v[76:79], v8 offset:14336
  v_mfma_f32_16x16x32_bf16 v[216:219], v[16:19], v[80:83], v[216:219]
  v_mfma_f32_16x16x32_bf16 v[220:223], v[20:23], v[80:83], v[220:223]
  v_mfma_f32_16x16x32_bf16 v[224:227], v[24:27], v[80:83], v[224:227]
  v_mfma_f32_16x16x32_bf16 v[228:231], v[28:31], v[80:83], v[228:231]
  ds_read_b128 v[80:83], v8 offset:16384
  v_mfma_f32_16x16x32_bf16 v[244:247], v[28:31], v[84:87], v[244:247]
  s_waitcnt lgkmcnt(4)
  v_mfma_f32_16x16x32_bf16 v[240:243], v[24:27], v[84:87], v[240:243]
  v_mfma_f32_16x16x32_bf16 v[236:239], v[20:23], v[84:87], v[236:239]
  s_nop 0
  v_mfma_f32_16x16x32_bf16 v[232:235], v[16:19], v[84:87], v[232:235]
  ds_read_b128 v[84:87], v8 offset:18432
  v_mfma_f32_16x16x32_bf16 v[88:91], v[32:35], v[48:51], v[88:91]
  v_mfma_f32_16x16x32_bf16 v[92:95], v[36:39], v[48:51], v[92:95]
  v_mfma_f32_16x16x32_bf16 v[96:99], v[40:43], v[48:51], v[96:99]
  v_mfma_f32_16x16x32_bf16 v[100:103], v[44:47], v[48:51], v[100:103]
  v_mfma_f32_16x16x32_bf16 v[116:119], v[44:47], v[52:55], v[116:119]
  v_mfma_f32_16x16x32_bf16 v[112:115], v[40:43], v[52:55], v[112:115]
  v_mfma_f32_16x16x32_bf16 v[108:111], v[36:39], v[52:55], v[108:111]
  v_mfma_f32_16x16x32_bf16 v[104:107], v[32:35], v[52:55], v[104:107]
  s_waitcnt lgkmcnt(0)
  s_barrier
  v_mfma_f32_16x16x32_bf16 v[120:123], v[32:35], v[56:59], v[120:123]
  ds_read_b128 v[48:51], v5 offset:0
  v_mfma_f32_16x16x32_bf16 v[124:127], v[36:39], v[56:59], v[124:127]
  ds_read_b128 v[52:55], v5 offset:2048
  v_mfma_f32_16x16x32_bf16 v[128:131], v[40:43], v[56:59], v[128:131]
  ds_read_b64_tr_b16 v[16:17], v1 offset:0
  v_mfma_f32_16x16x32_bf16 v[132:135], v[44:47], v[56:59], v[132:135]
  ds_read_b128 v[56:59], v5 offset:4096
  v_mfma_f32_16x16x32_bf16 v[148:151], v[44:47], v[60:63], v[148:151]
  ds_read_b64_tr_b16 v[18:19], v1 offset:1024
  v_mfma_f32_16x16x32_bf16 v[144:147], v[40:43], v[60:63], v[144:147]
  ds_read_b64_tr_b16 v[20:21], v2 offset:0
  v_mfma_f32_16x16x32_bf16 v[140:143], v[36:39], v[60:63], v[140:143]
  ds_read_b64_tr_b16 v[22:23], v2 offset:1024
  v_mfma_f32_16x16x32_bf16 v[136:139], v[32:35], v[60:63], v[136:139]
  ds_read_b128 v[60:63], v5 offset:6144
  v_mfma_f32_16x16x32_bf16 v[152:155], v[32:35], v[64:67], v[152:155]
  ds_read_b64_tr_b16 v[24:25], v3 offset:0
  v_mfma_f32_16x16x32_bf16 v[156:159], v[36:39], v[64:67], v[156:159]
  ds_read_b64_tr_b16 v[26:27], v3 offset:1024
  v_mfma_f32_16x16x32_bf16 v[160:163], v[40:43], v[64:67], v[160:163]
  ds_read_b64_tr_b16 v[28:29], v4 offset:0
  v_mfma_f32_16x16x32_bf16 v[164:167], v[44:47], v[64:67], v[164:167]
  ds_read_b128 v[64:67], v5 offset:8192
  v_mfma_f32_16x16x32_bf16 v[180:183], v[44:47], v[68:71], v[180:183]
  ds_read_b64_tr_b16 v[30:31], v4 offset:1024
  v_mfma_f32_16x16x32_bf16 v[176:179], v[40:43], v[68:71], v[176:179]
  v_mfma_f32_16x16x32_bf16 v[172:175], v[36:39], v[68:71], v[172:175]
  v_mfma_f32_16x16x32_bf16 v[168:171], v[32:35], v[68:71], v[168:171]
  ds_read_b128 v[68:71], v5 offset:10240
  v_mfma_f32_16x16x32_bf16 v[184:187], v[32:35], v[72:75], v[184:187]
  v_mfma_f32_16x16x32_bf16 v[188:191], v[36:39], v[72:75], v[188:191]
  v_mfma_f32_16x16x32_bf16 v[192:195], v[40:43], v[72:75], v[192:195]
  v_mfma_f32_16x16x32_bf16 v[196:199], v[44:47], v[72:75], v[196:199]
  ds_read_b128 v[72:75], v5 offset:12288
  v_mfma_f32_16x16x32_bf16 v[212:215], v[44:47], v[76:79], v[212:215]
  v_mfma_f32_16x16x32_bf16 v[208:211], v[40:43], v[76:79], v[208:211]
  v_mfma_f32_16x16x32_bf16 v[204:207], v[36:39], v[76:79], v[204:207]
  v_mfma_f32_16x16x32_bf16 v[200:203], v[32:35], v[76:79], v[200:203]
  ds_read_b128 v[76:79], v5 offset:14336
  v_mfma_f32_16x16x32_bf16 v[216:219], v[32:35], v[80:83], v[216:219]
  v_mfma_f32_16x16x32_bf16 v[220:223], v[36:39], v[80:83], v[220:223]
  v_mfma_f32_16x16x32_bf16 v[224:227], v[40:43], v[80:83], v[224:227]
  v_mfma_f32_16x16x32_bf16 v[228:231], v[44:47], v[80:83], v[228:231]
  ds_read_b128 v[80:83], v5 offset:16384
  v_mfma_f32_16x16x32_bf16 v[244:247], v[44:47], v[84:87], v[244:247]
  s_waitcnt lgkmcnt(4)
  v_mfma_f32_16x16x32_bf16 v[240:243], v[40:43], v[84:87], v[240:243]
  s_add_u32 s72, s72, 1
  s_cmp_lt_u32 s72, 8
  v_mfma_f32_16x16x32_bf16 v[236:239], v[36:39], v[84:87], v[236:239]
  v_mfma_f32_16x16x32_bf16 v[232:235], v[32:35], v[84:87], v[232:235]
  ds_read_b128 v[84:87], v5 offset:18432
  s_cbranch_scc1 L_dnn_loop0
L_tail:
  v_mfma_f32_16x16x32_bf16 v[88:91], v[16:19], v[48:51], v[88:91]
  v_mfma_f32_16x16x32_bf16 v[92:95], v[20:23], v[48:51], v[92:95]
  v_mfma_f32_16x16x32_bf16 v[96:99], v[24:27], v[48:51], v[96:99]
  v_mfma_f32_16x16x32_bf16 v[100:103], v[28:31], v[48:51], v[100:103]
  v_mfma_f32_16x16x32_bf16 v[116:119], v[28:31], v[52:55], v[116:119]
  v_mfma_f32_16x16x32_bf16 v[112:115], v[24:27], v[52:55], v[112:115]
  v_mfma_f32_16x16x32_bf16 v[108:111], v[20:23], v[52:55], v[108:111]
  v_mfma_f32_16x16x32_bf16 v[104:107], v[16:19], v[52:55], v[104:107]
  s_waitcnt lgkmcnt(0)
  s_barrier
  v_mfma_f32_16x16x32_bf16 v[120:123], v[16:19], v[56:59], v[120:123]
  ds_read_b128 v[48:51], v7 offset:0
  v_mfma_f32_16x16x32_bf16 v[124:127], v[20:23], v[56:59], v[124:127]
  ds_read_b128 v[52:55], v7 offset:2048
  v_mfma_f32_16x16x32_bf16 v[128:131], v[24:27], v[56:59], v[128:131]
  ds_read_b64_tr_b16 v[32:33], v1 offset:8192
  v_mfma_f32_16x16x32_bf16 v[132:135], v[28:31], v[56:59], v[132:135]
  ds_read_b128 v[56:59], v7 offset:4096
  v_mfma_f32_16x16x32_bf16 v[148:151], v[28:31], v[60:63], v[148:151]
  ds_read_b64_tr_b16 v[34:35], v1 offset:9216
  v_mfma_f32_16x16x32_bf16 v[144:147], v[24:27], v[60:63], v[144:147]
  ds_read_b64_tr_b16 v[36:37], v2 offset:8192
  v_mfma_f32_16x16x32_bf16 v[140:143], v[20:23], v[60:63], v[140:143]
  ds_read_b64_tr_b16 v[38:39], v2 offset:9216
  v_mfma_f32_16x16x32_bf16 v[136:139], v[16:19], v[60:63], v[136:139]
  ds_read_b128 v[60:63], v7 offset:6144
  v_mfma_f32_16x16x32_bf16 v[152:155], v[16:19], v[64:67], v[152:155]
  ds_read_b64_tr_b16 v[40:41], v3 offset:8192
  v_mfma_f32_16x16x32_bf16 v[156:159], v[20:23], v[64:67], v[156:159]
  ds_read_b64_tr_b16 v[42:43], v3 offset:9216
  v_mfma_f32_16x16x32_bf16 v[160:163], v[24:27], v[64:67], v[160:163]
  ds_read_b64_tr_b16 v[44:45], v4 offset:8192
  v_mfma_f32_16x16x32_bf16 v[164:167], v[28:31], v[64:67], v[164:167]
  ds_read_b128 v[64:67], v7 offset:8192
  v_mfma_f32_16x16x32_bf16 v[180:183], v[28:31], v[68:71], v[180:183]
  ds_read_b64_tr_b16 v[46:47], v4 offset:9216
  v_mfma_f32_16x16x32_bf16 v[176:179], v[24:27], v[68:71], v[176:179]
  v_mfma_f32_16x16x32_bf16 v[172:175], v[20:23], v[68:71], v[172:175]
  v_mfma_f32_16x16x32_bf16 v[168:171], v[16:19], v[68:71], v[168:171]
  ds_read_b128 v[68:71], v7 offset:10240
  v_mfma_f32_16x16x32_bf16 v[184:187], v[16:19], v[72:75], v[184:187]
  v_mfma_f32_16x16x32_bf16 v[188:191], v[20:23], v[72:75], v[188:191]
  v_mfma_f32_16x16x32_bf16 v[192:195], v[24:27], v[72:75], v[192:195]
  v_mfma_f32_16x16x32_bf16 v[196:199], v[28:31], v[72:75], v[196:199]
  ds_read_b128 v[72:75], v7 offset:12288
  v_mfma_f32_16x16x32_bf16 v[212:215], v[28:31], v[76:79], v[212:215]
  v_mfma_f32_16x16x32_bf16 v[208:211], v[24:27], v[76:79], v[208:211]
  v_mfma_f32_16x16x32_bf16 v[204:207], v[20:23], v[76:79], v[204:207]
  v_mfma_f32_16x16x32_bf16 v[200:203], v[16:19], v[76:79], v[200:203]
  ds_read_b128 v[76:79], v7 offset:14336
  v_mfma_f32_16x16x32_bf16 v[216:219], v[16:19], v[80:83], v[216:219]
  v_mfma_f32_16x16x32_bf16 v[220:223], v[20:23], v[80:83], v[220:223]
  v_mfma_f32_16x16x32_bf16 v[224:227], v[24:27], v[80:83], v[224:227]
  v_mfma_f32_16x16x32_bf16 v[228:231], v[28:31], v[80:83], v[228:231]
  ds_read_b128 v[80:83], v7 offset:16384
  v_mfma_f32_16x16x32_bf16 v[244:247], v[28:31], v[84:87], v[244:247]
  s_waitcnt lgkmcnt(4)
  v_mfma_f32_16x16x32_bf16 v[240:243], v[24:27], v[84:87], v[240:243]
  s_nop 0
  v_mfma_f32_16x16x32_bf16 v[236:239], v[20:23], v[84:87], v[236:239]
  v_mfma_f32_16x16x32_bf16 v[232:235], v[16:19], v[84:87], v[232:235]
  ds_read_b128 v[84:87], v7 offset:18432
  v_mfma_f32_16x16x32_bf16 v[88:91], v[32:35], v[48:51], v[88:91]
  v_mfma_f32_16x16x32_bf16 v[92:95], v[36:39], v[48:51], v[92:95]
  v_mfma_f32_16x16x32_bf16 v[96:99], v[40:43], v[48:51], v[96:99]
  v_mfma_f32_16x16x32_bf16 v[100:103], v[44:47], v[48:51], v[100:103]
  v_mfma_f32_16x16x32_bf16 v[116:119], v[44:47], v[52:55], v[116:119]
  v_mfma_f32_16x16x32_bf16 v[112:115], v[40:43], v[52:55], v[112:115]
  v_mfma_f32_16x16x32_bf16 v[108:111], v[36:39], v[52:55], v[108:111]
  v_mfma_f32_16x16x32_bf16 v[104:107], v[32:35], v[52:55], v[104:107]
  s_waitcnt lgkmcnt(0)
  s_barrier
  v_mfma_f32_16x16x32_bf16 v[120:123], v[32:35], v[56:59], v[120:123]
  ds_read_b128 v[48:51], v5 offset:40960
  v_mfma_f32_16x16x32_bf16 v[124:127], v[36:39], v[56:59], v[124:127]
  ds_read_b128 v[52:55], v5 offset:43008
  v_mfma_f32_16x16x32_bf16 v[128:131], v[40:43], v[56:59], v[128:131]
  ds_read_b64_tr_b16 v[16:17], v1 offset:16384
  v_mfma_f32_16x16x32_bf16 v[132:135], v[44:47], v[56:59], v[132:135]
  ds_read_b128 v[56:59], v5 offset:45056
  v_mfma_f32_16x16x32_bf16 v[148:151], v[44:47], v[60:63], v[148:151]
  ds_read_b64_tr_b16 v[18:19], v1 offset:17408
  v_mfma_f32_16x16x32_bf16 v[144:147], v[40:43], v[60:63], v[144:147]
  ds_read_b64_tr_b16 v[20:21], v2 offset:16384
  v_mfma_f32_16x16x32_bf16 v[140:143], v[36:39], v[60:63], v[140:143]
  ds_read_b64_tr_b16 v[22:23], v2 offset:17408
  v_mfma_f32_16x16x32_bf16 v[136:139], v[32:35], v[60:63], v[136:139]
  ds_read_b128 v[60:63], v5 offset:47104
  v_mfma_f32_16x16x32_bf16 v[152:155], v[32:35], v[64:67], v[152:155]
  ds_read_b64_tr_b16 v[24:25], v3 offset:16384
  v_mfma_f32_16x16x32_bf16 v[156:159], v[36:39], v[64:67], v[156:159]
  ds_read_b64_tr_b16 v[26:27], v3 offset:17408
  v_mfma_f32_16x16x32_bf16 v[160:163], v[40:43], v[64:67], v[160:163]
  ds_read_b64_tr_b16 v[28:29], v4 offset:16384
  v_mfma_f32_16x16x32_bf16 v[164:167], v[44:47], v[64:67], v[164:167]
  ds_read_b128 v[64:67], v5 offset:49152
  v_mfma_f32_16x16x32_bf16 v[180:183], v[44:47], v[68:71], v[180:183]
  ds_read_b64_tr_b16 v[30:31], v4 offset:17408
  v_mfma_f32_16x16x32_bf16 v[176:179], v[40:43], v[68:71], v[176:179]
  v_mfma_f32_16x16x32_bf16 v[172:175], v[36:39], v[68:71], v[172:175]
  v_mfma_f32_16x16x32_bf16 v[168:171], v[32:35], v[68:71], v[168:171]
  ds_read_b128 v[68:71], v5 offset:51200
  v_mfma_f32_16x16x32_bf16 v[184:187], v[32:35], v[72:75], v[184:187]
  v_mfma_f32_16x16x32_bf16 v[188:191], v[36:39], v[72:75], v[188:191]
  v_mfma_f32_16x16x32_bf16 v[192:195], v[40:43], v[72:75], v[192:195]
  v_mfma_f32_16x16x32_bf16 v[196:199], v[44:47], v[72:75], v[196:199]
  ds_read_b128 v[72:75], v5 offset:53248
  v_mfma_f32_16x16x32_bf16 v[212:215], v[44:47], v[76:79], v[212:215]
  v_mfma_f32_16x16x32_bf16 v[208:211], v[40:43], v[76:79], v[208:211]
  v_mfma_f32_16x16x32_bf16 v[204:207], v[36:39], v[76:79], v[204:207]
  v_mfma_f32_16x16x32_bf16 v[200:203], v[32:35], v[76:79], v[200:203]
  ds_read_b128 v[76:79], v5 offset:55296
  v_mfma_f32_16x16x32_bf16 v[216:219], v[32:35], v[80:83], v[216:219]
  v_mfma_f32_16x16x32_bf16 v[220:223], v[36:39], v[80:83], v[220:223]
  v_mfma_f32_16x16x32_bf16 v[224:227], v[40:43], v[80:83], v[224:227]
  v_mfma_f32_16x16x32_bf16 v[228:231], v[44:47], v[80:83], v[228:231]
  ds_read_b128 v[80:83], v5 offset:57344
  v_mfma_f32_16x16x32_bf16 v[244:247], v[44:47], v[84:87], v[244:247]
  s_waitcnt lgkmcnt(4)
  v_mfma_f32_16x16x32_bf16 v[240:243], v[40:43], v[84:87], v[240:243]
  v_mfma_f32_16x16x32_bf16 v[236:239], v[36:39], v[84:87], v[236:239]
  v_mfma_f32_16x16x32_bf16 v[232:235], v[32:35], v[84:87], v[232:235]
  ds_read_b128 v[84:87], v5 offset:59392
  v_mfma_f32_16x16x32_bf16 v[88:91], v[16:19], v[48:51], v[88:91]
  s_nop 0
  v_mfma_f32_16x16x32_bf16 v[92:95], v[20:23], v[48:51], v[92:95]
  v_mfma_f32_16x16x32_bf16 v[96:99], v[24:27], v[48:51], v[96:99]
  v_mfma_f32_16x16x32_bf16 v[100:103], v[28:31], v[48:51], v[100:103]
  v_mfma_f32_16x16x32_bf16 v[116:119], v[28:31], v[52:55], v[116:119]
  v_mfma_f32_16x16x32_bf16 v[112:115], v[24:27], v[52:55], v[112:115]
  v_mfma_f32_16x16x32_bf16 v[108:111], v[20:23], v[52:55], v[108:111]
  v_mfma_f32_16x16x32_bf16 v[104:107], v[16:19], v[52:55], v[104:107]
  s_waitcnt lgkmcnt(0)
  s_barrier
  v_mfma_f32_16x16x32_bf16 v[120:123], v[16:19], v[56:59], v[120:123]
  ds_read_b128 v[48:51], v7 offset:40960
  v_mfma_f32_16x16x32_bf16 v[124:127], v[20:23], v[56:59], v[124:127]
  ds_read_b128 v[52:55], v7 offset:43008
  v_mfma_f32_16x16x32_bf16 v[128:131], v[24:27], v[56:59], v[128:131]
  ds_read_b64_tr_b16 v[32:33], v1 offset:0
  v_mfma_f32_16x16x32_bf16 v[132:135], v[28:31], v[56:59], v[132:135]
  ds_read_b128 v[56:59], v7 offset:45056
  v_mfma_f32_16x16x32_bf16 v[148:151], v[28:31], v[60:63], v[148:151]
  ds_read_b64_tr_b16 v[34:35], v1 offset:1024
  v_mfma_f32_16x16x32_bf16 v[144:147], v[24:27], v[60:63], v[144:147]
  ds_read_b64_tr_b16 v[36:37], v2 offset:0
  v_mfma_f32_16x16x32_bf16 v[140:143], v[20:23], v[60:63], v[140:143]
  ds_read_b64_tr_b16 v[38:39], v2 offset:1024
  v_mfma_f32_16x16x32_bf16 v[136:139], v[16:19], v[60:63], v[136:139]
  ds_read_b128 v[60:63], v7 offset:47104
  v_mfma_f32_16x16x32_bf16 v[152:155], v[16:19], v[64:67], v[152:155]
  ds_read_b64_tr_b16 v[40:41], v3 offset:0
  v_mfma_f32_16x16x32_bf16 v[156:159], v[20:23], v[64:67], v[156:159]
  ds_read_b64_tr_b16 v[42:43], v3 offset:1024
  v_mfma_f32_16x16x32_bf16 v[160:163], v[24:27], v[64:67], v[160:163]
  ds_read_b64_tr_b16 v[44:45], v4 offset:0
  v_mfma_f32_16x16x32_bf16 v[164:167], v[28:31], v[64:67], v[164:167]
  ds_read_b128 v[64:67], v7 offset:49152
  v_mfma_f32_16x16x32_bf16 v[180:183], v[28:31], v[68:71], v[180:183]
  ds_read_b64_tr_b16 v[46:47], v4 offset:1024
  v_mfma_f32_16x16x32_bf16 v[176:179], v[24:27], v[68:71], v[176:179]
  v_mfma_f32_16x16x32_bf16 v[172:175], v[20:23], v[68:71], v[172:175]
  v_mfma_f32_16x16x32_bf16 v[168:171], v[16:19], v[68:71], v[168:171]
  ds_read_b128 v[68:71], v7 offset:51200
  v_mfma_f32_16x16x32_bf16 v[184:187], v[16:19], v[72:75], v[184:187]
  v_mfma_f32_16x16x32_bf16 v[188:191], v[20:23], v[72:75], v[188:191]
  v_mfma_f32_16x16x32_bf16 v[192:195], v[24:27], v[72:75], v[192:195]
  v_mfma_f32_16x16x32_bf16 v[196:199], v[28:31], v[72:75], v[196:199]
  ds_read_b128 v[72:75], v7 offset:53248
  v_mfma_f32_16x16x32_bf16 v[212:215], v[28:31], v[76:79], v[212:215]
  v_mfma_f32_16x16x32_bf16 v[208:211], v[24:27], v[76:79], v[208:211]
  v_mfma_f32_16x16x32_bf16 v[204:207], v[20:23], v[76:79], v[204:207]
  v_mfma_f32_16x16x32_bf16 v[200:203], v[16:19], v[76:79], v[200:203]
  ds_read_b128 v[76:79], v7 offset:55296
  v_mfma_f32_16x16x32_bf16 v[216:219], v[16:19], v[80:83], v[216:219]
  v_mfma_f32_16x16x32_bf16 v[220:223], v[20:23], v[80:83], v[220:223]
  v_mfma_f32_16x16x32_bf16 v[224:227], v[24:27], v[80:83], v[224:227]
  v_mfma_f32_16x16x32_bf16 v[228:231], v[28:31], v[80:83], v[228:231]
  ds_read_b128 v[80:83], v7 offset:57344
  v_mfma_f32_16x16x32_bf16 v[244:247], v[28:31], v[84:87], v[244:247]
  s_waitcnt lgkmcnt(4)
  v_mfma_f32_16x16x32_bf16 v[240:243], v[24:27], v[84:87], v[240:243]
  s_nop 0
  v_mfma_f32_16x16x32_bf16 v[236:239], v[20:23], v[84:87], v[236:239]
  v_mfma_f32_16x16x32_bf16 v[232:235], v[16:19], v[84:87], v[232:235]
  ds_read_b128 v[84:87], v7 offset:59392
  v_mfma_f32_16x16x32_bf16 v[88:91], v[32:35], v[48:51], v[88:91]
  ds_read_b64 v[18:19], v9 offset:256
  v_mfma_f32_16x16x32_bf16 v[92:95], v[36:39], v[48:51], v[92:95]
  ds_read_b64 v[22:23], v9 offset:288
  v_mfma_f32_16x16x32_bf16 v[96:99], v[40:43], v[48:51], v[96:99]
  ds_read_b64 v[26:27], v9 offset:320
  v_mfma_f32_16x16x32_bf16 v[100:103], v[44:47], v[48:51], v[100:103]
  ds_read_b64 v[30:31], v9 offset:352
  v_mfma_f32_16x16x32_bf16 v[116:119], v[44:47], v[52:55], v[116:119]
  v_mfma_f32_16x16x32_bf16 v[112:115], v[40:43], v[52:55], v[112:115]
  v_mfma_f32_16x16x32_bf16 v[108:111], v[36:39], v[52:55], v[108:111]
  v_mfma_f32_16x16x32_bf16 v[104:107], v[32:35], v[52:55], v[104:107]
  v_mfma_f32_16x16x32_bf16 v[120:123], v[32:35], v[56:59], v[120:123]
  v_mfma_f32_16x16x32_bf16 v[124:127], v[36:39], v[56:59], v[124:127]
  v_mfma_f32_16x16x32_bf16 v[128:131], v[40:43], v[56:59], v[128:131]
  v_mfma_f32_16x16x32_bf16 v[132:135], v[44:47], v[56:59], v[132:135]
  v_mfma_f32_16x16x32_bf16 v[148:151], v[44:47], v[60:63], v[148:151]
  v_mfma_f32_16x16x32_bf16 v[144:147], v[40:43], v[60:63], v[144:147]
  v_mfma_f32_16x16x32_bf16 v[140:143], v[36:39], v[60:63], v[140:143]
  v_mfma_f32_16x16x32_bf16 v[136:139], v[32:35], v[60:63], v[136:139]
  v_mfma_f32_16x16x32_bf16 v[152:155], v[32:35], v[64:67], v[152:155]
  s_waitcnt lgkmcnt(3)
  v_lshlrev_b32 v16, 16, v18
  v_mfma_f32_16x16x32_bf16 v[156:159], v[36:39], v[64:67], v[156:159]
  v_and_b32 v17, 0xffff0000, v18
  v_mfma_f32_16x16x32_bf16 v[160:163], v[40:43], v[64:67], v[160:163]
  v_lshlrev_b32 v18, 16, v19
  v_mfma_f32_16x16x32_bf16 v[164:167], v[44:47], v[64:67], v[164:167]
  v_and_b32 v19, 0xffff0000, v19
  v_mfma_f32_16x16x32_bf16 v[180:183], v[44:47], v[68:71], v[180:183]
  s_waitcnt lgkmcnt(2)
  v_lshlrev_b32 v20, 16, v22
  v_mfma_f32_16x16x32_bf16 v[176:179], v[40:43], v[68:71], v[176:179]
  v_and_b32 v21, 0xffff0000, v22
  v_mfma_f32_16x16x32_bf16 v[172:175], v[36:39], v[68:71], v[172:175]
  v_lshlrev_b32 v22, 16, v23
  v_mfma_f32_16x16x32_bf16 v[168:171], v[32:35], v[68:71], v[168:171]
  v_and_b32 v23, 0xffff0000, v23
  v_mfma_f32_16x16x32_bf16 v[184:187], v[32:35], v[72:75], v[184:187]
  s_waitcnt lgkmcnt(1)
  v_lshlrev_b32 v24, 16, v26
  v_mfma_f32_16x16x32_bf16 v[188:191], v[36:39], v[72:75], v[188:191]
  v_and_b32 v25, 0xffff0000, v26
  v_mfma_f32_16x16x32_bf16 v[192:195], v[40:43], v[72:75], v[192:195]
  v_lshlrev_b32 v26, 16, v27
  v_mfma_f32_16x16x32_bf16 v[196:199], v[44:47], v[72:75], v[196:199]
  v_and_b32 v27, 0xffff0000, v27
  v_mfma_f32_16x16x32_bf16 v[212:215], v[44:47], v[76:79], v[212:215]
  s_waitcnt lgkmcnt(0)
  v_lshlrev_b32_e64 v28, 16, v30
  v_mfma_f32_16x16x32_bf16 v[208:211], v[40:43], v[76:79], v[208:211]
  v_and_b32 v29, 0xffff0000, v30
  v_mfma_f32_16x16x32_bf16 v[204:207], v[36:39], v[76:79], v[204:207]
  v_lshlrev_b32_e64 v30, 16, v31
  v_mfma_f32_16x16x32_bf16 v[200:203], v[32:35], v[76:79], v[200:203]
  v_and_b32 v31, 0xffff0000, v31
  v_mfma_f32_16x16x32_bf16 v[216:219], v[32:35], v[80:83], v[216:219]
  v_mfma_f32_16x16x32_bf16 v[220:223], v[36:39], v[80:83], v[220:223]
  v_mfma_f32_16x16x32_bf16 v[224:227], v[40:43], v[80:83], v[224:227]
  v_mfma_f32_16x16x32_bf16 v[228:231], v[44:47], v[80:83], v[228:231]
  v_mfma_f32_16x16x32_bf16 v[244:247], v[44:47], v[84:87], v[244:247]
  v_mfma_f32_16x16x32_bf16 v[240:243], v[40:43], v[84:87], v[240:243]
  v_mfma_f32_16x16x32_bf16 v[236:239], v[36:39], v[84:87], v[236:239]
  v_mfma_f32_16x16x32_bf16 v[232:235], v[32:35], v[84:87], v[232:235]
L_epi:
  v_pk_mul_f32 v[52:53], v[88:89], v[88:89]
  v_pk_mul_f32 v[56:57], v[104:105], v[104:105]
  v_pk_mul_f32 v[60:61], v[90:91], v[90:91]
  v_pk_mul_f32 v[64:65], v[106:107], v[106:107]
  v_pk_fma_f32 v[52:53], v[52:53], v[14:15], v[12:13]
  v_pk_fma_f32 v[56:57], v[56:57], v[14:15], v[12:13]
  v_pk_fma_f32 v[60:61], v[60:61], v[14:15], v[12:13]
  v_pk_fma_f32 v[64:65], v[64:65], v[14:15], v[12:13]
  v_pk_mul_f32 v[52:53], v[52:53], v[88:89]
  v_pk_mul_f32 v[56:57], v[56:57], v[104:105]
  v_pk_mul_f32 v[60:61], v[60:61], v[90:91]
  v_pk_mul_f32 v[64:65], v[64:65], v[106:107]
  v_exp_f32 v52, v52
  v_exp_f32 v53, v53
  v_exp_f32 v56, v56
  v_exp_f32 v57, v57
  v_exp_f32 v60, v60
  v_exp_f32 v61, v61
  v_exp_f32 v64, v64
  v_exp_f32 v65, v65
  v_pk_mul_f32 v[54:55], v[88:89], v[16:17]
  v_pk_mul_f32 v[58:59], v[104:105], v[16:17]
  v_pk_mul_f32 v[62:63], v[90:91], v[18:19]
  v_pk_mul_f32 v[66:67], v[106:107], v[18:19]
  v_pk_add_f32 v[52:53], v[52:53], v[248:249]
  v_pk_add_f32 v[56:57], v[56:57], v[248:249]
  v_pk_add_f32 v[60:61], v[60:61], v[248:249]
  v_pk_add_f32 v[64:65], v[64:65], v[248:249]
  v_rcp_f32 v52, v52
  v_rcp_f32 v53, v53
  v_rcp_f32 v56, v56
  v_rcp_f32 v57, v57
  v_rcp_f32 v60, v60
  v_rcp_f32 v61, v61
  v_rcp_f32 v64, v64
  v_rcp_f32 v65, v65
  v_pk_mul_f32 v[32:33], v[52:53], v[54:55]
  v_pk_mul_f32 v[34:35], v[56:57], v[58:59]
  v_pk_fma_f32 v[32:33], v[60:61], v[62:63], v[32:33]
  v_pk_fma_f32 v[34:35], v[64:65], v[66:67], v[34:35]
  v_pk_mul_f32 v[68:69], v[92:93], v[92:93]
  v_pk_mul_f32 v[72:73], v[108:109], v[108:109]
  v_pk_mul_f32 v[76:77], v[94:95], v[94:95]
  v_pk_mul_f32 v[80:81], v[110:111], v[110:111]
  v_pk_fma_f32 v[68:69], v[68:69], v[14:15], v[12:13]
  v_pk_fma_f32 v[72:73], v[72:73], v[14:15], v[12:13]
  v_pk_fma_f32 v[76:77], v[76:77], v[14:15], v[12:13]
  v_pk_fma_f32 v[80:81], v[80:81], v[14:15], v[12:13]
  v_pk_mul_f32 v[68:69], v[68:69], v[92:93]
  v_pk_mul_f32 v[72:73], v[72:73], v[108:109]
  v_pk_mul_f32 v[76:77], v[76:77], v[94:95]
  v_pk_mul_f32 v[80:81], v[80:81], v[110:111]
  v_exp_f32 v68, v68
  v_exp_f32 v69, v69
  v_exp_f32 v72, v72
  v_exp_f32 v73, v73
  v_exp_f32 v76, v76
  v_exp_f32 v77, v77
  v_exp_f32 v80, v80
  v_exp_f32 v81, v81
  v_pk_mul_f32 v[70:71], v[92:93], v[20:21]
  v_pk_mul_f32 v[74:75], v[108:109], v[20:21]
  v_pk_mul_f32 v[78:79], v[94:95], v[22:23]
  v_pk_mul_f32 v[82:83], v[110:111], v[22:23]
  v_pk_add_f32 v[68:69], v[68:69], v[248:249]
  v_pk_add_f32 v[72:73], v[72:73], v[248:249]
  v_pk_add_f32 v[76:77], v[76:77], v[248:249]
  v_pk_add_f32 v[80:81], v[80:81], v[248:249]
  v_rcp_f32 v68, v68
  v_rcp_f32 v69, v69
  v_rcp_f32 v72, v72
  v_rcp_f32 v73, v73
  v_rcp_f32 v76, v76
  v_rcp_f32 v77, v77
  v_rcp_f32 v80, v80
  v_rcp_f32 v81, v81
  v_pk_fma_f32 v[32:33], v[68:69], v[70:71], v[32:33]
  v_pk_fma_f32 v[34:35], v[72:73], v[74:75], v[34:35]
  v_pk_fma_f32 v[32:33], v[76:77], v[78:79], v[32:33]
  v_pk_fma_f32 v[34:35], v[80:81], v[82:83], v[34:35]
  v_pk_mul_f32 v[52:53], v[96:97], v[96:97]
  v_pk_mul_f32 v[56:57], v[112:113], v[112:113]
  v_pk_mul_f32 v[60:61], v[98:99], v[98:99]
  v_pk_mul_f32 v[64:65], v[114:115], v[114:115]
  v_pk_fma_f32 v[52:53], v[52:53], v[14:15], v[12:13]
  v_pk_fma_f32 v[56:57], v[56:57], v[14:15], v[12:13]
  v_pk_fma_f32 v[60:61], v[60:61], v[14:15], v[12:13]
  v_pk_fma_f32 v[64:65], v[64:65], v[14:15], v[12:13]
  v_pk_mul_f32 v[52:53], v[52:53], v[96:97]
  v_pk_mul_f32 v[56:57], v[56:57], v[112:113]
  v_pk_mul_f32 v[60:61], v[60:61], v[98:99]
  v_pk_mul_f32 v[64:65], v[64:65], v[114:115]
  v_exp_f32 v52, v52
  v_exp_f32 v53, v53
  v_exp_f32 v56, v56
  v_exp_f32 v57, v57
  v_exp_f32 v60, v60
  v_exp_f32 v61, v61
  v_exp_f32 v64, v64
  v_exp_f32 v65, v65
  v_pk_mul_f32 v[54:55], v[96:97], v[24:25]
  v_pk_mul_f32 v[58:59], v[112:113], v[24:25]
  v_pk_mul_f32 v[62:63], v[98:99], v[26:27]
  v_pk_mul_f32 v[66:67], v[114:115], v[26:27]
  v_pk_add_f32 v[52:53], v[52:53], v[248:249]
  v_pk_add_f32 v[56:57], v[56:57], v[248:249]
  v_pk_add_f32 v[60:61], v[60:61], v[248:249]
  v_pk_add_f32 v[64:65], v[64:65], v[248:249]
  v_rcp_f32 v52, v52
  v_rcp_f32 v53, v53
  v_rcp_f32 v56, v56
  v_rcp_f32 v57, v57
  v_rcp_f32 v60, v60
  v_rcp_f32 v61, v61
  v_rcp_f32 v64, v64
  v_rcp_f32 v65, v65
  v_pk_fma_f32 v[32:33], v[52:53], v[54:55], v[32:33]
  v_pk_fma_f32 v[34:35], v[56:57], v[58:59], v[34:35]
  v_pk_fma_f32 v[32:33], v[60:61], v[62:63], v[32:33]
  v_pk_fma_f32 v[34:35], v[64:65], v[66:67], v[34:35]
  v_pk_mul_f32 v[68:69], v[100:101], v[100:101]
  v_pk_mul_f32 v[72:73], v[116:117], v[116:117]
  v_pk_mul_f32 v[76:77], v[102:103], v[102:103]
  v_pk_mul_f32 v[80:81], v[118:119], v[118:119]
  v_pk_fma_f32 v[68:69], v[68:69], v[14:15], v[12:13]
  v_pk_fma_f32 v[72:73], v[72:73], v[14:15], v[12:13]
  v_pk_fma_f32 v[76:77], v[76:77], v[14:15], v[12:13]
  v_pk_fma_f32 v[80:81], v[80:81], v[14:15], v[12:13]
  v_pk_mul_f32 v[68:69], v[68:69], v[100:101]
  v_pk_mul_f32 v[72:73], v[72:73], v[116:117]
  v_pk_mul_f32 v[76:77], v[76:77], v[102:103]
  v_pk_mul_f32 v[80:81], v[80:81], v[118:119]
  v_exp_f32 v68, v68
  v_exp_f32 v69, v69
  v_exp_f32 v72, v72
  v_exp_f32 v73, v73
  v_exp_f32 v76, v76
  v_exp_f32 v77, v77
  v_exp_f32 v80, v80
  v_exp_f32 v81, v81
  v_pk_mul_f32 v[70:71], v[100:101], v[28:29]
  v_pk_mul_f32 v[74:75], v[116:117], v[28:29]
  v_pk_mul_f32 v[78:79], v[102:103], v[30:31]
  v_pk_mul_f32 v[82:83], v[118:119], v[30:31]
  v_pk_add_f32 v[68:69], v[68:69], v[248:249]
  v_pk_add_f32 v[72:73], v[72:73], v[248:249]
  v_pk_add_f32 v[76:77], v[76:77], v[248:249]
  v_pk_add_f32 v[80:81], v[80:81], v[248:249]
  v_rcp_f32 v68, v68
  v_rcp_f32 v69, v69
  v_rcp_f32 v72, v72
  v_rcp_f32 v73, v73
  v_rcp_f32 v76, v76
  v_rcp_f32 v77, v77
  v_rcp_f32 v80, v80
  v_rcp_f32 v81, v81
  v_pk_fma_f32 v[32:33], v[68:69], v[70:71], v[32:33]
  v_pk_fma_f32 v[34:35], v[72:73], v[74:75], v[34:35]
  v_pk_fma_f32 v[32:33], v[76:77], v[78:79], v[32:33]
  v_pk_fma_f32 v[34:35], v[80:81], v[82:83], v[34:35]
  v_pk_mul_f32 v[52:53], v[120:121], v[120:121]
  v_pk_mul_f32 v[56:57], v[136:137], v[136:137]
  v_pk_mul_f32 v[60:61], v[122:123], v[122:123]
  v_pk_mul_f32 v[64:65], v[138:139], v[138:139]
  v_pk_fma_f32 v[52:53], v[52:53], v[14:15], v[12:13]
  v_pk_fma_f32 v[56:57], v[56:57], v[14:15], v[12:13]
  v_pk_fma_f32 v[60:61], v[60:61], v[14:15], v[12:13]
  v_pk_fma_f32 v[64:65], v[64:65], v[14:15], v[12:13]
  v_pk_mul_f32 v[52:53], v[52:53], v[120:121]
  v_pk_mul_f32 v[56:57], v[56:57], v[136:137]
  v_pk_mul_f32 v[60:61], v[60:61], v[122:123]
  v_pk_mul_f32 v[64:65], v[64:65], v[138:139]
  v_exp_f32 v52, v52
  v_exp_f32 v53, v53
  v_exp_f32 v56, v56
  v_exp_f32 v57, v57
  v_exp_f32 v60, v60
  v_exp_f32 v61, v61
  v_exp_f32 v64, v64
  v_exp_f32 v65, v65
  v_pk_mul_f32 v[54:55], v[120:121], v[16:17]
  v_pk_mul_f32 v[58:59], v[136:137], v[16:17]
  v_pk_mul_f32 v[62:63], v[122:123], v[18:19]
  v_pk_mul_f32 v[66:67], v[138:139], v[18:19]
  v_pk_add_f32 v[52:53], v[52:53], v[248:249]
  v_pk_add_f32 v[56:57], v[56:57], v[248:249]
  v_pk_add_f32 v[60:61], v[60:61], v[248:249]
  v_pk_add_f32 v[64:65], v[64:65], v[248:249]
  v_rcp_f32 v52, v52
  v_rcp_f32 v53, v53
  v_rcp_f32 v56, v56
  v_rcp_f32 v57, v57
  v_rcp_f32 v60, v60
  v_rcp_f32 v61, v61
  v_rcp_f32 v64, v64
  v_rcp_f32 v65, v65
  v_pk_mul_f32 v[36:37], v[52:53], v[54:55]
  v_pk_mul_f32 v[38:39], v[56:57], v[58:59]
  v_pk_fma_f32 v[36:37], v[60:61], v[62:63], v[36:37]
  v_pk_fma_f32 v[38:39], v[64:65], v[66:67], v[38:39]
  v_pk_mul_f32 v[68:69], v[124:125], v[124:125]
  v_pk_mul_f32 v[72:73], v[140:141], v[140:141]
  v_pk_mul_f32 v[76:77], v[126:127], v[126:127]
  v_pk_mul_f32 v[80:81], v[142:143], v[142:143]
  v_pk_fma_f32 v[68:69], v[68:69], v[14:15], v[12:13]
  v_pk_fma_f32 v[72:73], v[72:73], v[14:15], v[12:13]
  v_pk_fma_f32 v[76:77], v[76:77], v[14:15], v[12:13]
  v_pk_fma_f32 v[80:81], v[80:81], v[14:15], v[12:13]
  v_pk_mul_f32 v[68:69], v[68:69], v[124:125]
  v_pk_mul_f32 v[72:73], v[72:73], v[140:141]
  v_pk_mul_f32 v[76:77], v[76:77], v[126:127]
  v_pk_mul_f32 v[80:81], v[80:81], v[142:143]
  v_exp_f32 v68, v68
  v_exp_f32 v69, v69
  v_exp_f32 v72, v72
  v_exp_f32 v73, v73
  v_exp_f32 v76, v76
  v_exp_f32 v77, v77
  v_exp_f32 v80, v80
  v_exp_f32 v81, v81
  v_pk_mul_f32 v[70:71], v[124:125], v[20:21]
  v_pk_mul_f32 v[74:75], v[140:141], v[20:21]
  v_pk_mul_f32 v[78:79], v[126:127], v[22:23]
  v_pk_mul_f32 v[82:83], v[142:143], v[22:23]
  v_pk_add_f32 v[68:69], v[68:69], v[248:249]
  v_pk_add_f32 v[72:73], v[72:73], v[248:249]
  v_pk_add_f32 v[76:77], v[76:77], v[248:249]
  v_pk_add_f32 v[80:81], v[80:81], v[248:249]
  v_rcp_f32 v68, v68
  v_rcp_f32 v69, v69
  v_rcp_f32 v72, v72
  v_rcp_f32 v73, v73
  v_rcp_f32 v76, v76
  v_rcp_f32 v77, v77
  v_rcp_f32 v80, v80
  v_rcp_f32 v81, v81
  v_pk_fma_f32 v[36:37], v[68:69], v[70:71], v[36:37]
  v_pk_fma_f32 v[38:39], v[72:73], v[74:75], v[38:39]
  v_pk_fma_f32 v[36:37], v[76:77], v[78:79], v[36:37]
  v_pk_fma_f32 v[38:39], v[80:81], v[82:83], v[38:39]
  v_pk_mul_f32 v[52:53], v[128:129], v[128:129]
  v_pk_mul_f32 v[56:57], v[144:145], v[144:145]
  v_pk_mul_f32 v[60:61], v[130:131], v[130:131]
  v_pk_mul_f32 v[64:65], v[146:147], v[146:147]
  v_pk_fma_f32 v[52:53], v[52:53], v[14:15], v[12:13]
  v_pk_fma_f32 v[56:57], v[56:57], v[14:15], v[12:13]
  v_pk_fma_f32 v[60:61], v[60:61], v[14:15], v[12:13]
  v_pk_fma_f32 v[64:65], v[64:65], v[14:15], v[12:13]
  v_pk_mul_f32 v[52:53], v[52:53], v[128:129]
  v_pk_mul_f32 v[56:57], v[56:57], v[144:145]
  v_pk_mul_f32 v[60:61], v[60:61], v[130:131]
  v_pk_mul_f32 v[64:65], v[64:65], v[146:147]
  v_exp_f32 v52, v52
  v_exp_f32 v53, v53
  v_exp_f32 v56, v56
  v_exp_f32 v57, v57
  v_exp_f32 v60, v60
  v_exp_f32 v61, v61
  v_exp_f32 v64, v64
  v_exp_f32 v65, v65
  v_pk_mul_f32 v[54:55], v[128:129], v[24:25]
  v_pk_mul_f32 v[58:59], v[144:145], v[24:25]
  v_pk_mul_f32 v[62:63], v[130:131], v[26:27]
  v_pk_mul_f32 v[66:67], v[146:147], v[26:27]
  v_pk_add_f32 v[52:53], v[52:53], v[248:249]
  v_pk_add_f32 v[56:57], v[56:57], v[248:249]
  v_pk_add_f32 v[60:61], v[60:61], v[248:249]
  v_pk_add_f32 v[64:65], v[64:65], v[248:249]
  v_rcp_f32 v52, v52
  v_rcp_f32 v53, v53
  v_rcp_f32 v56, v56
  v_rcp_f32 v57, v57
  v_rcp_f32 v60, v60
  v_rcp_f32 v61, v61
  v_rcp_f32 v64, v64
  v_rcp_f32 v65, v65
  v_pk_fma_f32 v[36:37], v[52:53], v[54:55], v[36:37]
  v_pk_fma_f32 v[38:39], v[56:57], v[58:59], v[38:39]
  v_pk_fma_f32 v[36:37], v[60:61], v[62:63], v[36:37]
  v_pk_fma_f32 v[38:39], v[64:65], v[66:67], v[38:39]
  v_pk_mul_f32 v[68:69], v[132:133], v[132:133]
  v_pk_mul_f32 v[72:73], v[148:149], v[148:149]
  v_pk_mul_f32 v[76:77], v[134:135], v[134:135]
  v_pk_mul_f32 v[80:81], v[150:151], v[150:151]
  v_pk_fma_f32 v[68:69], v[68:69], v[14:15], v[12:13]
  v_pk_fma_f32 v[72:73], v[72:73], v[14:15], v[12:13]
  v_pk_fma_f32 v[76:77], v[76:77], v[14:15], v[12:13]
  v_pk_fma_f32 v[80:81], v[80:81], v[14:15], v[12:13]
  v_pk_mul_f32 v[68:69], v[68:69], v[132:133]
  v_pk_mul_f32 v[72:73], v[72:73], v[148:149]
  v_pk_mul_f32 v[76:77], v[76:77], v[134:135]
  v_pk_mul_f32 v[80:81], v[80:81], v[150:151]
  v_exp_f32 v68, v68
  v_exp_f32 v69, v69
  v_exp_f32 v72, v72
  v_exp_f32 v73, v73
  v_exp_f32 v76, v76
  v_exp_f32 v77, v77
  v_exp_f32 v80, v80
  v_exp_f32 v81, v81
  v_pk_mul_f32 v[70:71], v[132:133], v[28:29]
  v_pk_mul_f32 v[74:75], v[148:149], v[28:29]
  v_pk_mul_f32 v[78:79], v[134:135], v[30:31]
  v_pk_mul_f32 v[82:83], v[150:151], v[30:31]
  v_pk_add_f32 v[68:69], v[68:69], v[248:249]
  v_pk_add_f32 v[72:73], v[72:73], v[248:249]
  v_pk_add_f32 v[76:77], v[76:77], v[248:249]
  v_pk_add_f32 v[80:81], v[80:81], v[248:249]
  v_rcp_f32 v68, v68
  v_rcp_f32 v69, v69
  v_rcp_f32 v72, v72
  v_rcp_f32 v73, v73
  v_rcp_f32 v76, v76
  v_rcp_f32 v77, v77
  v_rcp_f32 v80, v80
  v_rcp_f32 v81, v81
  v_pk_fma_f32 v[36:37], v[68:69], v[70:71], v[36:37]
  v_pk_fma_f32 v[38:39], v[72:73], v[74:75], v[38:39]
  v_pk_fma_f32 v[36:37], v[76:77], v[78:79], v[36:37]
  v_pk_fma_f32 v[38:39], v[80:81], v[82:83], v[38:39]
  v_pk_mul_f32 v[52:53], v[152:153], v[152:153]
  v_pk_mul_f32 v[56:57], v[168:169], v[168:169]
  v_pk_mul_f32 v[60:61], v[154:155], v[154:155]
  v_pk_mul_f32 v[64:65], v[170:171], v[170:171]
  v_pk_fma_f32 v[52:53], v[52:53], v[14:15], v[12:13]
  v_pk_fma_f32 v[56:57], v[56:57], v[14:15], v[12:13]
  v_pk_fma_f32 v[60:61], v[60:61], v[14:15], v[12:13]
  v_pk_fma_f32 v[64:65], v[64:65], v[14:15], v[12:13]
  v_pk_mul_f32 v[52:53], v[52:53], v[152:153]
  v_pk_mul_f32 v[56:57], v[56:57], v[168:169]
  v_pk_mul_f32 v[60:61], v[60:61], v[154:155]
  v_pk_mul_f32 v[64:65], v[64:65], v[170:171]
  v_exp_f32 v52, v52
  v_exp_f32 v53, v53
  v_exp_f32 v56, v56
  v_exp_f32 v57, v57
  v_exp_f32 v60, v60
  v_exp_f32 v61, v61
  v_exp_f32 v64, v64
  v_exp_f32 v65, v65
  v_pk_mul_f32 v[54:55], v[152:153], v[16:17]
  v_pk_mul_f32 v[58:59], v[168:169], v[16:17]
  v_pk_mul_f32 v[62:63], v[154:155], v[18:19]
  v_pk_mul_f32 v[66:67], v[170:171], v[18:19]
  v_pk_add_f32 v[52:53], v[52:53], v[248:249]
  v_pk_add_f32 v[56:57], v[56:57], v[248:249]
  v_pk_add_f32 v[60:61], v[60:61], v[248:249]
  v_pk_add_f32 v[64:65], v[64:65], v[248:249]
  v_rcp_f32 v52, v52
  v_rcp_f32 v53, v53
  v_rcp_f32 v56, v56
  v_rcp_f32 v57, v57
  v_rcp_f32 v60, v60
  v_rcp_f32 v61, v61
  v_rcp_f32 v64, v64
  v_rcp_f32 v65, v65
  v_pk_mul_f32 v[40:41], v[52:53], v[54:55]
  v_pk_mul_f32 v[42:43], v[56:57], v[58:59]
  v_pk_fma_f32 v[40:41], v[60:61], v[62:63], v[40:41]
  v_pk_fma_f32 v[42:43], v[64:65], v[66:67], v[42:43]
  v_pk_mul_f32 v[68:69], v[156:157], v[156:157]
  v_pk_mul_f32 v[72:73], v[172:173], v[172:173]
  v_pk_mul_f32 v[76:77], v[158:159], v[158:159]
  v_pk_mul_f32 v[80:81], v[174:175], v[174:175]
  v_pk_fma_f32 v[68:69], v[68:69], v[14:15], v[12:13]
  v_pk_fma_f32 v[72:73], v[72:73], v[14:15], v[12:13]
  v_pk_fma_f32 v[76:77], v[76:77], v[14:15], v[12:13]
  v_pk_fma_f32 v[80:81], v[80:81], v[14:15], v[12:13]
  v_pk_mul_f32 v[68:69], v[68:69], v[156:157]
  v_pk_mul_f32 v[72:73], v[72:73], v[172:173]
  v_pk_mul_f32 v[76:77], v[76:77], v[158:159]
  v_pk_mul_f32 v[80:81], v[80:81], v[174:175]
  v_exp_f32 v68, v68
  v_exp_f32 v69, v69
  v_exp_f32 v72, v72
  v_exp_f32 v73, v73
  v_exp_f32 v76, v76
  v_exp_f32 v77, v77
  v_exp_f32 v80, v80
  v_exp_f32 v81, v81
  v_pk_mul_f32 v[70:71], v[156:157], v[20:21]
  v_pk_mul_f32 v[74:75], v[172:173], v[20:21]
  v_pk_mul_f32 v[78:79], v[158:159], v[22:23]
  v_pk_mul_f32 v[82:83], v[174:175], v[22:23]
  v_pk_add_f32 v[68:69], v[68:69], v[248:249]
  v_pk_add_f32 v[72:73], v[72:73], v[248:249]
  v_pk_add_f32 v[76:77], v[76:77], v[248:249]
  v_pk_add_f32 v[80:81], v[80:81], v[248:249]
  v_rcp_f32 v68, v68
  v_rcp_f32 v69, v69
  v_rcp_f32 v72, v72
  v_rcp_f32 v73, v73
  v_rcp_f32 v76, v76
  v_rcp_f32 v77, v77
  v_rcp_f32 v80, v80
  v_rcp_f32 v81, v81
  v_pk_fma_f32 v[40:41], v[68:69], v[70:71], v[40:41]
  v_pk_fma_f32 v[42:43], v[72:73], v[74:75], v[42:43]
  v_pk_fma_f32 v[40:41], v[76:77], v[78:79], v[40:41]
  v_pk_fma_f32 v[42:43], v[80:81], v[82:83], v[42:43]
  v_pk_mul_f32 v[52:53], v[160:161], v[160:161]
  v_pk_mul_f32 v[56:57], v[176:177], v[176:177]
  v_pk_mul_f32 v[60:61], v[162:163], v[162:163]
  v_pk_mul_f32 v[64:65], v[178:179], v[178:179]
  v_pk_fma_f32 v[52:53], v[52:53], v[14:15], v[12:13]
  v_pk_fma_f32 v[56:57], v[56:57], v[14:15], v[12:13]
  v_pk_fma_f32 v[60:61], v[60:61], v[14:15], v[12:13]
  v_pk_fma_f32 v[64:65], v[64:65], v[14:15], v[12:13]
  v_pk_mul_f32 v[52:53], v[52:53], v[160:161]
  v_pk_mul_f32 v[56:57], v[56:57], v[176:177]
  v_pk_mul_f32 v[60:61], v[60:61], v[162:163]
  v_pk_mul_f32 v[64:65], v[64:65], v[178:179]
  v_exp_f32 v52, v52
  v_exp_f32 v53, v53
  v_exp_f32 v56, v56
  v_exp_f32 v57, v57
  v_exp_f32 v60, v60
  v_exp_f32 v61, v61
  v_exp_f32 v64, v64
  v_exp_f32 v65, v65
  v_pk_mul_f32 v[54:55], v[160:161], v[24:25]
  v_pk_mul_f32 v[58:59], v[176:177], v[24:25]
  v_pk_mul_f32 v[62:63], v[162:163], v[26:27]
  v_pk_mul_f32 v[66:67], v[178:179], v[26:27]
  v_pk_add_f32 v[52:53], v[52:53], v[248:249]
  v_pk_add_f32 v[56:57], v[56:57], v[248:249]
  v_pk_add_f32 v[60:61], v[60:61], v[248:249]
  v_pk_add_f32 v[64:65], v[64:65], v[248:249]
  v_rcp_f32 v52, v52
  v_rcp_f32 v53, v53
  v_rcp_f32 v56, v56
  v_rcp_f32 v57, v57
  v_rcp_f32 v60, v60
  v_rcp_f32 v61, v61
  v_rcp_f32 v64, v64
  v_rcp_f32 v65, v65
  v_pk_fma_f32 v[40:41], v[52:53], v[54:55], v[40:41]
  v_pk_fma_f32 v[42:43], v[56:57], v[58:59], v[42:43]
  v_pk_fma_f32 v[40:41], v[60:61], v[62:63], v[40:41]
  v_pk_fma_f32 v[42:43], v[64:65], v[66:67], v[42:43]
  v_pk_mul_f32 v[68:69], v[164:165], v[164:165]
  v_pk_mul_f32 v[72:73], v[180:181], v[180:181]
  v_pk_mul_f32 v[76:77], v[166:167], v[166:167]
  v_pk_mul_f32 v[80:81], v[182:183], v[182:183]
  v_pk_fma_f32 v[68:69], v[68:69], v[14:15], v[12:13]
  v_pk_fma_f32 v[72:73], v[72:73], v[14:15], v[12:13]
  v_pk_fma_f32 v[76:77], v[76:77], v[14:15], v[12:13]
  v_pk_fma_f32 v[80:81], v[80:81], v[14:15], v[12:13]
  v_pk_mul_f32 v[68:69], v[68:69], v[164:165]
  v_pk_mul_f32 v[72:73], v[72:73], v[180:181]
  v_pk_mul_f32 v[76:77], v[76:77], v[166:167]
  v_pk_mul_f32 v[80:81], v[80:81], v[182:183]
  v_exp_f32 v68, v68
  v_exp_f32 v69, v69
  v_exp_f32 v72, v72
  v_exp_f32 v73, v73
  v_exp_f32 v76, v76
  v_exp_f32 v77, v77
  v_exp_f32 v80, v80
  v_exp_f32 v81, v81
  v_pk_mul_f32 v[70:71], v[164:165], v[28:29]
  v_pk_mul_f32 v[74:75], v[180:181], v[28:29]
  v_pk_mul_f32 v[78:79], v[166:167], v[30:31]
  v_pk_mul_f32 v[82:83], v[182:183], v[30:31]
  v_pk_add_f32 v[68:69], v[68:69], v[248:249]
  v_pk_add_f32 v[72:73], v[72:73], v[248:249]
  v_pk_add_f32 v[76:77], v[76:77], v[248:249]
  v_pk_add_f32 v[80:81], v[80:81], v[248:249]
  v_rcp_f32 v68, v68
  v_rcp_f32 v69, v69
  v_rcp_f32 v72, v72
  v_rcp_f32 v73, v73
  v_rcp_f32 v76, v76
  v_rcp_f32 v77, v77
  v_rcp_f32 v80, v80
  v_rcp_f32 v81, v81
  v_pk_fma_f32 v[40:41], v[68:69], v[70:71], v[40:41]
  v_pk_fma_f32 v[42:43], v[72:73], v[74:75], v[42:43]
  v_pk_fma_f32 v[40:41], v[76:77], v[78:79], v[40:41]
  v_pk_fma_f32 v[42:43], v[80:81], v[82:83], v[42:43]
  v_pk_mul_f32 v[52:53], v[184:185], v[184:185]
  v_pk_mul_f32 v[56:57], v[200:201], v[200:201]
  v_pk_mul_f32 v[60:61], v[186:187], v[186:187]
  v_pk_mul_f32 v[64:65], v[202:203], v[202:203]
  v_pk_fma_f32 v[52:53], v[52:53], v[14:15], v[12:13]
  v_pk_fma_f32 v[56:57], v[56:57], v[14:15], v[12:13]
  v_pk_fma_f32 v[60:61], v[60:61], v[14:15], v[12:13]
  v_pk_fma_f32 v[64:65], v[64:65], v[14:15], v[12:13]
  v_pk_mul_f32 v[52:53], v[52:53], v[184:185]
  v_pk_mul_f32 v[56:57], v[56:57], v[200:201]
  v_pk_mul_f32 v[60:61], v[60:61], v[186:187]
  v_pk_mul_f32 v[64:65], v[64:65], v[202:203]
  v_exp_f32 v52, v52
  v_exp_f32 v53, v53
  v_exp_f32 v56, v56
  v_exp_f32 v57, v57
  v_exp_f32 v60, v60
  v_exp_f32 v61, v61
  v_exp_f32 v64, v64
  v_exp_f32 v65, v65
  v_pk_mul_f32 v[54:55], v[184:185], v[16:17]
  v_pk_mul_f32 v[58:59], v[200:201], v[16:17]
  v_pk_mul_f32 v[62:63], v[186:187], v[18:19]
  v_pk_mul_f32 v[66:67], v[202:203], v[18:19]
  v_pk_add_f32 v[52:53], v[52:53], v[248:249]
  v_pk_add_f32 v[56:57], v[56:57], v[248:249]
  v_pk_add_f32 v[60:61], v[60:61], v[248:249]
  v_pk_add_f32 v[64:65], v[64:65], v[248:249]
  v_rcp_f32 v52, v52
  v_rcp_f32 v53, v53
  v_rcp_f32 v56, v56
  v_rcp_f32 v57, v57
  v_rcp_f32 v60, v60
  v_rcp_f32 v61, v61
  v_rcp_f32 v64, v64
  v_rcp_f32 v65, v65
  v_pk_mul_f32 v[44:45], v[52:53], v[54:55]
  v_pk_mul_f32 v[46:47], v[56:57], v[58:59]
  v_pk_fma_f32 v[44:45], v[60:61], v[62:63], v[44:45]
  v_pk_fma_f32 v[46:47], v[64:65], v[66:67], v[46:47]
  v_pk_mul_f32 v[68:69], v[188:189], v[188:189]
  v_pk_mul_f32 v[72:73], v[204:205], v[204:205]
  v_pk_mul_f32 v[76:77], v[190:191], v[190:191]
  v_pk_mul_f32 v[80:81], v[206:207], v[206:207]
  v_pk_fma_f32 v[68:69], v[68:69], v[14:15], v[12:13]
  v_pk_fma_f32 v[72:73], v[72:73], v[14:15], v[12:13]
  v_pk_fma_f32 v[76:77], v[76:77], v[14:15], v[12:13]
  v_pk_fma_f32 v[80:81], v[80:81], v[14:15], v[12:13]
  v_pk_mul_f32 v[68:69], v[68:69], v[188:189]
  v_pk_mul_f32 v[72:73], v[72:73], v[204:205]
  v_pk_mul_f32 v[76:77], v[76:77], v[190:191]
  v_pk_mul_f32 v[80:81], v[80:81], v[206:207]
  v_exp_f32 v68, v68
  v_exp_f32 v69, v69
  v_exp_f32 v72, v72
  v_exp_f32 v73, v73
  v_exp_f32 v76, v76
  v_exp_f32 v77, v77
  v_exp_f32 v80, v80
  v_exp_f32 v81, v81
  v_pk_mul_f32 v[70:71], v[188:189], v[20:21]
  v_pk_mul_f32 v[74:75], v[204:205], v[20:21]
  v_pk_mul_f32 v[78:79], v[190:191], v[22:23]
  v_pk_mul_f32 v[82:83], v[206:207], v[22:23]
  v_pk_add_f32 v[68:69], v[68:69], v[248:249]
  v_pk_add_f32 v[72:73], v[72:73], v[248:249]
  v_pk_add_f32 v[76:77], v[76:77], v[248:249]
  v_pk_add_f32 v[80:81], v[80:81], v[248:249]
  v_rcp_f32 v68, v68
  v_rcp_f32 v69, v69
  v_rcp_f32 v72, v72
  v_rcp_f32 v73, v73
  v_rcp_f32 v76, v76
  v_rcp_f32 v77, v77
  v_rcp_f32 v80, v80
  v_rcp_f32 v81, v81
  v_pk_fma_f32 v[44:45], v[68:69], v[70:71], v[44:45]
  v_pk_fma_f32 v[46:47], v[72:73], v[74:75], v[46:47]
  v_pk_fma_f32 v[44:45], v[76:77], v[78:79], v[44:45]
  v_pk_fma_f32 v[46:47], v[80:81], v[82:83], v[46:47]
  v_pk_mul_f32 v[52:53], v[192:193], v[192:193]
  v_pk_mul_f32 v[56:57], v[208:209], v[208:209]
  v_pk_mul_f32 v[60:61], v[194:195], v[194:195]
  v_pk_mul_f32 v[64:65], v[210:211], v[210:211]
  v_pk_fma_f32 v[52:53], v[52:53], v[14:15], v[12:13]
  v_pk_fma_f32 v[56:57], v[56:57], v[14:15], v[12:13]
  v_pk_fma_f32 v[60:61], v[60:61], v[14:15], v[12:13]
  v_pk_fma_f32 v[64:65], v[64:65], v[14:15], v[12:13]
  v_pk_mul_f32 v[52:53], v[52:53], v[192:193]
  v_pk_mul_f32 v[56:57], v[56:57], v[208:209]
  v_pk_mul_f32 v[60:61], v[60:61], v[194:195]
  v_pk_mul_f32 v[64:65], v[64:65], v[210:211]
  v_exp_f32 v52, v52
  v_exp_f32 v53, v53
  v_exp_f32 v56, v56
  v_exp_f32 v57, v57
  v_exp_f32 v60, v60
  v_exp_f32 v61, v61
  v_exp_f32 v64, v64
  v_exp_f32 v65, v65
  v_pk_mul_f32 v[54:55], v[192:193], v[24:25]
  v_pk_mul_f32 v[58:59], v[208:209], v[24:25]
  v_pk_mul_f32 v[62:63], v[194:195], v[26:27]
  v_pk_mul_f32 v[66:67], v[210:211], v[26:27]
  v_pk_add_f32 v[52:53], v[52:53], v[248:249]
  v_pk_add_f32 v[56:57], v[56:57], v[248:249]
  v_pk_add_f32 v[60:61], v[60:61], v[248:249]
  v_pk_add_f32 v[64:65], v[64:65], v[248:249]
  v_rcp_f32 v52, v52
  v_rcp_f32 v53, v53
  v_rcp_f32 v56, v56
  v_rcp_f32 v57, v57
  v_rcp_f32 v60, v60
  v_rcp_f32 v61, v61
  v_rcp_f32 v64, v64
  v_rcp_f32 v65, v65
  v_pk_fma_f32 v[44:45], v[52:53], v[54:55], v[44:45]
  v_pk_fma_f32 v[46:47], v[56:57], v[58:59], v[46:47]
  v_pk_fma_f32 v[44:45], v[60:61], v[62:63], v[44:45]
  v_pk_fma_f32 v[46:47], v[64:65], v[66:67], v[46:47]
  v_pk_mul_f32 v[68:69], v[196:197], v[196:197]
  v_pk_mul_f32 v[72:73], v[212:213], v[212:213]
  v_pk_mul_f32 v[76:77], v[198:199], v[198:199]
  v_pk_mul_f32 v[80:81], v[214:215], v[214:215]
  v_pk_fma_f32 v[68:69], v[68:69], v[14:15], v[12:13]
  v_pk_fma_f32 v[72:73], v[72:73], v[14:15], v[12:13]
  v_pk_fma_f32 v[76:77], v[76:77], v[14:15], v[12:13]
  v_pk_fma_f32 v[80:81], v[80:81], v[14:15], v[12:13]
  v_pk_mul_f32 v[68:69], v[68:69], v[196:197]
  v_pk_mul_f32 v[72:73], v[72:73], v[212:213]
  v_pk_mul_f32 v[76:77], v[76:77], v[198:199]
  v_pk_mul_f32 v[80:81], v[80:81], v[214:215]
  v_exp_f32 v68, v68
  v_exp_f32 v69, v69
  v_exp_f32 v72, v72
  v_exp_f32 v73, v73
  v_exp_f32 v76, v76
  v_exp_f32 v77, v77
  v_exp_f32 v80, v80
  v_exp_f32 v81, v81
  v_pk_mul_f32 v[70:71], v[196:197], v[28:29]
  v_pk_mul_f32 v[74:75], v[212:213], v[28:29]
  v_pk_mul_f32 v[78:79], v[198:199], v[30:31]
  v_pk_mul_f32 v[82:83], v[214:215], v[30:31]
  v_pk_add_f32 v[68:69], v[68:69], v[248:249]
  v_pk_add_f32 v[72:73], v[72:73], v[248:249]
  v_pk_add_f32 v[76:77], v[76:77], v[248:249]
  v_pk_add_f32 v[80:81], v[80:81], v[248:249]
  v_rcp_f32 v68, v68
  v_rcp_f32 v69, v69
  v_rcp_f32 v72, v72
  v_rcp_f32 v73, v73
  v_rcp_f32 v76, v76
  v_rcp_f32 v77, v77
  v_rcp_f32 v80, v80
  v_rcp_f32 v81, v81
  v_pk_fma_f32 v[44:45], v[68:69], v[70:71], v[44:45]
  v_pk_fma_f32 v[46:47], v[72:73], v[74:75], v[46:47]
  v_pk_fma_f32 v[44:45], v[76:77], v[78:79], v[44:45]
  v_pk_fma_f32 v[46:47], v[80:81], v[82:83], v[46:47]
  v_pk_mul_f32 v[52:53], v[216:217], v[216:217]
  v_pk_mul_f32 v[56:57], v[232:233], v[232:233]
  v_pk_mul_f32 v[60:61], v[218:219], v[218:219]
  v_pk_mul_f32 v[64:65], v[234:235], v[234:235]
  v_pk_fma_f32 v[52:53], v[52:53], v[14:15], v[12:13]
  v_pk_fma_f32 v[56:57], v[56:57], v[14:15], v[12:13]
  v_pk_fma_f32 v[60:61], v[60:61], v[14:15], v[12:13]
  v_pk_fma_f32 v[64:65], v[64:65], v[14:15], v[12:13]
  v_pk_mul_f32 v[52:53], v[52:53], v[216:217]
  v_pk_mul_f32 v[56:57], v[56:57], v[232:233]
  v_pk_mul_f32 v[60:61], v[60:61], v[218:219]
  v_pk_mul_f32 v[64:65], v[64:65], v[234:235]
  v_exp_f32 v52, v52
  v_exp_f32 v53, v53
  v_exp_f32 v56, v56
  v_exp_f32 v57, v57
  v_exp_f32 v60, v60
  v_exp_f32 v61, v61
  v_exp_f32 v64, v64
  v_exp_f32 v65, v65
  v_pk_mul_f32 v[54:55], v[216:217], v[16:17]
  v_pk_mul_f32 v[58:59], v[232:233], v[16:17]
  v_pk_mul_f32 v[62:63], v[218:219], v[18:19]
  v_pk_mul_f32 v[66:67], v[234:235], v[18:19]
  v_pk_add_f32 v[52:53], v[52:53], v[248:249]
  v_pk_add_f32 v[56:57], v[56:57], v[248:249]
  v_pk_add_f32 v[60:61], v[60:61], v[248:249]
  v_pk_add_f32 v[64:65], v[64:65], v[248:249]
  v_rcp_f32 v52, v52
  v_rcp_f32 v53, v53
  v_rcp_f32 v56, v56
  v_rcp_f32 v57, v57
  v_rcp_f32 v60, v60
  v_rcp_f32 v61, v61
  v_rcp_f32 v64, v64
  v_rcp_f32 v65, v65
  v_pk_mul_f32 v[48:49], v[52:53], v[54:55]
  v_pk_mul_f32 v[50:51], v[56:57], v[58:59]
  v_pk_fma_f32 v[48:49], v[60:61], v[62:63], v[48:49]
  v_pk_fma_f32 v[50:51], v[64:65], v[66:67], v[50:51]
  v_pk_mul_f32 v[68:69], v[220:221], v[220:221]
  v_pk_mul_f32 v[72:73], v[236:237], v[236:237]
  v_pk_mul_f32 v[76:77], v[222:223], v[222:223]
  v_pk_mul_f32 v[80:81], v[238:239], v[238:239]
  v_pk_fma_f32 v[68:69], v[68:69], v[14:15], v[12:13]
  v_pk_fma_f32 v[72:73], v[72:73], v[14:15], v[12:13]
  v_pk_fma_f32 v[76:77], v[76:77], v[14:15], v[12:13]
  v_pk_fma_f32 v[80:81], v[80:81], v[14:15], v[12:13]
  v_pk_mul_f32 v[68:69], v[68:69], v[220:221]
  v_pk_mul_f32 v[72:73], v[72:73], v[236:237]
  v_pk_mul_f32 v[76:77], v[76:77], v[222:223]
  v_pk_mul_f32 v[80:81], v[80:81], v[238:239]
  v_exp_f32 v68, v68
  v_exp_f32 v69, v69
  v_exp_f32 v72, v72
  v_exp_f32 v73, v73
  v_exp_f32 v76, v76
  v_exp_f32 v77, v77
  v_exp_f32 v80, v80
  v_exp_f32 v81, v81
  v_pk_mul_f32 v[70:71], v[220:221], v[20:21]
  v_pk_mul_f32 v[74:75], v[236:237], v[20:21]
  v_pk_mul_f32 v[78:79], v[222:223], v[22:23]
  v_pk_mul_f32 v[82:83], v[238:239], v[22:23]
  v_pk_add_f32 v[68:69], v[68:69], v[248:249]
  v_pk_add_f32 v[72:73], v[72:73], v[248:249]
  v_pk_add_f32 v[76:77], v[76:77], v[248:249]
  v_pk_add_f32 v[80:81], v[80:81], v[248:249]
  v_rcp_f32 v68, v68
  v_rcp_f32 v69, v69
  v_rcp_f32 v72, v72
  v_rcp_f32 v73, v73
  v_rcp_f32 v76, v76
  v_rcp_f32 v77, v77
  v_rcp_f32 v80, v80
  v_rcp_f32 v81, v81
  v_pk_fma_f32 v[48:49], v[68:69], v[70:71], v[48:49]
  v_pk_fma_f32 v[50:51], v[72:73], v[74:75], v[50:51]
  v_pk_fma_f32 v[48:49], v[76:77], v[78:79], v[48:49]
  v_pk_fma_f32 v[50:51], v[80:81], v[82:83], v[50:51]
  v_pk_mul_f32 v[52:53], v[224:225], v[224:225]
  v_pk_mul_f32 v[56:57], v[240:241], v[240:241]
  v_pk_mul_f32 v[60:61], v[226:227], v[226:227]
  v_pk_mul_f32 v[64:65], v[242:243], v[242:243]
  v_pk_fma_f32 v[52:53], v[52:53], v[14:15], v[12:13]
  v_pk_fma_f32 v[56:57], v[56:57], v[14:15], v[12:13]
  v_pk_fma_f32 v[60:61], v[60:61], v[14:15], v[12:13]
  v_pk_fma_f32 v[64:65], v[64:65], v[14:15], v[12:13]
  v_pk_mul_f32 v[52:53], v[52:53], v[224:225]
  v_pk_mul_f32 v[56:57], v[56:57], v[240:241]
  v_pk_mul_f32 v[60:61], v[60:61], v[226:227]
  v_pk_mul_f32 v[64:65], v[64:65], v[242:243]
  v_exp_f32 v52, v52
  v_exp_f32 v53, v53
  v_exp_f32 v56, v56
  v_exp_f32 v57, v57
  v_exp_f32 v60, v60
  v_exp_f32 v61, v61
  v_exp_f32 v64, v64
  v_exp_f32 v65, v65
  v_pk_mul_f32 v[54:55], v[224:225], v[24:25]
  v_pk_mul_f32 v[58:59], v[240:241], v[24:25]
  v_pk_mul_f32 v[62:63], v[226:227], v[26:27]
  v_pk_mul_f32 v[66:67], v[242:243], v[26:27]
  v_pk_add_f32 v[52:53], v[52:53], v[248:249]
  v_pk_add_f32 v[56:57], v[56:57], v[248:249]
  v_pk_add_f32 v[60:61], v[60:61], v[248:249]
  v_pk_add_f32 v[64:65], v[64:65], v[248:249]
  v_rcp_f32 v52, v52
  v_rcp_f32 v53, v53
  v_rcp_f32 v56, v56
  v_rcp_f32 v57, v57
  v_rcp_f32 v60, v60
  v_rcp_f32 v61, v61
  v_rcp_f32 v64, v64
  v_rcp_f32 v65, v65
  v_pk_fma_f32 v[48:49], v[52:53], v[54:55], v[48:49]
  v_pk_fma_f32 v[50:51], v[56:57], v[58:59], v[50:51]
  v_pk_fma_f32 v[48:49], v[60:61], v[62:63], v[48:49]
  v_pk_fma_f32 v[50:51], v[64:65], v[66:67], v[50:51]
  v_pk_mul_f32 v[68:69], v[228:229], v[228:229]
  v_pk_mul_f32 v[72:73], v[244:245], v[244:245]
  v_pk_mul_f32 v[76:77], v[230:231], v[230:231]
  v_pk_mul_f32 v[80:81], v[246:247], v[246:247]
  v_pk_fma_f32 v[68:69], v[68:69], v[14:15], v[12:13]
  v_pk_fma_f32 v[72:73], v[72:73], v[14:15], v[12:13]
  v_pk_fma_f32 v[76:77], v[76:77], v[14:15], v[12:13]
  v_pk_fma_f32 v[80:81], v[80:81], v[14:15], v[12:13]
  v_pk_mul_f32 v[68:69], v[68:69], v[228:229]
  v_pk_mul_f32 v[72:73], v[72:73], v[244:245]
  v_pk_mul_f32 v[76:77], v[76:77], v[230:231]
  v_pk_mul_f32 v[80:81], v[80:81], v[246:247]
  v_exp_f32 v68, v68
  v_exp_f32 v69, v69
  v_exp_f32 v72, v72
  v_exp_f32 v73, v73
  v_exp_f32 v76, v76
  v_exp_f32 v77, v77
  v_exp_f32 v80, v80
  v_exp_f32 v81, v81
  v_pk_mul_f32 v[70:71], v[228:229], v[28:29]
  v_pk_mul_f32 v[74:75], v[244:245], v[28:29]
  v_pk_mul_f32 v[78:79], v[230:231], v[30:31]
  v_pk_mul_f32 v[82:83], v[246:247], v[30:31]
  v_pk_add_f32 v[68:69], v[68:69], v[248:249]
  v_pk_add_f32 v[72:73], v[72:73], v[248:249]
  v_pk_add_f32 v[76:77], v[76:77], v[248:249]
  v_pk_add_f32 v[80:81], v[80:81], v[248:249]
  v_rcp_f32 v68, v68
  v_rcp_f32 v69, v69
  v_rcp_f32 v72, v72
  v_rcp_f32 v73, v73
  v_rcp_f32 v76, v76
  v_rcp_f32 v77, v77
  v_rcp_f32 v80, v80
  v_rcp_f32 v81, v81
  v_pk_fma_f32 v[48:49], v[68:69], v[70:71], v[48:49]
  v_pk_fma_f32 v[50:51], v[72:73], v[74:75], v[50:51]
  v_pk_fma_f32 v[48:49], v[76:77], v[78:79], v[48:49]
  v_pk_fma_f32 v[50:51], v[80:81], v[82:83], v[50:51]
  v_add_f32 v32, v32, v33
  v_add_f32 v34, v34, v35
  v_add_f32 v36, v36, v37
  v_add_f32 v38, v38, v39
  v_add_f32 v40, v40, v41
  v_add_f32 v42, v42, v43
  v_add_f32 v44, v44, v45
  v_add_f32 v46, v46, v47
  v_add_f32 v48, v48, v49
  v_add_f32 v50, v50, v51
  v_permlane32_swap_b32 v32, v34
  v_permlane32_swap_b32 v36, v38
  v_permlane32_swap_b32 v40, v42
  v_permlane32_swap_b32 v44, v46
  v_permlane32_swap_b32 v48, v50
  v_add_f32 v48, v48, v50
  v_add_f32 v32, v32, v34
  v_add_f32 v36, v36, v38
  v_add_f32 v40, v40, v42
  v_add_f32 v44, v44, v46
  v_mov_b32 v50, v48
  v_permlane16_swap_b32 v32, v36
  v_permlane16_swap_b32 v40, v44
  v_permlane16_swap_b32 v48, v50
  v_add_f32 v32, v32, v36
  v_add_f32 v40, v40, v44
  v_add_f32_e64 v48, v48, v50
  ds_write_b32 v10, v32
  ds_write_b32 v10, v40 offset:256
  s_mov_b32 exec_lo, 0xffff
  s_mov_b32 exec_hi, 0xffff
  ds_write_b32 v10, v48 offset:512
  s_mov_b64 exec, -1
  s_waitcnt lgkmcnt(0)
  s_barrier
  s_endpgm
L_ld_tail:
  s_barrier
  s_add_u32 m0, s75, 122880
  s_nop 0
  buffer_load_dwordx4 v4, s[44:47], s74 offen lds
  s_add_u32 m0, s75, 123904
  s_nop 0
  buffer_load_dwordx4 v5, s[44:47], s74 offen lds
  s_add_u32 s74, s74, 106496
  s_mov_b32 m0, 147712
  s_mov_b64 exec, 0xffff
  buffer_load_dwordx4 v11, s[52:55], s77 offen lds
  s_mov_b64 exec, -1
  s_mov_b32 s60, s24
  s_and_b32 s61, s25, 0xffff
  s_mov_b32 s62, 268435456
  s_mov_b32 s63, 0x20000
  s_mov_b32 s56, s20
  s_and_b32 s57, s21, 0xffff
  s_mov_b32 s58, 8192
  s_mov_b32 s59, 0x20000
  s_mov_b32 s64, s22
  s_and_b32 s65, s23, 0xffff
  s_mov_b32 s66, 256
  s_mov_b32 s67, 0x20000
  s_load_dword s80, s[18:19], 0
  v_mov_b32 v100, 0
  s_mov_b64 exec, 1
  s_mov_b32 s81, 0x80000
  buffer_load_dword v101, v100, s[60:63], s81 offen
  buffer_load_dword v102, v100, s[56:59], 0 offen
  s_mov_b64 exec, -1
  s_mov_b64 exec, 1
  buffer_load_dword v250, v100, s[64:67], 0 offen offset:240 sc1
  s_mov_b64 exec, -1
  s_waitcnt vmcnt(11)
  s_barrier
  s_waitcnt vmcnt(0)
  s_barrier
  s_cmp_lg_u32 s3, 4
  s_cbranch_scc1 L_end
  v_lshlrev_b32 v3, 4, v0
  v_lshlrev_b32 v4, 2, v0
  v_add_u32 v1, 147968, v3
  v_add_u32 v2, 148992, v4
  v_add_u32 v4, 1024, v4
  v_mov_b32 v5, 32
  v_mov_b32 v7, s26
  s_mul_i32 s68, s26, 1280
  s_mul_i32 s69, s27, 16640
  s_add_u32 s69, s69, s68
  s_setprio 3
  s_barrier
  ds_read_b128 v[64:67], v1
  ds_read_b128 v[72:75], v1 offset:1280
  ds_read2st64_b32 v[68:69], v2 offset0:0 offset1:5
  s_waitcnt lgkmcnt(0)
  v_pk_add_f32 v[64:65], v[64:65], v[72:73]
  v_pk_add_f32 v[66:67], v[66:67], v[74:75]
  v_add_f32 v68, v68, v69
  buffer_store_dwordx4 v[64:67], v3, s[60:63], s69 offen sc1
  buffer_store_dword v68, v4, s[60:63], s69 offen sc1
  s_mov_b64 exec, 1
L_pub:
  v_lshlrev_b32 v6, 4, v7
  v_cmp_eq_u32 vcc, 12, v7
  v_mov_b32 v8, 436
  v_mov_b32 v9, 434
  v_cndmask_b32 v8, v8, v9, vcc
  v_sub_u32_e64 v8, v8, v5
  s_waitcnt vmcnt(0)
  buffer_atomic_add v5, v6, s[64:67], 0 offen sc0
  s_waitcnt vmcnt(0) lgkmcnt(0)
  v_cmp_eq_u32 s[82:83], v5, v8
  s_mov_b64 exec, -1
  s_lshl_b32 s80, s80, 16
L_fin:
  s_cmp_eq_u32 s82, 0
  s_cbranch_scc1 L_done
  s_ff1_i32_b32 s70, s82
  s_bitset0_b32 s82, s70
  v_readlane_b32 s71, v7, s70
  s_nop 0
  s_mul_i32 s68, s71, 1280
  s_mul_i32 s71, s71, 640
  buffer_load_dwordx4 v[64:67], v3, s[60:63], s68 offen sc1
  buffer_load_dword v68, v4, s[60:63], s68 offen sc1
  s_add_u32 s68, s68, 16640
  buffer_load_dwordx4 v[72:75], v3, s[60:63], s68 offen sc1
  buffer_load_dword v76, v4, s[60:63], s68 offen sc1
  s_add_u32 s68, s68, 16640
  buffer_load_dwordx4 v[80:83], v3, s[60:63], s68 offen sc1
  buffer_load_dword v84, v4, s[60:63], s68 offen sc1
  s_add_u32 s68, s68, 16640
  buffer_load_dwordx4 v[88:91], v3, s[60:63], s68 offen sc1
  buffer_load_dword v92, v4, s[60:63], s68 offen sc1
  s_add_u32 s68, s68, 16640
  buffer_load_dwordx4 v[96:99], v3, s[60:63], s68 offen sc1
  buffer_load_dword v100, v4, s[60:63], s68 offen sc1
  s_add_u32 s68, s68, 16640
  buffer_load_dwordx4 v[104:107], v3, s[60:63], s68 offen sc1
  buffer_load_dword v108, v4, s[60:63], s68 offen sc1
  s_add_u32 s68, s68, 16640
  buffer_load_dwordx4 v[112:115], v3, s[60:63], s68 offen sc1
  buffer_load_dword v116, v4, s[60:63], s68 offen sc1
  s_add_u32 s68, s68, 16640
  buffer_load_dwordx4 v[120:123], v3, s[60:63], s68 offen sc1
  buffer_load_dword v124, v4, s[60:63], s68 offen sc1
  s_add_u32 s68, s68, 16640
  buffer_load_dwordx4 v[128:131], v3, s[60:63], s68 offen sc1
  buffer_load_dword v132, v4, s[60:63], s68 offen sc1
  s_add_u32 s68, s68, 16640
  buffer_load_dwordx4 v[136:139], v3, s[60:63], s68 offen sc1
  buffer_load_dword v140, v4, s[60:63], s68 offen sc1
  s_add_u32 s68, s68, 16640
  buffer_load_dwordx4 v[144:147], v3, s[60:63], s68 offen sc1
  buffer_load_dword v148, v4, s[60:63], s68 offen sc1
  s_add_u32 s68, s68, 16640
  buffer_load_dwordx4 v[152:155], v3, s[60:63], s68 offen sc1
  buffer_load_dword v156, v4, s[60:63], s68 offen sc1
  s_add_u32 s68, s68, 16640
  buffer_load_dwordx4 v[160:163], v3, s[60:63], s68 offen sc1
  buffer_load_dword v164, v4, s[60:63], s68 offen sc1
  s_add_u32 s68, s68, 16640
  buffer_load_dwordx4 v[168:171], v3, s[60:63], s68 offen sc1
  buffer_load_dword v172, v4, s[60:63], s68 offen sc1
  s_add_u32 s68, s68, 16640
  v_lshrrev_b32 v1, 1, v3
  v_lshrrev_b32 v2, 1, v4
  s_waitcnt vmcnt(25)
  v_pk_add_f32 v[64:65], v[64:65], v[72:73]
  v_pk_add_f32 v[66:67], v[66:67], v[74:75]
  s_waitcnt vmcnt(24)
  v_add_f32 v68, v68, v76
  s_waitcnt vmcnt(23)
  v_pk_add_f32 v[64:65], v[64:65], v[80:81]
  v_pk_add_f32 v[66:67], v[66:67], v[82:83]
  s_waitcnt vmcnt(22)
  v_add_f32 v68, v68, v84
  s_waitcnt vmcnt(21)
  v_pk_add_f32 v[64:65], v[64:65], v[88:89]
  v_pk_add_f32 v[66:67], v[66:67], v[90:91]
  s_waitcnt vmcnt(20)
  v_add_f32 v68, v68, v92
  s_waitcnt vmcnt(19)
  v_pk_add_f32 v[64:65], v[64:65], v[96:97]
  v_pk_add_f32 v[66:67], v[66:67], v[98:99]
  s_waitcnt vmcnt(18)
  v_add_f32 v68, v68, v100
  s_waitcnt vmcnt(17)
  v_pk_add_f32 v[64:65], v[64:65], v[104:105]
  v_pk_add_f32 v[66:67], v[66:67], v[106:107]
  s_waitcnt vmcnt(16)
  v_add_f32 v68, v68, v108
  s_waitcnt vmcnt(15)
  v_pk_add_f32 v[64:65], v[64:65], v[112:113]
  v_pk_add_f32 v[66:67], v[66:67], v[114:115]
  s_waitcnt vmcnt(14)
  v_add_f32 v68, v68, v116
  s_waitcnt vmcnt(13)
  v_pk_add_f32 v[64:65], v[64:65], v[120:121]
  v_pk_add_f32 v[66:67], v[66:67], v[122:123]
  s_waitcnt vmcnt(12)
  v_add_f32 v68, v68, v124
  s_waitcnt vmcnt(11)
  v_pk_add_f32 v[64:65], v[64:65], v[128:129]
  v_pk_add_f32 v[66:67], v[66:67], v[130:131]
  s_waitcnt vmcnt(10)
  v_add_f32 v68, v68, v132
  s_waitcnt vmcnt(9)
  v_pk_add_f32 v[64:65], v[64:65], v[136:137]
  v_pk_add_f32 v[66:67], v[66:67], v[138:139]
  s_waitcnt vmcnt(8)
  v_add_f32 v68, v68, v140
  s_waitcnt vmcnt(7)
  v_pk_add_f32 v[64:65], v[64:65], v[144:145]
  v_pk_add_f32 v[66:67], v[66:67], v[146:147]
  s_waitcnt vmcnt(6)
  v_add_f32_e64 v68, v68, v148
  s_waitcnt vmcnt(5)
  v_pk_add_f32 v[64:65], v[64:65], v[152:153]
  v_pk_add_f32 v[66:67], v[66:67], v[154:155]
  s_waitcnt vmcnt(4)
  v_add_f32 v68, v68, v156
  s_waitcnt vmcnt(3)
  v_pk_add_f32 v[64:65], v[64:65], v[160:161]
  v_pk_add_f32 v[66:67], v[66:67], v[162:163]
  s_waitcnt vmcnt(2)
  v_add_f32 v68, v68, v164
  s_waitcnt vmcnt(1)
  v_pk_add_f32 v[64:65], v[64:65], v[168:169]
  v_pk_add_f32 v[66:67], v[66:67], v[170:171]
  s_waitcnt vmcnt(0)
  v_add_f32 v68, v68, v172
  v_add_f32 v64, s80, v64
  v_add_f32 v65, s80, v65
  v_add_f32 v66, s80, v66
  v_add_f32 v67, s80, v67
  v_add_f32_e64 v68, s80, v68
  v_cvt_pk_bf16_f32 v10, v64, v65
  v_cvt_pk_bf16_f32 v11, v66, v67
  v_cvt_pk_bf16_f32 v12, v68, v68
  buffer_store_dwordx2 v[10:11], v1, s[56:59], s71 offen
  buffer_store_short v12, v2, s[56:59], s71 offen
  s_branch L_fin
L_done:
  s_endpgm
L_cin_done:
  s_mov_b32 s60, s24
  s_and_b32 s61, s25, 0xffff
  s_mov_b32 s62, 268435456
  s_mov_b32 s63, 0x20000
  s_mov_b32 s56, s20
  s_and_b32 s57, s21, 0xffff
  s_mov_b32 s58, 8192
  s_mov_b32 s59, 0x20000
  s_mov_b32 s64, s22
  s_and_b32 s65, s23, 0xffff
  s_mov_b32 s66, 256
  s_mov_b32 s67, 0x20000
  v_mul_f32 v116, v184, v192
  v_mul_f32 v117, v185, v193
  v_mul_f32 v118, v186, v194
  v_mul_f32 v119, v187, v195
  v_fmac_f32 v116, v188, v191
  v_fmac_f32 v117, v200, v208
  v_fmac_f32 v118, v201, v209
  v_fmac_f32 v119, v202, v210
  v_fmac_f32 v116, v203, v211
  v_fmac_f32 v117, v204, v207
  v_fmac_f32 v118, v216, v224
  v_fmac_f32 v119, v217, v225
  v_fmac_f32 v116, v218, v226
  v_fmac_f32 v117, v219, v227
  v_fmac_f32 v118, v220, v223
  v_fmac_f32 v119, v232, v240
  v_fmac_f32 v116, v233, v241
  v_fmac_f32 v117, v234, v242
  v_fmac_f32 v118, v235, v243
  v_fmac_f32 v119, v236, v239
  v_fmac_f32 v116, v189, v196
  v_fmac_f32 v117, v189, v197
  v_fmac_f32 v118, v190, v198
  v_fmac_f32 v119, v190, v199
  v_fmac_f32 v116, v205, v212
  v_fmac_f32 v117, v205, v213
  v_fmac_f32 v118, v206, v214
  v_fmac_f32 v119, v206, v215
  v_fmac_f32 v116, v221, v228
  v_fmac_f32 v117, v221, v229
  v_fmac_f32 v118, v222, v230
  v_fmac_f32 v119, v222, v231
  v_fmac_f32 v116, v237, v244
  v_fmac_f32 v117, v237, v245
  v_fmac_f32 v118, v238, v246
  v_fmac_f32 v119, v238, v247
  v_add_f32 v116, v116, v117
  v_add_f32 v118, v118, v119
  v_add_f32 v116, v116, v118
  v_mul_f32 v116, s74, v116
  v_mul_f32 v116, s75, v116
  ds_write_b32 v7, v116
  s_mul_i32 s98, s3, 1536
  s_add_u32 s98, s98, 116736
  v_lshlrev_b32 v116, 5, v0
  v_add_u32 v116, s98, v116
  ds_read_b128 v[60:63], v116
  ds_read_b128 v[64:67], v116 offset:16
  v_lshrrev_b32 v117, 3, v0
  v_cmp_gt_u32 vcc, 6, v117
  v_lshlrev_b32 v117, 4, v117
  v_add_u32 v117, s85, v117
  s_waitcnt lgkmcnt(1)
  v_pk_add_f32 v[60:61], v[60:61], v[62:63]
  s_waitcnt lgkmcnt(0)
  v_pk_add_f32 v[64:65], v[64:65], v[66:67]
  v_pk_add_f32 v[60:61], v[60:61], v[64:65]
  v_add_f32 v60, v60, v61
  s_nop 1
  v_add_f32_dpp v60, v60, v60 quad_perm:[1,0,3,2] row_mask:0xf bank_mask:0xf
  s_nop 1
  v_add_f32_dpp v60, v60, v60 quad_perm:[2,3,0,1] row_mask:0xf bank_mask:0xf
  s_nop 1
  v_add_f32_dpp v60, v60, v60 row_half_mirror row_mask:0xf bank_mask:0xf
  s_and_b64 exec, exec, vcc
  ds_write_b32 v117, v60
  s_mov_b64 exec, -1
  s_waitcnt lgkmcnt(0)
  s_barrier
  s_cmp_lg_u32 s3, 4
  s_cbranch_scc1 L_end
  v_lshlrev_b32_e64 v4, 2, v0
  v_add_u32 v2, 129728, v4
  ds_read_b32 v64, v2
  s_mul_i32 s69, s26, 192
  s_add_u32 s69, s69, 216320
  s_mul_i32 s68, s26, 3
  s_mul_i32 s70, s68, 3277
  s_lshr_b32 s70, s70, 16
  v_add_u32 v7, s70, v0
  s_mul_i32 s70, s70, 20
  s_add_u32 s70, s70, 20
  s_sub_u32 s70, s70, s68
  s_min_u32 s70, s70, 3
  s_sub_u32 s68, 3, s70
  v_mov_b32 v5, s68
  v_writelane_b32 v5, s70, 0
  s_cmp_eq_u32 s68, 0
  s_cselect_b32 s68, 1, 3
  v_lshlrev_b32 v3, 4, v0
  s_mov_b32 exec_hi, 0xffff
  s_waitcnt lgkmcnt(0)
  buffer_store_dword v64, v4, s[60:63], s69 offen sc1
  s_mov_b32 exec_hi, -1
  v_add_u32 v4, 1024, v4
  s_mov_b32 exec_lo, s68
  s_mov_b32 exec_hi, 0
  s_branch L_pub
L_dnn_loop1:
  s_barrier
L_ld_in:
  s_add_u32 m0, s75, 122880
  v_add_u32_dpp v56, v19, v2 row_newbcast:0 row_mask:0xf bank_mask:0x3
  buffer_load_dwordx4 v4, s[44:47], s74 offen lds
  s_add_u32 m0, s75, 123904
  v_add_u32_dpp v57, v23, v3 row_newbcast:0 row_mask:0xf bank_mask:0x3
  buffer_load_dwordx4 v5, s[44:47], s74 offen lds
  s_add_u32 s74, s74, 106496
  s_add_u32 m0, s41, 81920
  v_add_u32_dpp v58, v27, v2 row_newbcast:0 row_mask:0xf bank_mask:0x3
  buffer_load_dwordx4 v61, s[32:35], 0 offen lds
  s_add_u32 m0, s42, 81920
  v_add_u32_dpp v59, v31, v3 row_newbcast:0 row_mask:0xf bank_mask:0x3
  buffer_load_dwordx4 v62, s[32:35], 0 offen lds
  s_add_u32 m0, s43, 81920
  v_add_u32_dpp v60, v35, v2 row_newbcast:0 row_mask:0xf bank_mask:0x3
  buffer_load_dwordx4 v63, s[32:35], 0 offen lds
  s_add_u32 m0, s48, 81920
  v_add_u32_dpp v56, v17, v2 row_newbcast:7 row_mask:0xf bank_mask:0xc
  buffer_load_dwordx4 v64, s[32:35], 0 offen lds
  s_add_u32 m0, s49, 81920
  v_add_u32_dpp v57, v21, v3 row_newbcast:7 row_mask:0xf bank_mask:0xc
  buffer_load_dwordx4 v65, s[32:35], 0 offen lds
  v_add_u32_dpp v58, v25, v2 row_newbcast:7 row_mask:0xf bank_mask:0xc
  v_add_u32_dpp v59, v29, v3 row_newbcast:7 row_mask:0xf bank_mask:0xc
  v_add_u32_dpp v60, v33, v2 row_newbcast:7 row_mask:0xf bank_mask:0xc
  s_waitcnt vmcnt(12)
  s_barrier
  s_add_u32 m0, s75, 131072
  v_add_u32_dpp v61, v39, v3 row_newbcast:0 row_mask:0xf bank_mask:0x3
  buffer_load_dwordx4 v4, s[44:47], s74 offen lds
  s_add_u32 m0, s75, 132096
  v_add_u32_dpp v62, v43, v2 row_newbcast:0 row_mask:0xf bank_mask:0x3
  buffer_load_dwordx4 v5, s[44:47], s74 offen lds
  s_add_u32 s74, s74, 106496
  s_add_u32 m0, s36, 0
  v_add_u32_dpp v63, v47, v3 row_newbcast:0 row_mask:0xf bank_mask:0x3
  buffer_load_dwordx4 v56, s[32:35], 0 offen lds
  s_add_u32 m0, s37, 0
  v_add_u32_dpp v64, v51, v2 row_newbcast:0 row_mask:0xf bank_mask:0x3
  buffer_load_dwordx4 v57, s[32:35], 0 offen lds
  s_add_u32 m0, s38, 0
  v_add_u32_dpp v65, v55, v3 row_newbcast:0 row_mask:0xf bank_mask:0x3
  buffer_load_dwordx4 v58, s[32:35], 0 offen lds
  s_add_u32 m0, s39, 0
  v_add_u32_dpp v61, v37, v3 row_newbcast:7 row_mask:0xf bank_mask:0xc
  buffer_load_dwordx4 v59, s[32:35], 0 offen lds
  s_add_u32 m0, s40, 0
  v_add_u32_dpp v62, v41, v2 row_newbcast:7 row_mask:0xf bank_mask:0xc
  buffer_load_dwordx4 v60, s[32:35], 0 offen lds
  v_add_u32_dpp v63, v45, v3 row_newbcast:7 row_mask:0xf bank_mask:0xc
  v_add_u32_dpp v64, v49, v2 row_newbcast:7 row_mask:0xf bank_mask:0xc
  v_add_u32_dpp v65, v53, v3 row_newbcast:7 row_mask:0xf bank_mask:0xc
  s_waitcnt vmcnt(12)
  s_barrier
  s_add_u32 m0, s75, 139264
  v_add_u32_dpp v56, v16, v2 row_newbcast:1 row_mask:0xf bank_mask:0x3
  buffer_load_dwordx4 v4, s[44:47], s74 offen lds
  s_add_u32 m0, s75, 140288
  v_add_u32_dpp v57, v20, v3 row_newbcast:1 row_mask:0xf bank_mask:0x3
  buffer_load_dwordx4 v5, s[44:47], s74 offen lds
  s_add_u32 s74, s74, 106496
  s_add_u32 m0, s41, 0
  v_add_u32_dpp v58, v24, v2 row_newbcast:1 row_mask:0xf bank_mask:0x3
  buffer_load_dwordx4 v61, s[32:35], 0 offen lds
  s_add_u32 m0, s42, 0
  v_add_u32_dpp v59, v28, v3 row_newbcast:1 row_mask:0xf bank_mask:0x3
  buffer_load_dwordx4 v62, s[32:35], 0 offen lds
  s_add_u32 m0, s43, 0
  v_add_u32_dpp v60, v32, v2 row_newbcast:1 row_mask:0xf bank_mask:0x3
  buffer_load_dwordx4 v63, s[32:35], 0 offen lds
  s_add_u32 m0, s48, 0
  v_add_u32_dpp v56, v18, v2 row_newbcast:7 row_mask:0xf bank_mask:0xc
  buffer_load_dwordx4 v64, s[32:35], 0 offen lds
  s_add_u32 m0, s49, 0
  v_add_u32_dpp v57, v22, v3 row_newbcast:7 row_mask:0xf bank_mask:0xc
  buffer_load_dwordx4 v65, s[32:35], 0 offen lds
  v_add_u32_dpp v58, v26, v2 row_newbcast:7 row_mask:0xf bank_mask:0xc
  v_add_u32_dpp v59, v30, v3 row_newbcast:7 row_mask:0xf bank_mask:0xc
  v_add_u32_dpp v60, v34, v2 row_newbcast:7 row_mask:0xf bank_mask:0xc
  s_waitcnt vmcnt(12)
  s_barrier
  s_add_u32 m0, s75, 122880
  v_add_u32_dpp v61, v36, v3 row_newbcast:1 row_mask:0xf bank_mask:0x3
  buffer_load_dwordx4 v4, s[44:47], s74 offen lds
  s_add_u32 m0, s75, 123904
  v_add_u32_dpp v62, v40, v2 row_newbcast:1 row_mask:0xf bank_mask:0x3
  buffer_load_dwordx4 v5, s[44:47], s74 offen lds
  s_add_u32 s74, s74, 106496
  s_add_u32 m0, s36, 40960
  v_add_u32_dpp v63, v44, v3 row_newbcast:1 row_mask:0xf bank_mask:0x3
  buffer_load_dwordx4 v56, s[32:35], 0 offen lds
  s_add_u32 m0, s37, 40960
  v_add_u32_dpp v64, v48, v2 row_newbcast:1 row_mask:0xf bank_mask:0x3
  buffer_load_dwordx4 v57, s[32:35], 0 offen lds
  s_add_u32 m0, s38, 40960
  v_add_u32_dpp v65, v52, v3 row_newbcast:1 row_mask:0xf bank_mask:0x3
  buffer_load_dwordx4 v58, s[32:35], 0 offen lds
  s_add_u32 m0, s39, 40960
  v_add_u32_dpp v61, v38, v3 row_newbcast:7 row_mask:0xf bank_mask:0xc
  buffer_load_dwordx4 v59, s[32:35], 0 offen lds
  s_add_u32 m0, s40, 40960
  v_add_u32_dpp v62, v42, v2 row_newbcast:7 row_mask:0xf bank_mask:0xc
  buffer_load_dwordx4 v60, s[32:35], 0 offen lds
  v_add_u32_dpp v63, v46, v3 row_newbcast:7 row_mask:0xf bank_mask:0xc
  v_add_u32_dpp v64, v50, v2 row_newbcast:7 row_mask:0xf bank_mask:0xc
  v_add_u32_dpp v65, v54, v3 row_newbcast:7 row_mask:0xf bank_mask:0xc
  s_waitcnt vmcnt(12)
  s_barrier
  s_add_u32 m0, s75, 131072
  v_add_u32_dpp v56, v17, v2 row_newbcast:1 row_mask:0xf bank_mask:0x3
  buffer_load_dwordx4 v4, s[44:47], s74 offen lds
  s_add_u32 m0, s75, 132096
  v_add_u32_dpp v57, v21, v3 row_newbcast:1 row_mask:0xf bank_mask:0x3
  buffer_load_dwordx4 v5, s[44:47], s74 offen lds
  s_add_u32 s74, s74, 106496
  s_add_u32 m0, s41, 40960
  v_add_u32_dpp v58, v25, v2 row_newbcast:1 row_mask:0xf bank_mask:0x3
  buffer_load_dwordx4 v61, s[32:35], 0 offen lds
  s_add_u32 m0, s42, 40960
  v_add_u32_dpp v59, v29, v3 row_newbcast:1 row_mask:0xf bank_mask:0x3
  buffer_load_dwordx4 v62, s[32:35], 0 offen lds
  s_add_u32 m0, s43, 40960
  v_add_u32_dpp v60, v33, v2 row_newbcast:1 row_mask:0xf bank_mask:0x3
  buffer_load_dwordx4 v63, s[32:35], 0 offen lds
  s_add_u32 m0, s48, 40960
  v_add_u32_dpp v56, v19, v2 row_newbcast:7 row_mask:0xf bank_mask:0xc
  buffer_load_dwordx4 v64, s[32:35], 0 offen lds
  s_add_u32 m0, s49, 40960
  v_add_u32_dpp v57, v23, v3 row_newbcast:7 row_mask:0xf bank_mask:0xc
  buffer_load_dwordx4 v65, s[32:35], 0 offen lds
  v_add_u32_dpp v58, v27, v2 row_newbcast:7 row_mask:0xf bank_mask:0xc
  v_add_u32_dpp v59, v31, v3 row_newbcast:7 row_mask:0xf bank_mask:0xc
  v_add_u32_dpp v60, v35, v2 row_newbcast:7 row_mask:0xf bank_mask:0xc
  s_waitcnt vmcnt(12)
  s_barrier
  s_add_u32 m0, s75, 139264
  v_add_u32_dpp v61, v37, v3 row_newbcast:1 row_mask:0xf bank_mask:0x3
  buffer_load_dwordx4 v4, s[44:47], s74 offen lds
  s_add_u32 m0, s75, 140288
  v_add_u32_dpp v62, v41, v2 row_newbcast:1 row_mask:0xf bank_mask:0x3
  buffer_load_dwordx4 v5, s[44:47], s74 offen lds
  s_add_u32 s74, s74, 106496
  s_add_u32 m0, s36, 81920
  v_add_u32_dpp v63, v45, v3 row_newbcast:1 row_mask:0xf bank_mask:0x3
  buffer_load_dwordx4 v56, s[32:35], 0 offen lds
  s_add_u32 m0, s37, 81920
  v_add_u32_dpp v64, v49, v2 row_newbcast:1 row_mask:0xf bank_mask:0x3
  buffer_load_dwordx4 v57, s[32:35], 0 offen lds
  s_add_u32 m0, s38, 81920
  v_add_u32_dpp v65, v53, v3 row_newbcast:1 row_mask:0xf bank_mask:0x3
  buffer_load_dwordx4 v58, s[32:35], 0 offen lds
  s_add_u32 m0, s39, 81920
  v_add_u32_dpp v61, v39, v3 row_newbcast:7 row_mask:0xf bank_mask:0xc
  buffer_load_dwordx4 v59, s[32:35], 0 offen lds
  s_add_u32 m0, s40, 81920
  v_add_u32_dpp v62, v43, v2 row_newbcast:7 row_mask:0xf bank_mask:0xc
  buffer_load_dwordx4 v60, s[32:35], 0 offen lds
  v_add_u32_dpp v63, v47, v3 row_newbcast:7 row_mask:0xf bank_mask:0xc
  v_add_u32_dpp v64, v51, v2 row_newbcast:7 row_mask:0xf bank_mask:0xc
  v_add_u32_dpp v65, v55, v3 row_newbcast:7 row_mask:0xf bank_mask:0xc
  s_waitcnt vmcnt(12)
  s_barrier
  s_add_u32 m0, s75, 122880
  v_add_u32_dpp v56, v18, v2 row_newbcast:1 row_mask:0xf bank_mask:0x3
  buffer_load_dwordx4 v4, s[44:47], s74 offen lds
  s_add_u32 m0, s75, 123904
  v_add_u32_dpp v57, v22, v3 row_newbcast:1 row_mask:0xf bank_mask:0x3
  buffer_load_dwordx4 v5, s[44:47], s74 offen lds
  s_add_u32 s74, s74, 106496
  s_add_u32 m0, s41, 81920
  v_add_u32_dpp v58, v26, v2 row_newbcast:1 row_mask:0xf bank_mask:0x3
  buffer_load_dwordx4 v61, s[32:35], 0 offen lds
  s_add_u32 m0, s42, 81920
  v_add_u32_dpp v59, v30, v3 row_newbcast:1 row_mask:0xf bank_mask:0x3
  buffer_load_dwordx4 v62, s[32:35], 0 offen lds
  s_add_u32 m0, s43, 81920
  v_add_u32_dpp v60, v34, v2 row_newbcast:1 row_mask:0xf bank_mask:0x3
  buffer_load_dwordx4 v63, s[32:35], 0 offen lds
  s_add_u32 m0, s48, 81920
  v_add_u32_dpp v56, v16, v2 row_newbcast:8 row_mask:0xf bank_mask:0xc
  buffer_load_dwordx4 v64, s[32:35], 0 offen lds
  s_add_u32 m0, s49, 81920
  v_add_u32_dpp v57, v20, v3 row_newbcast:8 row_mask:0xf bank_mask:0xc
  buffer_load_dwordx4 v65, s[32:35], 0 offen lds
  v_add_u32_dpp v58, v24, v2 row_newbcast:8 row_mask:0xf bank_mask:0xc
  v_add_u32_dpp v59, v28, v3 row_newbcast:8 row_mask:0xf bank_mask:0xc
  v_add_u32_dpp v60, v32, v2 row_newbcast:8 row_mask:0xf bank_mask:0xc
  s_waitcnt vmcnt(12)
  s_barrier
  s_add_u32 m0, s75, 131072
  v_add_u32_dpp v61, v38, v3 row_newbcast:1 row_mask:0xf bank_mask:0x3
  buffer_load_dwordx4 v4, s[44:47], s74 offen lds
  s_add_u32 m0, s75, 132096
  v_add_u32_dpp v62, v42, v2 row_newbcast:1 row_mask:0xf bank_mask:0x3
  buffer_load_dwordx4 v5, s[44:47], s74 offen lds
  s_add_u32 s74, s74, 106496
  s_add_u32 m0, s36, 0
  v_add_u32_dpp v63, v46, v3 row_newbcast:1 row_mask:0xf bank_mask:0x3
  buffer_load_dwordx4 v56, s[32:35], 0 offen lds
  s_add_u32 m0, s37, 0
  v_add_u32_dpp v64, v50, v2 row_newbcast:1 row_mask:0xf bank_mask:0x3
  buffer_load_dwordx4 v57, s[32:35], 0 offen lds
  s_add_u32 m0, s38, 0
  v_add_u32_dpp v65, v54, v3 row_newbcast:1 row_mask:0xf bank_mask:0x3
  buffer_load_dwordx4 v58, s[32:35], 0 offen lds
  s_add_u32 m0, s39, 0
  v_add_u32_dpp v61, v36, v3 row_newbcast:8 row_mask:0xf bank_mask:0xc
  buffer_load_dwordx4 v59, s[32:35], 0 offen lds
  s_add_u32 m0, s40, 0
  v_add_u32_dpp v62, v40, v2 row_newbcast:8 row_mask:0xf bank_mask:0xc
  buffer_load_dwordx4 v60, s[32:35], 0 offen lds
  v_add_u32_dpp v63, v44, v3 row_newbcast:8 row_mask:0xf bank_mask:0xc
  v_add_u32_dpp v64, v48, v2 row_newbcast:8 row_mask:0xf bank_mask:0xc
  v_add_u32_dpp v65, v52, v3 row_newbcast:8 row_mask:0xf bank_mask:0xc
  s_waitcnt vmcnt(12)
  s_barrier
  s_add_u32 m0, s75, 139264
  v_add_u32_dpp v56, v19, v2 row_newbcast:1 row_mask:0xf bank_mask:0x3
  buffer_load_dwordx4 v4, s[44:47], s74 offen lds
  s_add_u32 m0, s75, 140288
  v_add_u32_dpp v57, v23, v3 row_newbcast:1 row_mask:0xf bank_mask:0x3
  buffer_load_dwordx4 v5, s[44:47], s74 offen lds
  s_add_u32 s74, s74, 106496
  s_add_u32 m0, s41, 0
  v_add_u32_dpp v58, v27, v2 row_newbcast:1 row_mask:0xf bank_mask:0x3
  buffer_load_dwordx4 v61, s[32:35], 0 offen lds
  s_add_u32 m0, s42, 0
  v_add_u32_dpp v59, v31, v3 row_newbcast:1 row_mask:0xf bank_mask:0x3
  buffer_load_dwordx4 v62, s[32:35], 0 offen lds
  s_add_u32 m0, s43, 0
  v_add_u32_dpp v60, v35, v2 row_newbcast:1 row_mask:0xf bank_mask:0x3
  buffer_load_dwordx4 v63, s[32:35], 0 offen lds
  s_add_u32 m0, s48, 0
  v_add_u32_dpp v56, v17, v2 row_newbcast:8 row_mask:0xf bank_mask:0xc
  buffer_load_dwordx4 v64, s[32:35], 0 offen lds
  s_add_u32 m0, s49, 0
  v_add_u32_dpp v57, v21, v3 row_newbcast:8 row_mask:0xf bank_mask:0xc
  buffer_load_dwordx4 v65, s[32:35], 0 offen lds
  v_add_u32_dpp v58, v25, v2 row_newbcast:8 row_mask:0xf bank_mask:0xc
  v_add_u32_dpp v59, v29, v3 row_newbcast:8 row_mask:0xf bank_mask:0xc
  v_add_u32_dpp v60, v33, v2 row_newbcast:8 row_mask:0xf bank_mask:0xc
  s_waitcnt vmcnt(12)
  s_barrier
  s_add_u32 m0, s75, 122880
  v_add_u32_dpp v61, v39, v3 row_newbcast:1 row_mask:0xf bank_mask:0x3
  buffer_load_dwordx4 v4, s[44:47], s74 offen lds
  s_add_u32 m0, s75, 123904
  v_add_u32_dpp v62, v43, v2 row_newbcast:1 row_mask:0xf bank_mask:0x3
  buffer_load_dwordx4 v5, s[44:47], s74 offen lds
  s_add_u32 s74, s74, 106496
  s_add_u32 m0, s36, 40960
  v_add_u32_dpp v63, v47, v3 row_newbcast:1 row_mask:0xf bank_mask:0x3
  buffer_load_dwordx4 v56, s[32:35], 0 offen lds
  s_add_u32 m0, s37, 40960
  v_add_u32_dpp v64, v51, v2 row_newbcast:1 row_mask:0xf bank_mask:0x3
  buffer_load_dwordx4 v57, s[32:35], 0 offen lds
  s_add_u32 m0, s38, 40960
  v_add_u32_dpp v65, v55, v3 row_newbcast:1 row_mask:0xf bank_mask:0x3
  buffer_load_dwordx4 v58, s[32:35], 0 offen lds
  s_add_u32 m0, s39, 40960
  v_add_u32_dpp v61, v37, v3 row_newbcast:8 row_mask:0xf bank_mask:0xc
  buffer_load_dwordx4 v59, s[32:35], 0 offen lds
  s_add_u32 m0, s40, 40960
  v_add_u32_dpp v62, v41, v2 row_newbcast:8 row_mask:0xf bank_mask:0xc
  buffer_load_dwordx4 v60, s[32:35], 0 offen lds
  v_add_u32_dpp v63, v45, v3 row_newbcast:8 row_mask:0xf bank_mask:0xc
  v_add_u32_dpp v64, v49, v2 row_newbcast:8 row_mask:0xf bank_mask:0xc
  v_add_u32_dpp v65, v53, v3 row_newbcast:8 row_mask:0xf bank_mask:0xc
  s_waitcnt vmcnt(12)
  s_barrier
  s_add_u32 m0, s75, 131072
  v_add_u32_dpp v56, v16, v2 row_newbcast:2 row_mask:0xf bank_mask:0x3
  buffer_load_dwordx4 v4, s[44:47], s74 offen lds
  s_add_u32 m0, s75, 132096
  v_add_u32_dpp v57, v20, v3 row_newbcast:2 row_mask:0xf bank_mask:0x3
  buffer_load_dwordx4 v5, s[44:47], s74 offen lds
  s_add_u32 s74, s74, 106496
  s_add_u32 m0, s41, 40960
  v_add_u32_dpp v58, v24, v2 row_newbcast:2 row_mask:0xf bank_mask:0x3
  buffer_load_dwordx4 v61, s[32:35], 0 offen lds
  s_add_u32 m0, s42, 40960
  v_add_u32_dpp v59, v28, v3 row_newbcast:2 row_mask:0xf bank_mask:0x3
  buffer_load_dwordx4 v62, s[32:35], 0 offen lds
  s_add_u32 m0, s43, 40960
  v_add_u32_dpp v60, v32, v2 row_newbcast:2 row_mask:0xf bank_mask:0x3
  buffer_load_dwordx4 v63, s[32:35], 0 offen lds
  s_add_u32 m0, s48, 40960
  v_add_u32_dpp v56, v18, v2 row_newbcast:8 row_mask:0xf bank_mask:0xc
  buffer_load_dwordx4 v64, s[32:35], 0 offen lds
  s_add_u32 m0, s49, 40960
  v_add_u32_dpp v57, v22, v3 row_newbcast:8 row_mask:0xf bank_mask:0xc
  buffer_load_dwordx4 v65, s[32:35], 0 offen lds
  v_add_u32_dpp v58, v26, v2 row_newbcast:8 row_mask:0xf bank_mask:0xc
  v_add_u32_dpp v59, v30, v3 row_newbcast:8 row_mask:0xf bank_mask:0xc
  v_add_u32_dpp v60, v34, v2 row_newbcast:8 row_mask:0xf bank_mask:0xc
  s_waitcnt vmcnt(12)
  s_barrier
  s_add_u32 m0, s75, 139264
  v_add_u32_dpp v61, v36, v3 row_newbcast:2 row_mask:0xf bank_mask:0x3
  buffer_load_dwordx4 v4, s[44:47], s74 offen lds
  s_add_u32 m0, s75, 140288
  v_add_u32_dpp v62, v40, v2 row_newbcast:2 row_mask:0xf bank_mask:0x3
  buffer_load_dwordx4 v5, s[44:47], s74 offen lds
  s_add_u32 s74, s74, 106496
  s_add_u32 m0, s36, 81920
  v_add_u32_dpp v63, v44, v3 row_newbcast:2 row_mask:0xf bank_mask:0x3
  buffer_load_dwordx4 v56, s[32:35], 0 offen lds
  s_add_u32 m0, s37, 81920
  v_add_u32_dpp v64, v48, v2 row_newbcast:2 row_mask:0xf bank_mask:0x3
  buffer_load_dwordx4 v57, s[32:35], 0 offen lds
  s_add_u32 m0, s38, 81920
  v_add_u32_dpp v65, v52, v3 row_newbcast:2 row_mask:0xf bank_mask:0x3
  buffer_load_dwordx4 v58, s[32:35], 0 offen lds
  s_add_u32 m0, s39, 81920
  v_add_u32_dpp v61, v38, v3 row_newbcast:8 row_mask:0xf bank_mask:0xc
  buffer_load_dwordx4 v59, s[32:35], 0 offen lds
  s_add_u32 m0, s40, 81920
  v_add_u32_dpp v62, v42, v2 row_newbcast:8 row_mask:0xf bank_mask:0xc
  buffer_load_dwordx4 v60, s[32:35], 0 offen lds
  v_add_u32_dpp v63, v46, v3 row_newbcast:8 row_mask:0xf bank_mask:0xc
  v_add_u32_dpp v64, v50, v2 row_newbcast:8 row_mask:0xf bank_mask:0xc
  v_add_u32_dpp v65, v54, v3 row_newbcast:8 row_mask:0xf bank_mask:0xc
  s_waitcnt vmcnt(12)
  s_barrier
  s_add_u32 m0, s75, 122880
  v_add_u32_dpp v56, v17, v2 row_newbcast:2 row_mask:0xf bank_mask:0x3
  buffer_load_dwordx4 v4, s[44:47], s74 offen lds
  s_add_u32 m0, s75, 123904
  v_add_u32_dpp v57, v21, v3 row_newbcast:2 row_mask:0xf bank_mask:0x3
  buffer_load_dwordx4 v5, s[44:47], s74 offen lds
  s_add_u32 s74, s74, 106496
  s_add_u32 m0, s41, 81920
  v_add_u32_dpp v58, v25, v2 row_newbcast:2 row_mask:0xf bank_mask:0x3
  buffer_load_dwordx4 v61, s[32:35], 0 offen lds
  s_add_u32 m0, s42, 81920
  v_add_u32_dpp v59, v29, v3 row_newbcast:2 row_mask:0xf bank_mask:0x3
  buffer_load_dwordx4 v62, s[32:35], 0 offen lds
  s_add_u32 m0, s43, 81920
  v_add_u32_dpp v60, v33, v2 row_newbcast:2 row_mask:0xf bank_mask:0x3
  buffer_load_dwordx4 v63, s[32:35], 0 offen lds
  s_add_u32 m0, s48, 81920
  v_add_u32_dpp v56, v19, v2 row_newbcast:8 row_mask:0xf bank_mask:0xc
  buffer_load_dwordx4 v64, s[32:35], 0 offen lds
  s_add_u32 m0, s49, 81920
  v_add_u32_dpp v57, v23, v3 row_newbcast:8 row_mask:0xf bank_mask:0xc
  buffer_load_dwordx4 v65, s[32:35], 0 offen lds
  v_add_u32_dpp v58, v27, v2 row_newbcast:8 row_mask:0xf bank_mask:0xc
  v_add_u32_dpp v59, v31, v3 row_newbcast:8 row_mask:0xf bank_mask:0xc
  v_add_u32_dpp v60, v35, v2 row_newbcast:8 row_mask:0xf bank_mask:0xc
  s_waitcnt vmcnt(12)
  s_barrier
  s_add_u32 m0, s75, 131072
  v_add_u32_dpp v61, v37, v3 row_newbcast:2 row_mask:0xf bank_mask:0x3
  buffer_load_dwordx4 v4, s[44:47], s74 offen lds
  s_add_u32 m0, s75, 132096
  v_add_u32_dpp v62, v41, v2 row_newbcast:2 row_mask:0xf bank_mask:0x3
  buffer_load_dwordx4 v5, s[44:47], s74 offen lds
  s_add_u32 s74, s74, 106496
  s_add_u32 m0, s36, 0
  v_add_u32_dpp v63, v45, v3 row_newbcast:2 row_mask:0xf bank_mask:0x3
  buffer_load_dwordx4 v56, s[32:35], 0 offen lds
  s_add_u32 m0, s37, 0
  v_add_u32_dpp v64, v49, v2 row_newbcast:2 row_mask:0xf bank_mask:0x3
  buffer_load_dwordx4 v57, s[32:35], 0 offen lds
  s_add_u32 m0, s38, 0
  v_add_u32_dpp v65, v53, v3 row_newbcast:2 row_mask:0xf bank_mask:0x3
  buffer_load_dwordx4 v58, s[32:35], 0 offen lds
  s_add_u32 m0, s39, 0
  v_add_u32_dpp v61, v39, v3 row_newbcast:8 row_mask:0xf bank_mask:0xc
  buffer_load_dwordx4 v59, s[32:35], 0 offen lds
  s_add_u32 m0, s40, 0
  v_add_u32_dpp v62, v43, v2 row_newbcast:8 row_mask:0xf bank_mask:0xc
  buffer_load_dwordx4 v60, s[32:35], 0 offen lds
  v_add_u32_dpp v63, v47, v3 row_newbcast:8 row_mask:0xf bank_mask:0xc
  v_add_u32_dpp v64, v51, v2 row_newbcast:8 row_mask:0xf bank_mask:0xc
  v_add_u32_dpp v65, v55, v3 row_newbcast:8 row_mask:0xf bank_mask:0xc
  s_waitcnt vmcnt(12)
  s_barrier
  s_add_u32 m0, s75, 139264
  v_add_u32_dpp v56, v18, v2 row_newbcast:2 row_mask:0xf bank_mask:0x3
  buffer_load_dwordx4 v4, s[44:47], s74 offen lds
  s_add_u32 m0, s75, 140288
  v_add_u32_dpp v57, v22, v3 row_newbcast:2 row_mask:0xf bank_mask:0x3
  buffer_load_dwordx4 v5, s[44:47], s74 offen lds
  s_add_u32 s74, s74, 106496
  s_add_u32 m0, s41, 0
  v_add_u32_dpp v58, v26, v2 row_newbcast:2 row_mask:0xf bank_mask:0x3
  buffer_load_dwordx4 v61, s[32:35], 0 offen lds
  s_add_u32 m0, s42, 0
  v_add_u32_dpp v59, v30, v3 row_newbcast:2 row_mask:0xf bank_mask:0x3
  buffer_load_dwordx4 v62, s[32:35], 0 offen lds
  s_add_u32 m0, s43, 0
  v_add_u32_dpp v60, v34, v2 row_newbcast:2 row_mask:0xf bank_mask:0x3
  buffer_load_dwordx4 v63, s[32:35], 0 offen lds
  s_add_u32 m0, s48, 0
  v_add_u32_dpp v56, v16, v2 row_newbcast:9 row_mask:0xf bank_mask:0xc
  buffer_load_dwordx4 v64, s[32:35], 0 offen lds
  s_add_u32 m0, s49, 0
  v_add_u32_dpp v57, v20, v3 row_newbcast:9 row_mask:0xf bank_mask:0xc
  buffer_load_dwordx4 v65, s[32:35], 0 offen lds
  v_add_u32_dpp v58, v24, v2 row_newbcast:9 row_mask:0xf bank_mask:0xc
  v_add_u32_dpp v59, v28, v3 row_newbcast:9 row_mask:0xf bank_mask:0xc
  v_add_u32_dpp v60, v32, v2 row_newbcast:9 row_mask:0xf bank_mask:0xc
  s_waitcnt vmcnt(12)
  s_cmp_lg_u32 s72, 1
  s_cbranch_scc1 L_nolpf
  s_mov_b64 exec, 1048575
  global_load_dword v10, v[8:9], off
  s_mov_b64 exec, -1
L_nolpf:
  s_barrier
  s_add_u32 m0, s75, 122880
  v_add_u32_dpp v61, v38, v3 row_newbcast:2 row_mask:0xf bank_mask:0x3
  buffer_load_dwordx4 v4, s[44:47], s74 offen lds
  s_add_u32 m0, s75, 123904
  v_add_u32_dpp v62, v42, v2 row_newbcast:2 row_mask:0xf bank_mask:0x3
  buffer_load_dwordx4 v5, s[44:47], s74 offen lds
  s_add_u32 s74, s74, 106496
  s_add_u32 m0, s36, 40960
  v_add_u32_dpp v63, v46, v3 row_newbcast:2 row_mask:0xf bank_mask:0x3
  buffer_load_dwordx4 v56, s[32:35], 0 offen lds
  s_add_u32 m0, s37, 40960
  v_add_u32_dpp v64, v50, v2 row_newbcast:2 row_mask:0xf bank_mask:0x3
  buffer_load_dwordx4 v57, s[32:35], 0 offen lds
  s_add_u32 m0, s38, 40960
  v_add_u32_dpp v65, v54, v3 row_newbcast:2 row_mask:0xf bank_mask:0x3
  buffer_load_dwordx4 v58, s[32:35], 0 offen lds
  s_add_u32 m0, s39, 40960
  v_add_u32_dpp v61, v36, v3 row_newbcast:9 row_mask:0xf bank_mask:0xc
  buffer_load_dwordx4 v59, s[32:35], 0 offen lds
  s_add_u32 m0, s40, 40960
  v_add_u32_dpp v62, v40, v2 row_newbcast:9 row_mask:0xf bank_mask:0xc
  buffer_load_dwordx4 v60, s[32:35], 0 offen lds
  v_add_u32_dpp v63, v44, v3 row_newbcast:9 row_mask:0xf bank_mask:0xc
  v_add_u32_dpp v64, v48, v2 row_newbcast:9 row_mask:0xf bank_mask:0xc
  v_add_u32_dpp v65, v52, v3 row_newbcast:9 row_mask:0xf bank_mask:0xc
  s_waitcnt vmcnt(12)
  s_barrier
  s_add_u32 m0, s75, 131072
  v_add_u32_dpp v56, v19, v2 row_newbcast:2 row_mask:0xf bank_mask:0x3
  buffer_load_dwordx4 v4, s[44:47], s74 offen lds
  s_add_u32 m0, s75, 132096
  v_add_u32_dpp v57, v23, v3 row_newbcast:2 row_mask:0xf bank_mask:0x3
  buffer_load_dwordx4 v5, s[44:47], s74 offen lds
  s_add_u32 s74, s74, 106496
  s_add_u32 m0, s41, 40960
  v_add_u32_dpp v58, v27, v2 row_newbcast:2 row_mask:0xf bank_mask:0x3
  buffer_load_dwordx4 v61, s[32:35], 0 offen lds
  s_add_u32 m0, s42, 40960
  v_add_u32_dpp v59, v31, v3 row_newbcast:2 row_mask:0xf bank_mask:0x3
  buffer_load_dwordx4 v62, s[32:35], 0 offen lds
  s_add_u32 m0, s43, 40960
  v_add_u32_dpp v60, v35, v2 row_newbcast:2 row_mask:0xf bank_mask:0x3
  buffer_load_dwordx4 v63, s[32:35], 0 offen lds
  s_add_u32 m0, s48, 40960
  v_add_u32_dpp v56, v17, v2 row_newbcast:9 row_mask:0xf bank_mask:0xc
  buffer_load_dwordx4 v64, s[32:35], 0 offen lds
  s_add_u32 m0, s49, 40960
  v_add_u32_dpp v57, v21, v3 row_newbcast:9 row_mask:0xf bank_mask:0xc
  buffer_load_dwordx4 v65, s[32:35], 0 offen lds
  v_add_u32_dpp v58, v25, v2 row_newbcast:9 row_mask:0xf bank_mask:0xc
  v_add_u32_dpp v59, v29, v3 row_newbcast:9 row_mask:0xf bank_mask:0xc
  v_add_u32_dpp v60, v33, v2 row_newbcast:9 row_mask:0xf bank_mask:0xc
  s_waitcnt vmcnt(12)
  s_barrier
  s_add_u32 m0, s75, 139264
  v_add_u32_dpp v61, v39, v3 row_newbcast:2 row_mask:0xf bank_mask:0x3
  buffer_load_dwordx4 v4, s[44:47], s74 offen lds
  s_add_u32 m0, s75, 140288
  v_add_u32_dpp v62, v43, v2 row_newbcast:2 row_mask:0xf bank_mask:0x3
  buffer_load_dwordx4 v5, s[44:47], s74 offen lds
  s_add_u32 s74, s74, 106496
  s_add_u32 m0, s36, 81920
  v_add_u32_dpp v63, v47, v3 row_newbcast:2 row_mask:0xf bank_mask:0x3
  buffer_load_dwordx4 v56, s[32:35], 0 offen lds
  s_add_u32 m0, s37, 81920
  v_add_u32_dpp v64, v51, v2 row_newbcast:2 row_mask:0xf bank_mask:0x3
  buffer_load_dwordx4 v57, s[32:35], 0 offen lds
  s_add_u32 m0, s38, 81920
  v_add_u32_dpp v65, v55, v3 row_newbcast:2 row_mask:0xf bank_mask:0x3
  buffer_load_dwordx4 v58, s[32:35], 0 offen lds
  s_add_u32 m0, s39, 81920
  v_add_u32_dpp v61, v37, v3 row_newbcast:9 row_mask:0xf bank_mask:0xc
  buffer_load_dwordx4 v59, s[32:35], 0 offen lds
  s_add_u32 m0, s40, 81920
  v_add_u32_dpp v62, v41, v2 row_newbcast:9 row_mask:0xf bank_mask:0xc
  buffer_load_dwordx4 v60, s[32:35], 0 offen lds
  v_add_u32_dpp v63, v45, v3 row_newbcast:9 row_mask:0xf bank_mask:0xc
  v_add_u32_dpp v64, v49, v2 row_newbcast:9 row_mask:0xf bank_mask:0xc
  v_add_u32_dpp v65, v53, v3 row_newbcast:9 row_mask:0xf bank_mask:0xc
  s_waitcnt vmcnt(12)
  s_barrier
  s_add_u32 m0, s75, 122880
  v_add_u32_dpp v56, v16, v2 row_newbcast:3 row_mask:0xf bank_mask:0x3
  buffer_load_dwordx4 v4, s[44:47], s74 offen lds
  s_add_u32 m0, s75, 123904
  v_add_u32_dpp v57, v20, v3 row_newbcast:3 row_mask:0xf bank_mask:0x3
  buffer_load_dwordx4 v5, s[44:47], s74 offen lds
  s_add_u32 s74, s74, 106496
  s_add_u32 m0, s41, 81920
  v_add_u32_dpp v58, v24, v2 row_newbcast:3 row_mask:0xf bank_mask:0x3
  buffer_load_dwordx4 v61, s[32:35], 0 offen lds
  s_add_u32 m0, s42, 81920
  v_add_u32_dpp v59, v28, v3 row_newbcast:3 row_mask:0xf bank_mask:0x3
  buffer_load_dwordx4 v62, s[32:35], 0 offen lds
  s_add_u32 m0, s43, 81920
  v_add_u32_dpp v60, v32, v2 row_newbcast:3 row_mask:0xf bank_mask:0x3
  buffer_load_dwordx4 v63, s[32:35], 0 offen lds
  s_add_u32 m0, s48, 81920
  v_add_u32_dpp v56, v18, v2 row_newbcast:9 row_mask:0xf bank_mask:0xc
  buffer_load_dwordx4 v64, s[32:35], 0 offen lds
  s_add_u32 m0, s49, 81920
  v_add_u32_dpp v57, v22, v3 row_newbcast:9 row_mask:0xf bank_mask:0xc
  buffer_load_dwordx4 v65, s[32:35], 0 offen lds
  v_add_u32_dpp v58, v26, v2 row_newbcast:9 row_mask:0xf bank_mask:0xc
  v_add_u32_dpp v59, v30, v3 row_newbcast:9 row_mask:0xf bank_mask:0xc
  v_add_u32_dpp v60, v34, v2 row_newbcast:9 row_mask:0xf bank_mask:0xc
  s_waitcnt vmcnt(12)
  s_barrier
  s_add_u32 m0, s75, 131072
  v_add_u32_dpp v61, v36, v3 row_newbcast:3 row_mask:0xf bank_mask:0x3
  buffer_load_dwordx4 v4, s[44:47], s74 offen lds
  s_add_u32 m0, s75, 132096
  v_add_u32_dpp v62, v40, v2 row_newbcast:3 row_mask:0xf bank_mask:0x3
  buffer_load_dwordx4 v5, s[44:47], s74 offen lds
  s_add_u32 s74, s74, 106496
  s_add_u32 m0, s36, 0
  v_add_u32_dpp v63, v44, v3 row_newbcast:3 row_mask:0xf bank_mask:0x3
  buffer_load_dwordx4 v56, s[32:35], 0 offen lds
  s_add_u32 m0, s37, 0
  v_add_u32_dpp v64, v48, v2 row_newbcast:3 row_mask:0xf bank_mask:0x3
  buffer_load_dwordx4 v57, s[32:35], 0 offen lds
  s_add_u32 m0, s38, 0
  v_add_u32_dpp v65, v52, v3 row_newbcast:3 row_mask:0xf bank_mask:0x3
  buffer_load_dwordx4 v58, s[32:35], 0 offen lds
  s_add_u32 m0, s39, 0
  v_add_u32_dpp v61, v38, v3 row_newbcast:9 row_mask:0xf bank_mask:0xc
  buffer_load_dwordx4 v59, s[32:35], 0 offen lds
  s_add_u32 m0, s40, 0
  v_add_u32_dpp v62, v42, v2 row_newbcast:9 row_mask:0xf bank_mask:0xc
  buffer_load_dwordx4 v60, s[32:35], 0 offen lds
  v_add_u32_dpp v63, v46, v3 row_newbcast:9 row_mask:0xf bank_mask:0xc
  v_add_u32_dpp v64, v50, v2 row_newbcast:9 row_mask:0xf bank_mask:0xc
  v_add_u32_dpp v65, v54, v3 row_newbcast:9 row_mask:0xf bank_mask:0xc
  s_waitcnt vmcnt(12)
  s_barrier
  s_add_u32 m0, s75, 139264
  v_add_u32_dpp v56, v17, v2 row_newbcast:3 row_mask:0xf bank_mask:0x3
  buffer_load_dwordx4 v4, s[44:47], s74 offen lds
  s_add_u32 m0, s75, 140288
  v_add_u32_dpp v57, v21, v3 row_newbcast:3 row_mask:0xf bank_mask:0x3
  buffer_load_dwordx4 v5, s[44:47], s74 offen lds
  s_add_u32 s74, s74, 106496
  s_add_u32 m0, s41, 0
  v_add_u32_dpp v58, v25, v2 row_newbcast:3 row_mask:0xf bank_mask:0x3
  buffer_load_dwordx4 v61, s[32:35], 0 offen lds
  s_add_u32 m0, s42, 0
  v_add_u32_dpp v59, v29, v3 row_newbcast:3 row_mask:0xf bank_mask:0x3
  buffer_load_dwordx4 v62, s[32:35], 0 offen lds
  s_add_u32 m0, s43, 0
  v_add_u32_dpp v60, v33, v2 row_newbcast:3 row_mask:0xf bank_mask:0x3
  buffer_load_dwordx4 v63, s[32:35], 0 offen lds
  s_add_u32 m0, s48, 0
  v_add_u32_dpp v56, v19, v2 row_newbcast:9 row_mask:0xf bank_mask:0xc
  buffer_load_dwordx4 v64, s[32:35], 0 offen lds
  s_add_u32 m0, s49, 0
  v_add_u32_dpp v57, v23, v3 row_newbcast:9 row_mask:0xf bank_mask:0xc
  buffer_load_dwordx4 v65, s[32:35], 0 offen lds
  v_add_u32_dpp v58, v27, v2 row_newbcast:9 row_mask:0xf bank_mask:0xc
  v_add_u32_dpp v59, v31, v3 row_newbcast:9 row_mask:0xf bank_mask:0xc
  v_add_u32_dpp v60, v35, v2 row_newbcast:9 row_mask:0xf bank_mask:0xc
  s_waitcnt vmcnt(12)
  s_barrier
  s_add_u32 m0, s75, 122880
  v_add_u32_dpp v61, v37, v3 row_newbcast:3 row_mask:0xf bank_mask:0x3
  buffer_load_dwordx4 v4, s[44:47], s74 offen lds
  s_add_u32 m0, s75, 123904
  v_add_u32_dpp v62, v41, v2 row_newbcast:3 row_mask:0xf bank_mask:0x3
  buffer_load_dwordx4 v5, s[44:47], s74 offen lds
  s_add_u32 s74, s74, 106496
  s_add_u32 m0, s36, 40960
  v_add_u32_dpp v63, v45, v3 row_newbcast:3 row_mask:0xf bank_mask:0x3
  buffer_load_dwordx4 v56, s[32:35], 0 offen lds
  s_add_u32 m0, s37, 40960
  v_add_u32_dpp v64, v49, v2 row_newbcast:3 row_mask:0xf bank_mask:0x3
  buffer_load_dwordx4 v57, s[32:35], 0 offen lds
  s_add_u32 m0, s38, 40960
  v_add_u32_dpp v65, v53, v3 row_newbcast:3 row_mask:0xf bank_mask:0x3
  buffer_load_dwordx4 v58, s[32:35], 0 offen lds
  s_add_u32 m0, s39, 40960
  v_add_u32_dpp v61, v39, v3 row_newbcast:9 row_mask:0xf bank_mask:0xc
  buffer_load_dwordx4 v59, s[32:35], 0 offen lds
  s_add_u32 m0, s40, 40960
  v_add_u32_dpp v62, v43, v2 row_newbcast:9 row_mask:0xf bank_mask:0xc
  buffer_load_dwordx4 v60, s[32:35], 0 offen lds
  v_add_u32_dpp v63, v47, v3 row_newbcast:9 row_mask:0xf bank_mask:0xc
  v_add_u32_dpp v64, v51, v2 row_newbcast:9 row_mask:0xf bank_mask:0xc
  v_add_u32_dpp v65, v55, v3 row_newbcast:9 row_mask:0xf bank_mask:0xc
  s_waitcnt vmcnt(12)
  s_barrier
  s_add_u32 m0, s75, 131072
  v_add_u32_dpp v56, v18, v2 row_newbcast:3 row_mask:0xf bank_mask:0x3
  buffer_load_dwordx4 v4, s[44:47], s74 offen lds
  s_add_u32 m0, s75, 132096
  v_add_u32_dpp v57, v22, v3 row_newbcast:3 row_mask:0xf bank_mask:0x3
  buffer_load_dwordx4 v5, s[44:47], s74 offen lds
  s_add_u32 s74, s74, 106496
  s_add_u32 m0, s41, 40960
  v_add_u32_dpp v58, v26, v2 row_newbcast:3 row_mask:0xf bank_mask:0x3
  buffer_load_dwordx4 v61, s[32:35], 0 offen lds
  s_add_u32 m0, s42, 40960
  v_add_u32_dpp v59, v30, v3 row_newbcast:3 row_mask:0xf bank_mask:0x3
  buffer_load_dwordx4 v62, s[32:35], 0 offen lds
  s_add_u32 m0, s43, 40960
  v_add_u32_dpp v60, v34, v2 row_newbcast:3 row_mask:0xf bank_mask:0x3
  buffer_load_dwordx4 v63, s[32:35], 0 offen lds
  s_add_u32 m0, s48, 40960
  v_add_u32_dpp v56, v16, v2 row_newbcast:10 row_mask:0xf bank_mask:0xc
  buffer_load_dwordx4 v64, s[32:35], 0 offen lds
  s_add_u32 m0, s49, 40960
  v_add_u32_dpp v57, v20, v3 row_newbcast:10 row_mask:0xf bank_mask:0xc
  buffer_load_dwordx4 v65, s[32:35], 0 offen lds
  v_add_u32_dpp v58, v24, v2 row_newbcast:10 row_mask:0xf bank_mask:0xc
  v_add_u32_dpp v59, v28, v3 row_newbcast:10 row_mask:0xf bank_mask:0xc
  v_add_u32_dpp v60, v32, v2 row_newbcast:10 row_mask:0xf bank_mask:0xc
  v_mov_b32_dpp v16, v16 row_shl:3 row_mask:0xf bank_mask:0xf
  v_mov_b32_dpp v17, v17 row_shl:3 row_mask:0xf bank_mask:0xf
  v_mov_b32_dpp v18, v18 row_shl:3 row_mask:0xf bank_mask:0xf
  v_mov_b32_dpp v19, v19 row_shl:3 row_mask:0xf bank_mask:0xf
  v_mov_b32_dpp v20, v20 row_shl:3 row_mask:0xf bank_mask:0xf
  v_mov_b32_dpp v21, v21 row_shl:3 row_mask:0xf bank_mask:0xf
  v_mov_b32_dpp v22, v22 row_shl:3 row_mask:0xf bank_mask:0xf
  v_mov_b32_dpp v23, v23 row_shl:3 row_mask:0xf bank_mask:0xf
  v_mov_b32_dpp v24, v24 row_shl:3 row_mask:0xf bank_mask:0xf
  v_mov_b32_dpp v25, v25 row_shl:3 row_mask:0xf bank_mask:0xf
  v_mov_b32_dpp v26, v26 row_shl:3 row_mask:0xf bank_mask:0xf
  v_mov_b32_dpp v27, v27 row_shl:3 row_mask:0xf bank_mask:0xf
  v_mov_b32_dpp v28, v28 row_shl:3 row_mask:0xf bank_mask:0xf
  v_mov_b32_dpp v29, v29 row_shl:3 row_mask:0xf bank_mask:0xf
  v_mov_b32_dpp v30, v30 row_shl:3 row_mask:0xf bank_mask:0xf
  v_mov_b32_dpp v31, v31 row_shl:3 row_mask:0xf bank_mask:0xf
  v_mov_b32_dpp v32, v32 row_shl:3 row_mask:0xf bank_mask:0xf
  v_mov_b32_dpp v33, v33 row_shl:3 row_mask:0xf bank_mask:0xf
  v_mov_b32_dpp v34, v34 row_shl:3 row_mask:0xf bank_mask:0xf
  v_mov_b32_dpp v35, v35 row_shl:3 row_mask:0xf bank_mask:0xf
  s_waitcnt vmcnt(12)
  s_barrier
  s_add_u32 m0, s75, 139264
  v_add_u32_dpp v61, v38, v3 row_newbcast:3 row_mask:0xf bank_mask:0x3
  buffer_load_dwordx4 v4, s[44:47], s74 offen lds
  s_add_u32 m0, s75, 140288
  v_add_u32_dpp v62, v42, v2 row_newbcast:3 row_mask:0xf bank_mask:0x3
  buffer_load_dwordx4 v5, s[44:47], s74 offen lds
  s_add_u32 s74, s74, 106496
  s_add_u32 m0, s36, 81920
  v_add_u32_dpp v63, v46, v3 row_newbcast:3 row_mask:0xf bank_mask:0x3
  buffer_load_dwordx4 v56, s[32:35], 0 offen lds
  s_add_u32 m0, s37, 81920
  v_add_u32_dpp v64, v50, v2 row_newbcast:3 row_mask:0xf bank_mask:0x3
  buffer_load_dwordx4 v57, s[32:35], 0 offen lds
  s_add_u32 m0, s38, 81920
  v_add_u32_dpp v65, v54, v3 row_newbcast:3 row_mask:0xf bank_mask:0x3
  buffer_load_dwordx4 v58, s[32:35], 0 offen lds
  s_add_u32 m0, s39, 81920
  v_add_u32_dpp v61, v36, v3 row_newbcast:10 row_mask:0xf bank_mask:0xc
  buffer_load_dwordx4 v59, s[32:35], 0 offen lds
  s_add_u32 m0, s40, 81920
  v_add_u32_dpp v62, v40, v2 row_newbcast:10 row_mask:0xf bank_mask:0xc
  buffer_load_dwordx4 v60, s[32:35], 0 offen lds
  v_add_u32_dpp v63, v44, v3 row_newbcast:10 row_mask:0xf bank_mask:0xc
  v_add_u32_dpp v64, v48, v2 row_newbcast:10 row_mask:0xf bank_mask:0xc
  v_add_u32_dpp v65, v52, v3 row_newbcast:10 row_mask:0xf bank_mask:0xc
  v_mov_b32_dpp v36, v36 row_shl:3 row_mask:0xf bank_mask:0xf
  v_mov_b32_dpp v37, v37 row_shl:3 row_mask:0xf bank_mask:0xf
  v_mov_b32_dpp v38, v38 row_shl:3 row_mask:0xf bank_mask:0xf
  v_mov_b32_dpp v39, v39 row_shl:3 row_mask:0xf bank_mask:0xf
  v_mov_b32_dpp v40, v40 row_shl:3 row_mask:0xf bank_mask:0xf
  v_mov_b32_dpp v41, v41 row_shl:3 row_mask:0xf bank_mask:0xf
  v_mov_b32_dpp v42, v42 row_shl:3 row_mask:0xf bank_mask:0xf
  v_mov_b32_dpp v43, v43 row_shl:3 row_mask:0xf bank_mask:0xf
  v_mov_b32_dpp v44, v44 row_shl:3 row_mask:0xf bank_mask:0xf
  v_mov_b32_dpp v45, v45 row_shl:3 row_mask:0xf bank_mask:0xf
  v_mov_b32_dpp v46, v46 row_shl:3 row_mask:0xf bank_mask:0xf
  v_mov_b32_dpp v47, v47 row_shl:3 row_mask:0xf bank_mask:0xf
  v_mov_b32_dpp v48, v48 row_shl:3 row_mask:0xf bank_mask:0xf
  v_mov_b32_dpp v49, v49 row_shl:3 row_mask:0xf bank_mask:0xf
  v_mov_b32_dpp v50, v50 row_shl:3 row_mask:0xf bank_mask:0xf
  v_mov_b32_dpp v51, v51 row_shl:3 row_mask:0xf bank_mask:0xf
  v_mov_b32_dpp v52, v52 row_shl:3 row_mask:0xf bank_mask:0xf
  v_mov_b32_dpp v53, v53 row_shl:3 row_mask:0xf bank_mask:0xf
  v_mov_b32_dpp v54, v54 row_shl:3 row_mask:0xf bank_mask:0xf
  v_mov_b32_dpp v55, v55 row_shl:3 row_mask:0xf bank_mask:0xf
  s_add_u32 s72, s72, 1
  s_cmp_lt_u32 s72, 2
  s_waitcnt vmcnt(12)
  s_cbranch_scc1 L_dnn_loop1
  s_branch L_ld_tail
L_cin:
  v_lshlrev_b32 v1, 4, v0
  s_and_b32 s79, s3, 3
  s_lshr_b32 s84, s3, 2
  s_lshl_b32 s95, s79, 10
  s_mul_i32 s26, s68, 11
  s_add_u32 s26, s26, s69
  s_sub_u32 s26, s26, 22
  s_cmp_eq_u32 s26, 86
  s_cbranch_scc1 L_end
  s_cmp_eq_u32 s84, 0
  s_cbranch_scc1 L_sc
  s_setprio 2
  v_add_u32 v2, L_tables-L_pc, v1
  v_mov_b32 v3, s93
  v_add_co_u32 v2, vcc, s92, v2
  s_nop 1
  v_addc_co_u32 v3, vcc, 0, v3, vcc
  global_load_dwordx4 v[224:227], v[2:3], off
  global_load_dwordx4 v[240:243], v[2:3], off offset:1024
  v_add_co_u32 v2, vcc, s95, v2
  s_nop 1
  v_addc_co_u32 v3, vcc, 0, v3, vcc
  s_cmp_lt_u32 s79, 2
  s_mov_b32 s70, 119104
  s_cselect_b32 s70, 81920, s70
  s_add_u32 m0, s95, 77824
  s_nop 0
  global_load_lds_dwordx4 v[2:3], off
  v_add_co_u32 v2, vcc, 0x1000, v2
  s_nop 1
  v_addc_co_u32 v3, vcc, 0, v3, vcc
  s_add_u32 m0, s95, s70
  s_nop 0
  global_load_lds_dwordx4 v[2:3], off
  v_add_co_u32 v2, vcc, 0x1000, v2
  s_nop 1
  v_addc_co_u32 v3, vcc, 0, v3, vcc
  s_add_u32 m0, s95, 123200
  s_nop 0
  global_load_lds_dwordx4 v[2:3], off
  v_add_co_u32 v2, vcc, 0x1000, v2
  s_nop 1
  v_addc_co_u32 v3, vcc, 0, v3, vcc
  s_add_u32 m0, s95, 2048
  s_nop 0
  global_load_lds_dwordx4 v[2:3], off
L_sc:
  s_mul_i32 s85, s84, 20
  s_add_u32 s85, s85, s3
  s_mul_i32 s94, s26, 48
  s_add_u32 s94, s94, s85
  s_mul_i32 s94, s94, 104
  v_lshrrev_b32 v6, 3, v0
  v_lshlrev_b32 v6, 4, v6
  v_and_b32 v8, 0x70, v1
  s_mul_i32 s76, s3, 4064
  s_add_u32 s76, s76, 131136
  s_cmp_eq_u32 s84, 0
  s_cbranch_scc1 L_g0
  s_waitcnt lgkmcnt(0)
  s_mov_b32 s40, s10
  s_and_b32 s41, s11, 0xffff
  s_mov_b32 s42, 156
  s_mov_b32 s43, 0x20000
  s_mov_b32 m0, 129472
  s_mov_b64 exec, 0x7ff
  buffer_load_dwordx4 v1, s[40:43], 0 offen lds
  s_mov_b64 exec, -1
  s_lshl_b32 s85, s85, 2
  s_add_u32 s85, s85, 129728
  s_mul_i32 s72, s84, 3
  s_sub_u32 s72, 4, s72
  s_cmp_eq_u32 s26, 85
  s_cselect_b32 s72, s72, 6
  s_lshl_b32 s44, s3, 7
  s_mul_i32 s45, s3, 5280
  s_lshl_b32 s46, s3, 2
  s_lshl_b32 s47, s3, 1
  s_lshl_b32 s82, s3, 12
  s_and_b32 s98, s3, 1
  s_lshr_b32 s99, s3, 1
  s_mul_i32 s68, s99, 3072
  s_lshl_b32 s83, s98, 3
  s_add_u32 s68, s68, s83
  v_add_u32 v59, s68, v1
  s_lshl_b32 s69, s99, 3
  s_lshr_b32 s69, 0x05030200, s69
  s_and_b32 s69, s69, 0xff
  s_lshl_b32 s69, s69, 9
  s_lshl_b32 s70, s98, 2
  s_add_u32 s101, s69, s70
  s_mov_b32 s99, 0x05040100
  s_mov_b32 s100, 0x07060302
  v_mov_b32 v2, 129664
  v_mov_b32 v109, 0
  v_mov_b32 v108, 0
  v_mov_b64 v[32:33], 0
  v_mov_b64 v[34:35], 0
  v_mov_b64 v[36:37], 0
  v_mov_b64 v[38:39], 0
  v_mov_b64 v[40:41], 0
  v_mov_b64 v[42:43], 0
  v_mov_b64 v[44:45], 0
  v_mov_b64 v[46:47], 0
  v_mov_b64 v[48:49], 0
  v_mov_b64 v[50:51], 0
  v_mov_b64 v[52:53], 0
  v_mov_b64 v[54:55], 0
  v_mov_b64 v[56:57], 0
  v_add_u32 v14, 77824, v1
  v_add_u32 v15, 121152, v1
  v_lshrrev_b32_e64 v3, 5, v0
  v_lshl_add_u32 v3, v3, 2, v2
  s_mov_b32 s28, s4
  s_and_b32 s29, s5, 0xffff
  s_mov_b32 s30, 425984
  s_mov_b32 s31, 0x20000
  s_mov_b32 s32, s6
  s_and_b32 s33, s7, 0xffff
  s_mov_b32 s34, 12800000
  s_mov_b32 s35, 0x20000
  ds_write_b128 v2, v[32:35] offset:16
  s_lshl_b32 s68, s79, 6
  v_add_u32_e64 v29, s68, v0
  v_mul_u32_u24 v30, 2521, v29
  v_lshrrev_b32 v30, 16, v30
  v_mul_u32_u24 v30, 12, v30
  v_lshl_add_u32 v28, v29, 1, v30
  v_add_u32 v29, 256, v29
  v_mul_u32_u24 v30, 2521, v29
  v_lshrrev_b32 v30, 16, v30
  v_mul_u32_u24 v30, 12, v30
  v_lshl_add_u32 v58, v29, 1, v30
  v_add_u32 v29, 256, v29
  v_mul_u32_u24 v30, 2521, v29
  v_lshrrev_b32 v30, 16, v30
  v_mul_u32_u24 v30, 12, v30
  v_lshl_add_u32 v111, v29, 1, v30
  v_cmp_gt_u32 vcc, 676, v29
  s_nop 0
  s_mov_b64 s[92:93], vcc
  v_lshlrev_b32 v29, 3, v0
  s_mov_b32 exec_hi, 0xffff
  ds_write_b64 v29, v[32:33] offset:1664
  s_mov_b32 exec_hi, -1
  s_waitcnt vmcnt(5)
  ds_write_b32 v243, v32
  ds_write_b32 v243, v32 offset:43328
  s_waitcnt vmcnt(0)
  ds_read_b64 v[112:113], v240 offset:0
  ds_read_b64 v[114:115], v240 offset:8
  ds_read_b64 v[116:117], v240 offset:32
  ds_read_b64 v[118:119], v240 offset:40
  ds_read_u16 v110, v241
  s_mov_b64 exec, 0x3ffffff
  s_waitcnt lgkmcnt(0)
  ds_write_b16 v242, v110
  v_lshlrev_b32 v109, 17, v110
  v_lshrrev_b32 v109, 1, v109
  s_mov_b64 exec, -1
  v_add_u32 v225, s44, v225
  v_add_u32 v226, s44, v226
  v_add_u32_e64 v227, s44, v227
  s_waitcnt lgkmcnt(0)
  s_barrier
  ds_read_b64_tr_b16 v[60:61], v225 offset:35328
  ds_read_b64_tr_b16 v[62:63], v225 offset:40736
  ds_read_b64_tr_b16 v[64:65], v226 offset:35328
  ds_read_b64_tr_b16 v[66:67], v227 offset:35328
  ds_read_b64_tr_b16 v[68:69], v225 offset:35392
  ds_read_b64_tr_b16 v[70:71], v225 offset:40800
  ds_read_b64_tr_b16 v[72:73], v226 offset:35392
  ds_read_b64_tr_b16 v[74:75], v227 offset:35392
  ds_read_b64_tr_b16 v[76:77], v225 offset:35840
  ds_read_b64_tr_b16 v[78:79], v225 offset:41248
  ds_read_b64_tr_b16 v[80:81], v226 offset:35840
  ds_read_b64_tr_b16 v[82:83], v227 offset:35840
  ds_read_b64_tr_b16 v[84:85], v225 offset:35904
  ds_read_b64_tr_b16 v[86:87], v225 offset:41312
  ds_read_b64_tr_b16 v[88:89], v226 offset:35904
  ds_read_b64_tr_b16 v[90:91], v227 offset:35904
  s_waitcnt lgkmcnt(14)
  v_mfma_f32_32x32x16_bf16 v[120:135], v[112:115], v[60:63], 0
  s_waitcnt lgkmcnt(12)
  v_mfma_f32_32x32x16_bf16 v[120:135], v[116:119], v[64:67], v[120:135]
  ds_read_b64_tr_b16 v[92:93], v225 offset:36352
  ds_read_b64_tr_b16 v[94:95], v225 offset:41760
  ds_read_b64_tr_b16 v[96:97], v226 offset:36352
  ds_read_b64_tr_b16 v[98:99], v227 offset:36352
  s_waitcnt lgkmcnt(14)
  v_mfma_f32_32x32x16_bf16 v[136:151], v[112:115], v[68:71], 0
  s_waitcnt lgkmcnt(12)
  v_mfma_f32_32x32x16_bf16 v[136:151], v[116:119], v[72:75], v[136:151]
  ds_read_b64_tr_b16 v[100:101], v225 offset:36416
  ds_read_b64_tr_b16 v[102:103], v225 offset:41824
  ds_read_b64_tr_b16 v[104:105], v226 offset:36416
  ds_read_b64_tr_b16 v[106:107], v227 offset:36416
  s_waitcnt lgkmcnt(14)
  v_mfma_f32_32x32x16_bf16 v[152:167], v[112:115], v[76:79], 0
  s_waitcnt lgkmcnt(12)
  v_mfma_f32_32x32x16_bf16 v[152:167], v[116:119], v[80:83], v[152:167]
  s_waitcnt lgkmcnt(10)
  v_mfma_f32_32x32x16_bf16 v[168:183], v[112:115], v[84:87], 0
  s_waitcnt lgkmcnt(8)
  v_mfma_f32_32x32x16_bf16 v[168:183], v[116:119], v[88:91], v[168:183]
  ds_read_b128 v[228:231], v15 offset:1024
  ds_read_b128 v[232:235], v15 offset:2048
  ds_read_b128 v[4:7], v14 offset:4096
  ds_read_b128 v[8:11], v15 offset:4096
  ds_read_b128 v[20:23], v14 offset:2048
  ds_read_b128 v[24:27], v14 offset:3072
  ds_read_b128 v[216:219], v14 offset:5120
  ds_read_b128 v[220:223], v15 offset:0
  ds_read_b128 v[236:239], v15 offset:3072
  s_waitcnt lgkmcnt(14)
  v_mfma_f32_32x32x16_bf16 v[184:199], v[112:115], v[92:95], 0
  s_waitcnt lgkmcnt(13)
  v_mfma_f32_32x32x16_bf16 v[184:199], v[116:119], v[96:99], v[184:199]
  s_waitcnt lgkmcnt(11)
  v_mfma_f32_32x32x16_bf16 v[200:215], v[112:115], v[100:103], 0
  s_waitcnt lgkmcnt(9)
  v_mfma_f32_32x32x16_bf16 v[200:215], v[116:119], v[104:107], v[200:215]
  s_waitcnt lgkmcnt(8)
  v_add_u32 v228, s46, v228
  v_add_u32 v229, s46, v229
  v_add_u32 v231, s83, v231
  v_add_u32 v230, s101, v230
  s_waitcnt lgkmcnt(7)
  v_mad_u32_u24 v232, v233, s3, v232
  v_add_u32 v234, s47, v234
  v_mad_u32_u24 v233, v233, 5, v232
  v_add_u32 v246, s82, v235
  v_add_u32 v247, 2048, v246
  v_add_u32 v31, 0, v234
  v_and_b32 v31, 3, v31
  v_lshl_add_u32 v244, v31, 4, v232
  v_add_u32 v31, 1, v234
  v_and_b32 v31, 3, v31
  v_lshl_add_u32 v245, v31, 4, v232
  v_add_u32 v245, 1664, v245
  v_add_u32 v31, 2, v234
  v_and_b32 v31, 3, v31
  v_lshl_add_u32 v248, v31, 4, v233
  v_add_u32 v31, 3, v234
  v_and_b32 v31, 3, v31
  v_lshl_add_u32 v249, v31, 4, v233
  v_add_u32 v249, 1664, v249
  s_waitcnt lgkmcnt(5)
  v_add_u32 v10, s76, v10
  v_add_u32 v4, s76, v4
  v_add_u32 v5, s76, v5
  ds_write_b32 v10, v7 offset:2880
  v_add_u32 v11, s45, v11
  s_waitcnt lgkmcnt(5)
  v_add_u32 v20, s45, v20
  v_add_u32 v21, s45, v21
  v_add_u32 v22, s45, v22
  v_add_u32 v23, s45, v23
  s_waitcnt lgkmcnt(4)
  v_add_u32 v24, s45, v24
  v_add_u32 v25, s45, v25
  v_add_u32 v26, s45, v26
  v_add_u32 v27, s45, v27
  s_mov_b32 exec_lo, 0
  v_mov_b32 v120, v136
  s_mov_b32 exec_lo, -1
  v_cvt_pk_bf16_f32 v60, 0, v120
  ds_write_b16_d16_hi v28, v60
  v_max_f32 v108, |v60|, v108
  s_mov_b32 exec_lo, 0
  v_mov_b32 v152, v168
  s_mov_b32 exec_lo, -1
  v_cvt_pk_bf16_f32 v61, 0, v152
  ds_write_b16_d16_hi v58, v61
  v_max_f32 v108, |v61|, v108
  s_mov_b32 exec_lo, 0
  v_mov_b32_e64 v184, v200
  s_mov_b32 exec_lo, -1
  v_cvt_pk_bf16_f32 v62, 0, v184
  s_mov_b64 exec, s[92:93]
  ds_write_b16_d16_hi v111, v62
  v_max_f32 v108, |v62|, v108
  s_mov_b64 exec, -1
  s_nop 0
  v_permlane32_swap_b32 v108, v109
  v_max_u32_e64 v108, v108, v109
  s_nop 1
  v_max_u32_dpp v108, v108, v108 row_shr:1 row_mask:0xf bank_mask:0xf
  s_nop 1
  v_max_u32_dpp v108, v108, v108 row_shr:2 row_mask:0xf bank_mask:0xf
  s_nop 1
  v_max_u32_dpp v108, v108, v108 row_shr:4 row_mask:0xf bank_mask:0xf
  s_nop 1
  v_max_u32_dpp v108, v108, v108 row_shr:8 row_mask:0xf bank_mask:0xf
  s_nop 1
  v_max_u32_dpp v108, v108, v108 row_bcast:15 row_mask:0xa bank_mask:0xf
  s_mov_b32 exec_lo, 0x80000000
  s_mov_b32 exec_hi, 0x80000000
  ds_max_u32 v3, v108 offset:24
  s_mov_b64 exec, -1
  s_setprio 0
  s_barrier
  s_branch L_w2
L_g0:
  s_waitcnt lgkmcnt(0)
  s_mov_b32 s36, s8
  s_and_b32 s37, s9, 0xffff
  s_mov_b32 s38, 105456
  s_mov_b32 s39, 0x20000
  s_add_u32 m0, s95, 41984
  s_add_u32 s81, s95, 70304
  buffer_load_dwordx4 v1, s[36:39], s81 offen lds
  s_add_u32 m0, s95, 46080
  s_add_u32 s81, s95, 74400
  buffer_load_dwordx4 v1, s[36:39], s81 offen lds
  s_add_u32 m0, s95, 50176
  s_add_u32 s81, s95, 78496
  buffer_load_dwordx4 v1, s[36:39], s81 offen lds
  s_add_u32 m0, s95, 54272
  s_add_u32 s81, s95, 82592
  buffer_load_dwordx4 v1, s[36:39], s81 offen lds
  s_add_u32 m0, s95, 58368
  s_add_u32 s81, s95, 86688
  buffer_load_dwordx4 v1, s[36:39], s81 offen lds
  s_add_u32 m0, s95, 62464
  s_add_u32 s81, s95, 90784
  buffer_load_dwordx4 v1, s[36:39], s81 offen lds
  s_add_u32 m0, s95, 66560
  s_add_u32 s81, s95, 94880
  buffer_load_dwordx4 v1, s[36:39], s81 offen lds
  s_add_u32 m0, s95, 70656
  s_add_u32 s81, s95, 98976
  buffer_load_dwordx4 v1, s[36:39], s81 offen lds
  s_cmp_eq_u32 s79, 3
  s_cbranch_scc1 L_st3
  s_add_u32 m0, s95, 74752
  s_add_u32 s81, s95, 103072
  buffer_load_dwordx4 v1, s[36:39], s81 offen lds
L_st3:
  s_mov_b32 s28, s4
  s_and_b32 s29, s5, 0xffff
  s_mov_b32 s30, 425984
  s_mov_b32 s31, 0x20000
  buffer_load_dwordx4 v[16:19], v6, s[28:31], s94 offen
  s_add_u32 s94, s94, 416
  buffer_load_dwordx4 v[104:107], v6, s[28:31], s94 offen
  s_add_u32 s94, s94, 416
  s_mov_b32 s32, s6
  s_and_b32 s33, s7, 0xffff
  s_mov_b32 s34, 12800000
  s_mov_b32 s35, 0x20000
  s_add_u32 m0, s95, 85312
  s_add_u32 s81, s95, 35152
  buffer_load_dwordx4 v1, s[36:39], s81 offen lds
  s_lshl_b32 s85, s85, 2
  s_add_u32 s85, s85, 129728
  s_mul_i32 s72, s84, 3
  s_sub_u32 s72, 4, s72
  s_cmp_eq_u32 s26, 85
  s_cselect_b32 s72, s72, 6
  s_lshl_b32 s44, s3, 7
  s_add_u32 m0, s95, 89408
  s_add_u32 s81, s95, 39248
  buffer_load_dwordx4 v1, s[36:39], s81 offen lds
  s_mul_i32 s45, s3, 5280
  s_lshl_b32 s46, s3, 2
  s_lshl_b32 s47, s3, 1
  s_lshl_b32 s82, s3, 12
  s_and_b32 s98, s3, 1
  s_add_u32 m0, s95, 93504
  s_add_u32 s81, s95, 43344
  buffer_load_dwordx4 v1, s[36:39], s81 offen lds
  s_lshr_b32 s99, s3, 1
  s_mul_i32 s68, s99, 3072
  s_lshl_b32 s83, s98, 3
  s_add_u32 s68, s68, s83
  v_add_u32 v59, s68, v1
  s_lshl_b32 s69, s99, 3
  s_add_u32 m0, s95, 97600
  s_add_u32 s81, s95, 47440
  buffer_load_dwordx4 v1, s[36:39], s81 offen lds
  s_lshr_b32 s69, 0x05030200, s69
  s_and_b32 s69, s69, 0xff
  s_lshl_b32 s69, s69, 9
  s_lshl_b32 s70, s98, 2
  s_add_u32 s101, s69, s70
  s_add_u32 m0, s95, 101696
  s_add_u32 s81, s95, 51536
  buffer_load_dwordx4 v1, s[36:39], s81 offen lds
  s_mov_b32 s99, 0x05040100
  s_mov_b32 s100, 0x07060302
  v_mov_b32 v2, 129664
  v_mov_b32 v109, 0
  v_mov_b32 v108, 0
  v_mov_b64 v[32:33], 0
  s_add_u32 m0, s95, 105792
  s_add_u32 s81, s95, 55632
  buffer_load_dwordx4 v1, s[36:39], s81 offen lds
  v_mov_b64 v[34:35], 0
  v_mov_b64 v[36:37], 0
  v_mov_b64 v[38:39], 0
  v_mov_b64 v[40:41], 0
  v_mov_b64 v[42:43], 0
  s_add_u32 m0, s95, 109888
  s_add_u32 s81, s95, 59728
  buffer_load_dwordx4 v1, s[36:39], s81 offen lds
  v_mov_b64 v[44:45], 0
  v_mov_b64 v[46:47], 0
  v_mov_b64 v[48:49], 0
  v_mov_b64 v[50:51], 0
  v_mov_b64 v[52:53], 0
  v_mov_b64 v[54:55], 0
  s_add_u32 m0, s95, 113984
  s_add_u32 s81, s95, 63824
  buffer_load_dwordx4 v1, s[36:39], s81 offen lds
  v_mov_b64 v[56:57], 0
  v_add_u32 v14, 77824, v1
  v_add_u32 v15, 121152, v1
  v_lshrrev_b32_e64 v3, 5, v0
  v_lshl_add_u32 v3, v3, 2, v2
  s_cmp_eq_u32 s79, 3
  s_cbranch_scc1 L_st2
  s_add_u32 m0, s95, 118080
  s_add_u32 s81, s95, 67920
  buffer_load_dwordx4 v1, s[36:39], s81 offen lds
L_st2:
  s_add_u32 m0, s95, 6144
  s_add_u32 s81, s95, 0
  buffer_load_dwordx4 v1, s[36:39], s81 offen lds
  s_add_u32 m0, s95, 10240
  s_add_u32 s81, s95, 4096
  buffer_load_dwordx4 v1, s[36:39], s81 offen lds
  s_add_u32 m0, s95, 14336
  s_add_u32 s81, s95, 8192
  buffer_load_dwordx4 v1, s[36:39], s81 offen lds
  s_add_u32 m0, s95, 18432
  s_add_u32 s81, s95, 12288
  buffer_load_dwordx4 v1, s[36:39], s81 offen lds
  s_waitcnt vmcnt(14)
  s_barrier
  ds_read_b128 v[224:227], v14 offset:0
  ds_read_b128 v[228:231], v15 offset:1024
  ds_read_b128 v[232:235], v15 offset:2048
  ds_read_b128 v[4:7], v14 offset:4096
  ds_read_b128 v[8:11], v15 offset:4096
  ds_read_b128 v[20:23], v14 offset:2048
  ds_read_b128 v[24:27], v14 offset:3072
  ds_read_b128 v[216:219], v14 offset:5120
  ds_read_b128 v[220:223], v15 offset:0
  ds_read_b128 v[236:239], v15 offset:3072
  s_add_u32 m0, s95, 22528
  s_add_u32 s81, s95, 16384
  buffer_load_dwordx4 v1, s[36:39], s81 offen lds
  s_add_u32 m0, s95, 26624
  s_add_u32 s81, s95, 20480
  buffer_load_dwordx4 v1, s[36:39], s81 offen lds
  s_add_u32 m0, s95, 30720
  s_add_u32 s81, s95, 24576
  buffer_load_dwordx4 v1, s[36:39], s81 offen lds
  s_add_u32 m0, s95, 34816
  s_add_u32 s81, s95, 28672
  buffer_load_dwordx4 v1, s[36:39], s81 offen lds
  s_cmp_eq_u32 s79, 3
  s_cbranch_scc1 L_st1
  s_add_u32 m0, s95, 38912
  s_add_u32 s81, s95, 32768
  buffer_load_dwordx4 v1, s[36:39], s81 offen lds
L_st1:
  s_waitcnt vmcnt(17) lgkmcnt(5)
  v_lshl_add_u32 v16, v16, 7, v8
  v_lshl_add_u32 v17, v17, 7, v8
  v_lshl_add_u32 v18, v18, 7, v8
  v_lshl_add_u32 v19, v19, 7, v8
  s_add_u32 m0, s76, 0
  s_mov_b32 exec_hi, 0xffffff
  buffer_load_dwordx4 v16, s[32:35], 0 offen lds
  s_add_u32 m0, s76, 1056
  s_nop 0
  buffer_load_dwordx4 v17, s[32:35], 0 offen lds
  s_add_u32 m0, s76, 2112
  s_mov_b32 exec_hi, 0xffff
  buffer_load_dwordx4 v18, s[32:35], 0 offen lds
  s_add_u32 m0, s76, 3168
  s_nop 0
  buffer_load_dwordx4 v19, s[32:35], 0 offen lds
  s_mov_b32 exec_hi, -1
  s_waitcnt vmcnt(20)
  v_lshl_add_u32 v104, v104, 7, v8
  v_lshl_add_u32 v105, v105, 7, v8
  v_lshl_add_u32 v106, v106, 7, v8
  v_lshl_add_u32 v107, v107, 7, v8
  s_add_u32 m0, s76, 16256
  s_mov_b32 exec_hi, 0xffffff
  buffer_load_dwordx4 v104, s[32:35], 0 offen lds
  s_add_u32 m0, s76, 17312
  s_nop 0
  buffer_load_dwordx4 v105, s[32:35], 0 offen lds
  s_add_u32 m0, s76, 18368
  s_mov_b32 exec_hi, 0xffff
  buffer_load_dwordx4 v106, s[32:35], 0 offen lds
  s_add_u32 m0, s76, 19424
  s_nop 0
  buffer_load_dwordx4 v107, s[32:35], 0 offen lds
  s_mov_b32 exec_hi, -1
  v_add_u32 v225, s44, v225
  v_add_u32 v226, s44, v226
  v_add_u32 v227, s44, v227
  v_add_u32 v228, s46, v228
  v_add_u32 v229, s46, v229
  v_add_u32 v231, s83, v231
  v_add_u32 v230, s101, v230
  v_mad_u32_u24 v232, v233, s3, v232
  v_add_u32 v234, s47, v234
  v_mad_u32_u24 v233, v233, 5, v232
  v_add_u32 v246, s82, v235
  v_add_u32 v247, 2048, v246
  v_add_u32 v31, 0, v234
  v_and_b32 v31, 3, v31
  v_lshl_add_u32 v244, v31, 4, v232
  v_add_u32 v31, 1, v234
  v_and_b32 v31, 3, v31
  v_lshl_add_u32 v245, v31, 4, v232
  v_add_u32 v245, 1664, v245
  v_add_u32 v31, 2, v234
  v_and_b32 v31, 3, v31
  v_lshl_add_u32 v248, v31, 4, v233
  v_add_u32 v31, 3, v234
  v_and_b32 v31, 3, v31
  v_lshl_add_u32 v249, v31, 4, v233
  v_add_u32 v249, 1664, v249
  v_add_u32 v10, s76, v10
  v_add_u32 v4, s76, v4
  v_add_u32 v5, s76, v5
  ds_write_b32 v10, v7 offset:2880
  v_add_u32 v11, s45, v11
  s_waitcnt lgkmcnt(5)
  v_add_u32 v20, s45, v20
  v_add_u32 v21, s45, v21
  v_add_u32 v22, s45, v22
  v_add_u32 v23, s45, v23
  s_waitcnt lgkmcnt(4)
  v_add_u32 v24, s45, v24
  v_add_u32 v25, s45, v25
  v_add_u32 v26, s45, v26
  v_add_u32_e64 v27, s45, v27
  s_waitcnt vmcnt(16)
  s_barrier
L_w2:
  ds_read_b32 v60, v228 offset:0
  ds_read_b32 v61, v228 offset:1352
  ds_read_b32 v62, v228 offset:2704
  ds_read_b32 v63, v228 offset:4056
  ds_read_b32 v64, v228 offset:5408
  ds_read_b32 v65, v228 offset:6760
  ds_read_b32 v66, v228 offset:8112
  ds_read_b32 v67, v228 offset:9464
  ds_read_b32 v68, v228 offset:21632
  ds_read_b32 v69, v228 offset:22984
  ds_read_b32 v70, v229 offset:24336
  ds_read_b32 v71, v229 offset:25688
  ds_read_b32 v72, v229 offset:27040
  ds_read_b32 v73, v229 offset:28392
  ds_read_b32 v74, v229 offset:29744
  ds_read_b32 v75, v229 offset:31096
  s_cmp_lt_u32 s3, 3
  s_cbranch_scc1 L_u0
  ds_read_b32 v92, v228 offset:20
  s_waitcnt lgkmcnt(14)
  v_pk_maximum3_f16 v110, v60, v61, 0
  v_pk_minimum3_f16 v58, v60, v61, 0
  ds_read_b32 v93, v228 offset:1372
  s_waitcnt lgkmcnt(14)
  v_pk_maximum3_f16 v110, v62, v63, v110
  v_pk_minimum3_f16 v58, v62, v63, v58
  ds_read_b32 v94, v228 offset:2724
  s_waitcnt lgkmcnt(13)
  v_pk_maximum3_f16 v110, v64, v65, v110
  v_pk_minimum3_f16 v58, v64, v65, v58
  ds_read_b32 v95, v228 offset:4076
  s_waitcnt lgkmcnt(12)
  v_pk_maximum3_f16 v110, v66, v67, v110
  v_pk_minimum3_f16 v58, v66, v67, v58
  ds_read_b32 v96, v228 offset:5428
  s_waitcnt lgkmcnt(11)
  v_pk_maximum3_f16 v110, v68, v69, v110
  v_pk_minimum3_f16 v58, v68, v69, v58
  ds_read_b32 v97, v228 offset:6780
  s_waitcnt lgkmcnt(10)
  v_pk_maximum3_f16 v110, v70, v71, v110
  v_pk_minimum3_f16 v58, v70, v71, v58
  ds_read_b32 v98, v228 offset:8132
  s_waitcnt lgkmcnt(9)
  v_pk_maximum3_f16 v110, v72, v73, v110
  v_pk_minimum3_f16 v58, v72, v73, v58
  ds_read_b32 v99, v228 offset:9484
  s_waitcnt lgkmcnt(8)
  v_pk_maximum3_f16 v110, v74, v75, v110
  v_pk_minimum3_f16 v58, v74, v75, v58
  ds_read_b32 v100, v228 offset:21652
  v_perm_b32 v184, v61, v60, s99
  v_perm_b32 v185, v63, v62, s99
  ds_read_b32 v101, v228 offset:23004
  v_perm_b32 v186, v65, v64, s99
  v_perm_b32 v187, v67, v66, s99
  ds_read_b32 v102, v229 offset:24356
  v_perm_b32 v188, v69, v68, s99
  v_perm_b32 v189, v71, v70, s99
  ds_read_b32 v103, v229 offset:25708
  v_perm_b32 v190, v73, v72, s99
  v_perm_b32 v191, v75, v74, s99
  ds_read_b32 v104, v229 offset:27060
  v_perm_b32 v192, v61, v60, s100
  v_perm_b32 v193, v63, v62, s100
  ds_read_b32 v105, v229 offset:28412
  v_perm_b32 v194, v65, v64, s100
  v_perm_b32 v195, v67, v66, s100
  ds_read_b32 v106, v229 offset:29764
  v_perm_b32 v196, v69, v68, s100
  v_perm_b32 v197, v71, v70, s100
  ds_read_b32 v107, v229 offset:31116
  v_perm_b32 v198, v73, v72, s100
  v_perm_b32 v199, v75, v74, s100
  s_waitcnt vmcnt(8) lgkmcnt(0)
  s_barrier
  ds_read_b64_tr_b16 v[76:77], v225 offset:0
  ds_read_b64_tr_b16 v[78:79], v225 offset:5408
  ds_read_b64_tr_b16 v[80:81], v226 offset:0
  ds_read_b64_tr_b16 v[82:83], v227 offset:0
  ds_read_b64_tr_b16 v[84:85], v225 offset:64
  ds_read_b64_tr_b16 v[86:87], v225 offset:5472
  ds_read_b64_tr_b16 v[88:89], v226 offset:64
  ds_read_b64_tr_b16 v[90:91], v227 offset:64
  v_pk_maximum3_f16 v110, v92, v93, v110
  v_pk_minimum3_f16 v58, v92, v93, v58
  v_pk_maximum3_f16 v110, v94, v95, v110
  v_pk_minimum3_f16 v58, v94, v95, v58
  v_pk_maximum3_f16 v110, v96, v97, v110
  v_pk_minimum3_f16 v58, v96, v97, v58
  v_pk_maximum3_f16 v110, v98, v99, v110
  v_pk_minimum3_f16 v58, v98, v99, v58
  v_pk_maximum3_f16 v110, v100, v101, v110
  v_pk_minimum3_f16 v58, v100, v101, v58
  v_pk_maximum3_f16 v110, v102, v103, v110
  v_pk_minimum3_f16 v58, v102, v103, v58
  v_pk_maximum3_f16 v110, v104, v105, v110
  v_pk_minimum3_f16 v58, v104, v105, v58
  v_pk_maximum3_f16 v110, v106, v107, v110
  v_pk_minimum3_f16 v58, v106, v107, v58
  v_perm_b32 v60, v93, v92, s99
  v_perm_b32 v61, v95, v94, s99
  v_perm_b32 v62, v97, v96, s99
  v_perm_b32 v63, v99, v98, s99
  v_perm_b32 v64, v101, v100, s99
  v_perm_b32 v65, v103, v102, s99
  v_perm_b32 v66, v105, v104, s99
  v_perm_b32 v67, v107, v106, s99
  v_perm_b32 v68, v93, v92, s100
  v_perm_b32 v69, v95, v94, s100
  v_perm_b32 v70, v97, v96, s100
  v_perm_b32 v71, v99, v98, s100
  v_perm_b32 v72, v101, v100, s100
  v_perm_b32 v73, v103, v102, s100
  v_perm_b32 v74, v105, v104, s100
  v_perm_b32 v75, v107, v106, s100
  s_waitcnt lgkmcnt(7)
  v_pk_maximum3_f16 v111, v76, v77, 0
  v_pk_minimum3_f16 v28, v76, v77, 0
  s_waitcnt lgkmcnt(6)
  v_pk_maximum3_f16 v111, v78, v79, v111
  v_pk_minimum3_f16 v28, v78, v79, v28
  s_waitcnt lgkmcnt(5)
  v_pk_maximum3_f16 v111, v80, v81, v111
  v_pk_minimum3_f16 v28, v80, v81, v28
  s_waitcnt lgkmcnt(4)
  v_pk_maximum3_f16 v111, v82, v83, v111
  v_pk_minimum3_f16 v28, v82, v83, v28
  s_waitcnt lgkmcnt(3)
  v_pk_maximum3_f16 v111, v84, v85, v111
  v_pk_minimum3_f16 v28, v84, v85, v28
  s_waitcnt lgkmcnt(2)
  v_pk_maximum3_f16 v111, v86, v87, v111
  v_pk_minimum3_f16 v28, v86, v87, v28
  s_waitcnt lgkmcnt(1)
  v_pk_maximum3_f16 v111, v88, v89, v111
  v_pk_minimum3_f16 v28, v88, v89, v28
  s_waitcnt lgkmcnt(0)
  v_pk_maximum3_f16 v111, v90, v91, v111
  v_pk_minimum3_f16 v28, v90, v91, v28
  s_branch L_u1
L_u0:
  s_waitcnt vmcnt(8) lgkmcnt(0)
  s_barrier
  ds_read_b64_tr_b16 v[76:77], v225 offset:0
  ds_read_b64_tr_b16 v[78:79], v225 offset:5408
  ds_read_b64_tr_b16 v[80:81], v226 offset:0
  ds_read_b64_tr_b16 v[82:83], v227 offset:0
  ds_read_b64_tr_b16 v[84:85], v225 offset:64
  ds_read_b64_tr_b16 v[86:87], v225 offset:5472
  ds_read_b64_tr_b16 v[88:89], v226 offset:64
  ds_read_b64_tr_b16 v[90:91], v227 offset:64
  ds_read_b64_tr_b16 v[92:93], v225 offset:1024
  ds_read_b64_tr_b16 v[94:95], v225 offset:6432
  ds_read_b64_tr_b16 v[96:97], v226 offset:1024
  ds_read_b64_tr_b16 v[98:99], v227 offset:1024
  ds_read_b64_tr_b16 v[100:101], v225 offset:1088
  ds_read_b64_tr_b16 v[102:103], v225 offset:6496
  ds_read_b64_tr_b16 v[104:105], v226 offset:1088
  ds_read_b64_tr_b16 v[106:107], v227 offset:1088
  v_pk_maximum3_f16 v110, v60, v61, 0
  v_pk_minimum3_f16 v58, v60, v61, 0
  v_pk_maximum3_f16 v110, v62, v63, v110
  v_pk_minimum3_f16 v58, v62, v63, v58
  v_pk_maximum3_f16 v110, v64, v65, v110
  v_pk_minimum3_f16 v58, v64, v65, v58
  v_pk_maximum3_f16 v110, v66, v67, v110
  v_pk_minimum3_f16 v58, v66, v67, v58
  v_pk_maximum3_f16 v110, v68, v69, v110
  v_pk_minimum3_f16 v58, v68, v69, v58
  v_pk_maximum3_f16 v110, v70, v71, v110
  v_pk_minimum3_f16 v58, v70, v71, v58
  v_pk_maximum3_f16 v110, v72, v73, v110
  v_pk_minimum3_f16 v58, v72, v73, v58
  v_pk_maximum3_f16 v110, v74, v75, v110
  v_pk_minimum3_f16 v58, v74, v75, v58
  v_perm_b32 v184, v61, v60, s99
  v_perm_b32 v185, v63, v62, s99
  v_perm_b32 v186, v65, v64, s99
  v_perm_b32 v187, v67, v66, s99
  v_perm_b32 v188, v69, v68, s99
  v_perm_b32 v189, v71, v70, s99
  v_perm_b32 v190, v73, v72, s99
  v_perm_b32 v191, v75, v74, s99
  v_perm_b32 v192, v61, v60, s100
  v_perm_b32 v193, v63, v62, s100
  v_perm_b32 v194, v65, v64, s100
  v_perm_b32 v195, v67, v66, s100
  v_perm_b32 v196, v69, v68, s100
  v_perm_b32 v197, v71, v70, s100
  v_perm_b32 v198, v73, v72, s100
  v_perm_b32 v199, v75, v74, s100
  s_waitcnt lgkmcnt(14)
  v_pk_maximum3_f16 v111, v76, v77, 0
  v_pk_minimum3_f16 v28, v76, v77, 0
  v_pk_maximum3_f16 v111, v78, v79, v111
  v_pk_minimum3_f16 v28, v78, v79, v28
  s_waitcnt lgkmcnt(13)
  v_pk_maximum3_f16 v111, v80, v81, v111
  v_pk_minimum3_f16 v28, v80, v81, v28
  s_waitcnt lgkmcnt(12)
  v_pk_maximum3_f16 v111, v82, v83, v111
  v_pk_minimum3_f16 v28, v82, v83, v28
  s_waitcnt lgkmcnt(11)
  v_pk_maximum3_f16 v111, v84, v85, v111
  v_pk_minimum3_f16 v28, v84, v85, v28
  s_waitcnt lgkmcnt(10)
  v_pk_maximum3_f16 v111, v86, v87, v111
  v_pk_minimum3_f16 v28, v86, v87, v28
  s_waitcnt lgkmcnt(9)
  v_pk_maximum3_f16 v111, v88, v89, v111
  v_pk_minimum3_f16 v28, v88, v89, v28
  s_waitcnt lgkmcnt(8)
  v_pk_maximum3_f16 v111, v90, v91, v111
  v_pk_minimum3_f16 v28, v90, v91, v28
  s_waitcnt lgkmcnt(7)
  v_pk_maximum3_f16 v111, v92, v93, v111
  v_pk_minimum3_f16 v28, v92, v93, v28
  s_waitcnt lgkmcnt(6)
  v_pk_maximum3_f16 v111, v94, v95, v111
  v_pk_minimum3_f16 v28, v94, v95, v28
  s_waitcnt lgkmcnt(5)
  v_pk_maximum3_f16 v111, v96, v97, v111
  v_pk_minimum3_f16 v28, v96, v97, v28
  s_waitcnt lgkmcnt(4)
  v_pk_maximum3_f16 v111, v98, v99, v111
  v_pk_minimum3_f16 v28, v98, v99, v28
  s_waitcnt lgkmcnt(3)
  v_pk_maximum3_f16 v111, v100, v101, v111
  v_pk_minimum3_f16 v28, v100, v101, v28
  s_waitcnt lgkmcnt(2)
  v_pk_maximum3_f16 v111, v102, v103, v111
  v_pk_minimum3_f16 v28, v102, v103, v28
  s_waitcnt lgkmcnt(1)
  v_pk_maximum3_f16 v111, v104, v105, v111
  v_pk_minimum3_f16 v28, v104, v105, v28
  s_waitcnt lgkmcnt(0)
  v_pk_maximum3_f16 v111, v106, v107, v111
  v_pk_minimum3_f16 v28, v106, v107, v28
  v_add_u32 v248, 32768, v246
  v_add_u32 v249, 32768, v247
  s_cmp_lg_u32 s3, 2
  s_cbranch_scc1 L_u1
  s_mov_b32 exec_lo, 0xfffffff0
  s_mov_b32 exec_hi, 0xfffffff0
  v_mov_b32 v249, 1048576
  s_mov_b64 exec, -1
L_u1:
  ds_read_b64_tr_b16 v[112:113], v224 offset:0
  ds_read_b64_tr_b16 v[114:115], v224 offset:256
  ds_read_b64_tr_b16 v[116:117], v224 offset:1024
  ds_read_b64_tr_b16 v[118:119], v224 offset:1280
  v_and_b32 v28, 0x7fff7fff, v28
  v_and_b32 v58, 0x7fff7fff, v58
  v_and_b32 v111, 0x7fff7fff, v111
  v_and_b32 v110, 0x7fff7fff, v110
  v_pk_max_u16 v111, v111, v28
  v_pk_max_u16 v110, v110, v58
  v_lshlrev_b32 v28, 16, v111
  v_lshlrev_b32 v58, 16, v110
  v_max_u32 v111, v111, v28
  v_max_u32 v110, v110, v58
  s_nop 1
  v_permlane32_swap_b32 v111, v110
  v_max_u32_e64 v111, v111, v110
  s_nop 1
  v_max_u32_dpp v111, v111, v111 row_shr:1 row_mask:0xf bank_mask:0xf
  s_nop 1
  v_max_u32_dpp v111, v111, v111 row_shr:2 row_mask:0xf bank_mask:0xf
  s_nop 1
  v_max_u32_dpp v111, v111, v111 row_shr:4 row_mask:0xf bank_mask:0xf
  s_nop 1
  v_max_u32_dpp v111, v111, v111 row_shr:8 row_mask:0xf bank_mask:0xf
  s_nop 1
  v_max_u32_dpp v111, v111, v111 row_bcast:15 row_mask:0xa bank_mask:0xf
  s_mov_b32 exec_lo, 0x80000000
  s_mov_b32 exec_hi, 0x80000000
  ds_max_u32 v3, v111 offset:16
  s_mov_b64 exec, -1
  s_waitcnt lgkmcnt(0)
  s_barrier
  ds_read_b128 v[108:111], v2 offset:16
  s_waitcnt lgkmcnt(0)
  v_lshrrev_b32 v108, 23, v108
  v_lshrrev_b32 v109, 23, v109
  v_sub_u32 v108, 267, v108
  v_lshrrev_b32 v110, 23, v110
  v_min_u32 v108, 167, v108
  v_lshrrev_b32 v111, 23, v111
  v_readfirstlane_b32 s74, v108
  v_mul_u32_u24 v108, 0x800080, v108
  v_and_b32 v216, v216, v108
  v_and_b32 v217, v217, v108
  v_and_b32 v218, v218, v108
  v_and_b32 v219, v219, v108
  v_and_b32 v220, v220, v108
  v_and_b32 v221, v221, v108
  v_and_b32 v222, v222, v108
  v_and_b32 v223, v223, v108
  v_mfma_f32_32x32x16_bf16 v[152:167], v[216:219], v[76:79], 0
  s_mov_b32 vcc_lo, 0x4000000
  s_mov_b32 vcc_hi, 0x4000000
  v_cndmask_b32 v250, v110, v111, vcc
  v_mfma_f32_32x32x16_bf16 v[152:167], v[220:223], v[80:83], v[152:167]
  v_add_u32 v250, v250, v109
  v_sub_u32 v250, 388, v250
  s_movk_i32 s98, 167
  v_mfma_f32_32x32x16_bf16 v[168:183], v[216:219], v[84:87], 0
  v_med3_i32 v250, v250, 1, s98
  v_subrev_u32 v110, 127, v250
  v_lshlrev_b32 v250, 23, v250
  v_mfma_f32_32x32x16_bf16 v[168:183], v[220:223], v[88:91], v[168:183]
  v_cmp_gt_i32 vcc, 0, v110
  v_mul_u32_u24 v110, 0x800080, v110
  s_cbranch_vccnz L_sdown
  v_add_u32 v112, v112, v110
  v_add_u32 v113, v113, v110
  v_add_u32 v114, v114, v110
  v_add_u32 v115, v115, v110
  v_add_u32 v116, v116, v110
  v_add_u32 v117, v117, v110
  v_add_u32 v118, v118, v110
  v_add_u32_e64 v119, v119, v110
L_scaled:
  v_mfma_f32_32x32x16_bf16 v[120:135], v[184:187], v[112:115], 0
  v_cvt_pk_f16_f32 v152, v152, v153
  v_cvt_pk_f16_f32 v153, v154, v155
  v_cvt_pk_f16_f32 v154, v156, v157
  v_cvt_pk_f16_f32 v155, v158, v159
  ds_write_b128 v246, v[152:155]
  v_xor_b32_e64 v246, 16, v246
  v_mfma_f32_32x32x16_bf16 v[120:135], v[188:191], v[116:119], v[120:135]
  v_cvt_pk_f16_f32 v156, v160, v161
  v_cvt_pk_f16_f32 v157, v162, v163
  v_cvt_pk_f16_f32 v158, v164, v165
  v_cvt_pk_f16_f32 v159, v166, v167
  ds_write_b128 v246, v[156:159]
  v_mfma_f32_32x32x16_bf16 v[136:151], v[192:195], v[112:115], 0
  v_cvt_pk_f16_f32 v168, v168, v169
  v_cvt_pk_f16_f32 v169, v170, v171
  v_cvt_pk_f16_f32 v170, v172, v173
  v_cvt_pk_f16_f32 v171, v174, v175
  ds_write_b128 v247, v[168:171]
  v_xor_b32_e64 v247, 16, v247
  v_mfma_f32_32x32x16_bf16 v[136:151], v[196:199], v[116:119], v[136:151]
  v_cvt_pk_f16_f32 v172, v176, v177
  v_cvt_pk_f16_f32 v173, v178, v179
  v_cvt_pk_f16_f32 v174, v180, v181
  v_cvt_pk_f16_f32 v175, v182, v183
  ds_write_b128 v247, v[172:175]
  s_cmp_lt_u32 s3, 3
  s_cbranch_scc1 L_u2
  v_mfma_f32_32x32x16_bf16 v[184:199], v[60:63], v[112:115], 0
  v_mfma_f32_32x32x16_bf16 v[184:199], v[64:67], v[116:119], v[184:199]
  v_mfma_f32_32x32x16_bf16 v[200:215], v[68:71], v[112:115], 0
  v_mfma_f32_32x32x16_bf16 v[200:215], v[72:75], v[116:119], v[200:215]
  s_branch L_u3
L_u2:
  v_mfma_f32_32x32x16_bf16 v[184:199], v[216:219], v[92:95], 0
  v_mfma_f32_32x32x16_bf16 v[184:199], v[220:223], v[96:99], v[184:199]
  v_mfma_f32_32x32x16_bf16 v[200:215], v[216:219], v[100:103], 0
  v_mfma_f32_32x32x16_bf16 v[200:215], v[220:223], v[104:107], v[200:215]
L_u3:
  v_cvt_pk_f16_f32 v120, v120, v121
  v_cvt_pk_f16_f32 v121, v122, v123
  v_cvt_pk_f16_f32 v122, v124, v125
  v_cvt_pk_f16_f32 v123, v126, v127
  ds_write_b128 v244, v[120:123]
  v_xor_b32 v244, 16, v244
  v_cvt_pk_f16_f32 v124, v128, v129
  v_cvt_pk_f16_f32 v125, v130, v131
  v_cvt_pk_f16_f32 v126, v132, v133
  v_cvt_pk_f16_f32 v127, v134, v135
  ds_write_b128 v244, v[124:127]
  v_cvt_pk_f16_f32 v136, v136, v137
  v_cvt_pk_f16_f32 v137, v138, v139
  v_cvt_pk_f16_f32 v138, v140, v141
  v_cvt_pk_f16_f32 v139, v142, v143
  ds_write_b128 v245, v[136:139]
  v_xor_b32_e64 v245, 16, v245
  v_cvt_pk_f16_f32 v140, v144, v145
  v_cvt_pk_f16_f32 v141, v146, v147
  v_cvt_pk_f16_f32 v142, v148, v149
  v_cvt_pk_f16_f32 v143, v150, v151
  ds_write_b128 v245, v[140:143]
  v_cvt_pk_f16_f32 v184, v184, v185
  v_cvt_pk_f16_f32 v185, v186, v187
  v_cvt_pk_f16_f32 v186, v188, v189
  v_cvt_pk_f16_f32 v187, v190, v191
  ds_write_b128 v248, v[184:187]
  v_xor_b32_e64 v248, 16, v248
  v_cvt_pk_f16_f32 v188, v192, v193
  v_cvt_pk_f16_f32 v189, v194, v195
  v_cvt_pk_f16_f32 v190, v196, v197
  v_cvt_pk_f16_f32 v191, v198, v199
  ds_write_b128 v248, v[188:191]
  v_cvt_pk_f16_f32 v200, v200, v201
  v_cvt_pk_f16_f32 v201, v202, v203
  v_cvt_pk_f16_f32 v202, v204, v205
  v_cvt_pk_f16_f32 v203, v206, v207
  ds_write_b128 v249, v[200:203]
  v_xor_b32_e64 v249, 16, v249
  v_cvt_pk_f16_f32 v204, v208, v209
  v_cvt_pk_f16_f32 v205, v210, v211
  v_cvt_pk_f16_f32 v206, v212, v213
  v_cvt_pk_f16_f32 v207, v214, v215
  ds_write_b128 v249, v[204:207]
  v_readlane_b32 s0, v250, 0
  v_readlane_b32 s1, v250, 26
  s_sub_u32 s75, 0x7f000000, s0
  s_sub_u32 s1, 0x7f000000, s1
  s_sub_u32 s74, 254, s74
  s_lshl_b32 s74, s74, 23
  s_mov_b32 s92, 0x88888888
  s_mov_b32 s93, 0x88888888
  s_mul_i32 s68, s3, 384
  v_lshrrev_b32 v29, 2, v0
  v_mul_u32_u24 v29, 24, v29
  v_add_u32 v29, s68, v29
  v_and_b32 v30, 3, v0
  v_lshlrev_b32 v30, 3, v30
  ds_read_b64 v[152:153], v29 offset:2048
  ds_read_b64 v[154:155], v29 offset:2056
  ds_read_b64 v[156:157], v29 offset:2064
  buffer_load_dwordx4 v[16:19], v6, s[28:31], s94 offen
  s_add_u32 s94, s94, 416
  buffer_load_dwordx4 v[216:219], v6, s[28:31], s94 offen
  s_add_u32 s94, s94, 416
  s_waitcnt lgkmcnt(2)
  v_xor_b32 v152, v152, v30
  v_xor_b32 v158, 32, v152
  v_xor_b32 v153, v153, v30
  v_xor_b32 v159, 32, v153
  s_waitcnt lgkmcnt(1)
  v_xor_b32 v154, v154, v30
  v_xor_b32 v160, 32, v154
  v_xor_b32 v155, v155, v30
  v_xor_b32 v161, 32, v155
  s_waitcnt lgkmcnt(0)
  v_xor_b32 v156, v156, v30
  v_xor_b32 v162, 32, v156
  v_xor_b32 v157, v157, v30
  v_xor_b32_e64 v163, 32, v157
  s_waitcnt lgkmcnt(0)
  s_barrier
  ds_read_b64_tr_b16 v[60:61], v152 offset:0
  ds_read_b64_tr_b16 v[62:63], v153 offset:0
  ds_read_b64_tr_b16 v[64:65], v158 offset:0
  ds_read_b64_tr_b16 v[66:67], v159 offset:0
  ds_read_b64_tr_b16 v[68:69], v152 offset:43328
  ds_read_b64_tr_b16 v[70:71], v153 offset:43328
  ds_read_b64_tr_b16 v[72:73], v158 offset:43328
  ds_read_b64_tr_b16 v[74:75], v159 offset:43328
  ds_read_b64_tr_b16 v[76:77], v154 offset:0
  ds_read_b64_tr_b16 v[78:79], v155 offset:0
  ds_read_b64_tr_b16 v[80:81], v160 offset:0
  ds_read_b64_tr_b16 v[82:83], v161 offset:0
  ds_read_b64_tr_b16 v[84:85], v154 offset:43328
  ds_read_b64_tr_b16 v[86:87], v155 offset:43328
  ds_read_b64_tr_b16 v[88:89], v160 offset:43328
  ds_read_b64_tr_b16 v[90:91], v161 offset:43328
  s_cmp_ge_u32 s3, 6
  s_cbranch_scc1 L_lin
  ds_read_b64_tr_b16 v[92:93], v156 offset:0
  ds_read_b64_tr_b16 v[94:95], v157 offset:0
  ds_read_b64_tr_b16 v[96:97], v162 offset:0
  ds_read_b64_tr_b16 v[98:99], v163 offset:0
  ds_read_b64_tr_b16 v[100:101], v156 offset:43328
  ds_read_b64_tr_b16 v[102:103], v157 offset:43328
  ds_read_b64_tr_b16 v[104:105], v162 offset:43328
  ds_read_b64_tr_b16 v[106:107], v163 offset:43328
  s_waitcnt lgkmcnt(6)
  v_pk_add_f16 v92, v92, v94
  v_pk_add_f16 v93, v93, v95
  ds_write_b64 v59, v[92:93] offset:30720
  s_waitcnt lgkmcnt(5)
  v_pk_add_f16 v96, v96, v98
  v_pk_add_f16 v97, v97, v99
  s_waitcnt lgkmcnt(3)
  v_pk_add_f16 v100, v100, v102
  v_pk_add_f16 v101, v101, v103
  ds_write_b64 v59, v[100:101] offset:32768
  s_waitcnt lgkmcnt(2)
  v_pk_add_f16 v104, v104, v106
  v_pk_add_f16 v105, v105, v107
  v_cndmask_b32 v96, v96, v104, s[92:93]
  v_cndmask_b32 v97, v97, v105, s[92:93]
  ds_write_b64 v59, v[96:97] offset:31744
  ds_write_b32 v230, v104 offset:3072
  ds_write_b32 v230, v105 offset:3088
  s_branch L_p2
L_lin:
  s_and_b32 s98, s3, 1
  s_cselect_b64 vcc, -1, 0
  s_lshl_b32 s99, s98, 5
  v_mov_b32 v31, 0
  v_xor_b32 v236, s99, v236
  v_xor_b32 v237, s99, v237
  v_cndmask_b32 v238, v238, v239, vcc
  ds_read_b64_tr_b16 v[92:93], v236
  ds_read_b64_tr_b16 v[94:95], v237
  ds_read_u16_d16_hi v31, v238
  s_lshl_b32 s98, s98, 10
  v_add_u32 v29, s98, v1
  s_waitcnt lgkmcnt(2)
  v_cvt_f32_f16 v96, v92
  v_cvt_f32_f16_sdwa v97, v92 dst_sel:DWORD dst_unused:UNUSED_PAD src0_sel:WORD_1
  v_mul_f32 v96, s1, v96
  v_mul_f32 v97, s1, v97
  v_mul_f32 v96, s0, v96
  v_mul_f32 v97, s0, v97
  v_cvt_pk_bf16_f32 v92, v96, v97
  v_cvt_f32_f16 v98, v93
  v_cvt_f32_f16_sdwa v99, v93 dst_sel:DWORD dst_unused:UNUSED_PAD src0_sel:WORD_1
  v_mul_f32 v98, s1, v98
  v_mul_f32 v99, s1, v99
  v_mul_f32 v98, s0, v98
  v_mul_f32 v99, s0, v99
  v_cvt_pk_bf16_f32 v93, v98, v99
  s_waitcnt lgkmcnt(1)
  v_cvt_f32_f16 v100, v94
  v_cvt_f32_f16_sdwa v101, v94 dst_sel:DWORD dst_unused:UNUSED_PAD src0_sel:WORD_1
  v_mul_f32 v100, s1, v100
  v_mul_f32 v101, s1, v101
  v_mul_f32 v100, s0, v100
  v_mul_f32 v101, s0, v101
  v_cvt_pk_bf16_f32 v94, v100, v101
  v_cvt_f32_f16 v102, v95
  v_cvt_f32_f16_sdwa v103, v95 dst_sel:DWORD dst_unused:UNUSED_PAD src0_sel:WORD_1
  v_mul_f32 v102, s1, v102
  v_mul_f32 v103, s1, v103
  s_mov_b32 exec_lo, 0
  s_mov_b32 exec_hi, 0xffff
  s_waitcnt lgkmcnt(0)
  v_mov_b32 v102, v31
  s_mov_b64 exec, -1
  v_mul_f32 v102, s0, v102
  v_mul_f32 v103, s0, v103
  v_cvt_pk_bf16_f32 v95, v102, v103
  ds_write_b128 v29, v[92:95] offset:39936
L_p2:
  v_pk_add_f16 v76, v76, v78
  v_pk_add_f16 v77, v77, v79
  ds_write_b64 v59, v[76:77] offset:18432
  v_pk_add_f16 v80, v80, v82
  v_pk_add_f16 v81, v81, v83
  v_pk_add_f16 v84, v84, v86
  v_pk_add_f16 v85, v85, v87
  ds_write_b64 v59, v[84:85] offset:20480
  v_pk_add_f16 v88, v88, v90
  v_pk_add_f16 v89, v89, v91
  v_cndmask_b32 v80, v80, v88, s[92:93]
  v_cndmask_b32 v81, v81, v89, s[92:93]
  ds_write_b64 v59, v[80:81] offset:19456
  ds_write_b32 v230, v88 offset:1024
  ds_write_b32 v230, v89 offset:1040
  v_pk_add_f16 v60, v60, v62
  v_pk_add_f16 v61, v61, v63
  ds_write_b64 v59, v[60:61] offset:6144
  v_pk_add_f16 v64, v64, v66
  v_pk_add_f16 v65, v65, v67
  v_pk_add_f16 v68, v68, v70
  v_pk_add_f16 v69, v69, v71
  ds_write_b64 v59, v[68:69] offset:8192
  v_pk_add_f16 v72, v72, v74
  v_pk_add_f16 v73, v73, v75
  v_cndmask_b32 v64, v64, v72, s[92:93]
  v_cndmask_b32 v65, v65, v73, s[92:93]
  ds_write_b64 v59, v[64:65] offset:7168
  s_cmp_lt_u32 s3, 2
  s_cbranch_scc1 L_p2d
  v_subrev_u32 v230, 1024, v230
  ds_write_b32 v230, v72 offset:0
  ds_write_b32 v230, v73 offset:16
  s_branch L_built
L_p2d:
  ds_write_b64 v231, v[72:73] offset:5120
L_built:
  s_mov_b32 s0, s74
  s_mov_b32 s1, s75
  s_mov_b32 s96, 0x3e000000
  s_mov_b32 s97, 0x43000000
  s_mov_b32 s51, 1
  s_mul_i32 s98, s3, 1536
  s_add_u32 s98, s98, 1165312
  s_mov_b32 s48, -1048576
  s_cmp_lg_u32 s84, 0
  s_cbranch_scc1 L_g1c
  s_sub_u32 s94, s94, 416
  s_waitcnt vmcnt(2)
  ds_read_u16_d16_hi v32, v10 offset:0
  ds_read_u16_d16_hi v33, v10 offset:2
  ds_read_u16_d16_hi v34, v10 offset:2112
  ds_read_u16_d16_hi v35, v10 offset:2114
  ds_read_u16_d16_hi v36, v10 offset:128
  ds_read_u16_d16_hi v37, v10 offset:130
  ds_read_u16_d16_hi v38, v10 offset:2240
  ds_read_u16_d16_hi v39, v10 offset:2242
  ds_read_u16_d16_hi v40, v10 offset:256
  ds_read_u16_d16_hi v41, v10 offset:258
  ds_read_u16_d16_hi v42, v10 offset:2368
  ds_read_u16_d16_hi v43, v10 offset:2370
  ds_read_u16_d16_hi v44, v10 offset:384
  ds_read_u16_d16_hi v45, v10 offset:386
  ds_read_u16_d16_hi v46, v10 offset:2496
  ds_read_u16_d16_hi v47, v10 offset:2498
  ds_read_u16_d16_hi v48, v10 offset:512
  ds_read_u16_d16_hi v49, v10 offset:514
  ds_read_u16_d16_hi v50, v10 offset:2624
  ds_read_u16_d16_hi v51, v10 offset:2626
  ds_read_u16_d16_hi v52, v10 offset:640
  ds_read_u16_d16_hi v53, v10 offset:642
  ds_read_u16_d16_hi v54, v10 offset:2752
  ds_read_u16_d16_hi v55, v10 offset:2754
  ds_read_u16_d16_hi v56, v10 offset:768
  ds_read_u16_d16_hi v57, v10 offset:770
  s_waitcnt lgkmcnt(14)
  v_max3_f32 v58, |v32|, |v33|, 0
  v_cvt_pk_f16_f32 v184, v32, v33
  v_max3_f32 v58, |v34|, |v35|, v58
  v_cvt_pk_f16_f32 v185, v34, v35
  v_max3_f32 v58, |v36|, |v37|, v58
  v_cvt_pk_f16_f32 v186, v36, v37
  v_max3_f32 v58, |v38|, |v39|, v58
  v_cvt_pk_f16_f32 v187, v38, v39
  v_max3_f32 v58, |v40|, |v41|, v58
  v_cvt_pk_f16_f32 v188, v40, v41
  v_max3_f32 v58, |v42|, |v43|, v58
  v_cvt_pk_f16_f32 v189, v42, v43
  s_waitcnt lgkmcnt(12)
  v_max3_f32 v58, |v44|, |v45|, v58
  v_cvt_pk_f16_f32 v190, v44, v45
  s_waitcnt lgkmcnt(10)
  v_max3_f32 v58, |v46|, |v47|, v58
  v_cvt_pk_f16_f32 v191, v46, v47
  s_waitcnt lgkmcnt(8)
  v_max3_f32 v58, |v48|, |v49|, v58
  v_cvt_pk_f16_f32 v192, v48, v49
  s_waitcnt lgkmcnt(6)
  v_max3_f32 v58, |v50|, |v51|, v58
  v_cvt_pk_f16_f32 v193, v50, v51
  s_waitcnt lgkmcnt(4)
  v_max3_f32 v58, |v52|, |v53|, v58
  v_cvt_pk_f16_f32 v194, v52, v53
  s_waitcnt lgkmcnt(2)
  v_max3_f32 v58, |v54|, |v55|, v58
  v_cvt_pk_f16_f32 v195, v54, v55
  s_waitcnt lgkmcnt(0)
  v_max3_f32 v58, |v56|, |v57|, v58
  v_cvt_pk_f16_f32 v196, v56, v57
  s_waitcnt lgkmcnt(0)
  s_barrier
  s_branch L_cin_go
L_g1c:
  s_waitcnt lgkmcnt(0)
  s_barrier
  s_add_u32 s76, s76, -63168
  s_waitcnt vmcnt(1)
  v_lshl_add_u32 v16, v16, 7, v8
  v_lshl_add_u32 v17, v17, 7, v8
  v_lshl_add_u32 v18, v18, 7, v8
  v_lshl_add_u32 v19, v19, 7, v8
  s_add_u32 m0, s76, 0
  s_mov_b32 exec_hi, 0xffffff
  buffer_load_dwordx4 v16, s[32:35], 0 offen lds
  s_add_u32 m0, s76, 1056
  s_nop 0
  buffer_load_dwordx4 v17, s[32:35], 0 offen lds
  s_add_u32 m0, s76, 2112
  s_mov_b32 exec_hi, 0xffff
  buffer_load_dwordx4 v18, s[32:35], 0 offen lds
  s_add_u32 m0, s76, 3168
  s_nop 0
  buffer_load_dwordx4 v19, s[32:35], 0 offen lds
  s_mov_b32 exec_hi, -1
  s_waitcnt vmcnt(4)
  v_lshl_add_u32 v216, v216, 7, v8
  v_lshl_add_u32 v217, v217, 7, v8
  v_lshl_add_u32 v218, v218, 7, v8
  v_lshl_add_u32 v219, v219, 7, v8
  s_add_u32 m0, s76, 16256
  s_mov_b32 exec_hi, 0xffffff
  buffer_load_dwordx4 v216, s[32:35], 0 offen lds
  s_add_u32 m0, s76, 17312
  s_nop 0
  buffer_load_dwordx4 v217, s[32:35], 0 offen lds
  s_add_u32 m0, s76, 18368
  s_mov_b32 exec_hi, 0xffff
  buffer_load_dwordx4 v218, s[32:35], 0 offen lds
  s_add_u32 m0, s76, 19424
  s_nop 0
  buffer_load_dwordx4 v219, s[32:35], 0 offen lds
  s_mov_b32 exec_hi, -1
  buffer_load_dwordx4 v[16:19], v6, s[28:31], s94 offen
  s_add_u32 s94, s94, 416
  v_add_u32 v10, -63168, v10
  v_add_u32 v4, -63168, v4
  v_add_u32 v5, -63168, v5
  ds_write_b32 v10, v7 offset:2880
  ds_write_b32 v10, v7 offset:19136
  s_cmp_lg_u32 s3, 4
  s_cbranch_scc1 L_g1d
  s_mov_b32 s60, s24
  s_and_b32 s61, s25, 0xffff
  s_mov_b32 s62, 268435456
  s_mov_b32 s63, 0x20000
  s_mov_b32 s56, s20
  s_and_b32 s57, s21, 0xffff
  s_mov_b32 s58, 8192
  s_mov_b32 s59, 0x20000
  s_mov_b32 s64, s22
  s_and_b32 s65, s23, 0xffff
  s_mov_b32 s66, 256
  s_mov_b32 s67, 0x20000
  s_load_dword s80, s[18:19], 0
  v_mov_b32 v248, 0
  s_mov_b64 exec, 1
  s_mov_b32 s81, 0x80000
  buffer_load_dword v249, v248, s[60:63], s81 offen
  buffer_load_dword v250, v248, s[56:59], 0 offen
  s_mov_b64 exec, -1
  s_mov_b64 exec, 1
  buffer_load_dword v59, v248, s[64:67], 0 offen offset:240 sc1
  s_mov_b64 exec, -1
  s_mov_b32 s52, s16
  s_and_b32 s53, s17, 0xffff
  s_mov_b32 s54, 3328
  s_mov_b32 s55, 0x20000
  v_lshlrev_b32 v248, 7, v0
  buffer_load_dword v251, v248, s[52:55], 0 offen
L_g1d:
  s_waitcnt vmcnt(5)
  ds_read_u16_d16_hi v32, v10 offset:0
  ds_read_u16_d16_hi v33, v10 offset:2
  ds_read_u16_d16_hi v34, v10 offset:2112
  ds_read_u16_d16_hi v35, v10 offset:2114
  ds_read_u16_d16_hi v36, v10 offset:128
  ds_read_u16_d16_hi v37, v10 offset:130
  ds_read_u16_d16_hi v38, v10 offset:2240
  ds_read_u16_d16_hi v39, v10 offset:2242
  ds_read_u16_d16_hi v40, v10 offset:256
  ds_read_u16_d16_hi v41, v10 offset:258
  ds_read_u16_d16_hi v42, v10 offset:2368
  ds_read_u16_d16_hi v43, v10 offset:2370
  ds_read_u16_d16_hi v44, v10 offset:384
  ds_read_u16_d16_hi v45, v10 offset:386
  ds_read_u16_d16_hi v46, v10 offset:2496
  ds_read_u16_d16_hi v47, v10 offset:2498
  ds_read_u16_d16_hi v48, v10 offset:512
  ds_read_u16_d16_hi v49, v10 offset:514
  ds_read_u16_d16_hi v50, v10 offset:2624
  ds_read_u16_d16_hi v51, v10 offset:2626
  ds_read_u16_d16_hi v52, v10 offset:640
  ds_read_u16_d16_hi v53, v10 offset:642
  ds_read_u16_d16_hi v54, v10 offset:2752
  ds_read_u16_d16_hi v55, v10 offset:2754
  ds_read_u16_d16_hi v56, v10 offset:768
  ds_read_u16_d16_hi v57, v10 offset:770
  s_waitcnt lgkmcnt(0)
  v_max3_f32 v58, |v32|, |v33|, 0
  v_cvt_pk_f16_f32 v184, v32, v33
  v_max3_f32 v58, |v34|, |v35|, v58
  v_cvt_pk_f16_f32 v185, v34, v35
  v_max3_f32 v58, |v36|, |v37|, v58
  v_cvt_pk_f16_f32 v186, v36, v37
  v_max3_f32 v58, |v38|, |v39|, v58
  v_cvt_pk_f16_f32 v187, v38, v39
  v_max3_f32 v58, |v40|, |v41|, v58
  v_cvt_pk_f16_f32 v188, v40, v41
  v_max3_f32 v58, |v42|, |v43|, v58
  v_cvt_pk_f16_f32 v189, v42, v43
  s_waitcnt lgkmcnt(12)
  v_max3_f32 v58, |v44|, |v45|, v58
  v_cvt_pk_f16_f32 v190, v44, v45
  s_waitcnt lgkmcnt(10)
  v_max3_f32 v58, |v46|, |v47|, v58
  v_cvt_pk_f16_f32 v191, v46, v47
  s_waitcnt lgkmcnt(8)
  v_max3_f32 v58, |v48|, |v49|, v58
  v_cvt_pk_f16_f32 v192, v48, v49
  s_waitcnt lgkmcnt(6)
  v_max3_f32 v58, |v50|, |v51|, v58
  v_cvt_pk_f16_f32 v193, v50, v51
  s_waitcnt lgkmcnt(4)
  v_max3_f32 v58, |v52|, |v53|, v58
  v_cvt_pk_f16_f32 v194, v52, v53
  s_waitcnt lgkmcnt(2)
  v_max3_f32 v58, |v54|, |v55|, v58
  v_cvt_pk_f16_f32 v195, v54, v55
  s_waitcnt lgkmcnt(0)
  v_max3_f32 v58, |v56|, |v57|, v58
  v_cvt_pk_f16_f32 v196, v56, v57
L_cin_go:
  ds_write_b32 v11, v184 offset:0
  ds_write_b32 v11, v185 offset:160
  ds_write_b32 v11, v186 offset:320
  ds_write_b32 v11, v187 offset:480
  ds_write_b32 v11, v188 offset:640
  ds_write_b32 v11, v189 offset:800
  ds_write_b32 v11, v190 offset:960
  ds_write_b32 v11, v191 offset:1120
  ds_write_b32 v11, v192 offset:1280
  ds_write_b32 v11, v193 offset:1440
  ds_write_b32 v11, v194 offset:1600
  ds_write_b32 v11, v195 offset:1760
  ds_write_b32 v11, v196 offset:1920
  s_mov_b32 s81, 16256
  s_add_u32 s76, s76, 16256
  v_lshlrev_b32 v7, 2, v0
  v_add_u32 v7, s98, v7
L_cin_loop:
  v_cmp_le_f32 s[90:91], s97, v58
  v_cmp_le_f32 vcc, s96, v58
  s_mov_b32 s49, s74
  s_mov_b32 s50, s75
  s_cmp_lg_u64 s[90:91], 0
  s_cbranch_scc1 L_cslow
  s_cbranch_vccz L_cslow
L_cconv:
  ds_read_b64_tr_b16 v[60:61], v20 offset:0
  v_mul_f32 v116, v184, v192
  v_mul_f32 v117, v185, v193
  ds_read_b64_tr_b16 v[74:75], v20 offset:32
  v_mul_f32 v118, v186, v194
  ds_read_b64_tr_b16 v[88:89], v20 offset:64
  v_mul_f32 v119, v187, v195
  ds_read_b64_tr_b16 v[102:103], v20 offset:96
  v_fmac_f32_e64 v116, v188, v191
  ds_read_b64_tr_b16 v[66:67], v23 offset:0
  v_fmac_f32 v117, v200, v208
  ds_read_b64_tr_b16 v[80:81], v23 offset:32
  v_fmac_f32 v118, v201, v209
  ds_read_b64_tr_b16 v[94:95], v23 offset:64
  v_fmac_f32 v119, v202, v210
  ds_read_b64_tr_b16 v[108:109], v23 offset:96
  v_fmac_f32 v116, v203, v211
  ds_read_b64_tr_b16 v[68:69], v24 offset:0
  v_fmac_f32_e64 v117, v204, v207
  ds_read_b64_tr_b16 v[82:83], v24 offset:32
  s_waitcnt vmcnt(0)
  v_fmac_f32 v118, v216, v224
  ds_read_b64_tr_b16 v[96:97], v24 offset:64
  v_fmac_f32 v119, v217, v225
  v_fmac_f32 v116, v218, v226
  ds_read_b64_tr_b16 v[110:111], v24 offset:96
  v_fmac_f32 v117, v219, v227
  ds_read_b64_tr_b16 v[124:125], v4 offset:0
  v_fmac_f32 v118, v220, v223
  ds_read_b64_tr_b16 v[126:127], v5 offset:0
  v_fmac_f32 v119, v232, v240
  ds_read_b64_tr_b16 v[136:137], v4 offset:32
  v_fmac_f32 v116, v233, v241
  ds_read_b64_tr_b16 v[138:139], v5 offset:32
  v_fmac_f32 v117, v234, v242
  ds_read_b64_tr_b16 v[148:149], v4 offset:64
  v_fmac_f32 v118, v235, v243
  ds_read_b64_tr_b16 v[150:151], v5 offset:64
  v_fmac_f32 v119, v236, v239
  ds_read_b64_tr_b16 v[160:161], v4 offset:96
  v_fmac_f32 v116, v189, v196
  ds_read_b64_tr_b16 v[162:163], v5 offset:96
  v_fmac_f32 v117, v189, v197
  ds_read_b128 v[164:167], v1 offset:39936
  v_fmac_f32 v118, v190, v198
  v_fmac_f32 v119, v190, v199
  ds_read_b128 v[168:171], v1 offset:40960
  v_fmac_f32 v116, v205, v212
  ds_read_b128 v[172:175], v1 offset:8192
  v_fmac_f32 v117, v205, v213
  ds_read_b128 v[176:179], v1 offset:6144
  v_fmac_f32 v118, v206, v214
  ds_read_b64_tr_b16 v[70:71], v25 offset:0
  v_fmac_f32 v119, v206, v215
  ds_read_b64_tr_b16 v[84:85], v25 offset:32
  v_fmac_f32 v116, v221, v228
  ds_read_b64_tr_b16 v[98:99], v25 offset:64
  v_fmac_f32 v117, v221, v229
  ds_read_b64_tr_b16 v[112:113], v25 offset:96
  v_fmac_f32 v118, v222, v230
  ds_read_b64_tr_b16 v[72:73], v26 offset:0
  v_fmac_f32_e64 v119, v222, v231
  ds_read_b64_tr_b16 v[86:87], v26 offset:32
  v_fmac_f32 v116, v237, v244
  ds_read_b64_tr_b16 v[100:101], v26 offset:64
  v_fmac_f32 v117, v237, v245
  v_fmac_f32 v118, v238, v246
  ds_read_b64_tr_b16 v[114:115], v26 offset:96
  v_fmac_f32 v119, v238, v247
  ds_read_b64_tr_b16 v[62:63], v21 offset:0
  v_add_f32 v116, v116, v117
  ds_read_b64_tr_b16 v[76:77], v21 offset:32
  v_add_f32 v118, v118, v119
  ds_read_b64_tr_b16 v[90:91], v21 offset:64
  v_add_f32 v116, v116, v118
  ds_read_b64_tr_b16 v[104:105], v21 offset:96
  v_mul_f32 v116, s49, v116
  ds_read_b64_tr_b16 v[64:65], v22 offset:0
  v_mul_f32 v116, s50, v116
  ds_read_b64_tr_b16 v[78:79], v22 offset:32
  ds_write_b32 v7, v116
  ds_read_b64_tr_b16 v[92:93], v22 offset:64
  v_add_u32 v7, s48, v7
  ds_read_b64_tr_b16 v[106:107], v22 offset:96
  s_movk_i32 s48, 256
  s_waitcnt lgkmcnt(14)
  v_pk_mul_f16 v120, v60, v67 op_sel:[0,0] op_sel_hi:[0,1]
  v_pk_mul_f16 v121, v60, v67 op_sel:[1,0] op_sel_hi:[1,1]
  v_pk_mul_f16 v122, v60, v68 op_sel:[0,0] op_sel_hi:[0,1]
  v_pk_mul_f16 v123, v60, v68 op_sel:[1,0] op_sel_hi:[1,1]
  v_pk_mul_f16 v132, v74, v81 op_sel:[0,0] op_sel_hi:[0,1]
  v_pk_mul_f16 v133, v74, v81 op_sel:[1,0] op_sel_hi:[1,1]
  v_pk_mul_f16 v134, v74, v82 op_sel:[0,0] op_sel_hi:[0,1]
  v_pk_mul_f16 v135, v74, v82 op_sel:[1,0] op_sel_hi:[1,1]
  v_pk_mul_f16 v144, v88, v95 op_sel:[0,0] op_sel_hi:[0,1]
  v_pk_mul_f16 v145, v88, v95 op_sel:[1,0] op_sel_hi:[1,1]
  v_pk_mul_f16 v146, v88, v96 op_sel:[0,0] op_sel_hi:[0,1]
  v_pk_mul_f16 v147, v88, v96 op_sel:[1,0] op_sel_hi:[1,1]
  v_pk_mul_f16 v156, v102, v109 op_sel:[0,0] op_sel_hi:[0,1]
  v_pk_mul_f16 v157, v102, v109 op_sel:[1,0] op_sel_hi:[1,1]
  v_pk_mul_f16 v158, v102, v110 op_sel:[0,0] op_sel_hi:[0,1]
  v_pk_mul_f16 v159, v102, v110 op_sel:[1,0] op_sel_hi:[1,1]
  s_cmp_lg_u32 s51, 0
  s_cbranch_scc1 L_novm
  s_waitcnt vmcnt(0)
  v_lshl_add_u32 v16, v16, 7, v8
  v_lshl_add_u32 v17, v17, 7, v8
  v_lshl_add_u32 v18, v18, 7, v8
  v_lshl_add_u32 v19, v19, 7, v8
  s_add_u32 m0, s76, 0
  s_mov_b32 exec_hi, 0xffffff
  buffer_load_dwordx4 v16, s[32:35], 0 offen lds
  s_add_u32 m0, s76, 1056
  s_nop 0
  buffer_load_dwordx4 v17, s[32:35], 0 offen lds
  s_add_u32 m0, s76, 2112
  s_mov_b32 exec_hi, 0xffff
  buffer_load_dwordx4 v18, s[32:35], 0 offen lds
  s_add_u32 m0, s76, 3168
  s_nop 0
  buffer_load_dwordx4 v19, s[32:35], 0 offen lds
  s_mov_b32 exec_hi, -1
  buffer_load_dwordx4 v[16:19], v6, s[28:31], s94 offen
  s_add_u32 s94, s94, 416
L_novm:
  v_add_u32 v10, s81, v10
  v_add_u32 v4, s81, v4
  v_add_u32 v5, s81, v5
  s_sub_u32 s76, s76, s81
  s_sub_u32 s81, 0, s81
  s_mov_b32 s51, 0
  s_setprio 1
  v_mfma_f32_16x16x32_bf16 v[184:187], v[164:167], v[124:127], 0
  ds_read_b128 v[180:183], v1 offset:7168
  v_pk_mul_f16 v116, v60, v69 op_sel:[0,0] op_sel_hi:[0,1]
  v_mfma_f32_16x16x32_bf16 v[200:203], v[164:167], v[136:139], 0
  v_pk_mul_f16 v117, v60, v69 op_sel:[1,0] op_sel_hi:[1,1]
  v_mfma_f32_16x16x32_bf16 v[216:219], v[164:167], v[148:151], 0
  v_pk_mul_f16 v118, v60, v70 op_sel:[0,0] op_sel_hi:[0,1]
  v_mfma_f32_16x16x32_bf16 v[232:235], v[164:167], v[160:163], 0
  v_pk_mul_f16 v119, v60, v70 op_sel:[1,0] op_sel_hi:[1,1]
  v_mfma_f32_16x16x32_bf16 v[188:191], v[168:171], v[124:127], 0
  ds_read_b128 v[164:167], v1 offset:5120
  v_pk_mul_f16 v128, v74, v83 op_sel:[0,0] op_sel_hi:[0,1]
  v_mfma_f32_16x16x32_bf16 v[204:207], v[168:171], v[136:139], 0
  v_pk_mul_f16 v129, v74, v83 op_sel:[1,0] op_sel_hi:[1,1]
  v_mfma_f32_16x16x32_bf16 v[220:223], v[168:171], v[148:151], 0
  v_pk_mul_f16 v130, v74, v84 op_sel:[0,0] op_sel_hi:[0,1]
  v_mfma_f32_16x16x32_bf16 v[236:239], v[168:171], v[160:163], 0
  v_pk_mul_f16 v131, v74, v84 op_sel:[1,0] op_sel_hi:[1,1]
  v_mfma_f32_16x16x32_f16 v[192:195], v[172:175], v[120:123], 0
  ds_read_b128 v[168:171], v1 offset:11264
  v_pk_mul_f16 v140, v88, v97 op_sel:[0,0] op_sel_hi:[0,1]
  v_mfma_f32_16x16x32_f16 v[208:211], v[172:175], v[132:135], 0
  v_pk_mul_f16 v141, v88, v97 op_sel:[1,0] op_sel_hi:[1,1]
  v_mfma_f32_16x16x32_f16 v[224:227], v[172:175], v[144:147], 0
  v_pk_mul_f16 v142, v88, v98 op_sel:[0,0] op_sel_hi:[0,1]
  v_mfma_f32_16x16x32_f16 v[240:243], v[172:175], v[156:159], 0
  v_pk_mul_f16 v143, v88, v98 op_sel:[1,0] op_sel_hi:[1,1]
  v_mfma_f32_16x16x32_f16 v[184:187], v[176:179], v[120:123], v[184:187]
  ds_read_b128 v[172:175], v1 offset:9216
  v_pk_mul_f16 v152, v102, v111 op_sel:[0,0] op_sel_hi:[0,1]
  v_mfma_f32_16x16x32_f16 v[200:203], v[176:179], v[132:135], v[200:203]
  v_pk_mul_f16 v153, v102, v111 op_sel:[1,0] op_sel_hi:[1,1]
  v_mfma_f32_16x16x32_f16 v[216:219], v[176:179], v[144:147], v[216:219]
  s_setprio 2
  s_waitcnt lgkmcnt(14)
  v_pk_mul_f16 v154, v102, v112 op_sel:[0,0] op_sel_hi:[0,1]
  v_mfma_f32_16x16x32_f16 v[232:235], v[176:179], v[156:159], v[232:235]
  s_nop 0
  s_waitcnt lgkmcnt(3)
  v_pk_mul_f16 v155, v102, v112 op_sel:[1,0] op_sel_hi:[1,1]
  v_mfma_f32_16x16x32_f16 v[188:191], v[180:183], v[120:123], v[188:191]
  ds_read_b128 v[176:179], v1 offset:10240
  v_pk_mul_f16 v124, v61, v68 op_sel:[0,0] op_sel_hi:[0,1]
  v_mfma_f32_16x16x32_f16 v[204:207], v[180:183], v[132:135], v[204:207]
  v_pk_mul_f16 v125, v61, v68 op_sel:[1,0] op_sel_hi:[1,1]
  v_mfma_f32_16x16x32_f16 v[220:223], v[180:183], v[144:147], v[220:223]
  v_pk_mul_f16 v126, v61, v69 op_sel:[0,0] op_sel_hi:[0,1]
  v_mfma_f32_16x16x32_f16 v[236:239], v[180:183], v[156:159], v[236:239]
  s_nop 0
  s_waitcnt lgkmcnt(3)
  v_pk_mul_f16 v127, v61, v69 op_sel:[1,0] op_sel_hi:[1,1]
  v_mfma_f32_16x16x32_f16 v[196:199], v[164:167], v[120:123], 0
  ds_read_b128 v[180:183], v1 offset:14336
  v_pk_mul_f16 v136, v75, v82 op_sel:[0,0] op_sel_hi:[0,1]
  v_mfma_f32_16x16x32_f16 v[212:215], v[164:167], v[132:135], 0
  v_pk_mul_f16 v120, v60, v71 op_sel:[0,0] op_sel_hi:[0,1]
  v_mfma_f32_16x16x32_f16 v[228:231], v[164:167], v[144:147], 0
  v_pk_mul_f16 v121, v60, v71 op_sel:[1,0] op_sel_hi:[1,1]
  v_mfma_f32_16x16x32_f16 v[244:247], v[164:167], v[156:159], 0
  s_waitcnt lgkmcnt(3)
  v_pk_mul_f16 v122, v60, v66 op_sel:[0,1] op_sel_hi:[0,0]
  v_mfma_f32_16x16x32_f16 v[192:195], v[168:171], v[116:119], v[192:195]
  ds_read_b128 v[164:167], v1 offset:12288
  v_pk_mul_f16 v123, v60, v72 op_sel:[0,0] op_sel_hi:[1,0]
  v_mfma_f32_16x16x32_f16 v[208:211], v[168:171], v[128:131], v[208:211]
  v_pk_mul_f16 v132, v74, v85 op_sel:[0,0] op_sel_hi:[0,1]
  v_mfma_f32_16x16x32_f16 v[224:227], v[168:171], v[140:143], v[224:227]
  s_nop 0
  v_pk_mul_f16 v133, v74, v85 op_sel:[1,0] op_sel_hi:[1,1]
  v_mfma_f32_16x16x32_f16 v[240:243], v[168:171], v[152:155], v[240:243]
  s_waitcnt lgkmcnt(3)
  v_pk_mul_f16 v134, v74, v80 op_sel:[0,1] op_sel_hi:[0,0]
  v_mfma_f32_16x16x32_f16 v[184:187], v[172:175], v[116:119], v[184:187]
  ds_read_b128 v[168:171], v1 offset:13312
  v_pk_mul_f16 v135, v74, v86 op_sel:[0,0] op_sel_hi:[1,0]
  v_mfma_f32_16x16x32_f16 v[200:203], v[172:175], v[128:131], v[200:203]
  s_nop 0
  v_pk_mul_f16 v144, v88, v99 op_sel:[0,0] op_sel_hi:[0,1]
  v_mfma_f32_16x16x32_f16 v[216:219], v[172:175], v[140:143], v[216:219]
  v_pk_mul_f16 v145, v88, v99 op_sel:[1,0] op_sel_hi:[1,1]
  v_mfma_f32_16x16x32_f16 v[232:235], v[172:175], v[152:155], v[232:235]
  s_nop 0
  s_waitcnt lgkmcnt(3)
  v_pk_mul_f16 v146, v88, v94 op_sel:[0,1] op_sel_hi:[0,0]
  v_mfma_f32_16x16x32_f16 v[188:191], v[176:179], v[116:119], v[188:191]
  ds_read_b128 v[172:175], v1 offset:0
  v_pk_mul_f16 v147, v88, v100 op_sel:[0,0] op_sel_hi:[1,0]
  v_mfma_f32_16x16x32_f16 v[204:207], v[176:179], v[128:131], v[204:207]
  v_pk_mul_f16 v156, v102, v113 op_sel:[0,0] op_sel_hi:[0,1]
  v_mfma_f32_16x16x32_f16 v[220:223], v[176:179], v[140:143], v[220:223]
  v_pk_mul_f16 v157, v102, v113 op_sel:[1,0] op_sel_hi:[1,1]
  v_mfma_f32_16x16x32_f16 v[236:239], v[176:179], v[152:155], v[236:239]
  s_nop 0
  s_waitcnt lgkmcnt(3)
  v_pk_mul_f16 v158, v102, v108 op_sel:[0,1] op_sel_hi:[0,0]
  v_mfma_f32_16x16x32_f16 v[192:195], v[180:183], v[120:123], v[192:195]
  ds_read_b128 v[176:179], v1 offset:17408
  v_pk_mul_f16 v159, v102, v114 op_sel:[0,0] op_sel_hi:[1,0]
  v_mfma_f32_16x16x32_f16 v[208:211], v[180:183], v[132:135], v[208:211]
  v_pk_mul_f16 v137, v75, v82 op_sel:[1,0] op_sel_hi:[1,1]
  v_mfma_f32_16x16x32_f16 v[224:227], v[180:183], v[144:147], v[224:227]
  v_pk_mul_f16 v138, v75, v83 op_sel:[0,0] op_sel_hi:[0,1]
  v_mfma_f32_16x16x32_f16 v[240:243], v[180:183], v[156:159], v[240:243]
  s_waitcnt lgkmcnt(3)
  v_pk_mul_f16 v139, v75, v83 op_sel:[1,0] op_sel_hi:[1,1]
  v_mfma_f32_16x16x32_f16 v[184:187], v[164:167], v[120:123], v[184:187]
  ds_read_b128 v[180:183], v1 offset:15360
  v_pk_mul_f16 v148, v89, v96 op_sel:[0,0] op_sel_hi:[0,1]
  v_mfma_f32_16x16x32_f16 v[200:203], v[164:167], v[132:135], v[200:203]
  v_pk_mul_f16 v149, v89, v96 op_sel:[1,0] op_sel_hi:[1,1]
  v_mfma_f32_16x16x32_f16 v[216:219], v[164:167], v[144:147], v[216:219]
  s_nop 0
  v_pk_mul_f16 v150, v89, v97 op_sel:[0,0] op_sel_hi:[0,1]
  v_mfma_f32_16x16x32_f16 v[232:235], v[164:167], v[156:159], v[232:235]
  s_waitcnt lgkmcnt(3)
  v_pk_mul_f16 v151, v89, v97 op_sel:[1,0] op_sel_hi:[1,1]
  v_mfma_f32_16x16x32_f16 v[188:191], v[168:171], v[120:123], v[188:191]
  ds_read_b128 v[164:167], v1 offset:16384
  v_pk_mul_f16 v160, v103, v110 op_sel:[0,0] op_sel_hi:[0,1]
  v_mfma_f32_16x16x32_f16 v[204:207], v[168:171], v[132:135], v[204:207]
  s_nop 0
  v_pk_mul_f16 v161, v103, v110 op_sel:[1,0] op_sel_hi:[1,1]
  v_mfma_f32_16x16x32_f16 v[220:223], v[168:171], v[144:147], v[220:223]
  v_pk_mul_f16 v162, v103, v111 op_sel:[0,0] op_sel_hi:[0,1]
  v_mfma_f32_16x16x32_f16 v[236:239], v[168:171], v[156:159], v[236:239]
  s_waitcnt lgkmcnt(3)
  v_pk_mul_f16 v163, v103, v111 op_sel:[1,0] op_sel_hi:[1,1]
  v_smfmac_f32_16x16x64_f16 v[196:199], v[172:175], v[116:123], v9
  s_nop 0
  ds_read_b128 v[168:171], v1 offset:20480
  v_smfmac_f32_16x16x64_f16 v[212:215], v[172:175], v[128:135], v9
  v_pk_mul_f16 v120, v61, v70 op_sel:[0,0] op_sel_hi:[0,1]
  v_smfmac_f32_16x16x64_f16 v[228:231], v[172:175], v[140:147], v9
  v_pk_mul_f16 v121, v61, v70 op_sel:[1,0] op_sel_hi:[1,1]
  v_smfmac_f32_16x16x64_f16 v[244:247], v[172:175], v[152:159], v9
  s_nop 0
  s_waitcnt lgkmcnt(3)
  v_pk_mul_f16 v122, v61, v71 op_sel:[0,0] op_sel_hi:[0,1]
  v_mfma_f32_16x16x32_f16 v[192:195], v[176:179], v[124:127], v[192:195]
  ds_read_b128 v[172:175], v1 offset:18432
  v_pk_mul_f16 v123, v61, v71 op_sel:[1,0] op_sel_hi:[1,1]
  v_mfma_f32_16x16x32_f16 v[208:211], v[176:179], v[136:139], v[208:211]
  v_pk_mul_f16 v132, v75, v84 op_sel:[0,0] op_sel_hi:[0,1]
  v_mfma_f32_16x16x32_f16 v[224:227], v[176:179], v[148:151], v[224:227]
  v_pk_mul_f16 v133, v75, v84 op_sel:[1,0] op_sel_hi:[1,1]
  v_mfma_f32_16x16x32_f16 v[240:243], v[176:179], v[160:163], v[240:243]
  s_nop 0
  s_waitcnt lgkmcnt(3)
  v_pk_mul_f16 v134, v75, v85 op_sel:[0,0] op_sel_hi:[0,1]
  v_mfma_f32_16x16x32_f16 v[184:187], v[180:183], v[124:127], v[184:187]
  ds_read_b128 v[176:179], v1 offset:19456
  v_pk_mul_f16 v135, v75, v85 op_sel:[1,0] op_sel_hi:[1,1]
  v_mfma_f32_16x16x32_f16 v[200:203], v[180:183], v[136:139], v[200:203]
  v_pk_mul_f16 v144, v89, v98 op_sel:[0,0] op_sel_hi:[0,1]
  v_mfma_f32_16x16x32_f16 v[216:219], v[180:183], v[148:151], v[216:219]
  v_pk_mul_f16 v145, v89, v98 op_sel:[1,0] op_sel_hi:[1,1]
  v_mfma_f32_16x16x32_f16 v[232:235], v[180:183], v[160:163], v[232:235]
  s_waitcnt lgkmcnt(3)
  v_pk_mul_f16 v146, v89, v99 op_sel:[0,0] op_sel_hi:[0,1]
  v_mfma_f32_16x16x32_f16 v[188:191], v[164:167], v[124:127], v[188:191]
  ds_read_b128 v[180:183], v1 offset:1024
  v_pk_mul_f16 v147, v89, v99 op_sel:[1,0] op_sel_hi:[1,1]
  v_mfma_f32_16x16x32_f16 v[204:207], v[164:167], v[136:139], v[204:207]
  s_waitcnt vmcnt(1)
  ds_read_u16_d16_hi v32, v10 offset:0
  v_pk_mul_f16 v156, v103, v112 op_sel:[0,0] op_sel_hi:[0,1]
  v_mfma_f32_16x16x32_f16 v[220:223], v[164:167], v[148:151], v[220:223]
  ds_read_u16_d16_hi v33, v10 offset:2
  v_pk_mul_f16 v157, v103, v112 op_sel:[1,0] op_sel_hi:[1,1]
  v_mfma_f32_16x16x32_f16 v[236:239], v[164:167], v[160:163], v[236:239]
  s_nop 0
  s_waitcnt lgkmcnt(5)
  v_pk_mul_f16 v158, v103, v113 op_sel:[0,0] op_sel_hi:[0,1]
  v_mfma_f32_16x16x32_f16 v[192:195], v[168:171], v[120:123], v[192:195]
  ds_read_b128 v[164:167], v1 offset:23552
  v_pk_mul_f16 v159, v103, v113 op_sel:[1,0] op_sel_hi:[1,1]
  v_mfma_f32_16x16x32_f16 v[208:211], v[168:171], v[132:135], v[208:211]
  ds_read_u16_d16_hi v34, v10 offset:2112
  v_pk_mul_f16 v116, v61, v67 op_sel:[0,1] op_sel_hi:[0,0]
  v_mfma_f32_16x16x32_f16 v[224:227], v[168:171], v[144:147], v[224:227]
  ds_read_u16_d16_hi v35, v10 offset:2114
  v_pk_mul_f16 v117, v61, v72 op_sel:[0,0] op_sel_hi:[1,0]
  v_mfma_f32_16x16x32_f16 v[240:243], v[168:171], v[156:159], v[240:243]
  s_nop 0
  s_waitcnt lgkmcnt(7)
  v_pk_mul_f16 v118, v62, v69 op_sel:[0,0] op_sel_hi:[0,1]
  v_mfma_f32_16x16x32_f16 v[184:187], v[172:175], v[120:123], v[184:187]
  ds_read_b128 v[168:171], v1 offset:21504
  v_pk_mul_f16 v119, v62, v69 op_sel:[1,0] op_sel_hi:[1,1]
  v_mfma_f32_16x16x32_f16 v[200:203], v[172:175], v[132:135], v[200:203]
  ds_read_b64_tr_b16 v[60:61], v27 offset:0
  v_pk_mul_f16 v128, v75, v81 op_sel:[0,1] op_sel_hi:[0,0]
  v_mfma_f32_16x16x32_f16 v[216:219], v[172:175], v[144:147], v[216:219]
  ds_read_u16_d16_hi v36, v10 offset:128
  v_pk_mul_f16 v129, v75, v86 op_sel:[0,0] op_sel_hi:[1,0]
  v_mfma_f32_16x16x32_f16 v[232:235], v[172:175], v[156:159], v[232:235]
  s_waitcnt lgkmcnt(9)
  v_pk_mul_f16 v130, v76, v83 op_sel:[0,0] op_sel_hi:[0,1]
  v_pk_mul_f16 v131, v76, v83 op_sel:[1,0] op_sel_hi:[1,1]
  v_mfma_f32_16x16x32_f16 v[188:191], v[176:179], v[120:123], v[188:191]
  ds_read_b128 v[172:175], v1 offset:22528
  v_pk_mul_f16 v140, v89, v95 op_sel:[0,1] op_sel_hi:[0,0]
  v_mfma_f32_16x16x32_f16 v[204:207], v[176:179], v[132:135], v[204:207]
  ds_read_b64_tr_b16 v[74:75], v27 offset:32
  v_pk_mul_f16 v141, v89, v100 op_sel:[0,0] op_sel_hi:[1,0]
  v_mfma_f32_16x16x32_f16 v[220:223], v[176:179], v[144:147], v[220:223]
  ds_read_b64_tr_b16 v[88:89], v27 offset:64
  v_pk_mul_f16 v142, v90, v97 op_sel:[0,0] op_sel_hi:[0,1]
  v_mfma_f32_16x16x32_f16 v[236:239], v[176:179], v[156:159], v[236:239]
  s_waitcnt lgkmcnt(11)
  v_pk_mul_f16 v143, v90, v97 op_sel:[1,0] op_sel_hi:[1,1]
  v_pk_mul_f16 v152, v103, v109 op_sel:[0,1] op_sel_hi:[0,0]
  v_smfmac_f32_16x16x64_f16 v[196:199], v[180:183], v[120:127], v9
  ds_read_b128 v[176:179], v1 offset:26624
  v_pk_mul_f16 v153, v103, v114 op_sel:[0,0] op_sel_hi:[1,0]
  v_smfmac_f32_16x16x64_f16 v[212:215], v[180:183], v[132:139], v9
  ds_read_b64_tr_b16 v[102:103], v27 offset:96
  v_pk_mul_f16 v154, v104, v111 op_sel:[0,0] op_sel_hi:[0,1]
  v_smfmac_f32_16x16x64_f16 v[228:231], v[180:183], v[144:151], v9
  ds_read_u16_d16_hi v37, v10 offset:130
  v_pk_mul_f16 v155, v104, v111 op_sel:[1,0] op_sel_hi:[1,1]
  v_smfmac_f32_16x16x64_f16 v[244:247], v[180:183], v[156:163], v9
  s_nop 0
  s_waitcnt lgkmcnt(11)
  v_pk_mul_f16 v120, v62, v70 op_sel:[0,0] op_sel_hi:[0,1]
  v_mfma_f32_16x16x32_f16 v[192:195], v[164:167], v[116:119], v[192:195]
  ds_read_b128 v[180:183], v1 offset:24576
  v_pk_mul_f16 v121, v62, v70 op_sel:[1,0] op_sel_hi:[1,1]
  v_mfma_f32_16x16x32_f16 v[208:211], v[164:167], v[128:131], v[208:211]
  ds_read_u16_d16_hi v38, v10 offset:2240
  v_pk_mul_f16 v122, v62, v71 op_sel:[0,0] op_sel_hi:[0,1]
  v_mfma_f32_16x16x32_f16 v[224:227], v[164:167], v[140:143], v[224:227]
  ds_read_u16_d16_hi v39, v10 offset:2242
  v_pk_mul_f16 v123, v62, v71 op_sel:[1,0] op_sel_hi:[1,1]
  v_mfma_f32_16x16x32_f16 v[240:243], v[164:167], v[152:155], v[240:243]
  s_waitcnt lgkmcnt(11)
  v_pk_mul_f16 v132, v76, v84 op_sel:[0,0] op_sel_hi:[0,1]
  v_max3_f32 v58, |v32|, |v33|, 0
  v_mfma_f32_16x16x32_f16 v[184:187], v[168:171], v[116:119], v[184:187]
  ds_read_b128 v[164:167], v1 offset:25600
  v_pk_mul_f16 v133, v76, v84 op_sel:[1,0] op_sel_hi:[1,1]
  v_mfma_f32_16x16x32_f16 v[200:203], v[168:171], v[128:131], v[200:203]
  ds_read_u16_d16_hi v40, v10 offset:256
  v_pk_mul_f16 v134, v76, v85 op_sel:[0,0] op_sel_hi:[0,1]
  v_mfma_f32_16x16x32_f16 v[216:219], v[168:171], v[140:143], v[216:219]
  ds_read_u16_d16_hi v41, v10 offset:258
  v_pk_mul_f16 v135, v76, v85 op_sel:[1,0] op_sel_hi:[1,1]
  v_mfma_f32_16x16x32_f16 v[232:235], v[168:171], v[152:155], v[232:235]
  s_waitcnt lgkmcnt(11)
  v_pk_mul_f16 v144, v90, v98 op_sel:[0,0] op_sel_hi:[0,1]
  v_max3_f32 v58, |v34|, |v35|, v58
  v_mfma_f32_16x16x32_f16 v[188:191], v[172:175], v[116:119], v[188:191]
  ds_read_b128 v[168:171], v1 offset:2048
  v_pk_mul_f16 v145, v90, v98 op_sel:[1,0] op_sel_hi:[1,1]
  v_mfma_f32_16x16x32_f16 v[204:207], v[172:175], v[128:131], v[204:207]
  ds_read_u16_d16_hi v42, v10 offset:2368
  v_pk_mul_f16 v146, v90, v99 op_sel:[0,0] op_sel_hi:[0,1]
  v_mfma_f32_16x16x32_f16 v[220:223], v[172:175], v[140:143], v[220:223]
  ds_read_u16_d16_hi v43, v10 offset:2370
  v_pk_mul_f16 v147, v90, v99 op_sel:[1,0] op_sel_hi:[1,1]
  v_mfma_f32_16x16x32_f16 v[236:239], v[172:175], v[152:155], v[236:239]
  s_nop 0
  s_waitcnt lgkmcnt(11)
  v_pk_mul_f16 v156, v104, v112 op_sel:[0,0] op_sel_hi:[0,1]
  v_mfma_f32_16x16x32_f16 v[192:195], v[176:179], v[120:123], v[192:195]
  ds_read_b128 v[172:175], v1 offset:29696
  v_pk_mul_f16 v157, v104, v112 op_sel:[1,0] op_sel_hi:[1,1]
  v_mfma_f32_16x16x32_f16 v[208:211], v[176:179], v[132:135], v[208:211]
  ds_read_u16_d16_hi v44, v10 offset:384
  v_pk_mul_f16 v158, v104, v113 op_sel:[0,0] op_sel_hi:[0,1]
  v_mfma_f32_16x16x32_f16 v[224:227], v[176:179], v[144:147], v[224:227]
  ds_read_u16_d16_hi v45, v10 offset:386
  v_pk_mul_f16 v159, v104, v113 op_sel:[1,0] op_sel_hi:[1,1]
  s_nop 1
  v_mfma_f32_16x16x32_f16 v[240:243], v[176:179], v[156:159], v[240:243]
  s_waitcnt lgkmcnt(11)
  v_pk_mul_f16 v124, v62, v68 op_sel:[0,1] op_sel_hi:[0,0]
  v_mfma_f32_16x16x32_f16 v[184:187], v[180:183], v[120:123], v[184:187]
  ds_read_b128 v[176:179], v1 offset:27648
  v_pk_mul_f16 v125, v62, v72 op_sel:[0,0] op_sel_hi:[1,0]
  v_mfma_f32_16x16x32_f16 v[200:203], v[180:183], v[132:135], v[200:203]
  ds_read_u16_d16_hi v46, v10 offset:2496
  v_pk_mul_f16 v126, v63, v70 op_sel:[0,0] op_sel_hi:[0,1]
  v_mfma_f32_16x16x32_f16 v[216:219], v[180:183], v[144:147], v[216:219]
  ds_read_u16_d16_hi v47, v10 offset:2498
  v_pk_mul_f16 v127, v63, v70 op_sel:[1,0] op_sel_hi:[1,1]
  v_mfma_f32_16x16x32_f16 v[232:235], v[180:183], v[156:159], v[232:235]
  s_waitcnt lgkmcnt(11)
  v_pk_mul_f16 v136, v76, v82 op_sel:[0,1] op_sel_hi:[0,0]
  v_pk_mul_f16 v137, v76, v86 op_sel:[0,0] op_sel_hi:[1,0]
  v_mfma_f32_16x16x32_f16 v[188:191], v[164:167], v[120:123], v[188:191]
  ds_read_b128 v[180:183], v1 offset:28672
  v_pk_mul_f16 v138, v77, v84 op_sel:[0,0] op_sel_hi:[0,1]
  v_mfma_f32_16x16x32_f16 v[204:207], v[164:167], v[132:135], v[204:207]
  ds_read_u16_d16_hi v48, v10 offset:512
  v_pk_mul_f16 v139, v77, v84 op_sel:[1,0] op_sel_hi:[1,1]
  v_mfma_f32_16x16x32_f16 v[220:223], v[164:167], v[144:147], v[220:223]
  ds_read_u16_d16_hi v49, v10 offset:514
  v_pk_mul_f16 v148, v90, v96 op_sel:[0,1] op_sel_hi:[0,0]
  v_mfma_f32_16x16x32_f16 v[236:239], v[164:167], v[156:159], v[236:239]
  s_waitcnt lgkmcnt(11)
  v_pk_mul_f16 v149, v90, v100 op_sel:[0,0] op_sel_hi:[1,0]
  v_pk_mul_f16 v150, v91, v98 op_sel:[0,0] op_sel_hi:[0,1]
  v_smfmac_f32_16x16x64_f16 v[196:199], v[168:171], v[116:123], v9
  ds_read_b128 v[164:167], v1 offset:32768
  v_pk_mul_f16 v151, v91, v98 op_sel:[1,0] op_sel_hi:[1,1]
  v_smfmac_f32_16x16x64_f16 v[212:215], v[168:171], v[128:135], v9
  ds_read_u16_d16_hi v50, v10 offset:2624
  v_pk_mul_f16 v160, v104, v110 op_sel:[0,1] op_sel_hi:[0,0]
  v_smfmac_f32_16x16x64_f16 v[228:231], v[168:171], v[140:147], v9
  ds_read_u16_d16_hi v51, v10 offset:2626
  v_pk_mul_f16 v161, v104, v114 op_sel:[0,0] op_sel_hi:[1,0]
  v_smfmac_f32_16x16x64_f16 v[244:247], v[168:171], v[152:159], v9
  s_nop 0
  s_waitcnt lgkmcnt(11)
  v_pk_mul_f16 v162, v105, v112 op_sel:[0,0] op_sel_hi:[0,1]
  v_mfma_f32_16x16x32_f16 v[192:195], v[172:175], v[124:127], v[192:195]
  ds_read_b128 v[168:171], v1 offset:30720
  v_pk_mul_f16 v163, v105, v112 op_sel:[1,0] op_sel_hi:[1,1]
  v_mfma_f32_16x16x32_f16 v[208:211], v[172:175], v[136:139], v[208:211]
  ds_read_u16_d16_hi v52, v10 offset:640
  v_pk_mul_f16 v120, v63, v71 op_sel:[0,0] op_sel_hi:[0,1]
  v_mfma_f32_16x16x32_f16 v[224:227], v[172:175], v[148:151], v[224:227]
  ds_read_u16_d16_hi v53, v10 offset:642
  v_pk_mul_f16 v121, v63, v71 op_sel:[1,0] op_sel_hi:[1,1]
  v_mfma_f32_16x16x32_f16 v[240:243], v[172:175], v[160:163], v[240:243]
  s_waitcnt lgkmcnt(11)
  v_pk_mul_f16 v122, v63, v69 op_sel:[0,1] op_sel_hi:[1,1]
  v_pk_mul_f16 v123, v63, v72 op_sel:[0,0] op_sel_hi:[1,0]
  v_mfma_f32_16x16x32_f16 v[184:187], v[176:179], v[124:127], v[184:187]
  ds_read_b128 v[172:175], v1 offset:31744
  v_pk_mul_f16 v132, v77, v85 op_sel:[0,0] op_sel_hi:[0,1]
  v_mfma_f32_16x16x32_f16 v[200:203], v[176:179], v[136:139], v[200:203]
  ds_read_u16_d16_hi v54, v10 offset:2752
  v_pk_mul_f16 v133, v77, v85 op_sel:[1,0] op_sel_hi:[1,1]
  v_mfma_f32_16x16x32_f16 v[216:219], v[176:179], v[148:151], v[216:219]
  ds_read_u16_d16_hi v55, v10 offset:2754
  v_pk_mul_f16 v134, v77, v83 op_sel:[0,1] op_sel_hi:[1,1]
  v_mfma_f32_16x16x32_f16 v[232:235], v[176:179], v[160:163], v[232:235]
  s_waitcnt lgkmcnt(11)
  v_pk_mul_f16 v135, v77, v86 op_sel:[0,0] op_sel_hi:[1,0]
  v_pk_mul_f16 v144, v91, v99 op_sel:[0,0] op_sel_hi:[0,1]
  v_mfma_f32_16x16x32_f16 v[188:191], v[180:183], v[124:127], v[188:191]
  ds_read_b128 v[176:179], v1 offset:3072
  v_pk_mul_f16 v145, v91, v99 op_sel:[1,0] op_sel_hi:[1,1]
  v_mfma_f32_16x16x32_f16 v[204:207], v[180:183], v[136:139], v[204:207]
  ds_read_u16_d16_hi v56, v10 offset:768
  v_pk_mul_f16 v146, v91, v97 op_sel:[0,1] op_sel_hi:[1,1]
  v_mfma_f32_16x16x32_f16 v[220:223], v[180:183], v[148:151], v[220:223]
  ds_read_u16_d16_hi v57, v10 offset:770
  v_pk_mul_f16 v147, v91, v100 op_sel:[0,0] op_sel_hi:[1,0]
  v_mfma_f32_16x16x32_f16 v[236:239], v[180:183], v[160:163], v[236:239]
  s_waitcnt lgkmcnt(11)
  v_pk_mul_f16 v156, v105, v113 op_sel:[0,0] op_sel_hi:[0,1]
  v_max3_f32 v58, |v36|, |v37|, v58
  v_mfma_f32_16x16x32_f16 v[192:195], v[164:167], v[120:123], v[192:195]
  ds_read_b128 v[180:183], v1 offset:35840
  v_pk_mul_f16 v157, v105, v113 op_sel:[1,0] op_sel_hi:[1,1]
  v_mfma_f32_16x16x32_f16 v[208:211], v[164:167], v[132:135], v[208:211]
  s_nop 0
  v_pk_mul_f16 v158, v105, v111 op_sel:[0,1] op_sel_hi:[1,1]
  v_max3_f32 v58, |v38|, |v39|, v58
  v_mfma_f32_16x16x32_f16 v[224:227], v[164:167], v[144:147], v[224:227]
  v_pk_mul_f16 v159, v105, v114 op_sel:[0,0] op_sel_hi:[1,0]
  v_max3_f32 v58, |v40|, |v41|, v58
  s_nop 0
  v_mfma_f32_16x16x32_f16 v[240:243], v[164:167], v[156:159], v[240:243]
  s_waitcnt lgkmcnt(9)
  v_pk_mul_f16 v116, v64, v71 op_sel:[0,0] op_sel_hi:[0,1]
  v_mfma_f32_16x16x32_f16 v[184:187], v[168:171], v[120:123], v[184:187]
  ds_read_b128 v[164:167], v1 offset:33792
  v_pk_mul_f16 v117, v64, v71 op_sel:[1,0] op_sel_hi:[1,1]
  v_mfma_f32_16x16x32_f16 v[200:203], v[168:171], v[132:135], v[200:203]
  v_pk_mul_f16 v118, v64, v70 op_sel:[0,1] op_sel_hi:[1,1]
  v_max3_f32 v58, |v42|, |v43|, v58
  v_mfma_f32_16x16x32_f16 v[216:219], v[168:171], v[144:147], v[216:219]
  v_pk_mul_f16 v119, v64, v72 op_sel:[0,0] op_sel_hi:[1,0]
  v_pk_mul_f16 v128, v78, v85 op_sel:[0,0] op_sel_hi:[0,1]
  v_mfma_f32_16x16x32_f16 v[232:235], v[168:171], v[156:159], v[232:235]
  s_waitcnt lgkmcnt(7)
  v_pk_mul_f16 v129, v78, v85 op_sel:[1,0] op_sel_hi:[1,1]
  v_pk_mul_f16 v130, v78, v84 op_sel:[0,1] op_sel_hi:[1,1]
  v_mfma_f32_16x16x32_f16 v[188:191], v[172:175], v[120:123], v[188:191]
  ds_read_b128 v[168:171], v1 offset:34816
  v_pk_mul_f16 v131, v78, v86 op_sel:[0,0] op_sel_hi:[1,0]
  v_mfma_f32_16x16x32_f16 v[204:207], v[172:175], v[132:135], v[204:207]
  v_pk_mul_f16 v140, v92, v99 op_sel:[0,0] op_sel_hi:[0,1]
  v_pk_mul_f16 v141, v92, v99 op_sel:[1,0] op_sel_hi:[1,1]
  v_mfma_f32_16x16x32_f16 v[220:223], v[172:175], v[144:147], v[220:223]
  v_pk_mul_f16 v142, v92, v98 op_sel:[0,1] op_sel_hi:[1,1]
  v_pk_mul_f16 v143, v92, v100 op_sel:[0,0] op_sel_hi:[1,0]
  v_mfma_f32_16x16x32_f16 v[236:239], v[172:175], v[156:159], v[236:239]
  s_waitcnt lgkmcnt(5)
  v_pk_mul_f16 v152, v106, v113 op_sel:[0,0] op_sel_hi:[0,1]
  v_smfmac_f32_16x16x64_f16 v[196:199], v[176:179], v[120:127], v9
  ds_read_b128 v[172:175], v1 offset:38912
  v_pk_mul_f16 v153, v106, v113 op_sel:[1,0] op_sel_hi:[1,1]
  v_smfmac_f32_16x16x64_f16 v[212:215], v[176:179], v[132:139], v9
  v_pk_mul_f16 v154, v106, v112 op_sel:[0,1] op_sel_hi:[1,1]
  v_smfmac_f32_16x16x64_f16 v[228:231], v[176:179], v[144:151], v9
  v_pk_mul_f16 v155, v106, v114 op_sel:[0,0] op_sel_hi:[1,0]
  v_smfmac_f32_16x16x64_f16 v[244:247], v[176:179], v[156:163], v9
  s_waitcnt lgkmcnt(3)
  v_pk_mul_f16 v120, v65, v71 op_sel:[0,1] op_sel_hi:[1,1]
  v_mfma_f32_16x16x32_f16 v[192:195], v[180:183], v[116:119], v[192:195]
  ds_read_b128 v[176:179], v1 offset:36864
  v_pk_mul_f16 v121, v65, v72 op_sel:[0,0] op_sel_hi:[1,0]
  v_mfma_f32_16x16x32_f16 v[208:211], v[180:183], v[128:131], v[208:211]
  s_nop 0
  v_pk_mul_f16 v122, v72, v72 op_sel:[0,0] op_sel_hi:[1,1]
  v_max3_f32 v58, |v44|, |v45|, v58
  v_mfma_f32_16x16x32_f16 v[224:227], v[180:183], v[140:143], v[224:227]
  v_pk_mul_f16 v123, v60, v61 op_sel:[0,0] op_sel_hi:[1,1]
  v_max3_f32 v58, |v46|, |v47|, v58
  v_mfma_f32_16x16x32_f16 v[240:243], v[180:183], v[152:155], v[240:243]
  s_nop 0
  s_waitcnt lgkmcnt(3)
  v_pk_mul_f16 v132, v79, v85 op_sel:[0,1] op_sel_hi:[1,1]
  v_mfma_f32_16x16x32_f16 v[184:187], v[164:167], v[116:119], v[184:187]
  ds_read_b128 v[180:183], v1 offset:37888
  v_pk_mul_f16 v133, v79, v86 op_sel:[0,0] op_sel_hi:[1,0]
  v_mfma_f32_16x16x32_f16 v[200:203], v[164:167], v[128:131], v[200:203]
  v_pk_mul_f16 v134, v86, v86 op_sel:[0,0] op_sel_hi:[1,1]
  v_max3_f32 v58, |v48|, |v49|, v58
  v_mfma_f32_16x16x32_f16 v[216:219], v[164:167], v[140:143], v[216:219]
  v_pk_mul_f16 v135, v74, v75 op_sel:[0,0] op_sel_hi:[1,1]
  v_max3_f32 v58, |v50|, |v51|, v58
  v_mfma_f32_16x16x32_f16 v[232:235], v[164:167], v[152:155], v[232:235]
  s_waitcnt lgkmcnt(3)
  v_pk_mul_f16 v144, v93, v99 op_sel:[0,1] op_sel_hi:[1,1]
  v_mfma_f32_16x16x32_f16 v[188:191], v[168:171], v[116:119], v[188:191]
  ds_read_b128 v[164:167], v1 offset:4096
  v_pk_mul_f16 v145, v93, v100 op_sel:[0,0] op_sel_hi:[1,0]
  v_mfma_f32_16x16x32_f16 v[204:207], v[168:171], v[128:131], v[204:207]
  s_nop 0
  v_pk_mul_f16 v146, v100, v100 op_sel:[0,0] op_sel_hi:[1,1]
  v_max3_f32 v58, |v52|, |v53|, v58
  v_mfma_f32_16x16x32_f16 v[220:223], v[168:171], v[140:143], v[220:223]
  v_pk_mul_f16 v147, v88, v89 op_sel:[0,0] op_sel_hi:[1,1]
  v_max3_f32 v58, |v54|, |v55|, v58
  v_mfma_f32_16x16x32_f16 v[236:239], v[168:171], v[152:155], v[236:239]
  s_waitcnt lgkmcnt(3)
  v_pk_mul_f16 v156, v107, v113 op_sel:[0,1] op_sel_hi:[1,1]
  v_mfma_f32_16x16x32_f16 v[192:195], v[172:175], v[120:123], v[192:195]
  s_nop 0
  v_pk_mul_f16 v157, v107, v114 op_sel:[0,0] op_sel_hi:[1,0]
  v_max3_f32 v58, |v56|, |v57|, v58
  v_mfma_f32_16x16x32_f16 v[208:211], v[172:175], v[132:135], v[208:211]
  v_pk_mul_f16 v158, v114, v114 op_sel:[0,0] op_sel_hi:[1,1]
  v_cvt_pk_f16_f32 v62, v32, v33
  v_mfma_f32_16x16x32_f16 v[224:227], v[172:175], v[144:147], v[224:227]
  v_pk_mul_f16 v159, v102, v103 op_sel:[0,0] op_sel_hi:[1,1]
  s_nop 1
  v_mfma_f32_16x16x32_f16 v[240:243], v[172:175], v[156:159], v[240:243]
  s_waitcnt lgkmcnt(2)
  v_cvt_pk_f16_f32 v76, v34, v35
  v_cvt_pk_f16_f32 v90, v36, v37
  v_mfma_f32_16x16x32_f16 v[184:187], v[176:179], v[120:123], v[184:187]
  ds_write_b32 v11, v62 offset:0
  v_mfma_f32_16x16x32_f16 v[200:203], v[176:179], v[132:135], v[200:203]
  ds_write_b32 v11, v76 offset:160
  v_mfma_f32_16x16x32_f16 v[216:219], v[176:179], v[144:147], v[216:219]
  ds_write_b32 v11, v90 offset:320
  v_mfma_f32_16x16x32_f16 v[232:235], v[176:179], v[156:159], v[232:235]
  s_waitcnt lgkmcnt(4)
  v_cvt_pk_f16_f32 v104, v38, v39
  v_cvt_pk_f16_f32 v63, v40, v41
  v_mfma_f32_16x16x32_f16 v[188:191], v[180:183], v[120:123], v[188:191]
  ds_write_b32 v11, v104 offset:480
  v_mfma_f32_16x16x32_f16 v[204:207], v[180:183], v[132:135], v[204:207]
  ds_write_b32 v11, v63 offset:640
  v_mfma_f32_16x16x32_f16 v[220:223], v[180:183], v[144:147], v[220:223]
  v_cvt_pk_f16_f32 v77, v42, v43
  v_cvt_pk_f16_f32 v91, v44, v45
  v_mfma_f32_16x16x32_f16 v[236:239], v[180:183], v[156:159], v[236:239]
  s_waitcnt lgkmcnt(5)
  v_cvt_pk_f16_f32 v105, v46, v47
  v_cvt_pk_f16_f32 v66, v48, v49
  v_smfmac_f32_16x16x64_f16 v[196:199], v[164:167], v[116:123], v9
  ds_write_b32 v11, v77 offset:800
  v_smfmac_f32_16x16x64_f16 v[212:215], v[164:167], v[128:135], v9
  ds_write_b32 v11, v91 offset:960
  v_smfmac_f32_16x16x64_f16 v[228:231], v[164:167], v[140:147], v9
  ds_write_b32 v11, v105 offset:1120
  v_smfmac_f32_16x16x64_f16 v[244:247], v[164:167], v[152:159], v9
  ds_write_b32 v11, v66 offset:1280
  s_setprio 0
  v_cvt_pk_f16_f32 v80, v50, v51
  v_cvt_pk_f16_f32 v94, v52, v53
  v_cvt_pk_f16_f32 v108, v54, v55
  v_cvt_pk_f16_f32 v67, v56, v57
  ds_write_b32 v11, v80 offset:1440
  ds_write_b32 v11, v94 offset:1600
  ds_write_b32 v11, v108 offset:1760
  ds_write_b32 v11, v67 offset:1920
  s_sub_u32 s72, s72, 1
  s_cmp_lg_u32 s72, 0
  s_cbranch_scc1 L_cin_loop
  s_branch L_cin_done
L_cslow:
  v_max_f32_dpp v58, v58, v58 row_shr:1 row_mask:0xf bank_mask:0xf
  s_nop 1
  v_max_f32_dpp v58, v58, v58 row_shr:2 row_mask:0xf bank_mask:0xf
  s_nop 1
  v_max_f32_dpp v58, v58, v58 row_shr:4 row_mask:0xf bank_mask:0xf
  s_nop 1
  v_max_f32_dpp v58, v58, v58 row_shr:8 row_mask:0xf bank_mask:0xf
  s_nop 1
  v_max_f32_dpp v58, v58, v58 row_bcast:15 row_mask:0xa bank_mask:0xf
  s_nop 1
  v_max_f32_dpp v58, v58, v58 row_bcast:31 row_mask:0xc bank_mask:0xf
  s_nop 0
  v_readlane_b32 s98, v58, 63
  s_mov_b32 s97, 0
  s_lshr_b32 s98, s98, 23
  s_max_u32 s98, s98, 72
  s_min_u32 s98, s98, 182
  s_sub_u32 s99, 258, s98
  s_lshl_b32 s100, s99, 1
  s_sub_u32 s100, s100, 127
  s_sub_u32 s95, 254, s100
  s_lshl_b32 s95, s95, 23
  v_mov_b32 v60, s95
  v_mul_f32 v61, s0, v60
  v_mul_f32 v60, s1, v60
  v_readfirstlane_b32 s74, v61
  v_readfirstlane_b32 s75, v60
  s_lshl_b32 s99, s99, 23
  s_lshl_b32 s100, s100, 23
  v_mul_f32 v60, s99, v32
  v_mul_f32 v61, s99, v33
  v_mul_f32 v62, s100, v32
  v_mul_f32 v63, s100, v33
  v_cvt_pk_f16_f32 v80, v60, v61
  v_cvt_pk_bf16_f32 v64, v62, v63
  ds_write_b32 v11, v80 offset:0
  ds_write_b32 v10, v64 offset:0
  v_mul_f32 v60, s99, v34
  v_mul_f32 v61, s99, v35
  v_mul_f32 v62, s100, v34
  v_mul_f32 v63, s100, v35
  v_cvt_pk_f16_f32 v81, v60, v61
  v_cvt_pk_bf16_f32 v65, v62, v63
  ds_write_b32 v11, v81 offset:160
  ds_write_b32 v10, v65 offset:2112
  v_mul_f32 v60, s99, v36
  v_mul_f32 v61, s99, v37
  v_mul_f32 v62, s100, v36
  v_mul_f32 v63, s100, v37
  v_cvt_pk_f16_f32 v82, v60, v61
  v_cvt_pk_bf16_f32 v66, v62, v63
  ds_write_b32 v11, v82 offset:320
  ds_write_b32 v10, v66 offset:128
  v_mul_f32 v60, s99, v38
  v_mul_f32 v61, s99, v39
  v_mul_f32 v62, s100, v38
  v_mul_f32 v63, s100, v39
  v_cvt_pk_f16_f32 v83, v60, v61
  v_cvt_pk_bf16_f32 v67, v62, v63
  ds_write_b32 v11, v83 offset:480
  ds_write_b32 v10, v67 offset:2240
  v_mul_f32 v60, s99, v40
  v_mul_f32 v61, s99, v41
  v_mul_f32 v62, s100, v40
  v_mul_f32 v63, s100, v41
  v_cvt_pk_f16_f32 v84, v60, v61
  v_cvt_pk_bf16_f32 v68, v62, v63
  ds_write_b32 v11, v84 offset:640
  ds_write_b32 v10, v68 offset:256
  v_mul_f32 v60, s99, v42
  v_mul_f32 v61, s99, v43
  v_mul_f32 v62, s100, v42
  v_mul_f32 v63, s100, v43
  v_cvt_pk_f16_f32 v85, v60, v61
  v_cvt_pk_bf16_f32 v69, v62, v63
  ds_write_b32 v11, v85 offset:800
  ds_write_b32 v10, v69 offset:2368
  v_mul_f32 v60, s99, v44
  v_mul_f32 v61, s99, v45
  v_mul_f32 v62, s100, v44
  v_mul_f32 v63, s100, v45
  v_cvt_pk_f16_f32 v86, v60, v61
  v_cvt_pk_bf16_f32 v70, v62, v63
  ds_write_b32 v11, v86 offset:960
  ds_write_b32 v10, v70 offset:384
  v_mul_f32 v60, s99, v46
  v_mul_f32 v61, s99, v47
  v_mul_f32 v62, s100, v46
  v_mul_f32 v63, s100, v47
  v_cvt_pk_f16_f32 v87, v60, v61
  v_cvt_pk_bf16_f32 v71, v62, v63
  ds_write_b32 v11, v87 offset:1120
  ds_write_b32 v10, v71 offset:2496
  v_mul_f32 v60, s99, v48
  v_mul_f32 v61, s99, v49
  v_mul_f32 v62, s100, v48
  v_mul_f32 v63, s100, v49
  v_cvt_pk_f16_f32 v88, v60, v61
  v_cvt_pk_bf16_f32 v72, v62, v63
  ds_write_b32 v11, v88 offset:1280
  ds_write_b32 v10, v72 offset:512
  v_mul_f32 v60, s99, v50
  v_mul_f32 v61, s99, v51
  v_mul_f32 v62, s100, v50
  v_mul_f32 v63, s100, v51
  v_cvt_pk_f16_f32 v89, v60, v61
  v_cvt_pk_bf16_f32 v73, v62, v63
  ds_write_b32 v11, v89 offset:1440
  ds_write_b32 v10, v73 offset:2624
  v_mul_f32 v60, s99, v52
  v_mul_f32 v61, s99, v53
  v_mul_f32 v62, s100, v52
  v_mul_f32 v63, s100, v53
  v_cvt_pk_f16_f32 v90, v60, v61
  v_cvt_pk_bf16_f32 v74, v62, v63
  ds_write_b32 v11, v90 offset:1600
  ds_write_b32 v10, v74 offset:640
  v_mul_f32 v60, s99, v54
  v_mul_f32 v61, s99, v55
  v_mul_f32 v62, s100, v54
  v_mul_f32 v63, s100, v55
  v_cvt_pk_f16_f32 v91, v60, v61
  v_cvt_pk_bf16_f32 v75, v62, v63
  ds_write_b32 v11, v91 offset:1760
  ds_write_b32 v10, v75 offset:2752
  v_mul_f32 v60, s99, v56
  v_mul_f32 v61, s99, v57
  v_mul_f32 v62, s100, v56
  v_mul_f32 v63, s100, v57
  v_cvt_pk_f16_f32 v92, v60, v61
  v_cvt_pk_bf16_f32 v76, v62, v63
  ds_write_b32 v11, v92 offset:1920
  ds_write_b32 v10, v76 offset:768
  v_mov_b32 v60, s100
  v_cvt_pk_bf16_f32 v60, v60, v60
  s_mov_b32 exec_hi, 0
  ds_write_b32 v10, v60 offset:2880
  s_mov_b32 exec_hi, -1
  s_waitcnt lgkmcnt(0)
  s_branch L_cconv
L_sdown:
  v_lshlrev_b32 v108, 16, v112
  v_and_b32 v109, 0xffff0000, v112
  v_mul_f32 v108, v108, v250
  v_mul_f32 v109, v109, v250
  v_cvt_pk_bf16_f32 v112, v108, v109
  v_lshlrev_b32 v108, 16, v113
  v_and_b32 v109, 0xffff0000, v113
  v_mul_f32 v108, v108, v250
  v_mul_f32 v109, v109, v250
  v_cvt_pk_bf16_f32 v113, v108, v109
  v_lshlrev_b32 v108, 16, v114
  v_and_b32 v109, 0xffff0000, v114
  v_mul_f32 v108, v108, v250
  v_mul_f32 v109, v109, v250
  v_cvt_pk_bf16_f32 v114, v108, v109
  v_lshlrev_b32 v108, 16, v115
  v_and_b32 v109, 0xffff0000, v115
  v_mul_f32 v108, v108, v250
  v_mul_f32 v109, v109, v250
  v_cvt_pk_bf16_f32 v115, v108, v109
  v_lshlrev_b32 v108, 16, v116
  v_and_b32 v109, 0xffff0000, v116
  v_mul_f32 v108, v108, v250
  v_mul_f32 v109, v109, v250
  v_cvt_pk_bf16_f32 v116, v108, v109
  v_lshlrev_b32 v108, 16, v117
  v_and_b32 v109, 0xffff0000, v117
  v_mul_f32 v108, v108, v250
  v_mul_f32 v109, v109, v250
  v_cvt_pk_bf16_f32 v117, v108, v109
  v_lshlrev_b32 v108, 16, v118
  v_and_b32 v109, 0xffff0000, v118
  v_mul_f32 v108, v108, v250
  v_mul_f32 v109, v109, v250
  v_cvt_pk_bf16_f32 v118, v108, v109
  v_lshlrev_b32 v108, 16, v119
  v_and_b32 v109, 0xffff0000, v119
  v_mul_f32 v108, v108, v250
  v_mul_f32 v109, v109, v250
  v_cvt_pk_bf16_f32 v119, v108, v109
  s_branch L_scaled
L_end:
  s_endpgm
.p2align 8
L_tables:
.long 0x0, 0x1800, 0x6c80, 0x81a0, 0x8, 0x1808, 0x6c88, 0x81a8
.long 0x10, 0x1810, 0x6c90, 0x81b0, 0x18, 0x1818, 0x6c98, 0x81b8
.long 0x40, 0x1d48, 0x71c8, 0x86e8, 0x48, 0x1d50, 0x71d0, 0x86f0
.long 0x50, 0x1d58, 0x71d8, 0x86f8, 0x58, 0x1d60, 0x71e0, 0x8700
.long 0x80, 0x2290, 0x7710, 0x8c30, 0x88, 0x2298, 0x7718, 0x8c38
.long 0x90, 0x22a0, 0x7720, 0x8c40, 0x98, 0x22a8, 0x7728, 0x8c48
.long 0xc0, 0x27d8, 0x7c58, 0x9178, 0xc8, 0x27e0, 0x7c60, 0x9180
.long 0xd0, 0x27e8, 0x7c68, 0x9188, 0xd8, 0x27f0, 0x7c70, 0x9190
.long 0x20, 0x1820, 0x6ca0, 0x81c0, 0x28, 0x1828, 0x6ca8, 0x81c8
.long 0x30, 0x1830, 0x6cb0, 0x81d0, 0x38, 0x1838, 0x6cb8, 0x81d8
.long 0x60, 0x1d68, 0x71e8, 0x8708, 0x68, 0x1d70, 0x71f0, 0x8710
.long 0x70, 0x1d78, 0x71f8, 0x8718, 0x78, 0x1d80, 0x7200, 0x8720
.long 0xa0, 0x22b0, 0x7730, 0x8c50, 0xa8, 0x22b8, 0x7738, 0x8c58
.long 0xb0, 0x22c0, 0x7740, 0x8c60, 0xb8, 0x22c8, 0x7748, 0x8c68
.long 0xe0, 0x27f8, 0x7c78, 0x9198, 0xe8, 0x2800, 0x7c80, 0x91a0
.long 0xf0, 0x2808, 0x7c88, 0x91a8, 0xf8, 0x2810, 0x7c90, 0x91b0
.long 0x200, 0x4240, 0x96c0, 0x9c08, 0x208, 0x4248, 0x96c8, 0x9c10
.long 0x210, 0x4250, 0x96d0, 0x9c18, 0x218, 0x4258, 0x96d8, 0x9c20
.long 0x240, 0x4788, 0x9c08, 0x9c08, 0x248, 0x4790, 0x9c10, 0x9c10
.long 0x250, 0x4798, 0x9c18, 0x9c18, 0x258, 0x47a0, 0x9c20, 0x9c20
.long 0x280, 0x4cd0, 0x9c08, 0x9c08, 0x288, 0x4cd8, 0x9c10, 0x9c10
.long 0x290, 0x4ce0, 0x9c18, 0x9c18, 0x298, 0x4ce8, 0x9c20, 0x9c20
.long 0x2c0, 0x5218, 0x9c08, 0x9c08, 0x2c8, 0x5220, 0x9c10, 0x9c10
.long 0x2d0, 0x5228, 0x9c18, 0x9c18, 0x2d8, 0x5230, 0x9c20, 0x9c20
.long 0x220, 0x4260, 0x96e0, 0x9c28, 0x228, 0x4268, 0x96e8, 0x9c30
.long 0x230, 0x4270, 0x96f0, 0x9c38, 0x238, 0x4278, 0x96f8, 0x9c40
.long 0x260, 0x47a8, 0x9c28, 0x9c28, 0x268, 0x47b0, 0x9c30, 0x9c30
.long 0x270, 0x47b8, 0x9c38, 0x9c38, 0x278, 0x47c0, 0x9c40, 0x9c40
.long 0x2a0, 0x4cf0, 0x9c28, 0x9c28, 0x2a8, 0x4cf8, 0x9c30, 0x9c30
.long 0x2b0, 0x4d00, 0x9c38, 0x9c38, 0x2b8, 0x4d08, 0x9c40, 0x9c40
.long 0x2e0, 0x5238, 0x9c28, 0x9c28, 0x2e8, 0x5240, 0x9c30, 0x9c30
.long 0x2f0, 0x5248, 0x9c38, 0x9c38, 0x2f8, 0x5250, 0x9c40, 0x9c40
.long 0x1fa28, 0x1f9f4, 0x34, 0x14d00, 0x1fa28, 0x1f9f6, 0x74, 0x14d04
.long 0x1fa28, 0x1f9f8, 0xb4, 0x14d08, 0x1fa28, 0x1f9fa, 0xf4, 0x14d0c
.long 0x1fa28, 0x1f9fc, 0x134, 0x14d10, 0x1fa28, 0x1f9fe, 0x174, 0x14d14
.long 0x1fa28, 0x1fa00, 0x1b4, 0x14d18, 0x1fa28, 0x1fa02, 0x1f4, 0x14d1c
.long 0x1fa28, 0x1fa04, 0x234, 0x14d20, 0x1fa28, 0x1fa06, 0x274, 0x14d24
.long 0x1fa28, 0x1fa08, 0x2b4, 0x14d28, 0x1fa28, 0x1fa0a, 0x2f4, 0x14d2c
.long 0x1fa28, 0x1fa0c, 0x334, 0x14d30, 0x1fa28, 0x1fa0e, 0x374, 0x14d34
.long 0x1fa28, 0x1fa10, 0x3b4, 0x14d38, 0x1fa28, 0x1fa12, 0x3f4, 0x14d3c
.long 0x1fa28, 0x1fa14, 0x434, 0x14d00, 0x1fa28, 0x1fa16, 0x474, 0x14d04
.long 0x1fa28, 0x1fa18, 0x4b4, 0x14d08, 0x1fa28, 0x1fa1a, 0x4f4, 0x14d0c
.long 0x1fa28, 0x1fa1c, 0x534, 0x14d10, 0x1fa28, 0x1fa1e, 0x574, 0x14d14
.long 0x1fa28, 0x1fa20, 0x5b4, 0x14d18, 0x1fa28, 0x1fa22, 0x5f4, 0x14d1c
.long 0x1fa28, 0x1fa24, 0x634, 0x14d20, 0x1fa28, 0x1fa26, 0x674, 0x14d24
.long 0x1fa28, 0x1fa28, 0x6b4, 0x14d28, 0x1fa28, 0x1fa2a, 0x6f4, 0x14d2c
.long 0x1fa28, 0x1fa2c, 0x734, 0x14d30, 0x1fa28, 0x1fa2e, 0x774, 0x14d34
.long 0x1fa28, 0x1fa30, 0x7b4, 0x14d38, 0x1fa28, 0x1fa32, 0x7f4, 0x14d3c
.long 0x1fa38, 0x1fa34, 0x834, 0x14d00, 0x1fa38, 0x1fa36, 0x874, 0x14d04
.long 0x1fa38, 0x1fa38, 0x8b4, 0x14d08, 0x1fa38, 0x1fa3a, 0x8f4, 0x14d0c
.long 0x1fa38, 0x1fa3c, 0x934, 0x14d10, 0x1fa38, 0x1fa3e, 0x974, 0x14d14
.long 0x1fa38, 0x1fa40, 0x9b4, 0x14d18, 0x1fa38, 0x1fa42, 0x9f4, 0x14d1c
.long 0x1fa38, 0x1fa44, 0xa34, 0x14d20, 0x1fa38, 0x1fa46, 0xa74, 0x14d24
.long 0x1fa38, 0x1fa48, 0xab4, 0x14d28, 0x1fa38, 0x1fa4a, 0xaf4, 0x14d2c
.long 0x1fa38, 0x1fa4c, 0xb34, 0x14d30, 0x1fa38, 0x1fa4e, 0xb74, 0x14d34
.long 0x1fa38, 0x1fa50, 0xbb4, 0x14d38, 0x1fa38, 0x1fa52, 0xbf4, 0x14d3c
.long 0x1fa38, 0x1fa54, 0xc34, 0x14d00, 0x1fa38, 0x1fa56, 0xc74, 0x14d04
.long 0x1fa38, 0x1fa58, 0xcb4, 0x14d08, 0x1fa38, 0x1fa5a, 0xcf4, 0x14d0c
.long 0x1fa38, 0x1fa5c, 0xd34, 0x14d10, 0x1fa38, 0x1fa5e, 0xd74, 0x14d14
.long 0x1fa38, 0x1fa60, 0xdb4, 0x14d18, 0x1fa38, 0x1fa62, 0xdf4, 0x14d1c
.long 0x1fa38, 0x1fa64, 0xe34, 0x14d20, 0x1fa38, 0x1fa66, 0xe74, 0x14d24
.long 0x1fa38, 0x1fa68, 0xeb4, 0x14d28, 0x1fa38, 0x1fa6a, 0xef4, 0x14d2c
.long 0x1fa38, 0x1fa6c, 0xf34, 0x14d30, 0x1fa38, 0x1fa6e, 0xf74, 0x14d34
.long 0x1fa38, 0x1fa70, 0xfb4, 0x14d38, 0x1fa38, 0x1fa72, 0xff4, 0x14d3c
.long 0xaae0, 0xa680, 0xa900, 0xaae0, 0xaae8, 0xa688, 0xa908, 0xaae8
.long 0xaaf0, 0xa690, 0xa910, 0xaaf0, 0xaaf8, 0xa698, 0xa918, 0xaaf8
.long 0xaa40, 0xa860, 0xa9a0, 0xaa40, 0xaa48, 0xa868, 0xa9a8, 0xaa48
.long 0xaa50, 0xa870, 0xa9b0, 0xaa50, 0xaa58, 0xa878, 0xa9b8, 0xaa58
.long 0xa400, 0xa7c0, 0xa540, 0xa400, 0xa408, 0xa7c8, 0xa548, 0xa408
.long 0xa410, 0xa7d0, 0xa550, 0xa410, 0xa418, 0xa7d8, 0xa558, 0xa418
.long 0xa4a0, 0xa720, 0xa5e0, 0xa4a0, 0xa4a8, 0xa728, 0xa5e8, 0xa4a8
.long 0xa4b0, 0xa730, 0xa5f0, 0xa4b0, 0xa4b8, 0xa738, 0xa5f8, 0xa4b8
.long 0xb260, 0xb4e0, 0xb6c0, 0xb260, 0xb268, 0xb4e8, 0xb6c8, 0xb268
.long 0xb270, 0xb4f0, 0xb6d0, 0xb270, 0xb278, 0xb4f8, 0xb6d8, 0xb278
.long 0xb1c0, 0xb300, 0xb760, 0xb1c0, 0xb1c8, 0xb308, 0xb768, 0xb1c8
.long 0xb1d0, 0xb310, 0xb770, 0xb1d0, 0xb1d8, 0xb318, 0xb778, 0xb1d8
.long 0xb580, 0xb440, 0xb080, 0xb580, 0xb588, 0xb448, 0xb088, 0xb588
.long 0xb590, 0xb450, 0xb090, 0xb590, 0xb598, 0xb458, 0xb098, 0xb598
.long 0xb620, 0xb3a0, 0xb120, 0xb620, 0xb628, 0xb3a8, 0xb128, 0xb628
.long 0xb630, 0xb3b0, 0xb130, 0xb630, 0xb638, 0xb3b8, 0xb138, 0xb638
.long 0xa900, 0xa400, 0xaae0, 0xb620, 0xa908, 0xa408, 0xaae8, 0xb628
.long 0xa910, 0xa410, 0xaaf0, 0xb630, 0xa918, 0xa418, 0xaaf8, 0xb638
.long 0xa9a0, 0xa4a0, 0xab80, 0xb800, 0xa9a8, 0xa4a8, 0xab88, 0xb808
.long 0xa9b0, 0xa4b0, 0xab90, 0xb810, 0xa9b8, 0xa4b8, 0xab98, 0xb818
.long 0xaa40, 0xa680, 0xa860, 0xb3a0, 0xaa48, 0xa688, 0xa868, 0xb3a8
.long 0xaa50, 0xa690, 0xa870, 0xb3b0, 0xaa58, 0xa698, 0xa878, 0xb3b8
.long 0xa720, 0xa540, 0xa7c0, 0xb1c0, 0xa728, 0xa548, 0xa7c8, 0xb1c8
.long 0xa730, 0xa550, 0xa7d0, 0xb1d0, 0xa738, 0xa558, 0xa7d8, 0xb1d8
.long 0xa5e0, 0xaae0, 0xa400, 0xb080, 0xa5e8, 0xaae8, 0xa408, 0xb088
.long 0xa5f0, 0xaaf0, 0xa410, 0xb090, 0xa5f8, 0xaaf8, 0xa418, 0xb098
.long 0xa7c0, 0xa540, 0xa720, 0xb760, 0xa7c8, 0xa548, 0xa728, 0xb768
.long 0xa7d0, 0xa550, 0xa730, 0xb770, 0xa7d8, 0xa558, 0xa738, 0xb778
.long 0xa860, 0xa680, 0xaa40, 0xb440, 0xa868, 0xa688, 0xaa48, 0xb448
.long 0xa870, 0xa690, 0xaa50, 0xb450, 0xa878, 0xa698, 0xaa58, 0xb458
.long 0xab80, 0xa4a0, 0xa9a0, 0xb4e0, 0xab88, 0xa4a8, 0xa9a8, 0xb4e8
.long 0xab90, 0xa4b0, 0xa9b0, 0xb4f0, 0xab98, 0xa4b8, 0xa9b8, 0xb4f8
.long 0xa680, 0xa900, 0xab80, 0xa4a0, 0xa688, 0xa908, 0xab88, 0xa4a8
.long 0xa690, 0xa910, 0xab90, 0xa4b0, 0xa698, 0xa918, 0xab98, 0xa4b8
.long 0xa860, 0xa9a0, 0xb1c0, 0xb440, 0xa868, 0xa9a8, 0xb1c8, 0xb448
.long 0xa870, 0xa9b0, 0xb1d0, 0xb450, 0xa878, 0xa9b8, 0xb1d8, 0xb458
.long 0xa7c0, 0xa540, 0xab80, 0xa4a0, 0xa7c8, 0xa548, 0xab88, 0xa4a8
.long 0xa7d0, 0xa550, 0xab90, 0xa4b0, 0xa7d8, 0xa558, 0xab98, 0xa4b8
.long 0xa720, 0xa5e0, 0xb1c0, 0xb440, 0xa728, 0xa5e8, 0xb1c8, 0xb448
.long 0xa730, 0xa5f0, 0xb1d0, 0xb450, 0xa738, 0xa5f8, 0xb1d8, 0xb458
.long 0xb4e0, 0xb6c0, 0xb800, 0xa860, 0xb4e8, 0xb6c8, 0xb808, 0xa868
.long 0xb4f0, 0xb6d0, 0xb810, 0xa870, 0xb4f8, 0xb6d8, 0xb818, 0xa878
.long 0xb300, 0xb760, 0xa540, 0xa900, 0xb308, 0xb768, 0xa548, 0xa908
.long 0xb310, 0xb770, 0xa550, 0xa910, 0xb318, 0xb778, 0xa558, 0xa918
.long 0xb440, 0xb080, 0xb800, 0xa860, 0xb448, 0xb088, 0xb808, 0xa868
.long 0xb450, 0xb090, 0xb810, 0xa870, 0xb458, 0xb098, 0xb818, 0xa878
.long 0xb3a0, 0xb120, 0xa540, 0xa900, 0xb3a8, 0xb128, 0xa548, 0xa908
.long 0xb3b0, 0xb130, 0xa550, 0xa910, 0xb3b8, 0xb138, 0xa558, 0xa918
.long 0xb120, 0xb580, 0xb080, 0xb300, 0xb128, 0xb588, 0xb088, 0xb308
.long 0xb130, 0xb590, 0xb090, 0xb310, 0xb138, 0xb598, 0xb098, 0xb318
.long 0xb6c0, 0xb4e0, 0xaa40, 0xb6c0, 0xb6c8, 0xb4e8, 0xaa48, 0xb6c8
.long 0xb6d0, 0xb4f0, 0xaa50, 0xb6d0, 0xb6d8, 0xb4f8, 0xaa58, 0xb6d8
.long 0xb300, 0xb440, 0xb080, 0xb300, 0xb308, 0xb448, 0xb088, 0xb308
.long 0xb310, 0xb450, 0xb090, 0xb310, 0xb318, 0xb458, 0xb098, 0xb318
.long 0xb260, 0xb760, 0xaa40, 0xb6c0, 0xb268, 0xb768, 0xaa48, 0xb6c8
.long 0xb270, 0xb770, 0xaa50, 0xb6d0, 0xb278, 0xb778, 0xaa58, 0xb6d8
.long 0xb580, 0xb120, 0xb620, 0xa680, 0xb588, 0xb128, 0xb628, 0xa688
.long 0xb590, 0xb130, 0xb630, 0xa690, 0xb598, 0xb138, 0xb638, 0xa698
.long 0xb260, 0xb1c0, 0xa7c0, 0xa680, 0xb268, 0xb1c8, 0xa7c8, 0xa688
.long 0xb270, 0xb1d0, 0xa7d0, 0xa690, 0xb278, 0xb1d8, 0xa7d8, 0xa698
.long 0xb300, 0xb3a0, 0xb620, 0xb300, 0xb308, 0xb3a8, 0xb628, 0xb308
.long 0xb310, 0xb3b0, 0xb630, 0xb310, 0xb318, 0xb3b8, 0xb638, 0xb318
.long 0xb6c0, 0xb800, 0xa7c0, 0xb300, 0xb6c8, 0xb808, 0xa7c8, 0xb308
.long 0xb6d0, 0xb810, 0xa7d0, 0xb310, 0xb6d8, 0xb818, 0xa7d8, 0xb318
.long 0x0, 0x200, 0x0, 0x3f803f80, 0x8, 0x208, 0x0, 0x3f803f80
.long 0x10, 0x210, 0x0, 0x3f803f80, 0x18, 0x218, 0x0, 0x3f803f80
.long 0x420, 0x620, 0x0, 0x3f803f80, 0x428, 0x628, 0x0, 0x3f803f80
.long 0x430, 0x630, 0x0, 0x3f803f80, 0x438, 0x638, 0x0, 0x3f803f80
.long 0x840, 0xa40, 0x10, 0x3f803f80, 0x848, 0xa48, 0x10, 0x3f803f80
.long 0x850, 0xa50, 0x10, 0x3f803f80, 0x858, 0xa58, 0x10, 0x3f803f80
.long 0xc60, 0xe60, 0x10, 0x3f803f80, 0xc68, 0xe68, 0x10, 0x3f803f80
.long 0xc70, 0xe70, 0x10, 0x3f803f80, 0xc78, 0xe78, 0x10, 0x3f803f80
.long 0x80, 0x280, 0x20, 0x3f803f80, 0x88, 0x288, 0x20, 0x3f803f80
.long 0x90, 0x290, 0x20, 0x3f803f80, 0x98, 0x298, 0x20, 0x3f803f80
.long 0x4a0, 0x6a0, 0x20, 0x3f803f80, 0x4a8, 0x6a8, 0x20, 0x3f803f80
.long 0x4b0, 0x6b0, 0x20, 0x3f803f80, 0x4b8, 0x6b8, 0x20, 0x3f803f80
.long 0x8c0, 0xac0, 0x30, 0x3f803f80, 0x8c8, 0xac8, 0x30, 0x3f803f80
.long 0x8d0, 0xad0, 0x30, 0x3f803f80, 0x8d8, 0xad8, 0x30, 0x3f803f80
.long 0xce0, 0xee0, 0x30, 0x3f803f80, 0xce8, 0xee8, 0x30, 0x3f803f80
.long 0xcf0, 0xef0, 0x30, 0x3f803f80, 0xcf8, 0xef8, 0x30, 0x3f803f80
.long 0x100, 0x300, 0x40, 0x0, 0x108, 0x308, 0x40, 0x0
.long 0x110, 0x310, 0x40, 0x0, 0x118, 0x318, 0x40, 0x0
.long 0x520, 0x720, 0x40, 0x0, 0x528, 0x728, 0x40, 0x0
.long 0x530, 0x730, 0x40, 0x0, 0x538, 0x738, 0x40, 0x0
.long 0x940, 0xb40, 0x50, 0x0, 0x948, 0xb48, 0x50, 0x0
.long 0x950, 0xb50, 0x50, 0x0, 0x958, 0xb58, 0x50, 0x0
.long 0xd60, 0xf60, 0x50, 0x0, 0xd68, 0xf68, 0x50, 0x0
.long 0xd70, 0xf70, 0x50, 0x0, 0xd78, 0xf78, 0x50, 0x0
.long 0x180, 0xf60, 0x60, 0x0, 0x188, 0xf68, 0x60, 0x0
.long 0x190, 0xf70, 0x60, 0x0, 0x198, 0xf78, 0x60, 0x0
.long 0x5a0, 0xf60, 0x60, 0x0, 0x5a8, 0xf68, 0x60, 0x0
.long 0x5b0, 0xf70, 0x60, 0x0, 0x5b8, 0xf78, 0x60, 0x0
.long 0x9c0, 0xf60, 0x70, 0x0, 0x9c8, 0xf68, 0x70, 0x0
.long 0x9d0, 0xf70, 0x70, 0x0, 0x9d8, 0xf78, 0x70, 0x0
.long 0xde0, 0xf60, 0x70, 0x0, 0xde8, 0xf68, 0x70, 0x0
.long 0xdf0, 0xf70, 0x70, 0x0, 0xdf8, 0xf78, 0x70, 0x0
.long 0xffff, 0x0, 0x0, 0x0, 0x0, 0x0, 0xffff, 0x0
.long 0x0, 0x0, 0x0, 0x0, 0x0, 0x0, 0x0, 0x0
.long 0x0, 0x0, 0x0, 0x0, 0x0, 0x0, 0x0, 0x0
.long 0x0, 0x0, 0x0, 0x0, 0x0, 0x0, 0x0, 0x0
.long 0xffff0000, 0x0, 0x0, 0x0, 0x0, 0x0, 0xffff0000, 0x0
.long 0x0, 0x0, 0x0, 0x0, 0x0, 0x0, 0x0, 0x0
.long 0x0, 0x0, 0x0, 0x0, 0x0, 0x0, 0x0, 0x0
.long 0x0, 0x0, 0x0, 0x0, 0x0, 0x0, 0x0, 0x0
.long 0x0, 0xffff, 0x0, 0x0, 0x0, 0x0, 0x0, 0xffff
.long 0x0, 0x0, 0x0, 0x0, 0x0, 0x0, 0x0, 0x0
.long 0x0, 0x0, 0x0, 0x0, 0x0, 0x0, 0x0, 0x0
.long 0x0, 0x0, 0x0, 0x0, 0x0, 0x0, 0x0, 0x0
.long 0x0, 0xffff0000, 0x0, 0x0, 0x0, 0x0, 0x0, 0xffff0000
.long 0x0, 0x0, 0x0, 0x0, 0x0, 0x0, 0x0, 0x0
.long 0x0, 0x0, 0x0, 0x0, 0x0, 0x0, 0x0, 0x0
.long 0x0, 0x0, 0x0, 0x0, 0x0, 0x0, 0x0, 0x0
.long 0x0, 0x0, 0x0, 0x0, 0x0, 0x0, 0x0, 0x0
.long 0xffff, 0x0, 0x0, 0x0, 0x0, 0x0, 0xffff, 0x0
.long 0x0, 0x0, 0x0, 0x0, 0x0, 0x0, 0x0, 0x0
.long 0x0, 0x0, 0x0, 0x0, 0x0, 0x0, 0x0, 0x0
.long 0x0, 0x0, 0x0, 0x0, 0x0, 0x0, 0x0, 0x0
.long 0xffff0000, 0x0, 0x0, 0x0, 0x0, 0x0, 0xffff0000, 0x0
.long 0x0, 0x0, 0x0, 0x0, 0x0, 0x0, 0x0, 0x0
.long 0x0, 0x0, 0x0, 0x0, 0x0, 0x0, 0x0, 0x0
.long 0x0, 0x0, 0x0, 0x0, 0x0, 0x0, 0x0, 0x0
.long 0x0, 0xffff, 0x0, 0x0, 0x0, 0x0, 0x0, 0xffff
.long 0x0, 0x0, 0x0, 0x0, 0x0, 0x0, 0x0, 0x0
.long 0x0, 0x0, 0x0, 0x0, 0x0, 0x0, 0x0, 0x0
.long 0x0, 0x0, 0x0, 0x0, 0x0, 0x0, 0x0, 0x0
.long 0x0, 0xffff0000, 0x0, 0x0, 0x0, 0x0, 0x0, 0xffff0000
.long 0x0, 0x0, 0x0, 0x0, 0x0, 0x0, 0x0, 0x0
.long 0x0, 0x0, 0x0, 0x0, 0x0, 0x0, 0x0, 0x0
.long 0x0, 0x0, 0x0, 0x0, 0x0, 0x0, 0x0, 0x0
.long 0x0, 0x0, 0x0, 0x0, 0x0, 0x0, 0x0, 0x0
.long 0x0, 0x0, 0xffff, 0x0, 0x0, 0x0, 0x0, 0x0
.long 0x0, 0x0, 0x0, 0x0, 0xffff, 0x0, 0x0, 0x0
.long 0x0, 0x0, 0x0, 0x0, 0x0, 0x0, 0x0, 0x0
.long 0x0, 0x0, 0x0, 0x0, 0x0, 0x0, 0x0, 0x0
.long 0x0, 0x0, 0xffff0000, 0x0, 0x0, 0x0, 0x0, 0x0
.long 0x0, 0x0, 0x0, 0x0, 0xffff0000, 0x0, 0x0, 0x0
.long 0x0, 0x0, 0x0, 0x0, 0x0, 0x0, 0x0, 0x0
.long 0x0, 0x0, 0x0, 0x0, 0x0, 0x0, 0x0, 0x0
.long 0x0, 0x0, 0x0, 0xffff, 0x0, 0x0, 0x0, 0x0
.long 0x0, 0x0, 0x0, 0x0, 0x0, 0xffff, 0x0, 0x0
.long 0x0, 0x0, 0x0, 0x0, 0x0, 0x0, 0x0, 0x0
.long 0x0, 0x0, 0x0, 0x0, 0x0, 0x0, 0x0, 0x0
.long 0x0, 0x0, 0x0, 0xffff0000, 0x0, 0x0, 0x0, 0x0
.long 0x0, 0x0, 0x0, 0x0, 0x0, 0xffff0000, 0x0, 0x0
.long 0x0, 0x0, 0x0, 0x0, 0x0, 0x0, 0x0, 0x0
.long 0x0, 0x0, 0x0, 0x0, 0x0, 0x0, 0x0, 0x0
.long 0x0, 0x0, 0x0, 0x0, 0xffff, 0x0, 0x0, 0x0
.long 0x0, 0x0, 0x0, 0x0, 0x0, 0x0, 0x0, 0x0
.long 0x0, 0x0, 0x0, 0x0, 0x0, 0x0, 0x0, 0x0
.long 0x0, 0x0, 0x0, 0x0, 0x0, 0x0, 0x0, 0x0
.long 0x0, 0x0, 0x0, 0x0, 0xffff0000, 0x0, 0x0, 0x0
.long 0x0, 0x0, 0x0, 0x0, 0x0, 0x0, 0x0, 0x0
.long 0x0, 0x0, 0x0, 0x0, 0x0, 0x0, 0x0, 0x0
.long 0x0, 0x0, 0x0, 0x0, 0x0, 0x0, 0x0, 0x0
.long 0x0, 0x0, 0x0, 0x0, 0x0, 0x0, 0x0, 0x0
.long 0x0, 0x0, 0x0, 0x0, 0x0, 0x0, 0x0, 0x0
.long 0x0, 0x0, 0x0, 0x0, 0x0, 0x0, 0x0, 0x0
.long 0x0, 0x0, 0x0, 0x0, 0x0, 0x0, 0x0, 0x0
.long 0x0, 0x0, 0x0, 0x0, 0x0, 0x0, 0x0, 0x0
.long 0x0, 0x0, 0x0, 0x0, 0x0, 0x0, 0x0, 0x0
.long 0x14d40, 0x14d40, 0x0, 0x0, 0x14e10, 0x14e10, 0x20, 0x20
.long 0x14ee0, 0x14ee0, 0x100000, 0x100000, 0x14fb0, 0x14fb0, 0x100020, 0x100020
.long 0x15080, 0x15080, 0x40, 0x40, 0x15150, 0x15150, 0x60, 0x60
.long 0x15220, 0x15220, 0x100040, 0x100040, 0x100000, 0x100000, 0x100060, 0x100060
.long 0x14d74, 0x14d74, 0x80, 0x80, 0x14e44, 0x14e44, 0xa0, 0xa0
.long 0x14f14, 0x14f14, 0x100080, 0x100080, 0x14fe4, 0x14fe4, 0x1000a0, 0x1000a0
.long 0x150b4, 0x150b4, 0xc0, 0xc0, 0x15184, 0x15184, 0xe0, 0xe0
.long 0x15254, 0x15254, 0x1000c0, 0x1000c0, 0x100000, 0x100000, 0x1000e0, 0x1000e0
.long 0x14da8, 0x14da8, 0x8, 0x100, 0x14e78, 0x14e78, 0x28, 0x120
.long 0x14f48, 0x14f48, 0x100008, 0x100100, 0x15018, 0x15018, 0x100028, 0x100120
.long 0x150e8, 0x150e8, 0x48, 0x140, 0x151b8, 0x151b8, 0x68, 0x160
.long 0x100000, 0x100000, 0x100048, 0x100140, 0x100000, 0x100000, 0x100068, 0x100160
.long 0x14ddc, 0x14ddc, 0x88, 0x180, 0x14eac, 0x14eac, 0xa8, 0x1a0
.long 0x14f7c, 0x14f7c, 0x100088, 0x100180, 0x1504c, 0x1504c, 0x1000a8, 0x1001a0
.long 0x1511c, 0x1511c, 0xc8, 0x1c0, 0x151ec, 0x151ec, 0xe8, 0x1e0
.long 0x100000, 0x100000, 0x1000c8, 0x1001c0, 0x100000, 0x100000, 0x1000e8, 0x1001e0
.long 0x17780, 0x114d40, 0x100, 0x200, 0x17850, 0x114e10, 0x120, 0x220
.long 0x17920, 0x114ee0, 0x100100, 0x100200, 0x179f0, 0x114fb0, 0x100120, 0x100220
.long 0x17ac0, 0x115080, 0x140, 0x240, 0x17b90, 0x115150, 0x160, 0x260
.long 0x17c60, 0x115220, 0x100140, 0x100240, 0x102a40, 0x200000, 0x100160, 0x100260
.long 0x177b4, 0x114d74, 0x180, 0x280, 0x17884, 0x114e44, 0x1a0, 0x2a0
.long 0x17954, 0x114f14, 0x100180, 0x100280, 0x17a24, 0x114fe4, 0x1001a0, 0x1002a0
.long 0x17af4, 0x1150b4, 0x1c0, 0x2c0, 0x17bc4, 0x115184, 0x1e0, 0x2e0
.long 0x17c94, 0x115254, 0x1001c0, 0x1002c0, 0x102a40, 0x200000, 0x1001e0, 0x1002e0
.long 0x177e8, 0x114da8, 0x108, 0x300, 0x178b8, 0x114e78, 0x128, 0x320
.long 0x17988, 0x114f48, 0x100108, 0x100300, 0x17a58, 0x115018, 0x100128, 0x100320
.long 0x17b28, 0x1150e8, 0x148, 0x340, 0x17bf8, 0x1151b8, 0x168, 0x360
.long 0x102a40, 0x200000, 0x100148, 0x100340, 0x102a40, 0x200000, 0x100168, 0x100360
.long 0x1781c, 0x114ddc, 0x188, 0x380, 0x178ec, 0x114eac, 0x1a8, 0x3a0
.long 0x179bc, 0x114f7c, 0x100188, 0x100380, 0x17a8c, 0x11504c, 0x1001a8, 0x1003a0
.long 0x17b5c, 0x11511c, 0x1c8, 0x3c0, 0x17c2c, 0x1151ec, 0x1e8, 0x3e0
.long 0x102a40, 0x200000, 0x1001c8, 0x1003c0, 0x102a40, 0x200000, 0x1001e8, 0x1003e0
.long 0xa400, 0xd00, 0x0, 0x14d40, 0xa440, 0xd00, 0x0, 0x14d80
.long 0xa480, 0xd00, 0x1, 0x14dd0, 0xa4c0, 0xd00, 0x1, 0x14e10
.long 0xa500, 0xd00, 0x2, 0x14e60, 0xa540, 0xd00, 0x2, 0x14ea0
.long 0xa580, 0xd00, 0x3, 0x14ef0, 0xa5c0, 0xd00, 0x3, 0x14f30
.long 0xa600, 0xd00, 0x4, 0x14f40, 0xa640, 0xd00, 0x4, 0x14f80
.long 0xa680, 0xd00, 0x5, 0x14fd0, 0xa6c0, 0xd00, 0x5, 0x15010
.long 0xa700, 0xd00, 0x6, 0x15060, 0xa740, 0xd00, 0x6, 0x150a0
.long 0xa780, 0xd00, 0x7, 0x150f0, 0xa7c0, 0xd00, 0x7, 0x15130
.long 0xa800, 0xd00, 0x8, 0x15140, 0xa840, 0xd00, 0x8, 0x15180
.long 0xa880, 0xd00, 0x9, 0x151d0, 0xa8c0, 0xd00, 0x9, 0x15210
.long 0xa900, 0xd00, 0xa, 0x15260, 0xa940, 0xd00, 0xa, 0x152a0
.long 0xa980, 0xd00, 0xb, 0x152f0, 0xa9c0, 0xd00, 0xb, 0x15330
.long 0xaa00, 0xd00, 0xc, 0x15340, 0xaa40, 0xd00, 0xc, 0x15380
.long 0x1f680, 0x40, 0xd, 0x153d0, 0x100000, 0xd00, 0xd, 0x15410
.long 0x100000, 0xd00, 0xe, 0x15460, 0x100000, 0xd00, 0xe, 0x154a0
.long 0x100000, 0xd00, 0xf, 0x154f0, 0x100000, 0xd00, 0xf, 0x15530
.long 0xa400, 0xd00, 0x2, 0x14d60, 0xa440, 0xd00, 0x2, 0x14da0
.long 0xa480, 0xd00, 0x3, 0x14df0, 0xa4c0, 0xd00, 0x3, 0x14e30
.long 0xa500, 0xd00, 0x4, 0x14e40, 0xa540, 0xd00, 0x4, 0x14e80
.long 0xa580, 0xd00, 0x5, 0x14ed0, 0xa5c0, 0xd00, 0x5, 0x14f10
.long 0xa600, 0xd00, 0x6, 0x14f60, 0xa640, 0xd00, 0x6, 0x14fa0
.long 0xa680, 0xd00, 0x7, 0x14ff0, 0xa6c0, 0xd00, 0x7, 0x15030
.long 0xa700, 0xd00, 0x8, 0x15040, 0xa740, 0xd00, 0x8, 0x15080
.long 0xa780, 0xd00, 0x9, 0x150d0, 0xa7c0, 0xd00, 0x9, 0x15110
.long 0xa800, 0xd00, 0xa, 0x15160, 0xa840, 0xd00, 0xa, 0x151a0
.long 0xa880, 0xd00, 0xb, 0x151f0, 0xa8c0, 0xd00, 0xb, 0x15230
.long 0xa900, 0xd00, 0xc, 0x15240, 0xa940, 0xd00, 0xc, 0x15280
.long 0xa980, 0xd00, 0xd, 0x152d0, 0xa9c0, 0xd00, 0xd, 0x15310
.long 0xaa00, 0xd00, 0xe, 0x15360, 0xaa40, 0xd00, 0xe, 0x153a0
.long 0x1f680, 0x40, 0xf, 0x153f0, 0x100000, 0xd00, 0xf, 0x15430
.long 0x100000, 0xd00, 0x10, 0x15440, 0x100000, 0xd00, 0x10, 0x15480
.long 0x100000, 0xd00, 0x11, 0x154d0, 0x100000, 0xd00, 0x11, 0x15510
.long 0x1f690, 0x1f890, 0x1f9c0, 0x1f9e0, 0x1f698, 0x1f898, 0x1f9c8, 0x1f9e8
.long 0x1f680, 0x1f880, 0x1f9d0, 0x1f9f0, 0x1f688, 0x1f888, 0x1f9d8, 0x100000
.long 0x1fd20, 0x1ff20, 0x1f9c2, 0x1f9e2, 0x1fd28, 0x1ff28, 0x1f9ca, 0x1f9ea
.long 0x1fd30, 0x1ff30, 0x1f9d2, 0x1f9f2, 0x1fd38, 0x1ff38, 0x1f9da, 0x100000
.long 0x1f6f0, 0x1f8f0, 0x1f9c4, 0x1f9e4, 0x1f6f8, 0x1f8f8, 0x1f9cc, 0x1f9ec
.long 0x1f6e0, 0x1f8e0, 0x1f9d4, 0x100000, 0x1f6e8, 0x1f8e8, 0x1f9dc, 0x100000
.long 0x1fd40, 0x1ff40, 0x1f9c6, 0x1f9e6, 0x1fd48, 0x1ff48, 0x1f9ce, 0x1f9ee
.long 0x1fd50, 0x1ff50, 0x1f9d6, 0x100000, 0x1fd58, 0x1ff58, 0x1f9de, 0x100000
.long 0x1f710, 0x1f910, 0x1f9c0, 0x1f9e0, 0x1f718, 0x1f918, 0x1f9c8, 0x1f9e8
.long 0x1f700, 0x1f900, 0x1f9d0, 0x1f9f0, 0x1f708, 0x1f908, 0x1f9d8, 0x100000
.long 0x1fda0, 0x1ffa0, 0x1f9c2, 0x1f9e2, 0x1fda8, 0x1ffa8, 0x1f9ca, 0x1f9ea
.long 0x1fdb0, 0x1ffb0, 0x1f9d2, 0x1f9f2, 0x1fdb8, 0x1ffb8, 0x1f9da, 0x100000
.long 0x1f770, 0x1f970, 0x1f9c4, 0x1f9e4, 0x1f778, 0x1f978, 0x1f9cc, 0x1f9ec
.long 0x1f760, 0x1f960, 0x1f9d4, 0x100000, 0x1f768, 0x1f968, 0x1f9dc, 0x100000
.long 0x1fdc0, 0x1ffc0, 0x1f9c6, 0x1f9e6, 0x1fdc8, 0x1ffc8, 0x1f9ce, 0x1f9ee
.long 0x1fdd0, 0x1ffd0, 0x1f9d6, 0x100000, 0x1fdd8, 0x1ffd8, 0x1f9de, 0x100000
.long 0x1f790, 0x1f990, 0x1f9c0, 0x1f9e0, 0x1f798, 0x1f998, 0x1f9c8, 0x1f9e8
.long 0x1f780, 0x1f980, 0x1f9d0, 0x1f9f0, 0x1f788, 0x1f988, 0x1f9d8, 0x100000
.long 0x1fe20, 0x20020, 0x1f9c2, 0x1f9e2, 0x1fe28, 0x20028, 0x1f9ca, 0x1f9ea
.long 0x1fe30, 0x20030, 0x1f9d2, 0x1f9f2, 0x1fe38, 0x20038, 0x1f9da, 0x100000
.long 0x1f7f0, 0x14d00, 0x1f9c4, 0x1f9e4, 0x1f7f8, 0x14d08, 0x1f9cc, 0x1f9ec
.long 0x1f7e0, 0x14d10, 0x1f9d4, 0x100000, 0x1f7e8, 0x14d18, 0x1f9dc, 0x100000
.long 0x1fe40, 0x14d00, 0x1f9c6, 0x1f9e6, 0x1fe48, 0x14d08, 0x1f9ce, 0x1f9ee
.long 0x1fe50, 0x14d10, 0x1f9d6, 0x100000, 0x1fe58, 0x14d18, 0x1f9de, 0x100000
.long 0x1f810, 0x14d00, 0x1f9c0, 0x1f9e0, 0x1f818, 0x14d08, 0x1f9c8, 0x1f9e8
.long 0x1f800, 0x14d10, 0x1f9d0, 0x1f9f0, 0x1f808, 0x14d18, 0x1f9d8, 0x100000
.long 0x1fea0, 0x14d00, 0x1f9c2, 0x1f9e2, 0x1fea8, 0x14d08, 0x1f9ca, 0x1f9ea
.long 0x1feb0, 0x14d10, 0x1f9d2, 0x1f9f2, 0x1feb8, 0x14d18, 0x1f9da, 0x100000
.long 0x1f870, 0x14d00, 0x1f9c4, 0x1f9e4, 0x1f878, 0x14d08, 0x1f9cc, 0x1f9ec
.long 0x1f860, 0x14d10, 0x1f9d4, 0x100000, 0x1f868, 0x14d18, 0x1f9dc, 0x100000
.long 0x1fec0, 0x14d00, 0x1f9c6, 0x1f9e6, 0x1fec8, 0x14d08, 0x1f9ce, 0x1f9ee
.long 0x1fed0, 0x14d10, 0x1f9d6, 0x100000, 0x1fed8, 0x14d18, 0x1f9de, 0x100000
.long 0x0, 0x4444, 0x0, 0xa400, 0x10, 0xeeee, 0x4, 0xa404
.long 0x20, 0x4444, 0x8, 0xa408, 0x30, 0xeeee, 0xc, 0xa40c
.long 0x40, 0x4444, 0x10, 0xa410, 0x50, 0xeeee, 0x14, 0xa414
.long 0x60, 0x4444, 0x18, 0xa418, 0x70, 0xeeee, 0x1c, 0xa41c
.long 0x0, 0x4444, 0x20, 0xa420, 0x10, 0xeeee, 0x24, 0xa424
.long 0x20, 0x4444, 0x28, 0xa428, 0x30, 0xeeee, 0x2c, 0xa42c
.long 0x40, 0x4444, 0x30, 0xa430, 0x50, 0xeeee, 0x34, 0xa434
.long 0x60, 0x4444, 0x38, 0xa438, 0x70, 0xeeee, 0x3c, 0xa43c
.long 0x0, 0x4444, 0x40, 0xa440, 0x10, 0xeeee, 0x44, 0xa444
.long 0x20, 0x4444, 0x48, 0xa448, 0x30, 0xeeee, 0x4c, 0xa44c
.long 0x40, 0x4444, 0x50, 0xa450, 0x50, 0xeeee, 0x54, 0xa454
.long 0x60, 0x4444, 0x58, 0xa458, 0x70, 0xeeee, 0x5c, 0xa45c
.long 0x0, 0x4444, 0x60, 0xa460, 0x10, 0xeeee, 0x64, 0xa464
.long 0x20, 0x4444, 0x68, 0xa468, 0x30, 0xeeee, 0x6c, 0xa46c
.long 0x40, 0x4444, 0x70, 0xa470, 0x50, 0xeeee, 0x74, 0xa474
.long 0x60, 0x4444, 0x78, 0xa478, 0x70, 0xeeee, 0x7c, 0xa47c
.long 0x0, 0x4444, 0x420, 0xb080, 0x10, 0xeeee, 0x424, 0xb084
.long 0x20, 0x4444, 0x428, 0xb088, 0x30, 0xeeee, 0x42c, 0xb08c
.long 0x40, 0x4444, 0x430, 0xb090, 0x50, 0xeeee, 0x434, 0xb094
.long 0x60, 0x4444, 0x438, 0xb098, 0x70, 0xeeee, 0x43c, 0xb09c
.long 0x0, 0x4444, 0x440, 0xb0a0, 0x10, 0xeeee, 0x444, 0xb0a4
.long 0x20, 0x4444, 0x448, 0xb0a8, 0x30, 0xeeee, 0x44c, 0xb0ac
.long 0x40, 0x4444, 0x450, 0xb0b0, 0x50, 0xeeee, 0x454, 0xb0b4
.long 0x60, 0x4444, 0x458, 0xb0b8, 0x70, 0xeeee, 0x45c, 0xb0bc
.long 0x0, 0x4444, 0x460, 0xb0c0, 0x10, 0xeeee, 0x464, 0xb0c4
.long 0x20, 0x4444, 0x468, 0xb0c8, 0x30, 0xeeee, 0x46c, 0xb0cc
.long 0x40, 0x4444, 0x470, 0xb0d0, 0x50, 0xeeee, 0x474, 0xb0d4
.long 0x60, 0x4444, 0x478, 0xb0d8, 0x70, 0xeeee, 0x47c, 0xb0dc
.long 0x0, 0x4444, 0x480, 0xb0e0, 0x10, 0xeeee, 0x484, 0xb0e4
.long 0x20, 0x4444, 0x488, 0xb0e8, 0x30, 0xeeee, 0x48c, 0xb0ec
.long 0x40, 0x4444, 0x490, 0xb0f0, 0x50, 0xeeee, 0x494, 0xb0f4
.long 0x60, 0x4444, 0x498, 0xb0f8, 0x70, 0xeeee, 0x49c, 0xb0fc
.long 0x0, 0x0, 0x0, 0x0, 0x0, 0x0, 0x0, 0x0
.long 0x0, 0x0, 0x0, 0x0, 0x0, 0x0, 0x0, 0x0
.long 0x0, 0x0, 0x0, 0x0, 0x0, 0x0, 0x0, 0x0
.long 0x0, 0x0, 0x0, 0x0, 0x0, 0x0, 0x0, 0x0
.long 0x0, 0x0, 0x0, 0x0, 0x0, 0x0, 0x0, 0x0
.long 0x0, 0x0, 0x0, 0x0, 0x0, 0x0, 0x0, 0x0
.long 0x0, 0x0, 0x0, 0x0, 0x0, 0x0, 0x0, 0x0
.long 0x0, 0x0, 0x0, 0x0, 0x0, 0x0, 0x0, 0x0
.long 0x0, 0x0, 0x0, 0x0, 0x0, 0x0, 0x0, 0x0
.long 0x0, 0x0, 0x0, 0x0, 0x0, 0x0, 0x0, 0x0
.long 0x0, 0x0, 0x0, 0x0, 0x0, 0x0, 0x0, 0x0
.long 0x0, 0x0, 0x0, 0x0, 0x0, 0x0, 0x0, 0x0
.long 0x0, 0x0, 0x0, 0x0, 0x0, 0x0, 0x0, 0x0
.long 0x0, 0x0, 0x0, 0x0, 0x0, 0x0, 0x0, 0x0
.long 0x0, 0x0, 0x0, 0x0, 0x0, 0x0, 0x0, 0x0
.long 0x0, 0x0, 0x0, 0x0, 0x0, 0x0, 0x0, 0x0
.long 0x0, 0x0, 0x0, 0x0, 0x0, 0x0, 0x0, 0x0
.long 0x0, 0x0, 0x0, 0x0, 0x0, 0x0, 0x0, 0x0
.long 0x0, 0x0, 0x0, 0x0, 0x0, 0x0, 0x0, 0x0
.long 0x0, 0x0, 0x0, 0x0, 0x0, 0x0, 0x0, 0x0
.long 0x0, 0x0, 0x0, 0x0, 0x0, 0x0, 0x0, 0x0
.long 0x0, 0x0, 0x0, 0x0, 0x0, 0x0, 0x0, 0x0
.long 0x0, 0x0, 0x0, 0x0, 0x0, 0x0, 0x0, 0x0
.long 0x0, 0x0, 0x0, 0x0, 0x0, 0x0, 0x0, 0x0
.long 0x0, 0x0, 0x0, 0x0, 0x0, 0x0, 0x0, 0x0
.long 0x0, 0x0, 0x0, 0x0, 0x0, 0x0, 0x0, 0x0
.long 0x0, 0x0, 0x0, 0x0, 0x0, 0x0, 0x0, 0x0
.long 0x0, 0x0, 0x0, 0x0, 0x0, 0x0, 0x0, 0x0
.long 0x0, 0x0, 0x0, 0x0, 0x0, 0x0, 0x0, 0x0
.long 0x0, 0x0, 0x0, 0x0, 0x0, 0x0, 0x0, 0x0
.long 0x0, 0x0, 0x0, 0x0, 0x0, 0x0, 0x0, 0x0
.long 0x0, 0x0, 0x0, 0x0, 0x0, 0x0, 0x0, 0x0
.long 0x13320, 0xa9b0, 0xa800, 0x10c00, 0xf320, 0xc120, 0x133b0, 0xb690
.long 0xa890, 0x11920, 0xf3b0, 0xce00, 0x12600, 0xa920, 0xb520, 0x10c90
.long 0xe600, 0xc090, 0x12690, 0xb600, 0xb5b0, 0x119b0, 0xe690, 0xcdb0
.long 0xd5f0, 0x11440, 0x117f0, 0x130d0, 0xf8d0, 0xadf0, 0xd640, 0x12160
.long 0x11840, 0x13df0, 0xf960, 0xbad0, 0xc8d0, 0x113f0, 0x124d0, 0x13160
.long 0xebf0, 0xad60, 0xc960, 0x120d0, 0x12560, 0x13e40, 0xec40, 0xba40
.long 0xefb0, 0x10ed0, 0x117b0, 0x12a40, 0xfa90, 0xdb60, 0xc890, 0x10d60
.long 0x10a90, 0x129f0, 0x13bb0, 0xddf0, 0xf000, 0x11bf0, 0x11520, 0xe960
.long 0xc160, 0xf9b0, 0xc920, 0x11a40, 0x10800, 0xe8d0, 0xc3f0, 0x13a90
.long 0xce40, 0xfa00, 0xfff0, 0xbb20, 0xedb0, 0xdad0, 0xced0, 0x10720
.long 0x10040, 0xc800, 0x14890, 0xde40, 0xf560, 0xfbb0, 0x140d0, 0xbdb0
.long 0xb3f0, 0xec00, 0xf5f0, 0x10890, 0x14160, 0xca90, 0xb760, 0x14720
.long 0x13520, 0xddb0, 0xa520, 0xbe00, 0xf490, 0xe800, 0x13690, 0x10490
.long 0xa5b0, 0xcb20, 0xe7b0, 0x14d00, 0x12800, 0xdd20, 0xb200, 0xbe90
.long 0xf800, 0x14320, 0x129b0, 0x10400, 0xb290, 0xcbb0, 0xeb20, 0x14290
.long 0xd560, 0x10760, 0x112d0, 0xaed0, 0xfb60, 0xeed0, 0xd3f0, 0xe040
.long 0x11360, 0xbbf0, 0xee40, 0x14d00, 0xc840, 0x106d0, 0x11ff0, 0xaf60
.long 0xfed0, 0x149f0, 0xc6d0, 0xdff0, 0x12040, 0xbc40, 0xf1f0, 0x14960
.long 0xbbb0, 0x10cd0, 0xfdb0, 0x12960, 0xd3b0, 0xd9f0, 0x13090, 0x11160
.long 0x13e90, 0x12bf0, 0xbff0, 0xd290, 0xbc00, 0x119f0, 0xfb20, 0xe840
.long 0xac90, 0xd840, 0x13120, 0x11e40, 0x13c00, 0xead0, 0xbe40, 0xabb0
.long 0xcf60, 0x11400, 0x101f0, 0xef20, 0x12e90, 0xdd60, 0xccd0, 0xd320
.long 0x10560, 0x14a00, 0xb640, 0x12d20, 0xf640, 0x115b0, 0x142d0, 0xf1b0
.long 0x121b0, 0xdcd0, 0xf3f0, 0xd490, 0x14640, 0x14c90, 0xb5f0, 0x12000
.long 0x13600, 0xf7b0, 0xa490, 0xb120, 0x10d20, 0xc200, 0x135b0, 0xea90
.long 0xa400, 0x14d00, 0x10db0, 0xcf20, 0x12920, 0xf720, 0xaa00, 0x14000
.long 0x11a00, 0xc290, 0x12890, 0xea00, 0xb720, 0x14090, 0x11a90, 0xcfb0
.long 0xd4d0, 0xfa40, 0x11760, 0x123f0, 0x12cd0, 0xaff0, 0xd440, 0xed60
.long 0x116d0, 0x14d00, 0x12d60, 0xbcd0, 0xc7f0, 0xf9f0, 0x118d0, 0x14ad0
.long 0x139f0, 0xb040, 0xc760, 0xecd0, 0x125f0, 0x14b60, 0x13a40, 0xbd60
.long 0xe290, 0x10e40, 0xc9b0, 0x12760, 0xfe00, 0x13640, 0x10df0, 0xd5b0
.long 0xf090, 0x128d0, 0x13f20, 0x138d0, 0xe320, 0x11b60, 0x12640, 0xafb0
.long 0xfe90, 0x14360, 0x11ad0, 0xd600, 0xe560, 0xad20, 0x13fb0, 0x145f0
.long 0xe000, 0xcd60, 0x10920, 0x102d0, 0xa6d0, 0xebb0, 0xd040, 0x12e00
.long 0xfc00, 0x10240, 0xaa40, 0x14690, 0xe1b0, 0xf440, 0x103f0, 0x12320
.long 0xe7f0, 0xee00, 0xf760, 0x12fb0, 0x144d0, 0x125b0, 0xeb60, 0x14920
.long 0x13720, 0x111b0, 0xdb20, 0xf400, 0x11090, 0x11d20, 0x137b0, 0x11e90
.long 0xda90, 0xe720, 0x11db0, 0x14d00, 0x12a00, 0x11120, 0x10200, 0xf5b0
.long 0x11200, 0x14400, 0x12a90, 0x11e00, 0x101b0, 0xe890, 0x11f20, 0x14490
.long 0xd6d0, 0x12e40, 0x108d0, 0xfc40, 0x13240, 0x13ed0, 0xd760, 0x13b60
.long 0x10840, 0xef60, 0x13f60, 0x14d00, 0xc9f0, 0x12df0, 0xe1f0, 0xfad0
.long 0x132d0, 0x14bf0, 0xca40, 0x13ad0, 0xe160, 0xedf0, 0x13ff0, 0x14c40
.long 0x11690, 0x11040, 0xde90, 0xa640, 0x10b20, 0x136d0, 0x109b0, 0x10ff0
.long 0xa5f0, 0xd1b0, 0x10bb0, 0x143f0, 0x11720, 0x11d60, 0xdf20, 0xb360
.long 0xb000, 0x13360, 0x10a00, 0x11cd0, 0xb2d0, 0xd200, 0xb090, 0x14040
.long 0xcbf0, 0xb920, 0xe400, 0x13560, 0xa560, 0xc490, 0xcc40, 0xc600
.long 0x13840, 0x13200, 0xe640, 0xc720, 0xf2d0, 0xba90, 0xdfb0, 0xc040
.long 0xa8d0, 0x11fb0, 0xf360, 0xc7b0, 0xc360, 0x12db0, 0xe9f0, 0x12200
.long 0x13400, 0xc3b0, 0xdc00, 0x10e00, 0xbfb0, 0xcc00, 0x13490, 0xd090
.long 0xdc90, 0x11b20, 0xcc90, 0x14d00, 0x12720, 0xc320, 0x10320, 0x10fb0
.long 0xc400, 0x14120, 0x127b0, 0xd000, 0x103b0, 0x11c90, 0xd120, 0x141b0
.long 0xd1f0, 0xac40, 0x10ad0, 0x13040, 0xab60, 0xb7f0, 0xd240, 0xb960
.long 0x10b60, 0x13d60, 0xb840, 0x14d00, 0xc4d0, 0xabf0, 0xe3f0, 0x12ed0
.long 0xb0d0, 0x146d0, 0xc560, 0xb8d0, 0xe440, 0x13bf0, 0xbdf0, 0x14760
.long 0xfc90, 0x10f60, 0x11290, 0xa840, 0x13d20, 0x104d0, 0x13db0, 0x111f0
.long 0x105b0, 0xa7f0, 0x13c90, 0xf7f0, 0xfd20, 0x11c40, 0x11320, 0xb560
.long 0xae00, 0xff60, 0x13e00, 0x11ed0, 0x10600, 0xb4d0, 0xadb0, 0xf240
.long 0xcdf0, 0xed20, 0x133f0, 0xbd20, 0x12c40, 0x14bb0, 0xd160, 0x14800
.long 0x13440, 0xca00, 0x11f60, 0x14b20, 0xf4d0, 0xee90, 0xbed0, 0xb890
.long 0x12ad0, 0x12490, 0xf840, 0x149b0, 0xbf60, 0xc5b0, 0x11df0, 0x12400
.long 0x12bb0, 0x13800, 0xd920, 0xc000, 0x14600, 0x14d00, 0x13890, 0x14d00
.long 0xd9b0, 0xcd20, 0xc5f0, 0x14d00, 0x13920, 0x145b0, 0x10000, 0xc1b0
.long 0xb1b0, 0x14d00, 0x12c00, 0x14520, 0x10090, 0xce90, 0xfbf0, 0x14d00
.long 0xc640, 0xd2d0, 0x105f0, 0xae40, 0x14cd0, 0x14d00, 0xd360, 0x14d00
.long 0x10640, 0xbb60, 0xbf20, 0x14d00, 0xd7f0, 0x14840, 0xded0, 0xacd0
.long 0x10290, 0x14d00, 0xcad0, 0x147f0, 0xdf60, 0xb9f0, 0x11000, 0x14d00
.long 0x14a90, 0x11240, 0xf890, 0xa760, 0x14d00, 0xaad0, 0x123b0, 0x110d0
.long 0x139b0, 0xa9f0, 0x14d00, 0x12b20, 0x10c40, 0xae90, 0xf920, 0xb440
.long 0xe0d0, 0x14d00, 0x11960, 0xaf20, 0x13a00, 0xb6d0, 0x131f0, 0x14d00
.long 0x13b20, 0xd0d0, 0x135f0, 0xf120, 0x14d00, 0x12440, 0xac00, 0xcb60
.long 0x13960, 0x14c00, 0xf520, 0x14d00, 0xcff0, 0x12120, 0xc0d0, 0xec90
.long 0xda40, 0xe090, 0xf6d0, 0x12290, 0xc440, 0x147b0, 0x14d00, 0x14d00
.long 0xa600, 0xd800, 0xdbb0, 0x10120, 0x0, 0x0, 0xa7b0, 0xff20
.long 0xda00, 0x14d00, 0x0, 0x0, 0xb320, 0xd890, 0xde00, 0x14200
.long 0x0, 0x0, 0xb490, 0xffb0, 0x10520, 0x143b0, 0x0, 0x0
.long 0x11640, 0x109f0, 0x107f0, 0xe240, 0x0, 0x0, 0x114d0, 0xe2d0
.long 0x10960, 0x14d00, 0x0, 0x0, 0x12360, 0x10a40, 0x10bf0, 0x14a40
.long 0x0, 0x0, 0x121f0, 0xe360, 0xe4d0, 0x148d0, 0x0, 0x0
.long 0xbc90, 0x126d0, 0x12c90, 0xa960, 0x0, 0x0, 0x131b0, 0x12b60
.long 0xb7b0, 0xa4d0, 0x0, 0x0, 0xba00, 0xe5f0, 0xa440, 0xaa90
.long 0x0, 0x0, 0x12f20, 0xea40, 0xb160, 0xab20, 0x0, 0x0
.long 0x10360, 0x11600, 0xd720, 0x134d0, 0x0, 0x0, 0x100d0, 0xd520
.long 0x11800, 0x13760, 0x0, 0x0, 0x14440, 0x11890, 0x137f0, 0x12520
.long 0x0, 0x0, 0x141f0, 0xd7b0, 0xc2d0, 0x12090, 0x0, 0x0
.long 0xa720, 0xf200, 0xf600, 0x10f20, 0x0, 0x0, 0xa690, 0xe520
.long 0xf690, 0x11c00, 0x0, 0x0, 0xb400, 0xf290, 0xe920, 0x10e90
.long 0x0, 0x0, 0xb3b0, 0xe5b0, 0xe9b0, 0x11bb0, 0x0, 0x0
.long 0x115f0, 0xfcd0, 0xfdf0, 0x12ff0, 0x0, 0x0, 0x11560, 0xeff0
.long 0xfe40, 0x13cd0, 0x0, 0x0, 0x122d0, 0xfd60, 0xf0d0, 0x12f60
.long 0x0, 0x0, 0x12240, 0xf040, 0xf160, 0x13c40, 0x0, 0x0
.long 0xe3b0, 0x12840, 0x11490, 0xdc40, 0x0, 0x0, 0x127f0, 0xd690
.long 0x107b0, 0xdbf0, 0x0, 0x0, 0xe120, 0xe760, 0xc240, 0x113b0
.long 0x0, 0x0, 0xe6d0, 0xd400, 0xc1f0, 0x10690, 0x0, 0x0
.long 0xe200, 0x10160, 0xb9b0, 0xd8d0, 0x0, 0x0, 0x10440, 0x13000
.long 0xc690, 0xd960, 0x0, 0x0, 0xe490, 0x14240, 0xb1f0, 0xb800
.long 0x0, 0x0, 0x14560, 0x13290, 0xb240, 0xc520, 0x0, 0x0
.long 0x0, 0x0, 0x0, 0x0, 0x0, 0x0, 0x0, 0x0
.long 0x0, 0x0, 0x0, 0x0, 0x0, 0x0, 0x0, 0x0
.long 0x0, 0x0, 0x0, 0x0, 0x0, 0x0, 0x0, 0x0
.long 0x0, 0x0, 0x0, 0x0, 0x0, 0x0, 0x0, 0x0
.long 0x0, 0x0, 0x0, 0x0, 0x0, 0x0, 0x0, 0x0
.long 0x0, 0x0, 0x0, 0x0, 0x0, 0x0, 0x0, 0x0
.long 0x0, 0x0, 0x0, 0x0, 0x0, 0x0, 0x0, 0x0
.long 0x0, 0x0, 0x0, 0x0, 0x0, 0x0, 0x0, 0x0
.long 0x0, 0x0, 0x0, 0x0, 0x0, 0x0, 0x0, 0x0
.long 0x0, 0x0, 0x0, 0x0, 0x0, 0x0, 0x0, 0x0
.long 0x0, 0x0, 0x0, 0x0, 0x0, 0x0, 0x0, 0x0
.long 0x0, 0x0, 0x0, 0x0, 0x0, 0x0, 0x0, 0x0
.long 0x0, 0x0, 0x0, 0x0, 0x0, 0x0, 0x0, 0x0
.long 0x0, 0x0, 0x0, 0x0, 0x0, 0x0, 0x0, 0x0
.long 0x0, 0x0, 0x0, 0x0, 0x0, 0x0, 0x0, 0x0
.long 0x0, 0x0, 0x0, 0x0, 0x0, 0x0, 0x0, 0x0
.long 0x0, 0x0, 0x0, 0x0, 0x0, 0x0, 0x0, 0x0
.long 0x0, 0x0, 0x0, 0x0, 0x0, 0x0, 0x0, 0x0
.long 0x0, 0x0, 0x0, 0x0, 0x0, 0x0, 0x0, 0x0
.long 0x0, 0x0, 0x0, 0x0, 0x0, 0x0, 0x0, 0x0
.long 0x0, 0x0, 0x0, 0x0, 0x0, 0x0, 0x0, 0x0
.long 0x0, 0x0, 0x0, 0x0, 0x0, 0x0, 0x0, 0x0
.long 0x0, 0x0, 0x0, 0x0, 0x0, 0x0, 0x0, 0x0
.long 0x0, 0x0, 0x0, 0x0, 0x0, 0x0, 0x0, 0x0
.long 0x0, 0x0, 0x0, 0x0, 0x0, 0x0, 0x0, 0x0
.long 0x0, 0x0, 0x0, 0x0, 0x0, 0x0, 0x0, 0x0
.long 0x0, 0x0, 0x0, 0x0, 0x0, 0x0, 0x0, 0x0
.long 0x0, 0x0, 0x0, 0x0, 0x0, 0x0, 0x0, 0x0
.long 0x0, 0x0, 0x0, 0x0, 0x0, 0x0, 0x0, 0x0
.long 0x0, 0x0, 0x0, 0x0, 0x0, 0x0, 0x0, 0x0
.long 0x0, 0x0, 0x0, 0x0, 0x0, 0x0, 0x0, 0x0
.long 0x0, 0x0, 0x0, 0x0, 0x0, 0x0, 0x0, 0x0
.section .rodata,"a"
.p2align 6
.amdhsa_kernel standalone__deep_cross_xdeepfm__recsys_kernel
  .amdhsa_next_free_vgpr 256
  .amdhsa_next_free_sgpr 102
  .amdhsa_accum_offset 256
  .amdhsa_group_segment_fixed_size 0
  .amdhsa_kernarg_size 88
  .amdhsa_user_sgpr_count 2
  .amdhsa_user_sgpr_kernarg_segment_ptr 1
  .amdhsa_system_sgpr_workgroup_id_x 1
  .amdhsa_float_denorm_mode_32 3
.end_amdhsa_kernel
```

```asm
; @launch grid=(256,1,1) block=(512,1,1) lds=163840
.amdgcn_target "amdgcn-amd-amdhsa--gfx950"
.text
.globl standalone__deep_cross_xdeepfm__recsys_kernel
.p2align 8
.type standalone__deep_cross_xdeepfm__recsys_kernel,@function
standalone__deep_cross_xdeepfm__recsys_kernel:
  s_cmp_ge_u32 s2, 256
  s_cbranch_scc1 L_end
  s_load_dwordx16 s[4:19], s[0:1], 0
  s_load_dwordx4 s[20:23], s[0:1], 64
  s_load_dwordx2 s[24:25], s[0:1], 80
  v_lshrrev_b32 v1, 6, v0
  s_getpc_b64 s[92:93]
L_pc:
  s_and_b32 s68, s2, 0xf8
  v_add_u32 v2, s68, v1
  v_and_b32_e64 v3, 32, v0
  v_lshl_add_u32 v2, v3, 3, v2
  v_lshlrev_b32 v2, 7, v2
  v_min_u32 v2, L_end-L_pc, v2
  v_mov_b32 v3, s93
  v_add_co_u32 v2, vcc, s92, v2
  s_nop 1
  v_addc_co_u32 v3, vcc, 0, v3, vcc
  global_load_dword v251, v[2:3], off
  v_and_b32_e64 v0, 63, v0
  v_readfirstlane_b32 s3, v1
  s_and_b32 s68, s2, 7
  s_lshr_b32 s69, s2, 3
  s_and_b32 s80, s2, 0xf8
  s_add_u32 s80, s80, s3
  s_lshl_b32 s80, s80, 0
  s_min_u32 s70, s68, 1
  s_add_u32 s71, s69, s70
  s_cmp_ge_u32 s71, 22
  s_cbranch_scc1 L_cin
  s_mul_i32 s68, s68, 21
  s_add_u32 s68, s68, s71
  s_mul_i32 s26, s68, 5042
  s_lshr_b32 s26, s26, 16
  s_mul_i32 s69, s26, 13
  s_sub_u32 s27, s68, s69
  s_lshl_b32 s77, s27, 8
  s_mul_i32 s71, s26, 320
  v_lshrrev_b32 v116, 4, v0
  v_lshlrev_b32 v11, 4, v0
  s_and_b32 s79, s3, 3
  s_cmp_lt_u32 s3, 4
  s_cbranch_scc1 L_cmp
  s_lshr_b32 s68, s79, 1
  s_mul_i32 s68, s68, 20
  s_and_b32 s69, s79, 1
  s_add_u32 s68, s68, s69
  s_lshl_b32 s76, s68, 10
  s_mul_i32 s78, s71, 104
  s_mul_i32 s68, s68, 832
  s_add_u32 s94, s78, s68
  v_mul_u32_u24 v118, 48, v116
  v_sub_u32 v12, v11, v118
  s_add_u32 s95, s94, 3328
  s_add_u32 s96, s94, 6656
  s_add_u32 s97, s94, 9984
  s_add_u32 s98, s94, 13312
  s_and_b32 s70, s79, 1
  s_lshl_b32 s70, s70, 3
  v_lshlrev_b32 v117, 1, v116
  v_or_b32 v117, s70, v117
  v_xor_b32 v117, v117, v0
  v_and_b32_e64 v117, 15, v117
  v_mul_u32_u24 v4, 3328, v116
  v_lshl_add_u32 v4, v117, 4, v4
  v_add_u32 v5, 13312, v4
  s_mul_i32 s74, s79, 26624
  s_add_u32 s74, s74, s77
  s_lshl_b32 s75, s79, 11
  s_waitcnt lgkmcnt(0)
  s_mov_b32 s28, s4
  s_and_b32 s29, s5, 0xffff
  s_mov_b32 s30, 425984
  s_mov_b32 s31, 0x20000
  buffer_load_dwordx4 v[16:19], v12, s[28:31], s94 offen offset:0
  s_mov_b32 s32, s6
  s_and_b32 s33, s7, 0xffff
  s_mov_b32 s34, 12800000
  s_mov_b32 s35, 0x20000
  s_mov_b32 s44, s12
  s_and_b32 s45, s13, 0xffff
  s_mov_b32 s46, 5537792
  s_mov_b32 s47, 0x20000
  s_add_u32 m0, s75, 122880
  s_nop 0
  buffer_load_dwordx4 v4, s[44:47], s74 offen lds
  s_add_u32 m0, s75, 123904
  s_nop 0
  buffer_load_dwordx4 v5, s[44:47], s74 offen lds
  s_add_u32 s74, s74, 106496
  s_add_u32 m0, s75, 131072
  s_nop 0
  buffer_load_dwordx4 v4, s[44:47], s74 offen lds
  s_add_u32 m0, s75, 132096
  s_nop 0
  buffer_load_dwordx4 v5, s[44:47], s74 offen lds
  s_add_u32 s74, s74, 106496
  buffer_load_dwordx4 v[20:23], v12, s[28:31], s94 offen offset:1664
  buffer_load_dwordx4 v[24:27], v12, s[28:31], s95 offen offset:0
  buffer_load_dwordx4 v[28:31], v12, s[28:31], s95 offen offset:1664
  buffer_load_dwordx4 v[32:35], v12, s[28:31], s96 offen offset:0
  buffer_load_dwordx4 v[36:39], v12, s[28:31], s96 offen offset:1664
  buffer_load_dwordx4 v[40:43], v12, s[28:31], s97 offen offset:0
  buffer_load_dwordx4 v[44:47], v12, s[28:31], s97 offen offset:1664
  buffer_load_dwordx4 v[48:51], v12, s[28:31], s98 offen offset:0
  buffer_load_dwordx4 v[52:55], v12, s[28:31], s98 offen offset:1664
  s_lshl_b32 s70, s69, 6
  v_and_b32 v118, 7, v0
  v_xor_b32 v118, v118, v116
  v_lshlrev_b32 v118, 4, v118
  v_xor_b32 v2, s70, v118
  v_xor_b32 v3, 64, v2
  s_mov_b32 s72, 0
  s_mul_i32 s70, s79, 13
  s_add_u32 s70, s70, s27
  s_min_u32 s70, s70, 39
  s_lshl_b32 s70, s70, 3
  s_add_u32 s70, s70, s71
  s_mul_i32 s84, s70, 104
  v_lshrrev_b32 v118, 2, v0
  v_min_u32 v118, 7, v118
  v_mul_u32_u24 v118, 104, v118
  v_and_b32 v117, 3, v0
  v_lshl_add_u32 v7, v117, 2, v118
  s_lshl_b32 s70, s26, 2
  s_add_u32 s70, s70, s79
  s_add_u32 s70, s70, 384
  s_mul_i32 s85, s70, 3328
  s_add_u32 s85, s85, s77
  s_mov_b32 s70, 173056
  v_lshrrev_b32 v118, 1, v0
  v_mul_lo_u32 v118, s70, v118
  v_and_b32 v117, 1, v0
  v_lshl_add_u32 v76, v117, 7, v118
  s_mov_b32 s52, s16
  s_and_b32 s53, s17, 0xffff
  s_mov_b32 s54, 3328
  s_mov_b32 s55, 0x20000
  s_mul_i32 s70, s79, 2560
  s_add_u32 s70, s70, L_tail-L_pc
  v_lshlrev_b32 v8, 7, v0
  v_add_u32 v8, s70, v8
  v_mov_b32 v9, s93
  v_add_co_u32 v8, vcc, s92, v8
  s_nop 1
  v_addc_co_u32 v9, vcc, 0, v9, vcc
  s_waitcnt vmcnt(13)
  v_lshlrev_b32 v16, 7, v16
  v_lshlrev_b32 v18, 7, v18
  v_lshlrev_b32 v17, 7, v17
  v_lshlrev_b32_e64 v19, 7, v19
  v_add_u32_dpp v56, v16, v2 row_newbcast:0 row_mask:0xf bank_mask:0x3
  s_nop 1
  v_add_u32_dpp v56, v18, v2 row_newbcast:6 row_mask:0xf bank_mask:0xc
  s_add_u32 m0, s76, 0
  s_nop 0
  buffer_load_dwordx4 v56, s[32:35], 0 offen lds
  s_waitcnt vmcnt(10)
  s_barrier
  s_waitcnt vmcnt(9)
  v_lshlrev_b32 v20, 7, v20
  v_lshlrev_b32 v22, 7, v22
  v_lshlrev_b32 v21, 7, v21
  v_lshlrev_b32 v23, 7, v23
  v_add_u32_dpp v57, v20, v2 row_newbcast:0 row_mask:0xf bank_mask:0x3
  s_nop 1
  v_add_u32_dpp v57, v22, v2 row_newbcast:6 row_mask:0xf bank_mask:0xc
  s_add_u32 m0, s76, 2048
  s_nop 0
  buffer_load_dwordx4 v57, s[32:35], 0 offen lds
  s_waitcnt vmcnt(9)
  v_lshlrev_b32 v24, 7, v24
  v_lshlrev_b32 v26, 7, v26
  v_lshlrev_b32 v25, 7, v25
  v_lshlrev_b32 v27, 7, v27
  v_add_u32_dpp v58, v24, v2 row_newbcast:0 row_mask:0xf bank_mask:0x3
  s_nop 1
  v_add_u32_dpp v58, v26, v2 row_newbcast:6 row_mask:0xf bank_mask:0xc
  s_add_u32 m0, s76, 4096
  s_nop 0
  buffer_load_dwordx4 v58, s[32:35], 0 offen lds
  s_waitcnt vmcnt(9)
  v_lshlrev_b32 v28, 7, v28
  v_lshlrev_b32 v30, 7, v30
  v_lshlrev_b32 v29, 7, v29
  v_lshlrev_b32_e64 v31, 7, v31
  v_add_u32_dpp v59, v28, v2 row_newbcast:0 row_mask:0xf bank_mask:0x3
  s_nop 1
  v_add_u32_dpp v59, v30, v2 row_newbcast:6 row_mask:0xf bank_mask:0xc
  s_add_u32 m0, s76, 6144
  s_nop 0
  buffer_load_dwordx4 v59, s[32:35], 0 offen lds
  s_waitcnt vmcnt(9)
  v_lshlrev_b32 v32, 7, v32
  v_lshlrev_b32 v34, 7, v34
  v_lshlrev_b32 v33, 7, v33
  v_lshlrev_b32_e64 v35, 7, v35
  v_add_u32_dpp v60, v32, v2 row_newbcast:0 row_mask:0xf bank_mask:0x3
  s_nop 1
  v_add_u32_dpp v60, v34, v2 row_newbcast:6 row_mask:0xf bank_mask:0xc
  s_add_u32 m0, s76, 8192
  s_nop 0
  buffer_load_dwordx4 v60, s[32:35], 0 offen lds
  s_waitcnt vmcnt(9)
  v_lshlrev_b32 v36, 7, v36
  v_lshlrev_b32 v38, 7, v38
  v_lshlrev_b32 v37, 7, v37
  v_lshlrev_b32_e64 v39, 7, v39
  v_add_u32_dpp v61, v36, v2 row_newbcast:0 row_mask:0xf bank_mask:0x3
  s_nop 1
  v_add_u32_dpp v61, v38, v2 row_newbcast:6 row_mask:0xf bank_mask:0xc
  s_add_u32 m0, s76, 10240
  s_nop 0
  buffer_load_dwordx4 v61, s[32:35], 0 offen lds
  s_waitcnt vmcnt(9)
  v_lshlrev_b32 v40, 7, v40
  v_lshlrev_b32 v42, 7, v42
  v_lshlrev_b32 v41, 7, v41
  v_lshlrev_b32_e64 v43, 7, v43
  v_add_u32_dpp v62, v40, v2 row_newbcast:0 row_mask:0xf bank_mask:0x3
  s_nop 1
  v_add_u32_dpp v62, v42, v2 row_newbcast:6 row_mask:0xf bank_mask:0xc
  s_add_u32 m0, s76, 12288
  s_nop 0
  buffer_load_dwordx4 v62, s[32:35], 0 offen lds
  s_waitcnt vmcnt(9)
  v_lshlrev_b32 v44, 7, v44
  v_lshlrev_b32 v46, 7, v46
  v_lshlrev_b32 v45, 7, v45
  v_lshlrev_b32_e64 v47, 7, v47
  v_add_u32_dpp v63, v44, v2 row_newbcast:0 row_mask:0xf bank_mask:0x3
  s_nop 1
  v_add_u32_dpp v63, v46, v2 row_newbcast:6 row_mask:0xf bank_mask:0xc
  s_add_u32 m0, s76, 14336
  s_nop 0
  buffer_load_dwordx4 v63, s[32:35], 0 offen lds
  s_waitcnt vmcnt(9)
  v_lshlrev_b32 v48, 7, v48
  v_lshlrev_b32 v50, 7, v50
  v_lshlrev_b32 v49, 7, v49
  v_lshlrev_b32_e64 v51, 7, v51
  v_add_u32_dpp v64, v48, v2 row_newbcast:0 row_mask:0xf bank_mask:0x3
  s_nop 1
  v_add_u32_dpp v64, v50, v2 row_newbcast:6 row_mask:0xf bank_mask:0xc
  s_add_u32 m0, s76, 16384
  s_nop 0
  buffer_load_dwordx4 v64, s[32:35], 0 offen lds
  s_waitcnt vmcnt(9)
  v_lshlrev_b32 v52, 7, v52
  v_lshlrev_b32 v54, 7, v54
  v_lshlrev_b32 v53, 7, v53
  v_lshlrev_b32_e64 v55, 7, v55
  v_add_u32_dpp v65, v52, v2 row_newbcast:0 row_mask:0xf bank_mask:0x3
  s_nop 1
  v_add_u32_dpp v65, v54, v2 row_newbcast:6 row_mask:0xf bank_mask:0xc
  s_add_u32 m0, s76, 18432
  s_nop 0
  buffer_load_dwordx4 v65, s[32:35], 0 offen lds
  v_add_u32_dpp v56, v17, v2 row_newbcast:0 row_mask:0xf bank_mask:0x3
  s_nop 1
  v_add_u32_dpp v56, v19, v2 row_newbcast:6 row_mask:0xf bank_mask:0xc
  s_add_u32 m0, s76, 40960
  s_nop 0
  buffer_load_dwordx4 v56, s[32:35], 0 offen lds
  v_add_u32_dpp v57, v21, v2 row_newbcast:0 row_mask:0xf bank_mask:0x3
  s_nop 1
  v_add_u32_dpp v57, v23, v2 row_newbcast:6 row_mask:0xf bank_mask:0xc
  s_add_u32 m0, s76, 43008
  s_nop 0
  buffer_load_dwordx4 v57, s[32:35], 0 offen lds
  v_add_u32_dpp v58, v25, v2 row_newbcast:0 row_mask:0xf bank_mask:0x3
  s_nop 1
  v_add_u32_dpp v58, v27, v2 row_newbcast:6 row_mask:0xf bank_mask:0xc
  s_add_u32 m0, s76, 45056
  s_nop 0
  buffer_load_dwordx4 v58, s[32:35], 0 offen lds
  v_add_u32_dpp v59, v29, v2 row_newbcast:0 row_mask:0xf bank_mask:0x3
  s_nop 1
  v_add_u32_dpp v59, v31, v2 row_newbcast:6 row_mask:0xf bank_mask:0xc
  s_add_u32 m0, s76, 47104
  s_nop 0
  buffer_load_dwordx4 v59, s[32:35], 0 offen lds
  v_add_u32_dpp v60, v33, v2 row_newbcast:0 row_mask:0xf bank_mask:0x3
  s_nop 1
  v_add_u32_dpp v60, v35, v2 row_newbcast:6 row_mask:0xf bank_mask:0xc
  s_add_u32 m0, s76, 49152
  s_nop 0
  buffer_load_dwordx4 v60, s[32:35], 0 offen lds
  s_waitcnt vmcnt(12)
  s_barrier
  v_add_u32_dpp v61, v37, v2 row_newbcast:0 row_mask:0xf bank_mask:0x3
  s_nop 1
  v_add_u32_dpp v61, v39, v2 row_newbcast:6 row_mask:0xf bank_mask:0xc
  s_add_u32 m0, s76, 51200
  s_nop 0
  buffer_load_dwordx4 v61, s[32:35], 0 offen lds
  v_add_u32_dpp v62, v41, v2 row_newbcast:0 row_mask:0xf bank_mask:0x3
  s_nop 1
  v_add_u32_dpp v62, v43, v2 row_newbcast:6 row_mask:0xf bank_mask:0xc
  s_add_u32 m0, s76, 53248
  s_nop 0
  buffer_load_dwordx4 v62, s[32:35], 0 offen lds
  v_add_u32_dpp v63, v45, v2 row_newbcast:0 row_mask:0xf bank_mask:0x3
  s_nop 1
  v_add_u32_dpp v63, v47, v2 row_newbcast:6 row_mask:0xf bank_mask:0xc
  s_add_u32 m0, s76, 55296
  s_nop 0
  buffer_load_dwordx4 v63, s[32:35], 0 offen lds
  v_add_u32_dpp v64, v49, v2 row_newbcast:0 row_mask:0xf bank_mask:0x3
  s_nop 1
  v_add_u32_dpp v64, v51, v2 row_newbcast:6 row_mask:0xf bank_mask:0xc
  s_add_u32 m0, s76, 57344
  s_nop 0
  buffer_load_dwordx4 v64, s[32:35], 0 offen lds
  v_add_u32_dpp v65, v53, v2 row_newbcast:0 row_mask:0xf bank_mask:0x3
  s_nop 1
  v_add_u32_dpp v65, v55, v2 row_newbcast:6 row_mask:0xf bank_mask:0xc
  s_add_u32 m0, s76, 59392
  s_nop 0
  buffer_load_dwordx4 v65, s[32:35], 0 offen lds
  s_waitcnt vmcnt(10)
  s_barrier
  s_add_u32 m0, s75, 139264
  s_nop 0
  buffer_load_dwordx4 v4, s[44:47], s74 offen lds
  s_add_u32 m0, s75, 140288
  s_nop 0
  buffer_load_dwordx4 v5, s[44:47], s74 offen lds
  s_add_u32 s74, s74, 106496
  v_add_u32_dpp v56, v18, v2 row_newbcast:0 row_mask:0xf bank_mask:0x3
  v_add_u32_dpp v57, v22, v2 row_newbcast:0 row_mask:0xf bank_mask:0x3
  v_add_u32_dpp v58, v26, v2 row_newbcast:0 row_mask:0xf bank_mask:0x3
  v_add_u32_dpp v59, v30, v2 row_newbcast:0 row_mask:0xf bank_mask:0x3
  v_add_u32_dpp v60, v34, v2 row_newbcast:0 row_mask:0xf bank_mask:0x3
  v_add_u32_dpp v61, v38, v2 row_newbcast:0 row_mask:0xf bank_mask:0x3
  v_add_u32_dpp v62, v42, v2 row_newbcast:0 row_mask:0xf bank_mask:0x3
  v_add_u32_dpp v63, v46, v2 row_newbcast:0 row_mask:0xf bank_mask:0x3
  v_add_u32_dpp v64, v50, v2 row_newbcast:0 row_mask:0xf bank_mask:0x3
  v_add_u32_dpp v65, v54, v2 row_newbcast:0 row_mask:0xf bank_mask:0x3
  v_add_u32_dpp v56, v16, v2 row_newbcast:7 row_mask:0xf bank_mask:0xc
  v_add_u32_dpp v57, v20, v2 row_newbcast:7 row_mask:0xf bank_mask:0xc
  v_add_u32_dpp v58, v24, v2 row_newbcast:7 row_mask:0xf bank_mask:0xc
  v_add_u32_dpp v59, v28, v2 row_newbcast:7 row_mask:0xf bank_mask:0xc
  v_add_u32_dpp v60, v32, v2 row_newbcast:7 row_mask:0xf bank_mask:0xc
  v_add_u32_dpp v61, v36, v2 row_newbcast:7 row_mask:0xf bank_mask:0xc
  v_add_u32_dpp v62, v40, v2 row_newbcast:7 row_mask:0xf bank_mask:0xc
  v_add_u32_dpp v63, v44, v2 row_newbcast:7 row_mask:0xf bank_mask:0xc
  v_add_u32_dpp v64, v48, v2 row_newbcast:7 row_mask:0xf bank_mask:0xc
  v_add_u32_dpp v65, v52, v2 row_newbcast:7 row_mask:0xf bank_mask:0xc
  s_add_u32 m0, s75, 122880
  s_nop 0
  buffer_load_dwordx4 v4, s[44:47], s74 offen lds
  s_add_u32 m0, s75, 123904
  s_nop 0
  buffer_load_dwordx4 v5, s[44:47], s74 offen lds
  s_add_u32 s74, s74, 106496
  s_add_u32 m0, s76, 81920
  s_nop 0
  buffer_load_dwordx4 v56, s[32:35], 0 offen lds
  s_add_u32 m0, s76, 83968
  s_nop 0
  buffer_load_dwordx4 v57, s[32:35], 0 offen lds
  s_add_u32 m0, s76, 86016
  s_nop 0
  buffer_load_dwordx4 v58, s[32:35], 0 offen lds
  s_add_u32 m0, s76, 88064
  s_nop 0
  buffer_load_dwordx4 v59, s[32:35], 0 offen lds
  s_add_u32 m0, s76, 90112
  s_nop 0
  buffer_load_dwordx4 v60, s[32:35], 0 offen lds
  s_waitcnt vmcnt(7)
  s_barrier
  s_add_u32 m0, s76, 92160
  s_nop 0
  buffer_load_dwordx4 v61, s[32:35], 0 offen lds
  s_add_u32 m0, s76, 94208
  s_nop 0
  buffer_load_dwordx4 v62, s[32:35], 0 offen lds
  s_add_u32 m0, s76, 96256
  s_nop 0
  buffer_load_dwordx4 v63, s[32:35], 0 offen lds
  s_add_u32 m0, s76, 98304
  s_nop 0
  buffer_load_dwordx4 v64, s[32:35], 0 offen lds
  s_add_u32 m0, s76, 100352
  s_nop 0
  buffer_load_dwordx4 v65, s[32:35], 0 offen lds
  v_add_u32_dpp v56, v19, v2 row_newbcast:0 row_mask:0xf bank_mask:0x3
  v_add_u32_dpp v57, v23, v2 row_newbcast:0 row_mask:0xf bank_mask:0x3
  v_add_u32_dpp v58, v27, v2 row_newbcast:0 row_mask:0xf bank_mask:0x3
  v_add_u32_dpp v59, v31, v2 row_newbcast:0 row_mask:0xf bank_mask:0x3
  v_add_u32_dpp v60, v35, v2 row_newbcast:0 row_mask:0xf bank_mask:0x3
  v_add_u32_dpp v56, v17, v2 row_newbcast:7 row_mask:0xf bank_mask:0xc
  v_add_u32_dpp v57, v21, v2 row_newbcast:7 row_mask:0xf bank_mask:0xc
  v_add_u32_dpp v58, v25, v2 row_newbcast:7 row_mask:0xf bank_mask:0xc
  v_add_u32_dpp v59, v29, v2 row_newbcast:7 row_mask:0xf bank_mask:0xc
  v_add_u32_dpp v60, v33, v2 row_newbcast:7 row_mask:0xf bank_mask:0xc
  s_setprio 0
  s_branch L_ld_in
L_cmp:
  s_mul_i32 s70, s3, 13
  v_min_u32 v118, 12, v0
  v_add_u32 v118, s70, v118
  v_lshrrev_b32 v117, 1, v118
  v_mul_u32_u24 v117, 96, v117
  v_lshl_add_u32 v118, v118, 2, v117
  s_mul_i32 s78, s27, 25
  s_min_u32 s78, s78, 294
  s_add_u32 s78, s78, s71
  s_mul_i32 s78, s78, 104
  s_waitcnt lgkmcnt(0)
  s_mov_b32 s28, s4
  s_and_b32 s29, s5, 0xffff
  s_mov_b32 s30, 425984
  s_mov_b32 s31, 0x20000
  s_mov_b32 s32, s6
  s_and_b32 s33, s7, 0xffff
  s_mov_b32 s34, 12800000
  s_mov_b32 s35, 0x20000
  s_mov_b32 s48, s14
  s_and_b32 s49, s15, 0xffff
  s_mov_b32 s50, 3328
  s_mov_b32 s51, 0x20000
  s_mov_b32 m0, 147456
  s_mov_b64 exec, 0xffff
  buffer_load_dwordx4 v11, s[48:51], s77 offen lds
  s_mov_b64 exec, -1
  s_and_b32 s68, s3, 1
  s_lshr_b32 s69, s3, 1
  v_bfe_u32 v117, v0, 2, 2
  v_lshl_add_u32 v118, v116, 3, v117
  v_lshlrev_b32 v118, 8, v118
  v_bfe_u32 v117, v0, 2, 3
  s_lshl_b32 s70, s69, 2
  v_xor_b32 v117, s70, v117
  v_lshl_add_u32 v118, v117, 5, v118
  v_and_b32_e64 v117, 3, v0
  v_lshl_add_u32 v118, v117, 3, v118
  v_add_u32 v1, 122880, v118
  v_xor_b32 v2, 32, v1
  v_xor_b32 v3, 64, v1
  v_xor_b32 v4, 96, v1
  s_lshl_b32 s70, s69, 7
  s_add_u32 s70, s70, 147456
  v_lshlrev_b32 v118, 3, v116
  v_add_u32 v9, s70, v118
  v_and_b32 v118, 15, v0
  v_lshlrev_b32 v118, 7, v118
  v_bfe_u32 v117, v0, 1, 3
  v_xor_b32 v117, v117, v116
  v_lshl_add_u32 v118, v117, 4, v118
  s_mul_i32 s70, s68, 20480
  v_add_u32 v5, s70, v118
  v_xor_b32 v7, 64, v5
  v_add_u32 v6, 81920, v5
  v_add_u32 v8, 81920, v7
  s_mul_i32 s70, s3, 640
  s_add_u32 s70, s70, 147968
  v_and_b32 v118, 15, v0
  v_lshlrev_b32 v118, 2, v118
  v_add_u32 v118, s70, v118
  v_lshrrev_b32_e64 v117, 5, v0
  v_lshl_add_u32 v118, v117, 6, v118
  v_bfe_u32 v117, v0, 4, 1
  v_lshl_add_u32 v10, v117, 7, v118
  s_mov_b32 s72, 0
  v_mov_b32 v12, 0xc0135761
  v_mov_b32 v13, 0xc0135761
  v_mov_b32 v14, 0xbdd2d3e8
  v_mov_b32 v15, 0xbdd2d3e8
  v_mov_b32 v248, 1.0
  v_mov_b32 v249, 1.0
  s_waitcnt vmcnt(0)
  ds_read_b64 v[18:19], v9 offset:0
  ds_read_b64 v[22:23], v9 offset:32
  ds_read_b64 v[26:27], v9 offset:64
  ds_read_b64 v[30:31], v9 offset:96
  s_waitcnt lgkmcnt(3)
  v_lshlrev_b32_e64 v16, 16, v18
  v_and_b32 v17, 0xffff0000, v18
  v_lshlrev_b32 v18, 16, v19
  v_and_b32 v19, 0xffff0000, v19
  s_waitcnt lgkmcnt(2)
  v_lshlrev_b32 v20, 16, v22
  v_and_b32 v21, 0xffff0000, v22
  v_lshlrev_b32 v22, 16, v23
  v_and_b32 v23, 0xffff0000, v23
  s_waitcnt lgkmcnt(1)
  v_lshlrev_b32 v24, 16, v26
  v_and_b32 v25, 0xffff0000, v26
  v_lshlrev_b32 v26, 16, v27
  v_and_b32 v27, 0xffff0000, v27
  s_waitcnt lgkmcnt(0)
  v_lshlrev_b32 v28, 16, v30
  v_and_b32 v29, 0xffff0000, v30
  v_lshlrev_b32 v30, 16, v31
  v_and_b32 v31, 0xffff0000, v31
  v_mov_b64 v[88:89], v[16:17]
  v_mov_b64 v[90:91], v[18:19]
  v_mov_b64 v[92:93], v[20:21]
  v_mov_b64 v[94:95], v[22:23]
  v_mov_b64 v[96:97], v[24:25]
  v_mov_b64 v[98:99], v[26:27]
  v_mov_b64 v[100:101], v[28:29]
  v_mov_b64 v[102:103], v[30:31]
  v_mov_b64 v[104:105], v[16:17]
  v_mov_b64 v[106:107], v[18:19]
  v_mov_b64 v[108:109], v[20:21]
  v_mov_b64 v[110:111], v[22:23]
  v_mov_b64 v[112:113], v[24:25]
  v_mov_b64 v[114:115], v[26:27]
  v_mov_b64 v[116:117], v[28:29]
  v_mov_b64 v[118:119], v[30:31]
  v_mov_b64 v[120:121], v[16:17]
  v_mov_b64 v[122:123], v[18:19]
  v_mov_b64 v[124:125], v[20:21]
  v_mov_b64 v[126:127], v[22:23]
  v_mov_b64 v[128:129], v[24:25]
  v_mov_b64 v[130:131], v[26:27]
  v_mov_b64 v[132:133], v[28:29]
  v_mov_b64 v[134:135], v[30:31]
  v_mov_b64 v[136:137], v[16:17]
  v_mov_b64 v[138:139], v[18:19]
  v_mov_b64 v[140:141], v[20:21]
  v_mov_b64 v[142:143], v[22:23]
  v_mov_b64 v[144:145], v[24:25]
  v_mov_b64 v[146:147], v[26:27]
  v_mov_b64 v[148:149], v[28:29]
  v_mov_b64 v[150:151], v[30:31]
  v_mov_b64 v[152:153], v[16:17]
  v_mov_b64 v[154:155], v[18:19]
  v_mov_b64 v[156:157], v[20:21]
  v_mov_b64 v[158:159], v[22:23]
  v_mov_b64 v[160:161], v[24:25]
  v_mov_b64 v[162:163], v[26:27]
  v_mov_b64 v[164:165], v[28:29]
  v_mov_b64 v[166:167], v[30:31]
  v_mov_b64 v[168:169], v[16:17]
  v_mov_b64 v[170:171], v[18:19]
  v_mov_b64 v[172:173], v[20:21]
  v_mov_b64 v[174:175], v[22:23]
  v_mov_b64 v[176:177], v[24:25]
  v_mov_b64 v[178:179], v[26:27]
  v_mov_b64 v[180:181], v[28:29]
  v_mov_b64 v[182:183], v[30:31]
  v_mov_b64 v[184:185], v[16:17]
  v_mov_b64 v[186:187], v[18:19]
  v_mov_b64 v[188:189], v[20:21]
  v_mov_b64 v[190:191], v[22:23]
  v_mov_b64 v[192:193], v[24:25]
  v_mov_b64 v[194:195], v[26:27]
  v_mov_b64 v[196:197], v[28:29]
  v_mov_b64 v[198:199], v[30:31]
  v_mov_b64 v[200:201], v[16:17]
  v_mov_b64 v[202:203], v[18:19]
  v_mov_b64 v[204:205], v[20:21]
  v_mov_b64 v[206:207], v[22:23]
  v_mov_b64 v[208:209], v[24:25]
  v_mov_b64 v[210:211], v[26:27]
  v_mov_b64 v[212:213], v[28:29]
  v_mov_b64 v[214:215], v[30:31]
  v_mov_b64 v[216:217], v[16:17]
  v_mov_b64 v[218:219], v[18:19]
  v_mov_b64 v[220:221], v[20:21]
  v_mov_b64 v[222:223], v[22:23]
  v_mov_b64 v[224:225], v[24:25]
  v_mov_b64 v[226:227], v[26:27]
  v_mov_b64 v[228:229], v[28:29]
  v_mov_b64 v[230:231], v[30:31]
  v_mov_b64 v[232:233], v[16:17]
  v_mov_b64 v[234:235], v[18:19]
  v_mov_b64 v[236:237], v[20:21]
  v_mov_b64 v[238:239], v[22:23]
  v_mov_b64 v[240:241], v[24:25]
  v_mov_b64 v[242:243], v[26:27]
  v_mov_b64 v[244:245], v[28:29]
  v_mov_b64 v[246:247], v[30:31]
  s_barrier
  ds_read_b64_tr_b16 v[16:17], v1 offset:0
  ds_read_b64_tr_b16 v[18:19], v1 offset:1024
  ds_read_b64_tr_b16 v[20:21], v2 offset:0
  ds_read_b64_tr_b16 v[22:23], v2 offset:1024
  ds_read_b64_tr_b16 v[24:25], v3 offset:0
  ds_read_b64_tr_b16 v[26:27], v3 offset:1024
  ds_read_b64_tr_b16 v[28:29], v4 offset:0
  ds_read_b64_tr_b16 v[30:31], v4 offset:1024
  ds_read_b64_tr_b16 v[32:33], v1 offset:8192
  ds_read_b64_tr_b16 v[34:35], v1 offset:9216
  ds_read_b64_tr_b16 v[36:37], v2 offset:8192
  ds_read_b64_tr_b16 v[38:39], v2 offset:9216
  ds_read_b64_tr_b16 v[40:41], v3 offset:8192
  ds_read_b64_tr_b16 v[42:43], v3 offset:9216
  ds_read_b64_tr_b16 v[44:45], v4 offset:8192
  ds_read_b64_tr_b16 v[46:47], v4 offset:9216
  s_waitcnt lgkmcnt(0)
  s_setprio 1
  s_barrier
  ds_read_b128 v[48:51], v5 offset:0
  ds_read_b128 v[52:55], v7 offset:0
  ds_read_b128 v[56:59], v5 offset:2048
  ds_read_b128 v[60:63], v7 offset:2048
  ds_read_b128 v[64:67], v5 offset:4096
  ds_read_b128 v[68:71], v7 offset:4096
  s_waitcnt lgkmcnt(5)
  v_mfma_f32_16x16x32_bf16 v[88:91], v[16:19], v[48:51], v[88:91]
  v_mfma_f32_16x16x32_bf16 v[92:95], v[20:23], v[48:51], v[92:95]
  s_nop 0
  v_mfma_f32_16x16x32_bf16 v[96:99], v[24:27], v[48:51], v[96:99]
  v_mfma_f32_16x16x32_bf16 v[100:103], v[28:31], v[48:51], v[100:103]
  s_waitcnt lgkmcnt(4)
  v_mfma_f32_16x16x32_bf16 v[100:103], v[44:47], v[52:55], v[100:103]
  v_mfma_f32_16x16x32_bf16 v[96:99], v[40:43], v[52:55], v[96:99]
  v_mfma_f32_16x16x32_bf16 v[92:95], v[36:39], v[52:55], v[92:95]
  v_mfma_f32_16x16x32_bf16 v[88:91], v[32:35], v[52:55], v[88:91]
  s_waitcnt lgkmcnt(3)
  v_mfma_f32_16x16x32_bf16 v[104:107], v[16:19], v[56:59], v[104:107]
  v_mfma_f32_16x16x32_bf16 v[108:111], v[20:23], v[56:59], v[108:111]
  v_mfma_f32_16x16x32_bf16 v[112:115], v[24:27], v[56:59], v[112:115]
  v_mfma_f32_16x16x32_bf16 v[116:119], v[28:31], v[56:59], v[116:119]
  s_waitcnt lgkmcnt(2)
  v_mfma_f32_16x16x32_bf16 v[116:119], v[44:47], v[60:63], v[116:119]
  s_barrier
  v_mfma_f32_16x16x32_bf16 v[112:115], v[40:43], v[60:63], v[112:115]
  ds_read_b128 v[72:75], v5 offset:6144
  v_mfma_f32_16x16x32_bf16 v[108:111], v[36:39], v[60:63], v[108:111]
  ds_read_b128 v[76:79], v7 offset:6144
  v_mfma_f32_16x16x32_bf16 v[104:107], v[32:35], v[60:63], v[104:107]
  ds_read_b128 v[80:83], v5 offset:8192
  s_waitcnt lgkmcnt(4)
  v_mfma_f32_16x16x32_bf16 v[120:123], v[16:19], v[64:67], v[120:123]
  ds_read_b128 v[84:87], v7 offset:8192
  v_mfma_f32_16x16x32_bf16 v[124:127], v[20:23], v[64:67], v[124:127]
  s_nop 0
  ds_read_b128 v[48:51], v5 offset:10240
  v_mfma_f32_16x16x32_bf16 v[128:131], v[24:27], v[64:67], v[128:131]
  ds_read_b128 v[52:55], v5 offset:12288
  v_mfma_f32_16x16x32_bf16 v[132:135], v[28:31], v[64:67], v[132:135]
  ds_read_b128 v[56:59], v5 offset:14336
  s_waitcnt lgkmcnt(7)
  v_mfma_f32_16x16x32_bf16 v[132:135], v[44:47], v[68:71], v[132:135]
  ds_read_b128 v[60:63], v5 offset:16384
  v_mfma_f32_16x16x32_bf16 v[128:131], v[40:43], v[68:71], v[128:131]
  s_nop 0
  ds_read_b128 v[64:67], v5 offset:18432
  v_mfma_f32_16x16x32_bf16 v[124:127], v[36:39], v[68:71], v[124:127]
  v_mfma_f32_16x16x32_bf16 v[120:123], v[32:35], v[68:71], v[120:123]
  ds_read_b128 v[68:71], v7 offset:10240
  s_waitcnt lgkmcnt(9)
  v_mfma_f32_16x16x32_bf16 v[136:139], v[16:19], v[72:75], v[136:139]
  v_mfma_f32_16x16x32_bf16 v[140:143], v[20:23], v[72:75], v[140:143]
  v_mfma_f32_16x16x32_bf16 v[144:147], v[24:27], v[72:75], v[144:147]
  s_nop 0
  v_mfma_f32_16x16x32_bf16 v[148:151], v[28:31], v[72:75], v[148:151]
  ds_read_b128 v[72:75], v7 offset:12288
  s_waitcnt lgkmcnt(9)
  v_mfma_f32_16x16x32_bf16 v[148:151], v[44:47], v[76:79], v[148:151]
  v_mfma_f32_16x16x32_bf16 v[144:147], v[40:43], v[76:79], v[144:147]
  v_mfma_f32_16x16x32_bf16 v[140:143], v[36:39], v[76:79], v[140:143]
  v_mfma_f32_16x16x32_bf16 v[136:139], v[32:35], v[76:79], v[136:139]
  ds_read_b128 v[76:79], v7 offset:14336
  s_waitcnt lgkmcnt(9)
  v_mfma_f32_16x16x32_bf16 v[152:155], v[16:19], v[80:83], v[152:155]
  v_mfma_f32_16x16x32_bf16 v[156:159], v[20:23], v[80:83], v[156:159]
  v_mfma_f32_16x16x32_bf16 v[160:163], v[24:27], v[80:83], v[160:163]
  v_mfma_f32_16x16x32_bf16 v[164:167], v[28:31], v[80:83], v[164:167]
  ds_read_b128 v[80:83], v7 offset:16384
  s_waitcnt lgkmcnt(9)
  v_mfma_f32_16x16x32_bf16 v[164:167], v[44:47], v[84:87], v[164:167]
  v_mfma_f32_16x16x32_bf16 v[160:163], v[40:43], v[84:87], v[160:163]
  s_nop 0
  v_mfma_f32_16x16x32_bf16 v[156:159], v[36:39], v[84:87], v[156:159]
  v_mfma_f32_16x16x32_bf16 v[152:155], v[32:35], v[84:87], v[152:155]
  ds_read_b128 v[84:87], v7 offset:18432
  s_waitcnt lgkmcnt(9)
  v_mfma_f32_16x16x32_bf16 v[168:171], v[16:19], v[48:51], v[168:171]
  v_mfma_f32_16x16x32_bf16 v[172:175], v[20:23], v[48:51], v[172:175]
  v_mfma_f32_16x16x32_bf16 v[176:179], v[24:27], v[48:51], v[176:179]
  v_mfma_f32_16x16x32_bf16 v[180:183], v[28:31], v[48:51], v[180:183]
  s_waitcnt lgkmcnt(8)
  v_mfma_f32_16x16x32_bf16 v[196:199], v[28:31], v[52:55], v[196:199]
  v_mfma_f32_16x16x32_bf16 v[192:195], v[24:27], v[52:55], v[192:195]
  v_mfma_f32_16x16x32_bf16 v[188:191], v[20:23], v[52:55], v[188:191]
  v_mfma_f32_16x16x32_bf16 v[184:187], v[16:19], v[52:55], v[184:187]
  s_waitcnt lgkmcnt(0)
  s_barrier
  v_mfma_f32_16x16x32_bf16 v[200:203], v[16:19], v[56:59], v[200:203]
  ds_read_b128 v[48:51], v5 offset:40960
  v_mfma_f32_16x16x32_bf16 v[204:207], v[20:23], v[56:59], v[204:207]
  ds_read_b128 v[52:55], v5 offset:43008
  v_mfma_f32_16x16x32_bf16 v[208:211], v[24:27], v[56:59], v[208:211]
  v_mfma_f32_16x16x32_bf16 v[212:215], v[28:31], v[56:59], v[212:215]
  ds_read_b128 v[56:59], v5 offset:45056
  v_mfma_f32_16x16x32_bf16 v[228:231], v[28:31], v[60:63], v[228:231]
  v_mfma_f32_16x16x32_bf16 v[224:227], v[24:27], v[60:63], v[224:227]
  v_mfma_f32_16x16x32_bf16 v[220:223], v[20:23], v[60:63], v[220:223]
  v_mfma_f32_16x16x32_bf16 v[216:219], v[16:19], v[60:63], v[216:219]
  ds_read_b128 v[60:63], v5 offset:47104
  v_mfma_f32_16x16x32_bf16 v[232:235], v[16:19], v[64:67], v[232:235]
  v_mfma_f32_16x16x32_bf16 v[236:239], v[20:23], v[64:67], v[236:239]
  v_mfma_f32_16x16x32_bf16 v[240:243], v[24:27], v[64:67], v[240:243]
  v_mfma_f32_16x16x32_bf16 v[244:247], v[28:31], v[64:67], v[244:247]
  ds_read_b128 v[64:67], v5 offset:49152
  v_mfma_f32_16x16x32_bf16 v[180:183], v[44:47], v[68:71], v[180:183]
  ds_read_b64_tr_b16 v[16:17], v1 offset:16384
  v_mfma_f32_16x16x32_bf16 v[176:179], v[40:43], v[68:71], v[176:179]
  ds_read_b64_tr_b16 v[18:19], v1 offset:17408
  v_mfma_f32_16x16x32_bf16 v[172:175], v[36:39], v[68:71], v[172:175]
  ds_read_b64_tr_b16 v[20:21], v2 offset:16384
  v_mfma_f32_16x16x32_bf16 v[168:171], v[32:35], v[68:71], v[168:171]
  ds_read_b128 v[68:71], v5 offset:51200
  v_mfma_f32_16x16x32_bf16 v[184:187], v[32:35], v[72:75], v[184:187]
  ds_read_b64_tr_b16 v[22:23], v2 offset:17408
  v_mfma_f32_16x16x32_bf16 v[188:191], v[36:39], v[72:75], v[188:191]
  ds_read_b64_tr_b16 v[24:25], v3 offset:16384
  v_mfma_f32_16x16x32_bf16 v[192:195], v[40:43], v[72:75], v[192:195]
  ds_read_b64_tr_b16 v[26:27], v3 offset:17408
  v_mfma_f32_16x16x32_bf16 v[196:199], v[44:47], v[72:75], v[196:199]
  ds_read_b128 v[72:75], v5 offset:53248
  v_mfma_f32_16x16x32_bf16 v[212:215], v[44:47], v[76:79], v[212:215]
  ds_read_b64_tr_b16 v[28:29], v4 offset:16384
  v_mfma_f32_16x16x32_bf16 v[208:211], v[40:43], v[76:79], v[208:211]
  ds_read_b64_tr_b16 v[30:31], v4 offset:17408
  v_mfma_f32_16x16x32_bf16 v[204:207], v[36:39], v[76:79], v[204:207]
  v_mfma_f32_16x16x32_bf16 v[200:203], v[32:35], v[76:79], v[200:203]
  ds_read_b128 v[76:79], v5 offset:55296
  v_mfma_f32_16x16x32_bf16 v[216:219], v[32:35], v[80:83], v[216:219]
  v_mfma_f32_16x16x32_bf16 v[220:223], v[36:39], v[80:83], v[220:223]
  v_mfma_f32_16x16x32_bf16 v[224:227], v[40:43], v[80:83], v[224:227]
  v_mfma_f32_16x16x32_bf16 v[228:231], v[44:47], v[80:83], v[228:231]
  ds_read_b128 v[80:83], v5 offset:57344
  v_mfma_f32_16x16x32_bf16 v[244:247], v[44:47], v[84:87], v[244:247]
  v_mfma_f32_16x16x32_bf16 v[240:243], v[40:43], v[84:87], v[240:243]
  v_mfma_f32_16x16x32_bf16 v[236:239], v[36:39], v[84:87], v[236:239]
  s_nop 0
  v_mfma_f32_16x16x32_bf16 v[232:235], v[32:35], v[84:87], v[232:235]
  ds_read_b128 v[84:87], v5 offset:59392
  s_branch L_mid
L_dnn_loop0:
  v_mfma_f32_16x16x32_bf16 v[88:91], v[16:19], v[48:51], v[88:91]
  v_mfma_f32_16x16x32_bf16 v[92:95], v[20:23], v[48:51], v[92:95]
  v_mfma_f32_16x16x32_bf16 v[96:99], v[24:27], v[48:51], v[96:99]
  v_mfma_f32_16x16x32_bf16 v[100:103], v[28:31], v[48:51], v[100:103]
  v_mfma_f32_16x16x32_bf16 v[116:119], v[28:31], v[52:55], v[116:119]
  v_mfma_f32_16x16x32_bf16 v[112:115], v[24:27], v[52:55], v[112:115]
  v_mfma_f32_16x16x32_bf16 v[108:111], v[20:23], v[52:55], v[108:111]
  v_mfma_f32_16x16x32_bf16 v[104:107], v[16:19], v[52:55], v[104:107]
  s_waitcnt lgkmcnt(0)
  s_barrier
  v_mfma_f32_16x16x32_bf16 v[120:123], v[16:19], v[56:59], v[120:123]
  ds_read_b128 v[48:51], v7 offset:0
  v_mfma_f32_16x16x32_bf16 v[124:127], v[20:23], v[56:59], v[124:127]
  ds_read_b128 v[52:55], v7 offset:2048
  v_mfma_f32_16x16x32_bf16 v[128:131], v[24:27], v[56:59], v[128:131]
  ds_read_b64_tr_b16 v[32:33], v1 offset:8192
  v_mfma_f32_16x16x32_bf16 v[132:135], v[28:31], v[56:59], v[132:135]
  ds_read_b128 v[56:59], v7 offset:4096
  v_mfma_f32_16x16x32_bf16 v[148:151], v[28:31], v[60:63], v[148:151]
  ds_read_b64_tr_b16 v[34:35], v1 offset:9216
  v_mfma_f32_16x16x32_bf16 v[144:147], v[24:27], v[60:63], v[144:147]
  ds_read_b64_tr_b16 v[36:37], v2 offset:8192
  v_mfma_f32_16x16x32_bf16 v[140:143], v[20:23], v[60:63], v[140:143]
  ds_read_b64_tr_b16 v[38:39], v2 offset:9216
  v_mfma_f32_16x16x32_bf16 v[136:139], v[16:19], v[60:63], v[136:139]
  ds_read_b128 v[60:63], v7 offset:6144
  v_mfma_f32_16x16x32_bf16 v[152:155], v[16:19], v[64:67], v[152:155]
  ds_read_b64_tr_b16 v[40:41], v3 offset:8192
  v_mfma_f32_16x16x32_bf16 v[156:159], v[20:23], v[64:67], v[156:159]
  ds_read_b64_tr_b16 v[42:43], v3 offset:9216
  v_mfma_f32_16x16x32_bf16 v[160:163], v[24:27], v[64:67], v[160:163]
  ds_read_b64_tr_b16 v[44:45], v4 offset:8192
  v_mfma_f32_16x16x32_bf16 v[164:167], v[28:31], v[64:67], v[164:167]
  ds_read_b128 v[64:67], v7 offset:8192
  v_mfma_f32_16x16x32_bf16 v[180:183], v[28:31], v[68:71], v[180:183]
  ds_read_b64_tr_b16 v[46:47], v4 offset:9216
  v_mfma_f32_16x16x32_bf16 v[176:179], v[24:27], v[68:71], v[176:179]
  v_mfma_f32_16x16x32_bf16 v[172:175], v[20:23], v[68:71], v[172:175]
  v_mfma_f32_16x16x32_bf16 v[168:171], v[16:19], v[68:71], v[168:171]
  ds_read_b128 v[68:71], v7 offset:10240
  v_mfma_f32_16x16x32_bf16 v[184:187], v[16:19], v[72:75], v[184:187]
  v_mfma_f32_16x16x32_bf16 v[188:191], v[20:23], v[72:75], v[188:191]
  v_mfma_f32_16x16x32_bf16 v[192:195], v[24:27], v[72:75], v[192:195]
  v_mfma_f32_16x16x32_bf16 v[196:199], v[28:31], v[72:75], v[196:199]
  ds_read_b128 v[72:75], v7 offset:12288
  v_mfma_f32_16x16x32_bf16 v[212:215], v[28:31], v[76:79], v[212:215]
  v_mfma_f32_16x16x32_bf16 v[208:211], v[24:27], v[76:79], v[208:211]
  v_mfma_f32_16x16x32_bf16 v[204:207], v[20:23], v[76:79], v[204:207]
  v_mfma_f32_16x16x32_bf16 v[200:203], v[16:19], v[76:79], v[200:203]
  ds_read_b128 v[76:79], v7 offset:14336
  v_mfma_f32_16x16x32_bf16 v[216:219], v[16:19], v[80:83], v[216:219]
  v_mfma_f32_16x16x32_bf16 v[220:223], v[20:23], v[80:83], v[220:223]
  v_mfma_f32_16x16x32_bf16 v[224:227], v[24:27], v[80:83], v[224:227]
  v_mfma_f32_16x16x32_bf16 v[228:231], v[28:31], v[80:83], v[228:231]
  ds_read_b128 v[80:83], v7 offset:16384
  v_mfma_f32_16x16x32_bf16 v[244:247], v[28:31], v[84:87], v[244:247]
  s_nop 0
  s_waitcnt lgkmcnt(4)
  v_mfma_f32_16x16x32_bf16 v[240:243], v[24:27], v[84:87], v[240:243]
  v_mfma_f32_16x16x32_bf16 v[236:239], v[20:23], v[84:87], v[236:239]
  v_mfma_f32_16x16x32_bf16 v[232:235], v[16:19], v[84:87], v[232:235]
  ds_read_b128 v[84:87], v7 offset:18432
  v_mfma_f32_16x16x32_bf16 v[88:91], v[32:35], v[48:51], v[88:91]
  v_mfma_f32_16x16x32_bf16 v[92:95], v[36:39], v[48:51], v[92:95]
  v_mfma_f32_16x16x32_bf16 v[96:99], v[40:43], v[48:51], v[96:99]
  v_mfma_f32_16x16x32_bf16 v[100:103], v[44:47], v[48:51], v[100:103]
  v_mfma_f32_16x16x32_bf16 v[116:119], v[44:47], v[52:55], v[116:119]
  v_mfma_f32_16x16x32_bf16 v[112:115], v[40:43], v[52:55], v[112:115]
  v_mfma_f32_16x16x32_bf16 v[108:111], v[36:39], v[52:55], v[108:111]
  v_mfma_f32_16x16x32_bf16 v[104:107], v[32:35], v[52:55], v[104:107]
  s_waitcnt lgkmcnt(0)
  s_barrier
  v_mfma_f32_16x16x32_bf16 v[120:123], v[32:35], v[56:59], v[120:123]
  ds_read_b128 v[48:51], v5 offset:40960
  v_mfma_f32_16x16x32_bf16 v[124:127], v[36:39], v[56:59], v[124:127]
  ds_read_b128 v[52:55], v5 offset:43008
  v_mfma_f32_16x16x32_bf16 v[128:131], v[40:43], v[56:59], v[128:131]
  ds_read_b64_tr_b16 v[16:17], v1 offset:16384
  v_mfma_f32_16x16x32_bf16 v[132:135], v[44:47], v[56:59], v[132:135]
  ds_read_b128 v[56:59], v5 offset:45056
  v_mfma_f32_16x16x32_bf16 v[148:151], v[44:47], v[60:63], v[148:151]
  ds_read_b64_tr_b16 v[18:19], v1 offset:17408
  v_mfma_f32_16x16x32_bf16 v[144:147], v[40:43], v[60:63], v[144:147]
  ds_read_b64_tr_b16 v[20:21], v2 offset:16384
  v_mfma_f32_16x16x32_bf16 v[140:143], v[36:39], v[60:63], v[140:143]
  ds_read_b64_tr_b16 v[22:23], v2 offset:17408
  v_mfma_f32_16x16x32_bf16 v[136:139], v[32:35], v[60:63], v[136:139]
  ds_read_b128 v[60:63], v5 offset:47104
  v_mfma_f32_16x16x32_bf16 v[152:155], v[32:35], v[64:67], v[152:155]
  ds_read_b64_tr_b16 v[24:25], v3 offset:16384
  v_mfma_f32_16x16x32_bf16 v[156:159], v[36:39], v[64:67], v[156:159]
  ds_read_b64_tr_b16 v[26:27], v3 offset:17408
  v_mfma_f32_16x16x32_bf16 v[160:163], v[40:43], v[64:67], v[160:163]
  ds_read_b64_tr_b16 v[28:29], v4 offset:16384
  v_mfma_f32_16x16x32_bf16 v[164:167], v[44:47], v[64:67], v[164:167]
  ds_read_b128 v[64:67], v5 offset:49152
  v_mfma_f32_16x16x32_bf16 v[180:183], v[44:47], v[68:71], v[180:183]
  ds_read_b64_tr_b16 v[30:31], v4 offset:17408
  v_mfma_f32_16x16x32_bf16 v[176:179], v[40:43], v[68:71], v[176:179]
  v_mfma_f32_16x16x32_bf16 v[172:175], v[36:39], v[68:71], v[172:175]
  v_mfma_f32_16x16x32_bf16 v[168:171], v[32:35], v[68:71], v[168:171]
  ds_read_b128 v[68:71], v5 offset:51200
  v_mfma_f32_16x16x32_bf16 v[184:187], v[32:35], v[72:75], v[184:187]
  v_mfma_f32_16x16x32_bf16 v[188:191], v[36:39], v[72:75], v[188:191]
  v_mfma_f32_16x16x32_bf16 v[192:195], v[40:43], v[72:75], v[192:195]
  v_mfma_f32_16x16x32_bf16 v[196:199], v[44:47], v[72:75], v[196:199]
  ds_read_b128 v[72:75], v5 offset:53248
  v_mfma_f32_16x16x32_bf16 v[212:215], v[44:47], v[76:79], v[212:215]
  v_mfma_f32_16x16x32_bf16 v[208:211], v[40:43], v[76:79], v[208:211]
  v_mfma_f32_16x16x32_bf16 v[204:207], v[36:39], v[76:79], v[204:207]
  v_mfma_f32_16x16x32_bf16 v[200:203], v[32:35], v[76:79], v[200:203]
  ds_read_b128 v[76:79], v5 offset:55296
  v_mfma_f32_16x16x32_bf16 v[216:219], v[32:35], v[80:83], v[216:219]
  v_mfma_f32_16x16x32_bf16 v[220:223], v[36:39], v[80:83], v[220:223]
  v_mfma_f32_16x16x32_bf16 v[224:227], v[40:43], v[80:83], v[224:227]
  v_mfma_f32_16x16x32_bf16 v[228:231], v[44:47], v[80:83], v[228:231]
  ds_read_b128 v[80:83], v5 offset:57344
  v_mfma_f32_16x16x32_bf16 v[244:247], v[44:47], v[84:87], v[244:247]
  s_waitcnt lgkmcnt(4)
  v_mfma_f32_16x16x32_bf16 v[240:243], v[40:43], v[84:87], v[240:243]
  v_mfma_f32_16x16x32_bf16 v[236:239], v[36:39], v[84:87], v[236:239]
  v_mfma_f32_16x16x32_bf16 v[232:235], v[32:35], v[84:87], v[232:235]
  ds_read_b128 v[84:87], v5 offset:59392
L_mid:
  s_waitcnt lgkmcnt(11)
  v_mfma_f32_16x16x32_bf16 v[88:91], v[16:19], v[48:51], v[88:91]
  s_waitcnt lgkmcnt(8)
  v_mfma_f32_16x16x32_bf16 v[92:95], v[20:23], v[48:51], v[92:95]
  s_waitcnt lgkmcnt(6)
  v_mfma_f32_16x16x32_bf16 v[96:99], v[24:27], v[48:51], v[96:99]
  s_waitcnt lgkmcnt(3)
  v_mfma_f32_16x16x32_bf16 v[100:103], v[28:31], v[48:51], v[100:103]
  v_mfma_f32_16x16x32_bf16 v[116:119], v[28:31], v[52:55], v[116:119]
  v_mfma_f32_16x16x32_bf16 v[112:115], v[24:27], v[52:55], v[112:115]
  s_nop 0
  v_mfma_f32_16x16x32_bf16 v[108:111], v[20:23], v[52:55], v[108:111]
  v_mfma_f32_16x16x32_bf16 v[104:107], v[16:19], v[52:55], v[104:107]
  s_waitcnt lgkmcnt(0)
  s_barrier
  v_mfma_f32_16x16x32_bf16 v[120:123], v[16:19], v[56:59], v[120:123]
  ds_read_b128 v[48:51], v7 offset:40960
  v_mfma_f32_16x16x32_bf16 v[124:127], v[20:23], v[56:59], v[124:127]
  ds_read_b128 v[52:55], v7 offset:43008
  v_mfma_f32_16x16x32_bf16 v[128:131], v[24:27], v[56:59], v[128:131]
  ds_read_b64_tr_b16 v[32:33], v1 offset:0
  v_mfma_f32_16x16x32_bf16 v[132:135], v[28:31], v[56:59], v[132:135]
  ds_read_b128 v[56:59], v7 offset:45056
  v_mfma_f32_16x16x32_bf16 v[148:151], v[28:31], v[60:63], v[148:151]
  ds_read_b64_tr_b16 v[34:35], v1 offset:1024
  v_mfma_f32_16x16x32_bf16 v[144:147], v[24:27], v[60:63], v[144:147]
  ds_read_b64_tr_b16 v[36:37], v2 offset:0
  v_mfma_f32_16x16x32_bf16 v[140:143], v[20:23], v[60:63], v[140:143]
  ds_read_b64_tr_b16 v[38:39], v2 offset:1024
  v_mfma_f32_16x16x32_bf16 v[136:139], v[16:19], v[60:63], v[136:139]
  ds_read_b128 v[60:63], v7 offset:47104
  v_mfma_f32_16x16x32_bf16 v[152:155], v[16:19], v[64:67], v[152:155]
  ds_read_b64_tr_b16 v[40:41], v3 offset:0
  v_mfma_f32_16x16x32_bf16 v[156:159], v[20:23], v[64:67], v[156:159]
  ds_read_b64_tr_b16 v[42:43], v3 offset:1024
  v_mfma_f32_16x16x32_bf16 v[160:163], v[24:27], v[64:67], v[160:163]
  ds_read_b64_tr_b16 v[44:45], v4 offset:0
  v_mfma_f32_16x16x32_bf16 v[164:167], v[28:31], v[64:67], v[164:167]
  ds_read_b128 v[64:67], v7 offset:49152
  v_mfma_f32_16x16x32_bf16 v[180:183], v[28:31], v[68:71], v[180:183]
  ds_read_b64_tr_b16 v[46:47], v4 offset:1024
  v_mfma_f32_16x16x32_bf16 v[176:179], v[24:27], v[68:71], v[176:179]
  v_mfma_f32_16x16x32_bf16 v[172:175], v[20:23], v[68:71], v[172:175]
  v_mfma_f32_16x16x32_bf16 v[168:171], v[16:19], v[68:71], v[168:171]
  ds_read_b128 v[68:71], v7 offset:51200
  v_mfma_f32_16x16x32_bf16 v[184:187], v[16:19], v[72:75], v[184:187]
  v_mfma_f32_16x16x32_bf16 v[188:191], v[20:23], v[72:75], v[188:191]
  v_mfma_f32_16x16x32_bf16 v[192:195], v[24:27], v[72:75], v[192:195]
  v_mfma_f32_16x16x32_bf16 v[196:199], v[28:31], v[72:75], v[196:199]
  ds_read_b128 v[72:75], v7 offset:53248
  v_mfma_f32_16x16x32_bf16 v[212:215], v[28:31], v[76:79], v[212:215]
  v_mfma_f32_16x16x32_bf16 v[208:211], v[24:27], v[76:79], v[208:211]
  v_mfma_f32_16x16x32_bf16 v[204:207], v[20:23], v[76:79], v[204:207]
  v_mfma_f32_16x16x32_bf16 v[200:203], v[16:19], v[76:79], v[200:203]
  ds_read_b128 v[76:79], v7 offset:55296
  v_mfma_f32_16x16x32_bf16 v[216:219], v[16:19], v[80:83], v[216:219]
  v_mfma_f32_16x16x32_bf16 v[220:223], v[20:23], v[80:83], v[220:223]
  v_mfma_f32_16x16x32_bf16 v[224:227], v[24:27], v[80:83], v[224:227]
  v_mfma_f32_16x16x32_bf16 v[228:231], v[28:31], v[80:83], v[228:231]
  ds_read_b128 v[80:83], v7 offset:57344
  v_mfma_f32_16x16x32_bf16 v[244:247], v[28:31], v[84:87], v[244:247]
  s_waitcnt lgkmcnt(4)
  v_mfma_f32_16x16x32_bf16 v[240:243], v[24:27], v[84:87], v[240:243]
  v_mfma_f32_16x16x32_bf16 v[236:239], v[20:23], v[84:87], v[236:239]
  v_mfma_f32_16x16x32_bf16 v[232:235], v[16:19], v[84:87], v[232:235]
  ds_read_b128 v[84:87], v7 offset:59392
  v_mfma_f32_16x16x32_bf16 v[88:91], v[32:35], v[48:51], v[88:91]
  v_mfma_f32_16x16x32_bf16 v[92:95], v[36:39], v[48:51], v[92:95]
  s_nop 0
  v_mfma_f32_16x16x32_bf16 v[96:99], v[40:43], v[48:51], v[96:99]
  v_mfma_f32_16x16x32_bf16 v[100:103], v[44:47], v[48:51], v[100:103]
  v_mfma_f32_16x16x32_bf16 v[116:119], v[44:47], v[52:55], v[116:119]
  v_mfma_f32_16x16x32_bf16 v[112:115], v[40:43], v[52:55], v[112:115]
  v_mfma_f32_16x16x32_bf16 v[108:111], v[36:39], v[52:55], v[108:111]
  v_mfma_f32_16x16x32_bf16 v[104:107], v[32:35], v[52:55], v[104:107]
  s_waitcnt lgkmcnt(0)
  s_barrier
  v_mfma_f32_16x16x32_bf16 v[120:123], v[32:35], v[56:59], v[120:123]
  ds_read_b128 v[48:51], v6 offset:0
  v_mfma_f32_16x16x32_bf16 v[124:127], v[36:39], v[56:59], v[124:127]
  ds_read_b128 v[52:55], v6 offset:2048
  v_mfma_f32_16x16x32_bf16 v[128:131], v[40:43], v[56:59], v[128:131]
  ds_read_b64_tr_b16 v[16:17], v1 offset:8192
  v_mfma_f32_16x16x32_bf16 v[132:135], v[44:47], v[56:59], v[132:135]
  ds_read_b128 v[56:59], v6 offset:4096
  v_mfma_f32_16x16x32_bf16 v[148:151], v[44:47], v[60:63], v[148:151]
  ds_read_b64_tr_b16 v[18:19], v1 offset:9216
  v_mfma_f32_16x16x32_bf16 v[144:147], v[40:43], v[60:63], v[144:147]
  ds_read_b64_tr_b16 v[20:21], v2 offset:8192
  v_mfma_f32_16x16x32_bf16 v[140:143], v[36:39], v[60:63], v[140:143]
  ds_read_b64_tr_b16 v[22:23], v2 offset:9216
  v_mfma_f32_16x16x32_bf16 v[136:139], v[32:35], v[60:63], v[136:139]
  ds_read_b128 v[60:63], v6 offset:6144
  v_mfma_f32_16x16x32_bf16 v[152:155], v[32:35], v[64:67], v[152:155]
  ds_read_b64_tr_b16 v[24:25], v3 offset:8192
  v_mfma_f32_16x16x32_bf16 v[156:159], v[36:39], v[64:67], v[156:159]
  ds_read_b64_tr_b16 v[26:27], v3 offset:9216
  v_mfma_f32_16x16x32_bf16 v[160:163], v[40:43], v[64:67], v[160:163]
  ds_read_b64_tr_b16 v[28:29], v4 offset:8192
  v_mfma_f32_16x16x32_bf16 v[164:167], v[44:47], v[64:67], v[164:167]
  ds_read_b128 v[64:67], v6 offset:8192
  v_mfma_f32_16x16x32_bf16 v[180:183], v[44:47], v[68:71], v[180:183]
  ds_read_b64_tr_b16 v[30:31], v4 offset:9216
  v_mfma_f32_16x16x32_bf16 v[176:179], v[40:43], v[68:71], v[176:179]
  v_mfma_f32_16x16x32_bf16 v[172:175], v[36:39], v[68:71], v[172:175]
  v_mfma_f32_16x16x32_bf16 v[168:171], v[32:35], v[68:71], v[168:171]
  ds_read_b128 v[68:71], v6 offset:10240
  v_mfma_f32_16x16x32_bf16 v[184:187], v[32:35], v[72:75], v[184:187]
  v_mfma_f32_16x16x32_bf16 v[188:191], v[36:39], v[72:75], v[188:191]
  v_mfma_f32_16x16x32_bf16 v[192:195], v[40:43], v[72:75], v[192:195]
  v_mfma_f32_16x16x32_bf16 v[196:199], v[44:47], v[72:75], v[196:199]
  ds_read_b128 v[72:75], v6 offset:12288
  v_mfma_f32_16x16x32_bf16 v[212:215], v[44:47], v[76:79], v[212:215]
  v_mfma_f32_16x16x32_bf16 v[208:211], v[40:43], v[76:79], v[208:211]
  v_mfma_f32_16x16x32_bf16 v[204:207], v[36:39], v[76:79], v[204:207]
  v_mfma_f32_16x16x32_bf16 v[200:203], v[32:35], v[76:79], v[200:203]
  ds_read_b128 v[76:79], v6 offset:14336
  v_mfma_f32_16x16x32_bf16 v[216:219], v[32:35], v[80:83], v[216:219]
  v_mfma_f32_16x16x32_bf16 v[220:223], v[36:39], v[80:83], v[220:223]
  v_mfma_f32_16x16x32_bf16 v[224:227], v[40:43], v[80:83], v[224:227]
  v_mfma_f32_16x16x32_bf16 v[228:231], v[44:47], v[80:83], v[228:231]
  ds_read_b128 v[80:83], v6 offset:16384
  v_mfma_f32_16x16x32_bf16 v[244:247], v[44:47], v[84:87], v[244:247]
  s_waitcnt lgkmcnt(4)
  v_mfma_f32_16x16x32_bf16 v[240:243], v[40:43], v[84:87], v[240:243]
  v_mfma_f32_16x16x32_bf16 v[236:239], v[36:39], v[84:87], v[236:239]
  s_nop 0
  v_mfma_f32_16x16x32_bf16 v[232:235], v[32:35], v[84:87], v[232:235]
  ds_read_b128 v[84:87], v6 offset:18432
  v_mfma_f32_16x16x32_bf16 v[88:91], v[16:19], v[48:51], v[88:91]
  v_mfma_f32_16x16x32_bf16 v[92:95], v[20:23], v[48:51], v[92:95]
  v_mfma_f32_16x16x32_bf16 v[96:99], v[24:27], v[48:51], v[96:99]
  v_mfma_f32_16x16x32_bf16 v[100:103], v[28:31], v[48:51], v[100:103]
  v_mfma_f32_16x16x32_bf16 v[116:119], v[28:31], v[52:55], v[116:119]
  v_mfma_f32_16x16x32_bf16 v[112:115], v[24:27], v[52:55], v[112:115]
  v_mfma_f32_16x16x32_bf16 v[108:111], v[20:23], v[52:55], v[108:111]
  v_mfma_f32_16x16x32_bf16 v[104:107], v[16:19], v[52:55], v[104:107]
  s_waitcnt lgkmcnt(0)
  s_barrier
  v_mfma_f32_16x16x32_bf16 v[120:123], v[16:19], v[56:59], v[120:123]
  ds_read_b128 v[48:51], v8 offset:0
  v_mfma_f32_16x16x32_bf16 v[124:127], v[20:23], v[56:59], v[124:127]
  ds_read_b128 v[52:55], v8 offset:2048
  v_mfma_f32_16x16x32_bf16 v[128:131], v[24:27], v[56:59], v[128:131]
  ds_read_b64_tr_b16 v[32:33], v1 offset:16384
  v_mfma_f32_16x16x32_bf16 v[132:135], v[28:31], v[56:59], v[132:135]
  ds_read_b128 v[56:59], v8 offset:4096
  v_mfma_f32_16x16x32_bf16 v[148:151], v[28:31], v[60:63], v[148:151]
  ds_read_b64_tr_b16 v[34:35], v1 offset:17408
  v_mfma_f32_16x16x32_bf16 v[144:147], v[24:27], v[60:63], v[144:147]
  ds_read_b64_tr_b16 v[36:37], v2 offset:16384
  v_mfma_f32_16x16x32_bf16 v[140:143], v[20:23], v[60:63], v[140:143]
  ds_read_b64_tr_b16 v[38:39], v2 offset:17408
  v_mfma_f32_16x16x32_bf16 v[136:139], v[16:19], v[60:63], v[136:139]
  ds_read_b128 v[60:63], v8 offset:6144
  v_mfma_f32_16x16x32_bf16 v[152:155], v[16:19], v[64:67], v[152:155]
  ds_read_b64_tr_b16 v[40:41], v3 offset:16384
  v_mfma_f32_16x16x32_bf16 v[156:159], v[20:23], v[64:67], v[156:159]
  ds_read_b64_tr_b16 v[42:43], v3 offset:17408
  v_mfma_f32_16x16x32_bf16 v[160:163], v[24:27], v[64:67], v[160:163]
  ds_read_b64_tr_b16 v[44:45], v4 offset:16384
  v_mfma_f32_16x16x32_bf16 v[164:167], v[28:31], v[64:67], v[164:167]
  ds_read_b128 v[64:67], v8 offset:8192
  v_mfma_f32_16x16x32_bf16 v[180:183], v[28:31], v[68:71], v[180:183]
  ds_read_b64_tr_b16 v[46:47], v4 offset:17408
  v_mfma_f32_16x16x32_bf16 v[176:179], v[24:27], v[68:71], v[176:179]
  v_mfma_f32_16x16x32_bf16 v[172:175], v[20:23], v[68:71], v[172:175]
  v_mfma_f32_16x16x32_bf16 v[168:171], v[16:19], v[68:71], v[168:171]
  ds_read_b128 v[68:71], v8 offset:10240
  v_mfma_f32_16x16x32_bf16 v[184:187], v[16:19], v[72:75], v[184:187]
  v_mfma_f32_16x16x32_bf16 v[188:191], v[20:23], v[72:75], v[188:191]
  v_mfma_f32_16x16x32_bf16 v[192:195], v[24:27], v[72:75], v[192:195]
  v_mfma_f32_16x16x32_bf16 v[196:199], v[28:31], v[72:75], v[196:199]
  ds_read_b128 v[72:75], v8 offset:12288
  v_mfma_f32_16x16x32_bf16 v[212:215], v[28:31], v[76:79], v[212:215]
  v_mfma_f32_16x16x32_bf16 v[208:211], v[24:27], v[76:79], v[208:211]
  v_mfma_f32_16x16x32_bf16 v[204:207], v[20:23], v[76:79], v[204:207]
  v_mfma_f32_16x16x32_bf16 v[200:203], v[16:19], v[76:79], v[200:203]
  ds_read_b128 v[76:79], v8 offset:14336
  v_mfma_f32_16x16x32_bf16 v[216:219], v[16:19], v[80:83], v[216:219]
  v_mfma_f32_16x16x32_bf16 v[220:223], v[20:23], v[80:83], v[220:223]
  v_mfma_f32_16x16x32_bf16 v[224:227], v[24:27], v[80:83], v[224:227]
  v_mfma_f32_16x16x32_bf16 v[228:231], v[28:31], v[80:83], v[228:231]
  ds_read_b128 v[80:83], v8 offset:16384
  v_mfma_f32_16x16x32_bf16 v[244:247], v[28:31], v[84:87], v[244:247]
  s_waitcnt lgkmcnt(4)
  v_mfma_f32_16x16x32_bf16 v[240:243], v[24:27], v[84:87], v[240:243]
  v_mfma_f32_16x16x32_bf16 v[236:239], v[20:23], v[84:87], v[236:239]
  v_mfma_f32_16x16x32_bf16 v[232:235], v[16:19], v[84:87], v[232:235]
  ds_read_b128 v[84:87], v8 offset:18432
  v_mfma_f32_16x16x32_bf16 v[88:91], v[32:35], v[48:51], v[88:91]
  v_mfma_f32_16x16x32_bf16 v[92:95], v[36:39], v[48:51], v[92:95]
  s_nop 0
  v_mfma_f32_16x16x32_bf16 v[96:99], v[40:43], v[48:51], v[96:99]
  v_mfma_f32_16x16x32_bf16 v[100:103], v[44:47], v[48:51], v[100:103]
  v_mfma_f32_16x16x32_bf16 v[116:119], v[44:47], v[52:55], v[116:119]
  v_mfma_f32_16x16x32_bf16 v[112:115], v[40:43], v[52:55], v[112:115]
  v_mfma_f32_16x16x32_bf16 v[108:111], v[36:39], v[52:55], v[108:111]
  v_mfma_f32_16x16x32_bf16 v[104:107], v[32:35], v[52:55], v[104:107]
  s_waitcnt lgkmcnt(0)
  s_barrier
  v_mfma_f32_16x16x32_bf16 v[120:123], v[32:35], v[56:59], v[120:123]
  ds_read_b128 v[48:51], v5 offset:0
  v_mfma_f32_16x16x32_bf16 v[124:127], v[36:39], v[56:59], v[124:127]
  ds_read_b128 v[52:55], v5 offset:2048
  v_mfma_f32_16x16x32_bf16 v[128:131], v[40:43], v[56:59], v[128:131]
  ds_read_b64_tr_b16 v[16:17], v1 offset:0
  v_mfma_f32_16x16x32_bf16 v[132:135], v[44:47], v[56:59], v[132:135]
  ds_read_b128 v[56:59], v5 offset:4096
  v_mfma_f32_16x16x32_bf16 v[148:151], v[44:47], v[60:63], v[148:151]
  ds_read_b64_tr_b16 v[18:19], v1 offset:1024
  v_mfma_f32_16x16x32_bf16 v[144:147], v[40:43], v[60:63], v[144:147]
  ds_read_b64_tr_b16 v[20:21], v2 offset:0
  v_mfma_f32_16x16x32_bf16 v[140:143], v[36:39], v[60:63], v[140:143]
  ds_read_b64_tr_b16 v[22:23], v2 offset:1024
  v_mfma_f32_16x16x32_bf16 v[136:139], v[32:35], v[60:63], v[136:139]
  ds_read_b128 v[60:63], v5 offset:6144
  v_mfma_f32_16x16x32_bf16 v[152:155], v[32:35], v[64:67], v[152:155]
  ds_read_b64_tr_b16 v[24:25], v3 offset:0
  v_mfma_f32_16x16x32_bf16 v[156:159], v[36:39], v[64:67], v[156:159]
  ds_read_b64_tr_b16 v[26:27], v3 offset:1024
  v_mfma_f32_16x16x32_bf16 v[160:163], v[40:43], v[64:67], v[160:163]
  ds_read_b64_tr_b16 v[28:29], v4 offset:0
  v_mfma_f32_16x16x32_bf16 v[164:167], v[44:47], v[64:67], v[164:167]
  ds_read_b128 v[64:67], v5 offset:8192
  v_mfma_f32_16x16x32_bf16 v[180:183], v[44:47], v[68:71], v[180:183]
  ds_read_b64_tr_b16 v[30:31], v4 offset:1024
  v_mfma_f32_16x16x32_bf16 v[176:179], v[40:43], v[68:71], v[176:179]
  v_mfma_f32_16x16x32_bf16 v[172:175], v[36:39], v[68:71], v[172:175]
  v_mfma_f32_16x16x32_bf16 v[168:171], v[32:35], v[68:71], v[168:171]
  ds_read_b128 v[68:71], v5 offset:10240
  v_mfma_f32_16x16x32_bf16 v[184:187], v[32:35], v[72:75], v[184:187]
  v_mfma_f32_16x16x32_bf16 v[188:191], v[36:39], v[72:75], v[188:191]
  v_mfma_f32_16x16x32_bf16 v[192:195], v[40:43], v[72:75], v[192:195]
  v_mfma_f32_16x16x32_bf16 v[196:199], v[44:47], v[72:75], v[196:199]
  ds_read_b128 v[72:75], v5 offset:12288
  v_mfma_f32_16x16x32_bf16 v[212:215], v[44:47], v[76:79], v[212:215]
  v_mfma_f32_16x16x32_bf16 v[208:211], v[40:43], v[76:79], v[208:211]
  v_mfma_f32_16x16x32_bf16 v[204:207], v[36:39], v[76:79], v[204:207]
  v_mfma_f32_16x16x32_bf16 v[200:203], v[32:35], v[76:79], v[200:203]
  ds_read_b128 v[76:79], v5 offset:14336
  v_mfma_f32_16x16x32_bf16 v[216:219], v[32:35], v[80:83], v[216:219]
  v_mfma_f32_16x16x32_bf16 v[220:223], v[36:39], v[80:83], v[220:223]
  v_mfma_f32_16x16x32_bf16 v[224:227], v[40:43], v[80:83], v[224:227]
  v_mfma_f32_16x16x32_bf16 v[228:231], v[44:47], v[80:83], v[228:231]
  ds_read_b128 v[80:83], v5 offset:16384
  v_mfma_f32_16x16x32_bf16 v[244:247], v[44:47], v[84:87], v[244:247]
  s_waitcnt lgkmcnt(4)
  v_mfma_f32_16x16x32_bf16 v[240:243], v[40:43], v[84:87], v[240:243]
  s_nop 0
  s_add_u32 s72, s72, 1
  s_cmp_lt_u32 s72, 8
  v_mfma_f32_16x16x32_bf16 v[236:239], v[36:39], v[84:87], v[236:239]
  v_mfma_f32_16x16x32_bf16 v[232:235], v[32:35], v[84:87], v[232:235]
  ds_read_b128 v[84:87], v5 offset:18432
  s_cbranch_scc1 L_dnn_loop0
L_tail:
  v_mfma_f32_16x16x32_bf16 v[88:91], v[16:19], v[48:51], v[88:91]
  v_mfma_f32_16x16x32_bf16 v[92:95], v[20:23], v[48:51], v[92:95]
  v_mfma_f32_16x16x32_bf16 v[96:99], v[24:27], v[48:51], v[96:99]
  v_mfma_f32_16x16x32_bf16 v[100:103], v[28:31], v[48:51], v[100:103]
  s_nop 0
  v_mfma_f32_16x16x32_bf16 v[116:119], v[28:31], v[52:55], v[116:119]
  v_mfma_f32_16x16x32_bf16 v[112:115], v[24:27], v[52:55], v[112:115]
  v_mfma_f32_16x16x32_bf16 v[108:111], v[20:23], v[52:55], v[108:111]
  v_mfma_f32_16x16x32_bf16 v[104:107], v[16:19], v[52:55], v[104:107]
  s_waitcnt lgkmcnt(0)
  s_barrier
  v_mfma_f32_16x16x32_bf16 v[120:123], v[16:19], v[56:59], v[120:123]
  ds_read_b128 v[48:51], v7 offset:0
  v_mfma_f32_16x16x32_bf16 v[124:127], v[20:23], v[56:59], v[124:127]
  ds_read_b128 v[52:55], v7 offset:2048
  v_mfma_f32_16x16x32_bf16 v[128:131], v[24:27], v[56:59], v[128:131]
  ds_read_b64_tr_b16 v[32:33], v1 offset:8192
  v_mfma_f32_16x16x32_bf16 v[132:135], v[28:31], v[56:59], v[132:135]
  ds_read_b128 v[56:59], v7 offset:4096
  v_mfma_f32_16x16x32_bf16 v[148:151], v[28:31], v[60:63], v[148:151]
  ds_read_b64_tr_b16 v[34:35], v1 offset:9216
  v_mfma_f32_16x16x32_bf16 v[144:147], v[24:27], v[60:63], v[144:147]
  ds_read_b64_tr_b16 v[36:37], v2 offset:8192
  v_mfma_f32_16x16x32_bf16 v[140:143], v[20:23], v[60:63], v[140:143]
  ds_read_b64_tr_b16 v[38:39], v2 offset:9216
  v_mfma_f32_16x16x32_bf16 v[136:139], v[16:19], v[60:63], v[136:139]
  ds_read_b128 v[60:63], v7 offset:6144
  v_mfma_f32_16x16x32_bf16 v[152:155], v[16:19], v[64:67], v[152:155]
  ds_read_b64_tr_b16 v[40:41], v3 offset:8192
  v_mfma_f32_16x16x32_bf16 v[156:159], v[20:23], v[64:67], v[156:159]
  ds_read_b64_tr_b16 v[42:43], v3 offset:9216
  v_mfma_f32_16x16x32_bf16 v[160:163], v[24:27], v[64:67], v[160:163]
  ds_read_b64_tr_b16 v[44:45], v4 offset:8192
  v_mfma_f32_16x16x32_bf16 v[164:167], v[28:31], v[64:67], v[164:167]
  ds_read_b128 v[64:67], v7 offset:8192
  v_mfma_f32_16x16x32_bf16 v[180:183], v[28:31], v[68:71], v[180:183]
  ds_read_b64_tr_b16 v[46:47], v4 offset:9216
  v_mfma_f32_16x16x32_bf16 v[176:179], v[24:27], v[68:71], v[176:179]
  v_mfma_f32_16x16x32_bf16 v[172:175], v[20:23], v[68:71], v[172:175]
  v_mfma_f32_16x16x32_bf16 v[168:171], v[16:19], v[68:71], v[168:171]
  ds_read_b128 v[68:71], v7 offset:10240
  v_mfma_f32_16x16x32_bf16 v[184:187], v[16:19], v[72:75], v[184:187]
  v_mfma_f32_16x16x32_bf16 v[188:191], v[20:23], v[72:75], v[188:191]
  v_mfma_f32_16x16x32_bf16 v[192:195], v[24:27], v[72:75], v[192:195]
  v_mfma_f32_16x16x32_bf16 v[196:199], v[28:31], v[72:75], v[196:199]
  ds_read_b128 v[72:75], v7 offset:12288
  v_mfma_f32_16x16x32_bf16 v[212:215], v[28:31], v[76:79], v[212:215]
  v_mfma_f32_16x16x32_bf16 v[208:211], v[24:27], v[76:79], v[208:211]
  v_mfma_f32_16x16x32_bf16 v[204:207], v[20:23], v[76:79], v[204:207]
  v_mfma_f32_16x16x32_bf16 v[200:203], v[16:19], v[76:79], v[200:203]
  ds_read_b128 v[76:79], v7 offset:14336
  v_mfma_f32_16x16x32_bf16 v[216:219], v[16:19], v[80:83], v[216:219]
  v_mfma_f32_16x16x32_bf16 v[220:223], v[20:23], v[80:83], v[220:223]
  v_mfma_f32_16x16x32_bf16 v[224:227], v[24:27], v[80:83], v[224:227]
  v_mfma_f32_16x16x32_bf16 v[228:231], v[28:31], v[80:83], v[228:231]
  ds_read_b128 v[80:83], v7 offset:16384
  v_mfma_f32_16x16x32_bf16 v[244:247], v[28:31], v[84:87], v[244:247]
  s_waitcnt lgkmcnt(4)
  v_mfma_f32_16x16x32_bf16 v[240:243], v[24:27], v[84:87], v[240:243]
  v_mfma_f32_16x16x32_bf16 v[236:239], v[20:23], v[84:87], v[236:239]
  v_mfma_f32_16x16x32_bf16 v[232:235], v[16:19], v[84:87], v[232:235]
  s_nop 0
  ds_read_b128 v[84:87], v7 offset:18432
  v_mfma_f32_16x16x32_bf16 v[88:91], v[32:35], v[48:51], v[88:91]
  v_mfma_f32_16x16x32_bf16 v[92:95], v[36:39], v[48:51], v[92:95]
  v_mfma_f32_16x16x32_bf16 v[96:99], v[40:43], v[48:51], v[96:99]
  v_mfma_f32_16x16x32_bf16 v[100:103], v[44:47], v[48:51], v[100:103]
  v_mfma_f32_16x16x32_bf16 v[116:119], v[44:47], v[52:55], v[116:119]
  v_mfma_f32_16x16x32_bf16 v[112:115], v[40:43], v[52:55], v[112:115]
  v_mfma_f32_16x16x32_bf16 v[108:111], v[36:39], v[52:55], v[108:111]
  v_mfma_f32_16x16x32_bf16 v[104:107], v[32:35], v[52:55], v[104:107]
  s_waitcnt lgkmcnt(0)
  s_barrier
  v_mfma_f32_16x16x32_bf16 v[120:123], v[32:35], v[56:59], v[120:123]
  ds_read_b128 v[48:51], v5 offset:40960
  v_mfma_f32_16x16x32_bf16 v[124:127], v[36:39], v[56:59], v[124:127]
  ds_read_b128 v[52:55], v5 offset:43008
  v_mfma_f32_16x16x32_bf16 v[128:131], v[40:43], v[56:59], v[128:131]
  ds_read_b64_tr_b16 v[16:17], v1 offset:16384
  v_mfma_f32_16x16x32_bf16 v[132:135], v[44:47], v[56:59], v[132:135]
  ds_read_b128 v[56:59], v5 offset:45056
  v_mfma_f32_16x16x32_bf16 v[148:151], v[44:47], v[60:63], v[148:151]
  ds_read_b64_tr_b16 v[18:19], v1 offset:17408
  v_mfma_f32_16x16x32_bf16 v[144:147], v[40:43], v[60:63], v[144:147]
  ds_read_b64_tr_b16 v[20:21], v2 offset:16384
  v_mfma_f32_16x16x32_bf16 v[140:143], v[36:39], v[60:63], v[140:143]
  ds_read_b64_tr_b16 v[22:23], v2 offset:17408
  v_mfma_f32_16x16x32_bf16 v[136:139], v[32:35], v[60:63], v[136:139]
  ds_read_b128 v[60:63], v5 offset:47104
  v_mfma_f32_16x16x32_bf16 v[152:155], v[32:35], v[64:67], v[152:155]
  ds_read_b64_tr_b16 v[24:25], v3 offset:16384
  v_mfma_f32_16x16x32_bf16 v[156:159], v[36:39], v[64:67], v[156:159]
  ds_read_b64_tr_b16 v[26:27], v3 offset:17408
  v_mfma_f32_16x16x32_bf16 v[160:163], v[40:43], v[64:67], v[160:163]
  ds_read_b64_tr_b16 v[28:29], v4 offset:16384
  v_mfma_f32_16x16x32_bf16 v[164:167], v[44:47], v[64:67], v[164:167]
  ds_read_b128 v[64:67], v5 offset:49152
  v_mfma_f32_16x16x32_bf16 v[180:183], v[44:47], v[68:71], v[180:183]
  ds_read_b64_tr_b16 v[30:31], v4 offset:17408
  v_mfma_f32_16x16x32_bf16 v[176:179], v[40:43], v[68:71], v[176:179]
  v_mfma_f32_16x16x32_bf16 v[172:175], v[36:39], v[68:71], v[172:175]
  v_mfma_f32_16x16x32_bf16 v[168:171], v[32:35], v[68:71], v[168:171]
  ds_read_b128 v[68:71], v5 offset:51200
  v_mfma_f32_16x16x32_bf16 v[184:187], v[32:35], v[72:75], v[184:187]
  v_mfma_f32_16x16x32_bf16 v[188:191], v[36:39], v[72:75], v[188:191]
  v_mfma_f32_16x16x32_bf16 v[192:195], v[40:43], v[72:75], v[192:195]
  v_mfma_f32_16x16x32_bf16 v[196:199], v[44:47], v[72:75], v[196:199]
  ds_read_b128 v[72:75], v5 offset:53248
  v_mfma_f32_16x16x32_bf16 v[212:215], v[44:47], v[76:79], v[212:215]
  v_mfma_f32_16x16x32_bf16 v[208:211], v[40:43], v[76:79], v[208:211]
  v_mfma_f32_16x16x32_bf16 v[204:207], v[36:39], v[76:79], v[204:207]
  v_mfma_f32_16x16x32_bf16 v[200:203], v[32:35], v[76:79], v[200:203]
  ds_read_b128 v[76:79], v5 offset:55296
  v_mfma_f32_16x16x32_bf16 v[216:219], v[32:35], v[80:83], v[216:219]
  v_mfma_f32_16x16x32_bf16 v[220:223], v[36:39], v[80:83], v[220:223]
  v_mfma_f32_16x16x32_bf16 v[224:227], v[40:43], v[80:83], v[224:227]
  v_mfma_f32_16x16x32_bf16 v[228:231], v[44:47], v[80:83], v[228:231]
  ds_read_b128 v[80:83], v5 offset:57344
  v_mfma_f32_16x16x32_bf16 v[244:247], v[44:47], v[84:87], v[244:247]
  s_nop 0
  s_waitcnt lgkmcnt(4)
  v_mfma_f32_16x16x32_bf16 v[240:243], v[40:43], v[84:87], v[240:243]
  v_mfma_f32_16x16x32_bf16 v[236:239], v[36:39], v[84:87], v[236:239]
  v_mfma_f32_16x16x32_bf16 v[232:235], v[32:35], v[84:87], v[232:235]
  ds_read_b128 v[84:87], v5 offset:59392
  v_mfma_f32_16x16x32_bf16 v[88:91], v[16:19], v[48:51], v[88:91]
  v_mfma_f32_16x16x32_bf16 v[92:95], v[20:23], v[48:51], v[92:95]
  v_mfma_f32_16x16x32_bf16 v[96:99], v[24:27], v[48:51], v[96:99]
  v_mfma_f32_16x16x32_bf16 v[100:103], v[28:31], v[48:51], v[100:103]
  v_mfma_f32_16x16x32_bf16 v[116:119], v[28:31], v[52:55], v[116:119]
  v_mfma_f32_16x16x32_bf16 v[112:115], v[24:27], v[52:55], v[112:115]
  v_mfma_f32_16x16x32_bf16 v[108:111], v[20:23], v[52:55], v[108:111]
  v_mfma_f32_16x16x32_bf16 v[104:107], v[16:19], v[52:55], v[104:107]
  s_waitcnt lgkmcnt(0)
  s_barrier
  v_mfma_f32_16x16x32_bf16 v[120:123], v[16:19], v[56:59], v[120:123]
  ds_read_b128 v[48:51], v7 offset:40960
  v_mfma_f32_16x16x32_bf16 v[124:127], v[20:23], v[56:59], v[124:127]
  ds_read_b128 v[52:55], v7 offset:43008
  v_mfma_f32_16x16x32_bf16 v[128:131], v[24:27], v[56:59], v[128:131]
  ds_read_b64_tr_b16 v[32:33], v1 offset:0
  v_mfma_f32_16x16x32_bf16 v[132:135], v[28:31], v[56:59], v[132:135]
  ds_read_b128 v[56:59], v7 offset:45056
  v_mfma_f32_16x16x32_bf16 v[148:151], v[28:31], v[60:63], v[148:151]
  ds_read_b64_tr_b16 v[34:35], v1 offset:1024
  v_mfma_f32_16x16x32_bf16 v[144:147], v[24:27], v[60:63], v[144:147]
  ds_read_b64_tr_b16 v[36:37], v2 offset:0
  v_mfma_f32_16x16x32_bf16 v[140:143], v[20:23], v[60:63], v[140:143]
  ds_read_b64_tr_b16 v[38:39], v2 offset:1024
  v_mfma_f32_16x16x32_bf16 v[136:139], v[16:19], v[60:63], v[136:139]
  ds_read_b128 v[60:63], v7 offset:47104
  v_mfma_f32_16x16x32_bf16 v[152:155], v[16:19], v[64:67], v[152:155]
  ds_read_b64_tr_b16 v[40:41], v3 offset:0
  v_mfma_f32_16x16x32_bf16 v[156:159], v[20:23], v[64:67], v[156:159]
  ds_read_b64_tr_b16 v[42:43], v3 offset:1024
  v_mfma_f32_16x16x32_bf16 v[160:163], v[24:27], v[64:67], v[160:163]
  ds_read_b64_tr_b16 v[44:45], v4 offset:0
  v_mfma_f32_16x16x32_bf16 v[164:167], v[28:31], v[64:67], v[164:167]
  ds_read_b128 v[64:67], v7 offset:49152
  v_mfma_f32_16x16x32_bf16 v[180:183], v[28:31], v[68:71], v[180:183]
  ds_read_b64_tr_b16 v[46:47], v4 offset:1024
  v_mfma_f32_16x16x32_bf16 v[176:179], v[24:27], v[68:71], v[176:179]
  v_mfma_f32_16x16x32_bf16 v[172:175], v[20:23], v[68:71], v[172:175]
  v_mfma_f32_16x16x32_bf16 v[168:171], v[16:19], v[68:71], v[168:171]
  ds_read_b128 v[68:71], v7 offset:51200
  v_mfma_f32_16x16x32_bf16 v[184:187], v[16:19], v[72:75], v[184:187]
  v_mfma_f32_16x16x32_bf16 v[188:191], v[20:23], v[72:75], v[188:191]
  v_mfma_f32_16x16x32_bf16 v[192:195], v[24:27], v[72:75], v[192:195]
  v_mfma_f32_16x16x32_bf16 v[196:199], v[28:31], v[72:75], v[196:199]
  ds_read_b128 v[72:75], v7 offset:53248
  v_mfma_f32_16x16x32_bf16 v[212:215], v[28:31], v[76:79], v[212:215]
  v_mfma_f32_16x16x32_bf16 v[208:211], v[24:27], v[76:79], v[208:211]
  v_mfma_f32_16x16x32_bf16 v[204:207], v[20:23], v[76:79], v[204:207]
  v_mfma_f32_16x16x32_bf16 v[200:203], v[16:19], v[76:79], v[200:203]
  ds_read_b128 v[76:79], v7 offset:55296
  v_mfma_f32_16x16x32_bf16 v[216:219], v[16:19], v[80:83], v[216:219]
  v_mfma_f32_16x16x32_bf16 v[220:223], v[20:23], v[80:83], v[220:223]
  v_mfma_f32_16x16x32_bf16 v[224:227], v[24:27], v[80:83], v[224:227]
  v_mfma_f32_16x16x32_bf16 v[228:231], v[28:31], v[80:83], v[228:231]
  ds_read_b128 v[80:83], v7 offset:57344
  v_mfma_f32_16x16x32_bf16 v[244:247], v[28:31], v[84:87], v[244:247]
  s_waitcnt lgkmcnt(4)
  v_mfma_f32_16x16x32_bf16 v[240:243], v[24:27], v[84:87], v[240:243]
  v_mfma_f32_16x16x32_bf16 v[236:239], v[20:23], v[84:87], v[236:239]
  v_mfma_f32_16x16x32_bf16 v[232:235], v[16:19], v[84:87], v[232:235]
  s_nop 0
  ds_read_b128 v[84:87], v7 offset:59392
  v_mfma_f32_16x16x32_bf16 v[88:91], v[32:35], v[48:51], v[88:91]
  ds_read_b64 v[18:19], v9 offset:256
  v_mfma_f32_16x16x32_bf16 v[92:95], v[36:39], v[48:51], v[92:95]
  ds_read_b64 v[22:23], v9 offset:288
  v_mfma_f32_16x16x32_bf16 v[96:99], v[40:43], v[48:51], v[96:99]
  ds_read_b64 v[26:27], v9 offset:320
  v_mfma_f32_16x16x32_bf16 v[100:103], v[44:47], v[48:51], v[100:103]
  ds_read_b64 v[30:31], v9 offset:352
  v_mfma_f32_16x16x32_bf16 v[116:119], v[44:47], v[52:55], v[116:119]
  v_mfma_f32_16x16x32_bf16 v[112:115], v[40:43], v[52:55], v[112:115]
  v_mfma_f32_16x16x32_bf16 v[108:111], v[36:39], v[52:55], v[108:111]
  v_mfma_f32_16x16x32_bf16 v[104:107], v[32:35], v[52:55], v[104:107]
  v_mfma_f32_16x16x32_bf16 v[120:123], v[32:35], v[56:59], v[120:123]
  v_mfma_f32_16x16x32_bf16 v[124:127], v[36:39], v[56:59], v[124:127]
  v_mfma_f32_16x16x32_bf16 v[128:131], v[40:43], v[56:59], v[128:131]
  v_mfma_f32_16x16x32_bf16 v[132:135], v[44:47], v[56:59], v[132:135]
  v_mfma_f32_16x16x32_bf16 v[148:151], v[44:47], v[60:63], v[148:151]
  v_mfma_f32_16x16x32_bf16 v[144:147], v[40:43], v[60:63], v[144:147]
  v_mfma_f32_16x16x32_bf16 v[140:143], v[36:39], v[60:63], v[140:143]
  v_mfma_f32_16x16x32_bf16 v[136:139], v[32:35], v[60:63], v[136:139]
  v_mfma_f32_16x16x32_bf16 v[152:155], v[32:35], v[64:67], v[152:155]
  s_waitcnt lgkmcnt(3)
  v_lshlrev_b32 v16, 16, v18
  v_mfma_f32_16x16x32_bf16 v[156:159], v[36:39], v[64:67], v[156:159]
  v_and_b32 v17, 0xffff0000, v18
  v_mfma_f32_16x16x32_bf16 v[160:163], v[40:43], v[64:67], v[160:163]
  v_lshlrev_b32 v18, 16, v19
  v_mfma_f32_16x16x32_bf16 v[164:167], v[44:47], v[64:67], v[164:167]
  v_and_b32 v19, 0xffff0000, v19
  v_mfma_f32_16x16x32_bf16 v[180:183], v[44:47], v[68:71], v[180:183]
  s_waitcnt lgkmcnt(2)
  v_lshlrev_b32_e64 v20, 16, v22
  v_mfma_f32_16x16x32_bf16 v[176:179], v[40:43], v[68:71], v[176:179]
  v_and_b32 v21, 0xffff0000, v22
  v_mfma_f32_16x16x32_bf16 v[172:175], v[36:39], v[68:71], v[172:175]
  v_lshlrev_b32 v22, 16, v23
  v_mfma_f32_16x16x32_bf16 v[168:171], v[32:35], v[68:71], v[168:171]
  v_and_b32 v23, 0xffff0000, v23
  v_mfma_f32_16x16x32_bf16 v[184:187], v[32:35], v[72:75], v[184:187]
  s_waitcnt lgkmcnt(1)
  v_lshlrev_b32_e64 v24, 16, v26
  v_mfma_f32_16x16x32_bf16 v[188:191], v[36:39], v[72:75], v[188:191]
  v_and_b32 v25, 0xffff0000, v26
  v_mfma_f32_16x16x32_bf16 v[192:195], v[40:43], v[72:75], v[192:195]
  v_lshlrev_b32 v26, 16, v27
  v_mfma_f32_16x16x32_bf16 v[196:199], v[44:47], v[72:75], v[196:199]
  v_and_b32 v27, 0xffff0000, v27
  v_mfma_f32_16x16x32_bf16 v[212:215], v[44:47], v[76:79], v[212:215]
  s_waitcnt lgkmcnt(0)
  v_lshlrev_b32_e64 v28, 16, v30
  v_mfma_f32_16x16x32_bf16 v[208:211], v[40:43], v[76:79], v[208:211]
  v_and_b32 v29, 0xffff0000, v30
  v_mfma_f32_16x16x32_bf16 v[204:207], v[36:39], v[76:79], v[204:207]
  v_lshlrev_b32_e64 v30, 16, v31
  v_mfma_f32_16x16x32_bf16 v[200:203], v[32:35], v[76:79], v[200:203]
  v_and_b32 v31, 0xffff0000, v31
  v_mfma_f32_16x16x32_bf16 v[216:219], v[32:35], v[80:83], v[216:219]
  v_mfma_f32_16x16x32_bf16 v[220:223], v[36:39], v[80:83], v[220:223]
  v_mfma_f32_16x16x32_bf16 v[224:227], v[40:43], v[80:83], v[224:227]
  v_mfma_f32_16x16x32_bf16 v[228:231], v[44:47], v[80:83], v[228:231]
  v_mfma_f32_16x16x32_bf16 v[244:247], v[44:47], v[84:87], v[244:247]
  v_mfma_f32_16x16x32_bf16 v[240:243], v[40:43], v[84:87], v[240:243]
  v_mfma_f32_16x16x32_bf16 v[236:239], v[36:39], v[84:87], v[236:239]
  v_mfma_f32_16x16x32_bf16 v[232:235], v[32:35], v[84:87], v[232:235]
L_epi:
  v_pk_mul_f32 v[52:53], v[88:89], v[88:89]
  v_pk_mul_f32 v[56:57], v[104:105], v[104:105]
  v_pk_mul_f32 v[60:61], v[90:91], v[90:91]
  v_pk_mul_f32 v[64:65], v[106:107], v[106:107]
  v_pk_fma_f32 v[52:53], v[52:53], v[14:15], v[12:13]
  v_pk_fma_f32 v[56:57], v[56:57], v[14:15], v[12:13]
  v_pk_fma_f32 v[60:61], v[60:61], v[14:15], v[12:13]
  v_pk_fma_f32 v[64:65], v[64:65], v[14:15], v[12:13]
  v_pk_mul_f32 v[52:53], v[52:53], v[88:89]
  v_pk_mul_f32 v[56:57], v[56:57], v[104:105]
  v_pk_mul_f32 v[60:61], v[60:61], v[90:91]
  v_pk_mul_f32 v[64:65], v[64:65], v[106:107]
  v_exp_f32 v52, v52
  v_exp_f32 v53, v53
  v_exp_f32 v56, v56
  v_exp_f32 v57, v57
  v_exp_f32 v60, v60
  v_exp_f32 v61, v61
  v_exp_f32 v64, v64
  v_exp_f32 v65, v65
  v_pk_mul_f32 v[54:55], v[88:89], v[16:17]
  v_pk_mul_f32 v[58:59], v[104:105], v[16:17]
  v_pk_mul_f32 v[62:63], v[90:91], v[18:19]
  v_pk_mul_f32 v[66:67], v[106:107], v[18:19]
  v_pk_add_f32 v[52:53], v[52:53], v[248:249]
  v_pk_add_f32 v[56:57], v[56:57], v[248:249]
  v_pk_add_f32 v[60:61], v[60:61], v[248:249]
  v_pk_add_f32 v[64:65], v[64:65], v[248:249]
  v_rcp_f32 v52, v52
  v_rcp_f32 v53, v53
  v_rcp_f32 v56, v56
  v_rcp_f32 v57, v57
  v_rcp_f32 v60, v60
  v_rcp_f32 v61, v61
  v_rcp_f32 v64, v64
  v_rcp_f32 v65, v65
  v_pk_mul_f32 v[32:33], v[52:53], v[54:55]
  v_pk_mul_f32 v[34:35], v[56:57], v[58:59]
  v_pk_fma_f32 v[32:33], v[60:61], v[62:63], v[32:33]
  v_pk_fma_f32 v[34:35], v[64:65], v[66:67], v[34:35]
  v_pk_mul_f32 v[68:69], v[92:93], v[92:93]
  v_pk_mul_f32 v[72:73], v[108:109], v[108:109]
  v_pk_mul_f32 v[76:77], v[94:95], v[94:95]
  v_pk_mul_f32 v[80:81], v[110:111], v[110:111]
  v_pk_fma_f32 v[68:69], v[68:69], v[14:15], v[12:13]
  v_pk_fma_f32 v[72:73], v[72:73], v[14:15], v[12:13]
  v_pk_fma_f32 v[76:77], v[76:77], v[14:15], v[12:13]
  v_pk_fma_f32 v[80:81], v[80:81], v[14:15], v[12:13]
  v_pk_mul_f32 v[68:69], v[68:69], v[92:93]
  v_pk_mul_f32 v[72:73], v[72:73], v[108:109]
  v_pk_mul_f32 v[76:77], v[76:77], v[94:95]
  v_pk_mul_f32 v[80:81], v[80:81], v[110:111]
  v_exp_f32 v68, v68
  v_exp_f32 v69, v69
  v_exp_f32 v72, v72
  v_exp_f32 v73, v73
  v_exp_f32 v76, v76
  v_exp_f32 v77, v77
  v_exp_f32 v80, v80
  v_exp_f32 v81, v81
  v_pk_mul_f32 v[70:71], v[92:93], v[20:21]
  v_pk_mul_f32 v[74:75], v[108:109], v[20:21]
  v_pk_mul_f32 v[78:79], v[94:95], v[22:23]
  v_pk_mul_f32 v[82:83], v[110:111], v[22:23]
  v_pk_add_f32 v[68:69], v[68:69], v[248:249]
  v_pk_add_f32 v[72:73], v[72:73], v[248:249]
  v_pk_add_f32 v[76:77], v[76:77], v[248:249]
  v_pk_add_f32 v[80:81], v[80:81], v[248:249]
  v_rcp_f32 v68, v68
  v_rcp_f32 v69, v69
  v_rcp_f32 v72, v72
  v_rcp_f32 v73, v73
  v_rcp_f32 v76, v76
  v_rcp_f32 v77, v77
  v_rcp_f32 v80, v80
  v_rcp_f32 v81, v81
  v_pk_fma_f32 v[32:33], v[68:69], v[70:71], v[32:33]
  v_pk_fma_f32 v[34:35], v[72:73], v[74:75], v[34:35]
  v_pk_fma_f32 v[32:33], v[76:77], v[78:79], v[32:33]
  v_pk_fma_f32 v[34:35], v[80:81], v[82:83], v[34:35]
  v_pk_mul_f32 v[52:53], v[96:97], v[96:97]
  v_pk_mul_f32 v[56:57], v[112:113], v[112:113]
  v_pk_mul_f32 v[60:61], v[98:99], v[98:99]
  v_pk_mul_f32 v[64:65], v[114:115], v[114:115]
  v_pk_fma_f32 v[52:53], v[52:53], v[14:15], v[12:13]
  v_pk_fma_f32 v[56:57], v[56:57], v[14:15], v[12:13]
  v_pk_fma_f32 v[60:61], v[60:61], v[14:15], v[12:13]
  v_pk_fma_f32 v[64:65], v[64:65], v[14:15], v[12:13]
  v_pk_mul_f32 v[52:53], v[52:53], v[96:97]
  v_pk_mul_f32 v[56:57], v[56:57], v[112:113]
  v_pk_mul_f32 v[60:61], v[60:61], v[98:99]
  v_pk_mul_f32 v[64:65], v[64:65], v[114:115]
  v_exp_f32 v52, v52
  v_exp_f32 v53, v53
  v_exp_f32 v56, v56
  v_exp_f32 v57, v57
  v_exp_f32 v60, v60
  v_exp_f32 v61, v61
  v_exp_f32 v64, v64
  v_exp_f32 v65, v65
  v_pk_mul_f32 v[54:55], v[96:97], v[24:25]
  v_pk_mul_f32 v[58:59], v[112:113], v[24:25]
  v_pk_mul_f32 v[62:63], v[98:99], v[26:27]
  v_pk_mul_f32 v[66:67], v[114:115], v[26:27]
  v_pk_add_f32 v[52:53], v[52:53], v[248:249]
  v_pk_add_f32 v[56:57], v[56:57], v[248:249]
  v_pk_add_f32 v[60:61], v[60:61], v[248:249]
  v_pk_add_f32 v[64:65], v[64:65], v[248:249]
  v_rcp_f32 v52, v52
  v_rcp_f32 v53, v53
  v_rcp_f32 v56, v56
  v_rcp_f32 v57, v57
  v_rcp_f32 v60, v60
  v_rcp_f32 v61, v61
  v_rcp_f32 v64, v64
  v_rcp_f32 v65, v65
  v_pk_fma_f32 v[32:33], v[52:53], v[54:55], v[32:33]
  v_pk_fma_f32 v[34:35], v[56:57], v[58:59], v[34:35]
  v_pk_fma_f32 v[32:33], v[60:61], v[62:63], v[32:33]
  v_pk_fma_f32 v[34:35], v[64:65], v[66:67], v[34:35]
  v_pk_mul_f32 v[68:69], v[100:101], v[100:101]
  v_pk_mul_f32 v[72:73], v[116:117], v[116:117]
  v_pk_mul_f32 v[76:77], v[102:103], v[102:103]
  v_pk_mul_f32 v[80:81], v[118:119], v[118:119]
  v_pk_fma_f32 v[68:69], v[68:69], v[14:15], v[12:13]
  v_pk_fma_f32 v[72:73], v[72:73], v[14:15], v[12:13]
  v_pk_fma_f32 v[76:77], v[76:77], v[14:15], v[12:13]
  v_pk_fma_f32 v[80:81], v[80:81], v[14:15], v[12:13]
  v_pk_mul_f32 v[68:69], v[68:69], v[100:101]
  v_pk_mul_f32 v[72:73], v[72:73], v[116:117]
  v_pk_mul_f32 v[76:77], v[76:77], v[102:103]
  v_pk_mul_f32 v[80:81], v[80:81], v[118:119]
  v_exp_f32 v68, v68
  v_exp_f32 v69, v69
  v_exp_f32 v72, v72
  v_exp_f32 v73, v73
  v_exp_f32 v76, v76
  v_exp_f32 v77, v77
  v_exp_f32 v80, v80
  v_exp_f32 v81, v81
  v_pk_mul_f32 v[70:71], v[100:101], v[28:29]
  v_pk_mul_f32 v[74:75], v[116:117], v[28:29]
  v_pk_mul_f32 v[78:79], v[102:103], v[30:31]
  v_pk_mul_f32 v[82:83], v[118:119], v[30:31]
  v_pk_add_f32 v[68:69], v[68:69], v[248:249]
  v_pk_add_f32 v[72:73], v[72:73], v[248:249]
  v_pk_add_f32 v[76:77], v[76:77], v[248:249]
  v_pk_add_f32 v[80:81], v[80:81], v[248:249]
  v_rcp_f32 v68, v68
  v_rcp_f32 v69, v69
  v_rcp_f32 v72, v72
  v_rcp_f32 v73, v73
  v_rcp_f32 v76, v76
  v_rcp_f32 v77, v77
  v_rcp_f32 v80, v80
  v_rcp_f32 v81, v81
  v_pk_fma_f32 v[32:33], v[68:69], v[70:71], v[32:33]
  v_pk_fma_f32 v[34:35], v[72:73], v[74:75], v[34:35]
  v_pk_fma_f32 v[32:33], v[76:77], v[78:79], v[32:33]
  v_pk_fma_f32 v[34:35], v[80:81], v[82:83], v[34:35]
  v_pk_mul_f32 v[52:53], v[120:121], v[120:121]
  v_pk_mul_f32 v[56:57], v[136:137], v[136:137]
  v_pk_mul_f32 v[60:61], v[122:123], v[122:123]
  v_pk_mul_f32 v[64:65], v[138:139], v[138:139]
  v_pk_fma_f32 v[52:53], v[52:53], v[14:15], v[12:13]
  v_pk_fma_f32 v[56:57], v[56:57], v[14:15], v[12:13]
  v_pk_fma_f32 v[60:61], v[60:61], v[14:15], v[12:13]
  v_pk_fma_f32 v[64:65], v[64:65], v[14:15], v[12:13]
  v_pk_mul_f32 v[52:53], v[52:53], v[120:121]
  v_pk_mul_f32 v[56:57], v[56:57], v[136:137]
  v_pk_mul_f32 v[60:61], v[60:61], v[122:123]
  v_pk_mul_f32 v[64:65], v[64:65], v[138:139]
  v_exp_f32 v52, v52
  v_exp_f32 v53, v53
  v_exp_f32 v56, v56
  v_exp_f32 v57, v57
  v_exp_f32 v60, v60
  v_exp_f32 v61, v61
  v_exp_f32 v64, v64
  v_exp_f32 v65, v65
  v_pk_mul_f32 v[54:55], v[120:121], v[16:17]
  v_pk_mul_f32 v[58:59], v[136:137], v[16:17]
  v_pk_mul_f32 v[62:63], v[122:123], v[18:19]
  v_pk_mul_f32 v[66:67], v[138:139], v[18:19]
  v_pk_add_f32 v[52:53], v[52:53], v[248:249]
  v_pk_add_f32 v[56:57], v[56:57], v[248:249]
  v_pk_add_f32 v[60:61], v[60:61], v[248:249]
  v_pk_add_f32 v[64:65], v[64:65], v[248:249]
  v_rcp_f32 v52, v52
  v_rcp_f32 v53, v53
  v_rcp_f32 v56, v56
  v_rcp_f32 v57, v57
  v_rcp_f32 v60, v60
  v_rcp_f32 v61, v61
  v_rcp_f32 v64, v64
  v_rcp_f32 v65, v65
  v_pk_mul_f32 v[36:37], v[52:53], v[54:55]
  v_pk_mul_f32 v[38:39], v[56:57], v[58:59]
  v_pk_fma_f32 v[36:37], v[60:61], v[62:63], v[36:37]
  v_pk_fma_f32 v[38:39], v[64:65], v[66:67], v[38:39]
  v_pk_mul_f32 v[68:69], v[124:125], v[124:125]
  v_pk_mul_f32 v[72:73], v[140:141], v[140:141]
  v_pk_mul_f32 v[76:77], v[126:127], v[126:127]
  v_pk_mul_f32 v[80:81], v[142:143], v[142:143]
  v_pk_fma_f32 v[68:69], v[68:69], v[14:15], v[12:13]
  v_pk_fma_f32 v[72:73], v[72:73], v[14:15], v[12:13]
  v_pk_fma_f32 v[76:77], v[76:77], v[14:15], v[12:13]
  v_pk_fma_f32 v[80:81], v[80:81], v[14:15], v[12:13]
  v_pk_mul_f32 v[68:69], v[68:69], v[124:125]
  v_pk_mul_f32 v[72:73], v[72:73], v[140:141]
  v_pk_mul_f32 v[76:77], v[76:77], v[126:127]
  v_pk_mul_f32 v[80:81], v[80:81], v[142:143]
  v_exp_f32 v68, v68
  v_exp_f32 v69, v69
  v_exp_f32 v72, v72
  v_exp_f32 v73, v73
  v_exp_f32 v76, v76
  v_exp_f32 v77, v77
  v_exp_f32 v80, v80
  v_exp_f32 v81, v81
  v_pk_mul_f32 v[70:71], v[124:125], v[20:21]
  v_pk_mul_f32 v[74:75], v[140:141], v[20:21]
  v_pk_mul_f32 v[78:79], v[126:127], v[22:23]
  v_pk_mul_f32 v[82:83], v[142:143], v[22:23]
  v_pk_add_f32 v[68:69], v[68:69], v[248:249]
  v_pk_add_f32 v[72:73], v[72:73], v[248:249]
  v_pk_add_f32 v[76:77], v[76:77], v[248:249]
  v_pk_add_f32 v[80:81], v[80:81], v[248:249]
  v_rcp_f32 v68, v68
  v_rcp_f32 v69, v69
  v_rcp_f32 v72, v72
  v_rcp_f32 v73, v73
  v_rcp_f32 v76, v76
  v_rcp_f32 v77, v77
  v_rcp_f32 v80, v80
  v_rcp_f32 v81, v81
  v_pk_fma_f32 v[36:37], v[68:69], v[70:71], v[36:37]
  v_pk_fma_f32 v[38:39], v[72:73], v[74:75], v[38:39]
  v_pk_fma_f32 v[36:37], v[76:77], v[78:79], v[36:37]
  v_pk_fma_f32 v[38:39], v[80:81], v[82:83], v[38:39]
  v_pk_mul_f32 v[52:53], v[128:129], v[128:129]
  v_pk_mul_f32 v[56:57], v[144:145], v[144:145]
  v_pk_mul_f32 v[60:61], v[130:131], v[130:131]
  v_pk_mul_f32 v[64:65], v[146:147], v[146:147]
  v_pk_fma_f32 v[52:53], v[52:53], v[14:15], v[12:13]
  v_pk_fma_f32 v[56:57], v[56:57], v[14:15], v[12:13]
  v_pk_fma_f32 v[60:61], v[60:61], v[14:15], v[12:13]
  v_pk_fma_f32 v[64:65], v[64:65], v[14:15], v[12:13]
  v_pk_mul_f32 v[52:53], v[52:53], v[128:129]
  v_pk_mul_f32 v[56:57], v[56:57], v[144:145]
  v_pk_mul_f32 v[60:61], v[60:61], v[130:131]
  v_pk_mul_f32 v[64:65], v[64:65], v[146:147]
  v_exp_f32 v52, v52
  v_exp_f32 v53, v53
  v_exp_f32 v56, v56
  v_exp_f32 v57, v57
  v_exp_f32 v60, v60
  v_exp_f32 v61, v61
  v_exp_f32 v64, v64
  v_exp_f32 v65, v65
  v_pk_mul_f32 v[54:55], v[128:129], v[24:25]
  v_pk_mul_f32 v[58:59], v[144:145], v[24:25]
  v_pk_mul_f32 v[62:63], v[130:131], v[26:27]
  v_pk_mul_f32 v[66:67], v[146:147], v[26:27]
  v_pk_add_f32 v[52:53], v[52:53], v[248:249]
  v_pk_add_f32 v[56:57], v[56:57], v[248:249]
  v_pk_add_f32 v[60:61], v[60:61], v[248:249]
  v_pk_add_f32 v[64:65], v[64:65], v[248:249]
  v_rcp_f32 v52, v52
  v_rcp_f32 v53, v53
  v_rcp_f32 v56, v56
  v_rcp_f32 v57, v57
  v_rcp_f32 v60, v60
  v_rcp_f32 v61, v61
  v_rcp_f32 v64, v64
  v_rcp_f32 v65, v65
  v_pk_fma_f32 v[36:37], v[52:53], v[54:55], v[36:37]
  v_pk_fma_f32 v[38:39], v[56:57], v[58:59], v[38:39]
  v_pk_fma_f32 v[36:37], v[60:61], v[62:63], v[36:37]
  v_pk_fma_f32 v[38:39], v[64:65], v[66:67], v[38:39]
  v_pk_mul_f32 v[68:69], v[132:133], v[132:133]
  v_pk_mul_f32 v[72:73], v[148:149], v[148:149]
  v_pk_mul_f32 v[76:77], v[134:135], v[134:135]
  v_pk_mul_f32 v[80:81], v[150:151], v[150:151]
  v_pk_fma_f32 v[68:69], v[68:69], v[14:15], v[12:13]
  v_pk_fma_f32 v[72:73], v[72:73], v[14:15], v[12:13]
  v_pk_fma_f32 v[76:77], v[76:77], v[14:15], v[12:13]
  v_pk_fma_f32 v[80:81], v[80:81], v[14:15], v[12:13]
  v_pk_mul_f32 v[68:69], v[68:69], v[132:133]
  v_pk_mul_f32 v[72:73], v[72:73], v[148:149]
  v_pk_mul_f32 v[76:77], v[76:77], v[134:135]
  v_pk_mul_f32 v[80:81], v[80:81], v[150:151]
  v_exp_f32 v68, v68
  v_exp_f32 v69, v69
  v_exp_f32 v72, v72
  v_exp_f32 v73, v73
  v_exp_f32 v76, v76
  v_exp_f32 v77, v77
  v_exp_f32 v80, v80
  v_exp_f32 v81, v81
  v_pk_mul_f32 v[70:71], v[132:133], v[28:29]
  v_pk_mul_f32 v[74:75], v[148:149], v[28:29]
  v_pk_mul_f32 v[78:79], v[134:135], v[30:31]
  v_pk_mul_f32 v[82:83], v[150:151], v[30:31]
  v_pk_add_f32 v[68:69], v[68:69], v[248:249]
  v_pk_add_f32 v[72:73], v[72:73], v[248:249]
  v_pk_add_f32 v[76:77], v[76:77], v[248:249]
  v_pk_add_f32 v[80:81], v[80:81], v[248:249]
  v_rcp_f32 v68, v68
  v_rcp_f32 v69, v69
  v_rcp_f32 v72, v72
  v_rcp_f32 v73, v73
  v_rcp_f32 v76, v76
  v_rcp_f32 v77, v77
  v_rcp_f32 v80, v80
  v_rcp_f32 v81, v81
  v_pk_fma_f32 v[36:37], v[68:69], v[70:71], v[36:37]
  v_pk_fma_f32 v[38:39], v[72:73], v[74:75], v[38:39]
  v_pk_fma_f32 v[36:37], v[76:77], v[78:79], v[36:37]
  v_pk_fma_f32 v[38:39], v[80:81], v[82:83], v[38:39]
  v_pk_mul_f32 v[52:53], v[152:153], v[152:153]
  v_pk_mul_f32 v[56:57], v[168:169], v[168:169]
  v_pk_mul_f32 v[60:61], v[154:155], v[154:155]
  v_pk_mul_f32 v[64:65], v[170:171], v[170:171]
  v_pk_fma_f32 v[52:53], v[52:53], v[14:15], v[12:13]
  v_pk_fma_f32 v[56:57], v[56:57], v[14:15], v[12:13]
  v_pk_fma_f32 v[60:61], v[60:61], v[14:15], v[12:13]
  v_pk_fma_f32 v[64:65], v[64:65], v[14:15], v[12:13]
  v_pk_mul_f32 v[52:53], v[52:53], v[152:153]
  v_pk_mul_f32 v[56:57], v[56:57], v[168:169]
  v_pk_mul_f32 v[60:61], v[60:61], v[154:155]
  v_pk_mul_f32 v[64:65], v[64:65], v[170:171]
  v_exp_f32 v52, v52
  v_exp_f32 v53, v53
  v_exp_f32 v56, v56
  v_exp_f32 v57, v57
  v_exp_f32 v60, v60
  v_exp_f32 v61, v61
  v_exp_f32 v64, v64
  v_exp_f32 v65, v65
  v_pk_mul_f32 v[54:55], v[152:153], v[16:17]
  v_pk_mul_f32 v[58:59], v[168:169], v[16:17]
  v_pk_mul_f32 v[62:63], v[154:155], v[18:19]
  v_pk_mul_f32 v[66:67], v[170:171], v[18:19]
  v_pk_add_f32 v[52:53], v[52:53], v[248:249]
  v_pk_add_f32 v[56:57], v[56:57], v[248:249]
  v_pk_add_f32 v[60:61], v[60:61], v[248:249]
  v_pk_add_f32 v[64:65], v[64:65], v[248:249]
  v_rcp_f32 v52, v52
  v_rcp_f32 v53, v53
  v_rcp_f32 v56, v56
  v_rcp_f32 v57, v57
  v_rcp_f32 v60, v60
  v_rcp_f32 v61, v61
  v_rcp_f32 v64, v64
  v_rcp_f32 v65, v65
  v_pk_mul_f32 v[40:41], v[52:53], v[54:55]
  v_pk_mul_f32 v[42:43], v[56:57], v[58:59]
  v_pk_fma_f32 v[40:41], v[60:61], v[62:63], v[40:41]
  v_pk_fma_f32 v[42:43], v[64:65], v[66:67], v[42:43]
  v_pk_mul_f32 v[68:69], v[156:157], v[156:157]
  v_pk_mul_f32 v[72:73], v[172:173], v[172:173]
  v_pk_mul_f32 v[76:77], v[158:159], v[158:159]
  v_pk_mul_f32 v[80:81], v[174:175], v[174:175]
  v_pk_fma_f32 v[68:69], v[68:69], v[14:15], v[12:13]
  v_pk_fma_f32 v[72:73], v[72:73], v[14:15], v[12:13]
  v_pk_fma_f32 v[76:77], v[76:77], v[14:15], v[12:13]
  v_pk_fma_f32 v[80:81], v[80:81], v[14:15], v[12:13]
  v_pk_mul_f32 v[68:69], v[68:69], v[156:157]
  v_pk_mul_f32 v[72:73], v[72:73], v[172:173]
  v_pk_mul_f32 v[76:77], v[76:77], v[158:159]
  v_pk_mul_f32 v[80:81], v[80:81], v[174:175]
  v_exp_f32 v68, v68
  v_exp_f32 v69, v69
  v_exp_f32 v72, v72
  v_exp_f32 v73, v73
  v_exp_f32 v76, v76
  v_exp_f32 v77, v77
  v_exp_f32 v80, v80
  v_exp_f32 v81, v81
  v_pk_mul_f32 v[70:71], v[156:157], v[20:21]
  v_pk_mul_f32 v[74:75], v[172:173], v[20:21]
  v_pk_mul_f32 v[78:79], v[158:159], v[22:23]
  v_pk_mul_f32 v[82:83], v[174:175], v[22:23]
  v_pk_add_f32 v[68:69], v[68:69], v[248:249]
  v_pk_add_f32 v[72:73], v[72:73], v[248:249]
  v_pk_add_f32 v[76:77], v[76:77], v[248:249]
  v_pk_add_f32 v[80:81], v[80:81], v[248:249]
  v_rcp_f32 v68, v68
  v_rcp_f32 v69, v69
  v_rcp_f32 v72, v72
  v_rcp_f32 v73, v73
  v_rcp_f32 v76, v76
  v_rcp_f32 v77, v77
  v_rcp_f32 v80, v80
  v_rcp_f32 v81, v81
  v_pk_fma_f32 v[40:41], v[68:69], v[70:71], v[40:41]
  v_pk_fma_f32 v[42:43], v[72:73], v[74:75], v[42:43]
  v_pk_fma_f32 v[40:41], v[76:77], v[78:79], v[40:41]
  v_pk_fma_f32 v[42:43], v[80:81], v[82:83], v[42:43]
  v_pk_mul_f32 v[52:53], v[160:161], v[160:161]
  v_pk_mul_f32 v[56:57], v[176:177], v[176:177]
  v_pk_mul_f32 v[60:61], v[162:163], v[162:163]
  v_pk_mul_f32 v[64:65], v[178:179], v[178:179]
  v_pk_fma_f32 v[52:53], v[52:53], v[14:15], v[12:13]
  v_pk_fma_f32 v[56:57], v[56:57], v[14:15], v[12:13]
  v_pk_fma_f32 v[60:61], v[60:61], v[14:15], v[12:13]
  v_pk_fma_f32 v[64:65], v[64:65], v[14:15], v[12:13]
  v_pk_mul_f32 v[52:53], v[52:53], v[160:161]
  v_pk_mul_f32 v[56:57], v[56:57], v[176:177]
  v_pk_mul_f32 v[60:61], v[60:61], v[162:163]
  v_pk_mul_f32 v[64:65], v[64:65], v[178:179]
  v_exp_f32 v52, v52
  v_exp_f32 v53, v53
  v_exp_f32 v56, v56
  v_exp_f32 v57, v57
  v_exp_f32 v60, v60
  v_exp_f32 v61, v61
  v_exp_f32 v64, v64
  v_exp_f32 v65, v65
  v_pk_mul_f32 v[54:55], v[160:161], v[24:25]
  v_pk_mul_f32 v[58:59], v[176:177], v[24:25]
  v_pk_mul_f32 v[62:63], v[162:163], v[26:27]
  v_pk_mul_f32 v[66:67], v[178:179], v[26:27]
  v_pk_add_f32 v[52:53], v[52:53], v[248:249]
  v_pk_add_f32 v[56:57], v[56:57], v[248:249]
  v_pk_add_f32 v[60:61], v[60:61], v[248:249]
  v_pk_add_f32 v[64:65], v[64:65], v[248:249]
  v_rcp_f32 v52, v52
  v_rcp_f32 v53, v53
  v_rcp_f32 v56, v56
  v_rcp_f32 v57, v57
  v_rcp_f32 v60, v60
  v_rcp_f32 v61, v61
  v_rcp_f32 v64, v64
  v_rcp_f32 v65, v65
  v_pk_fma_f32 v[40:41], v[52:53], v[54:55], v[40:41]
  v_pk_fma_f32 v[42:43], v[56:57], v[58:59], v[42:43]
  v_pk_fma_f32 v[40:41], v[60:61], v[62:63], v[40:41]
  v_pk_fma_f32 v[42:43], v[64:65], v[66:67], v[42:43]
  v_pk_mul_f32 v[68:69], v[164:165], v[164:165]
  v_pk_mul_f32 v[72:73], v[180:181], v[180:181]
  v_pk_mul_f32 v[76:77], v[166:167], v[166:167]
  v_pk_mul_f32 v[80:81], v[182:183], v[182:183]
  v_pk_fma_f32 v[68:69], v[68:69], v[14:15], v[12:13]
  v_pk_fma_f32 v[72:73], v[72:73], v[14:15], v[12:13]
  v_pk_fma_f32 v[76:77], v[76:77], v[14:15], v[12:13]
  v_pk_fma_f32 v[80:81], v[80:81], v[14:15], v[12:13]
  v_pk_mul_f32 v[68:69], v[68:69], v[164:165]
  v_pk_mul_f32 v[72:73], v[72:73], v[180:181]
  v_pk_mul_f32 v[76:77], v[76:77], v[166:167]
  v_pk_mul_f32 v[80:81], v[80:81], v[182:183]
  v_exp_f32 v68, v68
  v_exp_f32 v69, v69
  v_exp_f32 v72, v72
  v_exp_f32 v73, v73
  v_exp_f32 v76, v76
  v_exp_f32 v77, v77
  v_exp_f32 v80, v80
  v_exp_f32 v81, v81
  v_pk_mul_f32 v[70:71], v[164:165], v[28:29]
  v_pk_mul_f32 v[74:75], v[180:181], v[28:29]
  v_pk_mul_f32 v[78:79], v[166:167], v[30:31]
  v_pk_mul_f32 v[82:83], v[182:183], v[30:31]
  v_pk_add_f32 v[68:69], v[68:69], v[248:249]
  v_pk_add_f32 v[72:73], v[72:73], v[248:249]
  v_pk_add_f32 v[76:77], v[76:77], v[248:249]
  v_pk_add_f32 v[80:81], v[80:81], v[248:249]
  v_rcp_f32 v68, v68
  v_rcp_f32 v69, v69
  v_rcp_f32 v72, v72
  v_rcp_f32 v73, v73
  v_rcp_f32 v76, v76
  v_rcp_f32 v77, v77
  v_rcp_f32 v80, v80
  v_rcp_f32 v81, v81
  v_pk_fma_f32 v[40:41], v[68:69], v[70:71], v[40:41]
  v_pk_fma_f32 v[42:43], v[72:73], v[74:75], v[42:43]
  v_pk_fma_f32 v[40:41], v[76:77], v[78:79], v[40:41]
  v_pk_fma_f32 v[42:43], v[80:81], v[82:83], v[42:43]
  v_pk_mul_f32 v[52:53], v[184:185], v[184:185]
  v_pk_mul_f32 v[56:57], v[200:201], v[200:201]
  v_pk_mul_f32 v[60:61], v[186:187], v[186:187]
  v_pk_mul_f32 v[64:65], v[202:203], v[202:203]
  v_pk_fma_f32 v[52:53], v[52:53], v[14:15], v[12:13]
  v_pk_fma_f32 v[56:57], v[56:57], v[14:15], v[12:13]
  v_pk_fma_f32 v[60:61], v[60:61], v[14:15], v[12:13]
  v_pk_fma_f32 v[64:65], v[64:65], v[14:15], v[12:13]
  v_pk_mul_f32 v[52:53], v[52:53], v[184:185]
  v_pk_mul_f32 v[56:57], v[56:57], v[200:201]
  v_pk_mul_f32 v[60:61], v[60:61], v[186:187]
  v_pk_mul_f32 v[64:65], v[64:65], v[202:203]
  v_exp_f32 v52, v52
  v_exp_f32 v53, v53
  v_exp_f32 v56, v56
  v_exp_f32 v57, v57
  v_exp_f32 v60, v60
  v_exp_f32 v61, v61
  v_exp_f32 v64, v64
  v_exp_f32 v65, v65
  v_pk_mul_f32 v[54:55], v[184:185], v[16:17]
  v_pk_mul_f32 v[58:59], v[200:201], v[16:17]
  v_pk_mul_f32 v[62:63], v[186:187], v[18:19]
  v_pk_mul_f32 v[66:67], v[202:203], v[18:19]
  v_pk_add_f32 v[52:53], v[52:53], v[248:249]
  v_pk_add_f32 v[56:57], v[56:57], v[248:249]
  v_pk_add_f32 v[60:61], v[60:61], v[248:249]
  v_pk_add_f32 v[64:65], v[64:65], v[248:249]
  v_rcp_f32 v52, v52
  v_rcp_f32 v53, v53
  v_rcp_f32 v56, v56
  v_rcp_f32 v57, v57
  v_rcp_f32 v60, v60
  v_rcp_f32 v61, v61
  v_rcp_f32 v64, v64
  v_rcp_f32 v65, v65
  v_pk_mul_f32 v[44:45], v[52:53], v[54:55]
  v_pk_mul_f32 v[46:47], v[56:57], v[58:59]
  v_pk_fma_f32 v[44:45], v[60:61], v[62:63], v[44:45]
  v_pk_fma_f32 v[46:47], v[64:65], v[66:67], v[46:47]
  v_pk_mul_f32 v[68:69], v[188:189], v[188:189]
  v_pk_mul_f32 v[72:73], v[204:205], v[204:205]
  v_pk_mul_f32 v[76:77], v[190:191], v[190:191]
  v_pk_mul_f32 v[80:81], v[206:207], v[206:207]
  v_pk_fma_f32 v[68:69], v[68:69], v[14:15], v[12:13]
  v_pk_fma_f32 v[72:73], v[72:73], v[14:15], v[12:13]
  v_pk_fma_f32 v[76:77], v[76:77], v[14:15], v[12:13]
  v_pk_fma_f32 v[80:81], v[80:81], v[14:15], v[12:13]
  v_pk_mul_f32 v[68:69], v[68:69], v[188:189]
  v_pk_mul_f32 v[72:73], v[72:73], v[204:205]
  v_pk_mul_f32 v[76:77], v[76:77], v[190:191]
  v_pk_mul_f32 v[80:81], v[80:81], v[206:207]
  v_exp_f32 v68, v68
  v_exp_f32 v69, v69
  v_exp_f32 v72, v72
  v_exp_f32 v73, v73
  v_exp_f32 v76, v76
  v_exp_f32 v77, v77
  v_exp_f32 v80, v80
  v_exp_f32 v81, v81
  v_pk_mul_f32 v[70:71], v[188:189], v[20:21]
  v_pk_mul_f32 v[74:75], v[204:205], v[20:21]
  v_pk_mul_f32 v[78:79], v[190:191], v[22:23]
  v_pk_mul_f32 v[82:83], v[206:207], v[22:23]
  v_pk_add_f32 v[68:69], v[68:69], v[248:249]
  v_pk_add_f32 v[72:73], v[72:73], v[248:249]
  v_pk_add_f32 v[76:77], v[76:77], v[248:249]
  v_pk_add_f32 v[80:81], v[80:81], v[248:249]
  v_rcp_f32 v68, v68
  v_rcp_f32 v69, v69
  v_rcp_f32 v72, v72
  v_rcp_f32 v73, v73
  v_rcp_f32 v76, v76
  v_rcp_f32 v77, v77
  v_rcp_f32 v80, v80
  v_rcp_f32 v81, v81
  v_pk_fma_f32 v[44:45], v[68:69], v[70:71], v[44:45]
  v_pk_fma_f32 v[46:47], v[72:73], v[74:75], v[46:47]
  v_pk_fma_f32 v[44:45], v[76:77], v[78:79], v[44:45]
  v_pk_fma_f32 v[46:47], v[80:81], v[82:83], v[46:47]
  v_pk_mul_f32 v[52:53], v[192:193], v[192:193]
  v_pk_mul_f32 v[56:57], v[208:209], v[208:209]
  v_pk_mul_f32 v[60:61], v[194:195], v[194:195]
  v_pk_mul_f32 v[64:65], v[210:211], v[210:211]
  v_pk_fma_f32 v[52:53], v[52:53], v[14:15], v[12:13]
  v_pk_fma_f32 v[56:57], v[56:57], v[14:15], v[12:13]
  v_pk_fma_f32 v[60:61], v[60:61], v[14:15], v[12:13]
  v_pk_fma_f32 v[64:65], v[64:65], v[14:15], v[12:13]
  v_pk_mul_f32 v[52:53], v[52:53], v[192:193]
  v_pk_mul_f32 v[56:57], v[56:57], v[208:209]
  v_pk_mul_f32 v[60:61], v[60:61], v[194:195]
  v_pk_mul_f32 v[64:65], v[64:65], v[210:211]
  v_exp_f32 v52, v52
  v_exp_f32 v53, v53
  v_exp_f32 v56, v56
  v_exp_f32 v57, v57
  v_exp_f32 v60, v60
  v_exp_f32 v61, v61
  v_exp_f32 v64, v64
  v_exp_f32 v65, v65
  v_pk_mul_f32 v[54:55], v[192:193], v[24:25]
  v_pk_mul_f32 v[58:59], v[208:209], v[24:25]
  v_pk_mul_f32 v[62:63], v[194:195], v[26:27]
  v_pk_mul_f32 v[66:67], v[210:211], v[26:27]
  v_pk_add_f32 v[52:53], v[52:53], v[248:249]
  v_pk_add_f32 v[56:57], v[56:57], v[248:249]
  v_pk_add_f32 v[60:61], v[60:61], v[248:249]
  v_pk_add_f32 v[64:65], v[64:65], v[248:249]
  v_rcp_f32 v52, v52
  v_rcp_f32 v53, v53
  v_rcp_f32 v56, v56
  v_rcp_f32 v57, v57
  v_rcp_f32 v60, v60
  v_rcp_f32 v61, v61
  v_rcp_f32 v64, v64
  v_rcp_f32 v65, v65
  v_pk_fma_f32 v[44:45], v[52:53], v[54:55], v[44:45]
  v_pk_fma_f32 v[46:47], v[56:57], v[58:59], v[46:47]
  v_pk_fma_f32 v[44:45], v[60:61], v[62:63], v[44:45]
  v_pk_fma_f32 v[46:47], v[64:65], v[66:67], v[46:47]
  v_pk_mul_f32 v[68:69], v[196:197], v[196:197]
  v_pk_mul_f32 v[72:73], v[212:213], v[212:213]
  v_pk_mul_f32 v[76:77], v[198:199], v[198:199]
  v_pk_mul_f32 v[80:81], v[214:215], v[214:215]
  v_pk_fma_f32 v[68:69], v[68:69], v[14:15], v[12:13]
  v_pk_fma_f32 v[72:73], v[72:73], v[14:15], v[12:13]
  v_pk_fma_f32 v[76:77], v[76:77], v[14:15], v[12:13]
  v_pk_fma_f32 v[80:81], v[80:81], v[14:15], v[12:13]
  v_pk_mul_f32 v[68:69], v[68:69], v[196:197]
  v_pk_mul_f32 v[72:73], v[72:73], v[212:213]
  v_pk_mul_f32 v[76:77], v[76:77], v[198:199]
  v_pk_mul_f32 v[80:81], v[80:81], v[214:215]
  v_exp_f32 v68, v68
  v_exp_f32 v69, v69
  v_exp_f32 v72, v72
  v_exp_f32 v73, v73
  v_exp_f32 v76, v76
  v_exp_f32 v77, v77
  v_exp_f32 v80, v80
  v_exp_f32 v81, v81
  v_pk_mul_f32 v[70:71], v[196:197], v[28:29]
  v_pk_mul_f32 v[74:75], v[212:213], v[28:29]
  v_pk_mul_f32 v[78:79], v[198:199], v[30:31]
  v_pk_mul_f32 v[82:83], v[214:215], v[30:31]
  v_pk_add_f32 v[68:69], v[68:69], v[248:249]
  v_pk_add_f32 v[72:73], v[72:73], v[248:249]
  v_pk_add_f32 v[76:77], v[76:77], v[248:249]
  v_pk_add_f32 v[80:81], v[80:81], v[248:249]
  v_rcp_f32 v68, v68
  v_rcp_f32 v69, v69
  v_rcp_f32 v72, v72
  v_rcp_f32 v73, v73
  v_rcp_f32 v76, v76
  v_rcp_f32 v77, v77
  v_rcp_f32 v80, v80
  v_rcp_f32 v81, v81
  v_pk_fma_f32 v[44:45], v[68:69], v[70:71], v[44:45]
  v_pk_fma_f32 v[46:47], v[72:73], v[74:75], v[46:47]
  v_pk_fma_f32 v[44:45], v[76:77], v[78:79], v[44:45]
  v_pk_fma_f32 v[46:47], v[80:81], v[82:83], v[46:47]
  v_pk_mul_f32 v[52:53], v[216:217], v[216:217]
  v_pk_mul_f32 v[56:57], v[232:233], v[232:233]
  v_pk_mul_f32 v[60:61], v[218:219], v[218:219]
  v_pk_mul_f32 v[64:65], v[234:235], v[234:235]
  v_pk_fma_f32 v[52:53], v[52:53], v[14:15], v[12:13]
  v_pk_fma_f32 v[56:57], v[56:57], v[14:15], v[12:13]
  v_pk_fma_f32 v[60:61], v[60:61], v[14:15], v[12:13]
  v_pk_fma_f32 v[64:65], v[64:65], v[14:15], v[12:13]
  v_pk_mul_f32 v[52:53], v[52:53], v[216:217]
  v_pk_mul_f32 v[56:57], v[56:57], v[232:233]
  v_pk_mul_f32 v[60:61], v[60:61], v[218:219]
  v_pk_mul_f32 v[64:65], v[64:65], v[234:235]
  v_exp_f32 v52, v52
  v_exp_f32 v53, v53
  v_exp_f32 v56, v56
  v_exp_f32 v57, v57
  v_exp_f32 v60, v60
  v_exp_f32 v61, v61
  v_exp_f32 v64, v64
  v_exp_f32 v65, v65
  v_pk_mul_f32 v[54:55], v[216:217], v[16:17]
  v_pk_mul_f32 v[58:59], v[232:233], v[16:17]
  v_pk_mul_f32 v[62:63], v[218:219], v[18:19]
  v_pk_mul_f32 v[66:67], v[234:235], v[18:19]
  v_pk_add_f32 v[52:53], v[52:53], v[248:249]
  v_pk_add_f32 v[56:57], v[56:57], v[248:249]
  v_pk_add_f32 v[60:61], v[60:61], v[248:249]
  v_pk_add_f32 v[64:65], v[64:65], v[248:249]
  v_rcp_f32 v52, v52
  v_rcp_f32 v53, v53
  v_rcp_f32 v56, v56
  v_rcp_f32 v57, v57
  v_rcp_f32 v60, v60
  v_rcp_f32 v61, v61
  v_rcp_f32 v64, v64
  v_rcp_f32 v65, v65
  v_pk_mul_f32 v[48:49], v[52:53], v[54:55]
  v_pk_mul_f32 v[50:51], v[56:57], v[58:59]
  v_pk_fma_f32 v[48:49], v[60:61], v[62:63], v[48:49]
  v_pk_fma_f32 v[50:51], v[64:65], v[66:67], v[50:51]
  v_pk_mul_f32 v[68:69], v[220:221], v[220:221]
  v_pk_mul_f32 v[72:73], v[236:237], v[236:237]
  v_pk_mul_f32 v[76:77], v[222:223], v[222:223]
  v_pk_mul_f32 v[80:81], v[238:239], v[238:239]
  v_pk_fma_f32 v[68:69], v[68:69], v[14:15], v[12:13]
  v_pk_fma_f32 v[72:73], v[72:73], v[14:15], v[12:13]
  v_pk_fma_f32 v[76:77], v[76:77], v[14:15], v[12:13]
  v_pk_fma_f32 v[80:81], v[80:81], v[14:15], v[12:13]
  v_pk_mul_f32 v[68:69], v[68:69], v[220:221]
  v_pk_mul_f32 v[72:73], v[72:73], v[236:237]
  v_pk_mul_f32 v[76:77], v[76:77], v[222:223]
  v_pk_mul_f32 v[80:81], v[80:81], v[238:239]
  v_exp_f32 v68, v68
  v_exp_f32 v69, v69
  v_exp_f32 v72, v72
  v_exp_f32 v73, v73
  v_exp_f32 v76, v76
  v_exp_f32 v77, v77
  v_exp_f32 v80, v80
  v_exp_f32 v81, v81
  v_pk_mul_f32 v[70:71], v[220:221], v[20:21]
  v_pk_mul_f32 v[74:75], v[236:237], v[20:21]
  v_pk_mul_f32 v[78:79], v[222:223], v[22:23]
  v_pk_mul_f32 v[82:83], v[238:239], v[22:23]
  v_pk_add_f32 v[68:69], v[68:69], v[248:249]
  v_pk_add_f32 v[72:73], v[72:73], v[248:249]
  v_pk_add_f32 v[76:77], v[76:77], v[248:249]
  v_pk_add_f32 v[80:81], v[80:81], v[248:249]
  v_rcp_f32 v68, v68
  v_rcp_f32 v69, v69
  v_rcp_f32 v72, v72
  v_rcp_f32 v73, v73
  v_rcp_f32 v76, v76
  v_rcp_f32 v77, v77
  v_rcp_f32 v80, v80
  v_rcp_f32 v81, v81
  v_pk_fma_f32 v[48:49], v[68:69], v[70:71], v[48:49]
  v_pk_fma_f32 v[50:51], v[72:73], v[74:75], v[50:51]
  v_pk_fma_f32 v[48:49], v[76:77], v[78:79], v[48:49]
  v_pk_fma_f32 v[50:51], v[80:81], v[82:83], v[50:51]
  v_pk_mul_f32 v[52:53], v[224:225], v[224:225]
  v_pk_mul_f32 v[56:57], v[240:241], v[240:241]
  v_pk_mul_f32 v[60:61], v[226:227], v[226:227]
  v_pk_mul_f32 v[64:65], v[242:243], v[242:243]
  v_pk_fma_f32 v[52:53], v[52:53], v[14:15], v[12:13]
  v_pk_fma_f32 v[56:57], v[56:57], v[14:15], v[12:13]
  v_pk_fma_f32 v[60:61], v[60:61], v[14:15], v[12:13]
  v_pk_fma_f32 v[64:65], v[64:65], v[14:15], v[12:13]
  v_pk_mul_f32 v[52:53], v[52:53], v[224:225]
  v_pk_mul_f32 v[56:57], v[56:57], v[240:241]
  v_pk_mul_f32 v[60:61], v[60:61], v[226:227]
  v_pk_mul_f32 v[64:65], v[64:65], v[242:243]
  v_exp_f32 v52, v52
  v_exp_f32 v53, v53
  v_exp_f32 v56, v56
  v_exp_f32 v57, v57
  v_exp_f32 v60, v60
  v_exp_f32 v61, v61
  v_exp_f32 v64, v64
  v_exp_f32 v65, v65
  v_pk_mul_f32 v[54:55], v[224:225], v[24:25]
  v_pk_mul_f32 v[58:59], v[240:241], v[24:25]
  v_pk_mul_f32 v[62:63], v[226:227], v[26:27]
  v_pk_mul_f32 v[66:67], v[242:243], v[26:27]
  v_pk_add_f32 v[52:53], v[52:53], v[248:249]
  v_pk_add_f32 v[56:57], v[56:57], v[248:249]
  v_pk_add_f32 v[60:61], v[60:61], v[248:249]
  v_pk_add_f32 v[64:65], v[64:65], v[248:249]
  v_rcp_f32 v52, v52
  v_rcp_f32 v53, v53
  v_rcp_f32 v56, v56
  v_rcp_f32 v57, v57
  v_rcp_f32 v60, v60
  v_rcp_f32 v61, v61
  v_rcp_f32 v64, v64
  v_rcp_f32 v65, v65
  v_pk_fma_f32 v[48:49], v[52:53], v[54:55], v[48:49]
  v_pk_fma_f32 v[50:51], v[56:57], v[58:59], v[50:51]
  v_pk_fma_f32 v[48:49], v[60:61], v[62:63], v[48:49]
  v_pk_fma_f32 v[50:51], v[64:65], v[66:67], v[50:51]
  v_pk_mul_f32 v[68:69], v[228:229], v[228:229]
  v_pk_mul_f32 v[72:73], v[244:245], v[244:245]
  v_pk_mul_f32 v[76:77], v[230:231], v[230:231]
  v_pk_mul_f32 v[80:81], v[246:247], v[246:247]
  v_pk_fma_f32 v[68:69], v[68:69], v[14:15], v[12:13]
  v_pk_fma_f32 v[72:73], v[72:73], v[14:15], v[12:13]
  v_pk_fma_f32 v[76:77], v[76:77], v[14:15], v[12:13]
  v_pk_fma_f32 v[80:81], v[80:81], v[14:15], v[12:13]
  v_pk_mul_f32 v[68:69], v[68:69], v[228:229]
  v_pk_mul_f32 v[72:73], v[72:73], v[244:245]
  v_pk_mul_f32 v[76:77], v[76:77], v[230:231]
  v_pk_mul_f32 v[80:81], v[80:81], v[246:247]
  v_exp_f32 v68, v68
  v_exp_f32 v69, v69
  v_exp_f32 v72, v72
  v_exp_f32 v73, v73
  v_exp_f32 v76, v76
  v_exp_f32 v77, v77
  v_exp_f32 v80, v80
  v_exp_f32 v81, v81
  v_pk_mul_f32 v[70:71], v[228:229], v[28:29]
  v_pk_mul_f32 v[74:75], v[244:245], v[28:29]
  v_pk_mul_f32 v[78:79], v[230:231], v[30:31]
  v_pk_mul_f32 v[82:83], v[246:247], v[30:31]
  v_pk_add_f32 v[68:69], v[68:69], v[248:249]
  v_pk_add_f32 v[72:73], v[72:73], v[248:249]
  v_pk_add_f32 v[76:77], v[76:77], v[248:249]
  v_pk_add_f32 v[80:81], v[80:81], v[248:249]
  v_rcp_f32 v68, v68
  v_rcp_f32 v69, v69
  v_rcp_f32 v72, v72
  v_rcp_f32 v73, v73
  v_rcp_f32 v76, v76
  v_rcp_f32 v77, v77
  v_rcp_f32 v80, v80
  v_rcp_f32 v81, v81
  v_pk_fma_f32 v[48:49], v[68:69], v[70:71], v[48:49]
  v_pk_fma_f32 v[50:51], v[72:73], v[74:75], v[50:51]
  v_pk_fma_f32 v[48:49], v[76:77], v[78:79], v[48:49]
  v_pk_fma_f32 v[50:51], v[80:81], v[82:83], v[50:51]
  v_add_f32 v32, v32, v33
  v_add_f32 v34, v34, v35
  v_add_f32 v36, v36, v37
  v_add_f32 v38, v38, v39
  v_add_f32 v40, v40, v41
  v_add_f32 v42, v42, v43
  v_add_f32 v44, v44, v45
  v_add_f32 v46, v46, v47
  v_add_f32 v48, v48, v49
  v_add_f32 v50, v50, v51
  v_permlane32_swap_b32 v32, v34
  v_permlane32_swap_b32 v36, v38
  v_permlane32_swap_b32 v40, v42
  v_permlane32_swap_b32 v44, v46
  v_permlane32_swap_b32 v48, v50
  v_add_f32 v48, v48, v50
  v_add_f32 v32, v32, v34
  v_add_f32 v36, v36, v38
  v_add_f32 v40, v40, v42
  v_add_f32 v44, v44, v46
  v_mov_b32 v50, v48
  v_permlane16_swap_b32 v32, v36
  v_permlane16_swap_b32 v40, v44
  v_permlane16_swap_b32 v48, v50
  v_add_f32 v32, v32, v36
  v_add_f32 v40, v40, v44
  v_add_f32 v48, v48, v50
  ds_write_b32 v10, v32
  ds_write_b32 v10, v40 offset:256
  s_mov_b32 exec_lo, 0xffff
  s_mov_b32 exec_hi, 0xffff
  ds_write_b32 v10, v48 offset:512
  s_mov_b64 exec, -1
  s_waitcnt lgkmcnt(0)
  s_barrier
  s_endpgm
L_ld_tail:
  s_barrier
  s_add_u32 m0, s75, 122880
  s_nop 0
  buffer_load_dwordx4 v4, s[44:47], s74 offen lds
  s_add_u32 m0, s75, 123904
  s_nop 0
  buffer_load_dwordx4 v5, s[44:47], s74 offen lds
  s_add_u32 s74, s74, 106496
  s_mov_b32 m0, 147712
  s_mov_b64 exec, 0xffff
  buffer_load_dwordx4 v11, s[52:55], s77 offen lds
  s_mov_b64 exec, -1
  s_mov_b32 s60, s24
  s_and_b32 s61, s25, 0xffff
  s_mov_b32 s62, 268435456
  s_mov_b32 s63, 0x20000
  s_mov_b32 s56, s20
  s_and_b32 s57, s21, 0xffff
  s_mov_b32 s58, 8192
  s_mov_b32 s59, 0x20000
  s_mov_b32 s64, s22
  s_and_b32 s65, s23, 0xffff
  s_mov_b32 s66, 256
  s_mov_b32 s67, 0x20000
  s_load_dword s80, s[18:19], 0
  v_mov_b32 v100, 0
  s_mov_b64 exec, 1
  s_mov_b32 s81, 0x80000
  buffer_load_dword v101, v100, s[60:63], s81 offen
  buffer_load_dword v102, v100, s[56:59], 0 offen
  s_mov_b64 exec, -1
  s_mov_b64 exec, 1
  buffer_load_dword v250, v100, s[64:67], 0 offen offset:240 sc1
  s_mov_b64 exec, -1
  s_waitcnt vmcnt(11)
  s_barrier
  s_waitcnt vmcnt(0)
  s_barrier
  s_cmp_lg_u32 s3, 4
  s_cbranch_scc1 L_end
  v_lshlrev_b32 v3, 4, v0
  v_lshlrev_b32 v4, 2, v0
  v_add_u32 v1, 147968, v3
  v_add_u32 v2, 148992, v4
  v_add_u32 v4, 1024, v4
  v_mov_b32 v5, 32
  v_mov_b32 v7, s26
  s_mul_i32 s68, s26, 1280
  s_mul_i32 s69, s27, 16640
  s_add_u32 s69, s69, s68
  s_setprio 3
  v_mov_b32 v64, -1
  v_mov_b32 v65, -1
  v_mov_b32 v66, -1
  v_mov_b32 v67, -1
  buffer_store_dwordx4 v[64:67], v3, s[60:63], s69 offen sc1
  buffer_store_dword v64, v4, s[60:63], s69 offen sc1
  s_waitcnt vmcnt(0)
  s_barrier
  ds_read_b128 v[64:67], v1
  ds_read_b128 v[72:75], v1 offset:1280
  ds_read2st64_b32 v[68:69], v2 offset0:0 offset1:5
  s_waitcnt lgkmcnt(0)
  v_pk_add_f32 v[64:65], v[64:65], v[72:73]
  v_pk_add_f32 v[66:67], v[66:67], v[74:75]
  v_add_f32 v68, v68, v69
  v_min_u32 v64, -2, v64
  v_min_u32 v65, -2, v65
  v_min_u32 v66, -2, v66
  v_min_u32 v67, -2, v67
  v_min_u32 v68, -2, v68
  buffer_store_dwordx4 v[64:67], v3, s[60:63], s69 offen sc1
  buffer_store_dword v68, v4, s[60:63], s69 offen sc1
  s_mov_b64 exec, 1
L_pub:
  v_lshlrev_b32 v6, 4, v7
  v_mov_b32 v13, v5
  buffer_atomic_add v5, v6, s[64:67], 0 offen sc0
  v_cmp_eq_u32 vcc, 12, v7
  v_mov_b32 v8, 436
  v_mov_b32 v9, 434
  v_cndmask_b32 v8, v8, v9, vcc
  v_sub_u32 v8, v8, v13
  s_waitcnt vmcnt(0) lgkmcnt(0)
  v_cmp_eq_u32 s[82:83], v5, v8
  s_mov_b64 exec, -1
  s_lshl_b32 s80, s80, 16
  v_lshrrev_b32 v1, 1, v3
  v_lshrrev_b32 v2, 1, v4
L_fin:
  s_cmp_eq_u32 s82, 0
  s_cbranch_scc1 L_done
  s_ff1_i32_b32 s70, s82
  s_bitset0_b32 s82, s70
  v_readlane_b32 s71, v7, s70
  s_waitcnt vmcnt(0)
L_again:
  s_mul_i32 s68, s71, 1280
  buffer_load_dwordx4 v[64:67], v3, s[60:63], s68 offen sc1
  buffer_load_dword v68, v4, s[60:63], s68 offen sc1
  s_add_u32 s68, s68, 16640
  buffer_load_dwordx4 v[72:75], v3, s[60:63], s68 offen sc1
  buffer_load_dword v76, v4, s[60:63], s68 offen sc1
  s_add_u32 s68, s68, 16640
  buffer_load_dwordx4 v[80:83], v3, s[60:63], s68 offen sc1
  buffer_load_dword v84, v4, s[60:63], s68 offen sc1
  s_add_u32 s68, s68, 16640
  buffer_load_dwordx4 v[88:91], v3, s[60:63], s68 offen sc1
  buffer_load_dword v92, v4, s[60:63], s68 offen sc1
  s_add_u32 s68, s68, 16640
  buffer_load_dwordx4 v[96:99], v3, s[60:63], s68 offen sc1
  buffer_load_dword v100, v4, s[60:63], s68 offen sc1
  s_add_u32 s68, s68, 16640
  buffer_load_dwordx4 v[104:107], v3, s[60:63], s68 offen sc1
  buffer_load_dword v108, v4, s[60:63], s68 offen sc1
  s_add_u32 s68, s68, 16640
  buffer_load_dwordx4 v[112:115], v3, s[60:63], s68 offen sc1
  buffer_load_dword v116, v4, s[60:63], s68 offen sc1
  s_add_u32 s68, s68, 16640
  buffer_load_dwordx4 v[120:123], v3, s[60:63], s68 offen sc1
  buffer_load_dword v124, v4, s[60:63], s68 offen sc1
  s_add_u32 s68, s68, 16640
  buffer_load_dwordx4 v[128:131], v3, s[60:63], s68 offen sc1
  buffer_load_dword v132, v4, s[60:63], s68 offen sc1
  s_add_u32 s68, s68, 16640
  buffer_load_dwordx4 v[136:139], v3, s[60:63], s68 offen sc1
  buffer_load_dword v140, v4, s[60:63], s68 offen sc1
  s_add_u32 s68, s68, 16640
  buffer_load_dwordx4 v[144:147], v3, s[60:63], s68 offen sc1
  buffer_load_dword v148, v4, s[60:63], s68 offen sc1
  s_add_u32 s68, s68, 16640
  buffer_load_dwordx4 v[152:155], v3, s[60:63], s68 offen sc1
  buffer_load_dword v156, v4, s[60:63], s68 offen sc1
  s_add_u32 s68, s68, 16640
  buffer_load_dwordx4 v[160:163], v3, s[60:63], s68 offen sc1
  buffer_load_dword v164, v4, s[60:63], s68 offen sc1
  s_add_u32 s68, s68, 16640
  buffer_load_dwordx4 v[168:171], v3, s[60:63], s68 offen sc1
  buffer_load_dword v172, v4, s[60:63], s68 offen sc1
  s_add_u32 s68, s68, 16640
L_sum:
  s_waitcnt vmcnt(25)
  v_pk_add_f32 v[56:57], v[64:65], v[72:73]
  v_pk_add_f32 v[58:59], v[66:67], v[74:75]
  s_waitcnt vmcnt(24)
  v_add_f32 v60, v68, v76
  s_waitcnt vmcnt(23)
  v_pk_add_f32 v[56:57], v[56:57], v[80:81]
  v_pk_add_f32 v[58:59], v[58:59], v[82:83]
  s_waitcnt vmcnt(22)
  v_add_f32_e64 v60, v60, v84
  s_waitcnt vmcnt(21)
  v_pk_add_f32 v[56:57], v[56:57], v[88:89]
  v_pk_add_f32 v[58:59], v[58:59], v[90:91]
  s_waitcnt vmcnt(20)
  v_add_f32 v60, v60, v92
  s_waitcnt vmcnt(19)
  v_pk_add_f32 v[56:57], v[56:57], v[96:97]
  v_pk_add_f32 v[58:59], v[58:59], v[98:99]
  s_waitcnt vmcnt(18)
  v_add_f32 v60, v60, v100
  s_waitcnt vmcnt(17)
  v_pk_add_f32 v[56:57], v[56:57], v[104:105]
  v_pk_add_f32 v[58:59], v[58:59], v[106:107]
  s_waitcnt vmcnt(16)
  v_add_f32 v60, v60, v108
  s_waitcnt vmcnt(15)
  v_pk_add_f32 v[56:57], v[56:57], v[112:113]
  v_pk_add_f32 v[58:59], v[58:59], v[114:115]
  s_waitcnt vmcnt(14)
  v_add_f32 v60, v60, v116
  s_waitcnt vmcnt(13)
  v_pk_add_f32 v[56:57], v[56:57], v[120:121]
  v_pk_add_f32 v[58:59], v[58:59], v[122:123]
  s_waitcnt vmcnt(12)
  v_add_f32 v60, v60, v124
  s_waitcnt vmcnt(11)
  v_pk_add_f32 v[56:57], v[56:57], v[128:129]
  v_pk_add_f32 v[58:59], v[58:59], v[130:131]
  s_waitcnt vmcnt(10)
  v_add_f32 v60, v60, v132
  s_waitcnt vmcnt(9)
  v_pk_add_f32 v[56:57], v[56:57], v[136:137]
  v_pk_add_f32 v[58:59], v[58:59], v[138:139]
  s_waitcnt vmcnt(8)
  v_add_f32_e64 v60, v60, v140
  s_waitcnt vmcnt(7)
  v_pk_add_f32 v[56:57], v[56:57], v[144:145]
  v_pk_add_f32 v[58:59], v[58:59], v[146:147]
  s_waitcnt vmcnt(6)
  v_add_f32 v60, v60, v148
  s_waitcnt vmcnt(5)
  v_pk_add_f32 v[56:57], v[56:57], v[152:153]
  v_pk_add_f32 v[58:59], v[58:59], v[154:155]
  s_waitcnt vmcnt(4)
  v_add_f32 v60, v60, v156
  s_waitcnt vmcnt(3)
  v_pk_add_f32 v[56:57], v[56:57], v[160:161]
  v_pk_add_f32 v[58:59], v[58:59], v[162:163]
  s_waitcnt vmcnt(2)
  v_add_f32 v60, v60, v164
  s_waitcnt vmcnt(1)
  v_pk_add_f32 v[56:57], v[56:57], v[168:169]
  v_pk_add_f32 v[58:59], v[58:59], v[170:171]
  s_waitcnt vmcnt(0)
  v_add_f32 v60, v60, v172
  v_cmp_u_f32 vcc, v56, v57
  v_cmp_u_f32 s[92:93], v58, v59
  s_nop 0
  s_or_b64 s[92:93], s[92:93], vcc
  v_cmp_u_f32 vcc, v60, v60
  s_nop 0
  s_or_b64 vcc, s[92:93], vcc
  s_cbranch_vccnz L_chk
L_ok:
  s_mul_i32 s71, s71, 640
  v_add_f32 v56, s80, v56
  v_add_f32 v57, s80, v57
  v_add_f32 v58, s80, v58
  v_add_f32 v59, s80, v59
  v_add_f32_e64 v60, s80, v60
  v_cvt_pk_bf16_f32 v10, v56, v57
  v_cvt_pk_bf16_f32 v11, v58, v59
  v_cvt_pk_bf16_f32 v12, v60, v60
  buffer_store_dwordx2 v[10:11], v1, s[56:59], s71 offen
  buffer_store_short v12, v2, s[56:59], s71 offen
  s_branch L_fin
L_chk:
  v_mov_b32 v14, 0
  v_mov_b32 v15, 0
  v_max3_u32 v14, v14, v64, v65
  v_max3_u32 v14, v14, v66, v67
  v_max_u32 v15, v15, v68
  v_max3_u32 v14, v14, v72, v73
  v_max3_u32 v14, v14, v74, v75
  v_max_u32 v15, v15, v76
  v_max3_u32 v14, v14, v80, v81
  v_max3_u32 v14, v14, v82, v83
  v_max_u32 v15, v15, v84
  v_max3_u32 v14, v14, v88, v89
  v_max3_u32 v14, v14, v90, v91
  v_max_u32_e64 v15, v15, v92
  v_max3_u32 v14, v14, v96, v97
  v_max3_u32 v14, v14, v98, v99
  v_max_u32 v15, v15, v100
  v_max3_u32 v14, v14, v104, v105
  v_max3_u32 v14, v14, v106, v107
  v_max_u32 v15, v15, v108
  v_max3_u32 v14, v14, v112, v113
  v_max3_u32 v14, v14, v114, v115
  v_max_u32_e64 v15, v15, v116
  v_max3_u32 v14, v14, v120, v121
  v_max3_u32 v14, v14, v122, v123
  v_max_u32 v15, v15, v124
  v_max3_u32 v14, v14, v128, v129
  v_max3_u32 v14, v14, v130, v131
  v_max_u32 v15, v15, v132
  v_max3_u32 v14, v14, v136, v137
  v_max3_u32 v14, v14, v138, v139
  v_max_u32_e64 v15, v15, v140
  v_max3_u32 v14, v14, v144, v145
  v_max3_u32 v14, v14, v146, v147
  v_max_u32 v15, v15, v148
  v_max3_u32 v14, v14, v152, v153
  v_max3_u32 v14, v14, v154, v155
  v_max_u32 v15, v15, v156
  v_max3_u32 v14, v14, v160, v161
  v_max3_u32 v14, v14, v162, v163
  v_max_u32_e64 v15, v15, v164
  v_max3_u32 v14, v14, v168, v169
  v_max3_u32 v14, v14, v170, v171
  v_max_u32 v15, v15, v172
  s_cmp_eq_u32 s71, 12
  s_cselect_b32 s68, 0, -1
  v_and_b32 v15, s68, v15
  v_max_u32 v14, v14, v15
  v_cmp_eq_u32 vcc, -1, v14
  s_cbranch_vccnz L_again
  s_branch L_ok
L_done:
  s_endpgm
L_cin_done:
  s_mov_b32 s60, s24
  s_and_b32 s61, s25, 0xffff
  s_mov_b32 s62, 268435456
  s_mov_b32 s63, 0x20000
  s_mov_b32 s56, s20
  s_and_b32 s57, s21, 0xffff
  s_mov_b32 s58, 8192
  s_mov_b32 s59, 0x20000
  s_mov_b32 s64, s22
  s_and_b32 s65, s23, 0xffff
  s_mov_b32 s66, 256
  s_mov_b32 s67, 0x20000
  v_mul_f32 v116, v184, v192
  v_mul_f32 v117, v185, v193
  v_mul_f32 v118, v186, v194
  v_mul_f32 v119, v187, v195
  v_fmac_f32 v116, v188, v191
  v_fmac_f32 v117, v200, v208
  v_fmac_f32 v118, v201, v209
  v_fmac_f32 v119, v202, v210
  v_fmac_f32 v116, v203, v211
  v_fmac_f32 v117, v204, v207
  v_fmac_f32 v118, v216, v224
  v_fmac_f32 v119, v217, v225
  v_fmac_f32 v116, v218, v226
  v_fmac_f32 v117, v219, v227
  v_fmac_f32 v118, v220, v223
  v_fmac_f32 v119, v232, v240
  v_fmac_f32 v116, v233, v241
  v_fmac_f32 v117, v234, v242
  v_fmac_f32 v118, v235, v243
  v_fmac_f32 v119, v236, v239
  v_fmac_f32 v116, v189, v196
  v_fmac_f32 v117, v189, v197
  v_fmac_f32 v118, v190, v198
  v_fmac_f32 v119, v190, v199
  v_fmac_f32 v116, v205, v212
  v_fmac_f32 v117, v205, v213
  v_fmac_f32 v118, v206, v214
  v_fmac_f32 v119, v206, v215
  v_fmac_f32 v116, v221, v228
  v_fmac_f32 v117, v221, v229
  v_fmac_f32 v118, v222, v230
  v_fmac_f32 v119, v222, v231
  v_fmac_f32 v116, v237, v244
  v_fmac_f32 v117, v237, v245
  v_fmac_f32 v118, v238, v246
  v_fmac_f32 v119, v238, v247
  v_add_f32 v116, v116, v117
  v_add_f32 v118, v118, v119
  v_add_f32 v116, v116, v118
  v_mul_f32 v116, s74, v116
  v_mul_f32 v116, s75, v116
  ds_write_b32 v7, v116
  s_mul_i32 s98, s3, 1536
  s_add_u32 s98, s98, 116736
  v_lshlrev_b32 v116, 5, v0
  v_add_u32 v116, s98, v116
  ds_read_b128 v[60:63], v116
  ds_read_b128 v[64:67], v116 offset:16
  v_lshrrev_b32 v117, 3, v0
  v_cmp_gt_u32 vcc, 6, v117
  v_lshlrev_b32 v117, 4, v117
  v_add_u32_e64 v117, s85, v117
  s_waitcnt lgkmcnt(1)
  v_pk_add_f32 v[60:61], v[60:61], v[62:63]
  s_waitcnt lgkmcnt(0)
  v_pk_add_f32 v[64:65], v[64:65], v[66:67]
  v_pk_add_f32 v[60:61], v[60:61], v[64:65]
  v_add_f32 v60, v60, v61
  s_nop 1
  v_add_f32_dpp v60, v60, v60 quad_perm:[1,0,3,2] row_mask:0xf bank_mask:0xf
  s_nop 1
  v_add_f32_dpp v60, v60, v60 quad_perm:[2,3,0,1] row_mask:0xf bank_mask:0xf
  s_nop 1
  v_add_f32_dpp v60, v60, v60 row_half_mirror row_mask:0xf bank_mask:0xf
  s_and_b64 exec, exec, vcc
  ds_write_b32 v117, v60
  s_mov_b64 exec, -1
  s_waitcnt vmcnt(0) lgkmcnt(0)
  s_barrier
  s_cmp_lg_u32 s3, 4
  s_cbranch_scc1 L_end
  v_lshlrev_b32 v4, 2, v0
  v_add_u32 v2, 129728, v4
  ds_read_b32 v64, v2
  s_mul_i32 s69, s26, 192
  s_add_u32 s69, s69, 216320
  s_mul_i32 s68, s26, 3
  s_mul_i32 s70, s68, 3277
  s_lshr_b32 s70, s70, 16
  v_add_u32 v7, s70, v0
  s_mul_i32 s70, s70, 20
  s_add_u32 s70, s70, 20
  s_sub_u32 s70, s70, s68
  s_min_u32 s70, s70, 3
  s_sub_u32 s68, 3, s70
  v_mov_b32 v5, s68
  v_writelane_b32 v5, s70, 0
  s_cmp_eq_u32 s68, 0
  s_cselect_b32 s68, 1, 3
  v_lshlrev_b32 v3, 4, v0
  s_mov_b32 exec_hi, 0xffff
  s_waitcnt lgkmcnt(0)
  v_min_u32 v64, -2, v64
  buffer_store_dword v64, v4, s[60:63], s69 offen sc1
  s_mov_b32 exec_hi, -1
  v_add_u32 v4, 1024, v4
  s_mov_b32 exec_lo, s68
  s_mov_b32 exec_hi, 0
  s_branch L_pub
L_dnn_loop1:
  s_barrier
  s_add_u32 m0, s75, 122880
  v_add_u32_dpp v56, v19, v2 row_newbcast:0 row_mask:0xf bank_mask:0x3
  buffer_load_dwordx4 v4, s[44:47], s74 offen lds
  s_add_u32 m0, s75, 123904
  v_add_u32_dpp v57, v23, v2 row_newbcast:0 row_mask:0xf bank_mask:0x3
  buffer_load_dwordx4 v5, s[44:47], s74 offen lds
  s_add_u32 s74, s74, 106496
  s_add_u32 m0, s76, 92160
  v_add_u32_dpp v58, v27, v2 row_newbcast:0 row_mask:0xf bank_mask:0x3
  buffer_load_dwordx4 v61, s[32:35], 0 offen lds
  s_add_u32 m0, s76, 94208
  v_add_u32_dpp v59, v31, v2 row_newbcast:0 row_mask:0xf bank_mask:0x3
  buffer_load_dwordx4 v62, s[32:35], 0 offen lds
  s_add_u32 m0, s76, 96256
  v_add_u32_dpp v60, v35, v2 row_newbcast:0 row_mask:0xf bank_mask:0x3
  buffer_load_dwordx4 v63, s[32:35], 0 offen lds
  s_add_u32 m0, s76, 98304
  v_add_u32_dpp v56, v17, v2 row_newbcast:7 row_mask:0xf bank_mask:0xc
  buffer_load_dwordx4 v64, s[32:35], 0 offen lds
  s_add_u32 m0, s76, 100352
  v_add_u32_dpp v57, v21, v2 row_newbcast:7 row_mask:0xf bank_mask:0xc
  buffer_load_dwordx4 v65, s[32:35], 0 offen lds
  v_add_u32_dpp v58, v25, v2 row_newbcast:7 row_mask:0xf bank_mask:0xc
  v_add_u32_dpp v59, v29, v2 row_newbcast:7 row_mask:0xf bank_mask:0xc
  v_add_u32_dpp v60, v33, v2 row_newbcast:7 row_mask:0xf bank_mask:0xc
  s_waitcnt vmcnt(12)
  s_barrier
L_ld_in:
  s_add_u32 m0, s75, 131072
  v_add_u32_dpp v61, v39, v2 row_newbcast:0 row_mask:0xf bank_mask:0x3
  buffer_load_dwordx4 v4, s[44:47], s74 offen lds
  s_add_u32 m0, s75, 132096
  v_add_u32_dpp v62, v43, v2 row_newbcast:0 row_mask:0xf bank_mask:0x3
  buffer_load_dwordx4 v5, s[44:47], s74 offen lds
  s_add_u32 s74, s74, 106496
  s_add_u32 m0, s76, 0
  v_add_u32_dpp v63, v47, v2 row_newbcast:0 row_mask:0xf bank_mask:0x3
  buffer_load_dwordx4 v56, s[32:35], 0 offen lds
  s_add_u32 m0, s76, 2048
  v_add_u32_dpp v64, v51, v2 row_newbcast:0 row_mask:0xf bank_mask:0x3
  buffer_load_dwordx4 v57, s[32:35], 0 offen lds
  s_add_u32 m0, s76, 4096
  v_add_u32_dpp v65, v55, v2 row_newbcast:0 row_mask:0xf bank_mask:0x3
  buffer_load_dwordx4 v58, s[32:35], 0 offen lds
  s_add_u32 m0, s76, 6144
  v_add_u32_dpp v61, v37, v2 row_newbcast:7 row_mask:0xf bank_mask:0xc
  buffer_load_dwordx4 v59, s[32:35], 0 offen lds
  s_add_u32 m0, s76, 8192
  v_add_u32_dpp v62, v41, v2 row_newbcast:7 row_mask:0xf bank_mask:0xc
  buffer_load_dwordx4 v60, s[32:35], 0 offen lds
  v_add_u32_dpp v63, v45, v2 row_newbcast:7 row_mask:0xf bank_mask:0xc
  v_add_u32_dpp v64, v49, v2 row_newbcast:7 row_mask:0xf bank_mask:0xc
  v_add_u32_dpp v65, v53, v2 row_newbcast:7 row_mask:0xf bank_mask:0xc
  s_waitcnt vmcnt(12)
  s_barrier
  s_add_u32 m0, s75, 139264
  v_add_u32_dpp v56, v16, v2 row_newbcast:1 row_mask:0xf bank_mask:0x3
  buffer_load_dwordx4 v4, s[44:47], s74 offen lds
  s_add_u32 m0, s75, 140288
  v_add_u32_dpp v57, v20, v2 row_newbcast:1 row_mask:0xf bank_mask:0x3
  buffer_load_dwordx4 v5, s[44:47], s74 offen lds
  s_add_u32 s74, s74, 106496
  s_add_u32 m0, s76, 10240
  v_add_u32_dpp v58, v24, v2 row_newbcast:1 row_mask:0xf bank_mask:0x3
  buffer_load_dwordx4 v61, s[32:35], 0 offen lds
  s_add_u32 m0, s76, 12288
  v_add_u32_dpp v59, v28, v2 row_newbcast:1 row_mask:0xf bank_mask:0x3
  buffer_load_dwordx4 v62, s[32:35], 0 offen lds
  s_add_u32 m0, s76, 14336
  v_add_u32_dpp v60, v32, v2 row_newbcast:1 row_mask:0xf bank_mask:0x3
  buffer_load_dwordx4 v63, s[32:35], 0 offen lds
  s_add_u32 m0, s76, 16384
  v_add_u32_dpp v56, v18, v2 row_newbcast:7 row_mask:0xf bank_mask:0xc
  buffer_load_dwordx4 v64, s[32:35], 0 offen lds
  s_add_u32 m0, s76, 18432
  v_add_u32_dpp v57, v22, v2 row_newbcast:7 row_mask:0xf bank_mask:0xc
  buffer_load_dwordx4 v65, s[32:35], 0 offen lds
  v_add_u32_dpp v58, v26, v2 row_newbcast:7 row_mask:0xf bank_mask:0xc
  v_add_u32_dpp v59, v30, v2 row_newbcast:7 row_mask:0xf bank_mask:0xc
  v_add_u32_dpp v60, v34, v2 row_newbcast:7 row_mask:0xf bank_mask:0xc
  s_waitcnt vmcnt(12)
  s_barrier
  s_add_u32 m0, s75, 122880
  v_add_u32_dpp v61, v36, v2 row_newbcast:1 row_mask:0xf bank_mask:0x3
  buffer_load_dwordx4 v4, s[44:47], s74 offen lds
  s_add_u32 m0, s75, 123904
  v_add_u32_dpp v62, v40, v2 row_newbcast:1 row_mask:0xf bank_mask:0x3
  buffer_load_dwordx4 v5, s[44:47], s74 offen lds
  s_add_u32 s74, s74, 106496
  s_add_u32 m0, s76, 40960
  v_add_u32_dpp v63, v44, v2 row_newbcast:1 row_mask:0xf bank_mask:0x3
  buffer_load_dwordx4 v56, s[32:35], 0 offen lds
  s_add_u32 m0, s76, 43008
  v_add_u32_dpp v64, v48, v2 row_newbcast:1 row_mask:0xf bank_mask:0x3
  buffer_load_dwordx4 v57, s[32:35], 0 offen lds
  s_add_u32 m0, s76, 45056
  v_add_u32_dpp v65, v52, v2 row_newbcast:1 row_mask:0xf bank_mask:0x3
  buffer_load_dwordx4 v58, s[32:35], 0 offen lds
  s_add_u32 m0, s76, 47104
  v_add_u32_dpp v61, v38, v2 row_newbcast:7 row_mask:0xf bank_mask:0xc
  buffer_load_dwordx4 v59, s[32:35], 0 offen lds
  s_add_u32 m0, s76, 49152
  v_add_u32_dpp v62, v42, v2 row_newbcast:7 row_mask:0xf bank_mask:0xc
  buffer_load_dwordx4 v60, s[32:35], 0 offen lds
  v_add_u32_dpp v63, v46, v2 row_newbcast:7 row_mask:0xf bank_mask:0xc
  v_add_u32_dpp v64, v50, v2 row_newbcast:7 row_mask:0xf bank_mask:0xc
  v_add_u32_dpp v65, v54, v2 row_newbcast:7 row_mask:0xf bank_mask:0xc
  s_waitcnt vmcnt(12)
  s_barrier
  s_add_u32 m0, s75, 131072
  v_add_u32_dpp v56, v17, v2 row_newbcast:1 row_mask:0xf bank_mask:0x3
  buffer_load_dwordx4 v4, s[44:47], s74 offen lds
  s_add_u32 m0, s75, 132096
  v_add_u32_dpp v57, v21, v2 row_newbcast:1 row_mask:0xf bank_mask:0x3
  buffer_load_dwordx4 v5, s[44:47], s74 offen lds
  s_add_u32 s74, s74, 106496
  s_add_u32 m0, s76, 51200
  v_add_u32_dpp v58, v25, v2 row_newbcast:1 row_mask:0xf bank_mask:0x3
  buffer_load_dwordx4 v61, s[32:35], 0 offen lds
  s_add_u32 m0, s76, 53248
  v_add_u32_dpp v59, v29, v2 row_newbcast:1 row_mask:0xf bank_mask:0x3
  buffer_load_dwordx4 v62, s[32:35], 0 offen lds
  s_add_u32 m0, s76, 55296
  v_add_u32_dpp v60, v33, v2 row_newbcast:1 row_mask:0xf bank_mask:0x3
  buffer_load_dwordx4 v63, s[32:35], 0 offen lds
  s_add_u32 m0, s76, 57344
  v_add_u32_dpp v56, v19, v2 row_newbcast:7 row_mask:0xf bank_mask:0xc
  buffer_load_dwordx4 v64, s[32:35], 0 offen lds
  s_add_u32 m0, s76, 59392
  v_add_u32_dpp v57, v23, v2 row_newbcast:7 row_mask:0xf bank_mask:0xc
  buffer_load_dwordx4 v65, s[32:35], 0 offen lds
  v_add_u32_dpp v58, v27, v2 row_newbcast:7 row_mask:0xf bank_mask:0xc
  v_add_u32_dpp v59, v31, v2 row_newbcast:7 row_mask:0xf bank_mask:0xc
  v_add_u32_dpp v60, v35, v2 row_newbcast:7 row_mask:0xf bank_mask:0xc
  s_waitcnt vmcnt(12)
  s_barrier
  s_add_u32 m0, s75, 139264
  v_add_u32_dpp v61, v37, v2 row_newbcast:1 row_mask:0xf bank_mask:0x3
  buffer_load_dwordx4 v4, s[44:47], s74 offen lds
  s_add_u32 m0, s75, 140288
  v_add_u32_dpp v62, v41, v2 row_newbcast:1 row_mask:0xf bank_mask:0x3
  buffer_load_dwordx4 v5, s[44:47], s74 offen lds
  s_add_u32 s74, s74, 106496
  s_add_u32 m0, s76, 81920
  v_add_u32_dpp v63, v45, v2 row_newbcast:1 row_mask:0xf bank_mask:0x3
  buffer_load_dwordx4 v56, s[32:35], 0 offen lds
  s_add_u32 m0, s76, 83968
  v_add_u32_dpp v64, v49, v2 row_newbcast:1 row_mask:0xf bank_mask:0x3
  buffer_load_dwordx4 v57, s[32:35], 0 offen lds
  s_add_u32 m0, s76, 86016
  v_add_u32_dpp v65, v53, v2 row_newbcast:1 row_mask:0xf bank_mask:0x3
  buffer_load_dwordx4 v58, s[32:35], 0 offen lds
  s_add_u32 m0, s76, 88064
  v_add_u32_dpp v61, v39, v2 row_newbcast:7 row_mask:0xf bank_mask:0xc
  buffer_load_dwordx4 v59, s[32:35], 0 offen lds
  s_add_u32 m0, s76, 90112
  v_add_u32_dpp v62, v43, v2 row_newbcast:7 row_mask:0xf bank_mask:0xc
  buffer_load_dwordx4 v60, s[32:35], 0 offen lds
  v_add_u32_dpp v63, v47, v2 row_newbcast:7 row_mask:0xf bank_mask:0xc
  v_add_u32_dpp v64, v51, v2 row_newbcast:7 row_mask:0xf bank_mask:0xc
  v_add_u32_dpp v65, v55, v2 row_newbcast:7 row_mask:0xf bank_mask:0xc
  s_waitcnt vmcnt(12)
  s_barrier
  s_add_u32 m0, s75, 122880
  v_add_u32_dpp v56, v18, v2 row_newbcast:1 row_mask:0xf bank_mask:0x3
  buffer_load_dwordx4 v4, s[44:47], s74 offen lds
  s_add_u32 m0, s75, 123904
  v_add_u32_dpp v57, v22, v2 row_newbcast:1 row_mask:0xf bank_mask:0x3
  buffer_load_dwordx4 v5, s[44:47], s74 offen lds
  s_add_u32 s74, s74, 106496
  s_add_u32 m0, s76, 92160
  v_add_u32_dpp v58, v26, v2 row_newbcast:1 row_mask:0xf bank_mask:0x3
  buffer_load_dwordx4 v61, s[32:35], 0 offen lds
  s_add_u32 m0, s76, 94208
  v_add_u32_dpp v59, v30, v2 row_newbcast:1 row_mask:0xf bank_mask:0x3
  buffer_load_dwordx4 v62, s[32:35], 0 offen lds
  s_add_u32 m0, s76, 96256
  v_add_u32_dpp v60, v34, v2 row_newbcast:1 row_mask:0xf bank_mask:0x3
  buffer_load_dwordx4 v63, s[32:35], 0 offen lds
  s_add_u32 m0, s76, 98304
  v_add_u32_dpp v56, v16, v2 row_newbcast:8 row_mask:0xf bank_mask:0xc
  buffer_load_dwordx4 v64, s[32:35], 0 offen lds
  s_add_u32 m0, s76, 100352
  v_add_u32_dpp v57, v20, v2 row_newbcast:8 row_mask:0xf bank_mask:0xc
  buffer_load_dwordx4 v65, s[32:35], 0 offen lds
  v_add_u32_dpp v58, v24, v2 row_newbcast:8 row_mask:0xf bank_mask:0xc
  v_add_u32_dpp v59, v28, v2 row_newbcast:8 row_mask:0xf bank_mask:0xc
  v_add_u32_dpp v60, v32, v2 row_newbcast:8 row_mask:0xf bank_mask:0xc
  s_waitcnt vmcnt(12)
  s_barrier
  s_add_u32 m0, s75, 131072
  v_add_u32_dpp v61, v38, v2 row_newbcast:1 row_mask:0xf bank_mask:0x3
  buffer_load_dwordx4 v4, s[44:47], s74 offen lds
  s_add_u32 m0, s75, 132096
  v_add_u32_dpp v62, v42, v2 row_newbcast:1 row_mask:0xf bank_mask:0x3
  buffer_load_dwordx4 v5, s[44:47], s74 offen lds
  s_add_u32 s74, s74, 106496
  s_add_u32 m0, s76, 0
  v_add_u32_dpp v63, v46, v2 row_newbcast:1 row_mask:0xf bank_mask:0x3
  buffer_load_dwordx4 v56, s[32:35], 0 offen lds
  s_add_u32 m0, s76, 2048
  v_add_u32_dpp v64, v50, v2 row_newbcast:1 row_mask:0xf bank_mask:0x3
  buffer_load_dwordx4 v57, s[32:35], 0 offen lds
  s_add_u32 m0, s76, 4096
  v_add_u32_dpp v65, v54, v2 row_newbcast:1 row_mask:0xf bank_mask:0x3
  buffer_load_dwordx4 v58, s[32:35], 0 offen lds
  s_add_u32 m0, s76, 6144
  v_add_u32_dpp v61, v36, v2 row_newbcast:8 row_mask:0xf bank_mask:0xc
  buffer_load_dwordx4 v59, s[32:35], 0 offen lds
  s_add_u32 m0, s76, 8192
  v_add_u32_dpp v62, v40, v2 row_newbcast:8 row_mask:0xf bank_mask:0xc
  buffer_load_dwordx4 v60, s[32:35], 0 offen lds
  v_add_u32_dpp v63, v44, v2 row_newbcast:8 row_mask:0xf bank_mask:0xc
  v_add_u32_dpp v64, v48, v2 row_newbcast:8 row_mask:0xf bank_mask:0xc
  v_add_u32_dpp v65, v52, v2 row_newbcast:8 row_mask:0xf bank_mask:0xc
  s_waitcnt vmcnt(12)
  s_barrier
  s_add_u32 m0, s75, 139264
  v_add_u32_dpp v56, v19, v2 row_newbcast:1 row_mask:0xf bank_mask:0x3
  buffer_load_dwordx4 v4, s[44:47], s74 offen lds
  s_add_u32 m0, s75, 140288
  v_add_u32_dpp v57, v23, v2 row_newbcast:1 row_mask:0xf bank_mask:0x3
  buffer_load_dwordx4 v5, s[44:47], s74 offen lds
  s_add_u32 s74, s74, 106496
  s_add_u32 m0, s76, 10240
  v_add_u32_dpp v58, v27, v2 row_newbcast:1 row_mask:0xf bank_mask:0x3
  buffer_load_dwordx4 v61, s[32:35], 0 offen lds
  s_add_u32 m0, s76, 12288
  v_add_u32_dpp v59, v31, v2 row_newbcast:1 row_mask:0xf bank_mask:0x3
  buffer_load_dwordx4 v62, s[32:35], 0 offen lds
  s_add_u32 m0, s76, 14336
  v_add_u32_dpp v60, v35, v2 row_newbcast:1 row_mask:0xf bank_mask:0x3
  buffer_load_dwordx4 v63, s[32:35], 0 offen lds
  s_add_u32 m0, s76, 16384
  v_add_u32_dpp v56, v17, v2 row_newbcast:8 row_mask:0xf bank_mask:0xc
  buffer_load_dwordx4 v64, s[32:35], 0 offen lds
  s_add_u32 m0, s76, 18432
  v_add_u32_dpp v57, v21, v2 row_newbcast:8 row_mask:0xf bank_mask:0xc
  buffer_load_dwordx4 v65, s[32:35], 0 offen lds
  v_add_u32_dpp v58, v25, v2 row_newbcast:8 row_mask:0xf bank_mask:0xc
  v_add_u32_dpp v59, v29, v2 row_newbcast:8 row_mask:0xf bank_mask:0xc
  v_add_u32_dpp v60, v33, v2 row_newbcast:8 row_mask:0xf bank_mask:0xc
  s_waitcnt vmcnt(12)
  s_barrier
  s_add_u32 m0, s75, 122880
  v_add_u32_dpp v61, v39, v2 row_newbcast:1 row_mask:0xf bank_mask:0x3
  buffer_load_dwordx4 v4, s[44:47], s74 offen lds
  s_add_u32 m0, s75, 123904
  v_add_u32_dpp v62, v43, v2 row_newbcast:1 row_mask:0xf bank_mask:0x3
  buffer_load_dwordx4 v5, s[44:47], s74 offen lds
  s_add_u32 s74, s74, 106496
  s_add_u32 m0, s76, 40960
  v_add_u32_dpp v63, v47, v2 row_newbcast:1 row_mask:0xf bank_mask:0x3
  buffer_load_dwordx4 v56, s[32:35], 0 offen lds
  s_add_u32 m0, s76, 43008
  v_add_u32_dpp v64, v51, v2 row_newbcast:1 row_mask:0xf bank_mask:0x3
  buffer_load_dwordx4 v57, s[32:35], 0 offen lds
  s_add_u32 m0, s76, 45056
  v_add_u32_dpp v65, v55, v2 row_newbcast:1 row_mask:0xf bank_mask:0x3
  buffer_load_dwordx4 v58, s[32:35], 0 offen lds
  s_add_u32 m0, s76, 47104
  v_add_u32_dpp v61, v37, v2 row_newbcast:8 row_mask:0xf bank_mask:0xc
  buffer_load_dwordx4 v59, s[32:35], 0 offen lds
  s_add_u32 m0, s76, 49152
  v_add_u32_dpp v62, v41, v2 row_newbcast:8 row_mask:0xf bank_mask:0xc
  buffer_load_dwordx4 v60, s[32:35], 0 offen lds
  v_add_u32_dpp v63, v45, v2 row_newbcast:8 row_mask:0xf bank_mask:0xc
  v_add_u32_dpp v64, v49, v2 row_newbcast:8 row_mask:0xf bank_mask:0xc
  v_add_u32_dpp v65, v53, v2 row_newbcast:8 row_mask:0xf bank_mask:0xc
  s_waitcnt vmcnt(12)
  s_barrier
  s_add_u32 m0, s75, 131072
  v_add_u32_dpp v56, v16, v2 row_newbcast:2 row_mask:0xf bank_mask:0x3
  buffer_load_dwordx4 v4, s[44:47], s74 offen lds
  s_add_u32 m0, s75, 132096
  v_add_u32_dpp v57, v20, v2 row_newbcast:2 row_mask:0xf bank_mask:0x3
  buffer_load_dwordx4 v5, s[44:47], s74 offen lds
  s_add_u32 s74, s74, 106496
  s_add_u32 m0, s76, 51200
  v_add_u32_dpp v58, v24, v2 row_newbcast:2 row_mask:0xf bank_mask:0x3
  buffer_load_dwordx4 v61, s[32:35], 0 offen lds
  s_add_u32 m0, s76, 53248
  v_add_u32_dpp v59, v28, v2 row_newbcast:2 row_mask:0xf bank_mask:0x3
  buffer_load_dwordx4 v62, s[32:35], 0 offen lds
  s_add_u32 m0, s76, 55296
  v_add_u32_dpp v60, v32, v2 row_newbcast:2 row_mask:0xf bank_mask:0x3
  buffer_load_dwordx4 v63, s[32:35], 0 offen lds
  s_add_u32 m0, s76, 57344
  v_add_u32_dpp v56, v18, v2 row_newbcast:8 row_mask:0xf bank_mask:0xc
  buffer_load_dwordx4 v64, s[32:35], 0 offen lds
  s_add_u32 m0, s76, 59392
  v_add_u32_dpp v57, v22, v2 row_newbcast:8 row_mask:0xf bank_mask:0xc
  buffer_load_dwordx4 v65, s[32:35], 0 offen lds
  v_add_u32_dpp v58, v26, v2 row_newbcast:8 row_mask:0xf bank_mask:0xc
  v_add_u32_dpp v59, v30, v2 row_newbcast:8 row_mask:0xf bank_mask:0xc
  v_add_u32_dpp v60, v34, v2 row_newbcast:8 row_mask:0xf bank_mask:0xc
  s_waitcnt vmcnt(12)
  s_barrier
  s_add_u32 m0, s75, 139264
  v_add_u32_dpp v61, v36, v2 row_newbcast:2 row_mask:0xf bank_mask:0x3
  buffer_load_dwordx4 v4, s[44:47], s74 offen lds
  s_add_u32 m0, s75, 140288
  v_add_u32_dpp v62, v40, v2 row_newbcast:2 row_mask:0xf bank_mask:0x3
  buffer_load_dwordx4 v5, s[44:47], s74 offen lds
  s_add_u32 s74, s74, 106496
  s_add_u32 m0, s76, 81920
  v_add_u32_dpp v63, v44, v2 row_newbcast:2 row_mask:0xf bank_mask:0x3
  buffer_load_dwordx4 v56, s[32:35], 0 offen lds
  s_add_u32 m0, s76, 83968
  v_add_u32_dpp v64, v48, v2 row_newbcast:2 row_mask:0xf bank_mask:0x3
  buffer_load_dwordx4 v57, s[32:35], 0 offen lds
  s_add_u32 m0, s76, 86016
  v_add_u32_dpp v65, v52, v2 row_newbcast:2 row_mask:0xf bank_mask:0x3
  buffer_load_dwordx4 v58, s[32:35], 0 offen lds
  s_add_u32 m0, s76, 88064
  v_add_u32_dpp v61, v38, v2 row_newbcast:8 row_mask:0xf bank_mask:0xc
  buffer_load_dwordx4 v59, s[32:35], 0 offen lds
  s_add_u32 m0, s76, 90112
  v_add_u32_dpp v62, v42, v2 row_newbcast:8 row_mask:0xf bank_mask:0xc
  buffer_load_dwordx4 v60, s[32:35], 0 offen lds
  v_add_u32_dpp v63, v46, v2 row_newbcast:8 row_mask:0xf bank_mask:0xc
  v_add_u32_dpp v64, v50, v2 row_newbcast:8 row_mask:0xf bank_mask:0xc
  v_add_u32_dpp v65, v54, v2 row_newbcast:8 row_mask:0xf bank_mask:0xc
  s_waitcnt vmcnt(12)
  s_barrier
  s_add_u32 m0, s75, 122880
  v_add_u32_dpp v56, v17, v2 row_newbcast:2 row_mask:0xf bank_mask:0x3
  buffer_load_dwordx4 v4, s[44:47], s74 offen lds
  s_add_u32 m0, s75, 123904
  v_add_u32_dpp v57, v21, v2 row_newbcast:2 row_mask:0xf bank_mask:0x3
  buffer_load_dwordx4 v5, s[44:47], s74 offen lds
  s_add_u32 s74, s74, 106496
  s_add_u32 m0, s76, 92160
  v_add_u32_dpp v58, v25, v2 row_newbcast:2 row_mask:0xf bank_mask:0x3
  buffer_load_dwordx4 v61, s[32:35], 0 offen lds
  s_add_u32 m0, s76, 94208
  v_add_u32_dpp v59, v29, v2 row_newbcast:2 row_mask:0xf bank_mask:0x3
  buffer_load_dwordx4 v62, s[32:35], 0 offen lds
  s_add_u32 m0, s76, 96256
  v_add_u32_dpp v60, v33, v2 row_newbcast:2 row_mask:0xf bank_mask:0x3
  buffer_load_dwordx4 v63, s[32:35], 0 offen lds
  s_add_u32 m0, s76, 98304
  v_add_u32_dpp v56, v19, v2 row_newbcast:8 row_mask:0xf bank_mask:0xc
  buffer_load_dwordx4 v64, s[32:35], 0 offen lds
  s_add_u32 m0, s76, 100352
  v_add_u32_dpp v57, v23, v2 row_newbcast:8 row_mask:0xf bank_mask:0xc
  buffer_load_dwordx4 v65, s[32:35], 0 offen lds
  v_add_u32_dpp v58, v27, v2 row_newbcast:8 row_mask:0xf bank_mask:0xc
  v_add_u32_dpp v59, v31, v2 row_newbcast:8 row_mask:0xf bank_mask:0xc
  v_add_u32_dpp v60, v35, v2 row_newbcast:8 row_mask:0xf bank_mask:0xc
  s_waitcnt vmcnt(12)
  s_barrier
  s_add_u32 m0, s75, 131072
  v_add_u32_dpp v61, v37, v2 row_newbcast:2 row_mask:0xf bank_mask:0x3
  buffer_load_dwordx4 v4, s[44:47], s74 offen lds
  s_add_u32 m0, s75, 132096
  v_add_u32_dpp v62, v41, v2 row_newbcast:2 row_mask:0xf bank_mask:0x3
  buffer_load_dwordx4 v5, s[44:47], s74 offen lds
  s_add_u32 s74, s74, 106496
  s_add_u32 m0, s76, 0
  v_add_u32_dpp v63, v45, v2 row_newbcast:2 row_mask:0xf bank_mask:0x3
  buffer_load_dwordx4 v56, s[32:35], 0 offen lds
  s_add_u32 m0, s76, 2048
  v_add_u32_dpp v64, v49, v2 row_newbcast:2 row_mask:0xf bank_mask:0x3
  buffer_load_dwordx4 v57, s[32:35], 0 offen lds
  s_add_u32 m0, s76, 4096
  v_add_u32_dpp v65, v53, v2 row_newbcast:2 row_mask:0xf bank_mask:0x3
  buffer_load_dwordx4 v58, s[32:35], 0 offen lds
  s_add_u32 m0, s76, 6144
  v_add_u32_dpp v61, v39, v2 row_newbcast:8 row_mask:0xf bank_mask:0xc
  buffer_load_dwordx4 v59, s[32:35], 0 offen lds
  s_add_u32 m0, s76, 8192
  v_add_u32_dpp v62, v43, v2 row_newbcast:8 row_mask:0xf bank_mask:0xc
  buffer_load_dwordx4 v60, s[32:35], 0 offen lds
  v_add_u32_dpp v63, v47, v2 row_newbcast:8 row_mask:0xf bank_mask:0xc
  v_add_u32_dpp v64, v51, v2 row_newbcast:8 row_mask:0xf bank_mask:0xc
  v_add_u32_dpp v65, v55, v2 row_newbcast:8 row_mask:0xf bank_mask:0xc
  s_waitcnt vmcnt(12)
  s_barrier
  s_add_u32 m0, s75, 139264
  v_add_u32_dpp v56, v18, v2 row_newbcast:2 row_mask:0xf bank_mask:0x3
  buffer_load_dwordx4 v4, s[44:47], s74 offen lds
  s_add_u32 m0, s75, 140288
  v_add_u32_dpp v57, v22, v2 row_newbcast:2 row_mask:0xf bank_mask:0x3
  buffer_load_dwordx4 v5, s[44:47], s74 offen lds
  s_add_u32 s74, s74, 106496
  s_add_u32 m0, s76, 10240
  v_add_u32_dpp v58, v26, v2 row_newbcast:2 row_mask:0xf bank_mask:0x3
  buffer_load_dwordx4 v61, s[32:35], 0 offen lds
  s_add_u32 m0, s76, 12288
  v_add_u32_dpp v59, v30, v2 row_newbcast:2 row_mask:0xf bank_mask:0x3
  buffer_load_dwordx4 v62, s[32:35], 0 offen lds
  s_add_u32 m0, s76, 14336
  v_add_u32_dpp v60, v34, v2 row_newbcast:2 row_mask:0xf bank_mask:0x3
  buffer_load_dwordx4 v63, s[32:35], 0 offen lds
  s_add_u32 m0, s76, 16384
  v_add_u32_dpp v56, v16, v2 row_newbcast:9 row_mask:0xf bank_mask:0xc
  buffer_load_dwordx4 v64, s[32:35], 0 offen lds
  s_add_u32 m0, s76, 18432
  v_add_u32_dpp v57, v20, v2 row_newbcast:9 row_mask:0xf bank_mask:0xc
  buffer_load_dwordx4 v65, s[32:35], 0 offen lds
  v_add_u32_dpp v58, v24, v2 row_newbcast:9 row_mask:0xf bank_mask:0xc
  v_add_u32_dpp v59, v28, v2 row_newbcast:9 row_mask:0xf bank_mask:0xc
  v_add_u32_dpp v60, v32, v2 row_newbcast:9 row_mask:0xf bank_mask:0xc
  s_waitcnt vmcnt(12)
  s_cmp_lg_u32 s72, 1
  s_cbranch_scc1 L_nolpf
  s_mov_b64 exec, 1048575
  global_load_dword v10, v[8:9], off
  s_mov_b64 exec, -1
L_nolpf:
  s_barrier
  s_add_u32 m0, s75, 122880
  v_add_u32_dpp v61, v38, v2 row_newbcast:2 row_mask:0xf bank_mask:0x3
  buffer_load_dwordx4 v4, s[44:47], s74 offen lds
  s_add_u32 m0, s75, 123904
  v_add_u32_dpp v62, v42, v2 row_newbcast:2 row_mask:0xf bank_mask:0x3
  buffer_load_dwordx4 v5, s[44:47], s74 offen lds
  s_add_u32 s74, s74, 106496
  s_add_u32 m0, s76, 40960
  v_add_u32_dpp v63, v46, v2 row_newbcast:2 row_mask:0xf bank_mask:0x3
  buffer_load_dwordx4 v56, s[32:35], 0 offen lds
  s_add_u32 m0, s76, 43008
  v_add_u32_dpp v64, v50, v2 row_newbcast:2 row_mask:0xf bank_mask:0x3
  buffer_load_dwordx4 v57, s[32:35], 0 offen lds
  s_add_u32 m0, s76, 45056
  v_add_u32_dpp v65, v54, v2 row_newbcast:2 row_mask:0xf bank_mask:0x3
  buffer_load_dwordx4 v58, s[32:35], 0 offen lds
  s_add_u32 m0, s76, 47104
  v_add_u32_dpp v61, v36, v2 row_newbcast:9 row_mask:0xf bank_mask:0xc
  buffer_load_dwordx4 v59, s[32:35], 0 offen lds
  s_add_u32 m0, s76, 49152
  v_add_u32_dpp v62, v40, v2 row_newbcast:9 row_mask:0xf bank_mask:0xc
  buffer_load_dwordx4 v60, s[32:35], 0 offen lds
  v_add_u32_dpp v63, v44, v2 row_newbcast:9 row_mask:0xf bank_mask:0xc
  v_add_u32_dpp v64, v48, v2 row_newbcast:9 row_mask:0xf bank_mask:0xc
  v_add_u32_dpp v65, v52, v2 row_newbcast:9 row_mask:0xf bank_mask:0xc
  s_waitcnt vmcnt(12)
  s_barrier
  s_add_u32 m0, s75, 131072
  v_add_u32_dpp v56, v19, v2 row_newbcast:2 row_mask:0xf bank_mask:0x3
  buffer_load_dwordx4 v4, s[44:47], s74 offen lds
  s_add_u32 m0, s75, 132096
  v_add_u32_dpp v57, v23, v2 row_newbcast:2 row_mask:0xf bank_mask:0x3
  buffer_load_dwordx4 v5, s[44:47], s74 offen lds
  s_add_u32 s74, s74, 106496
  s_add_u32 m0, s76, 51200
  v_add_u32_dpp v58, v27, v2 row_newbcast:2 row_mask:0xf bank_mask:0x3
  buffer_load_dwordx4 v61, s[32:35], 0 offen lds
  s_add_u32 m0, s76, 53248
  v_add_u32_dpp v59, v31, v2 row_newbcast:2 row_mask:0xf bank_mask:0x3
  buffer_load_dwordx4 v62, s[32:35], 0 offen lds
  s_add_u32 m0, s76, 55296
  v_add_u32_dpp v60, v35, v2 row_newbcast:2 row_mask:0xf bank_mask:0x3
  buffer_load_dwordx4 v63, s[32:35], 0 offen lds
  s_add_u32 m0, s76, 57344
  v_add_u32_dpp v56, v17, v2 row_newbcast:9 row_mask:0xf bank_mask:0xc
  buffer_load_dwordx4 v64, s[32:35], 0 offen lds
  s_add_u32 m0, s76, 59392
  v_add_u32_dpp v57, v21, v2 row_newbcast:9 row_mask:0xf bank_mask:0xc
  buffer_load_dwordx4 v65, s[32:35], 0 offen lds
  v_add_u32_dpp v58, v25, v2 row_newbcast:9 row_mask:0xf bank_mask:0xc
  v_add_u32_dpp v59, v29, v2 row_newbcast:9 row_mask:0xf bank_mask:0xc
  v_add_u32_dpp v60, v33, v2 row_newbcast:9 row_mask:0xf bank_mask:0xc
  s_waitcnt vmcnt(12)
  s_barrier
  s_add_u32 m0, s75, 139264
  v_add_u32_dpp v61, v39, v2 row_newbcast:2 row_mask:0xf bank_mask:0x3
  buffer_load_dwordx4 v4, s[44:47], s74 offen lds
  s_add_u32 m0, s75, 140288
  v_add_u32_dpp v62, v43, v2 row_newbcast:2 row_mask:0xf bank_mask:0x3
  buffer_load_dwordx4 v5, s[44:47], s74 offen lds
  s_add_u32 s74, s74, 106496
  s_add_u32 m0, s76, 81920
  v_add_u32_dpp v63, v47, v2 row_newbcast:2 row_mask:0xf bank_mask:0x3
  buffer_load_dwordx4 v56, s[32:35], 0 offen lds
  s_add_u32 m0, s76, 83968
  v_add_u32_dpp v64, v51, v2 row_newbcast:2 row_mask:0xf bank_mask:0x3
  buffer_load_dwordx4 v57, s[32:35], 0 offen lds
  s_add_u32 m0, s76, 86016
  v_add_u32_dpp v65, v55, v2 row_newbcast:2 row_mask:0xf bank_mask:0x3
  buffer_load_dwordx4 v58, s[32:35], 0 offen lds
  s_add_u32 m0, s76, 88064
  v_add_u32_dpp v61, v37, v2 row_newbcast:9 row_mask:0xf bank_mask:0xc
  buffer_load_dwordx4 v59, s[32:35], 0 offen lds
  s_add_u32 m0, s76, 90112
  v_add_u32_dpp v62, v41, v2 row_newbcast:9 row_mask:0xf bank_mask:0xc
  buffer_load_dwordx4 v60, s[32:35], 0 offen lds
  v_add_u32_dpp v63, v45, v2 row_newbcast:9 row_mask:0xf bank_mask:0xc
  v_add_u32_dpp v64, v49, v2 row_newbcast:9 row_mask:0xf bank_mask:0xc
  v_add_u32_dpp v65, v53, v2 row_newbcast:9 row_mask:0xf bank_mask:0xc
  s_waitcnt vmcnt(12)
  s_barrier
  s_add_u32 m0, s75, 122880
  v_add_u32_dpp v56, v16, v2 row_newbcast:3 row_mask:0xf bank_mask:0x3
  buffer_load_dwordx4 v4, s[44:47], s74 offen lds
  s_add_u32 m0, s75, 123904
  v_add_u32_dpp v57, v20, v2 row_newbcast:3 row_mask:0xf bank_mask:0x3
  buffer_load_dwordx4 v5, s[44:47], s74 offen lds
  s_add_u32 s74, s74, 106496
  s_add_u32 m0, s76, 92160
  v_add_u32_dpp v58, v24, v2 row_newbcast:3 row_mask:0xf bank_mask:0x3
  buffer_load_dwordx4 v61, s[32:35], 0 offen lds
  s_add_u32 m0, s76, 94208
  v_add_u32_dpp v59, v28, v2 row_newbcast:3 row_mask:0xf bank_mask:0x3
  buffer_load_dwordx4 v62, s[32:35], 0 offen lds
  s_add_u32 m0, s76, 96256
  v_add_u32_dpp v60, v32, v2 row_newbcast:3 row_mask:0xf bank_mask:0x3
  buffer_load_dwordx4 v63, s[32:35], 0 offen lds
  s_add_u32 m0, s76, 98304
  v_add_u32_dpp v56, v18, v2 row_newbcast:9 row_mask:0xf bank_mask:0xc
  buffer_load_dwordx4 v64, s[32:35], 0 offen lds
  s_add_u32 m0, s76, 100352
  v_add_u32_dpp v57, v22, v2 row_newbcast:9 row_mask:0xf bank_mask:0xc
  buffer_load_dwordx4 v65, s[32:35], 0 offen lds
  v_add_u32_dpp v58, v26, v2 row_newbcast:9 row_mask:0xf bank_mask:0xc
  v_add_u32_dpp v59, v30, v2 row_newbcast:9 row_mask:0xf bank_mask:0xc
  v_add_u32_dpp v60, v34, v2 row_newbcast:9 row_mask:0xf bank_mask:0xc
  s_waitcnt vmcnt(12)
  s_barrier
  s_add_u32 m0, s75, 131072
  v_add_u32_dpp v61, v36, v2 row_newbcast:3 row_mask:0xf bank_mask:0x3
  buffer_load_dwordx4 v4, s[44:47], s74 offen lds
  s_add_u32 m0, s75, 132096
  v_add_u32_dpp v62, v40, v2 row_newbcast:3 row_mask:0xf bank_mask:0x3
  buffer_load_dwordx4 v5, s[44:47], s74 offen lds
  s_add_u32 s74, s74, 106496
  s_add_u32 m0, s76, 0
  v_add_u32_dpp v63, v44, v2 row_newbcast:3 row_mask:0xf bank_mask:0x3
  buffer_load_dwordx4 v56, s[32:35], 0 offen lds
  s_add_u32 m0, s76, 2048
  v_add_u32_dpp v64, v48, v2 row_newbcast:3 row_mask:0xf bank_mask:0x3
  buffer_load_dwordx4 v57, s[32:35], 0 offen lds
  s_add_u32 m0, s76, 4096
  v_add_u32_dpp v65, v52, v2 row_newbcast:3 row_mask:0xf bank_mask:0x3
  buffer_load_dwordx4 v58, s[32:35], 0 offen lds
  s_add_u32 m0, s76, 6144
  v_add_u32_dpp v61, v38, v2 row_newbcast:9 row_mask:0xf bank_mask:0xc
  buffer_load_dwordx4 v59, s[32:35], 0 offen lds
  s_add_u32 m0, s76, 8192
  v_add_u32_dpp v62, v42, v2 row_newbcast:9 row_mask:0xf bank_mask:0xc
  buffer_load_dwordx4 v60, s[32:35], 0 offen lds
  v_add_u32_dpp v63, v46, v2 row_newbcast:9 row_mask:0xf bank_mask:0xc
  v_add_u32_dpp v64, v50, v2 row_newbcast:9 row_mask:0xf bank_mask:0xc
  v_add_u32_dpp v65, v54, v2 row_newbcast:9 row_mask:0xf bank_mask:0xc
  s_waitcnt vmcnt(12)
  s_barrier
  s_add_u32 m0, s75, 139264
  v_add_u32_dpp v56, v17, v2 row_newbcast:3 row_mask:0xf bank_mask:0x3
  buffer_load_dwordx4 v4, s[44:47], s74 offen lds
  s_add_u32 m0, s75, 140288
  v_add_u32_dpp v57, v21, v2 row_newbcast:3 row_mask:0xf bank_mask:0x3
  buffer_load_dwordx4 v5, s[44:47], s74 offen lds
  s_add_u32 s74, s74, 106496
  s_add_u32 m0, s76, 10240
  v_add_u32_dpp v58, v25, v2 row_newbcast:3 row_mask:0xf bank_mask:0x3
  buffer_load_dwordx4 v61, s[32:35], 0 offen lds
  s_add_u32 m0, s76, 12288
  v_add_u32_dpp v59, v29, v2 row_newbcast:3 row_mask:0xf bank_mask:0x3
  buffer_load_dwordx4 v62, s[32:35], 0 offen lds
  s_add_u32 m0, s76, 14336
  v_add_u32_dpp v60, v33, v2 row_newbcast:3 row_mask:0xf bank_mask:0x3
  buffer_load_dwordx4 v63, s[32:35], 0 offen lds
  s_add_u32 m0, s76, 16384
  v_add_u32_dpp v56, v19, v2 row_newbcast:9 row_mask:0xf bank_mask:0xc
  buffer_load_dwordx4 v64, s[32:35], 0 offen lds
  s_add_u32 m0, s76, 18432
  v_add_u32_dpp v57, v23, v2 row_newbcast:9 row_mask:0xf bank_mask:0xc
  buffer_load_dwordx4 v65, s[32:35], 0 offen lds
  v_add_u32_dpp v58, v27, v2 row_newbcast:9 row_mask:0xf bank_mask:0xc
  v_add_u32_dpp v59, v31, v2 row_newbcast:9 row_mask:0xf bank_mask:0xc
  v_add_u32_dpp v60, v35, v2 row_newbcast:9 row_mask:0xf bank_mask:0xc
  v_mov_b32_dpp v17, v17 row_shl:3 row_mask:0xf bank_mask:0xf
  v_mov_b32_dpp v19, v19 row_shl:3 row_mask:0xf bank_mask:0xf
  v_mov_b32_dpp v21, v21 row_shl:3 row_mask:0xf bank_mask:0xf
  v_mov_b32_dpp v23, v23 row_shl:3 row_mask:0xf bank_mask:0xf
  v_mov_b32_dpp v25, v25 row_shl:3 row_mask:0xf bank_mask:0xf
  v_mov_b32_dpp v27, v27 row_shl:3 row_mask:0xf bank_mask:0xf
  v_mov_b32_dpp v29, v29 row_shl:3 row_mask:0xf bank_mask:0xf
  v_mov_b32_dpp v31, v31 row_shl:3 row_mask:0xf bank_mask:0xf
  v_mov_b32_dpp v33, v33 row_shl:3 row_mask:0xf bank_mask:0xf
  v_mov_b32_dpp v35, v35 row_shl:3 row_mask:0xf bank_mask:0xf
  s_waitcnt vmcnt(12)
  s_barrier
  s_add_u32 m0, s75, 122880
  v_add_u32_dpp v61, v37, v2 row_newbcast:3 row_mask:0xf bank_mask:0x3
  buffer_load_dwordx4 v4, s[44:47], s74 offen lds
  s_add_u32 m0, s75, 123904
  v_add_u32_dpp v62, v41, v2 row_newbcast:3 row_mask:0xf bank_mask:0x3
  buffer_load_dwordx4 v5, s[44:47], s74 offen lds
  s_add_u32 s74, s74, 106496
  s_add_u32 m0, s76, 40960
  v_add_u32_dpp v63, v45, v2 row_newbcast:3 row_mask:0xf bank_mask:0x3
  buffer_load_dwordx4 v56, s[32:35], 0 offen lds
  s_add_u32 m0, s76, 43008
  v_add_u32_dpp v64, v49, v2 row_newbcast:3 row_mask:0xf bank_mask:0x3
  buffer_load_dwordx4 v57, s[32:35], 0 offen lds
  s_add_u32 m0, s76, 45056
  v_add_u32_dpp v65, v53, v2 row_newbcast:3 row_mask:0xf bank_mask:0x3
  buffer_load_dwordx4 v58, s[32:35], 0 offen lds
  s_add_u32 m0, s76, 47104
  v_add_u32_dpp v61, v39, v2 row_newbcast:9 row_mask:0xf bank_mask:0xc
  buffer_load_dwordx4 v59, s[32:35], 0 offen lds
  s_add_u32 m0, s76, 49152
  v_add_u32_dpp v62, v43, v2 row_newbcast:9 row_mask:0xf bank_mask:0xc
  buffer_load_dwordx4 v60, s[32:35], 0 offen lds
  v_add_u32_dpp v63, v47, v2 row_newbcast:9 row_mask:0xf bank_mask:0xc
  v_add_u32_dpp v64, v51, v2 row_newbcast:9 row_mask:0xf bank_mask:0xc
  v_add_u32_dpp v65, v55, v2 row_newbcast:9 row_mask:0xf bank_mask:0xc
  v_mov_b32_dpp v37, v37 row_shl:3 row_mask:0xf bank_mask:0xf
  v_mov_b32_dpp v39, v39 row_shl:3 row_mask:0xf bank_mask:0xf
  v_mov_b32_dpp v41, v41 row_shl:3 row_mask:0xf bank_mask:0xf
  v_mov_b32_dpp v43, v43 row_shl:3 row_mask:0xf bank_mask:0xf
  v_mov_b32_dpp v45, v45 row_shl:3 row_mask:0xf bank_mask:0xf
  v_mov_b32_dpp v47, v47 row_shl:3 row_mask:0xf bank_mask:0xf
  v_mov_b32_dpp v49, v49 row_shl:3 row_mask:0xf bank_mask:0xf
  v_mov_b32_dpp v51, v51 row_shl:3 row_mask:0xf bank_mask:0xf
  v_mov_b32_dpp v53, v53 row_shl:3 row_mask:0xf bank_mask:0xf
  v_mov_b32_dpp v55, v55 row_shl:3 row_mask:0xf bank_mask:0xf
  s_waitcnt vmcnt(12)
  s_barrier
  s_add_u32 m0, s75, 131072
  v_add_u32_dpp v56, v18, v2 row_newbcast:3 row_mask:0xf bank_mask:0x3
  buffer_load_dwordx4 v4, s[44:47], s74 offen lds
  s_add_u32 m0, s75, 132096
  v_add_u32_dpp v57, v22, v2 row_newbcast:3 row_mask:0xf bank_mask:0x3
  buffer_load_dwordx4 v5, s[44:47], s74 offen lds
  s_add_u32 s74, s74, 106496
  s_add_u32 m0, s76, 51200
  v_add_u32_dpp v58, v26, v2 row_newbcast:3 row_mask:0xf bank_mask:0x3
  buffer_load_dwordx4 v61, s[32:35], 0 offen lds
  s_add_u32 m0, s76, 53248
  v_add_u32_dpp v59, v30, v2 row_newbcast:3 row_mask:0xf bank_mask:0x3
  buffer_load_dwordx4 v62, s[32:35], 0 offen lds
  s_add_u32 m0, s76, 55296
  v_add_u32_dpp v60, v34, v2 row_newbcast:3 row_mask:0xf bank_mask:0x3
  buffer_load_dwordx4 v63, s[32:35], 0 offen lds
  s_add_u32 m0, s76, 57344
  v_add_u32_dpp v56, v16, v2 row_newbcast:10 row_mask:0xf bank_mask:0xc
  buffer_load_dwordx4 v64, s[32:35], 0 offen lds
  s_add_u32 m0, s76, 59392
  v_add_u32_dpp v57, v20, v2 row_newbcast:10 row_mask:0xf bank_mask:0xc
  buffer_load_dwordx4 v65, s[32:35], 0 offen lds
  v_add_u32_dpp v58, v24, v2 row_newbcast:10 row_mask:0xf bank_mask:0xc
  v_add_u32_dpp v59, v28, v2 row_newbcast:10 row_mask:0xf bank_mask:0xc
  v_add_u32_dpp v60, v32, v2 row_newbcast:10 row_mask:0xf bank_mask:0xc
  v_mov_b32_dpp v16, v16 row_shl:3 row_mask:0xf bank_mask:0xf
  v_mov_b32_dpp v18, v18 row_shl:3 row_mask:0xf bank_mask:0xf
  v_mov_b32_dpp v20, v20 row_shl:3 row_mask:0xf bank_mask:0xf
  v_mov_b32_dpp v22, v22 row_shl:3 row_mask:0xf bank_mask:0xf
  v_mov_b32_dpp v24, v24 row_shl:3 row_mask:0xf bank_mask:0xf
  v_mov_b32_dpp v26, v26 row_shl:3 row_mask:0xf bank_mask:0xf
  v_mov_b32_dpp v28, v28 row_shl:3 row_mask:0xf bank_mask:0xf
  v_mov_b32_dpp v30, v30 row_shl:3 row_mask:0xf bank_mask:0xf
  v_mov_b32_dpp v32, v32 row_shl:3 row_mask:0xf bank_mask:0xf
  v_mov_b32_dpp v34, v34 row_shl:3 row_mask:0xf bank_mask:0xf
  s_waitcnt vmcnt(12)
  s_barrier
  s_add_u32 m0, s75, 139264
  v_add_u32_dpp v61, v38, v2 row_newbcast:3 row_mask:0xf bank_mask:0x3
  buffer_load_dwordx4 v4, s[44:47], s74 offen lds
  s_add_u32 m0, s75, 140288
  v_add_u32_dpp v62, v42, v2 row_newbcast:3 row_mask:0xf bank_mask:0x3
  buffer_load_dwordx4 v5, s[44:47], s74 offen lds
  s_add_u32 s74, s74, 106496
  s_add_u32 m0, s76, 81920
  v_add_u32_dpp v63, v46, v2 row_newbcast:3 row_mask:0xf bank_mask:0x3
  buffer_load_dwordx4 v56, s[32:35], 0 offen lds
  s_add_u32 m0, s76, 83968
  v_add_u32_dpp v64, v50, v2 row_newbcast:3 row_mask:0xf bank_mask:0x3
  buffer_load_dwordx4 v57, s[32:35], 0 offen lds
  s_add_u32 m0, s76, 86016
  v_add_u32_dpp v65, v54, v2 row_newbcast:3 row_mask:0xf bank_mask:0x3
  buffer_load_dwordx4 v58, s[32:35], 0 offen lds
  s_add_u32 m0, s76, 88064
  v_add_u32_dpp v61, v36, v2 row_newbcast:10 row_mask:0xf bank_mask:0xc
  buffer_load_dwordx4 v59, s[32:35], 0 offen lds
  s_add_u32 m0, s76, 90112
  v_add_u32_dpp v62, v40, v2 row_newbcast:10 row_mask:0xf bank_mask:0xc
  buffer_load_dwordx4 v60, s[32:35], 0 offen lds
  v_add_u32_dpp v63, v44, v2 row_newbcast:10 row_mask:0xf bank_mask:0xc
  v_add_u32_dpp v64, v48, v2 row_newbcast:10 row_mask:0xf bank_mask:0xc
  v_add_u32_dpp v65, v52, v2 row_newbcast:10 row_mask:0xf bank_mask:0xc
  v_mov_b32_dpp v36, v36 row_shl:3 row_mask:0xf bank_mask:0xf
  v_mov_b32_dpp v38, v38 row_shl:3 row_mask:0xf bank_mask:0xf
  v_mov_b32_dpp v40, v40 row_shl:3 row_mask:0xf bank_mask:0xf
  v_mov_b32_dpp v42, v42 row_shl:3 row_mask:0xf bank_mask:0xf
  v_mov_b32_dpp v44, v44 row_shl:3 row_mask:0xf bank_mask:0xf
  v_mov_b32_dpp v46, v46 row_shl:3 row_mask:0xf bank_mask:0xf
  v_mov_b32_dpp v48, v48 row_shl:3 row_mask:0xf bank_mask:0xf
  v_mov_b32_dpp v50, v50 row_shl:3 row_mask:0xf bank_mask:0xf
  v_mov_b32_dpp v52, v52 row_shl:3 row_mask:0xf bank_mask:0xf
  v_mov_b32_dpp v54, v54 row_shl:3 row_mask:0xf bank_mask:0xf
  s_add_u32 s72, s72, 1
  s_cmp_lt_u32 s72, 2
  s_waitcnt vmcnt(12)
  s_cbranch_scc1 L_dnn_loop1
  s_branch L_ld_tail
L_cin:
  v_lshlrev_b32 v1, 4, v0
  s_and_b32 s79, s3, 3
  s_lshr_b32 s84, s3, 2
  s_lshl_b32 s95, s79, 10
  s_mul_i32 s26, s68, 11
  s_add_u32 s26, s26, s69
  s_sub_u32 s26, s26, 22
  s_cmp_eq_u32 s26, 86
  s_cbranch_scc1 L_end
  s_cmp_eq_u32 s84, 0
  s_cbranch_scc1 L_sc
  s_setprio 2
  v_add_u32 v2, L_tables-L_pc+4096, v1
  v_mov_b32 v3, s93
  v_add_co_u32 v2, vcc, s92, v2
  s_nop 1
  v_addc_co_u32 v3, vcc, 0, v3, vcc
  v_add_co_u32 v32, vcc, s95, v2
  s_nop 1
  v_addc_co_u32 v33, vcc, 0, v3, vcc
  s_cmp_lt_u32 s79, 2
  s_mov_b32 s70, 119104
  s_cselect_b32 s70, 81920, s70
  s_add_u32 m0, s95, 81920
  s_nop 0
  global_load_lds_dwordx4 v[32:33], off offset:-4096
  s_add_u32 m0, s95, s70
  s_nop 0
  global_load_lds_dwordx4 v[32:33], off offset:0
  v_add_co_u32 v32, vcc, 0x2000, v32
  s_nop 1
  v_addc_co_u32 v33, vcc, 0, v33, vcc
  s_add_u32 m0, s95, 127296
  s_nop 0
  global_load_lds_dwordx4 v[32:33], off offset:-4096
  s_add_u32 m0, s95, 2048
  s_nop 0
  global_load_lds_dwordx4 v[32:33], off offset:0
  global_load_dwordx4 v[224:227], v[2:3], off offset:-4096
  global_load_dwordx4 v[240:243], v[2:3], off offset:-3072
L_sc:
  s_mul_i32 s85, s84, 20
  s_add_u32 s85, s85, s3
  s_mul_i32 s94, s26, 48
  s_add_u32 s94, s94, s85
  s_mul_i32 s94, s94, 104
  v_lshrrev_b32 v30, 3, v0
  v_lshlrev_b32 v30, 4, v30
  v_and_b32 v29, 0x70, v1
  s_mul_i32 s76, s3, 4064
  s_add_u32 s76, s76, 131136
  s_cmp_eq_u32 s84, 0
  s_cbranch_scc1 L_g0
  s_waitcnt lgkmcnt(0)
  s_mov_b32 s40, s10
  s_and_b32 s41, s11, 0xffff
  s_mov_b32 s42, 156
  s_mov_b32 s43, 0x20000
  s_mov_b32 m0, 129472
  s_mov_b64 exec, 0x7ff
  buffer_load_dwordx4 v1, s[40:43], 0 offen lds
  s_mov_b64 exec, -1
  s_lshl_b32 s85, s85, 2
  s_add_u32 s85, s85, 129728
  s_mul_i32 s72, s84, 3
  s_sub_u32 s72, 4, s72
  s_cmp_eq_u32 s26, 85
  s_cselect_b32 s72, s72, 6
  s_lshl_b32 s44, s3, 7
  s_mul_i32 s45, s3, 5280
  s_lshl_b32 s46, s3, 2
  s_lshl_b32 s47, s3, 1
  s_lshl_b32 s82, s3, 12
  s_and_b32 s98, s3, 1
  s_lshr_b32 s99, s3, 1
  s_mul_i32 s68, s99, 3072
  s_lshl_b32 s83, s98, 3
  s_add_u32 s68, s68, s83
  v_add_u32 v59, s68, v1
  s_lshl_b32 s69, s99, 3
  s_lshr_b32 s69, 0x05030200, s69
  s_and_b32 s69, s69, 0xff
  s_lshl_b32 s69, s69, 9
  s_lshl_b32 s70, s98, 2
  s_add_u32 s101, s69, s70
  s_mov_b32 s99, 0x05040100
  s_mov_b32 s100, 0x07060302
  v_mov_b32 v2, 129664
  v_mov_b32 v109, 0
  v_mov_b32 v108, 0
  v_mov_b64 v[32:33], 0
  v_mov_b64 v[34:35], 0
  v_mov_b64 v[36:37], 0
  v_mov_b64 v[38:39], 0
  v_mov_b64 v[40:41], 0
  v_mov_b64 v[42:43], 0
  v_mov_b64 v[44:45], 0
  v_mov_b64 v[46:47], 0
  v_mov_b64 v[48:49], 0
  v_mov_b64 v[50:51], 0
  v_mov_b64 v[52:53], 0
  v_mov_b64 v[54:55], 0
  v_mov_b64 v[56:57], 0
  v_add_u32 v14, 77824, v1
  v_add_u32 v15, 121152, v1
  v_lshrrev_b32_e64 v3, 5, v0
  v_lshl_add_u32 v3, v3, 2, v2
  s_mov_b32 s28, s4
  s_and_b32 s29, s5, 0xffff
  s_mov_b32 s30, 425984
  s_mov_b32 s31, 0x20000
  s_mov_b32 s32, s6
  s_and_b32 s33, s7, 0xffff
  s_mov_b32 s34, 12800000
  s_mov_b32 s35, 0x20000
  ds_write_b128 v2, v[32:35] offset:16
  s_lshl_b32 s68, s79, 6
  v_add_u32 v29, s68, v0
  v_mul_u32_u24 v30, 2521, v29
  v_lshrrev_b32 v30, 16, v30
  v_mul_u32_u24 v30, 12, v30
  v_lshl_add_u32 v28, v29, 1, v30
  v_add_u32 v29, 256, v29
  v_mul_u32_u24 v30, 2521, v29
  v_lshrrev_b32 v30, 16, v30
  v_mul_u32_u24_e64 v30, 12, v30
  v_lshl_add_u32 v58, v29, 1, v30
  v_add_u32 v29, 256, v29
  v_mul_u32_u24 v30, 2521, v29
  v_lshrrev_b32 v30, 16, v30
  v_mul_u32_u24 v30, 12, v30
  v_lshl_add_u32 v111, v29, 1, v30
  v_cmp_gt_u32 vcc, 676, v29
  s_nop 0
  s_mov_b64 s[92:93], vcc
  v_lshlrev_b32_e64 v29, 3, v0
  s_mov_b32 exec_hi, 0xffff
  ds_write_b64 v29, v[32:33] offset:1664
  s_mov_b32 exec_hi, -1
  s_waitcnt vmcnt(1)
  ds_write_b32 v243, v32
  ds_write_b32 v243, v32 offset:43328
  s_waitcnt vmcnt(0)
  ds_read_b64 v[112:113], v240 offset:0
  ds_read_b64 v[114:115], v240 offset:8
  ds_read_b64 v[116:117], v240 offset:32
  ds_read_b64 v[118:119], v240 offset:40
  ds_read_u16 v110, v241
  s_mov_b64 exec, 0x3ffffff
  s_waitcnt lgkmcnt(0)
  ds_write_b16 v242, v110
  v_lshlrev_b32 v109, 17, v110
  v_lshrrev_b32 v109, 1, v109
  s_mov_b64 exec, -1
  v_add_u32 v225, s44, v225
  v_add_u32 v226, s44, v226
  v_add_u32 v227, s44, v227
  s_waitcnt lgkmcnt(0)
  s_barrier
  ds_read_b64_tr_b16 v[60:61], v225 offset:35328
  ds_read_b64_tr_b16 v[62:63], v225 offset:40736
  ds_read_b64_tr_b16 v[64:65], v226 offset:35328
  ds_read_b64_tr_b16 v[66:67], v227 offset:35328
  ds_read_b64_tr_b16 v[68:69], v225 offset:35392
  ds_read_b64_tr_b16 v[70:71], v225 offset:40800
  ds_read_b64_tr_b16 v[72:73], v226 offset:35392
  ds_read_b64_tr_b16 v[74:75], v227 offset:35392
  ds_read_b64_tr_b16 v[76:77], v225 offset:35840
  ds_read_b64_tr_b16 v[78:79], v225 offset:41248
  ds_read_b64_tr_b16 v[80:81], v226 offset:35840
  ds_read_b64_tr_b16 v[82:83], v227 offset:35840
  ds_read_b64_tr_b16 v[84:85], v225 offset:35904
  ds_read_b64_tr_b16 v[86:87], v225 offset:41312
  ds_read_b64_tr_b16 v[88:89], v226 offset:35904
  ds_read_b64_tr_b16 v[90:91], v227 offset:35904
  s_waitcnt lgkmcnt(14)
  v_mfma_f32_32x32x16_bf16 v[120:135], v[112:115], v[60:63], 0
  s_waitcnt lgkmcnt(12)
  v_mfma_f32_32x32x16_bf16 v[120:135], v[116:119], v[64:67], v[120:135]
  ds_read_b64_tr_b16 v[92:93], v225 offset:36352
  ds_read_b64_tr_b16 v[94:95], v225 offset:41760
  ds_read_b64_tr_b16 v[96:97], v226 offset:36352
  ds_read_b64_tr_b16 v[98:99], v227 offset:36352
  s_waitcnt lgkmcnt(14)
  v_mfma_f32_32x32x16_bf16 v[136:151], v[112:115], v[68:71], 0
  s_waitcnt lgkmcnt(12)
  v_mfma_f32_32x32x16_bf16 v[136:151], v[116:119], v[72:75], v[136:151]
  ds_read_b64_tr_b16 v[100:101], v225 offset:36416
  ds_read_b64_tr_b16 v[102:103], v225 offset:41824
  ds_read_b64_tr_b16 v[104:105], v226 offset:36416
  ds_read_b64_tr_b16 v[106:107], v227 offset:36416
  s_waitcnt lgkmcnt(14)
  v_mfma_f32_32x32x16_bf16 v[152:167], v[112:115], v[76:79], 0
  s_waitcnt lgkmcnt(12)
  v_mfma_f32_32x32x16_bf16 v[152:167], v[116:119], v[80:83], v[152:167]
  s_waitcnt lgkmcnt(10)
  v_mfma_f32_32x32x16_bf16 v[168:183], v[112:115], v[84:87], 0
  s_waitcnt lgkmcnt(8)
  v_mfma_f32_32x32x16_bf16 v[168:183], v[116:119], v[88:91], v[168:183]
  ds_read_b128 v[228:231], v15 offset:1024
  ds_read_b128 v[232:235], v15 offset:2048
  ds_read_b128 v[4:7], v14 offset:4096
  ds_read_b128 v[8:11], v15 offset:4096
  ds_read_b128 v[20:23], v14 offset:2048
  ds_read_b128 v[24:27], v14 offset:3072
  ds_read_b128 v[216:219], v14 offset:5120
  ds_read_b128 v[220:223], v15 offset:0
  ds_read_b128 v[236:239], v15 offset:3072
  s_waitcnt lgkmcnt(14)
  v_mfma_f32_32x32x16_bf16 v[184:199], v[112:115], v[92:95], 0
  s_waitcnt lgkmcnt(13)
  v_mfma_f32_32x32x16_bf16 v[184:199], v[116:119], v[96:99], v[184:199]
  s_waitcnt lgkmcnt(11)
  v_mfma_f32_32x32x16_bf16 v[200:215], v[112:115], v[100:103], 0
  s_waitcnt lgkmcnt(9)
  v_mfma_f32_32x32x16_bf16 v[200:215], v[116:119], v[104:107], v[200:215]
  s_waitcnt lgkmcnt(8)
  v_add_u32 v228, s46, v228
  v_add_u32 v229, s46, v229
  v_add_u32 v231, s83, v231
  v_add_u32 v230, s101, v230
  s_waitcnt lgkmcnt(7)
  v_mad_u32_u24 v232, v233, s3, v232
  v_add_u32_e64 v234, s47, v234
  v_mad_u32_u24 v233, v233, 8, v232
  v_add_u32 v246, s82, v235
  v_add_u32 v247, 2048, v246
  v_add_u32 v31, 0, v234
  v_and_b32 v31, 3, v31
  v_lshl_add_u32 v244, v31, 4, v232
  v_add_u32 v31, 1, v234
  v_and_b32 v31, 3, v31
  v_lshl_add_u32 v245, v31, 4, v232
  v_add_u32 v245, 1664, v245
  v_add_u32 v31, 0, v234
  v_and_b32 v31, 3, v31
  v_lshl_add_u32 v248, v31, 4, v233
  v_add_u32 v31, 1, v234
  v_and_b32 v31, 3, v31
  v_lshl_add_u32 v249, v31, 4, v233
  v_add_u32 v249, 1664, v249
  s_waitcnt lgkmcnt(5)
  v_add_u32 v10, s76, v10
  v_add_u32 v4, s76, v4
  v_add_u32 v5, s76, v5
  ds_write_b32 v10, v7 offset:2880
  v_add_u32 v11, s45, v11
  s_waitcnt lgkmcnt(5)
  v_add_u32 v20, s45, v20
  v_add_u32 v21, s45, v21
  v_add_u32 v22, s45, v22
  v_add_u32 v23, s45, v23
  s_waitcnt lgkmcnt(4)
  v_add_u32 v24, s45, v24
  v_add_u32 v25, s45, v25
  v_add_u32 v26, s45, v26
  v_add_u32 v27, s45, v27
  s_mov_b32 exec_lo, 0
  v_mov_b32_e64 v120, v136
  s_mov_b32 exec_lo, -1
  v_cvt_pk_bf16_f32 v60, 0, v120
  ds_write_b16_d16_hi v28, v60
  v_max_f32 v108, |v60|, v108
  s_mov_b32 exec_lo, 0
  v_mov_b32 v152, v168
  s_mov_b32 exec_lo, -1
  v_cvt_pk_bf16_f32 v61, 0, v152
  ds_write_b16_d16_hi v58, v61
  v_max_f32 v108, |v61|, v108
  s_mov_b32 exec_lo, 0
  v_mov_b32 v184, v200
  s_mov_b32 exec_lo, -1
  v_cvt_pk_bf16_f32 v62, 0, v184
  s_mov_b64 exec, s[92:93]
  ds_write_b16_d16_hi v111, v62
  v_max_f32 v108, |v62|, v108
  s_mov_b64 exec, -1
  s_nop 0
  v_permlane32_swap_b32 v108, v109
  v_max_u32_e64 v108, v108, v109
  s_nop 1
  v_max_u32_dpp v108, v108, v108 row_shr:1 row_mask:0xf bank_mask:0xf
  s_nop 1
  v_max_u32_dpp v108, v108, v108 row_shr:2 row_mask:0xf bank_mask:0xf
  s_nop 1
  v_max_u32_dpp v108, v108, v108 row_shr:4 row_mask:0xf bank_mask:0xf
  s_nop 1
  v_max_u32_dpp v108, v108, v108 row_shr:8 row_mask:0xf bank_mask:0xf
  s_nop 1
  v_max_u32_dpp v108, v108, v108 row_bcast:15 row_mask:0xa bank_mask:0xf
  s_mov_b32 exec_lo, 0x80000000
  s_mov_b32 exec_hi, 0x80000000
  ds_max_u32 v3, v108 offset:24
  s_mov_b64 exec, -1
  s_setprio 0
  s_barrier
  s_branch L_w2
L_g0:
  s_waitcnt lgkmcnt(0)
  s_mov_b32 s36, s8
  s_and_b32 s37, s9, 0xffff
  s_mov_b32 s38, 105456
  s_mov_b32 s39, 0x20000
  s_add_u32 m0, s95, 41984
  s_add_u32 s81, s95, 70304
  buffer_load_dwordx4 v1, s[36:39], s81 offen lds
  s_add_u32 m0, s95, 46080
  s_add_u32 s81, s95, 74400
  buffer_load_dwordx4 v1, s[36:39], s81 offen lds
  s_add_u32 m0, s95, 50176
  s_add_u32 s81, s95, 78496
  buffer_load_dwordx4 v1, s[36:39], s81 offen lds
  s_add_u32 m0, s95, 54272
  s_add_u32 s81, s95, 82592
  buffer_load_dwordx4 v1, s[36:39], s81 offen lds
  s_add_u32 m0, s95, 58368
  s_add_u32 s81, s95, 86688
  buffer_load_dwordx4 v1, s[36:39], s81 offen lds
  s_add_u32 m0, s95, 62464
  s_add_u32 s81, s95, 90784
  buffer_load_dwordx4 v1, s[36:39], s81 offen lds
  s_add_u32 m0, s95, 66560
  s_add_u32 s81, s95, 94880
  buffer_load_dwordx4 v1, s[36:39], s81 offen lds
  s_add_u32 m0, s95, 70656
  s_add_u32 s81, s95, 98976
  buffer_load_dwordx4 v1, s[36:39], s81 offen lds
  s_cmp_eq_u32 s79, 3
  s_cbranch_scc1 L_st3
  s_add_u32 m0, s95, 74752
  s_add_u32 s81, s95, 103072
  buffer_load_dwordx4 v1, s[36:39], s81 offen lds
L_st3:
  s_mov_b32 s28, s4
  s_and_b32 s29, s5, 0xffff
  s_mov_b32 s30, 425984
  s_mov_b32 s31, 0x20000
  buffer_load_dwordx4 v[16:19], v30, s[28:31], s94 offen
  s_add_u32 s94, s94, 416
  buffer_load_dwordx4 v[104:107], v30, s[28:31], s94 offen
  s_add_u32 s94, s94, 416
  s_mov_b32 s32, s6
  s_and_b32 s33, s7, 0xffff
  s_mov_b32 s34, 12800000
  s_mov_b32 s35, 0x20000
  s_add_u32 m0, s95, 85312
  s_add_u32 s81, s95, 35152
  buffer_load_dwordx4 v1, s[36:39], s81 offen lds
  s_lshl_b32 s85, s85, 2
  s_add_u32 s85, s85, 129728
  s_mul_i32 s72, s84, 3
  s_sub_u32 s72, 4, s72
  s_cmp_eq_u32 s26, 85
  s_cselect_b32 s72, s72, 6
  s_lshl_b32 s44, s3, 7
  s_add_u32 m0, s95, 89408
  s_add_u32 s81, s95, 39248
  buffer_load_dwordx4 v1, s[36:39], s81 offen lds
  s_mul_i32 s45, s3, 5280
  s_lshl_b32 s46, s3, 2
  s_lshl_b32 s47, s3, 1
  s_lshl_b32 s82, s3, 12
  s_and_b32 s98, s3, 1
  s_add_u32 m0, s95, 93504
  s_add_u32 s81, s95, 43344
  buffer_load_dwordx4 v1, s[36:39], s81 offen lds
  s_lshr_b32 s99, s3, 1
  s_mul_i32 s68, s99, 3072
  s_lshl_b32 s83, s98, 3
  s_add_u32 s68, s68, s83
  v_add_u32 v59, s68, v1
  s_lshl_b32 s69, s99, 3
  s_add_u32 m0, s95, 97600
  s_add_u32 s81, s95, 47440
  buffer_load_dwordx4 v1, s[36:39], s81 offen lds
  s_lshr_b32 s69, 0x05030200, s69
  s_and_b32 s69, s69, 0xff
  s_lshl_b32 s69, s69, 9
  s_lshl_b32 s70, s98, 2
  s_add_u32 s101, s69, s70
  s_add_u32 m0, s95, 101696
  s_add_u32 s81, s95, 51536
  buffer_load_dwordx4 v1, s[36:39], s81 offen lds
  s_mov_b32 s99, 0x05040100
  s_mov_b32 s100, 0x07060302
  v_mov_b32 v2, 129664
  v_mov_b32 v109, 0
  v_mov_b32_e64 v108, 0
  v_mov_b64 v[32:33], 0
  s_add_u32 m0, s95, 105792
  s_add_u32 s81, s95, 55632
  buffer_load_dwordx4 v1, s[36:39], s81 offen lds
  v_mov_b64 v[34:35], 0
  v_mov_b64 v[36:37], 0
  v_mov_b64 v[38:39], 0
  v_mov_b64 v[40:41], 0
  v_mov_b64 v[42:43], 0
  s_add_u32 m0, s95, 109888
  s_add_u32 s81, s95, 59728
  buffer_load_dwordx4 v1, s[36:39], s81 offen lds
  v_mov_b64 v[44:45], 0
  v_mov_b64 v[46:47], 0
  v_mov_b64 v[48:49], 0
  v_mov_b64 v[50:51], 0
  v_mov_b64 v[52:53], 0
  v_mov_b64 v[54:55], 0
  s_add_u32 m0, s95, 113984
  s_add_u32 s81, s95, 63824
  buffer_load_dwordx4 v1, s[36:39], s81 offen lds
  v_mov_b64 v[56:57], 0
  v_add_u32 v14, 77824, v1
  v_add_u32 v15, 121152, v1
  v_lshrrev_b32 v3, 5, v0
  v_lshl_add_u32 v3, v3, 2, v2
  s_cmp_eq_u32 s79, 3
  s_cbranch_scc1 L_st2
  s_add_u32 m0, s95, 118080
  s_add_u32 s81, s95, 67920
  buffer_load_dwordx4 v1, s[36:39], s81 offen lds
L_st2:
  s_add_u32 m0, s95, 6144
  s_add_u32 s81, s95, 0
  buffer_load_dwordx4 v1, s[36:39], s81 offen lds
  s_add_u32 m0, s95, 10240
  s_add_u32 s81, s95, 4096
  buffer_load_dwordx4 v1, s[36:39], s81 offen lds
  s_add_u32 m0, s95, 14336
  s_add_u32 s81, s95, 8192
  buffer_load_dwordx4 v1, s[36:39], s81 offen lds
  s_add_u32 m0, s95, 18432
  s_add_u32 s81, s95, 12288
  buffer_load_dwordx4 v1, s[36:39], s81 offen lds
  s_waitcnt vmcnt(14)
  s_barrier
  ds_read_b128 v[224:227], v14 offset:0
  ds_read_b128 v[228:231], v15 offset:1024
  ds_read_b128 v[232:235], v15 offset:2048
  ds_read_b128 v[4:7], v14 offset:4096
  ds_read_b128 v[8:11], v15 offset:4096
  ds_read_b128 v[20:23], v14 offset:2048
  ds_read_b128 v[24:27], v14 offset:3072
  ds_read_b128 v[216:219], v14 offset:5120
  ds_read_b128 v[220:223], v15 offset:0
  ds_read_b128 v[236:239], v15 offset:3072
  s_add_u32 m0, s95, 22528
  s_add_u32 s81, s95, 16384
  buffer_load_dwordx4 v1, s[36:39], s81 offen lds
  s_add_u32 m0, s95, 26624
  s_add_u32 s81, s95, 20480
  buffer_load_dwordx4 v1, s[36:39], s81 offen lds
  s_add_u32 m0, s95, 30720
  s_add_u32 s81, s95, 24576
  buffer_load_dwordx4 v1, s[36:39], s81 offen lds
  s_add_u32 m0, s95, 34816
  s_add_u32 s81, s95, 28672
  buffer_load_dwordx4 v1, s[36:39], s81 offen lds
  s_cmp_eq_u32 s79, 3
  s_cbranch_scc1 L_st1
  s_add_u32 m0, s95, 38912
  s_add_u32 s81, s95, 32768
  buffer_load_dwordx4 v1, s[36:39], s81 offen lds
L_st1:
  s_waitcnt vmcnt(17)
  v_lshl_add_u32 v16, v16, 7, v29
  v_lshl_add_u32 v17, v17, 7, v29
  v_lshl_add_u32 v18, v18, 7, v29
  v_lshl_add_u32 v19, v19, 7, v29
  s_add_u32 m0, s76, 0
  s_mov_b32 exec_hi, 0xffffff
  buffer_load_dwordx4 v16, s[32:35], 0 offen lds
  s_add_u32 m0, s76, 1056
  s_nop 0
  buffer_load_dwordx4 v17, s[32:35], 0 offen lds
  s_add_u32 m0, s76, 2112
  s_mov_b32 exec_hi, 0xffff
  buffer_load_dwordx4 v18, s[32:35], 0 offen lds
  s_add_u32 m0, s76, 3168
  s_nop 0
  buffer_load_dwordx4 v19, s[32:35], 0 offen lds
  s_mov_b32 exec_hi, -1
  s_waitcnt vmcnt(20)
  v_lshl_add_u32 v104, v104, 7, v29
  v_lshl_add_u32 v105, v105, 7, v29
  v_lshl_add_u32 v106, v106, 7, v29
  v_lshl_add_u32 v107, v107, 7, v29
  s_add_u32 m0, s76, 16256
  s_mov_b32 exec_hi, 0xffffff
  buffer_load_dwordx4 v104, s[32:35], 0 offen lds
  s_add_u32 m0, s76, 17312
  s_nop 0
  buffer_load_dwordx4 v105, s[32:35], 0 offen lds
  s_add_u32 m0, s76, 18368
  s_mov_b32 exec_hi, 0xffff
  buffer_load_dwordx4 v106, s[32:35], 0 offen lds
  s_add_u32 m0, s76, 19424
  s_nop 0
  buffer_load_dwordx4 v107, s[32:35], 0 offen lds
  s_mov_b32 exec_hi, -1
  s_waitcnt lgkmcnt(9)
  v_add_u32 v225, s44, v225
  v_add_u32 v226, s44, v226
  v_add_u32 v227, s44, v227
  s_waitcnt lgkmcnt(8)
  v_add_u32 v228, s46, v228
  v_add_u32 v229, s46, v229
  v_add_u32 v231, s83, v231
  v_add_u32 v230, s101, v230
  s_waitcnt lgkmcnt(7)
  v_mad_u32_u24 v232, v233, s3, v232
  v_add_u32 v234, s47, v234
  v_mad_u32_u24 v233, v233, 8, v232
  v_add_u32 v246, s82, v235
  v_add_u32 v247, 2048, v246
  v_add_u32 v31, 0, v234
  v_and_b32 v31, 3, v31
  v_lshl_add_u32 v244, v31, 4, v232
  v_add_u32 v31, 1, v234
  v_and_b32 v31, 3, v31
  v_lshl_add_u32 v245, v31, 4, v232
  v_add_u32 v245, 1664, v245
  v_add_u32 v31, 0, v234
  v_and_b32 v31, 3, v31
  v_lshl_add_u32 v248, v31, 4, v233
  v_add_u32 v31, 1, v234
  v_and_b32 v31, 3, v31
  v_lshl_add_u32 v249, v31, 4, v233
  v_add_u32 v249, 1664, v249
  s_waitcnt lgkmcnt(5)
  v_add_u32 v10, s76, v10
  v_add_u32 v4, s76, v4
  v_add_u32 v5, s76, v5
  ds_write_b32 v10, v7 offset:2880
  v_add_u32 v11, s45, v11
  s_waitcnt lgkmcnt(5)
  v_add_u32 v20, s45, v20
  v_add_u32 v21, s45, v21
  v_add_u32 v22, s45, v22
  v_add_u32 v23, s45, v23
  s_waitcnt lgkmcnt(4)
  v_add_u32 v24, s45, v24
  v_add_u32 v25, s45, v25
  v_add_u32 v26, s45, v26
  v_add_u32 v27, s45, v27
  s_waitcnt vmcnt(16)
  s_barrier
L_w2:
  ds_read_b32 v60, v228 offset:0
  ds_read_b32 v61, v228 offset:1352
  ds_read_b32 v62, v228 offset:2704
  ds_read_b32 v63, v228 offset:4056
  ds_read_b32 v64, v228 offset:5408
  ds_read_b32 v65, v228 offset:6760
  ds_read_b32 v66, v228 offset:8112
  ds_read_b32 v67, v228 offset:9464
  ds_read_b32 v68, v228 offset:21632
  ds_read_b32 v69, v228 offset:22984
  ds_read_b32 v70, v229 offset:24336
  ds_read_b32 v71, v229 offset:25688
  ds_read_b32 v72, v229 offset:27040
  ds_read_b32 v73, v229 offset:28392
  ds_read_b32 v74, v229 offset:29744
  ds_read_b32 v75, v229 offset:31096
  s_cmp_ge_u32 s3, 5
  s_cbranch_scc1 L_u0
  ds_read_b32 v92, v228 offset:32
  s_waitcnt lgkmcnt(14)
  v_pk_maximum3_f16 v110, v60, v61, 0
  v_pk_minimum3_f16 v58, v60, v61, 0
  ds_read_b32 v93, v228 offset:1384
  s_waitcnt lgkmcnt(14)
  v_pk_maximum3_f16 v110, v62, v63, v110
  v_pk_minimum3_f16 v58, v62, v63, v58
  ds_read_b32 v94, v228 offset:2736
  s_waitcnt lgkmcnt(13)
  v_pk_maximum3_f16 v110, v64, v65, v110
  v_pk_minimum3_f16 v58, v64, v65, v58
  ds_read_b32 v95, v228 offset:4088
  s_waitcnt lgkmcnt(12)
  v_pk_maximum3_f16 v110, v66, v67, v110
  v_pk_minimum3_f16 v58, v66, v67, v58
  ds_read_b32 v96, v228 offset:5440
  s_waitcnt lgkmcnt(11)
  v_pk_maximum3_f16 v110, v68, v69, v110
  v_pk_minimum3_f16 v58, v68, v69, v58
  ds_read_b32 v97, v228 offset:6792
  s_waitcnt lgkmcnt(10)
  v_pk_maximum3_f16 v110, v70, v71, v110
  v_pk_minimum3_f16 v58, v70, v71, v58
  ds_read_b32 v98, v228 offset:8144
  s_waitcnt lgkmcnt(9)
  v_pk_maximum3_f16 v110, v72, v73, v110
  v_pk_minimum3_f16 v58, v72, v73, v58
  ds_read_b32 v99, v228 offset:9496
  s_waitcnt lgkmcnt(8)
  v_pk_maximum3_f16 v110, v74, v75, v110
  v_pk_minimum3_f16 v58, v74, v75, v58
  ds_read_b32 v100, v228 offset:21664
  v_perm_b32 v184, v61, v60, s99
  v_perm_b32 v185, v63, v62, s99
  ds_read_b32 v101, v228 offset:23016
  v_perm_b32 v186, v65, v64, s99
  v_perm_b32 v187, v67, v66, s99
  ds_read_b32 v102, v229 offset:24368
  v_perm_b32 v188, v69, v68, s99
  v_perm_b32 v189, v71, v70, s99
  ds_read_b32 v103, v229 offset:25720
  v_perm_b32 v190, v73, v72, s99
  v_perm_b32 v191, v75, v74, s99
  ds_read_b32 v104, v229 offset:27072
  v_perm_b32 v192, v61, v60, s100
  v_perm_b32 v193, v63, v62, s100
  ds_read_b32 v105, v229 offset:28424
  v_perm_b32 v194, v65, v64, s100
  v_perm_b32 v195, v67, v66, s100
  ds_read_b32 v106, v229 offset:29776
  v_perm_b32 v196, v69, v68, s100
  v_perm_b32 v197, v71, v70, s100
  ds_read_b32 v107, v229 offset:31128
  v_perm_b32 v198, v73, v72, s100
  v_perm_b32 v199, v75, v74, s100
  s_waitcnt vmcnt(8) lgkmcnt(0)
  s_barrier
  ds_read_b64_tr_b16 v[76:77], v225 offset:0
  ds_read_b64_tr_b16 v[78:79], v225 offset:5408
  ds_read_b64_tr_b16 v[80:81], v226 offset:0
  ds_read_b64_tr_b16 v[82:83], v227 offset:0
  ds_read_b64_tr_b16 v[84:85], v225 offset:64
  ds_read_b64_tr_b16 v[86:87], v225 offset:5472
  ds_read_b64_tr_b16 v[88:89], v226 offset:64
  ds_read_b64_tr_b16 v[90:91], v227 offset:64
  v_pk_maximum3_f16 v110, v92, v93, v110
  v_pk_minimum3_f16 v58, v92, v93, v58
  v_pk_maximum3_f16 v110, v94, v95, v110
  v_pk_minimum3_f16 v58, v94, v95, v58
  v_pk_maximum3_f16 v110, v96, v97, v110
  v_pk_minimum3_f16 v58, v96, v97, v58
  v_pk_maximum3_f16 v110, v98, v99, v110
  v_pk_minimum3_f16 v58, v98, v99, v58
  v_pk_maximum3_f16 v110, v100, v101, v110
  v_pk_minimum3_f16 v58, v100, v101, v58
  v_pk_maximum3_f16 v110, v102, v103, v110
  v_pk_minimum3_f16 v58, v102, v103, v58
  v_pk_maximum3_f16 v110, v104, v105, v110
  v_pk_minimum3_f16 v58, v104, v105, v58
  v_pk_maximum3_f16 v110, v106, v107, v110
  v_pk_minimum3_f16 v58, v106, v107, v58
  v_perm_b32 v60, v93, v92, s99
  v_perm_b32 v61, v95, v94, s99
  v_perm_b32 v62, v97, v96, s99
  v_perm_b32 v63, v99, v98, s99
  v_perm_b32 v64, v101, v100, s99
  v_perm_b32 v65, v103, v102, s99
  v_perm_b32 v66, v105, v104, s99
  v_perm_b32 v67, v107, v106, s99
  v_perm_b32 v68, v93, v92, s100
  v_perm_b32 v69, v95, v94, s100
  v_perm_b32 v70, v97, v96, s100
  v_perm_b32 v71, v99, v98, s100
  v_perm_b32 v72, v101, v100, s100
  v_perm_b32 v73, v103, v102, s100
  v_perm_b32 v74, v105, v104, s100
  v_perm_b32 v75, v107, v106, s100
  s_waitcnt lgkmcnt(7)
  v_pk_maximum3_f16 v111, v76, v77, 0
  v_pk_minimum3_f16 v28, v76, v77, 0
  s_waitcnt lgkmcnt(6)
  v_pk_maximum3_f16 v111, v78, v79, v111
  v_pk_minimum3_f16 v28, v78, v79, v28
  s_waitcnt lgkmcnt(5)
  v_pk_maximum3_f16 v111, v80, v81, v111
  v_pk_minimum3_f16 v28, v80, v81, v28
  s_waitcnt lgkmcnt(4)
  v_pk_maximum3_f16 v111, v82, v83, v111
  v_pk_minimum3_f16 v28, v82, v83, v28
  s_waitcnt lgkmcnt(3)
  v_pk_maximum3_f16 v111, v84, v85, v111
  v_pk_minimum3_f16 v28, v84, v85, v28
  s_waitcnt lgkmcnt(2)
  v_pk_maximum3_f16 v111, v86, v87, v111
  v_pk_minimum3_f16 v28, v86, v87, v28
  s_waitcnt lgkmcnt(1)
  v_pk_maximum3_f16 v111, v88, v89, v111
  v_pk_minimum3_f16 v28, v88, v89, v28
  s_waitcnt lgkmcnt(0)
  v_pk_maximum3_f16 v111, v90, v91, v111
  v_pk_minimum3_f16 v28, v90, v91, v28
  s_branch L_u1
L_u0:
  s_waitcnt lgkmcnt(0)
  s_barrier
  ds_read_b64_tr_b16 v[76:77], v225 offset:0
  ds_read_b64_tr_b16 v[78:79], v225 offset:5408
  ds_read_b64_tr_b16 v[80:81], v226 offset:0
  ds_read_b64_tr_b16 v[82:83], v227 offset:0
  ds_read_b64_tr_b16 v[84:85], v225 offset:64
  ds_read_b64_tr_b16 v[86:87], v225 offset:5472
  ds_read_b64_tr_b16 v[88:89], v226 offset:64
  ds_read_b64_tr_b16 v[90:91], v227 offset:64
  ds_read_b64_tr_b16 v[92:93], v225 offset:384
  ds_read_b64_tr_b16 v[94:95], v225 offset:5792
  ds_read_b64_tr_b16 v[96:97], v226 offset:384
  ds_read_b64_tr_b16 v[98:99], v227 offset:384
  ds_read_b64_tr_b16 v[100:101], v225 offset:448
  ds_read_b64_tr_b16 v[102:103], v225 offset:5856
  ds_read_b64_tr_b16 v[104:105], v226 offset:448
  ds_read_b64_tr_b16 v[106:107], v227 offset:448
  v_pk_maximum3_f16 v110, v60, v61, 0
  v_pk_minimum3_f16 v58, v60, v61, 0
  v_pk_maximum3_f16 v110, v62, v63, v110
  v_pk_minimum3_f16 v58, v62, v63, v58
  v_pk_maximum3_f16 v110, v64, v65, v110
  v_pk_minimum3_f16 v58, v64, v65, v58
  v_pk_maximum3_f16 v110, v66, v67, v110
  v_pk_minimum3_f16 v58, v66, v67, v58
  v_pk_maximum3_f16 v110, v68, v69, v110
  v_pk_minimum3_f16 v58, v68, v69, v58
  v_pk_maximum3_f16 v110, v70, v71, v110
  v_pk_minimum3_f16 v58, v70, v71, v58
  v_pk_maximum3_f16 v110, v72, v73, v110
  v_pk_minimum3_f16 v58, v72, v73, v58
  v_pk_maximum3_f16 v110, v74, v75, v110
  v_pk_minimum3_f16 v58, v74, v75, v58
  v_perm_b32 v184, v61, v60, s99
  v_perm_b32 v185, v63, v62, s99
  v_perm_b32 v186, v65, v64, s99
  v_perm_b32 v187, v67, v66, s99
  v_perm_b32 v188, v69, v68, s99
  v_perm_b32 v189, v71, v70, s99
  v_perm_b32 v190, v73, v72, s99
  v_perm_b32 v191, v75, v74, s99
  v_perm_b32 v192, v61, v60, s100
  v_perm_b32 v193, v63, v62, s100
  v_perm_b32 v194, v65, v64, s100
  v_perm_b32 v195, v67, v66, s100
  v_perm_b32 v196, v69, v68, s100
  v_perm_b32 v197, v71, v70, s100
  v_perm_b32 v198, v73, v72, s100
  v_perm_b32 v199, v75, v74, s100
  s_waitcnt lgkmcnt(14)
  v_pk_maximum3_f16 v111, v76, v77, 0
  v_pk_minimum3_f16 v28, v76, v77, 0
  v_pk_maximum3_f16 v111, v78, v79, v111
  v_pk_minimum3_f16 v28, v78, v79, v28
  s_waitcnt lgkmcnt(13)
  v_pk_maximum3_f16 v111, v80, v81, v111
  v_pk_minimum3_f16 v28, v80, v81, v28
  s_waitcnt lgkmcnt(12)
  v_pk_maximum3_f16 v111, v82, v83, v111
  v_pk_minimum3_f16 v28, v82, v83, v28
  s_waitcnt lgkmcnt(11)
  v_pk_maximum3_f16 v111, v84, v85, v111
  v_pk_minimum3_f16 v28, v84, v85, v28
  s_waitcnt lgkmcnt(10)
  v_pk_maximum3_f16 v111, v86, v87, v111
  v_pk_minimum3_f16 v28, v86, v87, v28
  s_waitcnt lgkmcnt(9)
  v_pk_maximum3_f16 v111, v88, v89, v111
  v_pk_minimum3_f16 v28, v88, v89, v28
  s_waitcnt lgkmcnt(8)
  v_pk_maximum3_f16 v111, v90, v91, v111
  v_pk_minimum3_f16 v28, v90, v91, v28
  s_waitcnt lgkmcnt(7)
  v_pk_maximum3_f16 v111, v92, v93, v111
  v_pk_minimum3_f16 v28, v92, v93, v28
  s_waitcnt lgkmcnt(6)
  v_pk_maximum3_f16 v111, v94, v95, v111
  v_pk_minimum3_f16 v28, v94, v95, v28
  s_waitcnt lgkmcnt(5)
  v_pk_maximum3_f16 v111, v96, v97, v111
  v_pk_minimum3_f16 v28, v96, v97, v28
  s_waitcnt lgkmcnt(4)
  v_pk_maximum3_f16 v111, v98, v99, v111
  v_pk_minimum3_f16 v28, v98, v99, v28
  s_waitcnt lgkmcnt(3)
  v_pk_maximum3_f16 v111, v100, v101, v111
  v_pk_minimum3_f16 v28, v100, v101, v28
  s_waitcnt lgkmcnt(2)
  v_pk_maximum3_f16 v111, v102, v103, v111
  v_pk_minimum3_f16 v28, v102, v103, v28
  s_waitcnt lgkmcnt(1)
  v_pk_maximum3_f16 v111, v104, v105, v111
  v_pk_minimum3_f16 v28, v104, v105, v28
  s_waitcnt lgkmcnt(0)
  v_pk_maximum3_f16 v111, v106, v107, v111
  v_pk_minimum3_f16 v28, v106, v107, v28
  v_add_u32 v248, 12288, v246
  v_add_u32 v249, 12288, v247
  s_cmp_lg_u32 s3, 7
  s_cbranch_scc1 L_u1
  s_mov_b32 exec_lo, 0xfffffff0
  s_mov_b32 exec_hi, 0xfffffff0
  v_mov_b32 v249, 1048576
  s_mov_b64 exec, -1
L_u1:
  ds_read_b64_tr_b16 v[112:113], v224 offset:0
  ds_read_b64_tr_b16 v[114:115], v224 offset:256
  ds_read_b64_tr_b16 v[116:117], v224 offset:1024
  ds_read_b64_tr_b16 v[118:119], v224 offset:1280
  v_and_b32 v28, 0x7fff7fff, v28
  v_and_b32 v58, 0x7fff7fff, v58
  v_and_b32 v111, 0x7fff7fff, v111
  v_and_b32 v110, 0x7fff7fff, v110
  v_pk_max_u16 v111, v111, v28
  v_pk_max_u16 v110, v110, v58
  v_lshlrev_b32 v28, 16, v111
  v_lshlrev_b32 v58, 16, v110
  v_max_u32 v111, v111, v28
  v_max_u32 v110, v110, v58
  s_nop 1
  v_permlane32_swap_b32 v111, v110
  v_max_u32_e64 v111, v111, v110
  s_nop 1
  v_max_u32_dpp v111, v111, v111 row_shr:1 row_mask:0xf bank_mask:0xf
  s_nop 1
  v_max_u32_dpp v111, v111, v111 row_shr:2 row_mask:0xf bank_mask:0xf
  s_nop 1
  v_max_u32_dpp v111, v111, v111 row_shr:4 row_mask:0xf bank_mask:0xf
  s_nop 1
  v_max_u32_dpp v111, v111, v111 row_shr:8 row_mask:0xf bank_mask:0xf
  s_nop 1
  v_max_u32_dpp v111, v111, v111 row_bcast:15 row_mask:0xa bank_mask:0xf
  s_mov_b32 exec_lo, 0x80000000
  s_mov_b32 exec_hi, 0x80000000
  ds_max_u32 v3, v111 offset:16
  s_mov_b64 exec, -1
  s_setprio 0
  s_waitcnt lgkmcnt(0)
  s_barrier
  ds_read_b128 v[108:111], v2 offset:16
  s_waitcnt lgkmcnt(0)
  v_lshrrev_b32 v108, 23, v108
  v_lshrrev_b32 v109, 23, v109
  v_sub_u32 v108, 267, v108
  v_lshrrev_b32 v110, 23, v110
  v_min_u32 v108, 167, v108
  v_lshrrev_b32 v111, 23, v111
  v_readfirstlane_b32 s74, v108
  v_mul_u32_u24 v108, 0x800080, v108
  v_and_b32 v216, v216, v108
  v_and_b32 v217, v217, v108
  v_and_b32 v218, v218, v108
  v_and_b32 v219, v219, v108
  v_and_b32 v220, v220, v108
  v_and_b32 v221, v221, v108
  v_and_b32 v222, v222, v108
  v_and_b32 v223, v223, v108
  v_mfma_f32_32x32x16_bf16 v[152:167], v[216:219], v[76:79], 0
  s_mov_b32 vcc_lo, 0x4000000
  s_mov_b32 vcc_hi, 0x4000000
  v_cndmask_b32 v250, v110, v111, vcc
  v_mfma_f32_32x32x16_bf16 v[152:167], v[220:223], v[80:83], v[152:167]
  v_add_u32_e64 v250, v250, v109
  v_sub_u32 v250, 388, v250
  s_movk_i32 s98, 167
  v_mfma_f32_32x32x16_bf16 v[168:183], v[216:219], v[84:87], 0
  v_med3_i32 v250, v250, 1, s98
  v_subrev_u32 v110, 127, v250
  v_lshlrev_b32 v250, 23, v250
  v_mfma_f32_32x32x16_bf16 v[168:183], v[220:223], v[88:91], v[168:183]
  v_cmp_gt_i32 vcc, 0, v110
  v_mul_u32_u24 v110, 0x800080, v110
  s_cbranch_vccnz L_sdown
  v_add_u32 v112, v112, v110
  v_add_u32 v113, v113, v110
  v_add_u32 v114, v114, v110
  v_add_u32 v115, v115, v110
  v_add_u32 v116, v116, v110
  v_add_u32 v117, v117, v110
  v_add_u32 v118, v118, v110
  v_add_u32 v119, v119, v110
L_scaled:
  v_mfma_f32_32x32x16_bf16 v[120:135], v[184:187], v[112:115], 0
  v_cvt_pk_f16_f32 v152, v152, v153
  v_cvt_pk_f16_f32 v153, v154, v155
  v_cvt_pk_f16_f32 v154, v156, v157
  v_cvt_pk_f16_f32 v155, v158, v159
  ds_write_b128 v246, v[152:155]
  v_xor_b32 v246, 16, v246
  v_mfma_f32_32x32x16_bf16 v[120:135], v[188:191], v[116:119], v[120:135]
  v_cvt_pk_f16_f32 v156, v160, v161
  v_cvt_pk_f16_f32 v157, v162, v163
  v_cvt_pk_f16_f32 v158, v164, v165
  v_cvt_pk_f16_f32 v159, v166, v167
  ds_write_b128 v246, v[156:159]
  v_mfma_f32_32x32x16_bf16 v[136:151], v[192:195], v[112:115], 0
  v_cvt_pk_f16_f32 v168, v168, v169
  v_cvt_pk_f16_f32 v169, v170, v171
  v_cvt_pk_f16_f32 v170, v172, v173
  v_cvt_pk_f16_f32 v171, v174, v175
  ds_write_b128 v247, v[168:171]
  v_xor_b32_e64 v247, 16, v247
  v_mfma_f32_32x32x16_bf16 v[136:151], v[196:199], v[116:119], v[136:151]
  v_cvt_pk_f16_f32 v172, v176, v177
  v_cvt_pk_f16_f32 v173, v178, v179
  v_cvt_pk_f16_f32 v174, v180, v181
  v_cvt_pk_f16_f32 v175, v182, v183
  ds_write_b128 v247, v[172:175]
  s_cmp_ge_u32 s3, 5
  s_cbranch_scc1 L_u2
  v_mfma_f32_32x32x16_bf16 v[184:199], v[60:63], v[112:115], 0
  v_mfma_f32_32x32x16_bf16 v[184:199], v[64:67], v[116:119], v[184:199]
  v_mfma_f32_32x32x16_bf16 v[200:215], v[68:71], v[112:115], 0
  v_mfma_f32_32x32x16_bf16 v[200:215], v[72:75], v[116:119], v[200:215]
  s_branch L_u3
L_u2:
  v_mfma_f32_32x32x16_bf16 v[184:199], v[216:219], v[92:95], 0
  v_mfma_f32_32x32x16_bf16 v[184:199], v[220:223], v[96:99], v[184:199]
  v_mfma_f32_32x32x16_bf16 v[200:215], v[216:219], v[100:103], 0
  v_mfma_f32_32x32x16_bf16 v[200:215], v[220:223], v[104:107], v[200:215]
L_u3:
  v_cvt_pk_f16_f32 v120, v120, v121
  v_cvt_pk_f16_f32 v121, v122, v123
  v_cvt_pk_f16_f32 v122, v124, v125
  v_cvt_pk_f16_f32 v123, v126, v127
  ds_write_b128 v244, v[120:123]
  v_xor_b32 v244, 16, v244
  v_cvt_pk_f16_f32 v124, v128, v129
  v_cvt_pk_f16_f32 v125, v130, v131
  v_cvt_pk_f16_f32 v126, v132, v133
  v_cvt_pk_f16_f32 v127, v134, v135
  ds_write_b128 v244, v[124:127]
  v_cvt_pk_f16_f32 v136, v136, v137
  v_cvt_pk_f16_f32 v137, v138, v139
  v_cvt_pk_f16_f32 v138, v140, v141
  v_cvt_pk_f16_f32 v139, v142, v143
  ds_write_b128 v245, v[136:139]
  v_xor_b32_e64 v245, 16, v245
  v_cvt_pk_f16_f32 v140, v144, v145
  v_cvt_pk_f16_f32 v141, v146, v147
  v_cvt_pk_f16_f32 v142, v148, v149
  v_cvt_pk_f16_f32 v143, v150, v151
  ds_write_b128 v245, v[140:143]
  v_cvt_pk_f16_f32 v184, v184, v185
  v_cvt_pk_f16_f32 v185, v186, v187
  v_cvt_pk_f16_f32 v186, v188, v189
  v_cvt_pk_f16_f32 v187, v190, v191
  ds_write_b128 v248, v[184:187]
  v_xor_b32_e64 v248, 16, v248
  v_cvt_pk_f16_f32 v188, v192, v193
  v_cvt_pk_f16_f32 v189, v194, v195
  v_cvt_pk_f16_f32 v190, v196, v197
  v_cvt_pk_f16_f32 v191, v198, v199
  ds_write_b128 v248, v[188:191]
  v_cvt_pk_f16_f32 v200, v200, v201
  v_cvt_pk_f16_f32 v201, v202, v203
  v_cvt_pk_f16_f32 v202, v204, v205
  v_cvt_pk_f16_f32 v203, v206, v207
  ds_write_b128 v249, v[200:203]
  v_xor_b32_e64 v249, 16, v249
  v_cvt_pk_f16_f32 v204, v208, v209
  v_cvt_pk_f16_f32 v205, v210, v211
  v_cvt_pk_f16_f32 v206, v212, v213
  v_cvt_pk_f16_f32 v207, v214, v215
  ds_write_b128 v249, v[204:207]
  v_readlane_b32 s0, v250, 0
  v_readlane_b32 s1, v250, 26
  s_sub_u32 s75, 0x7f000000, s0
  s_sub_u32 s1, 0x7f000000, s1
  s_sub_u32 s74, 254, s74
  s_lshl_b32 s74, s74, 23
  s_mov_b32 s92, 0x88888888
  s_mov_b32 s93, 0x88888888
  s_mul_i32 s68, s3, 384
  v_lshrrev_b32 v29, 2, v0
  v_mul_u32_u24 v29, 24, v29
  v_add_u32 v29, s68, v29
  v_and_b32 v30, 3, v0
  v_lshlrev_b32 v30, 3, v30
  ds_read_b64 v[152:153], v29 offset:2048
  ds_read_b64 v[154:155], v29 offset:2056
  ds_read_b64 v[156:157], v29 offset:2064
  buffer_load_dwordx4 v[16:19], v6, s[28:31], s94 offen
  s_add_u32 s94, s94, 416
  buffer_load_dwordx4 v[216:219], v6, s[28:31], s94 offen
  s_add_u32 s94, s94, 416
  s_waitcnt lgkmcnt(2)
  v_xor_b32 v152, v152, v30
  v_xor_b32 v158, 32, v152
  v_xor_b32 v153, v153, v30
  v_xor_b32 v159, 32, v153
  s_waitcnt lgkmcnt(1)
  v_xor_b32 v154, v154, v30
  v_xor_b32 v160, 32, v154
  v_xor_b32 v155, v155, v30
  v_xor_b32 v161, 32, v155
  s_waitcnt lgkmcnt(0)
  v_xor_b32 v156, v156, v30
  v_xor_b32 v162, 32, v156
  v_xor_b32 v157, v157, v30
  v_xor_b32_e64 v163, 32, v157
  s_waitcnt lgkmcnt(0)
  s_barrier
  ds_read_b64_tr_b16 v[60:61], v152 offset:0
  ds_read_b64_tr_b16 v[62:63], v153 offset:0
  ds_read_b64_tr_b16 v[64:65], v158 offset:0
  ds_read_b64_tr_b16 v[66:67], v159 offset:0
  ds_read_b64_tr_b16 v[68:69], v152 offset:43328
  ds_read_b64_tr_b16 v[70:71], v153 offset:43328
  ds_read_b64_tr_b16 v[72:73], v158 offset:43328
  ds_read_b64_tr_b16 v[74:75], v159 offset:43328
  ds_read_b64_tr_b16 v[76:77], v154 offset:0
  ds_read_b64_tr_b16 v[78:79], v155 offset:0
  ds_read_b64_tr_b16 v[80:81], v160 offset:0
  ds_read_b64_tr_b16 v[82:83], v161 offset:0
  ds_read_b64_tr_b16 v[84:85], v154 offset:43328
  ds_read_b64_tr_b16 v[86:87], v155 offset:43328
  ds_read_b64_tr_b16 v[88:89], v160 offset:43328
  ds_read_b64_tr_b16 v[90:91], v161 offset:43328
  s_cmp_ge_u32 s3, 6
  s_cbranch_scc1 L_lin
  ds_read_b64_tr_b16 v[92:93], v156 offset:0
  ds_read_b64_tr_b16 v[94:95], v157 offset:0
  ds_read_b64_tr_b16 v[96:97], v162 offset:0
  ds_read_b64_tr_b16 v[98:99], v163 offset:0
  ds_read_b64_tr_b16 v[100:101], v156 offset:43328
  ds_read_b64_tr_b16 v[102:103], v157 offset:43328
  ds_read_b64_tr_b16 v[104:105], v162 offset:43328
  ds_read_b64_tr_b16 v[106:107], v163 offset:43328
  s_waitcnt lgkmcnt(6)
  v_pk_add_f16 v92, v92, v94
  v_pk_add_f16 v93, v93, v95
  ds_write_b64 v59, v[92:93] offset:30720
  s_waitcnt lgkmcnt(5)
  v_pk_add_f16 v96, v96, v98
  v_pk_add_f16 v97, v97, v99
  s_waitcnt lgkmcnt(3)
  v_pk_add_f16 v100, v100, v102
  v_pk_add_f16 v101, v101, v103
  ds_write_b64 v59, v[100:101] offset:32768
  s_waitcnt lgkmcnt(2)
  v_pk_add_f16 v104, v104, v106
  v_pk_add_f16 v105, v105, v107
  v_cndmask_b32 v96, v96, v104, s[92:93]
  v_cndmask_b32 v97, v97, v105, s[92:93]
  ds_write_b64 v59, v[96:97] offset:31744
  ds_write_b32 v230, v104 offset:3072
  ds_write_b32 v230, v105 offset:3088
  s_branch L_p2
L_lin:
  s_and_b32 s98, s3, 1
  s_cselect_b64 vcc, -1, 0
  s_lshl_b32 s99, s98, 5
  v_mov_b32 v31, 0
  v_xor_b32 v236, s99, v236
  v_xor_b32 v237, s99, v237
  v_cndmask_b32 v238, v238, v239, vcc
  ds_read_b64_tr_b16 v[92:93], v236
  ds_read_b64_tr_b16 v[94:95], v237
  ds_read_u16_d16_hi v31, v238
  s_lshl_b32 s98, s98, 10
  v_add_u32 v29, s98, v1
  s_waitcnt lgkmcnt(2)
  v_cvt_f32_f16 v96, v92
  v_cvt_f32_f16_sdwa v97, v92 dst_sel:DWORD dst_unused:UNUSED_PAD src0_sel:WORD_1
  v_mul_f32 v96, s1, v96
  v_mul_f32 v97, s1, v97
  v_mul_f32 v96, s0, v96
  v_mul_f32 v97, s0, v97
  v_cvt_pk_bf16_f32 v92, v96, v97
  v_cvt_f32_f16 v98, v93
  v_cvt_f32_f16_sdwa v99, v93 dst_sel:DWORD dst_unused:UNUSED_PAD src0_sel:WORD_1
  v_mul_f32 v98, s1, v98
  v_mul_f32 v99, s1, v99
  v_mul_f32 v98, s0, v98
  v_mul_f32 v99, s0, v99
  v_cvt_pk_bf16_f32 v93, v98, v99
  s_waitcnt lgkmcnt(1)
  v_cvt_f32_f16 v100, v94
  v_cvt_f32_f16_sdwa v101, v94 dst_sel:DWORD dst_unused:UNUSED_PAD src0_sel:WORD_1
  v_mul_f32 v100, s1, v100
  v_mul_f32 v101, s1, v101
  v_mul_f32 v100, s0, v100
  v_mul_f32 v101, s0, v101
  v_cvt_pk_bf16_f32 v94, v100, v101
  v_cvt_f32_f16 v102, v95
  v_cvt_f32_f16_sdwa v103, v95 dst_sel:DWORD dst_unused:UNUSED_PAD src0_sel:WORD_1
  v_mul_f32 v102, s1, v102
  v_mul_f32 v103, s1, v103
  s_mov_b32 exec_lo, 0
  s_mov_b32 exec_hi, 0xffff
  s_waitcnt lgkmcnt(0)
  v_mov_b32 v102, v31
  s_mov_b64 exec, -1
  v_mul_f32 v102, s0, v102
  v_mul_f32 v103, s0, v103
  v_cvt_pk_bf16_f32 v95, v102, v103
  ds_write_b128 v29, v[92:95] offset:39936
L_p2:
  v_pk_add_f16 v76, v76, v78
  v_pk_add_f16 v77, v77, v79
  ds_write_b64 v59, v[76:77] offset:18432
  v_pk_add_f16 v80, v80, v82
  v_pk_add_f16 v81, v81, v83
  v_pk_add_f16 v84, v84, v86
  v_pk_add_f16 v85, v85, v87
  ds_write_b64 v59, v[84:85] offset:20480
  v_pk_add_f16 v88, v88, v90
  v_pk_add_f16 v89, v89, v91
  v_cndmask_b32 v80, v80, v88, s[92:93]
  v_cndmask_b32 v81, v81, v89, s[92:93]
  ds_write_b64 v59, v[80:81] offset:19456
  ds_write_b32 v230, v88 offset:1024
  ds_write_b32 v230, v89 offset:1040
  v_pk_add_f16 v60, v60, v62
  v_pk_add_f16 v61, v61, v63
  ds_write_b64 v59, v[60:61] offset:6144
  v_pk_add_f16 v64, v64, v66
  v_pk_add_f16 v65, v65, v67
  v_pk_add_f16 v68, v68, v70
  v_pk_add_f16 v69, v69, v71
  ds_write_b64 v59, v[68:69] offset:8192
  v_pk_add_f16 v72, v72, v74
  v_pk_add_f16 v73, v73, v75
  v_cndmask_b32 v64, v64, v72, s[92:93]
  v_cndmask_b32 v65, v65, v73, s[92:93]
  ds_write_b64 v59, v[64:65] offset:7168
  s_cmp_lt_u32 s3, 2
  s_cbranch_scc1 L_p2d
  v_subrev_u32 v230, 1024, v230
  ds_write_b32 v230, v72 offset:0
  ds_write_b32 v230, v73 offset:16
  s_branch L_built
L_p2d:
  ds_write_b64 v231, v[72:73] offset:5120
L_built:
  s_mov_b32 s0, s74
  s_mov_b32 s1, s75
  s_mov_b32 s96, 0x3e000000
  s_mov_b32 s97, 0x43000000
  s_mov_b32 s51, 1
  s_mul_i32 s98, s3, 1536
  s_add_u32 s98, s98, 1165312
  s_mov_b32 s48, -1048576
  s_cmp_lg_u32 s84, 0
  s_cbranch_scc1 L_g1c
  s_sub_u32 s94, s94, 416
  s_waitcnt vmcnt(2)
  ds_read_u16_d16_hi v32, v10 offset:0
  ds_read_u16_d16_hi v33, v10 offset:2
  ds_read_u16_d16_hi v34, v10 offset:2112
  ds_read_u16_d16_hi v35, v10 offset:2114
  ds_read_u16_d16_hi v36, v10 offset:128
  ds_read_u16_d16_hi v37, v10 offset:130
  ds_read_u16_d16_hi v38, v10 offset:2240
  ds_read_u16_d16_hi v39, v10 offset:2242
  ds_read_u16_d16_hi v40, v10 offset:256
  ds_read_u16_d16_hi v41, v10 offset:258
  ds_read_u16_d16_hi v42, v10 offset:2368
  ds_read_u16_d16_hi v43, v10 offset:2370
  ds_read_u16_d16_hi v44, v10 offset:384
  ds_read_u16_d16_hi v45, v10 offset:386
  ds_read_u16_d16_hi v46, v10 offset:2496
  ds_read_u16_d16_hi v47, v10 offset:2498
  ds_read_u16_d16_hi v48, v10 offset:512
  ds_read_u16_d16_hi v49, v10 offset:514
  ds_read_u16_d16_hi v50, v10 offset:2624
  ds_read_u16_d16_hi v51, v10 offset:2626
  ds_read_u16_d16_hi v52, v10 offset:640
  ds_read_u16_d16_hi v53, v10 offset:642
  ds_read_u16_d16_hi v54, v10 offset:2752
  ds_read_u16_d16_hi v55, v10 offset:2754
  ds_read_u16_d16_hi v56, v10 offset:768
  ds_read_u16_d16_hi v57, v10 offset:770
  s_waitcnt lgkmcnt(14)
  v_max3_f32 v58, |v32|, |v33|, 0
  v_cvt_pk_f16_f32 v184, v32, v33
  v_max3_f32 v58, |v34|, |v35|, v58
  v_cvt_pk_f16_f32 v185, v34, v35
  v_max3_f32 v58, |v36|, |v37|, v58
  v_cvt_pk_f16_f32 v186, v36, v37
  v_max3_f32 v58, |v38|, |v39|, v58
  v_cvt_pk_f16_f32 v187, v38, v39
  v_max3_f32 v58, |v40|, |v41|, v58
  v_cvt_pk_f16_f32 v188, v40, v41
  v_max3_f32 v58, |v42|, |v43|, v58
  v_cvt_pk_f16_f32 v189, v42, v43
  s_waitcnt lgkmcnt(12)
  v_max3_f32 v58, |v44|, |v45|, v58
  v_cvt_pk_f16_f32 v190, v44, v45
  s_waitcnt lgkmcnt(10)
  v_max3_f32 v58, |v46|, |v47|, v58
  v_cvt_pk_f16_f32 v191, v46, v47
  s_waitcnt lgkmcnt(8)
  v_max3_f32 v58, |v48|, |v49|, v58
  v_cvt_pk_f16_f32 v192, v48, v49
  s_waitcnt lgkmcnt(6)
  v_max3_f32 v58, |v50|, |v51|, v58
  v_cvt_pk_f16_f32 v193, v50, v51
  s_waitcnt lgkmcnt(4)
  v_max3_f32 v58, |v52|, |v53|, v58
  v_cvt_pk_f16_f32 v194, v52, v53
  s_waitcnt lgkmcnt(2)
  v_max3_f32 v58, |v54|, |v55|, v58
  v_cvt_pk_f16_f32 v195, v54, v55
  s_waitcnt lgkmcnt(0)
  v_max3_f32 v58, |v56|, |v57|, v58
  v_cvt_pk_f16_f32 v196, v56, v57
  s_waitcnt lgkmcnt(0)
  s_barrier
  s_branch L_cin_go
L_g1c:
  s_waitcnt lgkmcnt(0)
  s_barrier
  s_add_u32 s76, s76, -63168
  s_waitcnt vmcnt(1)
  v_lshl_add_u32 v16, v16, 7, v8
  v_lshl_add_u32 v17, v17, 7, v8
  v_lshl_add_u32 v18, v18, 7, v8
  v_lshl_add_u32 v19, v19, 7, v8
  s_add_u32 m0, s76, 0
  s_mov_b32 exec_hi, 0xffffff
  buffer_load_dwordx4 v16, s[32:35], 0 offen lds
  s_add_u32 m0, s76, 1056
  s_nop 0
  buffer_load_dwordx4 v17, s[32:35], 0 offen lds
  s_add_u32 m0, s76, 2112
  s_mov_b32 exec_hi, 0xffff
  buffer_load_dwordx4 v18, s[32:35], 0 offen lds
  s_add_u32 m0, s76, 3168
  s_nop 0
  buffer_load_dwordx4 v19, s[32:35], 0 offen lds
  s_mov_b32 exec_hi, -1
  s_waitcnt vmcnt(4)
  v_lshl_add_u32 v216, v216, 7, v8
  v_lshl_add_u32 v217, v217, 7, v8
  v_lshl_add_u32 v218, v218, 7, v8
  v_lshl_add_u32 v219, v219, 7, v8
  s_add_u32 m0, s76, 16256
  s_mov_b32 exec_hi, 0xffffff
  buffer_load_dwordx4 v216, s[32:35], 0 offen lds
  s_add_u32 m0, s76, 17312
  s_nop 0
  buffer_load_dwordx4 v217, s[32:35], 0 offen lds
  s_add_u32 m0, s76, 18368
  s_mov_b32 exec_hi, 0xffff
  buffer_load_dwordx4 v218, s[32:35], 0 offen lds
  s_add_u32 m0, s76, 19424
  s_nop 0
  buffer_load_dwordx4 v219, s[32:35], 0 offen lds
  s_mov_b32 exec_hi, -1
  buffer_load_dwordx4 v[16:19], v6, s[28:31], s94 offen
  s_add_u32 s94, s94, 416
  v_add_u32 v10, -63168, v10
  v_add_u32 v4, -63168, v4
  v_add_u32 v5, -63168, v5
  ds_write_b32 v10, v7 offset:2880
  ds_write_b32 v10, v7 offset:19136
  s_cmp_lg_u32 s3, 4
  s_cbranch_scc1 L_g1d
  s_mov_b32 s60, s24
  s_and_b32 s61, s25, 0xffff
  s_mov_b32 s62, 268435456
  s_mov_b32 s63, 0x20000
  s_mov_b32 s56, s20
  s_and_b32 s57, s21, 0xffff
  s_mov_b32 s58, 8192
  s_mov_b32 s59, 0x20000
  s_mov_b32 s64, s22
  s_and_b32 s65, s23, 0xffff
  s_mov_b32 s66, 256
  s_mov_b32 s67, 0x20000
  s_load_dword s80, s[18:19], 0
  v_mov_b32 v248, 0
  s_mov_b64 exec, 1
  s_mov_b32 s81, 0x80000
  buffer_load_dword v249, v248, s[60:63], s81 offen
  buffer_load_dword v250, v248, s[56:59], 0 offen
  s_mov_b64 exec, -1
  s_mov_b64 exec, 1
  buffer_load_dword v59, v248, s[64:67], 0 offen offset:240 sc1
  s_mov_b64 exec, -1
  s_mov_b32 s52, s16
  s_and_b32 s53, s17, 0xffff
  s_mov_b32 s54, 3328
  s_mov_b32 s55, 0x20000
  v_lshlrev_b32_e64 v248, 7, v0
  buffer_load_dword v251, v248, s[52:55], 0 offen
  s_mul_i32 s69, s26, 192
  s_add_u32 s69, s69, 216320
  v_lshlrev_b32 v248, 2, v0
  s_waitcnt vmcnt(3)
  v_mov_b32_e64 v249, -1
  s_mov_b32 exec_hi, 0xffff
  buffer_store_dword v249, v248, s[60:63], s69 offen sc1
  s_mov_b32 exec_hi, -1
L_g1d:
  s_waitcnt vmcnt(5)
  ds_read_u16_d16_hi v32, v10 offset:0
  ds_read_u16_d16_hi v33, v10 offset:2
  ds_read_u16_d16_hi v34, v10 offset:2112
  ds_read_u16_d16_hi v35, v10 offset:2114
  ds_read_u16_d16_hi v36, v10 offset:128
  ds_read_u16_d16_hi v37, v10 offset:130
  ds_read_u16_d16_hi v38, v10 offset:2240
  ds_read_u16_d16_hi v39, v10 offset:2242
  ds_read_u16_d16_hi v40, v10 offset:256
  ds_read_u16_d16_hi v41, v10 offset:258
  ds_read_u16_d16_hi v42, v10 offset:2368
  ds_read_u16_d16_hi v43, v10 offset:2370
  ds_read_u16_d16_hi v44, v10 offset:384
  ds_read_u16_d16_hi v45, v10 offset:386
  ds_read_u16_d16_hi v46, v10 offset:2496
  ds_read_u16_d16_hi v47, v10 offset:2498
  ds_read_u16_d16_hi v48, v10 offset:512
  ds_read_u16_d16_hi v49, v10 offset:514
  ds_read_u16_d16_hi v50, v10 offset:2624
  ds_read_u16_d16_hi v51, v10 offset:2626
  ds_read_u16_d16_hi v52, v10 offset:640
  ds_read_u16_d16_hi v53, v10 offset:642
  ds_read_u16_d16_hi v54, v10 offset:2752
  ds_read_u16_d16_hi v55, v10 offset:2754
  ds_read_u16_d16_hi v56, v10 offset:768
  ds_read_u16_d16_hi v57, v10 offset:770
  s_waitcnt lgkmcnt(0)
  v_max3_f32 v58, |v32|, |v33|, 0
  v_cvt_pk_f16_f32 v184, v32, v33
  v_max3_f32 v58, |v34|, |v35|, v58
  v_cvt_pk_f16_f32 v185, v34, v35
  v_max3_f32 v58, |v36|, |v37|, v58
  v_cvt_pk_f16_f32 v186, v36, v37
  v_max3_f32 v58, |v38|, |v39|, v58
  v_cvt_pk_f16_f32 v187, v38, v39
  v_max3_f32 v58, |v40|, |v41|, v58
  v_cvt_pk_f16_f32 v188, v40, v41
  v_max3_f32 v58, |v42|, |v43|, v58
  v_cvt_pk_f16_f32 v189, v42, v43
  s_waitcnt lgkmcnt(12)
  v_max3_f32 v58, |v44|, |v45|, v58
  v_cvt_pk_f16_f32 v190, v44, v45
  s_waitcnt lgkmcnt(10)
  v_max3_f32 v58, |v46|, |v47|, v58
  v_cvt_pk_f16_f32 v191, v46, v47
  s_waitcnt lgkmcnt(8)
  v_max3_f32 v58, |v48|, |v49|, v58
  v_cvt_pk_f16_f32 v192, v48, v49
  s_waitcnt lgkmcnt(6)
  v_max3_f32 v58, |v50|, |v51|, v58
  v_cvt_pk_f16_f32 v193, v50, v51
  s_waitcnt lgkmcnt(4)
  v_max3_f32 v58, |v52|, |v53|, v58
  v_cvt_pk_f16_f32 v194, v52, v53
  s_waitcnt lgkmcnt(2)
  v_max3_f32 v58, |v54|, |v55|, v58
  v_cvt_pk_f16_f32 v195, v54, v55
  s_waitcnt lgkmcnt(0)
  v_max3_f32 v58, |v56|, |v57|, v58
  v_cvt_pk_f16_f32 v196, v56, v57
L_cin_go:
  ds_write_b32 v11, v184 offset:0
  ds_write_b32 v11, v185 offset:160
  ds_write_b32 v11, v186 offset:320
  ds_write_b32 v11, v187 offset:480
  ds_write_b32 v11, v188 offset:640
  ds_write_b32 v11, v189 offset:800
  ds_write_b32 v11, v190 offset:960
  ds_write_b32 v11, v191 offset:1120
  ds_write_b32 v11, v192 offset:1280
  ds_write_b32 v11, v193 offset:1440
  ds_write_b32 v11, v194 offset:1600
  ds_write_b32 v11, v195 offset:1760
  ds_write_b32 v11, v196 offset:1920
  s_mov_b32 s81, 16256
  s_add_u32 s76, s76, 16256
  v_lshlrev_b32 v7, 2, v0
  v_add_u32 v7, s98, v7
L_cin_loop:
  v_cmp_le_f32 s[90:91], s97, v58
  v_cmp_le_f32 vcc, s96, v58
  s_mov_b32 s49, s74
  s_mov_b32 s50, s75
  s_cmp_lg_u64 s[90:91], 0
  s_cbranch_scc1 L_cslow
  s_cbranch_vccz L_cslow
L_cconv:
  ds_read_b64_tr_b16 v[60:61], v20 offset:0
  v_mul_f32 v116, v184, v192
  v_mul_f32 v117, v185, v193
  ds_read_b64_tr_b16 v[74:75], v20 offset:32
  v_mul_f32 v118, v186, v194
  ds_read_b64_tr_b16 v[88:89], v20 offset:64
  v_mul_f32 v119, v187, v195
  ds_read_b64_tr_b16 v[102:103], v20 offset:96
  v_fmac_f32 v116, v188, v191
  ds_read_b64_tr_b16 v[66:67], v23 offset:0
  v_fmac_f32 v117, v200, v208
  ds_read_b64_tr_b16 v[80:81], v23 offset:32
  v_fmac_f32 v118, v201, v209
  ds_read_b64_tr_b16 v[94:95], v23 offset:64
  v_fmac_f32 v119, v202, v210
  ds_read_b64_tr_b16 v[108:109], v23 offset:96
  v_fmac_f32_e64 v116, v203, v211
  ds_read_b64_tr_b16 v[68:69], v24 offset:0
  v_fmac_f32 v117, v204, v207
  ds_read_b64_tr_b16 v[82:83], v24 offset:32
  s_waitcnt vmcnt(0)
  v_fmac_f32 v118, v216, v224
  ds_read_b64_tr_b16 v[96:97], v24 offset:64
  v_fmac_f32 v119, v217, v225
  v_fmac_f32 v116, v218, v226
  ds_read_b64_tr_b16 v[110:111], v24 offset:96
  v_fmac_f32 v117, v219, v227
  ds_read_b64_tr_b16 v[124:125], v4 offset:0
  v_fmac_f32 v118, v220, v223
  ds_read_b64_tr_b16 v[126:127], v5 offset:0
  v_fmac_f32 v119, v232, v240
  ds_read_b64_tr_b16 v[136:137], v4 offset:32
  v_fmac_f32 v116, v233, v241
  ds_read_b64_tr_b16 v[138:139], v5 offset:32
  v_fmac_f32 v117, v234, v242
  ds_read_b64_tr_b16 v[148:149], v4 offset:64
  v_fmac_f32 v118, v235, v243
  ds_read_b64_tr_b16 v[150:151], v5 offset:64
  v_fmac_f32 v119, v236, v239
  ds_read_b64_tr_b16 v[160:161], v4 offset:96
  v_fmac_f32 v116, v189, v196
  ds_read_b64_tr_b16 v[162:163], v5 offset:96
  v_fmac_f32 v117, v189, v197
  ds_read_b128 v[164:167], v1 offset:39936
  v_fmac_f32 v118, v190, v198
  v_fmac_f32 v119, v190, v199
  ds_read_b128 v[168:171], v1 offset:40960
  v_fmac_f32 v116, v205, v212
  ds_read_b128 v[172:175], v1 offset:8192
  v_fmac_f32 v117, v205, v213
  ds_read_b128 v[176:179], v1 offset:6144
  v_fmac_f32 v118, v206, v214
  ds_read_b64_tr_b16 v[70:71], v25 offset:0
  v_fmac_f32 v119, v206, v215
  ds_read_b64_tr_b16 v[84:85], v25 offset:32
  v_fmac_f32 v116, v221, v228
  ds_read_b64_tr_b16 v[98:99], v25 offset:64
  v_fmac_f32 v117, v221, v229
  ds_read_b64_tr_b16 v[112:113], v25 offset:96
  v_fmac_f32_e64 v118, v222, v230
  ds_read_b64_tr_b16 v[72:73], v26 offset:0
  v_fmac_f32 v119, v222, v231
  ds_read_b64_tr_b16 v[86:87], v26 offset:32
  v_fmac_f32 v116, v237, v244
  ds_read_b64_tr_b16 v[100:101], v26 offset:64
  v_fmac_f32 v117, v237, v245
  v_fmac_f32 v118, v238, v246
  ds_read_b64_tr_b16 v[114:115], v26 offset:96
  v_fmac_f32 v119, v238, v247
  ds_read_b64_tr_b16 v[62:63], v21 offset:0
  v_add_f32 v116, v116, v117
  ds_read_b64_tr_b16 v[76:77], v21 offset:32
  v_add_f32 v118, v118, v119
  ds_read_b64_tr_b16 v[90:91], v21 offset:64
  v_add_f32 v116, v116, v118
  ds_read_b64_tr_b16 v[104:105], v21 offset:96
  v_mul_f32 v116, s49, v116
  ds_read_b64_tr_b16 v[64:65], v22 offset:0
  v_mul_f32 v116, s50, v116
  ds_read_b64_tr_b16 v[78:79], v22 offset:32
  ds_write_b32 v7, v116
  ds_read_b64_tr_b16 v[92:93], v22 offset:64
  v_add_u32_e64 v7, s48, v7
  ds_read_b64_tr_b16 v[106:107], v22 offset:96
  s_movk_i32 s48, 256
  s_waitcnt lgkmcnt(14)
  v_pk_mul_f16 v120, v60, v67 op_sel:[0,0] op_sel_hi:[0,1]
  v_pk_mul_f16 v121, v60, v67 op_sel:[1,0] op_sel_hi:[1,1]
  v_pk_mul_f16 v122, v60, v68 op_sel:[0,0] op_sel_hi:[0,1]
  v_pk_mul_f16 v123, v60, v68 op_sel:[1,0] op_sel_hi:[1,1]
  v_pk_mul_f16 v132, v74, v81 op_sel:[0,0] op_sel_hi:[0,1]
  v_pk_mul_f16 v133, v74, v81 op_sel:[1,0] op_sel_hi:[1,1]
  v_pk_mul_f16 v134, v74, v82 op_sel:[0,0] op_sel_hi:[0,1]
  v_pk_mul_f16 v135, v74, v82 op_sel:[1,0] op_sel_hi:[1,1]
  v_pk_mul_f16 v144, v88, v95 op_sel:[0,0] op_sel_hi:[0,1]
  v_pk_mul_f16 v145, v88, v95 op_sel:[1,0] op_sel_hi:[1,1]
  v_pk_mul_f16 v146, v88, v96 op_sel:[0,0] op_sel_hi:[0,1]
  v_pk_mul_f16 v147, v88, v96 op_sel:[1,0] op_sel_hi:[1,1]
  v_pk_mul_f16 v156, v102, v109 op_sel:[0,0] op_sel_hi:[0,1]
  v_pk_mul_f16 v157, v102, v109 op_sel:[1,0] op_sel_hi:[1,1]
  v_pk_mul_f16 v158, v102, v110 op_sel:[0,0] op_sel_hi:[0,1]
  v_pk_mul_f16 v159, v102, v110 op_sel:[1,0] op_sel_hi:[1,1]
  s_cmp_lg_u32 s51, 0
  s_cbranch_scc1 L_novm
  s_waitcnt vmcnt(0)
  v_lshl_add_u32 v16, v16, 7, v8
  v_lshl_add_u32 v17, v17, 7, v8
  v_lshl_add_u32 v18, v18, 7, v8
  v_lshl_add_u32 v19, v19, 7, v8
  s_add_u32 m0, s76, 0
  s_mov_b32 exec_hi, 0xffffff
  buffer_load_dwordx4 v16, s[32:35], 0 offen lds
  s_add_u32 m0, s76, 1056
  s_nop 0
  buffer_load_dwordx4 v17, s[32:35], 0 offen lds
  s_add_u32 m0, s76, 2112
  s_mov_b32 exec_hi, 0xffff
  buffer_load_dwordx4 v18, s[32:35], 0 offen lds
  s_add_u32 m0, s76, 3168
  s_nop 0
  buffer_load_dwordx4 v19, s[32:35], 0 offen lds
  s_mov_b32 exec_hi, -1
  buffer_load_dwordx4 v[16:19], v6, s[28:31], s94 offen
  s_add_u32 s94, s94, 416
L_novm:
  v_add_u32 v10, s81, v10
  v_add_u32 v4, s81, v4
  v_add_u32 v5, s81, v5
  s_sub_u32 s76, s76, s81
  s_sub_u32 s81, 0, s81
  s_mov_b32 s51, 0
  s_setprio 1
  v_mfma_f32_16x16x32_bf16 v[184:187], v[164:167], v[124:127], 0
  ds_read_b128 v[180:183], v1 offset:7168
  v_pk_mul_f16 v116, v60, v69 op_sel:[0,0] op_sel_hi:[0,1]
  v_mfma_f32_16x16x32_bf16 v[200:203], v[164:167], v[136:139], 0
  v_pk_mul_f16 v117, v60, v69 op_sel:[1,0] op_sel_hi:[1,1]
  v_mfma_f32_16x16x32_bf16 v[216:219], v[164:167], v[148:151], 0
  v_pk_mul_f16 v118, v60, v70 op_sel:[0,0] op_sel_hi:[0,1]
  v_mfma_f32_16x16x32_bf16 v[232:235], v[164:167], v[160:163], 0
  v_pk_mul_f16 v119, v60, v70 op_sel:[1,0] op_sel_hi:[1,1]
  v_mfma_f32_16x16x32_bf16 v[188:191], v[168:171], v[124:127], 0
  ds_read_b128 v[164:167], v1 offset:5120
  v_pk_mul_f16 v128, v74, v83 op_sel:[0,0] op_sel_hi:[0,1]
  v_mfma_f32_16x16x32_bf16 v[204:207], v[168:171], v[136:139], 0
  v_pk_mul_f16 v129, v74, v83 op_sel:[1,0] op_sel_hi:[1,1]
  v_mfma_f32_16x16x32_bf16 v[220:223], v[168:171], v[148:151], 0
  v_pk_mul_f16 v130, v74, v84 op_sel:[0,0] op_sel_hi:[0,1]
  v_mfma_f32_16x16x32_bf16 v[236:239], v[168:171], v[160:163], 0
  v_pk_mul_f16 v131, v74, v84 op_sel:[1,0] op_sel_hi:[1,1]
  v_mfma_f32_16x16x32_f16 v[192:195], v[172:175], v[120:123], 0
  ds_read_b128 v[168:171], v1 offset:11264
  v_pk_mul_f16 v140, v88, v97 op_sel:[0,0] op_sel_hi:[0,1]
  v_mfma_f32_16x16x32_f16 v[208:211], v[172:175], v[132:135], 0
  v_pk_mul_f16 v141, v88, v97 op_sel:[1,0] op_sel_hi:[1,1]
  v_mfma_f32_16x16x32_f16 v[224:227], v[172:175], v[144:147], 0
  v_pk_mul_f16 v142, v88, v98 op_sel:[0,0] op_sel_hi:[0,1]
  v_mfma_f32_16x16x32_f16 v[240:243], v[172:175], v[156:159], 0
  v_pk_mul_f16 v143, v88, v98 op_sel:[1,0] op_sel_hi:[1,1]
  v_mfma_f32_16x16x32_f16 v[184:187], v[176:179], v[120:123], v[184:187]
  ds_read_b128 v[172:175], v1 offset:9216
  v_pk_mul_f16 v152, v102, v111 op_sel:[0,0] op_sel_hi:[0,1]
  v_mfma_f32_16x16x32_f16 v[200:203], v[176:179], v[132:135], v[200:203]
  v_pk_mul_f16 v153, v102, v111 op_sel:[1,0] op_sel_hi:[1,1]
  v_mfma_f32_16x16x32_f16 v[216:219], v[176:179], v[144:147], v[216:219]
  s_setprio 2
  s_waitcnt lgkmcnt(14)
  v_pk_mul_f16 v154, v102, v112 op_sel:[0,0] op_sel_hi:[0,1]
  v_mfma_f32_16x16x32_f16 v[232:235], v[176:179], v[156:159], v[232:235]
  s_nop 0
  s_waitcnt lgkmcnt(3)
  v_pk_mul_f16 v155, v102, v112 op_sel:[1,0] op_sel_hi:[1,1]
  v_mfma_f32_16x16x32_f16 v[188:191], v[180:183], v[120:123], v[188:191]
  ds_read_b128 v[176:179], v1 offset:10240
  v_pk_mul_f16 v124, v61, v68 op_sel:[0,0] op_sel_hi:[0,1]
  v_mfma_f32_16x16x32_f16 v[204:207], v[180:183], v[132:135], v[204:207]
  v_pk_mul_f16 v125, v61, v68 op_sel:[1,0] op_sel_hi:[1,1]
  v_mfma_f32_16x16x32_f16 v[220:223], v[180:183], v[144:147], v[220:223]
  v_pk_mul_f16 v126, v61, v69 op_sel:[0,0] op_sel_hi:[0,1]
  v_mfma_f32_16x16x32_f16 v[236:239], v[180:183], v[156:159], v[236:239]
  s_waitcnt lgkmcnt(3)
  v_pk_mul_f16 v127, v61, v69 op_sel:[1,0] op_sel_hi:[1,1]
  v_mfma_f32_16x16x32_f16 v[196:199], v[164:167], v[120:123], 0
  ds_read_b128 v[180:183], v1 offset:14336
  v_pk_mul_f16 v136, v75, v82 op_sel:[0,0] op_sel_hi:[0,1]
  v_mfma_f32_16x16x32_f16 v[212:215], v[164:167], v[132:135], 0
  v_pk_mul_f16 v120, v60, v71 op_sel:[0,0] op_sel_hi:[0,1]
  v_mfma_f32_16x16x32_f16 v[228:231], v[164:167], v[144:147], 0
  s_nop 0
  v_pk_mul_f16 v121, v60, v71 op_sel:[1,0] op_sel_hi:[1,1]
  v_mfma_f32_16x16x32_f16 v[244:247], v[164:167], v[156:159], 0
  s_waitcnt lgkmcnt(3)
  v_pk_mul_f16 v122, v60, v66 op_sel:[0,1] op_sel_hi:[0,0]
  v_mfma_f32_16x16x32_f16 v[192:195], v[168:171], v[116:119], v[192:195]
  ds_read_b128 v[164:167], v1 offset:12288
  v_pk_mul_f16 v123, v60, v72 op_sel:[0,0] op_sel_hi:[1,0]
  v_mfma_f32_16x16x32_f16 v[208:211], v[168:171], v[128:131], v[208:211]
  s_nop 0
  v_pk_mul_f16 v132, v74, v85 op_sel:[0,0] op_sel_hi:[0,1]
  v_mfma_f32_16x16x32_f16 v[224:227], v[168:171], v[140:143], v[224:227]
  v_pk_mul_f16 v133, v74, v85 op_sel:[1,0] op_sel_hi:[1,1]
  v_mfma_f32_16x16x32_f16 v[240:243], v[168:171], v[152:155], v[240:243]
  s_nop 0
  s_waitcnt lgkmcnt(3)
  v_pk_mul_f16 v134, v74, v80 op_sel:[0,1] op_sel_hi:[0,0]
  v_mfma_f32_16x16x32_f16 v[184:187], v[172:175], v[116:119], v[184:187]
  ds_read_b128 v[168:171], v1 offset:13312
  v_pk_mul_f16 v135, v74, v86 op_sel:[0,0] op_sel_hi:[1,0]
  v_mfma_f32_16x16x32_f16 v[200:203], v[172:175], v[128:131], v[200:203]
  v_pk_mul_f16 v144, v88, v99 op_sel:[0,0] op_sel_hi:[0,1]
  v_mfma_f32_16x16x32_f16 v[216:219], v[172:175], v[140:143], v[216:219]
  v_pk_mul_f16 v145, v88, v99 op_sel:[1,0] op_sel_hi:[1,1]
  v_mfma_f32_16x16x32_f16 v[232:235], v[172:175], v[152:155], v[232:235]
  s_nop 0
  s_waitcnt lgkmcnt(3)
  v_pk_mul_f16 v146, v88, v94 op_sel:[0,1] op_sel_hi:[0,0]
  v_mfma_f32_16x16x32_f16 v[188:191], v[176:179], v[116:119], v[188:191]
  ds_read_b128 v[172:175], v1 offset:0
  v_pk_mul_f16 v147, v88, v100 op_sel:[0,0] op_sel_hi:[1,0]
  v_mfma_f32_16x16x32_f16 v[204:207], v[176:179], v[128:131], v[204:207]
  v_pk_mul_f16 v156, v102, v113 op_sel:[0,0] op_sel_hi:[0,1]
  v_mfma_f32_16x16x32_f16 v[220:223], v[176:179], v[140:143], v[220:223]
  v_pk_mul_f16 v157, v102, v113 op_sel:[1,0] op_sel_hi:[1,1]
  v_mfma_f32_16x16x32_f16 v[236:239], v[176:179], v[152:155], v[236:239]
  s_waitcnt lgkmcnt(3)
  v_pk_mul_f16 v158, v102, v108 op_sel:[0,1] op_sel_hi:[0,0]
  v_mfma_f32_16x16x32_f16 v[192:195], v[180:183], v[120:123], v[192:195]
  ds_read_b128 v[176:179], v1 offset:17408
  v_pk_mul_f16 v159, v102, v114 op_sel:[0,0] op_sel_hi:[1,0]
  v_mfma_f32_16x16x32_f16 v[208:211], v[180:183], v[132:135], v[208:211]
  v_pk_mul_f16 v137, v75, v82 op_sel:[1,0] op_sel_hi:[1,1]
  v_mfma_f32_16x16x32_f16 v[224:227], v[180:183], v[144:147], v[224:227]
  s_nop 0
  v_pk_mul_f16 v138, v75, v83 op_sel:[0,0] op_sel_hi:[0,1]
  v_mfma_f32_16x16x32_f16 v[240:243], v[180:183], v[156:159], v[240:243]
  s_waitcnt lgkmcnt(3)
  v_pk_mul_f16 v139, v75, v83 op_sel:[1,0] op_sel_hi:[1,1]
  v_mfma_f32_16x16x32_f16 v[184:187], v[164:167], v[120:123], v[184:187]
  ds_read_b128 v[180:183], v1 offset:15360
  v_pk_mul_f16 v148, v89, v96 op_sel:[0,0] op_sel_hi:[0,1]
  v_mfma_f32_16x16x32_f16 v[200:203], v[164:167], v[132:135], v[200:203]
  s_nop 0
  v_pk_mul_f16 v149, v89, v96 op_sel:[1,0] op_sel_hi:[1,1]
  v_mfma_f32_16x16x32_f16 v[216:219], v[164:167], v[144:147], v[216:219]
  v_pk_mul_f16 v150, v89, v97 op_sel:[0,0] op_sel_hi:[0,1]
  v_mfma_f32_16x16x32_f16 v[232:235], v[164:167], v[156:159], v[232:235]
  s_nop 0
  s_waitcnt lgkmcnt(3)
  v_pk_mul_f16 v151, v89, v97 op_sel:[1,0] op_sel_hi:[1,1]
  v_mfma_f32_16x16x32_f16 v[188:191], v[168:171], v[120:123], v[188:191]
  ds_read_b128 v[164:167], v1 offset:16384
  v_pk_mul_f16 v160, v103, v110 op_sel:[0,0] op_sel_hi:[0,1]
  v_mfma_f32_16x16x32_f16 v[204:207], v[168:171], v[132:135], v[204:207]
  v_pk_mul_f16 v161, v103, v110 op_sel:[1,0] op_sel_hi:[1,1]
  v_mfma_f32_16x16x32_f16 v[220:223], v[168:171], v[144:147], v[220:223]
  v_pk_mul_f16 v162, v103, v111 op_sel:[0,0] op_sel_hi:[0,1]
  v_mfma_f32_16x16x32_f16 v[236:239], v[168:171], v[156:159], v[236:239]
  s_nop 0
  s_waitcnt lgkmcnt(3)
  v_pk_mul_f16 v163, v103, v111 op_sel:[1,0] op_sel_hi:[1,1]
  v_smfmac_f32_16x16x64_f16 v[196:199], v[172:175], v[116:123], v9
  ds_read_b128 v[168:171], v1 offset:20480
  v_smfmac_f32_16x16x64_f16 v[212:215], v[172:175], v[128:135], v9
  v_pk_mul_f16 v120, v61, v70 op_sel:[0,0] op_sel_hi:[0,1]
  v_smfmac_f32_16x16x64_f16 v[228:231], v[172:175], v[140:147], v9
  v_pk_mul_f16 v121, v61, v70 op_sel:[1,0] op_sel_hi:[1,1]
  v_smfmac_f32_16x16x64_f16 v[244:247], v[172:175], v[152:159], v9
  s_nop 0
  s_waitcnt lgkmcnt(3)
  v_pk_mul_f16 v122, v61, v71 op_sel:[0,0] op_sel_hi:[0,1]
  v_mfma_f32_16x16x32_f16 v[192:195], v[176:179], v[124:127], v[192:195]
  ds_read_b128 v[172:175], v1 offset:18432
  v_pk_mul_f16 v123, v61, v71 op_sel:[1,0] op_sel_hi:[1,1]
  v_mfma_f32_16x16x32_f16 v[208:211], v[176:179], v[136:139], v[208:211]
  v_pk_mul_f16 v132, v75, v84 op_sel:[0,0] op_sel_hi:[0,1]
  v_mfma_f32_16x16x32_f16 v[224:227], v[176:179], v[148:151], v[224:227]
  v_pk_mul_f16 v133, v75, v84 op_sel:[1,0] op_sel_hi:[1,1]
  v_mfma_f32_16x16x32_f16 v[240:243], v[176:179], v[160:163], v[240:243]
  s_waitcnt lgkmcnt(3)
  v_pk_mul_f16 v134, v75, v85 op_sel:[0,0] op_sel_hi:[0,1]
  v_mfma_f32_16x16x32_f16 v[184:187], v[180:183], v[124:127], v[184:187]
  ds_read_b128 v[176:179], v1 offset:19456
  v_pk_mul_f16 v135, v75, v85 op_sel:[1,0] op_sel_hi:[1,1]
  v_mfma_f32_16x16x32_f16 v[200:203], v[180:183], v[136:139], v[200:203]
  s_nop 0
  v_pk_mul_f16 v144, v89, v98 op_sel:[0,0] op_sel_hi:[0,1]
  v_mfma_f32_16x16x32_f16 v[216:219], v[180:183], v[148:151], v[216:219]
  v_pk_mul_f16 v145, v89, v98 op_sel:[1,0] op_sel_hi:[1,1]
  v_mfma_f32_16x16x32_f16 v[232:235], v[180:183], v[160:163], v[232:235]
  s_nop 0
  s_waitcnt lgkmcnt(3)
  v_pk_mul_f16 v146, v89, v99 op_sel:[0,0] op_sel_hi:[0,1]
  v_mfma_f32_16x16x32_f16 v[188:191], v[164:167], v[124:127], v[188:191]
  ds_read_b128 v[180:183], v1 offset:1024
  v_pk_mul_f16 v147, v89, v99 op_sel:[1,0] op_sel_hi:[1,1]
  v_mfma_f32_16x16x32_f16 v[204:207], v[164:167], v[136:139], v[204:207]
  s_waitcnt vmcnt(1)
  ds_read_u16_d16_hi v32, v10 offset:0
  v_pk_mul_f16 v156, v103, v112 op_sel:[0,0] op_sel_hi:[0,1]
  v_mfma_f32_16x16x32_f16 v[220:223], v[164:167], v[148:151], v[220:223]
  ds_read_u16_d16_hi v33, v10 offset:2
  v_pk_mul_f16 v157, v103, v112 op_sel:[1,0] op_sel_hi:[1,1]
  v_mfma_f32_16x16x32_f16 v[236:239], v[164:167], v[160:163], v[236:239]
  s_waitcnt lgkmcnt(5)
  v_pk_mul_f16 v158, v103, v113 op_sel:[0,0] op_sel_hi:[0,1]
  v_mfma_f32_16x16x32_f16 v[192:195], v[168:171], v[120:123], v[192:195]
  ds_read_b128 v[164:167], v1 offset:23552
  v_pk_mul_f16 v159, v103, v113 op_sel:[1,0] op_sel_hi:[1,1]
  v_mfma_f32_16x16x32_f16 v[208:211], v[168:171], v[132:135], v[208:211]
  ds_read_u16_d16_hi v34, v10 offset:2112
  v_pk_mul_f16 v116, v61, v67 op_sel:[0,1] op_sel_hi:[0,0]
  v_mfma_f32_16x16x32_f16 v[224:227], v[168:171], v[144:147], v[224:227]
  ds_read_u16_d16_hi v35, v10 offset:2114
  v_pk_mul_f16 v117, v61, v72 op_sel:[0,0] op_sel_hi:[1,0]
  v_mfma_f32_16x16x32_f16 v[240:243], v[168:171], v[156:159], v[240:243]
  s_nop 0
  s_waitcnt lgkmcnt(7)
  v_pk_mul_f16 v118, v62, v69 op_sel:[0,0] op_sel_hi:[0,1]
  v_mfma_f32_16x16x32_f16 v[184:187], v[172:175], v[120:123], v[184:187]
  ds_read_b128 v[168:171], v1 offset:21504
  v_pk_mul_f16 v119, v62, v69 op_sel:[1,0] op_sel_hi:[1,1]
  v_mfma_f32_16x16x32_f16 v[200:203], v[172:175], v[132:135], v[200:203]
  ds_read_b64_tr_b16 v[60:61], v27 offset:0
  v_pk_mul_f16 v128, v75, v81 op_sel:[0,1] op_sel_hi:[0,0]
  v_mfma_f32_16x16x32_f16 v[216:219], v[172:175], v[144:147], v[216:219]
  ds_read_u16_d16_hi v36, v10 offset:128
  v_pk_mul_f16 v129, v75, v86 op_sel:[0,0] op_sel_hi:[1,0]
  v_mfma_f32_16x16x32_f16 v[232:235], v[172:175], v[156:159], v[232:235]
  s_waitcnt lgkmcnt(9)
  v_pk_mul_f16 v130, v76, v83 op_sel:[0,0] op_sel_hi:[0,1]
  v_pk_mul_f16 v131, v76, v83 op_sel:[1,0] op_sel_hi:[1,1]
  v_mfma_f32_16x16x32_f16 v[188:191], v[176:179], v[120:123], v[188:191]
  ds_read_b128 v[172:175], v1 offset:22528
  v_pk_mul_f16 v140, v89, v95 op_sel:[0,1] op_sel_hi:[0,0]
  v_mfma_f32_16x16x32_f16 v[204:207], v[176:179], v[132:135], v[204:207]
  ds_read_b64_tr_b16 v[74:75], v27 offset:32
  v_pk_mul_f16 v141, v89, v100 op_sel:[0,0] op_sel_hi:[1,0]
  v_mfma_f32_16x16x32_f16 v[220:223], v[176:179], v[144:147], v[220:223]
  ds_read_b64_tr_b16 v[88:89], v27 offset:64
  v_pk_mul_f16 v142, v90, v97 op_sel:[0,0] op_sel_hi:[0,1]
  v_mfma_f32_16x16x32_f16 v[236:239], v[176:179], v[156:159], v[236:239]
  s_waitcnt lgkmcnt(11)
  v_pk_mul_f16 v143, v90, v97 op_sel:[1,0] op_sel_hi:[1,1]
  v_pk_mul_f16 v152, v103, v109 op_sel:[0,1] op_sel_hi:[0,0]
  v_smfmac_f32_16x16x64_f16 v[196:199], v[180:183], v[120:127], v9
  ds_read_b128 v[176:179], v1 offset:26624
  v_pk_mul_f16 v153, v103, v114 op_sel:[0,0] op_sel_hi:[1,0]
  v_smfmac_f32_16x16x64_f16 v[212:215], v[180:183], v[132:139], v9
  ds_read_b64_tr_b16 v[102:103], v27 offset:96
  v_pk_mul_f16 v154, v104, v111 op_sel:[0,0] op_sel_hi:[0,1]
  v_smfmac_f32_16x16x64_f16 v[228:231], v[180:183], v[144:151], v9
  ds_read_u16_d16_hi v37, v10 offset:130
  v_pk_mul_f16 v155, v104, v111 op_sel:[1,0] op_sel_hi:[1,1]
  v_smfmac_f32_16x16x64_f16 v[244:247], v[180:183], v[156:163], v9
  s_waitcnt lgkmcnt(11)
  v_pk_mul_f16 v120, v62, v70 op_sel:[0,0] op_sel_hi:[0,1]
  v_mfma_f32_16x16x32_f16 v[192:195], v[164:167], v[116:119], v[192:195]
  ds_read_b128 v[180:183], v1 offset:24576
  v_pk_mul_f16 v121, v62, v70 op_sel:[1,0] op_sel_hi:[1,1]
  v_mfma_f32_16x16x32_f16 v[208:211], v[164:167], v[128:131], v[208:211]
  ds_read_u16_d16_hi v38, v10 offset:2240
  v_pk_mul_f16 v122, v62, v71 op_sel:[0,0] op_sel_hi:[0,1]
  v_mfma_f32_16x16x32_f16 v[224:227], v[164:167], v[140:143], v[224:227]
  ds_read_u16_d16_hi v39, v10 offset:2242
  v_pk_mul_f16 v123, v62, v71 op_sel:[1,0] op_sel_hi:[1,1]
  v_mfma_f32_16x16x32_f16 v[240:243], v[164:167], v[152:155], v[240:243]
  s_waitcnt lgkmcnt(11)
  v_pk_mul_f16 v132, v76, v84 op_sel:[0,0] op_sel_hi:[0,1]
  v_max3_f32 v58, |v32|, |v33|, 0
  v_mfma_f32_16x16x32_f16 v[184:187], v[168:171], v[116:119], v[184:187]
  ds_read_b128 v[164:167], v1 offset:25600
  v_pk_mul_f16 v133, v76, v84 op_sel:[1,0] op_sel_hi:[1,1]
  v_mfma_f32_16x16x32_f16 v[200:203], v[168:171], v[128:131], v[200:203]
  ds_read_u16_d16_hi v40, v10 offset:256
  v_pk_mul_f16 v134, v76, v85 op_sel:[0,0] op_sel_hi:[0,1]
  v_mfma_f32_16x16x32_f16 v[216:219], v[168:171], v[140:143], v[216:219]
  ds_read_u16_d16_hi v41, v10 offset:258
  v_pk_mul_f16 v135, v76, v85 op_sel:[1,0] op_sel_hi:[1,1]
  v_mfma_f32_16x16x32_f16 v[232:235], v[168:171], v[152:155], v[232:235]
  s_waitcnt lgkmcnt(11)
  v_pk_mul_f16 v144, v90, v98 op_sel:[0,0] op_sel_hi:[0,1]
  v_max3_f32 v58, |v34|, |v35|, v58
  v_mfma_f32_16x16x32_f16 v[188:191], v[172:175], v[116:119], v[188:191]
  ds_read_b128 v[168:171], v1 offset:2048
  v_pk_mul_f16 v145, v90, v98 op_sel:[1,0] op_sel_hi:[1,1]
  v_mfma_f32_16x16x32_f16 v[204:207], v[172:175], v[128:131], v[204:207]
  ds_read_u16_d16_hi v42, v10 offset:2368
  v_pk_mul_f16 v146, v90, v99 op_sel:[0,0] op_sel_hi:[0,1]
  v_mfma_f32_16x16x32_f16 v[220:223], v[172:175], v[140:143], v[220:223]
  ds_read_u16_d16_hi v43, v10 offset:2370
  v_pk_mul_f16 v147, v90, v99 op_sel:[1,0] op_sel_hi:[1,1]
  v_mfma_f32_16x16x32_f16 v[236:239], v[172:175], v[152:155], v[236:239]
  s_waitcnt lgkmcnt(11)
  v_pk_mul_f16 v156, v104, v112 op_sel:[0,0] op_sel_hi:[0,1]
  v_mfma_f32_16x16x32_f16 v[192:195], v[176:179], v[120:123], v[192:195]
  ds_read_b128 v[172:175], v1 offset:29696
  v_pk_mul_f16 v157, v104, v112 op_sel:[1,0] op_sel_hi:[1,1]
  v_mfma_f32_16x16x32_f16 v[208:211], v[176:179], v[132:135], v[208:211]
  ds_read_u16_d16_hi v44, v10 offset:384
  v_pk_mul_f16 v158, v104, v113 op_sel:[0,0] op_sel_hi:[0,1]
  v_mfma_f32_16x16x32_f16 v[224:227], v[176:179], v[144:147], v[224:227]
  ds_read_u16_d16_hi v45, v10 offset:386
  v_pk_mul_f16 v159, v104, v113 op_sel:[1,0] op_sel_hi:[1,1]
  s_nop 1
  v_mfma_f32_16x16x32_f16 v[240:243], v[176:179], v[156:159], v[240:243]
  s_waitcnt lgkmcnt(11)
  v_pk_mul_f16 v124, v62, v68 op_sel:[0,1] op_sel_hi:[0,0]
  v_mfma_f32_16x16x32_f16 v[184:187], v[180:183], v[120:123], v[184:187]
  ds_read_b128 v[176:179], v1 offset:27648
  v_pk_mul_f16 v125, v62, v72 op_sel:[0,0] op_sel_hi:[1,0]
  v_mfma_f32_16x16x32_f16 v[200:203], v[180:183], v[132:135], v[200:203]
  ds_read_u16_d16_hi v46, v10 offset:2496
  v_pk_mul_f16 v126, v63, v70 op_sel:[0,0] op_sel_hi:[0,1]
  v_mfma_f32_16x16x32_f16 v[216:219], v[180:183], v[144:147], v[216:219]
  ds_read_u16_d16_hi v47, v10 offset:2498
  v_pk_mul_f16 v127, v63, v70 op_sel:[1,0] op_sel_hi:[1,1]
  v_mfma_f32_16x16x32_f16 v[232:235], v[180:183], v[156:159], v[232:235]
  s_waitcnt lgkmcnt(11)
  v_pk_mul_f16 v136, v76, v82 op_sel:[0,1] op_sel_hi:[0,0]
  v_pk_mul_f16 v137, v76, v86 op_sel:[0,0] op_sel_hi:[1,0]
  v_mfma_f32_16x16x32_f16 v[188:191], v[164:167], v[120:123], v[188:191]
  ds_read_b128 v[180:183], v1 offset:28672
  v_pk_mul_f16 v138, v77, v84 op_sel:[0,0] op_sel_hi:[0,1]
  v_mfma_f32_16x16x32_f16 v[204:207], v[164:167], v[132:135], v[204:207]
  ds_read_u16_d16_hi v48, v10 offset:512
  v_pk_mul_f16 v139, v77, v84 op_sel:[1,0] op_sel_hi:[1,1]
  v_mfma_f32_16x16x32_f16 v[220:223], v[164:167], v[144:147], v[220:223]
  ds_read_u16_d16_hi v49, v10 offset:514
  v_pk_mul_f16 v148, v90, v96 op_sel:[0,1] op_sel_hi:[0,0]
  v_mfma_f32_16x16x32_f16 v[236:239], v[164:167], v[156:159], v[236:239]
  s_waitcnt lgkmcnt(11)
  v_pk_mul_f16 v149, v90, v100 op_sel:[0,0] op_sel_hi:[1,0]
  v_pk_mul_f16 v150, v91, v98 op_sel:[0,0] op_sel_hi:[0,1]
  v_smfmac_f32_16x16x64_f16 v[196:199], v[168:171], v[116:123], v9
  ds_read_b128 v[164:167], v1 offset:32768
  v_pk_mul_f16 v151, v91, v98 op_sel:[1,0] op_sel_hi:[1,1]
  v_smfmac_f32_16x16x64_f16 v[212:215], v[168:171], v[128:135], v9
  ds_read_u16_d16_hi v50, v10 offset:2624
  v_pk_mul_f16 v160, v104, v110 op_sel:[0,1] op_sel_hi:[0,0]
  v_smfmac_f32_16x16x64_f16 v[228:231], v[168:171], v[140:147], v9
  ds_read_u16_d16_hi v51, v10 offset:2626
  v_pk_mul_f16 v161, v104, v114 op_sel:[0,0] op_sel_hi:[1,0]
  v_smfmac_f32_16x16x64_f16 v[244:247], v[168:171], v[152:159], v9
  s_nop 0
  s_waitcnt lgkmcnt(11)
  v_pk_mul_f16 v162, v105, v112 op_sel:[0,0] op_sel_hi:[0,1]
  v_mfma_f32_16x16x32_f16 v[192:195], v[172:175], v[124:127], v[192:195]
  ds_read_b128 v[168:171], v1 offset:30720
  v_pk_mul_f16 v163, v105, v112 op_sel:[1,0] op_sel_hi:[1,1]
  v_mfma_f32_16x16x32_f16 v[208:211], v[172:175], v[136:139], v[208:211]
  ds_read_u16_d16_hi v52, v10 offset:640
  v_pk_mul_f16 v120, v63, v71 op_sel:[0,0] op_sel_hi:[0,1]
  v_mfma_f32_16x16x32_f16 v[224:227], v[172:175], v[148:151], v[224:227]
  ds_read_u16_d16_hi v53, v10 offset:642
  v_pk_mul_f16 v121, v63, v71 op_sel:[1,0] op_sel_hi:[1,1]
  v_mfma_f32_16x16x32_f16 v[240:243], v[172:175], v[160:163], v[240:243]
  s_waitcnt lgkmcnt(11)
  v_pk_mul_f16 v122, v63, v69 op_sel:[0,1] op_sel_hi:[1,1]
  v_pk_mul_f16 v123, v63, v72 op_sel:[0,0] op_sel_hi:[1,0]
  v_mfma_f32_16x16x32_f16 v[184:187], v[176:179], v[124:127], v[184:187]
  ds_read_b128 v[172:175], v1 offset:31744
  v_pk_mul_f16 v132, v77, v85 op_sel:[0,0] op_sel_hi:[0,1]
  v_mfma_f32_16x16x32_f16 v[200:203], v[176:179], v[136:139], v[200:203]
  ds_read_u16_d16_hi v54, v10 offset:2752
  v_pk_mul_f16 v133, v77, v85 op_sel:[1,0] op_sel_hi:[1,1]
  v_mfma_f32_16x16x32_f16 v[216:219], v[176:179], v[148:151], v[216:219]
  ds_read_u16_d16_hi v55, v10 offset:2754
  v_pk_mul_f16 v134, v77, v83 op_sel:[0,1] op_sel_hi:[1,1]
  v_mfma_f32_16x16x32_f16 v[232:235], v[176:179], v[160:163], v[232:235]
  s_waitcnt lgkmcnt(11)
  v_pk_mul_f16 v135, v77, v86 op_sel:[0,0] op_sel_hi:[1,0]
  v_pk_mul_f16 v144, v91, v99 op_sel:[0,0] op_sel_hi:[0,1]
  v_mfma_f32_16x16x32_f16 v[188:191], v[180:183], v[124:127], v[188:191]
  ds_read_b128 v[176:179], v1 offset:3072
  v_pk_mul_f16 v145, v91, v99 op_sel:[1,0] op_sel_hi:[1,1]
  v_mfma_f32_16x16x32_f16 v[204:207], v[180:183], v[136:139], v[204:207]
  ds_read_u16_d16_hi v56, v10 offset:768
  v_pk_mul_f16 v146, v91, v97 op_sel:[0,1] op_sel_hi:[1,1]
  v_mfma_f32_16x16x32_f16 v[220:223], v[180:183], v[148:151], v[220:223]
  ds_read_u16_d16_hi v57, v10 offset:770
  v_pk_mul_f16 v147, v91, v100 op_sel:[0,0] op_sel_hi:[1,0]
  v_mfma_f32_16x16x32_f16 v[236:239], v[180:183], v[160:163], v[236:239]
  s_waitcnt lgkmcnt(11)
  v_pk_mul_f16 v156, v105, v113 op_sel:[0,0] op_sel_hi:[0,1]
  v_max3_f32 v58, |v36|, |v37|, v58
  v_mfma_f32_16x16x32_f16 v[192:195], v[164:167], v[120:123], v[192:195]
  ds_read_b128 v[180:183], v1 offset:35840
  v_pk_mul_f16 v157, v105, v113 op_sel:[1,0] op_sel_hi:[1,1]
  v_mfma_f32_16x16x32_f16 v[208:211], v[164:167], v[132:135], v[208:211]
  v_pk_mul_f16 v158, v105, v111 op_sel:[0,1] op_sel_hi:[1,1]
  v_max3_f32 v58, |v38|, |v39|, v58
  v_mfma_f32_16x16x32_f16 v[224:227], v[164:167], v[144:147], v[224:227]
  v_pk_mul_f16 v159, v105, v114 op_sel:[0,0] op_sel_hi:[1,0]
  v_max3_f32 v58, |v40|, |v41|, v58
  s_nop 0
  v_mfma_f32_16x16x32_f16 v[240:243], v[164:167], v[156:159], v[240:243]
  s_nop 0
  s_waitcnt lgkmcnt(9)
  v_pk_mul_f16 v116, v64, v71 op_sel:[0,0] op_sel_hi:[0,1]
  v_mfma_f32_16x16x32_f16 v[184:187], v[168:171], v[120:123], v[184:187]
  ds_read_b128 v[164:167], v1 offset:33792
  v_pk_mul_f16 v117, v64, v71 op_sel:[1,0] op_sel_hi:[1,1]
  v_mfma_f32_16x16x32_f16 v[200:203], v[168:171], v[132:135], v[200:203]
  v_pk_mul_f16 v118, v64, v70 op_sel:[0,1] op_sel_hi:[1,1]
  v_max3_f32 v58, |v42|, |v43|, v58
  v_mfma_f32_16x16x32_f16 v[216:219], v[168:171], v[144:147], v[216:219]
  v_pk_mul_f16 v119, v64, v72 op_sel:[0,0] op_sel_hi:[1,0]
  v_pk_mul_f16 v128, v78, v85 op_sel:[0,0] op_sel_hi:[0,1]
  v_mfma_f32_16x16x32_f16 v[232:235], v[168:171], v[156:159], v[232:235]
  s_waitcnt lgkmcnt(7)
  v_pk_mul_f16 v129, v78, v85 op_sel:[1,0] op_sel_hi:[1,1]
  v_pk_mul_f16 v130, v78, v84 op_sel:[0,1] op_sel_hi:[1,1]
  v_mfma_f32_16x16x32_f16 v[188:191], v[172:175], v[120:123], v[188:191]
  ds_read_b128 v[168:171], v1 offset:34816
  v_pk_mul_f16 v131, v78, v86 op_sel:[0,0] op_sel_hi:[1,0]
  v_mfma_f32_16x16x32_f16 v[204:207], v[172:175], v[132:135], v[204:207]
  v_pk_mul_f16 v140, v92, v99 op_sel:[0,0] op_sel_hi:[0,1]
  v_pk_mul_f16 v141, v92, v99 op_sel:[1,0] op_sel_hi:[1,1]
  v_mfma_f32_16x16x32_f16 v[220:223], v[172:175], v[144:147], v[220:223]
  v_pk_mul_f16 v142, v92, v98 op_sel:[0,1] op_sel_hi:[1,1]
  v_pk_mul_f16 v143, v92, v100 op_sel:[0,0] op_sel_hi:[1,0]
  v_mfma_f32_16x16x32_f16 v[236:239], v[172:175], v[156:159], v[236:239]
  s_waitcnt lgkmcnt(5)
  v_pk_mul_f16 v152, v106, v113 op_sel:[0,0] op_sel_hi:[0,1]
  v_smfmac_f32_16x16x64_f16 v[196:199], v[176:179], v[120:127], v9
  ds_read_b128 v[172:175], v1 offset:38912
  v_pk_mul_f16 v153, v106, v113 op_sel:[1,0] op_sel_hi:[1,1]
  v_smfmac_f32_16x16x64_f16 v[212:215], v[176:179], v[132:139], v9
  v_pk_mul_f16 v154, v106, v112 op_sel:[0,1] op_sel_hi:[1,1]
  v_smfmac_f32_16x16x64_f16 v[228:231], v[176:179], v[144:151], v9
  v_pk_mul_f16 v155, v106, v114 op_sel:[0,0] op_sel_hi:[1,0]
  v_smfmac_f32_16x16x64_f16 v[244:247], v[176:179], v[156:163], v9
  s_waitcnt lgkmcnt(3)
  v_pk_mul_f16 v120, v65, v71 op_sel:[0,1] op_sel_hi:[1,1]
  v_mfma_f32_16x16x32_f16 v[192:195], v[180:183], v[116:119], v[192:195]
  ds_read_b128 v[176:179], v1 offset:36864
  v_pk_mul_f16 v121, v65, v72 op_sel:[0,0] op_sel_hi:[1,0]
  v_mfma_f32_16x16x32_f16 v[208:211], v[180:183], v[128:131], v[208:211]
  s_nop 0
  v_pk_mul_f16 v122, v72, v72 op_sel:[0,0] op_sel_hi:[1,1]
  v_max3_f32 v58, |v44|, |v45|, v58
  v_mfma_f32_16x16x32_f16 v[224:227], v[180:183], v[140:143], v[224:227]
  v_pk_mul_f16 v123, v60, v61 op_sel:[0,0] op_sel_hi:[1,1]
  v_max3_f32 v58, |v46|, |v47|, v58
  v_mfma_f32_16x16x32_f16 v[240:243], v[180:183], v[152:155], v[240:243]
  s_nop 0
  s_waitcnt lgkmcnt(3)
  v_pk_mul_f16 v132, v79, v85 op_sel:[0,1] op_sel_hi:[1,1]
  v_mfma_f32_16x16x32_f16 v[184:187], v[164:167], v[116:119], v[184:187]
  ds_read_b128 v[180:183], v1 offset:37888
  v_pk_mul_f16 v133, v79, v86 op_sel:[0,0] op_sel_hi:[1,0]
  v_mfma_f32_16x16x32_f16 v[200:203], v[164:167], v[128:131], v[200:203]
  v_pk_mul_f16 v134, v86, v86 op_sel:[0,0] op_sel_hi:[1,1]
  v_max3_f32 v58, |v48|, |v49|, v58
  v_mfma_f32_16x16x32_f16 v[216:219], v[164:167], v[140:143], v[216:219]
  v_pk_mul_f16 v135, v74, v75 op_sel:[0,0] op_sel_hi:[1,1]
  v_max3_f32 v58, |v50|, |v51|, v58
  v_mfma_f32_16x16x32_f16 v[232:235], v[164:167], v[152:155], v[232:235]
  s_waitcnt lgkmcnt(3)
  v_pk_mul_f16 v144, v93, v99 op_sel:[0,1] op_sel_hi:[1,1]
  v_mfma_f32_16x16x32_f16 v[188:191], v[168:171], v[116:119], v[188:191]
  ds_read_b128 v[164:167], v1 offset:4096
  v_pk_mul_f16 v145, v93, v100 op_sel:[0,0] op_sel_hi:[1,0]
  v_mfma_f32_16x16x32_f16 v[204:207], v[168:171], v[128:131], v[204:207]
  s_nop 0
  v_pk_mul_f16 v146, v100, v100 op_sel:[0,0] op_sel_hi:[1,1]
  v_max3_f32 v58, |v52|, |v53|, v58
  v_mfma_f32_16x16x32_f16 v[220:223], v[168:171], v[140:143], v[220:223]
  v_pk_mul_f16 v147, v88, v89 op_sel:[0,0] op_sel_hi:[1,1]
  v_max3_f32 v58, |v54|, |v55|, v58
  v_mfma_f32_16x16x32_f16 v[236:239], v[168:171], v[152:155], v[236:239]
  s_waitcnt lgkmcnt(3)
  v_pk_mul_f16 v156, v107, v113 op_sel:[0,1] op_sel_hi:[1,1]
  v_mfma_f32_16x16x32_f16 v[192:195], v[172:175], v[120:123], v[192:195]
  s_nop 0
  v_pk_mul_f16 v157, v107, v114 op_sel:[0,0] op_sel_hi:[1,0]
  v_max3_f32 v58, |v56|, |v57|, v58
  v_mfma_f32_16x16x32_f16 v[208:211], v[172:175], v[132:135], v[208:211]
  v_pk_mul_f16 v158, v114, v114 op_sel:[0,0] op_sel_hi:[1,1]
  v_cvt_pk_f16_f32 v62, v32, v33
  v_mfma_f32_16x16x32_f16 v[224:227], v[172:175], v[144:147], v[224:227]
  s_nop 0
  v_pk_mul_f16 v159, v102, v103 op_sel:[0,0] op_sel_hi:[1,1]
  s_nop 1
  v_mfma_f32_16x16x32_f16 v[240:243], v[172:175], v[156:159], v[240:243]
  s_waitcnt lgkmcnt(2)
  v_cvt_pk_f16_f32 v76, v34, v35
  v_cvt_pk_f16_f32 v90, v36, v37
  v_mfma_f32_16x16x32_f16 v[184:187], v[176:179], v[120:123], v[184:187]
  ds_write_b32 v11, v62 offset:0
  v_mfma_f32_16x16x32_f16 v[200:203], v[176:179], v[132:135], v[200:203]
  ds_write_b32 v11, v76 offset:160
  v_mfma_f32_16x16x32_f16 v[216:219], v[176:179], v[144:147], v[216:219]
  ds_write_b32 v11, v90 offset:320
  v_mfma_f32_16x16x32_f16 v[232:235], v[176:179], v[156:159], v[232:235]
  s_waitcnt lgkmcnt(4)
  v_cvt_pk_f16_f32 v104, v38, v39
  v_cvt_pk_f16_f32 v63, v40, v41
  v_mfma_f32_16x16x32_f16 v[188:191], v[180:183], v[120:123], v[188:191]
  ds_write_b32 v11, v104 offset:480
  v_mfma_f32_16x16x32_f16 v[204:207], v[180:183], v[132:135], v[204:207]
  ds_write_b32 v11, v63 offset:640
  v_mfma_f32_16x16x32_f16 v[220:223], v[180:183], v[144:147], v[220:223]
  s_nop 0
  v_cvt_pk_f16_f32 v77, v42, v43
  v_cvt_pk_f16_f32 v91, v44, v45
  v_mfma_f32_16x16x32_f16 v[236:239], v[180:183], v[156:159], v[236:239]
  s_waitcnt lgkmcnt(5)
  v_cvt_pk_f16_f32 v105, v46, v47
  v_cvt_pk_f16_f32 v66, v48, v49
  v_smfmac_f32_16x16x64_f16 v[196:199], v[164:167], v[116:123], v9
  ds_write_b32 v11, v77 offset:800
  v_smfmac_f32_16x16x64_f16 v[212:215], v[164:167], v[128:135], v9
  ds_write_b32 v11, v91 offset:960
  v_smfmac_f32_16x16x64_f16 v[228:231], v[164:167], v[140:147], v9
  ds_write_b32 v11, v105 offset:1120
  v_smfmac_f32_16x16x64_f16 v[244:247], v[164:167], v[152:159], v9
  ds_write_b32 v11, v66 offset:1280
  s_setprio 0
  v_cvt_pk_f16_f32 v80, v50, v51
  v_cvt_pk_f16_f32 v94, v52, v53
  v_cvt_pk_f16_f32 v108, v54, v55
  v_cvt_pk_f16_f32 v67, v56, v57
  ds_write_b32 v11, v80 offset:1440
  ds_write_b32 v11, v94 offset:1600
  ds_write_b32 v11, v108 offset:1760
  ds_write_b32 v11, v67 offset:1920
  s_sub_u32 s72, s72, 1
  s_cmp_lg_u32 s72, 0
  s_cbranch_scc1 L_cin_loop
  s_branch L_cin_done
L_cslow:
  v_max_f32_dpp v58, v58, v58 row_shr:1 row_mask:0xf bank_mask:0xf
  s_nop 1
  v_max_f32_dpp v58, v58, v58 row_shr:2 row_mask:0xf bank_mask:0xf
  s_nop 1
  v_max_f32_dpp v58, v58, v58 row_shr:4 row_mask:0xf bank_mask:0xf
  s_nop 1
  v_max_f32_dpp v58, v58, v58 row_shr:8 row_mask:0xf bank_mask:0xf
  s_nop 1
  v_max_f32_dpp v58, v58, v58 row_bcast:15 row_mask:0xa bank_mask:0xf
  s_nop 1
  v_max_f32_dpp v58, v58, v58 row_bcast:31 row_mask:0xc bank_mask:0xf
  s_nop 0
  v_readlane_b32 s98, v58, 63
  s_mov_b32 s97, 0
  s_lshr_b32 s98, s98, 23
  s_max_u32 s98, s98, 72
  s_min_u32 s98, s98, 182
  s_sub_u32 s99, 258, s98
  s_lshl_b32 s100, s99, 1
  s_sub_u32 s100, s100, 127
  s_sub_u32 s95, 254, s100
  s_lshl_b32 s95, s95, 23
  v_mov_b32 v60, s95
  v_mul_f32 v61, s0, v60
  v_mul_f32 v60, s1, v60
  v_readfirstlane_b32 s74, v61
  v_readfirstlane_b32 s75, v60
  s_lshl_b32 s99, s99, 23
  s_lshl_b32 s100, s100, 23
  v_mul_f32 v60, s99, v32
  v_mul_f32 v61, s99, v33
  v_mul_f32 v62, s100, v32
  v_mul_f32 v63, s100, v33
  v_cvt_pk_f16_f32 v80, v60, v61
  v_cvt_pk_bf16_f32 v64, v62, v63
  ds_write_b32 v11, v80 offset:0
  ds_write_b32 v10, v64 offset:0
  v_mul_f32 v60, s99, v34
  v_mul_f32 v61, s99, v35
  v_mul_f32 v62, s100, v34
  v_mul_f32 v63, s100, v35
  v_cvt_pk_f16_f32 v81, v60, v61
  v_cvt_pk_bf16_f32 v65, v62, v63
  ds_write_b32 v11, v81 offset:160
  ds_write_b32 v10, v65 offset:2112
  v_mul_f32 v60, s99, v36
  v_mul_f32 v61, s99, v37
  v_mul_f32 v62, s100, v36
  v_mul_f32 v63, s100, v37
  v_cvt_pk_f16_f32 v82, v60, v61
  v_cvt_pk_bf16_f32 v66, v62, v63
  ds_write_b32 v11, v82 offset:320
  ds_write_b32 v10, v66 offset:128
  v_mul_f32 v60, s99, v38
  v_mul_f32 v61, s99, v39
  v_mul_f32 v62, s100, v38
  v_mul_f32 v63, s100, v39
  v_cvt_pk_f16_f32 v83, v60, v61
  v_cvt_pk_bf16_f32 v67, v62, v63
  ds_write_b32 v11, v83 offset:480
  ds_write_b32 v10, v67 offset:2240
  v_mul_f32 v60, s99, v40
  v_mul_f32 v61, s99, v41
  v_mul_f32 v62, s100, v40
  v_mul_f32 v63, s100, v41
  v_cvt_pk_f16_f32 v84, v60, v61
  v_cvt_pk_bf16_f32 v68, v62, v63
  ds_write_b32 v11, v84 offset:640
  ds_write_b32 v10, v68 offset:256
  v_mul_f32 v60, s99, v42
  v_mul_f32 v61, s99, v43
  v_mul_f32 v62, s100, v42
  v_mul_f32 v63, s100, v43
  v_cvt_pk_f16_f32 v85, v60, v61
  v_cvt_pk_bf16_f32 v69, v62, v63
  ds_write_b32 v11, v85 offset:800
  ds_write_b32 v10, v69 offset:2368
  v_mul_f32 v60, s99, v44
  v_mul_f32 v61, s99, v45
  v_mul_f32 v62, s100, v44
  v_mul_f32 v63, s100, v45
  v_cvt_pk_f16_f32 v86, v60, v61
  v_cvt_pk_bf16_f32 v70, v62, v63
  ds_write_b32 v11, v86 offset:960
  ds_write_b32 v10, v70 offset:384
  v_mul_f32 v60, s99, v46
  v_mul_f32 v61, s99, v47
  v_mul_f32 v62, s100, v46
  v_mul_f32 v63, s100, v47
  v_cvt_pk_f16_f32 v87, v60, v61
  v_cvt_pk_bf16_f32 v71, v62, v63
  ds_write_b32 v11, v87 offset:1120
  ds_write_b32 v10, v71 offset:2496
  v_mul_f32 v60, s99, v48
  v_mul_f32 v61, s99, v49
  v_mul_f32 v62, s100, v48
  v_mul_f32 v63, s100, v49
  v_cvt_pk_f16_f32 v88, v60, v61
  v_cvt_pk_bf16_f32 v72, v62, v63
  ds_write_b32 v11, v88 offset:1280
  ds_write_b32 v10, v72 offset:512
  v_mul_f32 v60, s99, v50
  v_mul_f32 v61, s99, v51
  v_mul_f32 v62, s100, v50
  v_mul_f32 v63, s100, v51
  v_cvt_pk_f16_f32 v89, v60, v61
  v_cvt_pk_bf16_f32 v73, v62, v63
  ds_write_b32 v11, v89 offset:1440
  ds_write_b32 v10, v73 offset:2624
  v_mul_f32 v60, s99, v52
  v_mul_f32 v61, s99, v53
  v_mul_f32 v62, s100, v52
  v_mul_f32 v63, s100, v53
  v_cvt_pk_f16_f32 v90, v60, v61
  v_cvt_pk_bf16_f32 v74, v62, v63
  ds_write_b32 v11, v90 offset:1600
  ds_write_b32 v10, v74 offset:640
  v_mul_f32 v60, s99, v54
  v_mul_f32 v61, s99, v55
  v_mul_f32 v62, s100, v54
  v_mul_f32 v63, s100, v55
  v_cvt_pk_f16_f32 v91, v60, v61
  v_cvt_pk_bf16_f32 v75, v62, v63
  ds_write_b32 v11, v91 offset:1760
  ds_write_b32 v10, v75 offset:2752
  v_mul_f32 v60, s99, v56
  v_mul_f32 v61, s99, v57
  v_mul_f32 v62, s100, v56
  v_mul_f32 v63, s100, v57
  v_cvt_pk_f16_f32 v92, v60, v61
  v_cvt_pk_bf16_f32 v76, v62, v63
  ds_write_b32 v11, v92 offset:1920
  ds_write_b32 v10, v76 offset:768
  v_mov_b32 v60, s100
  v_cvt_pk_bf16_f32 v60, v60, v60
  s_mov_b32 exec_hi, 0
  ds_write_b32 v10, v60 offset:2880
  s_mov_b32 exec_hi, -1
  s_waitcnt lgkmcnt(0)
  s_branch L_cconv
L_sdown:
  v_lshlrev_b32 v108, 16, v112
  v_and_b32 v109, 0xffff0000, v112
  v_mul_f32 v108, v108, v250
  v_mul_f32 v109, v109, v250
  v_cvt_pk_bf16_f32 v112, v108, v109
  v_lshlrev_b32 v108, 16, v113
  v_and_b32 v109, 0xffff0000, v113
  v_mul_f32 v108, v108, v250
  v_mul_f32_e64 v109, v109, v250
  v_cvt_pk_bf16_f32 v113, v108, v109
  v_lshlrev_b32 v108, 16, v114
  v_and_b32 v109, 0xffff0000, v114
  v_mul_f32 v108, v108, v250
  v_mul_f32 v109, v109, v250
  v_cvt_pk_bf16_f32 v114, v108, v109
  v_lshlrev_b32 v108, 16, v115
  v_and_b32 v109, 0xffff0000, v115
  v_mul_f32 v108, v108, v250
  v_mul_f32 v109, v109, v250
  v_cvt_pk_bf16_f32 v115, v108, v109
  v_lshlrev_b32 v108, 16, v116
  v_and_b32 v109, 0xffff0000, v116
  v_mul_f32 v108, v108, v250
  v_mul_f32 v109, v109, v250
  v_cvt_pk_bf16_f32 v116, v108, v109
  v_lshlrev_b32 v108, 16, v117
  v_and_b32 v109, 0xffff0000, v117
  v_mul_f32 v108, v108, v250
  v_mul_f32 v109, v109, v250
  v_cvt_pk_bf16_f32 v117, v108, v109
  v_lshlrev_b32_e64 v108, 16, v118
  v_and_b32 v109, 0xffff0000, v118
  v_mul_f32 v108, v108, v250
  v_mul_f32 v109, v109, v250
  v_cvt_pk_bf16_f32 v118, v108, v109
  v_lshlrev_b32 v108, 16, v119
  v_and_b32 v109, 0xffff0000, v119
  v_mul_f32 v108, v108, v250
  v_mul_f32 v109, v109, v250
  v_cvt_pk_bf16_f32 v119, v108, v109
  s_branch L_scaled
L_end:
  s_endpgm
.p2align 8
L_tables:
.long 0x0, 0x1800, 0x6c80, 0x81a0, 0x8, 0x1808, 0x6c88, 0x81a8
.long 0x10, 0x1810, 0x6c90, 0x81b0, 0x18, 0x1818, 0x6c98, 0x81b8
.long 0x40, 0x1d48, 0x71c8, 0x86e8, 0x48, 0x1d50, 0x71d0, 0x86f0
.long 0x50, 0x1d58, 0x71d8, 0x86f8, 0x58, 0x1d60, 0x71e0, 0x8700
.long 0x80, 0x2290, 0x7710, 0x8c30, 0x88, 0x2298, 0x7718, 0x8c38
.long 0x90, 0x22a0, 0x7720, 0x8c40, 0x98, 0x22a8, 0x7728, 0x8c48
.long 0xc0, 0x27d8, 0x7c58, 0x9178, 0xc8, 0x27e0, 0x7c60, 0x9180
.long 0xd0, 0x27e8, 0x7c68, 0x9188, 0xd8, 0x27f0, 0x7c70, 0x9190
.long 0x20, 0x1820, 0x6ca0, 0x81c0, 0x28, 0x1828, 0x6ca8, 0x81c8
.long 0x30, 0x1830, 0x6cb0, 0x81d0, 0x38, 0x1838, 0x6cb8, 0x81d8
.long 0x60, 0x1d68, 0x71e8, 0x8708, 0x68, 0x1d70, 0x71f0, 0x8710
.long 0x70, 0x1d78, 0x71f8, 0x8718, 0x78, 0x1d80, 0x7200, 0x8720
.long 0xa0, 0x22b0, 0x7730, 0x8c50, 0xa8, 0x22b8, 0x7738, 0x8c58
.long 0xb0, 0x22c0, 0x7740, 0x8c60, 0xb8, 0x22c8, 0x7748, 0x8c68
.long 0xe0, 0x27f8, 0x7c78, 0x9198, 0xe8, 0x2800, 0x7c80, 0x91a0
.long 0xf0, 0x2808, 0x7c88, 0x91a8, 0xf8, 0x2810, 0x7c90, 0x91b0
.long 0x200, 0x4240, 0x96c0, 0x9c08, 0x208, 0x4248, 0x96c8, 0x9c10
.long 0x210, 0x4250, 0x96d0, 0x9c18, 0x218, 0x4258, 0x96d8, 0x9c20
.long 0x240, 0x4788, 0x9c08, 0x9c08, 0x248, 0x4790, 0x9c10, 0x9c10
.long 0x250, 0x4798, 0x9c18, 0x9c18, 0x258, 0x47a0, 0x9c20, 0x9c20
.long 0x280, 0x4cd0, 0x9c08, 0x9c08, 0x288, 0x4cd8, 0x9c10, 0x9c10
.long 0x290, 0x4ce0, 0x9c18, 0x9c18, 0x298, 0x4ce8, 0x9c20, 0x9c20
.long 0x2c0, 0x5218, 0x9c08, 0x9c08, 0x2c8, 0x5220, 0x9c10, 0x9c10
.long 0x2d0, 0x5228, 0x9c18, 0x9c18, 0x2d8, 0x5230, 0x9c20, 0x9c20
.long 0x220, 0x4260, 0x96e0, 0x9c28, 0x228, 0x4268, 0x96e8, 0x9c30
.long 0x230, 0x4270, 0x96f0, 0x9c38, 0x238, 0x4278, 0x96f8, 0x9c40
.long 0x260, 0x47a8, 0x9c28, 0x9c28, 0x268, 0x47b0, 0x9c30, 0x9c30
.long 0x270, 0x47b8, 0x9c38, 0x9c38, 0x278, 0x47c0, 0x9c40, 0x9c40
.long 0x2a0, 0x4cf0, 0x9c28, 0x9c28, 0x2a8, 0x4cf8, 0x9c30, 0x9c30
.long 0x2b0, 0x4d00, 0x9c38, 0x9c38, 0x2b8, 0x4d08, 0x9c40, 0x9c40
.long 0x2e0, 0x5238, 0x9c28, 0x9c28, 0x2e8, 0x5240, 0x9c30, 0x9c30
.long 0x2f0, 0x5248, 0x9c38, 0x9c38, 0x2f8, 0x5250, 0x9c40, 0x9c40
.long 0x1fa28, 0x1f9f4, 0x34, 0x14d00, 0x1fa28, 0x1f9f6, 0x74, 0x14d04
.long 0x1fa28, 0x1f9f8, 0xb4, 0x14d08, 0x1fa28, 0x1f9fa, 0xf4, 0x14d0c
.long 0x1fa28, 0x1f9fc, 0x134, 0x14d10, 0x1fa28, 0x1f9fe, 0x174, 0x14d14
.long 0x1fa28, 0x1fa00, 0x1b4, 0x14d18, 0x1fa28, 0x1fa02, 0x1f4, 0x14d1c
.long 0x1fa28, 0x1fa04, 0x234, 0x14d20, 0x1fa28, 0x1fa06, 0x274, 0x14d24
.long 0x1fa28, 0x1fa08, 0x2b4, 0x14d28, 0x1fa28, 0x1fa0a, 0x2f4, 0x14d2c
.long 0x1fa28, 0x1fa0c, 0x334, 0x14d30, 0x1fa28, 0x1fa0e, 0x374, 0x14d34
.long 0x1fa28, 0x1fa10, 0x3b4, 0x14d38, 0x1fa28, 0x1fa12, 0x3f4, 0x14d3c
.long 0x1fa28, 0x1fa14, 0x434, 0x14d00, 0x1fa28, 0x1fa16, 0x474, 0x14d04
.long 0x1fa28, 0x1fa18, 0x4b4, 0x14d08, 0x1fa28, 0x1fa1a, 0x4f4, 0x14d0c
.long 0x1fa28, 0x1fa1c, 0x534, 0x14d10, 0x1fa28, 0x1fa1e, 0x574, 0x14d14
.long 0x1fa28, 0x1fa20, 0x5b4, 0x14d18, 0x1fa28, 0x1fa22, 0x5f4, 0x14d1c
.long 0x1fa28, 0x1fa24, 0x634, 0x14d20, 0x1fa28, 0x1fa26, 0x674, 0x14d24
.long 0x1fa28, 0x1fa28, 0x6b4, 0x14d28, 0x1fa28, 0x1fa2a, 0x6f4, 0x14d2c
.long 0x1fa28, 0x1fa2c, 0x734, 0x14d30, 0x1fa28, 0x1fa2e, 0x774, 0x14d34
.long 0x1fa28, 0x1fa30, 0x7b4, 0x14d38, 0x1fa28, 0x1fa32, 0x7f4, 0x14d3c
.long 0x1fa38, 0x1fa34, 0x834, 0x14d00, 0x1fa38, 0x1fa36, 0x874, 0x14d04
.long 0x1fa38, 0x1fa38, 0x8b4, 0x14d08, 0x1fa38, 0x1fa3a, 0x8f4, 0x14d0c
.long 0x1fa38, 0x1fa3c, 0x934, 0x14d10, 0x1fa38, 0x1fa3e, 0x974, 0x14d14
.long 0x1fa38, 0x1fa40, 0x9b4, 0x14d18, 0x1fa38, 0x1fa42, 0x9f4, 0x14d1c
.long 0x1fa38, 0x1fa44, 0xa34, 0x14d20, 0x1fa38, 0x1fa46, 0xa74, 0x14d24
.long 0x1fa38, 0x1fa48, 0xab4, 0x14d28, 0x1fa38, 0x1fa4a, 0xaf4, 0x14d2c
.long 0x1fa38, 0x1fa4c, 0xb34, 0x14d30, 0x1fa38, 0x1fa4e, 0xb74, 0x14d34
.long 0x1fa38, 0x1fa50, 0xbb4, 0x14d38, 0x1fa38, 0x1fa52, 0xbf4, 0x14d3c
.long 0x1fa38, 0x1fa54, 0xc34, 0x14d00, 0x1fa38, 0x1fa56, 0xc74, 0x14d04
.long 0x1fa38, 0x1fa58, 0xcb4, 0x14d08, 0x1fa38, 0x1fa5a, 0xcf4, 0x14d0c
.long 0x1fa38, 0x1fa5c, 0xd34, 0x14d10, 0x1fa38, 0x1fa5e, 0xd74, 0x14d14
.long 0x1fa38, 0x1fa60, 0xdb4, 0x14d18, 0x1fa38, 0x1fa62, 0xdf4, 0x14d1c
.long 0x1fa38, 0x1fa64, 0xe34, 0x14d20, 0x1fa38, 0x1fa66, 0xe74, 0x14d24
.long 0x1fa38, 0x1fa68, 0xeb4, 0x14d28, 0x1fa38, 0x1fa6a, 0xef4, 0x14d2c
.long 0x1fa38, 0x1fa6c, 0xf34, 0x14d30, 0x1fa38, 0x1fa6e, 0xf74, 0x14d34
.long 0x1fa38, 0x1fa70, 0xfb4, 0x14d38, 0x1fa38, 0x1fa72, 0xff4, 0x14d3c
.long 0xaae0, 0xa680, 0xa900, 0xaae0, 0xaae8, 0xa688, 0xa908, 0xaae8
.long 0xaaf0, 0xa690, 0xa910, 0xaaf0, 0xaaf8, 0xa698, 0xa918, 0xaaf8
.long 0xaa40, 0xa860, 0xa9a0, 0xaa40, 0xaa48, 0xa868, 0xa9a8, 0xaa48
.long 0xaa50, 0xa870, 0xa9b0, 0xaa50, 0xaa58, 0xa878, 0xa9b8, 0xaa58
.long 0xa400, 0xa7c0, 0xa540, 0xa400, 0xa408, 0xa7c8, 0xa548, 0xa408
.long 0xa410, 0xa7d0, 0xa550, 0xa410, 0xa418, 0xa7d8, 0xa558, 0xa418
.long 0xa4a0, 0xa720, 0xa5e0, 0xa4a0, 0xa4a8, 0xa728, 0xa5e8, 0xa4a8
.long 0xa4b0, 0xa730, 0xa5f0, 0xa4b0, 0xa4b8, 0xa738, 0xa5f8, 0xa4b8
.long 0xb260, 0xb4e0, 0xb6c0, 0xb260, 0xb268, 0xb4e8, 0xb6c8, 0xb268
.long 0xb270, 0xb4f0, 0xb6d0, 0xb270, 0xb278, 0xb4f8, 0xb6d8, 0xb278
.long 0xb1c0, 0xb300, 0xb760, 0xb1c0, 0xb1c8, 0xb308, 0xb768, 0xb1c8
.long 0xb1d0, 0xb310, 0xb770, 0xb1d0, 0xb1d8, 0xb318, 0xb778, 0xb1d8
.long 0xb580, 0xb440, 0xb080, 0xb580, 0xb588, 0xb448, 0xb088, 0xb588
.long 0xb590, 0xb450, 0xb090, 0xb590, 0xb598, 0xb458, 0xb098, 0xb598
.long 0xb620, 0xb3a0, 0xb120, 0xb620, 0xb628, 0xb3a8, 0xb128, 0xb628
.long 0xb630, 0xb3b0, 0xb130, 0xb630, 0xb638, 0xb3b8, 0xb138, 0xb638
.long 0xa900, 0xa400, 0xaae0, 0xb620, 0xa908, 0xa408, 0xaae8, 0xb628
.long 0xa910, 0xa410, 0xaaf0, 0xb630, 0xa918, 0xa418, 0xaaf8, 0xb638
.long 0xa9a0, 0xa4a0, 0xab80, 0xb800, 0xa9a8, 0xa4a8, 0xab88, 0xb808
.long 0xa9b0, 0xa4b0, 0xab90, 0xb810, 0xa9b8, 0xa4b8, 0xab98, 0xb818
.long 0xaa40, 0xa680, 0xa860, 0xb3a0, 0xaa48, 0xa688, 0xa868, 0xb3a8
.long 0xaa50, 0xa690, 0xa870, 0xb3b0, 0xaa58, 0xa698, 0xa878, 0xb3b8
.long 0xa720, 0xa540, 0xa7c0, 0xb1c0, 0xa728, 0xa548, 0xa7c8, 0xb1c8
.long 0xa730, 0xa550, 0xa7d0, 0xb1d0, 0xa738, 0xa558, 0xa7d8, 0xb1d8
.long 0xa5e0, 0xaae0, 0xa400, 0xb080, 0xa5e8, 0xaae8, 0xa408, 0xb088
.long 0xa5f0, 0xaaf0, 0xa410, 0xb090, 0xa5f8, 0xaaf8, 0xa418, 0xb098
.long 0xa7c0, 0xa540, 0xa720, 0xb760, 0xa7c8, 0xa548, 0xa728, 0xb768
.long 0xa7d0, 0xa550, 0xa730, 0xb770, 0xa7d8, 0xa558, 0xa738, 0xb778
.long 0xa860, 0xa680, 0xaa40, 0xb440, 0xa868, 0xa688, 0xaa48, 0xb448
.long 0xa870, 0xa690, 0xaa50, 0xb450, 0xa878, 0xa698, 0xaa58, 0xb458
.long 0xab80, 0xa4a0, 0xa9a0, 0xb4e0, 0xab88, 0xa4a8, 0xa9a8, 0xb4e8
.long 0xab90, 0xa4b0, 0xa9b0, 0xb4f0, 0xab98, 0xa4b8, 0xa9b8, 0xb4f8
.long 0xa680, 0xa900, 0xab80, 0xa4a0, 0xa688, 0xa908, 0xab88, 0xa4a8
.long 0xa690, 0xa910, 0xab90, 0xa4b0, 0xa698, 0xa918, 0xab98, 0xa4b8
.long 0xa860, 0xa9a0, 0xb1c0, 0xb440, 0xa868, 0xa9a8, 0xb1c8, 0xb448
.long 0xa870, 0xa9b0, 0xb1d0, 0xb450, 0xa878, 0xa9b8, 0xb1d8, 0xb458
.long 0xa7c0, 0xa540, 0xab80, 0xa4a0, 0xa7c8, 0xa548, 0xab88, 0xa4a8
.long 0xa7d0, 0xa550, 0xab90, 0xa4b0, 0xa7d8, 0xa558, 0xab98, 0xa4b8
.long 0xa720, 0xa5e0, 0xb1c0, 0xb440, 0xa728, 0xa5e8, 0xb1c8, 0xb448
.long 0xa730, 0xa5f0, 0xb1d0, 0xb450, 0xa738, 0xa5f8, 0xb1d8, 0xb458
.long 0xb4e0, 0xb6c0, 0xb800, 0xa860, 0xb4e8, 0xb6c8, 0xb808, 0xa868
.long 0xb4f0, 0xb6d0, 0xb810, 0xa870, 0xb4f8, 0xb6d8, 0xb818, 0xa878
.long 0xb300, 0xb760, 0xa540, 0xa900, 0xb308, 0xb768, 0xa548, 0xa908
.long 0xb310, 0xb770, 0xa550, 0xa910, 0xb318, 0xb778, 0xa558, 0xa918
.long 0xb440, 0xb080, 0xb800, 0xa860, 0xb448, 0xb088, 0xb808, 0xa868
.long 0xb450, 0xb090, 0xb810, 0xa870, 0xb458, 0xb098, 0xb818, 0xa878
.long 0xb3a0, 0xb120, 0xa540, 0xa900, 0xb3a8, 0xb128, 0xa548, 0xa908
.long 0xb3b0, 0xb130, 0xa550, 0xa910, 0xb3b8, 0xb138, 0xa558, 0xa918
.long 0xb120, 0xb580, 0xb080, 0xb300, 0xb128, 0xb588, 0xb088, 0xb308
.long 0xb130, 0xb590, 0xb090, 0xb310, 0xb138, 0xb598, 0xb098, 0xb318
.long 0xb6c0, 0xb4e0, 0xaa40, 0xb6c0, 0xb6c8, 0xb4e8, 0xaa48, 0xb6c8
.long 0xb6d0, 0xb4f0, 0xaa50, 0xb6d0, 0xb6d8, 0xb4f8, 0xaa58, 0xb6d8
.long 0xb300, 0xb440, 0xb080, 0xb300, 0xb308, 0xb448, 0xb088, 0xb308
.long 0xb310, 0xb450, 0xb090, 0xb310, 0xb318, 0xb458, 0xb098, 0xb318
.long 0xb260, 0xb760, 0xaa40, 0xb6c0, 0xb268, 0xb768, 0xaa48, 0xb6c8
.long 0xb270, 0xb770, 0xaa50, 0xb6d0, 0xb278, 0xb778, 0xaa58, 0xb6d8
.long 0xb580, 0xb120, 0xb620, 0xa680, 0xb588, 0xb128, 0xb628, 0xa688
.long 0xb590, 0xb130, 0xb630, 0xa690, 0xb598, 0xb138, 0xb638, 0xa698
.long 0xb260, 0xb1c0, 0xa7c0, 0xa680, 0xb268, 0xb1c8, 0xa7c8, 0xa688
.long 0xb270, 0xb1d0, 0xa7d0, 0xa690, 0xb278, 0xb1d8, 0xa7d8, 0xa698
.long 0xb300, 0xb3a0, 0xb620, 0xb300, 0xb308, 0xb3a8, 0xb628, 0xb308
.long 0xb310, 0xb3b0, 0xb630, 0xb310, 0xb318, 0xb3b8, 0xb638, 0xb318
.long 0xb6c0, 0xb800, 0xa7c0, 0xb300, 0xb6c8, 0xb808, 0xa7c8, 0xb308
.long 0xb6d0, 0xb810, 0xa7d0, 0xb310, 0xb6d8, 0xb818, 0xa7d8, 0xb318
.long 0x0, 0x200, 0x0, 0x3f803f80, 0x8, 0x208, 0x0, 0x3f803f80
.long 0x10, 0x210, 0x0, 0x3f803f80, 0x18, 0x218, 0x0, 0x3f803f80
.long 0x420, 0x620, 0x0, 0x3f803f80, 0x428, 0x628, 0x0, 0x3f803f80
.long 0x430, 0x630, 0x0, 0x3f803f80, 0x438, 0x638, 0x0, 0x3f803f80
.long 0x840, 0xa40, 0x10, 0x3f803f80, 0x848, 0xa48, 0x10, 0x3f803f80
.long 0x850, 0xa50, 0x10, 0x3f803f80, 0x858, 0xa58, 0x10, 0x3f803f80
.long 0xc60, 0xe60, 0x10, 0x3f803f80, 0xc68, 0xe68, 0x10, 0x3f803f80
.long 0xc70, 0xe70, 0x10, 0x3f803f80, 0xc78, 0xe78, 0x10, 0x3f803f80
.long 0x80, 0x280, 0x20, 0x3f803f80, 0x88, 0x288, 0x20, 0x3f803f80
.long 0x90, 0x290, 0x20, 0x3f803f80, 0x98, 0x298, 0x20, 0x3f803f80
.long 0x4a0, 0x6a0, 0x20, 0x3f803f80, 0x4a8, 0x6a8, 0x20, 0x3f803f80
.long 0x4b0, 0x6b0, 0x20, 0x3f803f80, 0x4b8, 0x6b8, 0x20, 0x3f803f80
.long 0x8c0, 0xac0, 0x30, 0x3f803f80, 0x8c8, 0xac8, 0x30, 0x3f803f80
.long 0x8d0, 0xad0, 0x30, 0x3f803f80, 0x8d8, 0xad8, 0x30, 0x3f803f80
.long 0xce0, 0xee0, 0x30, 0x3f803f80, 0xce8, 0xee8, 0x30, 0x3f803f80
.long 0xcf0, 0xef0, 0x30, 0x3f803f80, 0xcf8, 0xef8, 0x30, 0x3f803f80
.long 0x100, 0x300, 0x40, 0x0, 0x108, 0x308, 0x40, 0x0
.long 0x110, 0x310, 0x40, 0x0, 0x118, 0x318, 0x40, 0x0
.long 0x520, 0x720, 0x40, 0x0, 0x528, 0x728, 0x40, 0x0
.long 0x530, 0x730, 0x40, 0x0, 0x538, 0x738, 0x40, 0x0
.long 0x940, 0xb40, 0x50, 0x0, 0x948, 0xb48, 0x50, 0x0
.long 0x950, 0xb50, 0x50, 0x0, 0x958, 0xb58, 0x50, 0x0
.long 0xd60, 0xf60, 0x50, 0x0, 0xd68, 0xf68, 0x50, 0x0
.long 0xd70, 0xf70, 0x50, 0x0, 0xd78, 0xf78, 0x50, 0x0
.long 0x180, 0xf60, 0x60, 0x0, 0x188, 0xf68, 0x60, 0x0
.long 0x190, 0xf70, 0x60, 0x0, 0x198, 0xf78, 0x60, 0x0
.long 0x5a0, 0xf60, 0x60, 0x0, 0x5a8, 0xf68, 0x60, 0x0
.long 0x5b0, 0xf70, 0x60, 0x0, 0x5b8, 0xf78, 0x60, 0x0
.long 0x9c0, 0xf60, 0x70, 0x0, 0x9c8, 0xf68, 0x70, 0x0
.long 0x9d0, 0xf70, 0x70, 0x0, 0x9d8, 0xf78, 0x70, 0x0
.long 0xde0, 0xf60, 0x70, 0x0, 0xde8, 0xf68, 0x70, 0x0
.long 0xdf0, 0xf70, 0x70, 0x0, 0xdf8, 0xf78, 0x70, 0x0
.long 0xffff, 0x0, 0x0, 0x0, 0x0, 0x0, 0xffff, 0x0
.long 0x0, 0x0, 0x0, 0x0, 0x0, 0x0, 0x0, 0x0
.long 0x0, 0x0, 0x0, 0x0, 0x0, 0x0, 0x0, 0x0
.long 0x0, 0x0, 0x0, 0x0, 0x0, 0x0, 0x0, 0x0
.long 0xffff0000, 0x0, 0x0, 0x0, 0x0, 0x0, 0xffff0000, 0x0
.long 0x0, 0x0, 0x0, 0x0, 0x0, 0x0, 0x0, 0x0
.long 0x0, 0x0, 0x0, 0x0, 0x0, 0x0, 0x0, 0x0
.long 0x0, 0x0, 0x0, 0x0, 0x0, 0x0, 0x0, 0x0
.long 0x0, 0xffff, 0x0, 0x0, 0x0, 0x0, 0x0, 0xffff
.long 0x0, 0x0, 0x0, 0x0, 0x0, 0x0, 0x0, 0x0
.long 0x0, 0x0, 0x0, 0x0, 0x0, 0x0, 0x0, 0x0
.long 0x0, 0x0, 0x0, 0x0, 0x0, 0x0, 0x0, 0x0
.long 0x0, 0xffff0000, 0x0, 0x0, 0x0, 0x0, 0x0, 0xffff0000
.long 0x0, 0x0, 0x0, 0x0, 0x0, 0x0, 0x0, 0x0
.long 0x0, 0x0, 0x0, 0x0, 0x0, 0x0, 0x0, 0x0
.long 0x0, 0x0, 0x0, 0x0, 0x0, 0x0, 0x0, 0x0
.long 0x0, 0x0, 0x0, 0x0, 0x0, 0x0, 0x0, 0x0
.long 0xffff, 0x0, 0x0, 0x0, 0x0, 0x0, 0xffff, 0x0
.long 0x0, 0x0, 0x0, 0x0, 0x0, 0x0, 0x0, 0x0
.long 0x0, 0x0, 0x0, 0x0, 0x0, 0x0, 0x0, 0x0
.long 0x0, 0x0, 0x0, 0x0, 0x0, 0x0, 0x0, 0x0
.long 0xffff0000, 0x0, 0x0, 0x0, 0x0, 0x0, 0xffff0000, 0x0
.long 0x0, 0x0, 0x0, 0x0, 0x0, 0x0, 0x0, 0x0
.long 0x0, 0x0, 0x0, 0x0, 0x0, 0x0, 0x0, 0x0
.long 0x0, 0x0, 0x0, 0x0, 0x0, 0x0, 0x0, 0x0
.long 0x0, 0xffff, 0x0, 0x0, 0x0, 0x0, 0x0, 0xffff
.long 0x0, 0x0, 0x0, 0x0, 0x0, 0x0, 0x0, 0x0
.long 0x0, 0x0, 0x0, 0x0, 0x0, 0x0, 0x0, 0x0
.long 0x0, 0x0, 0x0, 0x0, 0x0, 0x0, 0x0, 0x0
.long 0x0, 0xffff0000, 0x0, 0x0, 0x0, 0x0, 0x0, 0xffff0000
.long 0x0, 0x0, 0x0, 0x0, 0x0, 0x0, 0x0, 0x0
.long 0x0, 0x0, 0x0, 0x0, 0x0, 0x0, 0x0, 0x0
.long 0x0, 0x0, 0x0, 0x0, 0x0, 0x0, 0x0, 0x0
.long 0x0, 0x0, 0x0, 0x0, 0x0, 0x0, 0x0, 0x0
.long 0x0, 0x0, 0xffff, 0x0, 0x0, 0x0, 0x0, 0x0
.long 0x0, 0x0, 0x0, 0x0, 0xffff, 0x0, 0x0, 0x0
.long 0x0, 0x0, 0x0, 0x0, 0x0, 0x0, 0x0, 0x0
.long 0x0, 0x0, 0x0, 0x0, 0x0, 0x0, 0x0, 0x0
.long 0x0, 0x0, 0xffff0000, 0x0, 0x0, 0x0, 0x0, 0x0
.long 0x0, 0x0, 0x0, 0x0, 0xffff0000, 0x0, 0x0, 0x0
.long 0x0, 0x0, 0x0, 0x0, 0x0, 0x0, 0x0, 0x0
.long 0x0, 0x0, 0x0, 0x0, 0x0, 0x0, 0x0, 0x0
.long 0x0, 0x0, 0x0, 0xffff, 0x0, 0x0, 0x0, 0x0
.long 0x0, 0x0, 0x0, 0x0, 0x0, 0xffff, 0x0, 0x0
.long 0x0, 0x0, 0x0, 0x0, 0x0, 0x0, 0x0, 0x0
.long 0x0, 0x0, 0x0, 0x0, 0x0, 0x0, 0x0, 0x0
.long 0x0, 0x0, 0x0, 0xffff0000, 0x0, 0x0, 0x0, 0x0
.long 0x0, 0x0, 0x0, 0x0, 0x0, 0xffff0000, 0x0, 0x0
.long 0x0, 0x0, 0x0, 0x0, 0x0, 0x0, 0x0, 0x0
.long 0x0, 0x0, 0x0, 0x0, 0x0, 0x0, 0x0, 0x0
.long 0x0, 0x0, 0x0, 0x0, 0xffff, 0x0, 0x0, 0x0
.long 0x0, 0x0, 0x0, 0x0, 0x0, 0x0, 0x0, 0x0
.long 0x0, 0x0, 0x0, 0x0, 0x0, 0x0, 0x0, 0x0
.long 0x0, 0x0, 0x0, 0x0, 0x0, 0x0, 0x0, 0x0
.long 0x0, 0x0, 0x0, 0x0, 0xffff0000, 0x0, 0x0, 0x0
.long 0x0, 0x0, 0x0, 0x0, 0x0, 0x0, 0x0, 0x0
.long 0x0, 0x0, 0x0, 0x0, 0x0, 0x0, 0x0, 0x0
.long 0x0, 0x0, 0x0, 0x0, 0x0, 0x0, 0x0, 0x0
.long 0x0, 0x0, 0x0, 0x0, 0x0, 0x0, 0x0, 0x0
.long 0x0, 0x0, 0x0, 0x0, 0x0, 0x0, 0x0, 0x0
.long 0x0, 0x0, 0x0, 0x0, 0x0, 0x0, 0x0, 0x0
.long 0x0, 0x0, 0x0, 0x0, 0x0, 0x0, 0x0, 0x0
.long 0x0, 0x0, 0x0, 0x0, 0x0, 0x0, 0x0, 0x0
.long 0x0, 0x0, 0x0, 0x0, 0x0, 0x0, 0x0, 0x0
.long 0x14d40, 0x14d40, 0x0, 0x0, 0x14e10, 0x14e10, 0x20, 0x20
.long 0x14ee0, 0x14ee0, 0x100000, 0x100000, 0x14fb0, 0x14fb0, 0x100020, 0x100020
.long 0x15080, 0x15080, 0x40, 0x40, 0x15150, 0x15150, 0x60, 0x60
.long 0x15220, 0x15220, 0x100040, 0x100040, 0x100000, 0x100000, 0x100060, 0x100060
.long 0x14d74, 0x14d74, 0x80, 0x80, 0x14e44, 0x14e44, 0xa0, 0xa0
.long 0x14f14, 0x14f14, 0x100080, 0x100080, 0x14fe4, 0x14fe4, 0x1000a0, 0x1000a0
.long 0x150b4, 0x150b4, 0xc0, 0xc0, 0x15184, 0x15184, 0xe0, 0xe0
.long 0x15254, 0x15254, 0x1000c0, 0x1000c0, 0x100000, 0x100000, 0x1000e0, 0x1000e0
.long 0x14da8, 0x14da8, 0x8, 0x100, 0x14e78, 0x14e78, 0x28, 0x120
.long 0x14f48, 0x14f48, 0x100008, 0x100100, 0x15018, 0x15018, 0x100028, 0x100120
.long 0x150e8, 0x150e8, 0x48, 0x140, 0x151b8, 0x151b8, 0x68, 0x160
.long 0x100000, 0x100000, 0x100048, 0x100140, 0x100000, 0x100000, 0x100068, 0x100160
.long 0x14ddc, 0x14ddc, 0x88, 0x180, 0x14eac, 0x14eac, 0xa8, 0x1a0
.long 0x14f7c, 0x14f7c, 0x100088, 0x100180, 0x1504c, 0x1504c, 0x1000a8, 0x1001a0
.long 0x1511c, 0x1511c, 0xc8, 0x1c0, 0x151ec, 0x151ec, 0xe8, 0x1e0
.long 0x100000, 0x100000, 0x1000c8, 0x1001c0, 0x100000, 0x100000, 0x1000e8, 0x1001e0
.long 0x17780, 0x114d40, 0x100, 0x200, 0x17850, 0x114e10, 0x120, 0x220
.long 0x17920, 0x114ee0, 0x100100, 0x100200, 0x179f0, 0x114fb0, 0x100120, 0x100220
.long 0x17ac0, 0x115080, 0x140, 0x240, 0x17b90, 0x115150, 0x160, 0x260
.long 0x17c60, 0x115220, 0x100140, 0x100240, 0x102a40, 0x200000, 0x100160, 0x100260
.long 0x177b4, 0x114d74, 0x180, 0x280, 0x17884, 0x114e44, 0x1a0, 0x2a0
.long 0x17954, 0x114f14, 0x100180, 0x100280, 0x17a24, 0x114fe4, 0x1001a0, 0x1002a0
.long 0x17af4, 0x1150b4, 0x1c0, 0x2c0, 0x17bc4, 0x115184, 0x1e0, 0x2e0
.long 0x17c94, 0x115254, 0x1001c0, 0x1002c0, 0x102a40, 0x200000, 0x1001e0, 0x1002e0
.long 0x177e8, 0x114da8, 0x108, 0x300, 0x178b8, 0x114e78, 0x128, 0x320
.long 0x17988, 0x114f48, 0x100108, 0x100300, 0x17a58, 0x115018, 0x100128, 0x100320
.long 0x17b28, 0x1150e8, 0x148, 0x340, 0x17bf8, 0x1151b8, 0x168, 0x360
.long 0x102a40, 0x200000, 0x100148, 0x100340, 0x102a40, 0x200000, 0x100168, 0x100360
.long 0x1781c, 0x114ddc, 0x188, 0x380, 0x178ec, 0x114eac, 0x1a8, 0x3a0
.long 0x179bc, 0x114f7c, 0x100188, 0x100380, 0x17a8c, 0x11504c, 0x1001a8, 0x1003a0
.long 0x17b5c, 0x11511c, 0x1c8, 0x3c0, 0x17c2c, 0x1151ec, 0x1e8, 0x3e0
.long 0x102a40, 0x200000, 0x1001c8, 0x1003c0, 0x102a40, 0x200000, 0x1001e8, 0x1003e0
.long 0xa400, 0xd00, 0x0, 0x14d40, 0xa440, 0xd00, 0x0, 0x14d80
.long 0xa480, 0xd00, 0x1, 0x14dd0, 0xa4c0, 0xd00, 0x1, 0x14e10
.long 0xa500, 0xd00, 0x2, 0x14e60, 0xa540, 0xd00, 0x2, 0x14ea0
.long 0xa580, 0xd00, 0x3, 0x14ef0, 0xa5c0, 0xd00, 0x3, 0x14f30
.long 0xa600, 0xd00, 0x4, 0x14f40, 0xa640, 0xd00, 0x4, 0x14f80
.long 0xa680, 0xd00, 0x5, 0x14fd0, 0xa6c0, 0xd00, 0x5, 0x15010
.long 0xa700, 0xd00, 0x6, 0x15060, 0xa740, 0xd00, 0x6, 0x150a0
.long 0xa780, 0xd00, 0x7, 0x150f0, 0xa7c0, 0xd00, 0x7, 0x15130
.long 0xa800, 0xd00, 0x8, 0x15140, 0xa840, 0xd00, 0x8, 0x15180
.long 0xa880, 0xd00, 0x9, 0x151d0, 0xa8c0, 0xd00, 0x9, 0x15210
.long 0xa900, 0xd00, 0xa, 0x15260, 0xa940, 0xd00, 0xa, 0x152a0
.long 0xa980, 0xd00, 0xb, 0x152f0, 0xa9c0, 0xd00, 0xb, 0x15330
.long 0xaa00, 0xd00, 0xc, 0x15340, 0xaa40, 0xd00, 0xc, 0x15380
.long 0x1f680, 0x40, 0xd, 0x153d0, 0x100000, 0xd00, 0xd, 0x15410
.long 0x100000, 0xd00, 0xe, 0x15460, 0x100000, 0xd00, 0xe, 0x154a0
.long 0x100000, 0xd00, 0xf, 0x154f0, 0x100000, 0xd00, 0xf, 0x15530
.long 0xa400, 0xd00, 0x2, 0x14d60, 0xa440, 0xd00, 0x2, 0x14da0
.long 0xa480, 0xd00, 0x3, 0x14df0, 0xa4c0, 0xd00, 0x3, 0x14e30
.long 0xa500, 0xd00, 0x4, 0x14e40, 0xa540, 0xd00, 0x4, 0x14e80
.long 0xa580, 0xd00, 0x5, 0x14ed0, 0xa5c0, 0xd00, 0x5, 0x14f10
.long 0xa600, 0xd00, 0x6, 0x14f60, 0xa640, 0xd00, 0x6, 0x14fa0
.long 0xa680, 0xd00, 0x7, 0x14ff0, 0xa6c0, 0xd00, 0x7, 0x15030
.long 0xa700, 0xd00, 0x8, 0x15040, 0xa740, 0xd00, 0x8, 0x15080
.long 0xa780, 0xd00, 0x9, 0x150d0, 0xa7c0, 0xd00, 0x9, 0x15110
.long 0xa800, 0xd00, 0xa, 0x15160, 0xa840, 0xd00, 0xa, 0x151a0
.long 0xa880, 0xd00, 0xb, 0x151f0, 0xa8c0, 0xd00, 0xb, 0x15230
.long 0xa900, 0xd00, 0xc, 0x15240, 0xa940, 0xd00, 0xc, 0x15280
.long 0xa980, 0xd00, 0xd, 0x152d0, 0xa9c0, 0xd00, 0xd, 0x15310
.long 0xaa00, 0xd00, 0xe, 0x15360, 0xaa40, 0xd00, 0xe, 0x153a0
.long 0x1f680, 0x40, 0xf, 0x153f0, 0x100000, 0xd00, 0xf, 0x15430
.long 0x100000, 0xd00, 0x10, 0x15440, 0x100000, 0xd00, 0x10, 0x15480
.long 0x100000, 0xd00, 0x11, 0x154d0, 0x100000, 0xd00, 0x11, 0x15510
.long 0x1f690, 0x1f890, 0x1f9c0, 0x1f9e0, 0x1f698, 0x1f898, 0x1f9c8, 0x1f9e8
.long 0x1f680, 0x1f880, 0x1f9d0, 0x1f9f0, 0x1f688, 0x1f888, 0x1f9d8, 0x100000
.long 0x1fd20, 0x1ff20, 0x1f9c2, 0x1f9e2, 0x1fd28, 0x1ff28, 0x1f9ca, 0x1f9ea
.long 0x1fd30, 0x1ff30, 0x1f9d2, 0x1f9f2, 0x1fd38, 0x1ff38, 0x1f9da, 0x100000
.long 0x1f6f0, 0x1f8f0, 0x1f9c4, 0x1f9e4, 0x1f6f8, 0x1f8f8, 0x1f9cc, 0x1f9ec
.long 0x1f6e0, 0x1f8e0, 0x1f9d4, 0x100000, 0x1f6e8, 0x1f8e8, 0x1f9dc, 0x100000
.long 0x1fd40, 0x1ff40, 0x1f9c6, 0x1f9e6, 0x1fd48, 0x1ff48, 0x1f9ce, 0x1f9ee
.long 0x1fd50, 0x1ff50, 0x1f9d6, 0x100000, 0x1fd58, 0x1ff58, 0x1f9de, 0x100000
.long 0x1f710, 0x1f910, 0x1f9c0, 0x1f9e0, 0x1f718, 0x1f918, 0x1f9c8, 0x1f9e8
.long 0x1f700, 0x1f900, 0x1f9d0, 0x1f9f0, 0x1f708, 0x1f908, 0x1f9d8, 0x100000
.long 0x1fda0, 0x1ffa0, 0x1f9c2, 0x1f9e2, 0x1fda8, 0x1ffa8, 0x1f9ca, 0x1f9ea
.long 0x1fdb0, 0x1ffb0, 0x1f9d2, 0x1f9f2, 0x1fdb8, 0x1ffb8, 0x1f9da, 0x100000
.long 0x1f770, 0x1f970, 0x1f9c4, 0x1f9e4, 0x1f778, 0x1f978, 0x1f9cc, 0x1f9ec
.long 0x1f760, 0x1f960, 0x1f9d4, 0x100000, 0x1f768, 0x1f968, 0x1f9dc, 0x100000
.long 0x1fdc0, 0x1ffc0, 0x1f9c6, 0x1f9e6, 0x1fdc8, 0x1ffc8, 0x1f9ce, 0x1f9ee
.long 0x1fdd0, 0x1ffd0, 0x1f9d6, 0x100000, 0x1fdd8, 0x1ffd8, 0x1f9de, 0x100000
.long 0x1f790, 0x1f990, 0x1f9c0, 0x1f9e0, 0x1f798, 0x1f998, 0x1f9c8, 0x1f9e8
.long 0x1f780, 0x1f980, 0x1f9d0, 0x1f9f0, 0x1f788, 0x1f988, 0x1f9d8, 0x100000
.long 0x1fe20, 0x20020, 0x1f9c2, 0x1f9e2, 0x1fe28, 0x20028, 0x1f9ca, 0x1f9ea
.long 0x1fe30, 0x20030, 0x1f9d2, 0x1f9f2, 0x1fe38, 0x20038, 0x1f9da, 0x100000
.long 0x1f7f0, 0x14d00, 0x1f9c4, 0x1f9e4, 0x1f7f8, 0x14d08, 0x1f9cc, 0x1f9ec
.long 0x1f7e0, 0x14d10, 0x1f9d4, 0x100000, 0x1f7e8, 0x14d18, 0x1f9dc, 0x100000
.long 0x1fe40, 0x14d00, 0x1f9c6, 0x1f9e6, 0x1fe48, 0x14d08, 0x1f9ce, 0x1f9ee
.long 0x1fe50, 0x14d10, 0x1f9d6, 0x100000, 0x1fe58, 0x14d18, 0x1f9de, 0x100000
.long 0x1f810, 0x14d00, 0x1f9c0, 0x1f9e0, 0x1f818, 0x14d08, 0x1f9c8, 0x1f9e8
.long 0x1f800, 0x14d10, 0x1f9d0, 0x1f9f0, 0x1f808, 0x14d18, 0x1f9d8, 0x100000
.long 0x1fea0, 0x14d00, 0x1f9c2, 0x1f9e2, 0x1fea8, 0x14d08, 0x1f9ca, 0x1f9ea
.long 0x1feb0, 0x14d10, 0x1f9d2, 0x1f9f2, 0x1feb8, 0x14d18, 0x1f9da, 0x100000
.long 0x1f870, 0x14d00, 0x1f9c4, 0x1f9e4, 0x1f878, 0x14d08, 0x1f9cc, 0x1f9ec
.long 0x1f860, 0x14d10, 0x1f9d4, 0x100000, 0x1f868, 0x14d18, 0x1f9dc, 0x100000
.long 0x1fec0, 0x14d00, 0x1f9c6, 0x1f9e6, 0x1fec8, 0x14d08, 0x1f9ce, 0x1f9ee
.long 0x1fed0, 0x14d10, 0x1f9d6, 0x100000, 0x1fed8, 0x14d18, 0x1f9de, 0x100000
.long 0x0, 0x4444, 0x0, 0xa400, 0x10, 0xeeee, 0x4, 0xa404
.long 0x20, 0x4444, 0x8, 0xa408, 0x30, 0xeeee, 0xc, 0xa40c
.long 0x40, 0x4444, 0x10, 0xa410, 0x50, 0xeeee, 0x14, 0xa414
.long 0x60, 0x4444, 0x18, 0xa418, 0x70, 0xeeee, 0x1c, 0xa41c
.long 0x0, 0x4444, 0x20, 0xa420, 0x10, 0xeeee, 0x24, 0xa424
.long 0x20, 0x4444, 0x28, 0xa428, 0x30, 0xeeee, 0x2c, 0xa42c
.long 0x40, 0x4444, 0x30, 0xa430, 0x50, 0xeeee, 0x34, 0xa434
.long 0x60, 0x4444, 0x38, 0xa438, 0x70, 0xeeee, 0x3c, 0xa43c
.long 0x0, 0x4444, 0x40, 0xa440, 0x10, 0xeeee, 0x44, 0xa444
.long 0x20, 0x4444, 0x48, 0xa448, 0x30, 0xeeee, 0x4c, 0xa44c
.long 0x40, 0x4444, 0x50, 0xa450, 0x50, 0xeeee, 0x54, 0xa454
.long 0x60, 0x4444, 0x58, 0xa458, 0x70, 0xeeee, 0x5c, 0xa45c
.long 0x0, 0x4444, 0x60, 0xa460, 0x10, 0xeeee, 0x64, 0xa464
.long 0x20, 0x4444, 0x68, 0xa468, 0x30, 0xeeee, 0x6c, 0xa46c
.long 0x40, 0x4444, 0x70, 0xa470, 0x50, 0xeeee, 0x74, 0xa474
.long 0x60, 0x4444, 0x78, 0xa478, 0x70, 0xeeee, 0x7c, 0xa47c
.long 0x0, 0x4444, 0x420, 0xb080, 0x10, 0xeeee, 0x424, 0xb084
.long 0x20, 0x4444, 0x428, 0xb088, 0x30, 0xeeee, 0x42c, 0xb08c
.long 0x40, 0x4444, 0x430, 0xb090, 0x50, 0xeeee, 0x434, 0xb094
.long 0x60, 0x4444, 0x438, 0xb098, 0x70, 0xeeee, 0x43c, 0xb09c
.long 0x0, 0x4444, 0x440, 0xb0a0, 0x10, 0xeeee, 0x444, 0xb0a4
.long 0x20, 0x4444, 0x448, 0xb0a8, 0x30, 0xeeee, 0x44c, 0xb0ac
.long 0x40, 0x4444, 0x450, 0xb0b0, 0x50, 0xeeee, 0x454, 0xb0b4
.long 0x60, 0x4444, 0x458, 0xb0b8, 0x70, 0xeeee, 0x45c, 0xb0bc
.long 0x0, 0x4444, 0x460, 0xb0c0, 0x10, 0xeeee, 0x464, 0xb0c4
.long 0x20, 0x4444, 0x468, 0xb0c8, 0x30, 0xeeee, 0x46c, 0xb0cc
.long 0x40, 0x4444, 0x470, 0xb0d0, 0x50, 0xeeee, 0x474, 0xb0d4
.long 0x60, 0x4444, 0x478, 0xb0d8, 0x70, 0xeeee, 0x47c, 0xb0dc
.long 0x0, 0x4444, 0x480, 0xb0e0, 0x10, 0xeeee, 0x484, 0xb0e4
.long 0x20, 0x4444, 0x488, 0xb0e8, 0x30, 0xeeee, 0x48c, 0xb0ec
.long 0x40, 0x4444, 0x490, 0xb0f0, 0x50, 0xeeee, 0x494, 0xb0f4
.long 0x60, 0x4444, 0x498, 0xb0f8, 0x70, 0xeeee, 0x49c, 0xb0fc
.long 0x0, 0x0, 0x0, 0x0, 0x0, 0x0, 0x0, 0x0
.long 0x0, 0x0, 0x0, 0x0, 0x0, 0x0, 0x0, 0x0
.long 0x0, 0x0, 0x0, 0x0, 0x0, 0x0, 0x0, 0x0
.long 0x0, 0x0, 0x0, 0x0, 0x0, 0x0, 0x0, 0x0
.long 0x0, 0x0, 0x0, 0x0, 0x0, 0x0, 0x0, 0x0
.long 0x0, 0x0, 0x0, 0x0, 0x0, 0x0, 0x0, 0x0
.long 0x0, 0x0, 0x0, 0x0, 0x0, 0x0, 0x0, 0x0
.long 0x0, 0x0, 0x0, 0x0, 0x0, 0x0, 0x0, 0x0
.long 0x0, 0x0, 0x0, 0x0, 0x0, 0x0, 0x0, 0x0
.long 0x0, 0x0, 0x0, 0x0, 0x0, 0x0, 0x0, 0x0
.long 0x0, 0x0, 0x0, 0x0, 0x0, 0x0, 0x0, 0x0
.long 0x0, 0x0, 0x0, 0x0, 0x0, 0x0, 0x0, 0x0
.long 0x0, 0x0, 0x0, 0x0, 0x0, 0x0, 0x0, 0x0
.long 0x0, 0x0, 0x0, 0x0, 0x0, 0x0, 0x0, 0x0
.long 0x0, 0x0, 0x0, 0x0, 0x0, 0x0, 0x0, 0x0
.long 0x0, 0x0, 0x0, 0x0, 0x0, 0x0, 0x0, 0x0
.long 0x0, 0x0, 0x0, 0x0, 0x0, 0x0, 0x0, 0x0
.long 0x0, 0x0, 0x0, 0x0, 0x0, 0x0, 0x0, 0x0
.long 0x0, 0x0, 0x0, 0x0, 0x0, 0x0, 0x0, 0x0
.long 0x0, 0x0, 0x0, 0x0, 0x0, 0x0, 0x0, 0x0
.long 0x0, 0x0, 0x0, 0x0, 0x0, 0x0, 0x0, 0x0
.long 0x0, 0x0, 0x0, 0x0, 0x0, 0x0, 0x0, 0x0
.long 0x0, 0x0, 0x0, 0x0, 0x0, 0x0, 0x0, 0x0
.long 0x0, 0x0, 0x0, 0x0, 0x0, 0x0, 0x0, 0x0
.long 0x0, 0x0, 0x0, 0x0, 0x0, 0x0, 0x0, 0x0
.long 0x0, 0x0, 0x0, 0x0, 0x0, 0x0, 0x0, 0x0
.long 0x0, 0x0, 0x0, 0x0, 0x0, 0x0, 0x0, 0x0
.long 0x0, 0x0, 0x0, 0x0, 0x0, 0x0, 0x0, 0x0
.long 0x0, 0x0, 0x0, 0x0, 0x0, 0x0, 0x0, 0x0
.long 0x0, 0x0, 0x0, 0x0, 0x0, 0x0, 0x0, 0x0
.long 0x0, 0x0, 0x0, 0x0, 0x0, 0x0, 0x0, 0x0
.long 0x0, 0x0, 0x0, 0x0, 0x0, 0x0, 0x0, 0x0
.long 0x13320, 0xa9b0, 0xa800, 0x10c00, 0xf320, 0xc120, 0x133b0, 0xb690
.long 0xa890, 0x11920, 0xf3b0, 0xce00, 0x12600, 0xa920, 0xb520, 0x10c90
.long 0xe600, 0xc090, 0x12690, 0xb600, 0xb5b0, 0x119b0, 0xe690, 0xcdb0
.long 0xd5f0, 0x11440, 0x117f0, 0x130d0, 0xf8d0, 0xadf0, 0xd640, 0x12160
.long 0x11840, 0x13df0, 0xf960, 0xbad0, 0xc8d0, 0x113f0, 0x124d0, 0x13160
.long 0xebf0, 0xad60, 0xc960, 0x120d0, 0x12560, 0x13e40, 0xec40, 0xba40
.long 0xefb0, 0x10ed0, 0x117b0, 0x12a40, 0xfa90, 0xdb60, 0xc890, 0x10d60
.long 0x10a90, 0x129f0, 0x13bb0, 0xddf0, 0xf000, 0x11bf0, 0x11520, 0xe960
.long 0xc160, 0xf9b0, 0xc920, 0x11a40, 0x10800, 0xe8d0, 0xc3f0, 0x13a90
.long 0xce40, 0xfa00, 0xfff0, 0xbb20, 0xedb0, 0xdad0, 0xced0, 0x10720
.long 0x10040, 0xc800, 0x14890, 0xde40, 0xf560, 0xfbb0, 0x140d0, 0xbdb0
.long 0xb3f0, 0xec00, 0xf5f0, 0x10890, 0x14160, 0xca90, 0xb760, 0x14720
.long 0x13520, 0xddb0, 0xa520, 0xbe00, 0xf490, 0xe800, 0x13690, 0x10490
.long 0xa5b0, 0xcb20, 0xe7b0, 0x14d00, 0x12800, 0xdd20, 0xb200, 0xbe90
.long 0xf800, 0x14320, 0x129b0, 0x10400, 0xb290, 0xcbb0, 0xeb20, 0x14290
.long 0xd560, 0x10760, 0x112d0, 0xaed0, 0xfb60, 0xeed0, 0xd3f0, 0xe040
.long 0x11360, 0xbbf0, 0xee40, 0x14d00, 0xc840, 0x106d0, 0x11ff0, 0xaf60
.long 0xfed0, 0x149f0, 0xc6d0, 0xdff0, 0x12040, 0xbc40, 0xf1f0, 0x14960
.long 0xbbb0, 0x10cd0, 0xfdb0, 0x12960, 0xd3b0, 0xd9f0, 0x13090, 0x11160
.long 0x13e90, 0x12bf0, 0xbff0, 0xd290, 0xbc00, 0x119f0, 0xfb20, 0xe840
.long 0xac90, 0xd840, 0x13120, 0x11e40, 0x13c00, 0xead0, 0xbe40, 0xabb0
.long 0xcf60, 0x11400, 0x101f0, 0xef20, 0x12e90, 0xdd60, 0xccd0, 0xd320
.long 0x10560, 0x14a00, 0xb640, 0x12d20, 0xf640, 0x115b0, 0x142d0, 0xf1b0
.long 0x121b0, 0xdcd0, 0xf3f0, 0xd490, 0x14640, 0x14c90, 0xb5f0, 0x12000
.long 0x13600, 0xf7b0, 0xa490, 0xb120, 0x10d20, 0xc200, 0x135b0, 0xea90
.long 0xa400, 0x14d00, 0x10db0, 0xcf20, 0x12920, 0xf720, 0xaa00, 0x14000
.long 0x11a00, 0xc290, 0x12890, 0xea00, 0xb720, 0x14090, 0x11a90, 0xcfb0
.long 0xd4d0, 0xfa40, 0x11760, 0x123f0, 0x12cd0, 0xaff0, 0xd440, 0xed60
.long 0x116d0, 0x14d00, 0x12d60, 0xbcd0, 0xc7f0, 0xf9f0, 0x118d0, 0x14ad0
.long 0x139f0, 0xb040, 0xc760, 0xecd0, 0x125f0, 0x14b60, 0x13a40, 0xbd60
.long 0xe290, 0x10e40, 0xc9b0, 0x12760, 0xfe00, 0x13640, 0x10df0, 0xd5b0
.long 0xf090, 0x128d0, 0x13f20, 0x138d0, 0xe320, 0x11b60, 0x12640, 0xafb0
.long 0xfe90, 0x14360, 0x11ad0, 0xd600, 0xe560, 0xad20, 0x13fb0, 0x145f0
.long 0xe000, 0xcd60, 0x10920, 0x102d0, 0xa6d0, 0xebb0, 0xd040, 0x12e00
.long 0xfc00, 0x10240, 0xaa40, 0x14690, 0xe1b0, 0xf440, 0x103f0, 0x12320
.long 0xe7f0, 0xee00, 0xf760, 0x12fb0, 0x144d0, 0x125b0, 0xeb60, 0x14920
.long 0x13720, 0x111b0, 0xdb20, 0xf400, 0x11090, 0x11d20, 0x137b0, 0x11e90
.long 0xda90, 0xe720, 0x11db0, 0x14d00, 0x12a00, 0x11120, 0x10200, 0xf5b0
.long 0x11200, 0x14400, 0x12a90, 0x11e00, 0x101b0, 0xe890, 0x11f20, 0x14490
.long 0xd6d0, 0x12e40, 0x108d0, 0xfc40, 0x13240, 0x13ed0, 0xd760, 0x13b60
.long 0x10840, 0xef60, 0x13f60, 0x14d00, 0xc9f0, 0x12df0, 0xe1f0, 0xfad0
.long 0x132d0, 0x14bf0, 0xca40, 0x13ad0, 0xe160, 0xedf0, 0x13ff0, 0x14c40
.long 0x11690, 0x11040, 0xde90, 0xa640, 0x10b20, 0x136d0, 0x109b0, 0x10ff0
.long 0xa5f0, 0xd1b0, 0x10bb0, 0x143f0, 0x11720, 0x11d60, 0xdf20, 0xb360
.long 0xb000, 0x13360, 0x10a00, 0x11cd0, 0xb2d0, 0xd200, 0xb090, 0x14040
.long 0xcbf0, 0xb920, 0xe400, 0x13560, 0xa560, 0xc490, 0xcc40, 0xc600
.long 0x13840, 0x13200, 0xe640, 0xc720, 0xf2d0, 0xba90, 0xdfb0, 0xc040
.long 0xa8d0, 0x11fb0, 0xf360, 0xc7b0, 0xc360, 0x12db0, 0xe9f0, 0x12200
.long 0x13400, 0xc3b0, 0xdc00, 0x10e00, 0xbfb0, 0xcc00, 0x13490, 0xd090
.long 0xdc90, 0x11b20, 0xcc90, 0x14d00, 0x12720, 0xc320, 0x10320, 0x10fb0
.long 0xc400, 0x14120, 0x127b0, 0xd000, 0x103b0, 0x11c90, 0xd120, 0x141b0
.long 0xd1f0, 0xac40, 0x10ad0, 0x13040, 0xab60, 0xb7f0, 0xd240, 0xb960
.long 0x10b60, 0x13d60, 0xb840, 0x14d00, 0xc4d0, 0xabf0, 0xe3f0, 0x12ed0
.long 0xb0d0, 0x146d0, 0xc560, 0xb8d0, 0xe440, 0x13bf0, 0xbdf0, 0x14760
.long 0xfc90, 0x10f60, 0x11290, 0xa840, 0x13d20, 0x104d0, 0x13db0, 0x111f0
.long 0x105b0, 0xa7f0, 0x13c90, 0xf7f0, 0xfd20, 0x11c40, 0x11320, 0xb560
.long 0xae00, 0xff60, 0x13e00, 0x11ed0, 0x10600, 0xb4d0, 0xadb0, 0xf240
.long 0xcdf0, 0xed20, 0x133f0, 0xbd20, 0x12c40, 0x14bb0, 0xd160, 0x14800
.long 0x13440, 0xca00, 0x11f60, 0x14b20, 0xf4d0, 0xee90, 0xbed0, 0xb890
.long 0x12ad0, 0x12490, 0xf840, 0x149b0, 0xbf60, 0xc5b0, 0x11df0, 0x12400
.long 0x12bb0, 0x13800, 0xd920, 0xc000, 0x14600, 0x14d00, 0x13890, 0x14d00
.long 0xd9b0, 0xcd20, 0xc5f0, 0x14d00, 0x13920, 0x145b0, 0x10000, 0xc1b0
.long 0xb1b0, 0x14d00, 0x12c00, 0x14520, 0x10090, 0xce90, 0xfbf0, 0x14d00
.long 0xc640, 0xd2d0, 0x105f0, 0xae40, 0x14cd0, 0x14d00, 0xd360, 0x14d00
.long 0x10640, 0xbb60, 0xbf20, 0x14d00, 0xd7f0, 0x14840, 0xded0, 0xacd0
.long 0x10290, 0x14d00, 0xcad0, 0x147f0, 0xdf60, 0xb9f0, 0x11000, 0x14d00
.long 0x14a90, 0x11240, 0xf890, 0xa760, 0x14d00, 0xaad0, 0x123b0, 0x110d0
.long 0x139b0, 0xa9f0, 0x14d00, 0x12b20, 0x10c40, 0xae90, 0xf920, 0xb440
.long 0xe0d0, 0x14d00, 0x11960, 0xaf20, 0x13a00, 0xb6d0, 0x131f0, 0x14d00
.long 0x13b20, 0xd0d0, 0x135f0, 0xf120, 0x14d00, 0x12440, 0xac00, 0xcb60
.long 0x13960, 0x14c00, 0xf520, 0x14d00, 0xcff0, 0x12120, 0xc0d0, 0xec90
.long 0xda40, 0xe090, 0xf6d0, 0x12290, 0xc440, 0x147b0, 0x14d00, 0x14d00
.long 0xa600, 0xd800, 0xdbb0, 0x10120, 0x0, 0x0, 0xa7b0, 0xff20
.long 0xda00, 0x14d00, 0x0, 0x0, 0xb320, 0xd890, 0xde00, 0x14200
.long 0x0, 0x0, 0xb490, 0xffb0, 0x10520, 0x143b0, 0x0, 0x0
.long 0x11640, 0x109f0, 0x107f0, 0xe240, 0x0, 0x0, 0x114d0, 0xe2d0
.long 0x10960, 0x14d00, 0x0, 0x0, 0x12360, 0x10a40, 0x10bf0, 0x14a40
.long 0x0, 0x0, 0x121f0, 0xe360, 0xe4d0, 0x148d0, 0x0, 0x0
.long 0xbc90, 0x126d0, 0x12c90, 0xa960, 0x0, 0x0, 0x131b0, 0x12b60
.long 0xb7b0, 0xa4d0, 0x0, 0x0, 0xba00, 0xe5f0, 0xa440, 0xaa90
.long 0x0, 0x0, 0x12f20, 0xea40, 0xb160, 0xab20, 0x0, 0x0
.long 0x10360, 0x11600, 0xd720, 0x134d0, 0x0, 0x0, 0x100d0, 0xd520
.long 0x11800, 0x13760, 0x0, 0x0, 0x14440, 0x11890, 0x137f0, 0x12520
.long 0x0, 0x0, 0x141f0, 0xd7b0, 0xc2d0, 0x12090, 0x0, 0x0
.long 0xa720, 0xf200, 0xf600, 0x10f20, 0x0, 0x0, 0xa690, 0xe520
.long 0xf690, 0x11c00, 0x0, 0x0, 0xb400, 0xf290, 0xe920, 0x10e90
.long 0x0, 0x0, 0xb3b0, 0xe5b0, 0xe9b0, 0x11bb0, 0x0, 0x0
.long 0x115f0, 0xfcd0, 0xfdf0, 0x12ff0, 0x0, 0x0, 0x11560, 0xeff0
.long 0xfe40, 0x13cd0, 0x0, 0x0, 0x122d0, 0xfd60, 0xf0d0, 0x12f60
.long 0x0, 0x0, 0x12240, 0xf040, 0xf160, 0x13c40, 0x0, 0x0
.long 0xe3b0, 0x12840, 0x11490, 0xdc40, 0x0, 0x0, 0x127f0, 0xd690
.long 0x107b0, 0xdbf0, 0x0, 0x0, 0xe120, 0xe760, 0xc240, 0x113b0
.long 0x0, 0x0, 0xe6d0, 0xd400, 0xc1f0, 0x10690, 0x0, 0x0
.long 0xe200, 0x10160, 0xb9b0, 0xd8d0, 0x0, 0x0, 0x10440, 0x13000
.long 0xc690, 0xd960, 0x0, 0x0, 0xe490, 0x14240, 0xb1f0, 0xb800
.long 0x0, 0x0, 0x14560, 0x13290, 0xb240, 0xc520, 0x0, 0x0
.long 0x0, 0x0, 0x0, 0x0, 0x0, 0x0, 0x0, 0x0
.long 0x0, 0x0, 0x0, 0x0, 0x0, 0x0, 0x0, 0x0
.long 0x0, 0x0, 0x0, 0x0, 0x0, 0x0, 0x0, 0x0
.long 0x0, 0x0, 0x0, 0x0, 0x0, 0x0, 0x0, 0x0
.long 0x0, 0x0, 0x0, 0x0, 0x0, 0x0, 0x0, 0x0
.long 0x0, 0x0, 0x0, 0x0, 0x0, 0x0, 0x0, 0x0
.long 0x0, 0x0, 0x0, 0x0, 0x0, 0x0, 0x0, 0x0
.long 0x0, 0x0, 0x0, 0x0, 0x0, 0x0, 0x0, 0x0
.long 0x0, 0x0, 0x0, 0x0, 0x0, 0x0, 0x0, 0x0
.long 0x0, 0x0, 0x0, 0x0, 0x0, 0x0, 0x0, 0x0
.long 0x0, 0x0, 0x0, 0x0, 0x0, 0x0, 0x0, 0x0
.long 0x0, 0x0, 0x0, 0x0, 0x0, 0x0, 0x0, 0x0
.long 0x0, 0x0, 0x0, 0x0, 0x0, 0x0, 0x0, 0x0
.long 0x0, 0x0, 0x0, 0x0, 0x0, 0x0, 0x0, 0x0
.long 0x0, 0x0, 0x0, 0x0, 0x0, 0x0, 0x0, 0x0
.long 0x0, 0x0, 0x0, 0x0, 0x0, 0x0, 0x0, 0x0
.long 0x0, 0x0, 0x0, 0x0, 0x0, 0x0, 0x0, 0x0
.long 0x0, 0x0, 0x0, 0x0, 0x0, 0x0, 0x0, 0x0
.long 0x0, 0x0, 0x0, 0x0, 0x0, 0x0, 0x0, 0x0
.long 0x0, 0x0, 0x0, 0x0, 0x0, 0x0, 0x0, 0x0
.long 0x0, 0x0, 0x0, 0x0, 0x0, 0x0, 0x0, 0x0
.long 0x0, 0x0, 0x0, 0x0, 0x0, 0x0, 0x0, 0x0
.long 0x0, 0x0, 0x0, 0x0, 0x0, 0x0, 0x0, 0x0
.long 0x0, 0x0, 0x0, 0x0, 0x0, 0x0, 0x0, 0x0
.long 0x0, 0x0, 0x0, 0x0, 0x0, 0x0, 0x0, 0x0
.long 0x0, 0x0, 0x0, 0x0, 0x0, 0x0, 0x0, 0x0
.long 0x0, 0x0, 0x0, 0x0, 0x0, 0x0, 0x0, 0x0
.long 0x0, 0x0, 0x0, 0x0, 0x0, 0x0, 0x0, 0x0
.long 0x0, 0x0, 0x0, 0x0, 0x0, 0x0, 0x0, 0x0
.long 0x0, 0x0, 0x0, 0x0, 0x0, 0x0, 0x0, 0x0
.long 0x0, 0x0, 0x0, 0x0, 0x0, 0x0, 0x0, 0x0
.long 0x0, 0x0, 0x0, 0x0, 0x0, 0x0, 0x0, 0x0
.section .rodata,"a"
.p2align 6
.amdhsa_kernel standalone__deep_cross_xdeepfm__recsys_kernel
  .amdhsa_next_free_vgpr 256
  .amdhsa_next_free_sgpr 102
  .amdhsa_accum_offset 256
  .amdhsa_group_segment_fixed_size 0
  .amdhsa_kernarg_size 88
  .amdhsa_user_sgpr_count 2
  .amdhsa_user_sgpr_kernarg_segment_ptr 1
  .amdhsa_system_sgpr_workgroup_id_x 1
  .amdhsa_float_denorm_mode_32 3
.end_amdhsa_kernel
```

```asm
; @launch grid=(256,1,1) block=(512,1,1) lds=163840
.amdgcn_target "amdgcn-amd-amdhsa--gfx950"
.text
.globl standalone__deep_cross_xdeepfm__recsys_kernel
.p2align 8
.type standalone__deep_cross_xdeepfm__recsys_kernel,@function
standalone__deep_cross_xdeepfm__recsys_kernel:
  s_cmp_ge_u32 s2, 256
  s_cbranch_scc1 L_end
  s_load_dwordx16 s[4:19], s[0:1], 0
  s_load_dwordx4 s[20:23], s[0:1], 64
  s_load_dwordx2 s[24:25], s[0:1], 80
  v_lshrrev_b32 v1, 6, v0
  s_getpc_b64 s[92:93]
L_pc:
  s_and_b32 s68, s2, 0xf8
  v_add_u32 v2, s68, v1
  v_and_b32_e64 v3, 32, v0
  v_lshl_add_u32 v2, v3, 3, v2
  v_lshlrev_b32 v2, 7, v2
  v_min_u32 v2, L_end-L_pc, v2
  v_mov_b32 v3, s93
  v_add_co_u32 v2, vcc, s92, v2
  s_nop 1
  v_addc_co_u32 v3, vcc, 0, v3, vcc
  global_load_dword v251, v[2:3], off
  v_and_b32_e64 v0, 63, v0
  v_readfirstlane_b32 s3, v1
  s_and_b32 s68, s2, 7
  s_lshr_b32 s69, s2, 3
  s_and_b32 s80, s2, 0xf8
  s_add_u32 s80, s80, s3
  s_lshl_b32 s80, s80, 0
  s_min_u32 s70, s68, 1
  s_add_u32 s71, s69, s70
  s_cmp_ge_u32 s71, 22
  s_cbranch_scc1 L_cin
  s_mul_i32 s68, s68, 21
  s_add_u32 s68, s68, s71
  s_mul_i32 s26, s68, 5042
  s_lshr_b32 s26, s26, 16
  s_mul_i32 s69, s26, 13
  s_sub_u32 s27, s68, s69
  s_lshl_b32 s77, s27, 8
  s_mul_i32 s71, s26, 320
  v_lshrrev_b32 v116, 4, v0
  v_lshlrev_b32 v11, 4, v0
  s_and_b32 s79, s3, 3
  s_cmp_lt_u32 s3, 4
  s_cbranch_scc1 L_cmp
  s_lshr_b32 s68, s79, 1
  s_mul_i32 s68, s68, 20
  s_and_b32 s69, s79, 1
  s_add_u32 s68, s68, s69
  s_lshl_b32 s76, s68, 10
  s_mul_i32 s78, s71, 104
  s_mul_i32 s68, s68, 832
  s_add_u32 s94, s78, s68
  v_mul_u32_u24 v118, 48, v116
  v_sub_u32 v12, v11, v118
  s_add_u32 s95, s94, 3328
  s_add_u32 s96, s94, 6656
  s_add_u32 s97, s94, 9984
  s_add_u32 s98, s94, 13312
  s_and_b32 s70, s79, 1
  s_lshl_b32 s70, s70, 3
  v_lshlrev_b32 v117, 1, v116
  v_or_b32 v117, s70, v117
  v_xor_b32 v117, v117, v0
  v_and_b32_e64 v117, 15, v117
  v_mul_u32_u24 v4, 3328, v116
  v_lshl_add_u32 v4, v117, 4, v4
  v_add_u32 v5, 13312, v4
  s_mul_i32 s74, s79, 26624
  s_add_u32 s74, s74, s77
  s_lshl_b32 s75, s79, 11
  s_waitcnt lgkmcnt(0)
  s_mov_b32 s28, s4
  s_and_b32 s29, s5, 0xffff
  s_mov_b32 s30, 425984
  s_mov_b32 s31, 0x20000
  buffer_load_dwordx4 v[16:19], v12, s[28:31], s94 offen offset:0
  s_mov_b32 s32, s6
  s_and_b32 s33, s7, 0xffff
  s_mov_b32 s34, 12800000
  s_mov_b32 s35, 0x20000
  s_mov_b32 s44, s12
  s_and_b32 s45, s13, 0xffff
  s_mov_b32 s46, 5537792
  s_mov_b32 s47, 0x20000
  s_add_u32 m0, s75, 131072
  s_nop 0
  buffer_load_dwordx4 v4, s[44:47], s74 offen lds
  s_add_u32 m0, s75, 132096
  s_nop 0
  buffer_load_dwordx4 v5, s[44:47], s74 offen lds
  s_add_u32 s74, s74, 106496
  s_add_u32 m0, s75, 139264
  s_nop 0
  buffer_load_dwordx4 v4, s[44:47], s74 offen lds
  s_add_u32 m0, s75, 140288
  s_nop 0
  buffer_load_dwordx4 v5, s[44:47], s74 offen lds
  s_add_u32 s74, s74, 106496
  buffer_load_dwordx4 v[20:23], v12, s[28:31], s94 offen offset:1664
  buffer_load_dwordx4 v[24:27], v12, s[28:31], s95 offen offset:0
  buffer_load_dwordx4 v[28:31], v12, s[28:31], s95 offen offset:1664
  buffer_load_dwordx4 v[32:35], v12, s[28:31], s96 offen offset:0
  buffer_load_dwordx4 v[36:39], v12, s[28:31], s96 offen offset:1664
  buffer_load_dwordx4 v[40:43], v12, s[28:31], s97 offen offset:0
  buffer_load_dwordx4 v[44:47], v12, s[28:31], s97 offen offset:1664
  buffer_load_dwordx4 v[48:51], v12, s[28:31], s98 offen offset:0
  buffer_load_dwordx4 v[52:55], v12, s[28:31], s98 offen offset:1664
  s_lshl_b32 s70, s69, 6
  v_and_b32 v118, 7, v0
  v_xor_b32 v118, v118, v116
  v_lshlrev_b32 v118, 4, v118
  v_xor_b32 v2, s70, v118
  v_xor_b32 v3, 64, v2
  s_mov_b32 s72, 0
  s_mul_i32 s70, s79, 13
  s_add_u32 s70, s70, s27
  s_min_u32 s70, s70, 39
  s_lshl_b32 s70, s70, 3
  s_add_u32 s70, s70, s71
  s_mul_i32 s84, s70, 104
  v_lshrrev_b32 v118, 2, v0
  v_min_u32 v118, 7, v118
  v_mul_u32_u24 v118, 104, v118
  v_and_b32 v117, 3, v0
  v_lshl_add_u32 v7, v117, 2, v118
  s_lshl_b32 s70, s26, 2
  s_add_u32 s70, s70, s79
  s_add_u32 s70, s70, 384
  s_mul_i32 s85, s70, 3328
  s_add_u32 s85, s85, s77
  s_mov_b32 s70, 173056
  v_lshrrev_b32 v118, 1, v0
  v_mul_lo_u32 v118, s70, v118
  v_and_b32 v117, 1, v0
  v_lshl_add_u32 v76, v117, 7, v118
  s_mov_b32 s52, s16
  s_and_b32 s53, s17, 0xffff
  s_mov_b32 s54, 3328
  s_mov_b32 s55, 0x20000
  s_mul_i32 s70, s79, 2560
  s_add_u32 s70, s70, L_tail-L_pc
  v_lshlrev_b32 v8, 7, v0
  v_add_u32 v8, s70, v8
  v_mov_b32 v9, s93
  v_add_co_u32 v8, vcc, s92, v8
  s_nop 1
  v_addc_co_u32 v9, vcc, 0, v9, vcc
  s_waitcnt vmcnt(13)
  v_lshlrev_b32 v16, 7, v16
  v_lshlrev_b32 v18, 7, v18
  v_lshlrev_b32 v17, 7, v17
  v_lshlrev_b32_e64 v19, 7, v19
  v_add_u32_dpp v56, v16, v2 row_newbcast:0 row_mask:0xf bank_mask:0x3
  s_nop 1
  v_add_u32_dpp v56, v18, v2 row_newbcast:6 row_mask:0xf bank_mask:0xc
  s_add_u32 m0, s76, 0
  s_nop 0
  buffer_load_dwordx4 v56, s[32:35], 0 offen lds
  s_waitcnt vmcnt(10)
  s_barrier
  s_waitcnt vmcnt(9)
  v_lshlrev_b32 v20, 7, v20
  v_lshlrev_b32 v22, 7, v22
  v_lshlrev_b32 v21, 7, v21
  v_lshlrev_b32 v23, 7, v23
  v_add_u32_dpp v57, v20, v2 row_newbcast:0 row_mask:0xf bank_mask:0x3
  s_nop 1
  v_add_u32_dpp v57, v22, v2 row_newbcast:6 row_mask:0xf bank_mask:0xc
  s_add_u32 m0, s76, 2048
  s_nop 0
  buffer_load_dwordx4 v57, s[32:35], 0 offen lds
  s_waitcnt vmcnt(9)
  v_lshlrev_b32 v24, 7, v24
  v_lshlrev_b32 v26, 7, v26
  v_lshlrev_b32 v25, 7, v25
  v_lshlrev_b32 v27, 7, v27
  v_add_u32_dpp v58, v24, v2 row_newbcast:0 row_mask:0xf bank_mask:0x3
  s_nop 1
  v_add_u32_dpp v58, v26, v2 row_newbcast:6 row_mask:0xf bank_mask:0xc
  s_add_u32 m0, s76, 4096
  s_nop 0
  buffer_load_dwordx4 v58, s[32:35], 0 offen lds
  s_waitcnt vmcnt(9)
  v_lshlrev_b32 v28, 7, v28
  v_lshlrev_b32 v30, 7, v30
  v_lshlrev_b32 v29, 7, v29
  v_lshlrev_b32_e64 v31, 7, v31
  v_add_u32_dpp v59, v28, v2 row_newbcast:0 row_mask:0xf bank_mask:0x3
  s_nop 1
  v_add_u32_dpp v59, v30, v2 row_newbcast:6 row_mask:0xf bank_mask:0xc
  s_add_u32 m0, s76, 6144
  s_nop 0
  buffer_load_dwordx4 v59, s[32:35], 0 offen lds
  s_waitcnt vmcnt(9)
  v_lshlrev_b32 v32, 7, v32
  v_lshlrev_b32 v34, 7, v34
  v_lshlrev_b32 v33, 7, v33
  v_lshlrev_b32_e64 v35, 7, v35
  v_add_u32_dpp v60, v32, v2 row_newbcast:0 row_mask:0xf bank_mask:0x3
  s_nop 1
  v_add_u32_dpp v60, v34, v2 row_newbcast:6 row_mask:0xf bank_mask:0xc
  s_add_u32 m0, s76, 8192
  s_nop 0
  buffer_load_dwordx4 v60, s[32:35], 0 offen lds
  s_waitcnt vmcnt(9)
  v_lshlrev_b32 v36, 7, v36
  v_lshlrev_b32 v38, 7, v38
  v_lshlrev_b32 v37, 7, v37
  v_lshlrev_b32_e64 v39, 7, v39
  v_add_u32_dpp v61, v36, v2 row_newbcast:0 row_mask:0xf bank_mask:0x3
  s_nop 1
  v_add_u32_dpp v61, v38, v2 row_newbcast:6 row_mask:0xf bank_mask:0xc
  s_add_u32 m0, s76, 10240
  s_nop 0
  buffer_load_dwordx4 v61, s[32:35], 0 offen lds
  s_waitcnt vmcnt(9)
  v_lshlrev_b32 v40, 7, v40
  v_lshlrev_b32 v42, 7, v42
  v_lshlrev_b32 v41, 7, v41
  v_lshlrev_b32_e64 v43, 7, v43
  v_add_u32_dpp v62, v40, v2 row_newbcast:0 row_mask:0xf bank_mask:0x3
  s_nop 1
  v_add_u32_dpp v62, v42, v2 row_newbcast:6 row_mask:0xf bank_mask:0xc
  s_add_u32 m0, s76, 12288
  s_nop 0
  buffer_load_dwordx4 v62, s[32:35], 0 offen lds
  s_waitcnt vmcnt(9)
  v_lshlrev_b32 v44, 7, v44
  v_lshlrev_b32 v46, 7, v46
  v_lshlrev_b32 v45, 7, v45
  v_lshlrev_b32_e64 v47, 7, v47
  v_add_u32_dpp v63, v44, v2 row_newbcast:0 row_mask:0xf bank_mask:0x3
  s_nop 1
  v_add_u32_dpp v63, v46, v2 row_newbcast:6 row_mask:0xf bank_mask:0xc
  s_add_u32 m0, s76, 14336
  s_nop 0
  buffer_load_dwordx4 v63, s[32:35], 0 offen lds
  s_waitcnt vmcnt(9)
  v_lshlrev_b32 v48, 7, v48
  v_lshlrev_b32 v50, 7, v50
  v_lshlrev_b32 v49, 7, v49
  v_lshlrev_b32_e64 v51, 7, v51
  v_add_u32_dpp v64, v48, v2 row_newbcast:0 row_mask:0xf bank_mask:0x3
  s_nop 1
  v_add_u32_dpp v64, v50, v2 row_newbcast:6 row_mask:0xf bank_mask:0xc
  s_add_u32 m0, s76, 16384
  s_nop 0
  buffer_load_dwordx4 v64, s[32:35], 0 offen lds
  s_waitcnt vmcnt(9)
  v_lshlrev_b32 v52, 7, v52
  v_lshlrev_b32 v54, 7, v54
  v_lshlrev_b32 v53, 7, v53
  v_lshlrev_b32_e64 v55, 7, v55
  v_add_u32_dpp v65, v52, v2 row_newbcast:0 row_mask:0xf bank_mask:0x3
  s_nop 1
  v_add_u32_dpp v65, v54, v2 row_newbcast:6 row_mask:0xf bank_mask:0xc
  s_add_u32 m0, s76, 18432
  s_nop 0
  buffer_load_dwordx4 v65, s[32:35], 0 offen lds
  v_add_u32_dpp v56, v17, v2 row_newbcast:0 row_mask:0xf bank_mask:0x3
  s_nop 1
  v_add_u32_dpp v56, v19, v2 row_newbcast:6 row_mask:0xf bank_mask:0xc
  s_add_u32 m0, s76, 40960
  s_nop 0
  buffer_load_dwordx4 v56, s[32:35], 0 offen lds
  v_add_u32_dpp v57, v21, v2 row_newbcast:0 row_mask:0xf bank_mask:0x3
  s_nop 1
  v_add_u32_dpp v57, v23, v2 row_newbcast:6 row_mask:0xf bank_mask:0xc
  s_add_u32 m0, s76, 43008
  s_nop 0
  buffer_load_dwordx4 v57, s[32:35], 0 offen lds
  v_add_u32_dpp v58, v25, v2 row_newbcast:0 row_mask:0xf bank_mask:0x3
  s_nop 1
  v_add_u32_dpp v58, v27, v2 row_newbcast:6 row_mask:0xf bank_mask:0xc
  s_add_u32 m0, s76, 45056
  s_nop 0
  buffer_load_dwordx4 v58, s[32:35], 0 offen lds
  v_add_u32_dpp v59, v29, v2 row_newbcast:0 row_mask:0xf bank_mask:0x3
  s_nop 1
  v_add_u32_dpp v59, v31, v2 row_newbcast:6 row_mask:0xf bank_mask:0xc
  s_add_u32 m0, s76, 47104
  s_nop 0
  buffer_load_dwordx4 v59, s[32:35], 0 offen lds
  v_add_u32_dpp v60, v33, v2 row_newbcast:0 row_mask:0xf bank_mask:0x3
  s_nop 1
  v_add_u32_dpp v60, v35, v2 row_newbcast:6 row_mask:0xf bank_mask:0xc
  s_add_u32 m0, s76, 49152
  s_nop 0
  buffer_load_dwordx4 v60, s[32:35], 0 offen lds
  s_waitcnt vmcnt(11)
  s_barrier
  v_add_u32_dpp v61, v37, v2 row_newbcast:0 row_mask:0xf bank_mask:0x3
  s_nop 1
  v_add_u32_dpp v61, v39, v2 row_newbcast:6 row_mask:0xf bank_mask:0xc
  s_add_u32 m0, s76, 51200
  s_nop 0
  buffer_load_dwordx4 v61, s[32:35], 0 offen lds
  v_add_u32_dpp v62, v41, v2 row_newbcast:0 row_mask:0xf bank_mask:0x3
  s_nop 1
  v_add_u32_dpp v62, v43, v2 row_newbcast:6 row_mask:0xf bank_mask:0xc
  s_add_u32 m0, s76, 53248
  s_nop 0
  buffer_load_dwordx4 v62, s[32:35], 0 offen lds
  v_add_u32_dpp v63, v45, v2 row_newbcast:0 row_mask:0xf bank_mask:0x3
  s_nop 1
  v_add_u32_dpp v63, v47, v2 row_newbcast:6 row_mask:0xf bank_mask:0xc
  s_add_u32 m0, s76, 55296
  s_nop 0
  buffer_load_dwordx4 v63, s[32:35], 0 offen lds
  v_add_u32_dpp v64, v49, v2 row_newbcast:0 row_mask:0xf bank_mask:0x3
  s_nop 1
  v_add_u32_dpp v64, v51, v2 row_newbcast:6 row_mask:0xf bank_mask:0xc
  s_add_u32 m0, s76, 57344
  s_nop 0
  buffer_load_dwordx4 v64, s[32:35], 0 offen lds
  v_add_u32_dpp v65, v53, v2 row_newbcast:0 row_mask:0xf bank_mask:0x3
  s_nop 1
  v_add_u32_dpp v65, v55, v2 row_newbcast:6 row_mask:0xf bank_mask:0xc
  s_add_u32 m0, s76, 59392
  s_nop 0
  buffer_load_dwordx4 v65, s[32:35], 0 offen lds
  s_waitcnt vmcnt(10)
  s_barrier
  s_add_u32 m0, s75, 147456
  s_nop 0
  buffer_load_dwordx4 v4, s[44:47], s74 offen lds
  s_add_u32 m0, s75, 148480
  s_nop 0
  buffer_load_dwordx4 v5, s[44:47], s74 offen lds
  s_add_u32 s74, s74, 106496
  s_add_u32 m0, s75, 155648
  s_nop 0
  buffer_load_dwordx4 v4, s[44:47], s74 offen lds
  s_add_u32 m0, s75, 156672
  s_nop 0
  buffer_load_dwordx4 v5, s[44:47], s74 offen lds
  s_add_u32 s74, s74, 106496
  v_add_u32_dpp v56, v18, v2 row_newbcast:0 row_mask:0xf bank_mask:0x3
  v_add_u32_dpp v57, v22, v2 row_newbcast:0 row_mask:0xf bank_mask:0x3
  v_add_u32_dpp v58, v26, v2 row_newbcast:0 row_mask:0xf bank_mask:0x3
  v_add_u32_dpp v59, v30, v2 row_newbcast:0 row_mask:0xf bank_mask:0x3
  v_add_u32_dpp v60, v34, v2 row_newbcast:0 row_mask:0xf bank_mask:0x3
  v_add_u32_dpp v61, v38, v2 row_newbcast:0 row_mask:0xf bank_mask:0x3
  v_add_u32_dpp v62, v42, v2 row_newbcast:0 row_mask:0xf bank_mask:0x3
  v_add_u32_dpp v63, v46, v2 row_newbcast:0 row_mask:0xf bank_mask:0x3
  v_add_u32_dpp v64, v50, v2 row_newbcast:0 row_mask:0xf bank_mask:0x3
  v_add_u32_dpp v65, v54, v2 row_newbcast:0 row_mask:0xf bank_mask:0x3
  v_add_u32_dpp v56, v16, v2 row_newbcast:7 row_mask:0xf bank_mask:0xc
  v_add_u32_dpp v57, v20, v2 row_newbcast:7 row_mask:0xf bank_mask:0xc
  v_add_u32_dpp v58, v24, v2 row_newbcast:7 row_mask:0xf bank_mask:0xc
  v_add_u32_dpp v59, v28, v2 row_newbcast:7 row_mask:0xf bank_mask:0xc
  v_add_u32_dpp v60, v32, v2 row_newbcast:7 row_mask:0xf bank_mask:0xc
  v_add_u32_dpp v61, v36, v2 row_newbcast:7 row_mask:0xf bank_mask:0xc
  v_add_u32_dpp v62, v40, v2 row_newbcast:7 row_mask:0xf bank_mask:0xc
  v_add_u32_dpp v63, v44, v2 row_newbcast:7 row_mask:0xf bank_mask:0xc
  v_add_u32_dpp v64, v48, v2 row_newbcast:7 row_mask:0xf bank_mask:0xc
  v_add_u32_dpp v65, v52, v2 row_newbcast:7 row_mask:0xf bank_mask:0xc
  s_add_u32 m0, s76, 81920
  s_nop 0
  buffer_load_dwordx4 v56, s[32:35], 0 offen lds
  s_add_u32 m0, s76, 83968
  s_nop 0
  buffer_load_dwordx4 v57, s[32:35], 0 offen lds
  s_add_u32 m0, s76, 86016
  s_nop 0
  buffer_load_dwordx4 v58, s[32:35], 0 offen lds
  s_add_u32 m0, s76, 88064
  s_nop 0
  buffer_load_dwordx4 v59, s[32:35], 0 offen lds
  s_add_u32 m0, s76, 90112
  s_nop 0
  buffer_load_dwordx4 v60, s[32:35], 0 offen lds
  s_add_u32 m0, s76, 92160
  s_nop 0
  buffer_load_dwordx4 v61, s[32:35], 0 offen lds
  s_add_u32 m0, s76, 94208
  s_nop 0
  buffer_load_dwordx4 v62, s[32:35], 0 offen lds
  s_add_u32 m0, s76, 96256
  s_nop 0
  buffer_load_dwordx4 v63, s[32:35], 0 offen lds
  s_waitcnt vmcnt(8)
  s_barrier
  s_add_u32 m0, s76, 98304
  s_nop 0
  buffer_load_dwordx4 v64, s[32:35], 0 offen lds
  s_add_u32 m0, s76, 100352
  s_nop 0
  buffer_load_dwordx4 v65, s[32:35], 0 offen lds
  v_add_u32_dpp v56, v19, v2 row_newbcast:0 row_mask:0xf bank_mask:0x3
  v_add_u32_dpp v57, v23, v2 row_newbcast:0 row_mask:0xf bank_mask:0x3
  v_add_u32_dpp v58, v27, v2 row_newbcast:0 row_mask:0xf bank_mask:0x3
  v_add_u32_dpp v59, v31, v2 row_newbcast:0 row_mask:0xf bank_mask:0x3
  v_add_u32_dpp v60, v35, v2 row_newbcast:0 row_mask:0xf bank_mask:0x3
  v_add_u32_dpp v61, v39, v2 row_newbcast:0 row_mask:0xf bank_mask:0x3
  v_add_u32_dpp v62, v43, v2 row_newbcast:0 row_mask:0xf bank_mask:0x3
  v_add_u32_dpp v63, v47, v2 row_newbcast:0 row_mask:0xf bank_mask:0x3
  v_add_u32_dpp v64, v51, v2 row_newbcast:0 row_mask:0xf bank_mask:0x3
  v_add_u32_dpp v65, v55, v2 row_newbcast:0 row_mask:0xf bank_mask:0x3
  v_add_u32_dpp v56, v17, v2 row_newbcast:7 row_mask:0xf bank_mask:0xc
  v_add_u32_dpp v57, v21, v2 row_newbcast:7 row_mask:0xf bank_mask:0xc
  v_add_u32_dpp v58, v25, v2 row_newbcast:7 row_mask:0xf bank_mask:0xc
  v_add_u32_dpp v59, v29, v2 row_newbcast:7 row_mask:0xf bank_mask:0xc
  v_add_u32_dpp v60, v33, v2 row_newbcast:7 row_mask:0xf bank_mask:0xc
  v_add_u32_dpp v61, v37, v2 row_newbcast:7 row_mask:0xf bank_mask:0xc
  v_add_u32_dpp v62, v41, v2 row_newbcast:7 row_mask:0xf bank_mask:0xc
  v_add_u32_dpp v63, v45, v2 row_newbcast:7 row_mask:0xf bank_mask:0xc
  v_add_u32_dpp v64, v49, v2 row_newbcast:7 row_mask:0xf bank_mask:0xc
  v_add_u32_dpp v65, v53, v2 row_newbcast:7 row_mask:0xf bank_mask:0xc
  s_setprio 0
  s_branch L_ld_in
L_cmp:
  s_mul_i32 s70, s3, 13
  v_min_u32 v118, 12, v0
  v_add_u32 v118, s70, v118
  v_lshrrev_b32 v117, 1, v118
  v_mul_u32_u24 v117, 96, v117
  v_lshl_add_u32 v118, v118, 2, v117
  s_mul_i32 s78, s27, 25
  s_min_u32 s78, s78, 294
  s_add_u32 s78, s78, s71
  s_mul_i32 s78, s78, 104
  s_waitcnt lgkmcnt(0)
  s_mov_b32 s28, s4
  s_and_b32 s29, s5, 0xffff
  s_mov_b32 s30, 425984
  s_mov_b32 s31, 0x20000
  s_mov_b32 s32, s6
  s_and_b32 s33, s7, 0xffff
  s_mov_b32 s34, 12800000
  s_mov_b32 s35, 0x20000
  s_mov_b32 s48, s14
  s_and_b32 s49, s15, 0xffff
  s_mov_b32 s50, 3328
  s_mov_b32 s51, 0x20000
  s_mov_b32 m0, 122880
  s_mov_b64 exec, 0xffff
  buffer_load_dwordx4 v11, s[48:51], s77 offen lds
  s_mov_b64 exec, -1
  s_and_b32 s68, s3, 1
  s_lshr_b32 s69, s3, 1
  v_bfe_u32 v117, v0, 2, 2
  v_lshl_add_u32 v118, v116, 3, v117
  v_lshlrev_b32 v118, 8, v118
  v_bfe_u32 v117, v0, 2, 3
  s_lshl_b32 s70, s69, 2
  v_xor_b32 v117, s70, v117
  v_lshl_add_u32 v118, v117, 5, v118
  v_and_b32 v117, 3, v0
  v_lshl_add_u32 v118, v117, 3, v118
  v_add_u32 v1, 131072, v118
  v_xor_b32 v2, 32, v1
  v_xor_b32 v3, 64, v1
  v_xor_b32 v4, 96, v1
  s_lshl_b32 s70, s69, 7
  s_add_u32 s70, s70, 122880
  v_lshlrev_b32 v118, 3, v116
  v_add_u32 v9, s70, v118
  v_and_b32 v118, 15, v0
  v_lshlrev_b32 v118, 7, v118
  v_bfe_u32 v117, v0, 1, 3
  v_xor_b32 v117, v117, v116
  v_lshl_add_u32 v118, v117, 4, v118
  s_mul_i32 s70, s68, 20480
  v_add_u32 v5, s70, v118
  v_xor_b32_e64 v7, 64, v5
  v_add_u32 v6, 81920, v5
  v_add_u32 v8, 81920, v7
  s_mul_i32 s70, s3, 640
  s_add_u32 s70, s70, 123392
  v_and_b32 v118, 15, v0
  v_lshlrev_b32 v118, 2, v118
  v_add_u32 v118, s70, v118
  v_lshrrev_b32_e64 v117, 5, v0
  v_lshl_add_u32 v118, v117, 6, v118
  v_bfe_u32 v117, v0, 4, 1
  v_lshl_add_u32 v10, v117, 7, v118
  s_mov_b32 s72, 0
  v_mov_b32 v12, 0xc0135761
  v_mov_b32 v13, 0xc0135761
  v_mov_b32 v14, 0xbdd2d3e8
  v_mov_b32 v15, 0xbdd2d3e8
  s_waitcnt vmcnt(0)
  ds_read_b64 v[18:19], v9 offset:0
  ds_read_b64 v[22:23], v9 offset:32
  ds_read_b64 v[26:27], v9 offset:64
  ds_read_b64 v[30:31], v9 offset:96
  s_waitcnt lgkmcnt(3)
  v_lshlrev_b32 v16, 16, v18
  v_and_b32 v17, 0xffff0000, v18
  v_lshlrev_b32 v18, 16, v19
  v_and_b32 v19, 0xffff0000, v19
  s_waitcnt lgkmcnt(2)
  v_lshlrev_b32 v20, 16, v22
  v_and_b32 v21, 0xffff0000, v22
  v_lshlrev_b32 v22, 16, v23
  v_and_b32 v23, 0xffff0000, v23
  s_waitcnt lgkmcnt(1)
  v_lshlrev_b32_e64 v24, 16, v26
  v_and_b32 v25, 0xffff0000, v26
  v_lshlrev_b32 v26, 16, v27
  v_and_b32 v27, 0xffff0000, v27
  s_waitcnt lgkmcnt(0)
  v_lshlrev_b32 v28, 16, v30
  v_and_b32 v29, 0xffff0000, v30
  v_lshlrev_b32 v30, 16, v31
  v_and_b32 v31, 0xffff0000, v31
  v_mov_b64 v[88:89], v[16:17]
  v_mov_b64 v[90:91], v[18:19]
  v_mov_b64 v[92:93], v[20:21]
  v_mov_b64 v[94:95], v[22:23]
  v_mov_b64 v[96:97], v[24:25]
  v_mov_b64 v[98:99], v[26:27]
  v_mov_b64 v[100:101], v[28:29]
  v_mov_b64 v[102:103], v[30:31]
  v_mov_b64 v[104:105], v[16:17]
  v_mov_b64 v[106:107], v[18:19]
  v_mov_b64 v[108:109], v[20:21]
  v_mov_b64 v[110:111], v[22:23]
  v_mov_b64 v[112:113], v[24:25]
  v_mov_b64 v[114:115], v[26:27]
  v_mov_b64 v[116:117], v[28:29]
  v_mov_b64 v[118:119], v[30:31]
  v_mov_b64 v[120:121], v[16:17]
  v_mov_b64 v[122:123], v[18:19]
  v_mov_b64 v[124:125], v[20:21]
  v_mov_b64 v[126:127], v[22:23]
  v_mov_b64 v[128:129], v[24:25]
  v_mov_b64 v[130:131], v[26:27]
  v_mov_b64 v[132:133], v[28:29]
  v_mov_b64 v[134:135], v[30:31]
  v_mov_b64 v[136:137], v[16:17]
  v_mov_b64 v[138:139], v[18:19]
  v_mov_b64 v[140:141], v[20:21]
  v_mov_b64 v[142:143], v[22:23]
  v_mov_b64 v[144:145], v[24:25]
  v_mov_b64 v[146:147], v[26:27]
  v_mov_b64 v[148:149], v[28:29]
  v_mov_b64 v[150:151], v[30:31]
  v_mov_b64 v[152:153], v[16:17]
  v_mov_b64 v[154:155], v[18:19]
  v_mov_b64 v[156:157], v[20:21]
  v_mov_b64 v[158:159], v[22:23]
  v_mov_b64 v[160:161], v[24:25]
  v_mov_b64 v[162:163], v[26:27]
  v_mov_b64 v[164:165], v[28:29]
  v_mov_b64 v[166:167], v[30:31]
  v_mov_b64 v[168:169], v[16:17]
  v_mov_b64 v[170:171], v[18:19]
  v_mov_b64 v[172:173], v[20:21]
  v_mov_b64 v[174:175], v[22:23]
  v_mov_b64 v[176:177], v[24:25]
  v_mov_b64 v[178:179], v[26:27]
  v_mov_b64 v[180:181], v[28:29]
  v_mov_b64 v[182:183], v[30:31]
  v_mov_b64 v[184:185], v[16:17]
  v_mov_b64 v[186:187], v[18:19]
  v_mov_b64 v[188:189], v[20:21]
  v_mov_b64 v[190:191], v[22:23]
  v_mov_b64 v[192:193], v[24:25]
  v_mov_b64 v[194:195], v[26:27]
  v_mov_b64 v[196:197], v[28:29]
  v_mov_b64 v[198:199], v[30:31]
  v_mov_b64 v[200:201], v[16:17]
  v_mov_b64 v[202:203], v[18:19]
  v_mov_b64 v[204:205], v[20:21]
  v_mov_b64 v[206:207], v[22:23]
  v_mov_b64 v[208:209], v[24:25]
  v_mov_b64 v[210:211], v[26:27]
  v_mov_b64 v[212:213], v[28:29]
  v_mov_b64 v[214:215], v[30:31]
  v_mov_b64 v[216:217], v[16:17]
  v_mov_b64 v[218:219], v[18:19]
  v_mov_b64 v[220:221], v[20:21]
  v_mov_b64 v[222:223], v[22:23]
  v_mov_b64 v[224:225], v[24:25]
  v_mov_b64 v[226:227], v[26:27]
  v_mov_b64 v[228:229], v[28:29]
  v_mov_b64 v[230:231], v[30:31]
  v_mov_b64 v[232:233], v[16:17]
  v_mov_b64 v[234:235], v[18:19]
  v_mov_b64 v[236:237], v[20:21]
  v_mov_b64 v[238:239], v[22:23]
  v_mov_b64 v[240:241], v[24:25]
  v_mov_b64 v[242:243], v[26:27]
  v_mov_b64 v[244:245], v[28:29]
  v_mov_b64 v[246:247], v[30:31]
  s_barrier
  ds_read_b64_tr_b16 v[16:17], v1 offset:0
  ds_read_b64_tr_b16 v[18:19], v1 offset:1024
  ds_read_b64_tr_b16 v[32:33], v1 offset:8192
  ds_read_b64_tr_b16 v[34:35], v1 offset:9216
  ds_read_b64_tr_b16 v[20:21], v2 offset:0
  ds_read_b64_tr_b16 v[22:23], v2 offset:1024
  ds_read_b64_tr_b16 v[36:37], v2 offset:8192
  ds_read_b64_tr_b16 v[38:39], v2 offset:9216
  ds_read_b64_tr_b16 v[24:25], v3 offset:0
  ds_read_b64_tr_b16 v[26:27], v3 offset:1024
  ds_read_b64_tr_b16 v[40:41], v3 offset:8192
  ds_read_b64_tr_b16 v[42:43], v3 offset:9216
  ds_read_b64_tr_b16 v[28:29], v4 offset:0
  ds_read_b64_tr_b16 v[30:31], v4 offset:1024
  ds_read_b64_tr_b16 v[44:45], v4 offset:8192
  ds_read_b64_tr_b16 v[46:47], v4 offset:9216
  s_waitcnt lgkmcnt(0)
  s_setprio 1
  s_barrier
  ds_read_b128 v[48:51], v5 offset:0
  ds_read_b128 v[52:55], v7 offset:0
  ds_read_b128 v[56:59], v5 offset:2048
  ds_read_b128 v[60:63], v7 offset:2048
  ds_read_b128 v[64:67], v5 offset:4096
  ds_read_b128 v[68:71], v7 offset:4096
  ds_read_b128 v[72:75], v5 offset:6144
  ds_read_b128 v[76:79], v7 offset:6144
  s_waitcnt lgkmcnt(7)
  v_mfma_f32_16x16x32_bf16 v[88:91], v[16:19], v[48:51], v[88:91]
  s_waitcnt lgkmcnt(4)
  v_mfma_f32_16x16x32_bf16 v[88:91], v[32:35], v[52:55], v[88:91]
  v_mfma_f32_16x16x32_bf16 v[104:107], v[16:19], v[56:59], v[104:107]
  v_mfma_f32_16x16x32_bf16 v[104:107], v[32:35], v[60:63], v[104:107]
  v_mfma_f32_16x16x32_bf16 v[92:95], v[20:23], v[48:51], v[92:95]
  v_mfma_f32_16x16x32_bf16 v[92:95], v[36:39], v[52:55], v[92:95]
  v_mfma_f32_16x16x32_bf16 v[108:111], v[20:23], v[56:59], v[108:111]
  v_mfma_f32_16x16x32_bf16 v[108:111], v[36:39], v[60:63], v[108:111]
  v_mfma_f32_16x16x32_bf16 v[96:99], v[24:27], v[48:51], v[96:99]
  v_xor_b32 v1, 16384, v1
  v_mfma_f32_16x16x32_bf16 v[96:99], v[40:43], v[52:55], v[96:99]
  v_xor_b32 v2, 16384, v2
  v_mfma_f32_16x16x32_bf16 v[112:115], v[24:27], v[56:59], v[112:115]
  v_xor_b32 v3, 16384, v3
  v_mfma_f32_16x16x32_bf16 v[112:115], v[40:43], v[60:63], v[112:115]
  v_xor_b32 v4, 16384, v4
  v_mfma_f32_16x16x32_bf16 v[100:103], v[28:31], v[48:51], v[100:103]
  v_mfma_f32_16x16x32_bf16 v[100:103], v[44:47], v[52:55], v[100:103]
  v_mfma_f32_16x16x32_bf16 v[116:119], v[28:31], v[56:59], v[116:119]
  s_waitcnt lgkmcnt(2)
  v_mfma_f32_16x16x32_bf16 v[116:119], v[44:47], v[60:63], v[116:119]
  s_nop 0
  v_mfma_f32_16x16x32_bf16 v[120:123], v[16:19], v[64:67], v[120:123]
  s_barrier
  s_waitcnt lgkmcnt(0)
  v_mfma_f32_16x16x32_bf16 v[120:123], v[32:35], v[68:71], v[120:123]
  ds_read_b128 v[80:83], v5 offset:8192
  v_mfma_f32_16x16x32_bf16 v[136:139], v[16:19], v[72:75], v[136:139]
  ds_read_b128 v[84:87], v7 offset:8192
  v_mfma_f32_16x16x32_bf16 v[136:139], v[32:35], v[76:79], v[136:139]
  ds_read_b128 v[48:51], v5 offset:10240
  v_mfma_f32_16x16x32_bf16 v[124:127], v[20:23], v[64:67], v[124:127]
  ds_read_b128 v[52:55], v7 offset:10240
  v_mfma_f32_16x16x32_bf16 v[124:127], v[36:39], v[68:71], v[124:127]
  ds_read_b128 v[56:59], v5 offset:12288
  v_mfma_f32_16x16x32_bf16 v[140:143], v[20:23], v[72:75], v[140:143]
  ds_read_b128 v[60:63], v7 offset:12288
  v_mfma_f32_16x16x32_bf16 v[140:143], v[36:39], v[76:79], v[140:143]
  v_mfma_f32_16x16x32_bf16 v[128:131], v[24:27], v[64:67], v[128:131]
  v_mfma_f32_16x16x32_bf16 v[128:131], v[40:43], v[68:71], v[128:131]
  v_mfma_f32_16x16x32_bf16 v[144:147], v[24:27], v[72:75], v[144:147]
  v_mfma_f32_16x16x32_bf16 v[144:147], v[40:43], v[76:79], v[144:147]
  v_mfma_f32_16x16x32_bf16 v[132:135], v[28:31], v[64:67], v[132:135]
  ds_read_b128 v[64:67], v5 offset:14336
  v_mfma_f32_16x16x32_bf16 v[132:135], v[44:47], v[68:71], v[132:135]
  s_nop 0
  ds_read_b128 v[68:71], v7 offset:14336
  v_mfma_f32_16x16x32_bf16 v[148:151], v[28:31], v[72:75], v[148:151]
  ds_read_b128 v[72:75], v5 offset:16384
  s_waitcnt lgkmcnt(7)
  v_mfma_f32_16x16x32_bf16 v[148:151], v[44:47], v[76:79], v[148:151]
  ds_read_b128 v[76:79], v7 offset:16384
  v_mfma_f32_16x16x32_bf16 v[152:155], v[16:19], v[80:83], v[152:155]
  s_waitcnt lgkmcnt(6)
  v_mfma_f32_16x16x32_bf16 v[152:155], v[32:35], v[84:87], v[152:155]
  v_mfma_f32_16x16x32_bf16 v[168:171], v[16:19], v[48:51], v[168:171]
  v_mfma_f32_16x16x32_bf16 v[168:171], v[32:35], v[52:55], v[168:171]
  v_mfma_f32_16x16x32_bf16 v[156:159], v[20:23], v[80:83], v[156:159]
  s_nop 0
  v_mfma_f32_16x16x32_bf16 v[156:159], v[36:39], v[84:87], v[156:159]
  v_mfma_f32_16x16x32_bf16 v[172:175], v[20:23], v[48:51], v[172:175]
  v_mfma_f32_16x16x32_bf16 v[172:175], v[36:39], v[52:55], v[172:175]
  v_mfma_f32_16x16x32_bf16 v[160:163], v[24:27], v[80:83], v[160:163]
  v_mfma_f32_16x16x32_bf16 v[160:163], v[40:43], v[84:87], v[160:163]
  v_mfma_f32_16x16x32_bf16 v[176:179], v[24:27], v[48:51], v[176:179]
  v_mfma_f32_16x16x32_bf16 v[176:179], v[40:43], v[52:55], v[176:179]
  v_mfma_f32_16x16x32_bf16 v[164:167], v[28:31], v[80:83], v[164:167]
  ds_read_b128 v[80:83], v5 offset:18432
  v_mfma_f32_16x16x32_bf16 v[164:167], v[44:47], v[84:87], v[164:167]
  ds_read_b128 v[84:87], v7 offset:18432
  v_mfma_f32_16x16x32_bf16 v[180:183], v[28:31], v[48:51], v[180:183]
  s_waitcnt lgkmcnt(6)
  v_mfma_f32_16x16x32_bf16 v[180:183], v[44:47], v[52:55], v[180:183]
  v_mfma_f32_16x16x32_bf16 v[184:187], v[16:19], v[56:59], v[184:187]
  s_waitcnt lgkmcnt(4)
  v_mfma_f32_16x16x32_bf16 v[184:187], v[32:35], v[60:63], v[184:187]
  v_mfma_f32_16x16x32_bf16 v[200:203], v[16:19], v[64:67], v[200:203]
  v_mfma_f32_16x16x32_bf16 v[200:203], v[32:35], v[68:71], v[200:203]
  v_mfma_f32_16x16x32_bf16 v[188:191], v[20:23], v[56:59], v[188:191]
  v_mfma_f32_16x16x32_bf16 v[188:191], v[36:39], v[60:63], v[188:191]
  s_waitcnt lgkmcnt(0)
  s_barrier
  v_mfma_f32_16x16x32_bf16 v[204:207], v[20:23], v[64:67], v[204:207]
  ds_read_b128 v[48:51], v5 offset:40960
  v_mfma_f32_16x16x32_bf16 v[204:207], v[36:39], v[68:71], v[204:207]
  ds_read_b128 v[52:55], v7 offset:40960
  v_mfma_f32_16x16x32_bf16 v[192:195], v[24:27], v[56:59], v[192:195]
  v_mfma_f32_16x16x32_bf16 v[192:195], v[40:43], v[60:63], v[192:195]
  v_mfma_f32_16x16x32_bf16 v[208:211], v[24:27], v[64:67], v[208:211]
  v_mfma_f32_16x16x32_bf16 v[208:211], v[40:43], v[68:71], v[208:211]
  v_mfma_f32_16x16x32_bf16 v[196:199], v[28:31], v[56:59], v[196:199]
  ds_read_b128 v[56:59], v5 offset:43008
  v_mfma_f32_16x16x32_bf16 v[196:199], v[44:47], v[60:63], v[196:199]
  ds_read_b128 v[60:63], v7 offset:43008
  v_mfma_f32_16x16x32_bf16 v[212:215], v[28:31], v[64:67], v[212:215]
  ds_read_b128 v[64:67], v5 offset:45056
  v_mfma_f32_16x16x32_bf16 v[212:215], v[44:47], v[68:71], v[212:215]
  ds_read_b128 v[68:71], v7 offset:45056
  v_mfma_f32_16x16x32_bf16 v[216:219], v[16:19], v[72:75], v[216:219]
  v_mfma_f32_16x16x32_bf16 v[216:219], v[32:35], v[76:79], v[216:219]
  v_mfma_f32_16x16x32_bf16 v[232:235], v[16:19], v[80:83], v[232:235]
  ds_read_b64_tr_b16 v[16:17], v1 offset:0
  v_mfma_f32_16x16x32_bf16 v[232:235], v[32:35], v[84:87], v[232:235]
  ds_read_b64_tr_b16 v[18:19], v1 offset:1024
  v_mfma_f32_16x16x32_bf16 v[220:223], v[20:23], v[72:75], v[220:223]
  ds_read_b64_tr_b16 v[32:33], v1 offset:8192
  v_mfma_f32_16x16x32_bf16 v[220:223], v[36:39], v[76:79], v[220:223]
  ds_read_b64_tr_b16 v[34:35], v1 offset:9216
  v_mfma_f32_16x16x32_bf16 v[236:239], v[20:23], v[80:83], v[236:239]
  ds_read_b64_tr_b16 v[20:21], v2 offset:0
  v_mfma_f32_16x16x32_bf16 v[236:239], v[36:39], v[84:87], v[236:239]
  ds_read_b64_tr_b16 v[22:23], v2 offset:1024
  v_mfma_f32_16x16x32_bf16 v[224:227], v[24:27], v[72:75], v[224:227]
  ds_read_b64_tr_b16 v[36:37], v2 offset:8192
  v_mfma_f32_16x16x32_bf16 v[224:227], v[40:43], v[76:79], v[224:227]
  ds_read_b64_tr_b16 v[38:39], v2 offset:9216
  v_mfma_f32_16x16x32_bf16 v[240:243], v[24:27], v[80:83], v[240:243]
  ds_read_b64_tr_b16 v[24:25], v3 offset:0
  v_mfma_f32_16x16x32_bf16 v[240:243], v[40:43], v[84:87], v[240:243]
  ds_read_b64_tr_b16 v[26:27], v3 offset:1024
  v_mfma_f32_16x16x32_bf16 v[228:231], v[28:31], v[72:75], v[228:231]
  ds_read_b64_tr_b16 v[40:41], v3 offset:8192
  v_mfma_f32_16x16x32_bf16 v[228:231], v[44:47], v[76:79], v[228:231]
  ds_read_b64_tr_b16 v[42:43], v3 offset:9216
  v_mfma_f32_16x16x32_bf16 v[244:247], v[28:31], v[80:83], v[244:247]
  ds_read_b64_tr_b16 v[28:29], v4 offset:0
  s_waitcnt lgkmcnt(9)
  v_mfma_f32_16x16x32_bf16 v[244:247], v[44:47], v[84:87], v[244:247]
  ds_read_b64_tr_b16 v[30:31], v4 offset:1024
L_dnn_loop0:
  v_mfma_f32_16x16x32_bf16 v[88:91], v[16:19], v[48:51], v[88:91]
  ds_read_b64_tr_b16 v[44:45], v4 offset:8192
  v_mfma_f32_16x16x32_bf16 v[88:91], v[32:35], v[52:55], v[88:91]
  s_nop 0
  ds_read_b64_tr_b16 v[46:47], v4 offset:9216
  v_mfma_f32_16x16x32_bf16 v[104:107], v[16:19], v[56:59], v[104:107]
  ds_read_b128 v[72:75], v5 offset:47104
  s_waitcnt lgkmcnt(9)
  v_mfma_f32_16x16x32_bf16 v[104:107], v[32:35], v[60:63], v[104:107]
  ds_read_b128 v[76:79], v7 offset:47104
  v_mfma_f32_16x16x32_bf16 v[92:95], v[20:23], v[48:51], v[92:95]
  ds_read_b128 v[80:83], v5 offset:49152
  v_mfma_f32_16x16x32_bf16 v[92:95], v[36:39], v[52:55], v[92:95]
  s_nop 0
  ds_read_b128 v[84:87], v7 offset:49152
  v_mfma_f32_16x16x32_bf16 v[108:111], v[20:23], v[56:59], v[108:111]
  s_waitcnt lgkmcnt(8)
  v_mfma_f32_16x16x32_bf16 v[108:111], v[36:39], v[60:63], v[108:111]
  v_mfma_f32_16x16x32_bf16 v[96:99], v[24:27], v[48:51], v[96:99]
  v_xor_b32 v1, 16384, v1
  v_mfma_f32_16x16x32_bf16 v[96:99], v[40:43], v[52:55], v[96:99]
  s_nop 0
  v_xor_b32 v2, 16384, v2
  v_mfma_f32_16x16x32_bf16 v[112:115], v[24:27], v[56:59], v[112:115]
  v_xor_b32 v3, 16384, v3
  s_waitcnt lgkmcnt(4)
  v_mfma_f32_16x16x32_bf16 v[112:115], v[40:43], v[60:63], v[112:115]
  v_xor_b32 v4, 16384, v4
  v_mfma_f32_16x16x32_bf16 v[100:103], v[28:31], v[48:51], v[100:103]
  ds_read_b128 v[48:51], v5 offset:51200
  v_mfma_f32_16x16x32_bf16 v[100:103], v[44:47], v[52:55], v[100:103]
  s_nop 0
  ds_read_b128 v[52:55], v7 offset:51200
  v_mfma_f32_16x16x32_bf16 v[116:119], v[28:31], v[56:59], v[116:119]
  ds_read_b128 v[56:59], v5 offset:53248
  v_mfma_f32_16x16x32_bf16 v[116:119], v[44:47], v[60:63], v[116:119]
  ds_read_b128 v[60:63], v7 offset:53248
  v_mfma_f32_16x16x32_bf16 v[120:123], v[16:19], v[64:67], v[120:123]
  s_waitcnt lgkmcnt(6)
  v_mfma_f32_16x16x32_bf16 v[120:123], v[32:35], v[68:71], v[120:123]
  s_nop 0
  v_mfma_f32_16x16x32_bf16 v[136:139], v[16:19], v[72:75], v[136:139]
  v_mfma_f32_16x16x32_bf16 v[136:139], v[32:35], v[76:79], v[136:139]
  v_mfma_f32_16x16x32_bf16 v[124:127], v[20:23], v[64:67], v[124:127]
  v_mfma_f32_16x16x32_bf16 v[124:127], v[36:39], v[68:71], v[124:127]
  v_mfma_f32_16x16x32_bf16 v[140:143], v[20:23], v[72:75], v[140:143]
  v_mfma_f32_16x16x32_bf16 v[140:143], v[36:39], v[76:79], v[140:143]
  v_mfma_f32_16x16x32_bf16 v[128:131], v[24:27], v[64:67], v[128:131]
  v_mfma_f32_16x16x32_bf16 v[128:131], v[40:43], v[68:71], v[128:131]
  v_mfma_f32_16x16x32_bf16 v[144:147], v[24:27], v[72:75], v[144:147]
  v_mfma_f32_16x16x32_bf16 v[144:147], v[40:43], v[76:79], v[144:147]
  v_mfma_f32_16x16x32_bf16 v[132:135], v[28:31], v[64:67], v[132:135]
  ds_read_b128 v[64:67], v5 offset:55296
  v_mfma_f32_16x16x32_bf16 v[132:135], v[44:47], v[68:71], v[132:135]
  ds_read_b128 v[68:71], v7 offset:55296
  v_mfma_f32_16x16x32_bf16 v[148:151], v[28:31], v[72:75], v[148:151]
  ds_read_b128 v[72:75], v5 offset:57344
  s_waitcnt lgkmcnt(7)
  v_mfma_f32_16x16x32_bf16 v[148:151], v[44:47], v[76:79], v[148:151]
  ds_read_b128 v[76:79], v7 offset:57344
  v_mfma_f32_16x16x32_bf16 v[152:155], v[16:19], v[80:83], v[152:155]
  s_waitcnt lgkmcnt(6)
  v_mfma_f32_16x16x32_bf16 v[152:155], v[32:35], v[84:87], v[152:155]
  v_mfma_f32_16x16x32_bf16 v[168:171], v[16:19], v[48:51], v[168:171]
  v_mfma_f32_16x16x32_bf16 v[168:171], v[32:35], v[52:55], v[168:171]
  v_mfma_f32_16x16x32_bf16 v[156:159], v[20:23], v[80:83], v[156:159]
  v_mfma_f32_16x16x32_bf16 v[156:159], v[36:39], v[84:87], v[156:159]
  v_mfma_f32_16x16x32_bf16 v[172:175], v[20:23], v[48:51], v[172:175]
  v_mfma_f32_16x16x32_bf16 v[172:175], v[36:39], v[52:55], v[172:175]
  v_mfma_f32_16x16x32_bf16 v[160:163], v[24:27], v[80:83], v[160:163]
  v_mfma_f32_16x16x32_bf16 v[160:163], v[40:43], v[84:87], v[160:163]
  v_mfma_f32_16x16x32_bf16 v[176:179], v[24:27], v[48:51], v[176:179]
  v_mfma_f32_16x16x32_bf16 v[176:179], v[40:43], v[52:55], v[176:179]
  v_mfma_f32_16x16x32_bf16 v[164:167], v[28:31], v[80:83], v[164:167]
  ds_read_b128 v[80:83], v5 offset:59392
  v_mfma_f32_16x16x32_bf16 v[164:167], v[44:47], v[84:87], v[164:167]
  ds_read_b128 v[84:87], v7 offset:59392
  v_mfma_f32_16x16x32_bf16 v[180:183], v[28:31], v[48:51], v[180:183]
  s_waitcnt lgkmcnt(6)
  v_mfma_f32_16x16x32_bf16 v[180:183], v[44:47], v[52:55], v[180:183]
  v_mfma_f32_16x16x32_bf16 v[184:187], v[16:19], v[56:59], v[184:187]
  s_waitcnt lgkmcnt(4)
  v_mfma_f32_16x16x32_bf16 v[184:187], v[32:35], v[60:63], v[184:187]
  v_mfma_f32_16x16x32_bf16 v[200:203], v[16:19], v[64:67], v[200:203]
  v_mfma_f32_16x16x32_bf16 v[200:203], v[32:35], v[68:71], v[200:203]
  v_mfma_f32_16x16x32_bf16 v[188:191], v[20:23], v[56:59], v[188:191]
  v_mfma_f32_16x16x32_bf16 v[188:191], v[36:39], v[60:63], v[188:191]
  s_waitcnt lgkmcnt(0)
  s_barrier
  v_mfma_f32_16x16x32_bf16 v[204:207], v[20:23], v[64:67], v[204:207]
  ds_read_b128 v[48:51], v6 offset:0
  v_mfma_f32_16x16x32_bf16 v[204:207], v[36:39], v[68:71], v[204:207]
  ds_read_b128 v[52:55], v8 offset:0
  v_mfma_f32_16x16x32_bf16 v[192:195], v[24:27], v[56:59], v[192:195]
  v_mfma_f32_16x16x32_bf16 v[192:195], v[40:43], v[60:63], v[192:195]
  v_mfma_f32_16x16x32_bf16 v[208:211], v[24:27], v[64:67], v[208:211]
  v_mfma_f32_16x16x32_bf16 v[208:211], v[40:43], v[68:71], v[208:211]
  v_mfma_f32_16x16x32_bf16 v[196:199], v[28:31], v[56:59], v[196:199]
  ds_read_b128 v[56:59], v6 offset:2048
  v_mfma_f32_16x16x32_bf16 v[196:199], v[44:47], v[60:63], v[196:199]
  ds_read_b128 v[60:63], v8 offset:2048
  v_mfma_f32_16x16x32_bf16 v[212:215], v[28:31], v[64:67], v[212:215]
  ds_read_b128 v[64:67], v6 offset:4096
  v_mfma_f32_16x16x32_bf16 v[212:215], v[44:47], v[68:71], v[212:215]
  ds_read_b128 v[68:71], v8 offset:4096
  v_mfma_f32_16x16x32_bf16 v[216:219], v[16:19], v[72:75], v[216:219]
  v_mfma_f32_16x16x32_bf16 v[216:219], v[32:35], v[76:79], v[216:219]
  v_mfma_f32_16x16x32_bf16 v[232:235], v[16:19], v[80:83], v[232:235]
  ds_read_b64_tr_b16 v[16:17], v1 offset:0
  v_mfma_f32_16x16x32_bf16 v[232:235], v[32:35], v[84:87], v[232:235]
  ds_read_b64_tr_b16 v[18:19], v1 offset:1024
  v_mfma_f32_16x16x32_bf16 v[220:223], v[20:23], v[72:75], v[220:223]
  ds_read_b64_tr_b16 v[32:33], v1 offset:8192
  v_mfma_f32_16x16x32_bf16 v[220:223], v[36:39], v[76:79], v[220:223]
  ds_read_b64_tr_b16 v[34:35], v1 offset:9216
  v_mfma_f32_16x16x32_bf16 v[236:239], v[20:23], v[80:83], v[236:239]
  ds_read_b64_tr_b16 v[20:21], v2 offset:0
  v_mfma_f32_16x16x32_bf16 v[236:239], v[36:39], v[84:87], v[236:239]
  ds_read_b64_tr_b16 v[22:23], v2 offset:1024
  v_mfma_f32_16x16x32_bf16 v[224:227], v[24:27], v[72:75], v[224:227]
  ds_read_b64_tr_b16 v[36:37], v2 offset:8192
  v_mfma_f32_16x16x32_bf16 v[224:227], v[40:43], v[76:79], v[224:227]
  ds_read_b64_tr_b16 v[38:39], v2 offset:9216
  v_mfma_f32_16x16x32_bf16 v[240:243], v[24:27], v[80:83], v[240:243]
  ds_read_b64_tr_b16 v[24:25], v3 offset:0
  v_mfma_f32_16x16x32_bf16 v[240:243], v[40:43], v[84:87], v[240:243]
  ds_read_b64_tr_b16 v[26:27], v3 offset:1024
  v_mfma_f32_16x16x32_bf16 v[228:231], v[28:31], v[72:75], v[228:231]
  ds_read_b64_tr_b16 v[40:41], v3 offset:8192
  v_mfma_f32_16x16x32_bf16 v[228:231], v[44:47], v[76:79], v[228:231]
  ds_read_b64_tr_b16 v[42:43], v3 offset:9216
  v_mfma_f32_16x16x32_bf16 v[244:247], v[28:31], v[80:83], v[244:247]
  ds_read_b64_tr_b16 v[28:29], v4 offset:0
  s_waitcnt lgkmcnt(9)
  v_mfma_f32_16x16x32_bf16 v[244:247], v[44:47], v[84:87], v[244:247]
  ds_read_b64_tr_b16 v[30:31], v4 offset:1024
  v_mfma_f32_16x16x32_bf16 v[88:91], v[16:19], v[48:51], v[88:91]
  ds_read_b64_tr_b16 v[44:45], v4 offset:8192
  v_mfma_f32_16x16x32_bf16 v[88:91], v[32:35], v[52:55], v[88:91]
  s_nop 0
  ds_read_b64_tr_b16 v[46:47], v4 offset:9216
  v_mfma_f32_16x16x32_bf16 v[104:107], v[16:19], v[56:59], v[104:107]
  ds_read_b128 v[72:75], v6 offset:6144
  s_waitcnt lgkmcnt(9)
  v_mfma_f32_16x16x32_bf16 v[104:107], v[32:35], v[60:63], v[104:107]
  ds_read_b128 v[76:79], v8 offset:6144
  v_mfma_f32_16x16x32_bf16 v[92:95], v[20:23], v[48:51], v[92:95]
  ds_read_b128 v[80:83], v6 offset:8192
  v_mfma_f32_16x16x32_bf16 v[92:95], v[36:39], v[52:55], v[92:95]
  s_nop 0
  ds_read_b128 v[84:87], v8 offset:8192
  v_mfma_f32_16x16x32_bf16 v[108:111], v[20:23], v[56:59], v[108:111]
  s_waitcnt lgkmcnt(8)
  v_mfma_f32_16x16x32_bf16 v[108:111], v[36:39], v[60:63], v[108:111]
  v_mfma_f32_16x16x32_bf16 v[96:99], v[24:27], v[48:51], v[96:99]
  v_xor_b32 v1, 16384, v1
  v_mfma_f32_16x16x32_bf16 v[96:99], v[40:43], v[52:55], v[96:99]
  s_nop 0
  v_xor_b32 v2, 16384, v2
  v_mfma_f32_16x16x32_bf16 v[112:115], v[24:27], v[56:59], v[112:115]
  v_xor_b32 v3, 16384, v3
  s_waitcnt lgkmcnt(4)
  v_mfma_f32_16x16x32_bf16 v[112:115], v[40:43], v[60:63], v[112:115]
  v_xor_b32 v4, 16384, v4
  v_mfma_f32_16x16x32_bf16 v[100:103], v[28:31], v[48:51], v[100:103]
  ds_read_b128 v[48:51], v6 offset:10240
  v_mfma_f32_16x16x32_bf16 v[100:103], v[44:47], v[52:55], v[100:103]
  s_nop 0
  ds_read_b128 v[52:55], v8 offset:10240
  v_mfma_f32_16x16x32_bf16 v[116:119], v[28:31], v[56:59], v[116:119]
  ds_read_b128 v[56:59], v6 offset:12288
  v_mfma_f32_16x16x32_bf16 v[116:119], v[44:47], v[60:63], v[116:119]
  ds_read_b128 v[60:63], v8 offset:12288
  v_mfma_f32_16x16x32_bf16 v[120:123], v[16:19], v[64:67], v[120:123]
  s_waitcnt lgkmcnt(6)
  v_mfma_f32_16x16x32_bf16 v[120:123], v[32:35], v[68:71], v[120:123]
  s_nop 0
  v_mfma_f32_16x16x32_bf16 v[136:139], v[16:19], v[72:75], v[136:139]
  v_mfma_f32_16x16x32_bf16 v[136:139], v[32:35], v[76:79], v[136:139]
  v_mfma_f32_16x16x32_bf16 v[124:127], v[20:23], v[64:67], v[124:127]
  v_mfma_f32_16x16x32_bf16 v[124:127], v[36:39], v[68:71], v[124:127]
  v_mfma_f32_16x16x32_bf16 v[140:143], v[20:23], v[72:75], v[140:143]
  v_mfma_f32_16x16x32_bf16 v[140:143], v[36:39], v[76:79], v[140:143]
  v_mfma_f32_16x16x32_bf16 v[128:131], v[24:27], v[64:67], v[128:131]
  v_mfma_f32_16x16x32_bf16 v[128:131], v[40:43], v[68:71], v[128:131]
  v_mfma_f32_16x16x32_bf16 v[144:147], v[24:27], v[72:75], v[144:147]
  v_mfma_f32_16x16x32_bf16 v[144:147], v[40:43], v[76:79], v[144:147]
  v_mfma_f32_16x16x32_bf16 v[132:135], v[28:31], v[64:67], v[132:135]
  ds_read_b128 v[64:67], v6 offset:14336
  v_mfma_f32_16x16x32_bf16 v[132:135], v[44:47], v[68:71], v[132:135]
  ds_read_b128 v[68:71], v8 offset:14336
  v_mfma_f32_16x16x32_bf16 v[148:151], v[28:31], v[72:75], v[148:151]
  ds_read_b128 v[72:75], v6 offset:16384
  s_waitcnt lgkmcnt(7)
  v_mfma_f32_16x16x32_bf16 v[148:151], v[44:47], v[76:79], v[148:151]
  ds_read_b128 v[76:79], v8 offset:16384
  v_mfma_f32_16x16x32_bf16 v[152:155], v[16:19], v[80:83], v[152:155]
  s_waitcnt lgkmcnt(6)
  v_mfma_f32_16x16x32_bf16 v[152:155], v[32:35], v[84:87], v[152:155]
  v_mfma_f32_16x16x32_bf16 v[168:171], v[16:19], v[48:51], v[168:171]
  v_mfma_f32_16x16x32_bf16 v[168:171], v[32:35], v[52:55], v[168:171]
  v_mfma_f32_16x16x32_bf16 v[156:159], v[20:23], v[80:83], v[156:159]
  v_mfma_f32_16x16x32_bf16 v[156:159], v[36:39], v[84:87], v[156:159]
  v_mfma_f32_16x16x32_bf16 v[172:175], v[20:23], v[48:51], v[172:175]
  v_mfma_f32_16x16x32_bf16 v[172:175], v[36:39], v[52:55], v[172:175]
  v_mfma_f32_16x16x32_bf16 v[160:163], v[24:27], v[80:83], v[160:163]
  v_mfma_f32_16x16x32_bf16 v[160:163], v[40:43], v[84:87], v[160:163]
  v_mfma_f32_16x16x32_bf16 v[176:179], v[24:27], v[48:51], v[176:179]
  v_mfma_f32_16x16x32_bf16 v[176:179], v[40:43], v[52:55], v[176:179]
  v_mfma_f32_16x16x32_bf16 v[164:167], v[28:31], v[80:83], v[164:167]
  ds_read_b128 v[80:83], v6 offset:18432
  v_mfma_f32_16x16x32_bf16 v[164:167], v[44:47], v[84:87], v[164:167]
  ds_read_b128 v[84:87], v8 offset:18432
  v_mfma_f32_16x16x32_bf16 v[180:183], v[28:31], v[48:51], v[180:183]
  s_waitcnt lgkmcnt(6)
  v_mfma_f32_16x16x32_bf16 v[180:183], v[44:47], v[52:55], v[180:183]
  v_mfma_f32_16x16x32_bf16 v[184:187], v[16:19], v[56:59], v[184:187]
  s_waitcnt lgkmcnt(4)
  v_mfma_f32_16x16x32_bf16 v[184:187], v[32:35], v[60:63], v[184:187]
  v_mfma_f32_16x16x32_bf16 v[200:203], v[16:19], v[64:67], v[200:203]
  v_mfma_f32_16x16x32_bf16 v[200:203], v[32:35], v[68:71], v[200:203]
  v_mfma_f32_16x16x32_bf16 v[188:191], v[20:23], v[56:59], v[188:191]
  v_mfma_f32_16x16x32_bf16 v[188:191], v[36:39], v[60:63], v[188:191]
  s_waitcnt lgkmcnt(0)
  s_barrier
  v_mfma_f32_16x16x32_bf16 v[204:207], v[20:23], v[64:67], v[204:207]
  ds_read_b128 v[48:51], v5 offset:0
  v_mfma_f32_16x16x32_bf16 v[204:207], v[36:39], v[68:71], v[204:207]
  ds_read_b128 v[52:55], v7 offset:0
  v_mfma_f32_16x16x32_bf16 v[192:195], v[24:27], v[56:59], v[192:195]
  v_mfma_f32_16x16x32_bf16 v[192:195], v[40:43], v[60:63], v[192:195]
  v_mfma_f32_16x16x32_bf16 v[208:211], v[24:27], v[64:67], v[208:211]
  v_mfma_f32_16x16x32_bf16 v[208:211], v[40:43], v[68:71], v[208:211]
  v_mfma_f32_16x16x32_bf16 v[196:199], v[28:31], v[56:59], v[196:199]
  ds_read_b128 v[56:59], v5 offset:2048
  v_mfma_f32_16x16x32_bf16 v[196:199], v[44:47], v[60:63], v[196:199]
  ds_read_b128 v[60:63], v7 offset:2048
  v_mfma_f32_16x16x32_bf16 v[212:215], v[28:31], v[64:67], v[212:215]
  ds_read_b128 v[64:67], v5 offset:4096
  v_mfma_f32_16x16x32_bf16 v[212:215], v[44:47], v[68:71], v[212:215]
  ds_read_b128 v[68:71], v7 offset:4096
  v_mfma_f32_16x16x32_bf16 v[216:219], v[16:19], v[72:75], v[216:219]
  v_mfma_f32_16x16x32_bf16 v[216:219], v[32:35], v[76:79], v[216:219]
  v_mfma_f32_16x16x32_bf16 v[232:235], v[16:19], v[80:83], v[232:235]
  ds_read_b64_tr_b16 v[16:17], v1 offset:0
  v_mfma_f32_16x16x32_bf16 v[232:235], v[32:35], v[84:87], v[232:235]
  ds_read_b64_tr_b16 v[18:19], v1 offset:1024
  v_mfma_f32_16x16x32_bf16 v[220:223], v[20:23], v[72:75], v[220:223]
  ds_read_b64_tr_b16 v[32:33], v1 offset:8192
  v_mfma_f32_16x16x32_bf16 v[220:223], v[36:39], v[76:79], v[220:223]
  ds_read_b64_tr_b16 v[34:35], v1 offset:9216
  v_mfma_f32_16x16x32_bf16 v[236:239], v[20:23], v[80:83], v[236:239]
  ds_read_b64_tr_b16 v[20:21], v2 offset:0
  v_mfma_f32_16x16x32_bf16 v[236:239], v[36:39], v[84:87], v[236:239]
  ds_read_b64_tr_b16 v[22:23], v2 offset:1024
  v_mfma_f32_16x16x32_bf16 v[224:227], v[24:27], v[72:75], v[224:227]
  ds_read_b64_tr_b16 v[36:37], v2 offset:8192
  v_mfma_f32_16x16x32_bf16 v[224:227], v[40:43], v[76:79], v[224:227]
  ds_read_b64_tr_b16 v[38:39], v2 offset:9216
  v_mfma_f32_16x16x32_bf16 v[240:243], v[24:27], v[80:83], v[240:243]
  ds_read_b64_tr_b16 v[24:25], v3 offset:0
  v_mfma_f32_16x16x32_bf16 v[240:243], v[40:43], v[84:87], v[240:243]
  ds_read_b64_tr_b16 v[26:27], v3 offset:1024
  v_mfma_f32_16x16x32_bf16 v[228:231], v[28:31], v[72:75], v[228:231]
  ds_read_b64_tr_b16 v[40:41], v3 offset:8192
  v_mfma_f32_16x16x32_bf16 v[228:231], v[44:47], v[76:79], v[228:231]
  ds_read_b64_tr_b16 v[42:43], v3 offset:9216
  v_mfma_f32_16x16x32_bf16 v[244:247], v[28:31], v[80:83], v[244:247]
  ds_read_b64_tr_b16 v[28:29], v4 offset:0
  s_waitcnt lgkmcnt(9)
  v_mfma_f32_16x16x32_bf16 v[244:247], v[44:47], v[84:87], v[244:247]
  ds_read_b64_tr_b16 v[30:31], v4 offset:1024
  v_mfma_f32_16x16x32_bf16 v[88:91], v[16:19], v[48:51], v[88:91]
  ds_read_b64_tr_b16 v[44:45], v4 offset:8192
  v_mfma_f32_16x16x32_bf16 v[88:91], v[32:35], v[52:55], v[88:91]
  s_nop 0
  ds_read_b64_tr_b16 v[46:47], v4 offset:9216
  v_mfma_f32_16x16x32_bf16 v[104:107], v[16:19], v[56:59], v[104:107]
  ds_read_b128 v[72:75], v5 offset:6144
  s_waitcnt lgkmcnt(9)
  v_mfma_f32_16x16x32_bf16 v[104:107], v[32:35], v[60:63], v[104:107]
  ds_read_b128 v[76:79], v7 offset:6144
  v_mfma_f32_16x16x32_bf16 v[92:95], v[20:23], v[48:51], v[92:95]
  ds_read_b128 v[80:83], v5 offset:8192
  v_mfma_f32_16x16x32_bf16 v[92:95], v[36:39], v[52:55], v[92:95]
  s_nop 0
  ds_read_b128 v[84:87], v7 offset:8192
  v_mfma_f32_16x16x32_bf16 v[108:111], v[20:23], v[56:59], v[108:111]
  s_waitcnt lgkmcnt(8)
  v_mfma_f32_16x16x32_bf16 v[108:111], v[36:39], v[60:63], v[108:111]
  v_mfma_f32_16x16x32_bf16 v[96:99], v[24:27], v[48:51], v[96:99]
  v_xor_b32 v1, 16384, v1
  v_mfma_f32_16x16x32_bf16 v[96:99], v[40:43], v[52:55], v[96:99]
  s_nop 0
  v_xor_b32 v2, 16384, v2
  v_mfma_f32_16x16x32_bf16 v[112:115], v[24:27], v[56:59], v[112:115]
  v_xor_b32 v3, 16384, v3
  s_waitcnt lgkmcnt(4)
  v_mfma_f32_16x16x32_bf16 v[112:115], v[40:43], v[60:63], v[112:115]
  v_xor_b32 v4, 16384, v4
  v_mfma_f32_16x16x32_bf16 v[100:103], v[28:31], v[48:51], v[100:103]
  ds_read_b128 v[48:51], v5 offset:10240
  v_mfma_f32_16x16x32_bf16 v[100:103], v[44:47], v[52:55], v[100:103]
  s_nop 0
  ds_read_b128 v[52:55], v7 offset:10240
  v_mfma_f32_16x16x32_bf16 v[116:119], v[28:31], v[56:59], v[116:119]
  ds_read_b128 v[56:59], v5 offset:12288
  v_mfma_f32_16x16x32_bf16 v[116:119], v[44:47], v[60:63], v[116:119]
  ds_read_b128 v[60:63], v7 offset:12288
  v_mfma_f32_16x16x32_bf16 v[120:123], v[16:19], v[64:67], v[120:123]
  s_waitcnt lgkmcnt(6)
  v_mfma_f32_16x16x32_bf16 v[120:123], v[32:35], v[68:71], v[120:123]
  s_nop 0
  v_mfma_f32_16x16x32_bf16 v[136:139], v[16:19], v[72:75], v[136:139]
  v_mfma_f32_16x16x32_bf16 v[136:139], v[32:35], v[76:79], v[136:139]
  v_mfma_f32_16x16x32_bf16 v[124:127], v[20:23], v[64:67], v[124:127]
  v_mfma_f32_16x16x32_bf16 v[124:127], v[36:39], v[68:71], v[124:127]
  v_mfma_f32_16x16x32_bf16 v[140:143], v[20:23], v[72:75], v[140:143]
  v_mfma_f32_16x16x32_bf16 v[140:143], v[36:39], v[76:79], v[140:143]
  v_mfma_f32_16x16x32_bf16 v[128:131], v[24:27], v[64:67], v[128:131]
  v_mfma_f32_16x16x32_bf16 v[128:131], v[40:43], v[68:71], v[128:131]
  v_mfma_f32_16x16x32_bf16 v[144:147], v[24:27], v[72:75], v[144:147]
  v_mfma_f32_16x16x32_bf16 v[144:147], v[40:43], v[76:79], v[144:147]
  v_mfma_f32_16x16x32_bf16 v[132:135], v[28:31], v[64:67], v[132:135]
  ds_read_b128 v[64:67], v5 offset:14336
  v_mfma_f32_16x16x32_bf16 v[132:135], v[44:47], v[68:71], v[132:135]
  ds_read_b128 v[68:71], v7 offset:14336
  v_mfma_f32_16x16x32_bf16 v[148:151], v[28:31], v[72:75], v[148:151]
  ds_read_b128 v[72:75], v5 offset:16384
  s_waitcnt lgkmcnt(7)
  v_mfma_f32_16x16x32_bf16 v[148:151], v[44:47], v[76:79], v[148:151]
  ds_read_b128 v[76:79], v7 offset:16384
  v_mfma_f32_16x16x32_bf16 v[152:155], v[16:19], v[80:83], v[152:155]
  s_waitcnt lgkmcnt(6)
  v_mfma_f32_16x16x32_bf16 v[152:155], v[32:35], v[84:87], v[152:155]
  v_mfma_f32_16x16x32_bf16 v[168:171], v[16:19], v[48:51], v[168:171]
  v_mfma_f32_16x16x32_bf16 v[168:171], v[32:35], v[52:55], v[168:171]
  v_mfma_f32_16x16x32_bf16 v[156:159], v[20:23], v[80:83], v[156:159]
  v_mfma_f32_16x16x32_bf16 v[156:159], v[36:39], v[84:87], v[156:159]
  v_mfma_f32_16x16x32_bf16 v[172:175], v[20:23], v[48:51], v[172:175]
  v_mfma_f32_16x16x32_bf16 v[172:175], v[36:39], v[52:55], v[172:175]
  v_mfma_f32_16x16x32_bf16 v[160:163], v[24:27], v[80:83], v[160:163]
  v_mfma_f32_16x16x32_bf16 v[160:163], v[40:43], v[84:87], v[160:163]
  v_mfma_f32_16x16x32_bf16 v[176:179], v[24:27], v[48:51], v[176:179]
  v_mfma_f32_16x16x32_bf16 v[176:179], v[40:43], v[52:55], v[176:179]
  v_mfma_f32_16x16x32_bf16 v[164:167], v[28:31], v[80:83], v[164:167]
  ds_read_b128 v[80:83], v5 offset:18432
  v_mfma_f32_16x16x32_bf16 v[164:167], v[44:47], v[84:87], v[164:167]
  ds_read_b128 v[84:87], v7 offset:18432
  v_mfma_f32_16x16x32_bf16 v[180:183], v[28:31], v[48:51], v[180:183]
  s_waitcnt lgkmcnt(6)
  v_mfma_f32_16x16x32_bf16 v[180:183], v[44:47], v[52:55], v[180:183]
  v_mfma_f32_16x16x32_bf16 v[184:187], v[16:19], v[56:59], v[184:187]
  s_waitcnt lgkmcnt(4)
  s_add_u32 s72, s72, 1
  s_cmp_lt_u32 s72, 8
  v_mfma_f32_16x16x32_bf16 v[184:187], v[32:35], v[60:63], v[184:187]
  v_mfma_f32_16x16x32_bf16 v[200:203], v[16:19], v[64:67], v[200:203]
  v_mfma_f32_16x16x32_bf16 v[200:203], v[32:35], v[68:71], v[200:203]
  v_mfma_f32_16x16x32_bf16 v[188:191], v[20:23], v[56:59], v[188:191]
  v_mfma_f32_16x16x32_bf16 v[188:191], v[36:39], v[60:63], v[188:191]
  s_waitcnt lgkmcnt(0)
  s_barrier
  v_mfma_f32_16x16x32_bf16 v[204:207], v[20:23], v[64:67], v[204:207]
  ds_read_b128 v[48:51], v5 offset:40960
  v_mfma_f32_16x16x32_bf16 v[204:207], v[36:39], v[68:71], v[204:207]
  ds_read_b128 v[52:55], v7 offset:40960
  v_mfma_f32_16x16x32_bf16 v[192:195], v[24:27], v[56:59], v[192:195]
  v_mfma_f32_16x16x32_bf16 v[192:195], v[40:43], v[60:63], v[192:195]
  v_mfma_f32_16x16x32_bf16 v[208:211], v[24:27], v[64:67], v[208:211]
  v_mfma_f32_16x16x32_bf16 v[208:211], v[40:43], v[68:71], v[208:211]
  v_mfma_f32_16x16x32_bf16 v[196:199], v[28:31], v[56:59], v[196:199]
  ds_read_b128 v[56:59], v5 offset:43008
  v_mfma_f32_16x16x32_bf16 v[196:199], v[44:47], v[60:63], v[196:199]
  ds_read_b128 v[60:63], v7 offset:43008
  v_mfma_f32_16x16x32_bf16 v[212:215], v[28:31], v[64:67], v[212:215]
  ds_read_b128 v[64:67], v5 offset:45056
  v_mfma_f32_16x16x32_bf16 v[212:215], v[44:47], v[68:71], v[212:215]
  ds_read_b128 v[68:71], v7 offset:45056
  v_mfma_f32_16x16x32_bf16 v[216:219], v[16:19], v[72:75], v[216:219]
  v_mfma_f32_16x16x32_bf16 v[216:219], v[32:35], v[76:79], v[216:219]
  v_mfma_f32_16x16x32_bf16 v[232:235], v[16:19], v[80:83], v[232:235]
  ds_read_b64_tr_b16 v[16:17], v1 offset:0
  v_mfma_f32_16x16x32_bf16 v[232:235], v[32:35], v[84:87], v[232:235]
  ds_read_b64_tr_b16 v[18:19], v1 offset:1024
  v_mfma_f32_16x16x32_bf16 v[220:223], v[20:23], v[72:75], v[220:223]
  ds_read_b64_tr_b16 v[32:33], v1 offset:8192
  v_mfma_f32_16x16x32_bf16 v[220:223], v[36:39], v[76:79], v[220:223]
  ds_read_b64_tr_b16 v[34:35], v1 offset:9216
  v_mfma_f32_16x16x32_bf16 v[236:239], v[20:23], v[80:83], v[236:239]
  ds_read_b64_tr_b16 v[20:21], v2 offset:0
  v_mfma_f32_16x16x32_bf16 v[236:239], v[36:39], v[84:87], v[236:239]
  ds_read_b64_tr_b16 v[22:23], v2 offset:1024
  v_mfma_f32_16x16x32_bf16 v[224:227], v[24:27], v[72:75], v[224:227]
  ds_read_b64_tr_b16 v[36:37], v2 offset:8192
  v_mfma_f32_16x16x32_bf16 v[224:227], v[40:43], v[76:79], v[224:227]
  ds_read_b64_tr_b16 v[38:39], v2 offset:9216
  v_mfma_f32_16x16x32_bf16 v[240:243], v[24:27], v[80:83], v[240:243]
  ds_read_b64_tr_b16 v[24:25], v3 offset:0
  v_mfma_f32_16x16x32_bf16 v[240:243], v[40:43], v[84:87], v[240:243]
  ds_read_b64_tr_b16 v[26:27], v3 offset:1024
  v_mfma_f32_16x16x32_bf16 v[228:231], v[28:31], v[72:75], v[228:231]
  ds_read_b64_tr_b16 v[40:41], v3 offset:8192
  v_mfma_f32_16x16x32_bf16 v[228:231], v[44:47], v[76:79], v[228:231]
  ds_read_b64_tr_b16 v[42:43], v3 offset:9216
  v_mfma_f32_16x16x32_bf16 v[244:247], v[28:31], v[80:83], v[244:247]
  ds_read_b64_tr_b16 v[28:29], v4 offset:0
  s_waitcnt lgkmcnt(9)
  v_mfma_f32_16x16x32_bf16 v[244:247], v[44:47], v[84:87], v[244:247]
  ds_read_b64_tr_b16 v[30:31], v4 offset:1024
  s_cbranch_scc1 L_dnn_loop0
L_tail:
  v_mfma_f32_16x16x32_bf16 v[88:91], v[16:19], v[48:51], v[88:91]
  ds_read_b64_tr_b16 v[44:45], v4 offset:8192
  v_mfma_f32_16x16x32_bf16 v[88:91], v[32:35], v[52:55], v[88:91]
  ds_read_b64_tr_b16 v[46:47], v4 offset:9216
  v_mfma_f32_16x16x32_bf16 v[104:107], v[16:19], v[56:59], v[104:107]
  ds_read_b128 v[72:75], v5 offset:47104
  s_waitcnt lgkmcnt(9)
  v_mfma_f32_16x16x32_bf16 v[104:107], v[32:35], v[60:63], v[104:107]
  ds_read_b128 v[76:79], v7 offset:47104
  v_mfma_f32_16x16x32_bf16 v[92:95], v[20:23], v[48:51], v[92:95]
  s_nop 0
  ds_read_b128 v[80:83], v5 offset:49152
  v_mfma_f32_16x16x32_bf16 v[92:95], v[36:39], v[52:55], v[92:95]
  ds_read_b128 v[84:87], v7 offset:49152
  v_mul_f32 v11, v88, v88
  v_mfma_f32_16x16x32_bf16 v[108:111], v[20:23], v[56:59], v[108:111]
  s_waitcnt lgkmcnt(8)
  v_mul_f32 v248, v89, v89
  v_mul_f32 v249, v90, v90
  v_mfma_f32_16x16x32_bf16 v[108:111], v[36:39], v[60:63], v[108:111]
  v_mul_f32_e64 v250, v91, v91
  v_fma_f32 v11, v11, v14, v12
  v_mfma_f32_16x16x32_bf16 v[96:99], v[24:27], v[48:51], v[96:99]
  v_fma_f32 v248, v248, v14, v12
  v_fma_f32 v249, v249, v14, v12
  v_mfma_f32_16x16x32_bf16 v[96:99], v[40:43], v[52:55], v[96:99]
  v_fma_f32 v250, v250, v14, v12
  v_mul_f32 v11, v11, v88
  v_mfma_f32_16x16x32_bf16 v[112:115], v[24:27], v[56:59], v[112:115]
  s_waitcnt lgkmcnt(4)
  v_mul_f32 v248, v248, v89
  v_mul_f32 v249, v249, v90
  v_mfma_f32_16x16x32_bf16 v[112:115], v[40:43], v[60:63], v[112:115]
  v_mul_f32_e64 v250, v250, v91
  v_mfma_f32_16x16x32_bf16 v[100:103], v[28:31], v[48:51], v[100:103]
  ds_read_b128 v[48:51], v5 offset:51200
  v_mfma_f32_16x16x32_bf16 v[100:103], v[44:47], v[52:55], v[100:103]
  ds_read_b128 v[52:55], v7 offset:51200
  v_mfma_f32_16x16x32_bf16 v[116:119], v[28:31], v[56:59], v[116:119]
  ds_read_b128 v[56:59], v5 offset:53248
  v_mfma_f32_16x16x32_bf16 v[116:119], v[44:47], v[60:63], v[116:119]
  ds_read_b128 v[60:63], v7 offset:53248
  v_mfma_f32_16x16x32_bf16 v[120:123], v[16:19], v[64:67], v[120:123]
  s_waitcnt lgkmcnt(6)
  v_exp_f32 v11, v11
  v_mfma_f32_16x16x32_bf16 v[120:123], v[32:35], v[68:71], v[120:123]
  v_exp_f32 v248, v248
  v_mfma_f32_16x16x32_bf16 v[136:139], v[16:19], v[72:75], v[136:139]
  v_exp_f32 v249, v249
  v_mfma_f32_16x16x32_bf16 v[136:139], v[32:35], v[76:79], v[136:139]
  v_exp_f32 v250, v250
  v_mfma_f32_16x16x32_bf16 v[124:127], v[20:23], v[64:67], v[124:127]
  v_add_f32 v11, 1.0, v11
  v_add_f32 v248, 1.0, v248
  v_mfma_f32_16x16x32_bf16 v[124:127], v[36:39], v[68:71], v[124:127]
  v_add_f32 v249, 1.0, v249
  v_add_f32 v250, 1.0, v250
  v_mfma_f32_16x16x32_bf16 v[140:143], v[20:23], v[72:75], v[140:143]
  v_rcp_f32 v11, v11
  v_mfma_f32_16x16x32_bf16 v[140:143], v[36:39], v[76:79], v[140:143]
  v_rcp_f32_e64 v248, v248
  v_mfma_f32_16x16x32_bf16 v[128:131], v[24:27], v[64:67], v[128:131]
  v_rcp_f32 v249, v249
  v_mfma_f32_16x16x32_bf16 v[128:131], v[40:43], v[68:71], v[128:131]
  v_rcp_f32 v250, v250
  v_mfma_f32_16x16x32_bf16 v[144:147], v[24:27], v[72:75], v[144:147]
  v_mul_f32 v88, v88, v11
  v_mul_f32 v89, v89, v248
  v_mfma_f32_16x16x32_bf16 v[144:147], v[40:43], v[76:79], v[144:147]
  v_mul_f32 v90, v90, v249
  v_mul_f32 v91, v91, v250
  v_mfma_f32_16x16x32_bf16 v[132:135], v[28:31], v[64:67], v[132:135]
  ds_read_b128 v[64:67], v5 offset:55296
  v_mul_f32 v11, v92, v92
  v_mfma_f32_16x16x32_bf16 v[132:135], v[44:47], v[68:71], v[132:135]
  ds_read_b128 v[68:71], v7 offset:55296
  v_mul_f32 v248, v93, v93
  v_mfma_f32_16x16x32_bf16 v[148:151], v[28:31], v[72:75], v[148:151]
  ds_read_b128 v[72:75], v5 offset:57344
  s_waitcnt lgkmcnt(7)
  v_mul_f32 v249, v94, v94
  v_mfma_f32_16x16x32_bf16 v[148:151], v[44:47], v[76:79], v[148:151]
  ds_read_b128 v[76:79], v7 offset:57344
  v_mul_f32 v250, v95, v95
  v_mfma_f32_16x16x32_bf16 v[152:155], v[16:19], v[80:83], v[152:155]
  s_waitcnt lgkmcnt(6)
  v_fma_f32 v11, v11, v14, v12
  v_fma_f32 v248, v248, v14, v12
  v_mfma_f32_16x16x32_bf16 v[152:155], v[32:35], v[84:87], v[152:155]
  v_fma_f32 v249, v249, v14, v12
  v_fma_f32 v250, v250, v14, v12
  v_mfma_f32_16x16x32_bf16 v[168:171], v[16:19], v[48:51], v[168:171]
  v_mul_f32 v11, v11, v92
  v_mul_f32 v248, v248, v93
  v_mfma_f32_16x16x32_bf16 v[168:171], v[32:35], v[52:55], v[168:171]
  v_mul_f32 v249, v249, v94
  v_mul_f32 v250, v250, v95
  v_mfma_f32_16x16x32_bf16 v[156:159], v[20:23], v[80:83], v[156:159]
  v_exp_f32 v11, v11
  v_mfma_f32_16x16x32_bf16 v[156:159], v[36:39], v[84:87], v[156:159]
  v_exp_f32 v248, v248
  v_mfma_f32_16x16x32_bf16 v[172:175], v[20:23], v[48:51], v[172:175]
  v_exp_f32 v249, v249
  v_mfma_f32_16x16x32_bf16 v[172:175], v[36:39], v[52:55], v[172:175]
  v_exp_f32 v250, v250
  v_mfma_f32_16x16x32_bf16 v[160:163], v[24:27], v[80:83], v[160:163]
  v_add_f32 v11, 1.0, v11
  v_add_f32 v248, 1.0, v248
  v_mfma_f32_16x16x32_bf16 v[160:163], v[40:43], v[84:87], v[160:163]
  v_add_f32 v249, 1.0, v249
  v_add_f32 v250, 1.0, v250
  v_mfma_f32_16x16x32_bf16 v[176:179], v[24:27], v[48:51], v[176:179]
  v_rcp_f32_e64 v11, v11
  v_mfma_f32_16x16x32_bf16 v[176:179], v[40:43], v[52:55], v[176:179]
  v_rcp_f32 v248, v248
  v_mfma_f32_16x16x32_bf16 v[164:167], v[28:31], v[80:83], v[164:167]
  ds_read_b128 v[80:83], v5 offset:59392
  v_mfma_f32_16x16x32_bf16 v[164:167], v[44:47], v[84:87], v[164:167]
  ds_read_b128 v[84:87], v7 offset:59392
  v_mfma_f32_16x16x32_bf16 v[180:183], v[28:31], v[48:51], v[180:183]
  s_waitcnt lgkmcnt(6)
  v_rcp_f32_e64 v249, v249
  v_mfma_f32_16x16x32_bf16 v[180:183], v[44:47], v[52:55], v[180:183]
  v_rcp_f32 v250, v250
  v_mfma_f32_16x16x32_bf16 v[184:187], v[16:19], v[56:59], v[184:187]
  s_waitcnt lgkmcnt(4)
  v_mul_f32 v92, v92, v11
  v_mul_f32 v93, v93, v248
  v_mfma_f32_16x16x32_bf16 v[184:187], v[32:35], v[60:63], v[184:187]
  v_mul_f32 v94, v94, v249
  v_mul_f32 v95, v95, v250
  v_mfma_f32_16x16x32_bf16 v[200:203], v[16:19], v[64:67], v[200:203]
  v_mul_f32 v11, v96, v96
  v_mul_f32 v248, v97, v97
  v_mfma_f32_16x16x32_bf16 v[200:203], v[32:35], v[68:71], v[200:203]
  v_mul_f32 v249, v98, v98
  v_mul_f32 v250, v99, v99
  v_mfma_f32_16x16x32_bf16 v[188:191], v[20:23], v[56:59], v[188:191]
  v_fma_f32 v11, v11, v14, v12
  v_fma_f32 v248, v248, v14, v12
  v_mfma_f32_16x16x32_bf16 v[188:191], v[36:39], v[60:63], v[188:191]
  v_fma_f32 v249, v249, v14, v12
  v_fma_f32 v250, v250, v14, v12
  v_mfma_f32_16x16x32_bf16 v[204:207], v[20:23], v[64:67], v[204:207]
  v_mul_f32 v11, v11, v96
  v_mul_f32 v248, v248, v97
  v_mfma_f32_16x16x32_bf16 v[204:207], v[36:39], v[68:71], v[204:207]
  v_mul_f32 v249, v249, v98
  v_mul_f32 v250, v250, v99
  v_mfma_f32_16x16x32_bf16 v[192:195], v[24:27], v[56:59], v[192:195]
  v_exp_f32 v11, v11
  v_mfma_f32_16x16x32_bf16 v[192:195], v[40:43], v[60:63], v[192:195]
  v_exp_f32 v248, v248
  v_mfma_f32_16x16x32_bf16 v[208:211], v[24:27], v[64:67], v[208:211]
  v_exp_f32 v249, v249
  v_mfma_f32_16x16x32_bf16 v[208:211], v[40:43], v[68:71], v[208:211]
  v_exp_f32 v250, v250
  v_mfma_f32_16x16x32_bf16 v[196:199], v[28:31], v[56:59], v[196:199]
  v_add_f32 v11, 1.0, v11
  v_add_f32 v248, 1.0, v248
  v_mfma_f32_16x16x32_bf16 v[196:199], v[44:47], v[60:63], v[196:199]
  v_add_f32 v249, 1.0, v249
  v_add_f32 v250, 1.0, v250
  v_mfma_f32_16x16x32_bf16 v[212:215], v[28:31], v[64:67], v[212:215]
  s_waitcnt lgkmcnt(2)
  v_rcp_f32 v11, v11
  v_mfma_f32_16x16x32_bf16 v[212:215], v[44:47], v[68:71], v[212:215]
  v_rcp_f32 v248, v248
  v_mfma_f32_16x16x32_bf16 v[216:219], v[16:19], v[72:75], v[216:219]
  s_waitcnt lgkmcnt(0)
  v_rcp_f32 v249, v249
  v_mfma_f32_16x16x32_bf16 v[216:219], v[32:35], v[76:79], v[216:219]
  v_rcp_f32 v250, v250
  v_mfma_f32_16x16x32_bf16 v[232:235], v[16:19], v[80:83], v[232:235]
  v_mul_f32 v96, v96, v11
  v_mul_f32 v97, v97, v248
  v_mfma_f32_16x16x32_bf16 v[232:235], v[32:35], v[84:87], v[232:235]
  v_mul_f32 v98, v98, v249
  v_mul_f32 v99, v99, v250
  v_mfma_f32_16x16x32_bf16 v[220:223], v[20:23], v[72:75], v[220:223]
  v_mul_f32 v11, v100, v100
  v_mul_f32 v248, v101, v101
  v_mfma_f32_16x16x32_bf16 v[220:223], v[36:39], v[76:79], v[220:223]
  v_mul_f32 v249, v102, v102
  v_mul_f32 v250, v103, v103
  v_mfma_f32_16x16x32_bf16 v[236:239], v[20:23], v[80:83], v[236:239]
  v_fma_f32 v11, v11, v14, v12
  v_fma_f32 v248, v248, v14, v12
  v_mfma_f32_16x16x32_bf16 v[236:239], v[36:39], v[84:87], v[236:239]
  v_fma_f32 v249, v249, v14, v12
  v_fma_f32 v250, v250, v14, v12
  v_mfma_f32_16x16x32_bf16 v[224:227], v[24:27], v[72:75], v[224:227]
  v_mul_f32 v11, v11, v100
  v_mul_f32 v248, v248, v101
  v_mfma_f32_16x16x32_bf16 v[224:227], v[40:43], v[76:79], v[224:227]
  v_mul_f32 v249, v249, v102
  v_mul_f32 v250, v250, v103
  v_mfma_f32_16x16x32_bf16 v[240:243], v[24:27], v[80:83], v[240:243]
  v_exp_f32 v11, v11
  v_mfma_f32_16x16x32_bf16 v[240:243], v[40:43], v[84:87], v[240:243]
  v_exp_f32 v248, v248
  v_mfma_f32_16x16x32_bf16 v[228:231], v[28:31], v[72:75], v[228:231]
  v_exp_f32 v249, v249
  v_mfma_f32_16x16x32_bf16 v[228:231], v[44:47], v[76:79], v[228:231]
  v_exp_f32 v250, v250
  v_mfma_f32_16x16x32_bf16 v[244:247], v[28:31], v[80:83], v[244:247]
  v_add_f32 v11, 1.0, v11
  v_add_f32 v248, 1.0, v248
  v_mfma_f32_16x16x32_bf16 v[244:247], v[44:47], v[84:87], v[244:247]
  v_add_f32 v249, 1.0, v249
  v_add_f32 v250, 1.0, v250
  v_rcp_f32 v11, v11
  v_rcp_f32 v248, v248
  v_rcp_f32 v249, v249
  v_rcp_f32 v250, v250
  v_mul_f32 v100, v100, v11
  v_mul_f32 v101, v101, v248
  v_mul_f32 v102, v102, v249
  v_mul_f32 v103, v103, v250
  ds_read_b64 v[18:19], v9 offset:256
  ds_read_b64 v[22:23], v9 offset:288
  ds_read_b64 v[26:27], v9 offset:320
  ds_read_b64 v[30:31], v9 offset:352
  v_mov_b32 v248, 1.0
  v_mov_b32 v249, 1.0
L_epi:
  v_pk_mul_f32 v[52:53], v[104:105], v[104:105]
  v_pk_mul_f32 v[56:57], v[106:107], v[106:107]
  v_pk_mul_f32 v[60:61], v[108:109], v[108:109]
  v_pk_mul_f32 v[64:65], v[110:111], v[110:111]
  v_pk_fma_f32 v[52:53], v[52:53], v[14:15], v[12:13]
  v_pk_fma_f32 v[56:57], v[56:57], v[14:15], v[12:13]
  v_pk_fma_f32 v[60:61], v[60:61], v[14:15], v[12:13]
  v_pk_fma_f32 v[64:65], v[64:65], v[14:15], v[12:13]
  v_pk_mul_f32 v[52:53], v[52:53], v[104:105]
  v_pk_mul_f32 v[56:57], v[56:57], v[106:107]
  v_pk_mul_f32 v[60:61], v[60:61], v[108:109]
  v_pk_mul_f32 v[64:65], v[64:65], v[110:111]
  v_exp_f32 v52, v52
  v_exp_f32 v53, v53
  v_exp_f32 v56, v56
  v_exp_f32 v57, v57
  v_exp_f32 v60, v60
  v_exp_f32 v61, v61
  v_exp_f32 v64, v64
  v_exp_f32 v65, v65
  s_waitcnt lgkmcnt(3)
  v_lshlrev_b32 v16, 16, v18
  v_and_b32 v17, 0xffff0000, v18
  v_lshlrev_b32 v18, 16, v19
  v_and_b32 v19, 0xffff0000, v19
  s_waitcnt lgkmcnt(2)
  v_lshlrev_b32 v20, 16, v22
  v_and_b32 v21, 0xffff0000, v22
  v_lshlrev_b32 v22, 16, v23
  v_and_b32 v23, 0xffff0000, v23
  s_waitcnt lgkmcnt(1)
  v_lshlrev_b32 v24, 16, v26
  v_and_b32 v25, 0xffff0000, v26
  v_lshlrev_b32 v26, 16, v27
  v_and_b32 v27, 0xffff0000, v27
  s_waitcnt lgkmcnt(0)
  v_lshlrev_b32 v28, 16, v30
  v_and_b32 v29, 0xffff0000, v30
  v_lshlrev_b32 v30, 16, v31
  v_and_b32 v31, 0xffff0000, v31
  v_pk_mul_f32 v[54:55], v[104:105], v[16:17]
  v_pk_mul_f32 v[58:59], v[106:107], v[18:19]
  v_pk_mul_f32 v[62:63], v[108:109], v[20:21]
  v_pk_mul_f32 v[66:67], v[110:111], v[22:23]
  v_pk_add_f32 v[52:53], v[52:53], v[248:249]
  v_pk_add_f32 v[56:57], v[56:57], v[248:249]
  v_pk_add_f32 v[60:61], v[60:61], v[248:249]
  v_pk_add_f32 v[64:65], v[64:65], v[248:249]
  v_rcp_f32 v52, v52
  v_rcp_f32 v53, v53
  v_rcp_f32 v56, v56
  v_rcp_f32 v57, v57
  v_rcp_f32 v60, v60
  v_rcp_f32 v61, v61
  v_rcp_f32 v64, v64
  v_rcp_f32 v65, v65
  v_pk_mul_f32 v[34:35], v[52:53], v[54:55]
  v_pk_fma_f32 v[34:35], v[56:57], v[58:59], v[34:35]
  v_pk_fma_f32 v[34:35], v[60:61], v[62:63], v[34:35]
  v_pk_fma_f32 v[34:35], v[64:65], v[66:67], v[34:35]
  v_pk_mul_f32 v[68:69], v[112:113], v[112:113]
  v_pk_mul_f32 v[72:73], v[114:115], v[114:115]
  v_pk_mul_f32 v[76:77], v[116:117], v[116:117]
  v_pk_mul_f32 v[80:81], v[118:119], v[118:119]
  v_pk_fma_f32 v[68:69], v[68:69], v[14:15], v[12:13]
  v_pk_fma_f32 v[72:73], v[72:73], v[14:15], v[12:13]
  v_pk_fma_f32 v[76:77], v[76:77], v[14:15], v[12:13]
  v_pk_fma_f32 v[80:81], v[80:81], v[14:15], v[12:13]
  v_pk_mul_f32 v[68:69], v[68:69], v[112:113]
  v_pk_mul_f32 v[72:73], v[72:73], v[114:115]
  v_pk_mul_f32 v[76:77], v[76:77], v[116:117]
  v_pk_mul_f32 v[80:81], v[80:81], v[118:119]
  v_exp_f32 v68, v68
  v_exp_f32 v69, v69
  v_exp_f32 v72, v72
  v_exp_f32 v73, v73
  v_exp_f32 v76, v76
  v_exp_f32 v77, v77
  v_exp_f32 v80, v80
  v_exp_f32 v81, v81
  v_pk_mul_f32 v[70:71], v[112:113], v[24:25]
  v_pk_mul_f32 v[74:75], v[114:115], v[26:27]
  v_pk_mul_f32 v[78:79], v[116:117], v[28:29]
  v_pk_mul_f32 v[82:83], v[118:119], v[30:31]
  v_pk_add_f32 v[68:69], v[68:69], v[248:249]
  v_pk_add_f32 v[72:73], v[72:73], v[248:249]
  v_pk_add_f32 v[76:77], v[76:77], v[248:249]
  v_pk_add_f32 v[80:81], v[80:81], v[248:249]
  v_rcp_f32 v68, v68
  v_rcp_f32 v69, v69
  v_rcp_f32 v72, v72
  v_rcp_f32 v73, v73
  v_rcp_f32 v76, v76
  v_rcp_f32 v77, v77
  v_rcp_f32 v80, v80
  v_rcp_f32 v81, v81
  v_pk_fma_f32 v[34:35], v[68:69], v[70:71], v[34:35]
  v_pk_fma_f32 v[34:35], v[72:73], v[74:75], v[34:35]
  v_pk_fma_f32 v[34:35], v[76:77], v[78:79], v[34:35]
  v_pk_fma_f32 v[34:35], v[80:81], v[82:83], v[34:35]
  v_pk_mul_f32 v[52:53], v[120:121], v[120:121]
  v_pk_mul_f32 v[56:57], v[136:137], v[136:137]
  v_pk_mul_f32 v[60:61], v[122:123], v[122:123]
  v_pk_mul_f32 v[64:65], v[138:139], v[138:139]
  v_pk_fma_f32 v[52:53], v[52:53], v[14:15], v[12:13]
  v_pk_fma_f32 v[56:57], v[56:57], v[14:15], v[12:13]
  v_pk_fma_f32 v[60:61], v[60:61], v[14:15], v[12:13]
  v_pk_fma_f32 v[64:65], v[64:65], v[14:15], v[12:13]
  v_pk_mul_f32 v[52:53], v[52:53], v[120:121]
  v_pk_mul_f32 v[56:57], v[56:57], v[136:137]
  v_pk_mul_f32 v[60:61], v[60:61], v[122:123]
  v_pk_mul_f32 v[64:65], v[64:65], v[138:139]
  v_exp_f32 v52, v52
  v_exp_f32 v53, v53
  v_exp_f32 v56, v56
  v_exp_f32 v57, v57
  v_exp_f32 v60, v60
  v_exp_f32 v61, v61
  v_exp_f32 v64, v64
  v_exp_f32 v65, v65
  v_pk_mul_f32 v[54:55], v[120:121], v[16:17]
  v_pk_mul_f32 v[58:59], v[136:137], v[16:17]
  v_pk_mul_f32 v[62:63], v[122:123], v[18:19]
  v_pk_mul_f32 v[66:67], v[138:139], v[18:19]
  v_pk_add_f32 v[52:53], v[52:53], v[248:249]
  v_pk_add_f32 v[56:57], v[56:57], v[248:249]
  v_pk_add_f32 v[60:61], v[60:61], v[248:249]
  v_pk_add_f32 v[64:65], v[64:65], v[248:249]
  v_rcp_f32 v52, v52
  v_rcp_f32 v53, v53
  v_rcp_f32 v56, v56
  v_rcp_f32 v57, v57
  v_rcp_f32 v60, v60
  v_rcp_f32 v61, v61
  v_rcp_f32 v64, v64
  v_rcp_f32 v65, v65
  v_pk_mul_f32 v[36:37], v[52:53], v[54:55]
  v_pk_mul_f32 v[38:39], v[56:57], v[58:59]
  v_pk_fma_f32 v[36:37], v[60:61], v[62:63], v[36:37]
  v_pk_fma_f32 v[38:39], v[64:65], v[66:67], v[38:39]
  v_pk_mul_f32 v[68:69], v[124:125], v[124:125]
  v_pk_mul_f32 v[72:73], v[140:141], v[140:141]
  v_pk_mul_f32 v[76:77], v[126:127], v[126:127]
  v_pk_mul_f32 v[80:81], v[142:143], v[142:143]
  v_pk_fma_f32 v[68:69], v[68:69], v[14:15], v[12:13]
  v_pk_fma_f32 v[72:73], v[72:73], v[14:15], v[12:13]
  v_pk_fma_f32 v[76:77], v[76:77], v[14:15], v[12:13]
  v_pk_fma_f32 v[80:81], v[80:81], v[14:15], v[12:13]
  v_pk_mul_f32 v[68:69], v[68:69], v[124:125]
  v_pk_mul_f32 v[72:73], v[72:73], v[140:141]
  v_pk_mul_f32 v[76:77], v[76:77], v[126:127]
  v_pk_mul_f32 v[80:81], v[80:81], v[142:143]
  v_exp_f32 v68, v68
  v_exp_f32 v69, v69
  v_exp_f32 v72, v72
  v_exp_f32 v73, v73
  v_exp_f32 v76, v76
  v_exp_f32 v77, v77
  v_exp_f32 v80, v80
  v_exp_f32 v81, v81
  v_pk_mul_f32 v[70:71], v[124:125], v[20:21]
  v_pk_mul_f32 v[74:75], v[140:141], v[20:21]
  v_pk_mul_f32 v[78:79], v[126:127], v[22:23]
  v_pk_mul_f32 v[82:83], v[142:143], v[22:23]
  v_pk_add_f32 v[68:69], v[68:69], v[248:249]
  v_pk_add_f32 v[72:73], v[72:73], v[248:249]
  v_pk_add_f32 v[76:77], v[76:77], v[248:249]
  v_pk_add_f32 v[80:81], v[80:81], v[248:249]
  v_rcp_f32 v68, v68
  v_rcp_f32 v69, v69
  v_rcp_f32 v72, v72
  v_rcp_f32 v73, v73
  v_rcp_f32 v76, v76
  v_rcp_f32 v77, v77
  v_rcp_f32 v80, v80
  v_rcp_f32 v81, v81
  v_pk_fma_f32 v[36:37], v[68:69], v[70:71], v[36:37]
  v_pk_fma_f32 v[38:39], v[72:73], v[74:75], v[38:39]
  v_pk_fma_f32 v[36:37], v[76:77], v[78:79], v[36:37]
  v_pk_fma_f32 v[38:39], v[80:81], v[82:83], v[38:39]
  v_pk_mul_f32 v[52:53], v[128:129], v[128:129]
  v_pk_mul_f32 v[56:57], v[144:145], v[144:145]
  v_pk_mul_f32 v[60:61], v[130:131], v[130:131]
  v_pk_mul_f32 v[64:65], v[146:147], v[146:147]
  v_pk_fma_f32 v[52:53], v[52:53], v[14:15], v[12:13]
  v_pk_fma_f32 v[56:57], v[56:57], v[14:15], v[12:13]
  v_pk_fma_f32 v[60:61], v[60:61], v[14:15], v[12:13]
  v_pk_fma_f32 v[64:65], v[64:65], v[14:15], v[12:13]
  v_pk_mul_f32 v[52:53], v[52:53], v[128:129]
  v_pk_mul_f32 v[56:57], v[56:57], v[144:145]
  v_pk_mul_f32 v[60:61], v[60:61], v[130:131]
  v_pk_mul_f32 v[64:65], v[64:65], v[146:147]
  v_exp_f32 v52, v52
  v_exp_f32 v53, v53
  v_exp_f32 v56, v56
  v_exp_f32 v57, v57
  v_exp_f32 v60, v60
  v_exp_f32 v61, v61
  v_exp_f32 v64, v64
  v_exp_f32 v65, v65
  v_pk_mul_f32 v[54:55], v[128:129], v[24:25]
  v_pk_mul_f32 v[58:59], v[144:145], v[24:25]
  v_pk_mul_f32 v[62:63], v[130:131], v[26:27]
  v_pk_mul_f32 v[66:67], v[146:147], v[26:27]
  v_pk_add_f32 v[52:53], v[52:53], v[248:249]
  v_pk_add_f32 v[56:57], v[56:57], v[248:249]
  v_pk_add_f32 v[60:61], v[60:61], v[248:249]
  v_pk_add_f32 v[64:65], v[64:65], v[248:249]
  v_rcp_f32 v52, v52
  v_rcp_f32 v53, v53
  v_rcp_f32 v56, v56
  v_rcp_f32 v57, v57
  v_rcp_f32 v60, v60
  v_rcp_f32 v61, v61
  v_rcp_f32 v64, v64
  v_rcp_f32 v65, v65
  v_pk_fma_f32 v[36:37], v[52:53], v[54:55], v[36:37]
  v_pk_fma_f32 v[38:39], v[56:57], v[58:59], v[38:39]
  v_pk_fma_f32 v[36:37], v[60:61], v[62:63], v[36:37]
  v_pk_fma_f32 v[38:39], v[64:65], v[66:67], v[38:39]
  v_pk_mul_f32 v[68:69], v[132:133], v[132:133]
  v_pk_mul_f32 v[72:73], v[148:149], v[148:149]
  v_pk_mul_f32 v[76:77], v[134:135], v[134:135]
  v_pk_mul_f32 v[80:81], v[150:151], v[150:151]
  v_pk_fma_f32 v[68:69], v[68:69], v[14:15], v[12:13]
  v_pk_fma_f32 v[72:73], v[72:73], v[14:15], v[12:13]
  v_pk_fma_f32 v[76:77], v[76:77], v[14:15], v[12:13]
  v_pk_fma_f32 v[80:81], v[80:81], v[14:15], v[12:13]
  v_pk_mul_f32 v[68:69], v[68:69], v[132:133]
  v_pk_mul_f32 v[72:73], v[72:73], v[148:149]
  v_pk_mul_f32 v[76:77], v[76:77], v[134:135]
  v_pk_mul_f32 v[80:81], v[80:81], v[150:151]
  v_exp_f32 v68, v68
  v_exp_f32 v69, v69
  v_exp_f32 v72, v72
  v_exp_f32 v73, v73
  v_exp_f32 v76, v76
  v_exp_f32 v77, v77
  v_exp_f32 v80, v80
  v_exp_f32 v81, v81
  v_pk_mul_f32 v[70:71], v[132:133], v[28:29]
  v_pk_mul_f32 v[74:75], v[148:149], v[28:29]
  v_pk_mul_f32 v[78:79], v[134:135], v[30:31]
  v_pk_mul_f32 v[82:83], v[150:151], v[30:31]
  v_pk_add_f32 v[68:69], v[68:69], v[248:249]
  v_pk_add_f32 v[72:73], v[72:73], v[248:249]
  v_pk_add_f32 v[76:77], v[76:77], v[248:249]
  v_pk_add_f32 v[80:81], v[80:81], v[248:249]
  v_rcp_f32 v68, v68
  v_rcp_f32 v69, v69
  v_rcp_f32 v72, v72
  v_rcp_f32 v73, v73
  v_rcp_f32 v76, v76
  v_rcp_f32 v77, v77
  v_rcp_f32 v80, v80
  v_rcp_f32 v81, v81
  v_pk_fma_f32 v[36:37], v[68:69], v[70:71], v[36:37]
  v_pk_fma_f32 v[38:39], v[72:73], v[74:75], v[38:39]
  v_pk_fma_f32 v[36:37], v[76:77], v[78:79], v[36:37]
  v_pk_fma_f32 v[38:39], v[80:81], v[82:83], v[38:39]
  v_pk_mul_f32 v[52:53], v[152:153], v[152:153]
  v_pk_mul_f32 v[56:57], v[168:169], v[168:169]
  v_pk_mul_f32 v[60:61], v[154:155], v[154:155]
  v_pk_mul_f32 v[64:65], v[170:171], v[170:171]
  v_pk_fma_f32 v[52:53], v[52:53], v[14:15], v[12:13]
  v_pk_fma_f32 v[56:57], v[56:57], v[14:15], v[12:13]
  v_pk_fma_f32 v[60:61], v[60:61], v[14:15], v[12:13]
  v_pk_fma_f32 v[64:65], v[64:65], v[14:15], v[12:13]
  v_pk_mul_f32 v[52:53], v[52:53], v[152:153]
  v_pk_mul_f32 v[56:57], v[56:57], v[168:169]
  v_pk_mul_f32 v[60:61], v[60:61], v[154:155]
  v_pk_mul_f32 v[64:65], v[64:65], v[170:171]
  v_exp_f32 v52, v52
  v_exp_f32 v53, v53
  v_exp_f32 v56, v56
  v_exp_f32 v57, v57
  v_exp_f32 v60, v60
  v_exp_f32 v61, v61
  v_exp_f32 v64, v64
  v_exp_f32 v65, v65
  v_pk_mul_f32 v[54:55], v[152:153], v[16:17]
  v_pk_mul_f32 v[58:59], v[168:169], v[16:17]
  v_pk_mul_f32 v[62:63], v[154:155], v[18:19]
  v_pk_mul_f32 v[66:67], v[170:171], v[18:19]
  v_pk_add_f32 v[52:53], v[52:53], v[248:249]
  v_pk_add_f32 v[56:57], v[56:57], v[248:249]
  v_pk_add_f32 v[60:61], v[60:61], v[248:249]
  v_pk_add_f32 v[64:65], v[64:65], v[248:249]
  v_rcp_f32 v52, v52
  v_rcp_f32 v53, v53
  v_rcp_f32 v56, v56
  v_rcp_f32 v57, v57
  v_rcp_f32 v60, v60
  v_rcp_f32 v61, v61
  v_rcp_f32 v64, v64
  v_rcp_f32 v65, v65
  v_pk_mul_f32 v[40:41], v[52:53], v[54:55]
  v_pk_mul_f32 v[42:43], v[56:57], v[58:59]
  v_pk_fma_f32 v[40:41], v[60:61], v[62:63], v[40:41]
  v_pk_fma_f32 v[42:43], v[64:65], v[66:67], v[42:43]
  v_pk_mul_f32 v[68:69], v[156:157], v[156:157]
  v_pk_mul_f32 v[72:73], v[172:173], v[172:173]
  v_pk_mul_f32 v[76:77], v[158:159], v[158:159]
  v_pk_mul_f32 v[80:81], v[174:175], v[174:175]
  v_pk_fma_f32 v[68:69], v[68:69], v[14:15], v[12:13]
  v_pk_fma_f32 v[72:73], v[72:73], v[14:15], v[12:13]
  v_pk_fma_f32 v[76:77], v[76:77], v[14:15], v[12:13]
  v_pk_fma_f32 v[80:81], v[80:81], v[14:15], v[12:13]
  v_pk_mul_f32 v[68:69], v[68:69], v[156:157]
  v_pk_mul_f32 v[72:73], v[72:73], v[172:173]
  v_pk_mul_f32 v[76:77], v[76:77], v[158:159]
  v_pk_mul_f32 v[80:81], v[80:81], v[174:175]
  v_exp_f32 v68, v68
  v_exp_f32 v69, v69
  v_exp_f32 v72, v72
  v_exp_f32 v73, v73
  v_exp_f32 v76, v76
  v_exp_f32 v77, v77
  v_exp_f32 v80, v80
  v_exp_f32 v81, v81
  v_pk_mul_f32 v[70:71], v[156:157], v[20:21]
  v_pk_mul_f32 v[74:75], v[172:173], v[20:21]
  v_pk_mul_f32 v[78:79], v[158:159], v[22:23]
  v_pk_mul_f32 v[82:83], v[174:175], v[22:23]
  v_pk_add_f32 v[68:69], v[68:69], v[248:249]
  v_pk_add_f32 v[72:73], v[72:73], v[248:249]
  v_pk_add_f32 v[76:77], v[76:77], v[248:249]
  v_pk_add_f32 v[80:81], v[80:81], v[248:249]
  v_rcp_f32 v68, v68
  v_rcp_f32 v69, v69
  v_rcp_f32 v72, v72
  v_rcp_f32 v73, v73
  v_rcp_f32 v76, v76
  v_rcp_f32 v77, v77
  v_rcp_f32 v80, v80
  v_rcp_f32 v81, v81
  v_pk_fma_f32 v[40:41], v[68:69], v[70:71], v[40:41]
  v_pk_fma_f32 v[42:43], v[72:73], v[74:75], v[42:43]
  v_pk_fma_f32 v[40:41], v[76:77], v[78:79], v[40:41]
  v_pk_fma_f32 v[42:43], v[80:81], v[82:83], v[42:43]
  v_pk_mul_f32 v[52:53], v[160:161], v[160:161]
  v_pk_mul_f32 v[56:57], v[176:177], v[176:177]
  v_pk_mul_f32 v[60:61], v[162:163], v[162:163]
  v_pk_mul_f32 v[64:65], v[178:179], v[178:179]
  v_pk_fma_f32 v[52:53], v[52:53], v[14:15], v[12:13]
  v_pk_fma_f32 v[56:57], v[56:57], v[14:15], v[12:13]
  v_pk_fma_f32 v[60:61], v[60:61], v[14:15], v[12:13]
  v_pk_fma_f32 v[64:65], v[64:65], v[14:15], v[12:13]
  v_pk_mul_f32 v[52:53], v[52:53], v[160:161]
  v_pk_mul_f32 v[56:57], v[56:57], v[176:177]
  v_pk_mul_f32 v[60:61], v[60:61], v[162:163]
  v_pk_mul_f32 v[64:65], v[64:65], v[178:179]
  v_exp_f32 v52, v52
  v_exp_f32 v53, v53
  v_exp_f32 v56, v56
  v_exp_f32 v57, v57
  v_exp_f32 v60, v60
  v_exp_f32 v61, v61
  v_exp_f32 v64, v64
  v_exp_f32 v65, v65
  v_pk_mul_f32 v[54:55], v[160:161], v[24:25]
  v_pk_mul_f32 v[58:59], v[176:177], v[24:25]
  v_pk_mul_f32 v[62:63], v[162:163], v[26:27]
  v_pk_mul_f32 v[66:67], v[178:179], v[26:27]
  v_pk_add_f32 v[52:53], v[52:53], v[248:249]
  v_pk_add_f32 v[56:57], v[56:57], v[248:249]
  v_pk_add_f32 v[60:61], v[60:61], v[248:249]
  v_pk_add_f32 v[64:65], v[64:65], v[248:249]
  v_rcp_f32 v52, v52
  v_rcp_f32 v53, v53
  v_rcp_f32 v56, v56
  v_rcp_f32 v57, v57
  v_rcp_f32 v60, v60
  v_rcp_f32 v61, v61
  v_rcp_f32 v64, v64
  v_rcp_f32 v65, v65
  v_pk_fma_f32 v[40:41], v[52:53], v[54:55], v[40:41]
  v_pk_fma_f32 v[42:43], v[56:57], v[58:59], v[42:43]
  v_pk_fma_f32 v[40:41], v[60:61], v[62:63], v[40:41]
  v_pk_fma_f32 v[42:43], v[64:65], v[66:67], v[42:43]
  v_pk_mul_f32 v[68:69], v[164:165], v[164:165]
  v_pk_mul_f32 v[72:73], v[180:181], v[180:181]
  v_pk_mul_f32 v[76:77], v[166:167], v[166:167]
  v_pk_mul_f32 v[80:81], v[182:183], v[182:183]
  v_pk_fma_f32 v[68:69], v[68:69], v[14:15], v[12:13]
  v_pk_fma_f32 v[72:73], v[72:73], v[14:15], v[12:13]
  v_pk_fma_f32 v[76:77], v[76:77], v[14:15], v[12:13]
  v_pk_fma_f32 v[80:81], v[80:81], v[14:15], v[12:13]
  v_pk_mul_f32 v[68:69], v[68:69], v[164:165]
  v_pk_mul_f32 v[72:73], v[72:73], v[180:181]
  v_pk_mul_f32 v[76:77], v[76:77], v[166:167]
  v_pk_mul_f32 v[80:81], v[80:81], v[182:183]
  v_exp_f32 v68, v68
  v_exp_f32 v69, v69
  v_exp_f32 v72, v72
  v_exp_f32 v73, v73
  v_exp_f32 v76, v76
  v_exp_f32 v77, v77
  v_exp_f32 v80, v80
  v_exp_f32 v81, v81
  v_pk_mul_f32 v[70:71], v[164:165], v[28:29]
  v_pk_mul_f32 v[74:75], v[180:181], v[28:29]
  v_pk_mul_f32 v[78:79], v[166:167], v[30:31]
  v_pk_mul_f32 v[82:83], v[182:183], v[30:31]
  v_pk_add_f32 v[68:69], v[68:69], v[248:249]
  v_pk_add_f32 v[72:73], v[72:73], v[248:249]
  v_pk_add_f32 v[76:77], v[76:77], v[248:249]
  v_pk_add_f32 v[80:81], v[80:81], v[248:249]
  v_rcp_f32 v68, v68
  v_rcp_f32 v69, v69
  v_rcp_f32 v72, v72
  v_rcp_f32 v73, v73
  v_rcp_f32 v76, v76
  v_rcp_f32 v77, v77
  v_rcp_f32 v80, v80
  v_rcp_f32 v81, v81
  v_pk_fma_f32 v[40:41], v[68:69], v[70:71], v[40:41]
  v_pk_fma_f32 v[42:43], v[72:73], v[74:75], v[42:43]
  v_pk_fma_f32 v[40:41], v[76:77], v[78:79], v[40:41]
  v_pk_fma_f32 v[42:43], v[80:81], v[82:83], v[42:43]
  v_pk_mul_f32 v[52:53], v[184:185], v[184:185]
  v_pk_mul_f32 v[56:57], v[200:201], v[200:201]
  v_pk_mul_f32 v[60:61], v[186:187], v[186:187]
  v_pk_mul_f32 v[64:65], v[202:203], v[202:203]
  v_pk_fma_f32 v[52:53], v[52:53], v[14:15], v[12:13]
  v_pk_fma_f32 v[56:57], v[56:57], v[14:15], v[12:13]
  v_pk_fma_f32 v[60:61], v[60:61], v[14:15], v[12:13]
  v_pk_fma_f32 v[64:65], v[64:65], v[14:15], v[12:13]
  v_pk_mul_f32 v[52:53], v[52:53], v[184:185]
  v_pk_mul_f32 v[56:57], v[56:57], v[200:201]
  v_pk_mul_f32 v[60:61], v[60:61], v[186:187]
  v_pk_mul_f32 v[64:65], v[64:65], v[202:203]
  v_exp_f32 v52, v52
  v_exp_f32 v53, v53
  v_exp_f32 v56, v56
  v_exp_f32 v57, v57
  v_exp_f32 v60, v60
  v_exp_f32 v61, v61
  v_exp_f32 v64, v64
  v_exp_f32 v65, v65
  v_pk_mul_f32 v[54:55], v[184:185], v[16:17]
  v_pk_mul_f32 v[58:59], v[200:201], v[16:17]
  v_pk_mul_f32 v[62:63], v[186:187], v[18:19]
  v_pk_mul_f32 v[66:67], v[202:203], v[18:19]
  v_pk_add_f32 v[52:53], v[52:53], v[248:249]
  v_pk_add_f32 v[56:57], v[56:57], v[248:249]
  v_pk_add_f32 v[60:61], v[60:61], v[248:249]
  v_pk_add_f32 v[64:65], v[64:65], v[248:249]
  v_rcp_f32 v52, v52
  v_rcp_f32 v53, v53
  v_rcp_f32 v56, v56
  v_rcp_f32 v57, v57
  v_rcp_f32 v60, v60
  v_rcp_f32 v61, v61
  v_rcp_f32 v64, v64
  v_rcp_f32 v65, v65
  v_pk_mul_f32 v[44:45], v[52:53], v[54:55]
  v_pk_mul_f32 v[46:47], v[56:57], v[58:59]
  v_pk_fma_f32 v[44:45], v[60:61], v[62:63], v[44:45]
  v_pk_fma_f32 v[46:47], v[64:65], v[66:67], v[46:47]
  v_pk_mul_f32 v[68:69], v[188:189], v[188:189]
  v_pk_mul_f32 v[72:73], v[204:205], v[204:205]
  v_pk_mul_f32 v[76:77], v[190:191], v[190:191]
  v_pk_mul_f32 v[80:81], v[206:207], v[206:207]
  v_pk_fma_f32 v[68:69], v[68:69], v[14:15], v[12:13]
  v_pk_fma_f32 v[72:73], v[72:73], v[14:15], v[12:13]
  v_pk_fma_f32 v[76:77], v[76:77], v[14:15], v[12:13]
  v_pk_fma_f32 v[80:81], v[80:81], v[14:15], v[12:13]
  v_pk_mul_f32 v[68:69], v[68:69], v[188:189]
  v_pk_mul_f32 v[72:73], v[72:73], v[204:205]
  v_pk_mul_f32 v[76:77], v[76:77], v[190:191]
  v_pk_mul_f32 v[80:81], v[80:81], v[206:207]
  v_exp_f32 v68, v68
  v_exp_f32 v69, v69
  v_exp_f32 v72, v72
  v_exp_f32 v73, v73
  v_exp_f32 v76, v76
  v_exp_f32 v77, v77
  v_exp_f32 v80, v80
  v_exp_f32 v81, v81
  v_pk_mul_f32 v[70:71], v[188:189], v[20:21]
  v_pk_mul_f32 v[74:75], v[204:205], v[20:21]
  v_pk_mul_f32 v[78:79], v[190:191], v[22:23]
  v_pk_mul_f32 v[82:83], v[206:207], v[22:23]
  v_pk_add_f32 v[68:69], v[68:69], v[248:249]
  v_pk_add_f32 v[72:73], v[72:73], v[248:249]
  v_pk_add_f32 v[76:77], v[76:77], v[248:249]
  v_pk_add_f32 v[80:81], v[80:81], v[248:249]
  v_rcp_f32 v68, v68
  v_rcp_f32 v69, v69
  v_rcp_f32 v72, v72
  v_rcp_f32 v73, v73
  v_rcp_f32 v76, v76
  v_rcp_f32 v77, v77
  v_rcp_f32 v80, v80
  v_rcp_f32 v81, v81
  v_pk_fma_f32 v[44:45], v[68:69], v[70:71], v[44:45]
  v_pk_fma_f32 v[46:47], v[72:73], v[74:75], v[46:47]
  v_pk_fma_f32 v[44:45], v[76:77], v[78:79], v[44:45]
  v_pk_fma_f32 v[46:47], v[80:81], v[82:83], v[46:47]
  v_pk_mul_f32 v[52:53], v[192:193], v[192:193]
  v_pk_mul_f32 v[56:57], v[208:209], v[208:209]
  v_pk_mul_f32 v[60:61], v[194:195], v[194:195]
  v_pk_mul_f32 v[64:65], v[210:211], v[210:211]
  v_pk_fma_f32 v[52:53], v[52:53], v[14:15], v[12:13]
  v_pk_fma_f32 v[56:57], v[56:57], v[14:15], v[12:13]
  v_pk_fma_f32 v[60:61], v[60:61], v[14:15], v[12:13]
  v_pk_fma_f32 v[64:65], v[64:65], v[14:15], v[12:13]
  v_pk_mul_f32 v[52:53], v[52:53], v[192:193]
  v_pk_mul_f32 v[56:57], v[56:57], v[208:209]
  v_pk_mul_f32 v[60:61], v[60:61], v[194:195]
  v_pk_mul_f32 v[64:65], v[64:65], v[210:211]
  v_exp_f32 v52, v52
  v_exp_f32 v53, v53
  v_exp_f32 v56, v56
  v_exp_f32 v57, v57
  v_exp_f32 v60, v60
  v_exp_f32 v61, v61
  v_exp_f32 v64, v64
  v_exp_f32 v65, v65
  v_pk_mul_f32 v[54:55], v[192:193], v[24:25]
  v_pk_mul_f32 v[58:59], v[208:209], v[24:25]
  v_pk_mul_f32 v[62:63], v[194:195], v[26:27]
  v_pk_mul_f32 v[66:67], v[210:211], v[26:27]
  v_pk_add_f32 v[52:53], v[52:53], v[248:249]
  v_pk_add_f32 v[56:57], v[56:57], v[248:249]
  v_pk_add_f32 v[60:61], v[60:61], v[248:249]
  v_pk_add_f32 v[64:65], v[64:65], v[248:249]
  v_rcp_f32 v52, v52
  v_rcp_f32 v53, v53
  v_rcp_f32 v56, v56
  v_rcp_f32 v57, v57
  v_rcp_f32 v60, v60
  v_rcp_f32 v61, v61
  v_rcp_f32 v64, v64
  v_rcp_f32 v65, v65
  v_pk_fma_f32 v[44:45], v[52:53], v[54:55], v[44:45]
  v_pk_fma_f32 v[46:47], v[56:57], v[58:59], v[46:47]
  v_pk_fma_f32 v[44:45], v[60:61], v[62:63], v[44:45]
  v_pk_fma_f32 v[46:47], v[64:65], v[66:67], v[46:47]
  v_pk_mul_f32 v[68:69], v[196:197], v[196:197]
  v_pk_mul_f32 v[72:73], v[212:213], v[212:213]
  v_pk_mul_f32 v[76:77], v[198:199], v[198:199]
  v_pk_mul_f32 v[80:81], v[214:215], v[214:215]
  v_pk_fma_f32 v[68:69], v[68:69], v[14:15], v[12:13]
  v_pk_fma_f32 v[72:73], v[72:73], v[14:15], v[12:13]
  v_pk_fma_f32 v[76:77], v[76:77], v[14:15], v[12:13]
  v_pk_fma_f32 v[80:81], v[80:81], v[14:15], v[12:13]
  v_pk_mul_f32 v[68:69], v[68:69], v[196:197]
  v_pk_mul_f32 v[72:73], v[72:73], v[212:213]
  v_pk_mul_f32 v[76:77], v[76:77], v[198:199]
  v_pk_mul_f32 v[80:81], v[80:81], v[214:215]
  v_exp_f32 v68, v68
  v_exp_f32 v69, v69
  v_exp_f32 v72, v72
  v_exp_f32 v73, v73
  v_exp_f32 v76, v76
  v_exp_f32 v77, v77
  v_exp_f32 v80, v80
  v_exp_f32 v81, v81
  v_pk_mul_f32 v[70:71], v[196:197], v[28:29]
  v_pk_mul_f32 v[74:75], v[212:213], v[28:29]
  v_pk_mul_f32 v[78:79], v[198:199], v[30:31]
  v_pk_mul_f32 v[82:83], v[214:215], v[30:31]
  v_pk_add_f32 v[68:69], v[68:69], v[248:249]
  v_pk_add_f32 v[72:73], v[72:73], v[248:249]
  v_pk_add_f32 v[76:77], v[76:77], v[248:249]
  v_pk_add_f32 v[80:81], v[80:81], v[248:249]
  v_rcp_f32 v68, v68
  v_rcp_f32 v69, v69
  v_rcp_f32 v72, v72
  v_rcp_f32 v73, v73
  v_rcp_f32 v76, v76
  v_rcp_f32 v77, v77
  v_rcp_f32 v80, v80
  v_rcp_f32 v81, v81
  v_pk_fma_f32 v[44:45], v[68:69], v[70:71], v[44:45]
  v_pk_fma_f32 v[46:47], v[72:73], v[74:75], v[46:47]
  v_pk_fma_f32 v[44:45], v[76:77], v[78:79], v[44:45]
  v_pk_fma_f32 v[46:47], v[80:81], v[82:83], v[46:47]
  v_pk_mul_f32 v[52:53], v[216:217], v[216:217]
  v_pk_mul_f32 v[56:57], v[232:233], v[232:233]
  v_pk_mul_f32 v[60:61], v[218:219], v[218:219]
  v_pk_mul_f32 v[64:65], v[234:235], v[234:235]
  v_pk_fma_f32 v[52:53], v[52:53], v[14:15], v[12:13]
  v_pk_fma_f32 v[56:57], v[56:57], v[14:15], v[12:13]
  v_pk_fma_f32 v[60:61], v[60:61], v[14:15], v[12:13]
  v_pk_fma_f32 v[64:65], v[64:65], v[14:15], v[12:13]
  v_pk_mul_f32 v[52:53], v[52:53], v[216:217]
  v_pk_mul_f32 v[56:57], v[56:57], v[232:233]
  v_pk_mul_f32 v[60:61], v[60:61], v[218:219]
  v_pk_mul_f32 v[64:65], v[64:65], v[234:235]
  v_exp_f32 v52, v52
  v_exp_f32 v53, v53
  v_exp_f32 v56, v56
  v_exp_f32 v57, v57
  v_exp_f32 v60, v60
  v_exp_f32 v61, v61
  v_exp_f32 v64, v64
  v_exp_f32 v65, v65
  v_pk_mul_f32 v[54:55], v[216:217], v[16:17]
  v_pk_mul_f32 v[58:59], v[232:233], v[16:17]
  v_pk_mul_f32 v[62:63], v[218:219], v[18:19]
  v_pk_mul_f32 v[66:67], v[234:235], v[18:19]
  v_pk_add_f32 v[52:53], v[52:53], v[248:249]
  v_pk_add_f32 v[56:57], v[56:57], v[248:249]
  v_pk_add_f32 v[60:61], v[60:61], v[248:249]
  v_pk_add_f32 v[64:65], v[64:65], v[248:249]
  v_rcp_f32 v52, v52
  v_rcp_f32 v53, v53
  v_rcp_f32 v56, v56
  v_rcp_f32 v57, v57
  v_rcp_f32 v60, v60
  v_rcp_f32 v61, v61
  v_rcp_f32 v64, v64
  v_rcp_f32 v65, v65
  v_pk_mul_f32 v[48:49], v[52:53], v[54:55]
  v_pk_mul_f32 v[50:51], v[56:57], v[58:59]
  v_pk_fma_f32 v[48:49], v[60:61], v[62:63], v[48:49]
  v_pk_fma_f32 v[50:51], v[64:65], v[66:67], v[50:51]
  v_pk_mul_f32 v[68:69], v[220:221], v[220:221]
  v_pk_mul_f32 v[72:73], v[236:237], v[236:237]
  v_pk_mul_f32 v[76:77], v[222:223], v[222:223]
  v_pk_mul_f32 v[80:81], v[238:239], v[238:239]
  v_pk_fma_f32 v[68:69], v[68:69], v[14:15], v[12:13]
  v_pk_fma_f32 v[72:73], v[72:73], v[14:15], v[12:13]
  v_pk_fma_f32 v[76:77], v[76:77], v[14:15], v[12:13]
  v_pk_fma_f32 v[80:81], v[80:81], v[14:15], v[12:13]
  v_pk_mul_f32 v[68:69], v[68:69], v[220:221]
  v_pk_mul_f32 v[72:73], v[72:73], v[236:237]
  v_pk_mul_f32 v[76:77], v[76:77], v[222:223]
  v_pk_mul_f32 v[80:81], v[80:81], v[238:239]
  v_exp_f32 v68, v68
  v_exp_f32 v69, v69
  v_exp_f32 v72, v72
  v_exp_f32 v73, v73
  v_exp_f32 v76, v76
  v_exp_f32 v77, v77
  v_exp_f32 v80, v80
  v_exp_f32 v81, v81
  v_pk_mul_f32 v[70:71], v[220:221], v[20:21]
  v_pk_mul_f32 v[74:75], v[236:237], v[20:21]
  v_pk_mul_f32 v[78:79], v[222:223], v[22:23]
  v_pk_mul_f32 v[82:83], v[238:239], v[22:23]
  v_pk_add_f32 v[68:69], v[68:69], v[248:249]
  v_pk_add_f32 v[72:73], v[72:73], v[248:249]
  v_pk_add_f32 v[76:77], v[76:77], v[248:249]
  v_pk_add_f32 v[80:81], v[80:81], v[248:249]
  v_rcp_f32 v68, v68
  v_rcp_f32 v69, v69
  v_rcp_f32 v72, v72
  v_rcp_f32 v73, v73
  v_rcp_f32 v76, v76
  v_rcp_f32 v77, v77
  v_rcp_f32 v80, v80
  v_rcp_f32 v81, v81
  v_pk_fma_f32 v[48:49], v[68:69], v[70:71], v[48:49]
  v_pk_fma_f32 v[50:51], v[72:73], v[74:75], v[50:51]
  v_pk_fma_f32 v[48:49], v[76:77], v[78:79], v[48:49]
  v_pk_fma_f32 v[50:51], v[80:81], v[82:83], v[50:51]
  v_pk_mul_f32 v[52:53], v[224:225], v[224:225]
  v_pk_mul_f32 v[56:57], v[240:241], v[240:241]
  v_pk_mul_f32 v[60:61], v[226:227], v[226:227]
  v_pk_mul_f32 v[64:65], v[242:243], v[242:243]
  v_pk_fma_f32 v[52:53], v[52:53], v[14:15], v[12:13]
  v_pk_fma_f32 v[56:57], v[56:57], v[14:15], v[12:13]
  v_pk_fma_f32 v[60:61], v[60:61], v[14:15], v[12:13]
  v_pk_fma_f32 v[64:65], v[64:65], v[14:15], v[12:13]
  v_pk_mul_f32 v[52:53], v[52:53], v[224:225]
  v_pk_mul_f32 v[56:57], v[56:57], v[240:241]
  v_pk_mul_f32 v[60:61], v[60:61], v[226:227]
  v_pk_mul_f32 v[64:65], v[64:65], v[242:243]
  v_exp_f32 v52, v52
  v_exp_f32 v53, v53
  v_exp_f32 v56, v56
  v_exp_f32 v57, v57
  v_exp_f32 v60, v60
  v_exp_f32 v61, v61
  v_exp_f32 v64, v64
  v_exp_f32 v65, v65
  v_pk_mul_f32 v[54:55], v[224:225], v[24:25]
  v_pk_mul_f32 v[58:59], v[240:241], v[24:25]
  v_pk_mul_f32 v[62:63], v[226:227], v[26:27]
  v_pk_mul_f32 v[66:67], v[242:243], v[26:27]
  v_pk_add_f32 v[52:53], v[52:53], v[248:249]
  v_pk_add_f32 v[56:57], v[56:57], v[248:249]
  v_pk_add_f32 v[60:61], v[60:61], v[248:249]
  v_pk_add_f32 v[64:65], v[64:65], v[248:249]
  v_rcp_f32 v52, v52
  v_rcp_f32 v53, v53
  v_rcp_f32 v56, v56
  v_rcp_f32 v57, v57
  v_rcp_f32 v60, v60
  v_rcp_f32 v61, v61
  v_rcp_f32 v64, v64
  v_rcp_f32 v65, v65
  v_pk_fma_f32 v[48:49], v[52:53], v[54:55], v[48:49]
  v_pk_fma_f32 v[50:51], v[56:57], v[58:59], v[50:51]
  v_pk_fma_f32 v[48:49], v[60:61], v[62:63], v[48:49]
  v_pk_fma_f32 v[50:51], v[64:65], v[66:67], v[50:51]
  v_pk_mul_f32 v[68:69], v[228:229], v[228:229]
  v_pk_mul_f32 v[72:73], v[244:245], v[244:245]
  v_pk_mul_f32 v[76:77], v[230:231], v[230:231]
  v_pk_mul_f32 v[80:81], v[246:247], v[246:247]
  v_pk_fma_f32 v[68:69], v[68:69], v[14:15], v[12:13]
  v_pk_fma_f32 v[72:73], v[72:73], v[14:15], v[12:13]
  v_pk_fma_f32 v[76:77], v[76:77], v[14:15], v[12:13]
  v_pk_fma_f32 v[80:81], v[80:81], v[14:15], v[12:13]
  v_pk_mul_f32 v[68:69], v[68:69], v[228:229]
  v_pk_mul_f32 v[72:73], v[72:73], v[244:245]
  v_pk_mul_f32 v[76:77], v[76:77], v[230:231]
  v_pk_mul_f32 v[80:81], v[80:81], v[246:247]
  v_exp_f32 v68, v68
  v_exp_f32 v69, v69
  v_exp_f32 v72, v72
  v_exp_f32 v73, v73
  v_exp_f32 v76, v76
  v_exp_f32 v77, v77
  v_exp_f32 v80, v80
  v_exp_f32 v81, v81
  v_pk_mul_f32 v[70:71], v[228:229], v[28:29]
  v_pk_mul_f32 v[74:75], v[244:245], v[28:29]
  v_pk_mul_f32 v[78:79], v[230:231], v[30:31]
  v_pk_mul_f32 v[82:83], v[246:247], v[30:31]
  v_pk_add_f32 v[68:69], v[68:69], v[248:249]
  v_pk_add_f32 v[72:73], v[72:73], v[248:249]
  v_pk_add_f32 v[76:77], v[76:77], v[248:249]
  v_pk_add_f32 v[80:81], v[80:81], v[248:249]
  v_rcp_f32 v68, v68
  v_rcp_f32 v69, v69
  v_rcp_f32 v72, v72
  v_rcp_f32 v73, v73
  v_rcp_f32 v76, v76
  v_rcp_f32 v77, v77
  v_rcp_f32 v80, v80
  v_rcp_f32 v81, v81
  v_pk_fma_f32 v[48:49], v[68:69], v[70:71], v[48:49]
  v_pk_fma_f32 v[50:51], v[72:73], v[74:75], v[50:51]
  v_pk_fma_f32 v[48:49], v[76:77], v[78:79], v[48:49]
  v_pk_fma_f32 v[50:51], v[80:81], v[82:83], v[50:51]
  v_pk_mul_f32 v[32:33], v[88:89], v[16:17]
  v_pk_fma_f32 v[32:33], v[90:91], v[18:19], v[32:33]
  v_pk_fma_f32 v[32:33], v[92:93], v[20:21], v[32:33]
  v_pk_fma_f32 v[32:33], v[94:95], v[22:23], v[32:33]
  v_pk_fma_f32 v[32:33], v[96:97], v[24:25], v[32:33]
  v_pk_fma_f32 v[32:33], v[98:99], v[26:27], v[32:33]
  v_pk_fma_f32 v[32:33], v[100:101], v[28:29], v[32:33]
  v_pk_fma_f32 v[32:33], v[102:103], v[30:31], v[32:33]
  v_add_f32 v32, v32, v33
  v_add_f32 v34, v34, v35
  v_add_f32 v36, v36, v37
  v_add_f32 v38, v38, v39
  v_add_f32 v40, v40, v41
  v_add_f32 v42, v42, v43
  v_add_f32 v44, v44, v45
  v_add_f32 v46, v46, v47
  v_add_f32 v48, v48, v49
  v_add_f32 v50, v50, v51
  v_permlane32_swap_b32 v32, v34
  v_permlane32_swap_b32 v36, v38
  v_permlane32_swap_b32 v40, v42
  v_permlane32_swap_b32 v44, v46
  v_permlane32_swap_b32 v48, v50
  v_add_f32 v48, v48, v50
  v_add_f32 v32, v32, v34
  v_add_f32 v36, v36, v38
  v_add_f32 v40, v40, v42
  v_add_f32 v44, v44, v46
  v_mov_b32 v50, v48
  v_permlane16_swap_b32 v32, v36
  v_permlane16_swap_b32 v40, v44
  v_permlane16_swap_b32 v48, v50
  v_add_f32 v32, v32, v36
  v_add_f32 v40, v40, v44
  v_add_f32_e64 v48, v48, v50
  ds_write_b32 v10, v32
  ds_write_b32 v10, v40 offset:256
  s_mov_b32 exec_lo, 0xffff
  s_mov_b32 exec_hi, 0xffff
  ds_write_b32 v10, v48 offset:512
  s_mov_b64 exec, -1
  s_waitcnt lgkmcnt(0)
  s_barrier
  s_endpgm
L_ld_tail:
  s_barrier
  s_mov_b32 s60, s24
  s_and_b32 s61, s25, 0xffff
  s_mov_b32 s62, 268435456
  s_mov_b32 s63, 0x20000
  s_mov_b32 s56, s20
  s_and_b32 s57, s21, 0xffff
  s_mov_b32 s58, 8192
  s_mov_b32 s59, 0x20000
  s_mov_b32 s64, s22
  s_and_b32 s65, s23, 0xffff
  s_mov_b32 s66, 256
  s_mov_b32 s67, 0x20000
  s_load_dword s80, s[18:19], 0
  v_mov_b32 v100, 0
  s_mov_b64 exec, 1
  s_mov_b32 s81, 0x80000
  buffer_load_dword v101, v100, s[60:63], s81 offen
  buffer_load_dword v102, v100, s[56:59], 0 offen
  s_mov_b64 exec, -1
  s_mov_b64 exec, 1
  buffer_load_dword v250, v100, s[64:67], 0 offen offset:240 sc1
  s_mov_b64 exec, -1
  s_cmp_lg_u32 s3, 4
  s_cbranch_scc1 L_end
  v_lshlrev_b32 v3, 4, v0
  v_lshlrev_b32 v4, 2, v0
  v_add_u32 v1, 123392, v3
  v_add_u32 v2, 124416, v4
  v_add_u32 v4, 1024, v4
  v_mov_b32 v5, 32
  v_mov_b32 v7, s26
  s_mul_i32 s68, s26, 1280
  s_mul_i32 s69, s27, 16640
  s_add_u32 s69, s69, s68
  s_setprio 3
  v_mov_b32 v64, -1
  v_mov_b32 v65, -1
  v_mov_b32 v66, -1
  v_mov_b32_e64 v67, -1
  buffer_store_dwordx4 v[64:67], v3, s[60:63], s69 offen sc1
  buffer_store_dword v64, v4, s[60:63], s69 offen sc1
  s_waitcnt vmcnt(0)
  s_barrier
  ds_read_b128 v[64:67], v1
  ds_read_b128 v[72:75], v1 offset:1280
  ds_read2st64_b32 v[68:69], v2 offset0:0 offset1:5
  s_waitcnt lgkmcnt(0)
  v_pk_add_f32 v[64:65], v[64:65], v[72:73]
  v_pk_add_f32 v[66:67], v[66:67], v[74:75]
  v_add_f32 v68, v68, v69
  v_min_u32 v64, -2, v64
  v_min_u32 v65, -2, v65
  v_min_u32 v66, -2, v66
  v_min_u32 v67, -2, v67
  v_min_u32_e64 v68, -2, v68
  buffer_store_dwordx4 v[64:67], v3, s[60:63], s69 offen sc1
  buffer_store_dword v68, v4, s[60:63], s69 offen sc1
  s_mov_b64 exec, 1
L_pub:
  v_lshlrev_b32 v6, 4, v7
  v_mov_b32 v13, v5
  buffer_atomic_add v5, v6, s[64:67], 0 offen sc0
  v_cmp_eq_u32 vcc, 12, v7
  v_mov_b32 v8, 436
  v_mov_b32 v9, 434
  v_cndmask_b32 v8, v8, v9, vcc
  v_sub_u32_e64 v8, v8, v13
  s_waitcnt vmcnt(0) lgkmcnt(0)
  v_cmp_eq_u32 s[82:83], v5, v8
  s_mov_b64 exec, -1
  s_lshl_b32 s80, s80, 16
  v_lshrrev_b32 v1, 1, v3
  v_lshrrev_b32_e64 v2, 1, v4
L_fin:
  s_cmp_eq_u32 s82, 0
  s_cbranch_scc1 L_done
  s_ff1_i32_b32 s70, s82
  s_bitset0_b32 s82, s70
  v_readlane_b32 s71, v7, s70
  s_waitcnt vmcnt(0)
L_again:
  s_mul_i32 s68, s71, 1280
  buffer_load_dwordx4 v[64:67], v3, s[60:63], s68 offen sc1
  buffer_load_dword v68, v4, s[60:63], s68 offen sc1
  s_add_u32 s68, s68, 16640
  buffer_load_dwordx4 v[72:75], v3, s[60:63], s68 offen sc1
  buffer_load_dword v76, v4, s[60:63], s68 offen sc1
  s_add_u32 s68, s68, 16640
  buffer_load_dwordx4 v[80:83], v3, s[60:63], s68 offen sc1
  buffer_load_dword v84, v4, s[60:63], s68 offen sc1
  s_add_u32 s68, s68, 16640
  buffer_load_dwordx4 v[88:91], v3, s[60:63], s68 offen sc1
  buffer_load_dword v92, v4, s[60:63], s68 offen sc1
  s_add_u32 s68, s68, 16640
  buffer_load_dwordx4 v[96:99], v3, s[60:63], s68 offen sc1
  buffer_load_dword v100, v4, s[60:63], s68 offen sc1
  s_add_u32 s68, s68, 16640
  buffer_load_dwordx4 v[104:107], v3, s[60:63], s68 offen sc1
  buffer_load_dword v108, v4, s[60:63], s68 offen sc1
  s_add_u32 s68, s68, 16640
  buffer_load_dwordx4 v[112:115], v3, s[60:63], s68 offen sc1
  buffer_load_dword v116, v4, s[60:63], s68 offen sc1
  s_add_u32 s68, s68, 16640
  buffer_load_dwordx4 v[120:123], v3, s[60:63], s68 offen sc1
  buffer_load_dword v124, v4, s[60:63], s68 offen sc1
  s_add_u32 s68, s68, 16640
  buffer_load_dwordx4 v[128:131], v3, s[60:63], s68 offen sc1
  buffer_load_dword v132, v4, s[60:63], s68 offen sc1
  s_add_u32 s68, s68, 16640
  buffer_load_dwordx4 v[136:139], v3, s[60:63], s68 offen sc1
  buffer_load_dword v140, v4, s[60:63], s68 offen sc1
  s_add_u32 s68, s68, 16640
  buffer_load_dwordx4 v[144:147], v3, s[60:63], s68 offen sc1
  buffer_load_dword v148, v4, s[60:63], s68 offen sc1
  s_add_u32 s68, s68, 16640
  buffer_load_dwordx4 v[152:155], v3, s[60:63], s68 offen sc1
  buffer_load_dword v156, v4, s[60:63], s68 offen sc1
  s_add_u32 s68, s68, 16640
  buffer_load_dwordx4 v[160:163], v3, s[60:63], s68 offen sc1
  buffer_load_dword v164, v4, s[60:63], s68 offen sc1
  s_add_u32 s68, s68, 16640
  buffer_load_dwordx4 v[168:171], v3, s[60:63], s68 offen sc1
  buffer_load_dword v172, v4, s[60:63], s68 offen sc1
  s_add_u32 s68, s68, 16640
L_sum:
  s_waitcnt vmcnt(25)
  v_pk_add_f32 v[56:57], v[64:65], v[72:73]
  v_pk_add_f32 v[58:59], v[66:67], v[74:75]
  s_waitcnt vmcnt(24)
  v_add_f32 v60, v68, v76
  s_waitcnt vmcnt(23)
  v_pk_add_f32 v[56:57], v[56:57], v[80:81]
  v_pk_add_f32 v[58:59], v[58:59], v[82:83]
  s_waitcnt vmcnt(22)
  v_add_f32 v60, v60, v84
  s_waitcnt vmcnt(21)
  v_pk_add_f32 v[56:57], v[56:57], v[88:89]
  v_pk_add_f32 v[58:59], v[58:59], v[90:91]
  s_waitcnt vmcnt(20)
  v_add_f32 v60, v60, v92
  s_waitcnt vmcnt(19)
  v_pk_add_f32 v[56:57], v[56:57], v[96:97]
  v_pk_add_f32 v[58:59], v[58:59], v[98:99]
  s_waitcnt vmcnt(18)
  v_add_f32 v60, v60, v100
  s_waitcnt vmcnt(17)
  v_pk_add_f32 v[56:57], v[56:57], v[104:105]
  v_pk_add_f32 v[58:59], v[58:59], v[106:107]
  s_waitcnt vmcnt(16)
  v_add_f32 v60, v60, v108
  s_waitcnt vmcnt(15)
  v_pk_add_f32 v[56:57], v[56:57], v[112:113]
  v_pk_add_f32 v[58:59], v[58:59], v[114:115]
  s_waitcnt vmcnt(14)
  v_add_f32_e64 v60, v60, v116
  s_waitcnt vmcnt(13)
  v_pk_add_f32 v[56:57], v[56:57], v[120:121]
  v_pk_add_f32 v[58:59], v[58:59], v[122:123]
  s_waitcnt vmcnt(12)
  v_add_f32 v60, v60, v124
  s_waitcnt vmcnt(11)
  v_pk_add_f32 v[56:57], v[56:57], v[128:129]
  v_pk_add_f32 v[58:59], v[58:59], v[130:131]
  s_waitcnt vmcnt(10)
  v_add_f32 v60, v60, v132
  s_waitcnt vmcnt(9)
  v_pk_add_f32 v[56:57], v[56:57], v[136:137]
  v_pk_add_f32 v[58:59], v[58:59], v[138:139]
  s_waitcnt vmcnt(8)
  v_add_f32 v60, v60, v140
  s_waitcnt vmcnt(7)
  v_pk_add_f32 v[56:57], v[56:57], v[144:145]
  v_pk_add_f32 v[58:59], v[58:59], v[146:147]
  s_waitcnt vmcnt(6)
  v_add_f32 v60, v60, v148
  s_waitcnt vmcnt(5)
  v_pk_add_f32 v[56:57], v[56:57], v[152:153]
  v_pk_add_f32 v[58:59], v[58:59], v[154:155]
  s_waitcnt vmcnt(4)
  v_add_f32 v60, v60, v156
  s_waitcnt vmcnt(3)
  v_pk_add_f32 v[56:57], v[56:57], v[160:161]
  v_pk_add_f32 v[58:59], v[58:59], v[162:163]
  s_waitcnt vmcnt(2)
  v_add_f32 v60, v60, v164
  s_waitcnt vmcnt(1)
  v_pk_add_f32 v[56:57], v[56:57], v[168:169]
  v_pk_add_f32 v[58:59], v[58:59], v[170:171]
  s_waitcnt vmcnt(0)
  v_add_f32 v60, v60, v172
  v_cmp_u_f32 vcc, v56, v57
  v_cmp_u_f32 s[92:93], v58, v59
  s_nop 0
  s_or_b64 s[92:93], s[92:93], vcc
  v_cmp_u_f32 vcc, v60, v60
  s_nop 0
  s_or_b64 vcc, s[92:93], vcc
  s_cbranch_vccnz L_chk
L_ok:
  s_mul_i32 s71, s71, 640
  v_add_f32 v56, s80, v56
  v_add_f32 v57, s80, v57
  v_add_f32 v58, s80, v58
  v_add_f32 v59, s80, v59
  v_add_f32 v60, s80, v60
  v_cvt_pk_bf16_f32 v10, v56, v57
  v_cvt_pk_bf16_f32 v11, v58, v59
  v_cvt_pk_bf16_f32 v12, v60, v60
  buffer_store_dwordx2 v[10:11], v1, s[56:59], s71 offen
  buffer_store_short v12, v2, s[56:59], s71 offen
  s_branch L_fin
L_chk:
  v_mov_b32 v14, 0
  v_mov_b32_e64 v15, 0
  v_max3_u32 v14, v14, v64, v65
  v_max3_u32 v14, v14, v66, v67
  v_max_u32 v15, v15, v68
  v_max3_u32 v14, v14, v72, v73
  v_max3_u32 v14, v14, v74, v75
  v_max_u32 v15, v15, v76
  v_max3_u32 v14, v14, v80, v81
  v_max3_u32 v14, v14, v82, v83
  v_max_u32_e64 v15, v15, v84
  v_max3_u32 v14, v14, v88, v89
  v_max3_u32 v14, v14, v90, v91
  v_max_u32 v15, v15, v92
  v_max3_u32 v14, v14, v96, v97
  v_max3_u32 v14, v14, v98, v99
  v_max_u32 v15, v15, v100
  v_max3_u32 v14, v14, v104, v105
  v_max3_u32 v14, v14, v106, v107
  v_max_u32_e64 v15, v15, v108
  v_max3_u32 v14, v14, v112, v113
  v_max3_u32 v14, v14, v114, v115
  v_max_u32 v15, v15, v116
  v_max3_u32 v14, v14, v120, v121
  v_max3_u32 v14, v14, v122, v123
  v_max_u32 v15, v15, v124
  v_max3_u32 v14, v14, v128, v129
  v_max3_u32 v14, v14, v130, v131
  v_max_u32_e64 v15, v15, v132
  v_max3_u32 v14, v14, v136, v137
  v_max3_u32 v14, v14, v138, v139
  v_max_u32 v15, v15, v140
  v_max3_u32 v14, v14, v144, v145
  v_max3_u32 v14, v14, v146, v147
  v_max_u32 v15, v15, v148
  v_max3_u32 v14, v14, v152, v153
  v_max3_u32 v14, v14, v154, v155
  v_max_u32_e64 v15, v15, v156
  v_max3_u32 v14, v14, v160, v161
  v_max3_u32 v14, v14, v162, v163
  v_max_u32 v15, v15, v164
  v_max3_u32 v14, v14, v168, v169
  v_max3_u32 v14, v14, v170, v171
  v_max_u32 v15, v15, v172
  s_cmp_eq_u32 s71, 12
  s_cselect_b32 s68, 0, -1
  v_and_b32 v15, s68, v15
  v_max_u32 v14, v14, v15
  v_cmp_eq_u32 vcc, -1, v14
  s_cbranch_vccnz L_again
  s_branch L_ok
L_done:
  s_endpgm
L_cin_done:
  s_mul_i32 s98, s3, 1536
  s_add_u32 s98, s98, 116736
  v_lshlrev_b32 v120, 5, v0
  v_add_u32 v120, s98, v120
  ds_read_b128 v[60:63], v120
  ds_read_b128 v[64:67], v120 offset:16
  v_mul_f32 v116, v184, v192
  v_mul_f32 v117, v185, v193
  v_mul_f32 v118, v186, v194
  v_mul_f32 v119, v187, v195
  v_fmac_f32 v116, v188, v191
  v_fmac_f32 v117, v200, v208
  v_fmac_f32 v118, v201, v209
  v_fmac_f32 v119, v202, v210
  v_fmac_f32 v116, v203, v211
  v_fmac_f32 v117, v204, v207
  v_fmac_f32 v118, v216, v224
  v_fmac_f32 v119, v217, v225
  v_fmac_f32 v116, v218, v226
  v_fmac_f32 v117, v219, v227
  v_fmac_f32 v118, v220, v223
  v_fmac_f32 v119, v232, v240
  v_fmac_f32 v116, v233, v241
  v_fmac_f32 v117, v234, v242
  v_fmac_f32 v118, v235, v243
  v_fmac_f32 v119, v236, v239
  v_fmac_f32 v116, v189, v196
  v_fmac_f32 v117, v189, v197
  v_fmac_f32 v118, v190, v198
  v_fmac_f32 v119, v190, v199
  v_fmac_f32 v116, v205, v212
  v_fmac_f32 v117, v205, v213
  v_fmac_f32 v118, v206, v214
  v_fmac_f32 v119, v206, v215
  v_fmac_f32 v116, v221, v228
  v_fmac_f32 v117, v221, v229
  v_fmac_f32 v118, v222, v230
  v_fmac_f32 v119, v222, v231
  v_fmac_f32 v116, v237, v244
  v_fmac_f32 v117, v237, v245
  v_fmac_f32 v118, v238, v246
  v_fmac_f32 v119, v238, v247
  v_add_f32 v116, v116, v117
  v_add_f32 v118, v118, v119
  v_add_f32 v116, v116, v118
  v_mul_f32 v116, s74, v116
  v_mul_f32 v116, s75, v116
  s_nop 1
  v_add_f32_dpp v116, v116, v116 row_shr:1 row_mask:0xf bank_mask:0xf
  v_subrev_u32 v122, s98, v7
  v_lshrrev_b32 v122, 8, v122
  v_lshrrev_b32 v121, 3, v0
  v_add_f32_dpp v116, v116, v116 row_shr:2 row_mask:0xf bank_mask:0xf
  v_cmp_gt_u32 vcc, v122, v121
  v_min_u32 v121, v121, v122
  v_lshlrev_b32 v121, 4, v121
  v_add_f32_dpp v116, v116, v116 row_shr:4 row_mask:0xf bank_mask:0xf
  v_add_u32 v121, s85, v121
  s_waitcnt lgkmcnt(1)
  v_add_f32 v60, v60, v61
  v_add_f32 v62, v62, v63
  v_add_f32_dpp v116, v116, v116 row_shr:8 row_mask:0xf bank_mask:0xf
  s_waitcnt lgkmcnt(0)
  v_add_f32 v64, v64, v65
  v_add_f32 v66, v66, v67
  v_add_f32 v60, v60, v62
  v_add_f32_dpp v116, v116, v116 row_bcast:15 row_mask:0xa bank_mask:0xf
  v_add_f32 v64, v64, v66
  v_add_f32_e64 v60, v60, v64
  s_nop 1
  v_add_f32_dpp v60, v60, v60 quad_perm:[1,0,3,2] row_mask:0xf bank_mask:0xf
  v_add_f32_dpp v116, v116, v116 row_bcast:31 row_mask:0xc bank_mask:0xf
  s_nop 0
  v_add_f32_dpp v60, v60, v60 quad_perm:[2,3,0,1] row_mask:0xf bank_mask:0xf
  s_nop 1
  v_add_f32_dpp v60, v60, v60 row_half_mirror row_mask:0xf bank_mask:0xf
  v_cndmask_b32 v60, v116, v60, vcc
  s_bitset1_b32 vcc_hi, 31
  s_mov_b64 exec, vcc
  ds_write_b32 v121, v60
  s_mov_b64 exec, -1
  s_cmp_eq_u32 s3, 0
  s_cbranch_scc1 L_cpub
  s_waitcnt lgkmcnt(0)
  s_barrier
  s_endpgm
L_cpub:
  s_load_dword s80, s[18:19], 0
  s_mov_b32 s60, s24
  s_and_b32 s61, s25, 0xffff
  s_mov_b32 s62, 268435456
  s_mov_b32 s63, 0x20000
  s_mov_b32 s56, s20
  s_and_b32 s57, s21, 0xffff
  s_mov_b32 s58, 8192
  s_mov_b32 s59, 0x20000
  s_mov_b32 s64, s22
  s_and_b32 s65, s23, 0xffff
  s_mov_b32 s66, 256
  s_mov_b32 s67, 0x20000
  v_lshlrev_b32_e64 v6, 2, v0
  v_add_u32 v2, 129728, v6
  v_add_u32 v4, 1024, v6
  s_mul_i32 s69, s26, 192
  s_add_u32 s69, s69, 216320
  v_mov_b32 v13, -1
  s_mov_b32 exec_hi, 0xffff
  buffer_store_dword v13, v6, s[60:63], s69 offen sc1
  s_mov_b64 exec, 1
  buffer_load_dword v250, v6, s[56:59], 0 offen
  buffer_load_dword v251, v6, s[64:67], 0 offen offset:240 sc1
  s_mov_b64 exec, -1
  s_mul_i32 s68, s26, 3
  s_mul_i32 s70, s68, 3277
  s_lshr_b32 s70, s70, 16
  v_add_u32 v7, s70, v0
  s_mul_i32 s70, s70, 20
  s_add_u32 s70, s70, 20
  s_sub_u32 s70, s70, s68
  s_min_u32 s70, s70, 3
  s_sub_u32 s68, 3, s70
  v_mov_b32 v5, s68
  v_writelane_b32 v5, s70, 0
  s_cmp_eq_u32 s68, 0
  s_cselect_b32 s68, 1, 3
  v_lshlrev_b32 v3, 4, v0
  s_mov_b32 exec_hi, 0xffff
  s_waitcnt vmcnt(0) lgkmcnt(0)
  s_barrier
  ds_read_b32 v64, v2
  s_waitcnt lgkmcnt(0)
  v_min_u32_e64 v64, -2, v64
  buffer_store_dword v64, v6, s[60:63], s69 offen sc1
  s_mov_b32 exec_lo, s68
  s_mov_b32 exec_hi, 0
  s_branch L_pub
L_dnn_loop1:
  s_barrier
L_ld_in:
  s_add_u32 m0, s75, 131072
  s_nop 0
  buffer_load_dwordx4 v4, s[44:47], s74 offen lds
  s_add_u32 m0, s75, 132096
  s_nop 0
  buffer_load_dwordx4 v5, s[44:47], s74 offen lds
  s_add_u32 s74, s74, 106496
  s_add_u32 m0, s75, 139264
  s_nop 0
  buffer_load_dwordx4 v4, s[44:47], s74 offen lds
  s_add_u32 m0, s75, 140288
  s_nop 0
  buffer_load_dwordx4 v5, s[44:47], s74 offen lds
  s_add_u32 s74, s74, 106496
  s_add_u32 m0, s76, 0
  s_nop 0
  buffer_load_dwordx4 v56, s[32:35], 0 offen lds
  s_add_u32 m0, s76, 2048
  v_add_u32_dpp v56, v16, v2 row_newbcast:1 row_mask:0xf bank_mask:0x3
  buffer_load_dwordx4 v57, s[32:35], 0 offen lds
  s_nop 0
  v_add_u32_dpp v56, v18, v2 row_newbcast:7 row_mask:0xf bank_mask:0xc
  s_add_u32 m0, s76, 4096
  v_add_u32_dpp v57, v20, v2 row_newbcast:1 row_mask:0xf bank_mask:0x3
  buffer_load_dwordx4 v58, s[32:35], 0 offen lds
  s_nop 0
  v_add_u32_dpp v57, v22, v2 row_newbcast:7 row_mask:0xf bank_mask:0xc
  s_add_u32 m0, s76, 6144
  v_add_u32_dpp v58, v24, v2 row_newbcast:1 row_mask:0xf bank_mask:0x3
  buffer_load_dwordx4 v59, s[32:35], 0 offen lds
  s_nop 0
  v_add_u32_dpp v58, v26, v2 row_newbcast:7 row_mask:0xf bank_mask:0xc
  s_add_u32 m0, s76, 8192
  v_add_u32_dpp v59, v28, v2 row_newbcast:1 row_mask:0xf bank_mask:0x3
  buffer_load_dwordx4 v60, s[32:35], 0 offen lds
  s_nop 0
  v_add_u32_dpp v59, v30, v2 row_newbcast:7 row_mask:0xf bank_mask:0xc
  s_add_u32 m0, s76, 10240
  v_add_u32_dpp v60, v32, v2 row_newbcast:1 row_mask:0xf bank_mask:0x3
  buffer_load_dwordx4 v61, s[32:35], 0 offen lds
  s_nop 0
  v_add_u32_dpp v60, v34, v2 row_newbcast:7 row_mask:0xf bank_mask:0xc
  s_add_u32 m0, s76, 12288
  v_add_u32_dpp v61, v36, v2 row_newbcast:1 row_mask:0xf bank_mask:0x3
  buffer_load_dwordx4 v62, s[32:35], 0 offen lds
  s_nop 0
  v_add_u32_dpp v61, v38, v2 row_newbcast:7 row_mask:0xf bank_mask:0xc
  s_add_u32 m0, s76, 14336
  v_add_u32_dpp v62, v40, v2 row_newbcast:1 row_mask:0xf bank_mask:0x3
  buffer_load_dwordx4 v63, s[32:35], 0 offen lds
  s_nop 0
  v_add_u32_dpp v62, v42, v2 row_newbcast:7 row_mask:0xf bank_mask:0xc
  s_add_u32 m0, s76, 16384
  v_add_u32_dpp v63, v44, v2 row_newbcast:1 row_mask:0xf bank_mask:0x3
  buffer_load_dwordx4 v64, s[32:35], 0 offen lds
  s_nop 0
  v_add_u32_dpp v63, v46, v2 row_newbcast:7 row_mask:0xf bank_mask:0xc
  s_add_u32 m0, s76, 18432
  v_add_u32_dpp v64, v48, v2 row_newbcast:1 row_mask:0xf bank_mask:0x3
  buffer_load_dwordx4 v65, s[32:35], 0 offen lds
  s_nop 0
  v_add_u32_dpp v64, v50, v2 row_newbcast:7 row_mask:0xf bank_mask:0xc
  v_add_u32_dpp v65, v52, v2 row_newbcast:1 row_mask:0xf bank_mask:0x3
  s_nop 1
  v_add_u32_dpp v65, v54, v2 row_newbcast:7 row_mask:0xf bank_mask:0xc
  s_waitcnt vmcnt(10)
  s_barrier
  s_add_u32 m0, s75, 147456
  s_nop 0
  buffer_load_dwordx4 v4, s[44:47], s74 offen lds
  s_add_u32 m0, s75, 148480
  s_nop 0
  buffer_load_dwordx4 v5, s[44:47], s74 offen lds
  s_add_u32 s74, s74, 106496
  s_add_u32 m0, s75, 155648
  s_nop 0
  buffer_load_dwordx4 v4, s[44:47], s74 offen lds
  s_add_u32 m0, s75, 156672
  s_nop 0
  buffer_load_dwordx4 v5, s[44:47], s74 offen lds
  s_add_u32 s74, s74, 106496
  s_add_u32 m0, s76, 40960
  s_nop 0
  buffer_load_dwordx4 v56, s[32:35], 0 offen lds
  s_add_u32 m0, s76, 43008
  v_add_u32_dpp v56, v17, v2 row_newbcast:1 row_mask:0xf bank_mask:0x3
  buffer_load_dwordx4 v57, s[32:35], 0 offen lds
  s_nop 0
  v_add_u32_dpp v56, v19, v2 row_newbcast:7 row_mask:0xf bank_mask:0xc
  s_add_u32 m0, s76, 45056
  v_add_u32_dpp v57, v21, v2 row_newbcast:1 row_mask:0xf bank_mask:0x3
  buffer_load_dwordx4 v58, s[32:35], 0 offen lds
  s_nop 0
  v_add_u32_dpp v57, v23, v2 row_newbcast:7 row_mask:0xf bank_mask:0xc
  s_add_u32 m0, s76, 47104
  v_add_u32_dpp v58, v25, v2 row_newbcast:1 row_mask:0xf bank_mask:0x3
  buffer_load_dwordx4 v59, s[32:35], 0 offen lds
  s_nop 0
  v_add_u32_dpp v58, v27, v2 row_newbcast:7 row_mask:0xf bank_mask:0xc
  s_add_u32 m0, s76, 49152
  v_add_u32_dpp v59, v29, v2 row_newbcast:1 row_mask:0xf bank_mask:0x3
  buffer_load_dwordx4 v60, s[32:35], 0 offen lds
  s_nop 0
  v_add_u32_dpp v59, v31, v2 row_newbcast:7 row_mask:0xf bank_mask:0xc
  s_add_u32 m0, s76, 51200
  v_add_u32_dpp v60, v33, v2 row_newbcast:1 row_mask:0xf bank_mask:0x3
  buffer_load_dwordx4 v61, s[32:35], 0 offen lds
  s_nop 0
  v_add_u32_dpp v60, v35, v2 row_newbcast:7 row_mask:0xf bank_mask:0xc
  s_add_u32 m0, s76, 53248
  v_add_u32_dpp v61, v37, v2 row_newbcast:1 row_mask:0xf bank_mask:0x3
  buffer_load_dwordx4 v62, s[32:35], 0 offen lds
  s_nop 0
  v_add_u32_dpp v61, v39, v2 row_newbcast:7 row_mask:0xf bank_mask:0xc
  s_add_u32 m0, s76, 55296
  v_add_u32_dpp v62, v41, v2 row_newbcast:1 row_mask:0xf bank_mask:0x3
  buffer_load_dwordx4 v63, s[32:35], 0 offen lds
  s_nop 0
  v_add_u32_dpp v62, v43, v2 row_newbcast:7 row_mask:0xf bank_mask:0xc
  s_add_u32 m0, s76, 57344
  v_add_u32_dpp v63, v45, v2 row_newbcast:1 row_mask:0xf bank_mask:0x3
  buffer_load_dwordx4 v64, s[32:35], 0 offen lds
  s_nop 0
  v_add_u32_dpp v63, v47, v2 row_newbcast:7 row_mask:0xf bank_mask:0xc
  s_add_u32 m0, s76, 59392
  v_add_u32_dpp v64, v49, v2 row_newbcast:1 row_mask:0xf bank_mask:0x3
  buffer_load_dwordx4 v65, s[32:35], 0 offen lds
  s_nop 0
  v_add_u32_dpp v64, v51, v2 row_newbcast:7 row_mask:0xf bank_mask:0xc
  v_add_u32_dpp v65, v53, v2 row_newbcast:1 row_mask:0xf bank_mask:0x3
  s_nop 1
  v_add_u32_dpp v65, v55, v2 row_newbcast:7 row_mask:0xf bank_mask:0xc
  s_waitcnt vmcnt(10)
  s_barrier
  s_add_u32 m0, s75, 131072
  s_nop 0
  buffer_load_dwordx4 v4, s[44:47], s74 offen lds
  s_add_u32 m0, s75, 132096
  s_nop 0
  buffer_load_dwordx4 v5, s[44:47], s74 offen lds
  s_add_u32 s74, s74, 106496
  s_add_u32 m0, s75, 139264
  s_nop 0
  buffer_load_dwordx4 v4, s[44:47], s74 offen lds
  s_add_u32 m0, s75, 140288
  s_nop 0
  buffer_load_dwordx4 v5, s[44:47], s74 offen lds
  s_add_u32 s74, s74, 106496
  s_add_u32 m0, s76, 81920
  s_nop 0
  buffer_load_dwordx4 v56, s[32:35], 0 offen lds
  s_add_u32 m0, s76, 83968
  v_add_u32_dpp v56, v18, v2 row_newbcast:1 row_mask:0xf bank_mask:0x3
  buffer_load_dwordx4 v57, s[32:35], 0 offen lds
  s_nop 0
  v_add_u32_dpp v56, v16, v2 row_newbcast:8 row_mask:0xf bank_mask:0xc
  s_add_u32 m0, s76, 86016
  v_add_u32_dpp v57, v22, v2 row_newbcast:1 row_mask:0xf bank_mask:0x3
  buffer_load_dwordx4 v58, s[32:35], 0 offen lds
  s_nop 0
  v_add_u32_dpp v57, v20, v2 row_newbcast:8 row_mask:0xf bank_mask:0xc
  s_add_u32 m0, s76, 88064
  v_add_u32_dpp v58, v26, v2 row_newbcast:1 row_mask:0xf bank_mask:0x3
  buffer_load_dwordx4 v59, s[32:35], 0 offen lds
  s_nop 0
  v_add_u32_dpp v58, v24, v2 row_newbcast:8 row_mask:0xf bank_mask:0xc
  s_add_u32 m0, s76, 90112
  v_add_u32_dpp v59, v30, v2 row_newbcast:1 row_mask:0xf bank_mask:0x3
  buffer_load_dwordx4 v60, s[32:35], 0 offen lds
  s_nop 0
  v_add_u32_dpp v59, v28, v2 row_newbcast:8 row_mask:0xf bank_mask:0xc
  s_add_u32 m0, s76, 92160
  v_add_u32_dpp v60, v34, v2 row_newbcast:1 row_mask:0xf bank_mask:0x3
  buffer_load_dwordx4 v61, s[32:35], 0 offen lds
  s_nop 0
  v_add_u32_dpp v60, v32, v2 row_newbcast:8 row_mask:0xf bank_mask:0xc
  s_add_u32 m0, s76, 94208
  v_add_u32_dpp v61, v38, v2 row_newbcast:1 row_mask:0xf bank_mask:0x3
  buffer_load_dwordx4 v62, s[32:35], 0 offen lds
  s_nop 0
  v_add_u32_dpp v61, v36, v2 row_newbcast:8 row_mask:0xf bank_mask:0xc
  s_add_u32 m0, s76, 96256
  v_add_u32_dpp v62, v42, v2 row_newbcast:1 row_mask:0xf bank_mask:0x3
  buffer_load_dwordx4 v63, s[32:35], 0 offen lds
  s_nop 0
  v_add_u32_dpp v62, v40, v2 row_newbcast:8 row_mask:0xf bank_mask:0xc
  s_add_u32 m0, s76, 98304
  v_add_u32_dpp v63, v46, v2 row_newbcast:1 row_mask:0xf bank_mask:0x3
  buffer_load_dwordx4 v64, s[32:35], 0 offen lds
  s_nop 0
  v_add_u32_dpp v63, v44, v2 row_newbcast:8 row_mask:0xf bank_mask:0xc
  s_add_u32 m0, s76, 100352
  v_add_u32_dpp v64, v50, v2 row_newbcast:1 row_mask:0xf bank_mask:0x3
  buffer_load_dwordx4 v65, s[32:35], 0 offen lds
  s_nop 0
  v_add_u32_dpp v64, v48, v2 row_newbcast:8 row_mask:0xf bank_mask:0xc
  v_add_u32_dpp v65, v54, v2 row_newbcast:1 row_mask:0xf bank_mask:0x3
  s_nop 1
  v_add_u32_dpp v65, v52, v2 row_newbcast:8 row_mask:0xf bank_mask:0xc
  s_waitcnt vmcnt(10)
  s_barrier
  s_add_u32 m0, s75, 147456
  s_nop 0
  buffer_load_dwordx4 v4, s[44:47], s74 offen lds
  s_add_u32 m0, s75, 148480
  s_nop 0
  buffer_load_dwordx4 v5, s[44:47], s74 offen lds
  s_add_u32 s74, s74, 106496
  s_add_u32 m0, s75, 155648
  s_nop 0
  buffer_load_dwordx4 v4, s[44:47], s74 offen lds
  s_add_u32 m0, s75, 156672
  s_nop 0
  buffer_load_dwordx4 v5, s[44:47], s74 offen lds
  s_add_u32 s74, s74, 106496
  s_add_u32 m0, s76, 0
  s_nop 0
  buffer_load_dwordx4 v56, s[32:35], 0 offen lds
  s_add_u32 m0, s76, 2048
  v_add_u32_dpp v56, v19, v2 row_newbcast:1 row_mask:0xf bank_mask:0x3
  buffer_load_dwordx4 v57, s[32:35], 0 offen lds
  s_nop 0
  v_add_u32_dpp v56, v17, v2 row_newbcast:8 row_mask:0xf bank_mask:0xc
  s_add_u32 m0, s76, 4096
  v_add_u32_dpp v57, v23, v2 row_newbcast:1 row_mask:0xf bank_mask:0x3
  buffer_load_dwordx4 v58, s[32:35], 0 offen lds
  s_nop 0
  v_add_u32_dpp v57, v21, v2 row_newbcast:8 row_mask:0xf bank_mask:0xc
  s_add_u32 m0, s76, 6144
  v_add_u32_dpp v58, v27, v2 row_newbcast:1 row_mask:0xf bank_mask:0x3
  buffer_load_dwordx4 v59, s[32:35], 0 offen lds
  s_nop 0
  v_add_u32_dpp v58, v25, v2 row_newbcast:8 row_mask:0xf bank_mask:0xc
  s_add_u32 m0, s76, 8192
  v_add_u32_dpp v59, v31, v2 row_newbcast:1 row_mask:0xf bank_mask:0x3
  buffer_load_dwordx4 v60, s[32:35], 0 offen lds
  s_nop 0
  v_add_u32_dpp v59, v29, v2 row_newbcast:8 row_mask:0xf bank_mask:0xc
  s_add_u32 m0, s76, 10240
  v_add_u32_dpp v60, v35, v2 row_newbcast:1 row_mask:0xf bank_mask:0x3
  buffer_load_dwordx4 v61, s[32:35], 0 offen lds
  s_nop 0
  v_add_u32_dpp v60, v33, v2 row_newbcast:8 row_mask:0xf bank_mask:0xc
  s_add_u32 m0, s76, 12288
  v_add_u32_dpp v61, v39, v2 row_newbcast:1 row_mask:0xf bank_mask:0x3
  buffer_load_dwordx4 v62, s[32:35], 0 offen lds
  s_nop 0
  v_add_u32_dpp v61, v37, v2 row_newbcast:8 row_mask:0xf bank_mask:0xc
  s_add_u32 m0, s76, 14336
  v_add_u32_dpp v62, v43, v2 row_newbcast:1 row_mask:0xf bank_mask:0x3
  buffer_load_dwordx4 v63, s[32:35], 0 offen lds
  s_nop 0
  v_add_u32_dpp v62, v41, v2 row_newbcast:8 row_mask:0xf bank_mask:0xc
  s_add_u32 m0, s76, 16384
  v_add_u32_dpp v63, v47, v2 row_newbcast:1 row_mask:0xf bank_mask:0x3
  buffer_load_dwordx4 v64, s[32:35], 0 offen lds
  s_nop 0
  v_add_u32_dpp v63, v45, v2 row_newbcast:8 row_mask:0xf bank_mask:0xc
  s_add_u32 m0, s76, 18432
  v_add_u32_dpp v64, v51, v2 row_newbcast:1 row_mask:0xf bank_mask:0x3
  buffer_load_dwordx4 v65, s[32:35], 0 offen lds
  s_nop 0
  v_add_u32_dpp v64, v49, v2 row_newbcast:8 row_mask:0xf bank_mask:0xc
  v_add_u32_dpp v65, v55, v2 row_newbcast:1 row_mask:0xf bank_mask:0x3
  s_nop 1
  v_add_u32_dpp v65, v53, v2 row_newbcast:8 row_mask:0xf bank_mask:0xc
  s_waitcnt vmcnt(10)
  s_barrier
  s_add_u32 m0, s75, 131072
  s_nop 0
  buffer_load_dwordx4 v4, s[44:47], s74 offen lds
  s_add_u32 m0, s75, 132096
  s_nop 0
  buffer_load_dwordx4 v5, s[44:47], s74 offen lds
  s_add_u32 s74, s74, 106496
  s_add_u32 m0, s75, 139264
  s_nop 0
  buffer_load_dwordx4 v4, s[44:47], s74 offen lds
  s_add_u32 m0, s75, 140288
  s_nop 0
  buffer_load_dwordx4 v5, s[44:47], s74 offen lds
  s_add_u32 s74, s74, 106496
  s_add_u32 m0, s76, 40960
  s_nop 0
  buffer_load_dwordx4 v56, s[32:35], 0 offen lds
  s_add_u32 m0, s76, 43008
  v_add_u32_dpp v56, v16, v2 row_newbcast:2 row_mask:0xf bank_mask:0x3
  buffer_load_dwordx4 v57, s[32:35], 0 offen lds
  s_nop 0
  v_add_u32_dpp v56, v18, v2 row_newbcast:8 row_mask:0xf bank_mask:0xc
  s_add_u32 m0, s76, 45056
  v_add_u32_dpp v57, v20, v2 row_newbcast:2 row_mask:0xf bank_mask:0x3
  buffer_load_dwordx4 v58, s[32:35], 0 offen lds
  s_nop 0
  v_add_u32_dpp v57, v22, v2 row_newbcast:8 row_mask:0xf bank_mask:0xc
  s_add_u32 m0, s76, 47104
  v_add_u32_dpp v58, v24, v2 row_newbcast:2 row_mask:0xf bank_mask:0x3
  buffer_load_dwordx4 v59, s[32:35], 0 offen lds
  s_nop 0
  v_add_u32_dpp v58, v26, v2 row_newbcast:8 row_mask:0xf bank_mask:0xc
  s_add_u32 m0, s76, 49152
  v_add_u32_dpp v59, v28, v2 row_newbcast:2 row_mask:0xf bank_mask:0x3
  buffer_load_dwordx4 v60, s[32:35], 0 offen lds
  s_nop 0
  v_add_u32_dpp v59, v30, v2 row_newbcast:8 row_mask:0xf bank_mask:0xc
  s_add_u32 m0, s76, 51200
  v_add_u32_dpp v60, v32, v2 row_newbcast:2 row_mask:0xf bank_mask:0x3
  buffer_load_dwordx4 v61, s[32:35], 0 offen lds
  s_nop 0
  v_add_u32_dpp v60, v34, v2 row_newbcast:8 row_mask:0xf bank_mask:0xc
  s_add_u32 m0, s76, 53248
  v_add_u32_dpp v61, v36, v2 row_newbcast:2 row_mask:0xf bank_mask:0x3
  buffer_load_dwordx4 v62, s[32:35], 0 offen lds
  s_nop 0
  v_add_u32_dpp v61, v38, v2 row_newbcast:8 row_mask:0xf bank_mask:0xc
  s_add_u32 m0, s76, 55296
  v_add_u32_dpp v62, v40, v2 row_newbcast:2 row_mask:0xf bank_mask:0x3
  buffer_load_dwordx4 v63, s[32:35], 0 offen lds
  s_nop 0
  v_add_u32_dpp v62, v42, v2 row_newbcast:8 row_mask:0xf bank_mask:0xc
  s_add_u32 m0, s76, 57344
  v_add_u32_dpp v63, v44, v2 row_newbcast:2 row_mask:0xf bank_mask:0x3
  buffer_load_dwordx4 v64, s[32:35], 0 offen lds
  s_nop 0
  v_add_u32_dpp v63, v46, v2 row_newbcast:8 row_mask:0xf bank_mask:0xc
  s_add_u32 m0, s76, 59392
  v_add_u32_dpp v64, v48, v2 row_newbcast:2 row_mask:0xf bank_mask:0x3
  buffer_load_dwordx4 v65, s[32:35], 0 offen lds
  s_nop 0
  v_add_u32_dpp v64, v50, v2 row_newbcast:8 row_mask:0xf bank_mask:0xc
  v_add_u32_dpp v65, v52, v2 row_newbcast:2 row_mask:0xf bank_mask:0x3
  s_nop 1
  v_add_u32_dpp v65, v54, v2 row_newbcast:8 row_mask:0xf bank_mask:0xc
  s_waitcnt vmcnt(10)
  s_barrier
  s_add_u32 m0, s75, 147456
  s_nop 0
  buffer_load_dwordx4 v4, s[44:47], s74 offen lds
  s_add_u32 m0, s75, 148480
  s_nop 0
  buffer_load_dwordx4 v5, s[44:47], s74 offen lds
  s_add_u32 s74, s74, 106496
  s_add_u32 m0, s75, 155648
  s_nop 0
  buffer_load_dwordx4 v4, s[44:47], s74 offen lds
  s_add_u32 m0, s75, 156672
  s_nop 0
  buffer_load_dwordx4 v5, s[44:47], s74 offen lds
  s_add_u32 s74, s74, 106496
  s_add_u32 m0, s76, 81920
  s_nop 0
  buffer_load_dwordx4 v56, s[32:35], 0 offen lds
  s_add_u32 m0, s76, 83968
  v_add_u32_dpp v56, v17, v2 row_newbcast:2 row_mask:0xf bank_mask:0x3
  buffer_load_dwordx4 v57, s[32:35], 0 offen lds
  s_nop 0
  v_add_u32_dpp v56, v19, v2 row_newbcast:8 row_mask:0xf bank_mask:0xc
  s_add_u32 m0, s76, 86016
  v_add_u32_dpp v57, v21, v2 row_newbcast:2 row_mask:0xf bank_mask:0x3
  buffer_load_dwordx4 v58, s[32:35], 0 offen lds
  s_nop 0
  v_add_u32_dpp v57, v23, v2 row_newbcast:8 row_mask:0xf bank_mask:0xc
  s_add_u32 m0, s76, 88064
  v_add_u32_dpp v58, v25, v2 row_newbcast:2 row_mask:0xf bank_mask:0x3
  buffer_load_dwordx4 v59, s[32:35], 0 offen lds
  s_nop 0
  v_add_u32_dpp v58, v27, v2 row_newbcast:8 row_mask:0xf bank_mask:0xc
  s_add_u32 m0, s76, 90112
  v_add_u32_dpp v59, v29, v2 row_newbcast:2 row_mask:0xf bank_mask:0x3
  buffer_load_dwordx4 v60, s[32:35], 0 offen lds
  s_nop 0
  v_add_u32_dpp v59, v31, v2 row_newbcast:8 row_mask:0xf bank_mask:0xc
  s_add_u32 m0, s76, 92160
  v_add_u32_dpp v60, v33, v2 row_newbcast:2 row_mask:0xf bank_mask:0x3
  buffer_load_dwordx4 v61, s[32:35], 0 offen lds
  s_nop 0
  v_add_u32_dpp v60, v35, v2 row_newbcast:8 row_mask:0xf bank_mask:0xc
  s_add_u32 m0, s76, 94208
  v_add_u32_dpp v61, v37, v2 row_newbcast:2 row_mask:0xf bank_mask:0x3
  buffer_load_dwordx4 v62, s[32:35], 0 offen lds
  s_nop 0
  v_add_u32_dpp v61, v39, v2 row_newbcast:8 row_mask:0xf bank_mask:0xc
  s_add_u32 m0, s76, 96256
  v_add_u32_dpp v62, v41, v2 row_newbcast:2 row_mask:0xf bank_mask:0x3
  buffer_load_dwordx4 v63, s[32:35], 0 offen lds
  s_nop 0
  v_add_u32_dpp v62, v43, v2 row_newbcast:8 row_mask:0xf bank_mask:0xc
  s_add_u32 m0, s76, 98304
  v_add_u32_dpp v63, v45, v2 row_newbcast:2 row_mask:0xf bank_mask:0x3
  buffer_load_dwordx4 v64, s[32:35], 0 offen lds
  s_nop 0
  v_add_u32_dpp v63, v47, v2 row_newbcast:8 row_mask:0xf bank_mask:0xc
  s_add_u32 m0, s76, 100352
  v_add_u32_dpp v64, v49, v2 row_newbcast:2 row_mask:0xf bank_mask:0x3
  buffer_load_dwordx4 v65, s[32:35], 0 offen lds
  s_nop 0
  v_add_u32_dpp v64, v51, v2 row_newbcast:8 row_mask:0xf bank_mask:0xc
  v_add_u32_dpp v65, v53, v2 row_newbcast:2 row_mask:0xf bank_mask:0x3
  s_nop 1
  v_add_u32_dpp v65, v55, v2 row_newbcast:8 row_mask:0xf bank_mask:0xc
  s_waitcnt vmcnt(10)
  s_barrier
  s_add_u32 m0, s75, 131072
  s_nop 0
  buffer_load_dwordx4 v4, s[44:47], s74 offen lds
  s_add_u32 m0, s75, 132096
  s_nop 0
  buffer_load_dwordx4 v5, s[44:47], s74 offen lds
  s_add_u32 s74, s74, 106496
  s_add_u32 m0, s75, 139264
  s_nop 0
  buffer_load_dwordx4 v4, s[44:47], s74 offen lds
  s_add_u32 m0, s75, 140288
  s_nop 0
  buffer_load_dwordx4 v5, s[44:47], s74 offen lds
  s_add_u32 s74, s74, 106496
  s_add_u32 m0, s76, 0
  s_nop 0
  buffer_load_dwordx4 v56, s[32:35], 0 offen lds
  s_add_u32 m0, s76, 2048
  v_add_u32_dpp v56, v18, v2 row_newbcast:2 row_mask:0xf bank_mask:0x3
  buffer_load_dwordx4 v57, s[32:35], 0 offen lds
  s_nop 0
  v_add_u32_dpp v56, v16, v2 row_newbcast:9 row_mask:0xf bank_mask:0xc
  s_add_u32 m0, s76, 4096
  v_add_u32_dpp v57, v22, v2 row_newbcast:2 row_mask:0xf bank_mask:0x3
  buffer_load_dwordx4 v58, s[32:35], 0 offen lds
  s_nop 0
  v_add_u32_dpp v57, v20, v2 row_newbcast:9 row_mask:0xf bank_mask:0xc
  s_add_u32 m0, s76, 6144
  v_add_u32_dpp v58, v26, v2 row_newbcast:2 row_mask:0xf bank_mask:0x3
  buffer_load_dwordx4 v59, s[32:35], 0 offen lds
  s_nop 0
  v_add_u32_dpp v58, v24, v2 row_newbcast:9 row_mask:0xf bank_mask:0xc
  s_add_u32 m0, s76, 8192
  v_add_u32_dpp v59, v30, v2 row_newbcast:2 row_mask:0xf bank_mask:0x3
  buffer_load_dwordx4 v60, s[32:35], 0 offen lds
  s_nop 0
  v_add_u32_dpp v59, v28, v2 row_newbcast:9 row_mask:0xf bank_mask:0xc
  s_add_u32 m0, s76, 10240
  v_add_u32_dpp v60, v34, v2 row_newbcast:2 row_mask:0xf bank_mask:0x3
  buffer_load_dwordx4 v61, s[32:35], 0 offen lds
  s_nop 0
  v_add_u32_dpp v60, v32, v2 row_newbcast:9 row_mask:0xf bank_mask:0xc
  s_add_u32 m0, s76, 12288
  v_add_u32_dpp v61, v38, v2 row_newbcast:2 row_mask:0xf bank_mask:0x3
  buffer_load_dwordx4 v62, s[32:35], 0 offen lds
  s_nop 0
  v_add_u32_dpp v61, v36, v2 row_newbcast:9 row_mask:0xf bank_mask:0xc
  s_add_u32 m0, s76, 14336
  v_add_u32_dpp v62, v42, v2 row_newbcast:2 row_mask:0xf bank_mask:0x3
  buffer_load_dwordx4 v63, s[32:35], 0 offen lds
  s_nop 0
  v_add_u32_dpp v62, v40, v2 row_newbcast:9 row_mask:0xf bank_mask:0xc
  s_add_u32 m0, s76, 16384
  v_add_u32_dpp v63, v46, v2 row_newbcast:2 row_mask:0xf bank_mask:0x3
  buffer_load_dwordx4 v64, s[32:35], 0 offen lds
  s_nop 0
  v_add_u32_dpp v63, v44, v2 row_newbcast:9 row_mask:0xf bank_mask:0xc
  s_add_u32 m0, s76, 18432
  v_add_u32_dpp v64, v50, v2 row_newbcast:2 row_mask:0xf bank_mask:0x3
  buffer_load_dwordx4 v65, s[32:35], 0 offen lds
  s_nop 0
  v_add_u32_dpp v64, v48, v2 row_newbcast:9 row_mask:0xf bank_mask:0xc
  v_add_u32_dpp v65, v54, v2 row_newbcast:2 row_mask:0xf bank_mask:0x3
  s_nop 1
  v_add_u32_dpp v65, v52, v2 row_newbcast:9 row_mask:0xf bank_mask:0xc
  s_waitcnt vmcnt(10)
  s_barrier
  s_add_u32 m0, s75, 147456
  s_nop 0
  buffer_load_dwordx4 v4, s[44:47], s74 offen lds
  s_add_u32 m0, s75, 148480
  s_nop 0
  buffer_load_dwordx4 v5, s[44:47], s74 offen lds
  s_add_u32 s74, s74, 106496
  s_add_u32 m0, s75, 155648
  s_nop 0
  buffer_load_dwordx4 v4, s[44:47], s74 offen lds
  s_add_u32 m0, s75, 156672
  s_nop 0
  buffer_load_dwordx4 v5, s[44:47], s74 offen lds
  s_add_u32 s74, s74, 106496
  s_add_u32 m0, s76, 40960
  s_nop 0
  buffer_load_dwordx4 v56, s[32:35], 0 offen lds
  s_add_u32 m0, s76, 43008
  v_add_u32_dpp v56, v19, v2 row_newbcast:2 row_mask:0xf bank_mask:0x3
  buffer_load_dwordx4 v57, s[32:35], 0 offen lds
  s_nop 0
  v_add_u32_dpp v56, v17, v2 row_newbcast:9 row_mask:0xf bank_mask:0xc
  s_add_u32 m0, s76, 45056
  v_add_u32_dpp v57, v23, v2 row_newbcast:2 row_mask:0xf bank_mask:0x3
  buffer_load_dwordx4 v58, s[32:35], 0 offen lds
  s_nop 0
  v_add_u32_dpp v57, v21, v2 row_newbcast:9 row_mask:0xf bank_mask:0xc
  s_add_u32 m0, s76, 47104
  v_add_u32_dpp v58, v27, v2 row_newbcast:2 row_mask:0xf bank_mask:0x3
  buffer_load_dwordx4 v59, s[32:35], 0 offen lds
  s_nop 0
  v_add_u32_dpp v58, v25, v2 row_newbcast:9 row_mask:0xf bank_mask:0xc
  s_add_u32 m0, s76, 49152
  v_add_u32_dpp v59, v31, v2 row_newbcast:2 row_mask:0xf bank_mask:0x3
  buffer_load_dwordx4 v60, s[32:35], 0 offen lds
  s_nop 0
  v_add_u32_dpp v59, v29, v2 row_newbcast:9 row_mask:0xf bank_mask:0xc
  s_add_u32 m0, s76, 51200
  v_add_u32_dpp v60, v35, v2 row_newbcast:2 row_mask:0xf bank_mask:0x3
  buffer_load_dwordx4 v61, s[32:35], 0 offen lds
  s_nop 0
  v_add_u32_dpp v60, v33, v2 row_newbcast:9 row_mask:0xf bank_mask:0xc
  s_add_u32 m0, s76, 53248
  v_add_u32_dpp v61, v39, v2 row_newbcast:2 row_mask:0xf bank_mask:0x3
  buffer_load_dwordx4 v62, s[32:35], 0 offen lds
  s_nop 0
  v_add_u32_dpp v61, v37, v2 row_newbcast:9 row_mask:0xf bank_mask:0xc
  s_add_u32 m0, s76, 55296
  v_add_u32_dpp v62, v43, v2 row_newbcast:2 row_mask:0xf bank_mask:0x3
  buffer_load_dwordx4 v63, s[32:35], 0 offen lds
  s_nop 0
  v_add_u32_dpp v62, v41, v2 row_newbcast:9 row_mask:0xf bank_mask:0xc
  s_add_u32 m0, s76, 57344
  v_add_u32_dpp v63, v47, v2 row_newbcast:2 row_mask:0xf bank_mask:0x3
  buffer_load_dwordx4 v64, s[32:35], 0 offen lds
  s_nop 0
  v_add_u32_dpp v63, v45, v2 row_newbcast:9 row_mask:0xf bank_mask:0xc
  s_add_u32 m0, s76, 59392
  v_add_u32_dpp v64, v51, v2 row_newbcast:2 row_mask:0xf bank_mask:0x3
  buffer_load_dwordx4 v65, s[32:35], 0 offen lds
  s_nop 0
  v_add_u32_dpp v64, v49, v2 row_newbcast:9 row_mask:0xf bank_mask:0xc
  v_add_u32_dpp v65, v55, v2 row_newbcast:2 row_mask:0xf bank_mask:0x3
  s_nop 1
  v_add_u32_dpp v65, v53, v2 row_newbcast:9 row_mask:0xf bank_mask:0xc
  s_waitcnt vmcnt(10)
  s_cmp_lg_u32 s72, 1
  s_cbranch_scc1 L_nolpf
  s_mov_b64 exec, 1048575
  global_load_dword v10, v[8:9], off
  s_mov_b64 exec, -1
  s_mov_b32 m0, 123136
  s_mov_b64 exec, 0xffff
  buffer_load_dwordx4 v11, s[52:55], s77 offen lds
  s_mov_b64 exec, -1
L_nolpf:
  s_barrier
  s_add_u32 m0, s75, 131072
  s_nop 0
  buffer_load_dwordx4 v4, s[44:47], s74 offen lds
  s_add_u32 m0, s75, 132096
  s_nop 0
  buffer_load_dwordx4 v5, s[44:47], s74 offen lds
  s_add_u32 s74, s74, 106496
  s_add_u32 m0, s75, 139264
  s_nop 0
  buffer_load_dwordx4 v4, s[44:47], s74 offen lds
  s_add_u32 m0, s75, 140288
  s_nop 0
  buffer_load_dwordx4 v5, s[44:47], s74 offen lds
  s_add_u32 s74, s74, 106496
  s_add_u32 m0, s76, 81920
  s_nop 0
  buffer_load_dwordx4 v56, s[32:35], 0 offen lds
  s_add_u32 m0, s76, 83968
  v_add_u32_dpp v56, v16, v2 row_newbcast:3 row_mask:0xf bank_mask:0x3
  buffer_load_dwordx4 v57, s[32:35], 0 offen lds
  s_nop 0
  v_add_u32_dpp v56, v18, v2 row_newbcast:9 row_mask:0xf bank_mask:0xc
  s_add_u32 m0, s76, 86016
  v_add_u32_dpp v57, v20, v2 row_newbcast:3 row_mask:0xf bank_mask:0x3
  buffer_load_dwordx4 v58, s[32:35], 0 offen lds
  s_nop 0
  v_add_u32_dpp v57, v22, v2 row_newbcast:9 row_mask:0xf bank_mask:0xc
  s_add_u32 m0, s76, 88064
  v_add_u32_dpp v58, v24, v2 row_newbcast:3 row_mask:0xf bank_mask:0x3
  buffer_load_dwordx4 v59, s[32:35], 0 offen lds
  s_nop 0
  v_add_u32_dpp v58, v26, v2 row_newbcast:9 row_mask:0xf bank_mask:0xc
  s_add_u32 m0, s76, 90112
  v_add_u32_dpp v59, v28, v2 row_newbcast:3 row_mask:0xf bank_mask:0x3
  buffer_load_dwordx4 v60, s[32:35], 0 offen lds
  s_nop 0
  v_add_u32_dpp v59, v30, v2 row_newbcast:9 row_mask:0xf bank_mask:0xc
  s_add_u32 m0, s76, 92160
  v_add_u32_dpp v60, v32, v2 row_newbcast:3 row_mask:0xf bank_mask:0x3
  buffer_load_dwordx4 v61, s[32:35], 0 offen lds
  s_nop 0
  v_add_u32_dpp v60, v34, v2 row_newbcast:9 row_mask:0xf bank_mask:0xc
  s_add_u32 m0, s76, 94208
  v_add_u32_dpp v61, v36, v2 row_newbcast:3 row_mask:0xf bank_mask:0x3
  buffer_load_dwordx4 v62, s[32:35], 0 offen lds
  s_nop 0
  v_add_u32_dpp v61, v38, v2 row_newbcast:9 row_mask:0xf bank_mask:0xc
  s_add_u32 m0, s76, 96256
  v_add_u32_dpp v62, v40, v2 row_newbcast:3 row_mask:0xf bank_mask:0x3
  buffer_load_dwordx4 v63, s[32:35], 0 offen lds
  s_nop 0
  v_add_u32_dpp v62, v42, v2 row_newbcast:9 row_mask:0xf bank_mask:0xc
  s_add_u32 m0, s76, 98304
  v_add_u32_dpp v63, v44, v2 row_newbcast:3 row_mask:0xf bank_mask:0x3
  buffer_load_dwordx4 v64, s[32:35], 0 offen lds
  s_nop 0
  v_add_u32_dpp v63, v46, v2 row_newbcast:9 row_mask:0xf bank_mask:0xc
  s_add_u32 m0, s76, 100352
  v_add_u32_dpp v64, v48, v2 row_newbcast:3 row_mask:0xf bank_mask:0x3
  buffer_load_dwordx4 v65, s[32:35], 0 offen lds
  s_nop 0
  v_add_u32_dpp v64, v50, v2 row_newbcast:9 row_mask:0xf bank_mask:0xc
  v_add_u32_dpp v65, v52, v2 row_newbcast:3 row_mask:0xf bank_mask:0x3
  s_nop 1
  v_add_u32_dpp v65, v54, v2 row_newbcast:9 row_mask:0xf bank_mask:0xc
  s_waitcnt vmcnt(10)
  s_barrier
  s_add_u32 m0, s75, 147456
  s_nop 0
  buffer_load_dwordx4 v4, s[44:47], s74 offen lds
  s_add_u32 m0, s75, 148480
  s_nop 0
  buffer_load_dwordx4 v5, s[44:47], s74 offen lds
  s_add_u32 s74, s74, 106496
  s_add_u32 m0, s75, 155648
  s_nop 0
  buffer_load_dwordx4 v4, s[44:47], s74 offen lds
  s_add_u32 m0, s75, 156672
  s_nop 0
  buffer_load_dwordx4 v5, s[44:47], s74 offen lds
  s_add_u32 s74, s74, 106496
  s_add_u32 m0, s76, 0
  s_nop 0
  buffer_load_dwordx4 v56, s[32:35], 0 offen lds
  s_add_u32 m0, s76, 2048
  v_add_u32_dpp v56, v17, v2 row_newbcast:3 row_mask:0xf bank_mask:0x3
  buffer_load_dwordx4 v57, s[32:35], 0 offen lds
  s_nop 0
  v_add_u32_dpp v56, v19, v2 row_newbcast:9 row_mask:0xf bank_mask:0xc
  s_add_u32 m0, s76, 4096
  v_add_u32_dpp v57, v21, v2 row_newbcast:3 row_mask:0xf bank_mask:0x3
  buffer_load_dwordx4 v58, s[32:35], 0 offen lds
  s_nop 0
  v_add_u32_dpp v57, v23, v2 row_newbcast:9 row_mask:0xf bank_mask:0xc
  s_add_u32 m0, s76, 6144
  v_add_u32_dpp v58, v25, v2 row_newbcast:3 row_mask:0xf bank_mask:0x3
  buffer_load_dwordx4 v59, s[32:35], 0 offen lds
  s_nop 0
  v_add_u32_dpp v58, v27, v2 row_newbcast:9 row_mask:0xf bank_mask:0xc
  s_add_u32 m0, s76, 8192
  v_add_u32_dpp v59, v29, v2 row_newbcast:3 row_mask:0xf bank_mask:0x3
  buffer_load_dwordx4 v60, s[32:35], 0 offen lds
  s_nop 0
  v_add_u32_dpp v59, v31, v2 row_newbcast:9 row_mask:0xf bank_mask:0xc
  s_add_u32 m0, s76, 10240
  v_add_u32_dpp v60, v33, v2 row_newbcast:3 row_mask:0xf bank_mask:0x3
  buffer_load_dwordx4 v61, s[32:35], 0 offen lds
  s_nop 0
  v_add_u32_dpp v60, v35, v2 row_newbcast:9 row_mask:0xf bank_mask:0xc
  s_add_u32 m0, s76, 12288
  v_add_u32_dpp v61, v37, v2 row_newbcast:3 row_mask:0xf bank_mask:0x3
  buffer_load_dwordx4 v62, s[32:35], 0 offen lds
  s_nop 0
  v_add_u32_dpp v61, v39, v2 row_newbcast:9 row_mask:0xf bank_mask:0xc
  s_add_u32 m0, s76, 14336
  v_add_u32_dpp v62, v41, v2 row_newbcast:3 row_mask:0xf bank_mask:0x3
  buffer_load_dwordx4 v63, s[32:35], 0 offen lds
  s_nop 0
  v_add_u32_dpp v62, v43, v2 row_newbcast:9 row_mask:0xf bank_mask:0xc
  s_add_u32 m0, s76, 16384
  v_add_u32_dpp v63, v45, v2 row_newbcast:3 row_mask:0xf bank_mask:0x3
  buffer_load_dwordx4 v64, s[32:35], 0 offen lds
  s_nop 0
  v_add_u32_dpp v63, v47, v2 row_newbcast:9 row_mask:0xf bank_mask:0xc
  s_add_u32 m0, s76, 18432
  v_add_u32_dpp v64, v49, v2 row_newbcast:3 row_mask:0xf bank_mask:0x3
  buffer_load_dwordx4 v65, s[32:35], 0 offen lds
  s_nop 0
  v_add_u32_dpp v64, v51, v2 row_newbcast:9 row_mask:0xf bank_mask:0xc
  v_add_u32_dpp v65, v53, v2 row_newbcast:3 row_mask:0xf bank_mask:0x3
  s_nop 1
  v_add_u32_dpp v65, v55, v2 row_newbcast:9 row_mask:0xf bank_mask:0xc
  s_waitcnt vmcnt(10)
  s_barrier
  s_add_u32 m0, s75, 131072
  s_nop 0
  buffer_load_dwordx4 v4, s[44:47], s74 offen lds
  s_add_u32 m0, s75, 132096
  s_nop 0
  buffer_load_dwordx4 v5, s[44:47], s74 offen lds
  s_add_u32 s74, s74, 106496
  s_add_u32 m0, s75, 139264
  s_nop 0
  buffer_load_dwordx4 v4, s[44:47], s74 offen lds
  s_add_u32 m0, s75, 140288
  s_nop 0
  buffer_load_dwordx4 v5, s[44:47], s74 offen lds
  s_add_u32 s74, s74, 106496
  s_add_u32 m0, s76, 40960
  s_nop 0
  buffer_load_dwordx4 v56, s[32:35], 0 offen lds
  s_add_u32 m0, s76, 43008
  v_add_u32_dpp v56, v18, v2 row_newbcast:3 row_mask:0xf bank_mask:0x3
  buffer_load_dwordx4 v57, s[32:35], 0 offen lds
  s_nop 0
  v_add_u32_dpp v56, v16, v2 row_newbcast:10 row_mask:0xf bank_mask:0xc
  s_add_u32 m0, s76, 45056
  v_add_u32_dpp v57, v22, v2 row_newbcast:3 row_mask:0xf bank_mask:0x3
  buffer_load_dwordx4 v58, s[32:35], 0 offen lds
  s_nop 0
  v_add_u32_dpp v57, v20, v2 row_newbcast:10 row_mask:0xf bank_mask:0xc
  s_add_u32 m0, s76, 47104
  v_add_u32_dpp v58, v26, v2 row_newbcast:3 row_mask:0xf bank_mask:0x3
  buffer_load_dwordx4 v59, s[32:35], 0 offen lds
  s_nop 0
  v_add_u32_dpp v58, v24, v2 row_newbcast:10 row_mask:0xf bank_mask:0xc
  s_add_u32 m0, s76, 49152
  v_add_u32_dpp v59, v30, v2 row_newbcast:3 row_mask:0xf bank_mask:0x3
  buffer_load_dwordx4 v60, s[32:35], 0 offen lds
  s_nop 0
  v_add_u32_dpp v59, v28, v2 row_newbcast:10 row_mask:0xf bank_mask:0xc
  s_add_u32 m0, s76, 51200
  v_add_u32_dpp v60, v34, v2 row_newbcast:3 row_mask:0xf bank_mask:0x3
  buffer_load_dwordx4 v61, s[32:35], 0 offen lds
  s_nop 0
  v_add_u32_dpp v60, v32, v2 row_newbcast:10 row_mask:0xf bank_mask:0xc
  s_add_u32 m0, s76, 53248
  v_add_u32_dpp v61, v38, v2 row_newbcast:3 row_mask:0xf bank_mask:0x3
  buffer_load_dwordx4 v62, s[32:35], 0 offen lds
  s_nop 0
  v_add_u32_dpp v61, v36, v2 row_newbcast:10 row_mask:0xf bank_mask:0xc
  s_add_u32 m0, s76, 55296
  v_add_u32_dpp v62, v42, v2 row_newbcast:3 row_mask:0xf bank_mask:0x3
  buffer_load_dwordx4 v63, s[32:35], 0 offen lds
  s_nop 0
  v_add_u32_dpp v62, v40, v2 row_newbcast:10 row_mask:0xf bank_mask:0xc
  s_add_u32 m0, s76, 57344
  v_add_u32_dpp v63, v46, v2 row_newbcast:3 row_mask:0xf bank_mask:0x3
  buffer_load_dwordx4 v64, s[32:35], 0 offen lds
  s_nop 0
  v_add_u32_dpp v63, v44, v2 row_newbcast:10 row_mask:0xf bank_mask:0xc
  s_add_u32 m0, s76, 59392
  v_add_u32_dpp v64, v50, v2 row_newbcast:3 row_mask:0xf bank_mask:0x3
  buffer_load_dwordx4 v65, s[32:35], 0 offen lds
  s_nop 0
  v_add_u32_dpp v64, v48, v2 row_newbcast:10 row_mask:0xf bank_mask:0xc
  v_add_u32_dpp v65, v54, v2 row_newbcast:3 row_mask:0xf bank_mask:0x3
  s_nop 1
  v_add_u32_dpp v65, v52, v2 row_newbcast:10 row_mask:0xf bank_mask:0xc
  v_mov_b32_dpp v16, v16 row_shl:3 row_mask:0xf bank_mask:0xf
  v_mov_b32_dpp v18, v18 row_shl:3 row_mask:0xf bank_mask:0xf
  v_mov_b32_dpp v20, v20 row_shl:3 row_mask:0xf bank_mask:0xf
  v_mov_b32_dpp v22, v22 row_shl:3 row_mask:0xf bank_mask:0xf
  v_mov_b32_dpp v24, v24 row_shl:3 row_mask:0xf bank_mask:0xf
  v_mov_b32_dpp v26, v26 row_shl:3 row_mask:0xf bank_mask:0xf
  v_mov_b32_dpp v28, v28 row_shl:3 row_mask:0xf bank_mask:0xf
  v_mov_b32_dpp v30, v30 row_shl:3 row_mask:0xf bank_mask:0xf
  v_mov_b32_dpp v32, v32 row_shl:3 row_mask:0xf bank_mask:0xf
  v_mov_b32_dpp v34, v34 row_shl:3 row_mask:0xf bank_mask:0xf
  v_mov_b32_dpp v36, v36 row_shl:3 row_mask:0xf bank_mask:0xf
  v_mov_b32_dpp v38, v38 row_shl:3 row_mask:0xf bank_mask:0xf
  v_mov_b32_dpp v40, v40 row_shl:3 row_mask:0xf bank_mask:0xf
  v_mov_b32_dpp v42, v42 row_shl:3 row_mask:0xf bank_mask:0xf
  v_mov_b32_dpp v44, v44 row_shl:3 row_mask:0xf bank_mask:0xf
  v_mov_b32_dpp v46, v46 row_shl:3 row_mask:0xf bank_mask:0xf
  v_mov_b32_dpp v48, v48 row_shl:3 row_mask:0xf bank_mask:0xf
  v_mov_b32_dpp v50, v50 row_shl:3 row_mask:0xf bank_mask:0xf
  v_mov_b32_dpp v52, v52 row_shl:3 row_mask:0xf bank_mask:0xf
  v_mov_b32_dpp v54, v54 row_shl:3 row_mask:0xf bank_mask:0xf
  s_waitcnt vmcnt(10)
  s_barrier
  s_add_u32 m0, s75, 147456
  s_nop 0
  buffer_load_dwordx4 v4, s[44:47], s74 offen lds
  s_add_u32 m0, s75, 148480
  s_nop 0
  buffer_load_dwordx4 v5, s[44:47], s74 offen lds
  s_add_u32 s74, s74, 106496
  s_add_u32 m0, s75, 155648
  s_nop 0
  buffer_load_dwordx4 v4, s[44:47], s74 offen lds
  s_add_u32 m0, s75, 156672
  s_nop 0
  buffer_load_dwordx4 v5, s[44:47], s74 offen lds
  s_add_u32 s74, s74, 106496
  s_add_u32 m0, s76, 81920
  s_nop 0
  buffer_load_dwordx4 v56, s[32:35], 0 offen lds
  s_add_u32 m0, s76, 83968
  v_add_u32_dpp v56, v19, v2 row_newbcast:3 row_mask:0xf bank_mask:0x3
  buffer_load_dwordx4 v57, s[32:35], 0 offen lds
  s_nop 0
  v_add_u32_dpp v56, v17, v2 row_newbcast:10 row_mask:0xf bank_mask:0xc
  s_add_u32 m0, s76, 86016
  v_add_u32_dpp v57, v23, v2 row_newbcast:3 row_mask:0xf bank_mask:0x3
  buffer_load_dwordx4 v58, s[32:35], 0 offen lds
  s_nop 0
  v_add_u32_dpp v57, v21, v2 row_newbcast:10 row_mask:0xf bank_mask:0xc
  s_add_u32 m0, s76, 88064
  v_add_u32_dpp v58, v27, v2 row_newbcast:3 row_mask:0xf bank_mask:0x3
  buffer_load_dwordx4 v59, s[32:35], 0 offen lds
  s_nop 0
  v_add_u32_dpp v58, v25, v2 row_newbcast:10 row_mask:0xf bank_mask:0xc
  s_add_u32 m0, s76, 90112
  v_add_u32_dpp v59, v31, v2 row_newbcast:3 row_mask:0xf bank_mask:0x3
  buffer_load_dwordx4 v60, s[32:35], 0 offen lds
  s_nop 0
  v_add_u32_dpp v59, v29, v2 row_newbcast:10 row_mask:0xf bank_mask:0xc
  s_add_u32 m0, s76, 92160
  v_add_u32_dpp v60, v35, v2 row_newbcast:3 row_mask:0xf bank_mask:0x3
  buffer_load_dwordx4 v61, s[32:35], 0 offen lds
  s_nop 0
  v_add_u32_dpp v60, v33, v2 row_newbcast:10 row_mask:0xf bank_mask:0xc
  s_add_u32 m0, s76, 94208
  v_add_u32_dpp v61, v39, v2 row_newbcast:3 row_mask:0xf bank_mask:0x3
  buffer_load_dwordx4 v62, s[32:35], 0 offen lds
  s_nop 0
  v_add_u32_dpp v61, v37, v2 row_newbcast:10 row_mask:0xf bank_mask:0xc
  s_add_u32 m0, s76, 96256
  v_add_u32_dpp v62, v43, v2 row_newbcast:3 row_mask:0xf bank_mask:0x3
  buffer_load_dwordx4 v63, s[32:35], 0 offen lds
  s_nop 0
  v_add_u32_dpp v62, v41, v2 row_newbcast:10 row_mask:0xf bank_mask:0xc
  s_add_u32 m0, s76, 98304
  v_add_u32_dpp v63, v47, v2 row_newbcast:3 row_mask:0xf bank_mask:0x3
  buffer_load_dwordx4 v64, s[32:35], 0 offen lds
  s_nop 0
  v_add_u32_dpp v63, v45, v2 row_newbcast:10 row_mask:0xf bank_mask:0xc
  s_add_u32 m0, s76, 100352
  v_add_u32_dpp v64, v51, v2 row_newbcast:3 row_mask:0xf bank_mask:0x3
  buffer_load_dwordx4 v65, s[32:35], 0 offen lds
  s_nop 0
  v_add_u32_dpp v64, v49, v2 row_newbcast:10 row_mask:0xf bank_mask:0xc
  v_add_u32_dpp v65, v55, v2 row_newbcast:3 row_mask:0xf bank_mask:0x3
  s_nop 1
  v_add_u32_dpp v65, v53, v2 row_newbcast:10 row_mask:0xf bank_mask:0xc
  v_mov_b32_dpp v17, v17 row_shl:3 row_mask:0xf bank_mask:0xf
  v_mov_b32_dpp v19, v19 row_shl:3 row_mask:0xf bank_mask:0xf
  v_mov_b32_dpp v21, v21 row_shl:3 row_mask:0xf bank_mask:0xf
  v_mov_b32_dpp v23, v23 row_shl:3 row_mask:0xf bank_mask:0xf
  v_mov_b32_dpp v25, v25 row_shl:3 row_mask:0xf bank_mask:0xf
  v_mov_b32_dpp v27, v27 row_shl:3 row_mask:0xf bank_mask:0xf
  v_mov_b32_dpp v29, v29 row_shl:3 row_mask:0xf bank_mask:0xf
  v_mov_b32_dpp v31, v31 row_shl:3 row_mask:0xf bank_mask:0xf
  v_mov_b32_dpp v33, v33 row_shl:3 row_mask:0xf bank_mask:0xf
  v_mov_b32_dpp v35, v35 row_shl:3 row_mask:0xf bank_mask:0xf
  v_mov_b32_dpp v37, v37 row_shl:3 row_mask:0xf bank_mask:0xf
  v_mov_b32_dpp v39, v39 row_shl:3 row_mask:0xf bank_mask:0xf
  v_mov_b32_dpp v41, v41 row_shl:3 row_mask:0xf bank_mask:0xf
  v_mov_b32_dpp v43, v43 row_shl:3 row_mask:0xf bank_mask:0xf
  v_mov_b32_dpp v45, v45 row_shl:3 row_mask:0xf bank_mask:0xf
  v_mov_b32_dpp v47, v47 row_shl:3 row_mask:0xf bank_mask:0xf
  v_mov_b32_dpp v49, v49 row_shl:3 row_mask:0xf bank_mask:0xf
  v_mov_b32_dpp v51, v51 row_shl:3 row_mask:0xf bank_mask:0xf
  v_mov_b32_dpp v53, v53 row_shl:3 row_mask:0xf bank_mask:0xf
  v_mov_b32_dpp v55, v55 row_shl:3 row_mask:0xf bank_mask:0xf
  s_add_u32 s72, s72, 1
  s_cmp_lt_u32 s72, 2
  s_waitcnt vmcnt(10)
  s_cbranch_scc1 L_dnn_loop1
  s_branch L_ld_tail
L_cin:
  v_lshlrev_b32 v1, 4, v0
  s_and_b32 s79, s3, 3
  s_lshr_b32 s84, s3, 2
  s_lshl_b32 s95, s79, 10
  s_mul_i32 s26, s68, 11
  s_add_u32 s26, s26, s69
  s_sub_u32 s26, s26, 22
  s_cmp_eq_u32 s26, 86
  s_cbranch_scc1 L_end
  s_cmp_eq_u32 s84, 0
  s_cbranch_scc1 L_sc
  s_setprio 2
  v_add_u32 v2, L_tables-L_pc+4096, v1
  v_mov_b32_e64 v3, s93
  v_add_co_u32 v2, vcc, s92, v2
  s_nop 1
  v_addc_co_u32 v3, vcc, 0, v3, vcc
  v_add_co_u32 v32, vcc, s95, v2
  s_nop 1
  v_addc_co_u32 v33, vcc, 0, v3, vcc
  global_load_dwordx4 v[224:227], v[2:3], off offset:-4096
  v_add_co_u32 v2, vcc, 0x1800, v2
  s_nop 1
  v_addc_co_u32 v3, vcc, 0, v3, vcc
  global_load_dwordx4 v[240:243], v[2:3], off
  s_cmp_lt_u32 s79, 3
  s_mov_b32 s70, 122176
  s_cselect_b32 s70, 81920, s70
  s_add_u32 m0, s95, 81920
  s_nop 0
  global_load_lds_dwordx4 v[32:33], off offset:-4096
  s_add_u32 m0, s95, s70
  s_nop 0
  global_load_lds_dwordx4 v[32:33], off offset:0
  v_add_co_u32 v32, vcc, 0x2000, v32
  s_nop 1
  v_addc_co_u32 v33, vcc, 0, v33, vcc
  s_add_u32 m0, s95, 2048
  s_nop 0
  global_load_lds_dwordx4 v[32:33], off offset:0
  s_add_u32 m0, s95, 130368
  s_cmp_ge_u32 s79, 2
  s_cbranch_scc1 L_sc
  global_load_lds_dwordx4 v[32:33], off offset:-4096
L_sc:
  s_mul_i32 s85, s84, 20
  s_add_u32 s85, s85, s3
  s_mul_i32 s94, s26, 48
  s_add_u32 s94, s94, s85
  s_mul_i32 s94, s94, 104
  v_lshrrev_b32 v30, 3, v0
  v_lshlrev_b32_e64 v30, 4, v30
  v_and_b32 v29, 0x70, v1
  s_mul_i32 s76, s3, 4064
  s_add_u32 s76, s76, 131136
  s_cmp_eq_u32 s84, 0
  s_cbranch_scc1 L_g0
  s_waitcnt lgkmcnt(0)
  s_mov_b32 s40, s10
  s_and_b32 s41, s11, 0xffff
  s_mov_b32 s42, 156
  s_mov_b32 s43, 0x20000
  s_mov_b32 m0, 129472
  s_mov_b64 exec, 0x7ff
  buffer_load_dwordx4 v1, s[40:43], 0 offen lds
  s_mov_b64 exec, -1
  s_lshl_b32 s85, s85, 2
  s_add_u32 s85, s85, 129728
  s_mul_i32 s72, s84, 3
  s_sub_u32 s72, 4, s72
  s_cmp_eq_u32 s26, 85
  s_cselect_b32 s72, s72, 6
  s_lshl_b32 s44, s3, 7
  s_mul_i32 s45, s3, 5280
  s_lshl_b32 s46, s3, 2
  s_lshl_b32 s47, s3, 1
  s_lshl_b32 s82, s3, 12
  s_and_b32 s98, s3, 1
  s_lshr_b32 s99, s3, 1
  s_mul_i32 s68, s99, 3072
  s_lshl_b32 s83, s98, 3
  s_add_u32 s68, s68, s83
  v_add_u32 v59, s68, v1
  s_lshl_b32 s69, s99, 3
  s_lshr_b32 s69, 0x05030200, s69
  s_and_b32 s69, s69, 0xff
  s_lshl_b32 s69, s69, 9
  s_lshl_b32 s70, s98, 2
  s_add_u32 s101, s69, s70
  s_mov_b32 s99, 0x05040100
  s_mov_b32 s100, 0x07060302
  v_mov_b32 v2, 129664
  v_mov_b32 v109, 0
  v_mov_b32 v108, 0
  v_mov_b64 v[32:33], 0
  v_mov_b64 v[34:35], 0
  v_mov_b64 v[36:37], 0
  v_mov_b64 v[38:39], 0
  v_mov_b64 v[40:41], 0
  v_mov_b64 v[42:43], 0
  v_mov_b64 v[44:45], 0
  v_mov_b64 v[46:47], 0
  v_mov_b64 v[48:49], 0
  v_mov_b64 v[50:51], 0
  v_mov_b64 v[52:53], 0
  v_mov_b64 v[54:55], 0
  v_mov_b64 v[56:57], 0
  v_add_u32 v14, 77824, v1
  v_add_u32 v15, 125248, v1
  v_lshrrev_b32_e64 v3, 5, v0
  v_lshl_add_u32 v3, v3, 2, v2
  s_mov_b32 s28, s4
  s_and_b32 s29, s5, 0xffff
  s_mov_b32 s30, 425984
  s_mov_b32 s31, 0x20000
  s_mov_b32 s32, s6
  s_and_b32 s33, s7, 0xffff
  s_mov_b32 s34, 12800000
  s_mov_b32 s35, 0x20000
  ds_write_b128 v2, v[32:35] offset:16
  s_lshl_b32 s68, s79, 6
  v_add_u32 v29, s68, v0
  v_mul_u32_u24 v30, 2521, v29
  v_lshrrev_b32 v30, 16, v30
  v_mul_u32_u24 v30, 12, v30
  v_lshl_add_u32 v28, v29, 1, v30
  v_add_u32 v29, 256, v29
  v_mul_u32_u24 v30, 2521, v29
  v_lshrrev_b32 v30, 16, v30
  v_mul_u32_u24_e64 v30, 12, v30
  v_lshl_add_u32 v58, v29, 1, v30
  v_add_u32 v29, 256, v29
  v_mul_u32_u24 v30, 2521, v29
  v_lshrrev_b32 v30, 16, v30
  v_mul_u32_u24 v30, 12, v30
  v_lshl_add_u32 v111, v29, 1, v30
  v_cmp_gt_u32 vcc, 676, v29
  s_nop 0
  s_mov_b64 s[92:93], vcc
  v_lshlrev_b32_e64 v29, 3, v0
  s_mov_b32 exec_hi, 0xffff
  ds_write_b64 v29, v[32:33] offset:1664
  s_mov_b32 exec_hi, -1
  s_waitcnt vmcnt(4)
  ds_write_b32 v243, v32
  ds_write_b32 v243, v32 offset:43328
  s_waitcnt vmcnt(0)
  ds_read_b64 v[112:113], v240 offset:0
  ds_read_b64 v[114:115], v240 offset:8
  ds_read_b64 v[116:117], v240 offset:32
  ds_read_b64 v[118:119], v240 offset:40
  ds_read_u16 v110, v241
  s_mov_b64 exec, 0x3ffffff
  s_waitcnt lgkmcnt(0)
  ds_write_b16 v242, v110
  v_lshlrev_b32 v109, 17, v110
  v_lshrrev_b32 v109, 1, v109
  s_mov_b64 exec, -1
  v_add_u32 v225, s44, v225
  v_add_u32 v226, s44, v226
  v_add_u32 v227, s44, v227
  s_waitcnt lgkmcnt(0)
  s_barrier
  ds_read_b64_tr_b16 v[60:61], v225 offset:35328
  ds_read_b64_tr_b16 v[62:63], v225 offset:40736
  ds_read_b64_tr_b16 v[64:65], v226 offset:35328
  ds_read_b64_tr_b16 v[66:67], v227 offset:35328
  ds_read_b64_tr_b16 v[68:69], v225 offset:35392
  ds_read_b64_tr_b16 v[70:71], v225 offset:40800
  ds_read_b64_tr_b16 v[72:73], v226 offset:35392
  ds_read_b64_tr_b16 v[74:75], v227 offset:35392
  ds_read_b64_tr_b16 v[76:77], v225 offset:35840
  ds_read_b64_tr_b16 v[78:79], v225 offset:41248
  ds_read_b64_tr_b16 v[80:81], v226 offset:35840
  ds_read_b64_tr_b16 v[82:83], v227 offset:35840
  ds_read_b64_tr_b16 v[84:85], v225 offset:35904
  ds_read_b64_tr_b16 v[86:87], v225 offset:41312
  ds_read_b64_tr_b16 v[88:89], v226 offset:35904
  ds_read_b64_tr_b16 v[90:91], v227 offset:35904
  s_waitcnt lgkmcnt(14)
  v_mfma_f32_32x32x16_bf16 v[120:135], v[112:115], v[60:63], 0
  s_waitcnt lgkmcnt(12)
  v_mfma_f32_32x32x16_bf16 v[120:135], v[116:119], v[64:67], v[120:135]
  ds_read_b64_tr_b16 v[92:93], v225 offset:36352
  ds_read_b64_tr_b16 v[94:95], v225 offset:41760
  ds_read_b64_tr_b16 v[96:97], v226 offset:36352
  ds_read_b64_tr_b16 v[98:99], v227 offset:36352
  s_waitcnt lgkmcnt(14)
  v_mfma_f32_32x32x16_bf16 v[136:151], v[112:115], v[68:71], 0
  s_waitcnt lgkmcnt(12)
  v_mfma_f32_32x32x16_bf16 v[136:151], v[116:119], v[72:75], v[136:151]
  ds_read_b64_tr_b16 v[100:101], v225 offset:36416
  ds_read_b64_tr_b16 v[102:103], v225 offset:41824
  ds_read_b64_tr_b16 v[104:105], v226 offset:36416
  ds_read_b64_tr_b16 v[106:107], v227 offset:36416
  s_waitcnt lgkmcnt(14)
  v_mfma_f32_32x32x16_bf16 v[152:167], v[112:115], v[76:79], 0
  s_waitcnt lgkmcnt(12)
  v_mfma_f32_32x32x16_bf16 v[152:167], v[116:119], v[80:83], v[152:167]
  s_waitcnt lgkmcnt(10)
  v_mfma_f32_32x32x16_bf16 v[168:183], v[112:115], v[84:87], 0
  s_waitcnt lgkmcnt(8)
  v_mfma_f32_32x32x16_bf16 v[168:183], v[116:119], v[88:91], v[168:183]
  ds_read_b128 v[228:231], v14 offset:6144
  ds_read_b128 v[232:235], v15 offset:0
  ds_read_b128 v[4:7], v14 offset:3072
  ds_read_b128 v[8:11], v15 offset:2048
  ds_read_b128 v[20:23], v14 offset:1024
  ds_read_b128 v[24:27], v14 offset:2048
  ds_read_b128 v[216:219], v14 offset:4096
  ds_read_b128 v[220:223], v14 offset:5120
  ds_read_b128 v[236:239], v15 offset:1024
  s_waitcnt lgkmcnt(14)
  v_mfma_f32_32x32x16_bf16 v[184:199], v[112:115], v[92:95], 0
  s_waitcnt lgkmcnt(13)
  v_mfma_f32_32x32x16_bf16 v[184:199], v[116:119], v[96:99], v[184:199]
  s_waitcnt lgkmcnt(11)
  v_mfma_f32_32x32x16_bf16 v[200:215], v[112:115], v[100:103], 0
  s_waitcnt lgkmcnt(9)
  v_mfma_f32_32x32x16_bf16 v[200:215], v[116:119], v[104:107], v[200:215]
  s_waitcnt lgkmcnt(8)
  v_add_u32 v228, s46, v228
  v_add_u32 v229, s46, v229
  v_add_u32 v231, s83, v231
  v_add_u32 v230, s101, v230
  s_waitcnt lgkmcnt(7)
  v_mad_u32_u24 v232, v233, s3, v232
  v_add_u32_e64 v234, s47, v234
  v_mad_u32_u24 v233, v233, 8, v232
  v_add_u32 v246, s82, v235
  v_add_u32 v247, 2048, v246
  v_add_u32 v31, 0, v234
  v_and_b32 v31, 3, v31
  v_lshl_add_u32 v244, v31, 4, v232
  v_add_u32 v31, 1, v234
  v_and_b32 v31, 3, v31
  v_lshl_add_u32 v245, v31, 4, v232
  v_add_u32 v245, 1664, v245
  v_add_u32 v31, 0, v234
  v_and_b32 v31, 3, v31
  v_lshl_add_u32 v248, v31, 4, v233
  v_add_u32 v31, 1, v234
  v_and_b32 v31, 3, v31
  v_lshl_add_u32 v249, v31, 4, v233
  v_add_u32 v249, 1664, v249
  s_waitcnt lgkmcnt(5)
  v_add_u32 v10, s76, v10
  v_add_u32 v4, s76, v4
  v_add_u32 v5, s76, v5
  ds_write_b32 v10, v7 offset:2880
  v_add_u32 v11, s45, v11
  s_waitcnt lgkmcnt(5)
  v_add_u32 v20, s45, v20
  v_add_u32 v21, s45, v21
  v_add_u32 v22, s45, v22
  v_add_u32 v23, s45, v23
  s_waitcnt lgkmcnt(4)
  v_add_u32 v24, s45, v24
  v_add_u32 v25, s45, v25
  v_add_u32 v26, s45, v26
  v_add_u32 v27, s45, v27
  s_mov_b32 exec_lo, 0
  v_mov_b32_e64 v120, v136
  s_mov_b32 exec_lo, -1
  v_cvt_pk_bf16_f32 v60, 0, v120
  ds_write_b16_d16_hi v28, v60
  v_max_f32 v108, |v60|, v108
  s_mov_b32 exec_lo, 0
  v_mov_b32 v152, v168
  s_mov_b32 exec_lo, -1
  v_cvt_pk_bf16_f32 v61, 0, v152
  ds_write_b16_d16_hi v58, v61
  v_max_f32 v108, |v61|, v108
  s_mov_b32 exec_lo, 0
  v_mov_b32 v184, v200
  s_mov_b32 exec_lo, -1
  v_cvt_pk_bf16_f32 v62, 0, v184
  s_mov_b64 exec, s[92:93]
  ds_write_b16_d16_hi v111, v62
  v_max_f32 v108, |v62|, v108
  s_mov_b64 exec, -1
  s_nop 0
  v_permlane32_swap_b32 v108, v109
  v_max_u32_e64 v108, v108, v109
  s_nop 1
  v_max_u32_dpp v108, v108, v108 row_shr:1 row_mask:0xf bank_mask:0xf
  s_nop 1
  v_max_u32_dpp v108, v108, v108 row_shr:2 row_mask:0xf bank_mask:0xf
  s_nop 1
  v_max_u32_dpp v108, v108, v108 row_shr:4 row_mask:0xf bank_mask:0xf
  s_nop 1
  v_max_u32_dpp v108, v108, v108 row_shr:8 row_mask:0xf bank_mask:0xf
  s_nop 1
  v_max_u32_dpp v108, v108, v108 row_bcast:15 row_mask:0xa bank_mask:0xf
  s_mov_b32 exec_lo, 0x80000000
  s_mov_b32 exec_hi, 0x80000000
  ds_max_u32 v3, v108 offset:24
  s_mov_b64 exec, -1
  s_setprio 0
  s_barrier
  s_branch L_w2
L_g0:
  s_waitcnt lgkmcnt(0)
  s_mov_b32 s36, s8
  s_and_b32 s37, s9, 0xffff
  s_mov_b32 s38, 105456
  s_mov_b32 s39, 0x20000
  s_add_u32 m0, s95, 41984
  s_add_u32 s81, s95, 70304
  buffer_load_dwordx4 v1, s[36:39], s81 offen lds
  s_add_u32 m0, s95, 46080
  s_add_u32 s81, s95, 74400
  buffer_load_dwordx4 v1, s[36:39], s81 offen lds
  s_add_u32 m0, s95, 50176
  s_add_u32 s81, s95, 78496
  buffer_load_dwordx4 v1, s[36:39], s81 offen lds
  s_add_u32 m0, s95, 54272
  s_add_u32 s81, s95, 82592
  buffer_load_dwordx4 v1, s[36:39], s81 offen lds
  s_add_u32 m0, s95, 58368
  s_add_u32 s81, s95, 86688
  buffer_load_dwordx4 v1, s[36:39], s81 offen lds
  s_add_u32 m0, s95, 62464
  s_add_u32 s81, s95, 90784
  buffer_load_dwordx4 v1, s[36:39], s81 offen lds
  s_add_u32 m0, s95, 66560
  s_add_u32 s81, s95, 94880
  buffer_load_dwordx4 v1, s[36:39], s81 offen lds
  s_add_u32 m0, s95, 70656
  s_add_u32 s81, s95, 98976
  buffer_load_dwordx4 v1, s[36:39], s81 offen lds
  s_cmp_eq_u32 s79, 3
  s_cbranch_scc1 L_st3
  s_add_u32 m0, s95, 74752
  s_add_u32 s81, s95, 103072
  buffer_load_dwordx4 v1, s[36:39], s81 offen lds
L_st3:
  s_mov_b32 s28, s4
  s_and_b32 s29, s5, 0xffff
  s_mov_b32 s30, 425984
  s_mov_b32 s31, 0x20000
  buffer_load_dwordx4 v[16:19], v30, s[28:31], s94 offen
  s_add_u32 s94, s94, 416
  buffer_load_dwordx4 v[104:107], v30, s[28:31], s94 offen
  s_add_u32 s94, s94, 416
  s_mov_b32 s32, s6
  s_and_b32 s33, s7, 0xffff
  s_mov_b32 s34, 12800000
  s_mov_b32 s35, 0x20000
  s_mul_i32 s96, s79, 3072
  s_mul_i32 s97, s79, 2704
  v_lshrrev_b32 v31, 5, v0
  v_mul_u32_u24 v31, 184, v31
  v_sub_u32 v31, v1, v31
  s_add_u32 m0, s96, 85312
  s_add_u32 s81, s97, 35152
  buffer_load_dwordx4 v1, s[36:39], s81 offen lds
  s_lshl_b32 s85, s85, 2
  s_add_u32 s85, s85, 129728
  s_mul_i32 s72, s84, 3
  s_sub_u32 s72, 4, s72
  s_cmp_eq_u32 s26, 85
  s_cselect_b32 s72, s72, 6
  s_add_u32 m0, s96, 86336
  s_add_u32 s81, s97, 36176
  buffer_load_dwordx4 v31, s[36:39], s81 offen lds
  s_lshl_b32 s44, s3, 7
  s_mul_i32 s45, s3, 5280
  s_lshl_b32 s46, s3, 2
  s_lshl_b32 s47, s3, 1
  s_lshl_b32 s82, s3, 12
  s_add_u32 m0, s96, 87360
  s_add_u32 s81, s97, 37016
  buffer_load_dwordx4 v1, s[36:39], s81 offen lds
  s_and_b32 s98, s3, 1
  s_lshr_b32 s99, s3, 1
  s_mul_i32 s68, s99, 3072
  s_lshl_b32 s83, s98, 3
  s_add_u32 s68, s68, s83
  s_add_u32 m0, s96, 97600
  s_add_u32 s81, s97, 45968
  buffer_load_dwordx4 v1, s[36:39], s81 offen lds
  v_add_u32 v59, s68, v1
  s_lshl_b32 s69, s99, 3
  s_lshr_b32 s69, 0x05030200, s69
  s_and_b32 s69, s69, 0xff
  s_lshl_b32 s69, s69, 9
  s_add_u32 m0, s96, 98624
  s_add_u32 s81, s97, 46992
  buffer_load_dwordx4 v31, s[36:39], s81 offen lds
  s_lshl_b32 s70, s98, 2
  s_add_u32 s101, s69, s70
  s_mov_b32 s99, 0x05040100
  s_mov_b32 s100, 0x07060302
  v_mov_b32 v2, 129664
  s_add_u32 m0, s96, 99648
  s_add_u32 s81, s97, 47832
  buffer_load_dwordx4 v1, s[36:39], s81 offen lds
  v_mov_b32 v109, 0
  v_mov_b32_e64 v108, 0
  v_mov_b64 v[32:33], 0
  v_mov_b64 v[34:35], 0
  v_mov_b64 v[36:37], 0
  s_add_u32 m0, s96, 109888
  s_add_u32 s81, s97, 56784
  buffer_load_dwordx4 v1, s[36:39], s81 offen lds
  v_mov_b64 v[38:39], 0
  v_mov_b64 v[40:41], 0
  v_mov_b64 v[42:43], 0
  v_mov_b64 v[44:45], 0
  v_mov_b64 v[46:47], 0
  s_add_u32 m0, s96, 110912
  s_add_u32 s81, s97, 57808
  buffer_load_dwordx4 v31, s[36:39], s81 offen lds
  v_mov_b64 v[48:49], 0
  v_mov_b64 v[50:51], 0
  v_mov_b64 v[52:53], 0
  v_mov_b64 v[54:55], 0
  v_mov_b64 v[56:57], 0
  s_add_u32 m0, s96, 111936
  s_add_u32 s81, s97, 58648
  buffer_load_dwordx4 v1, s[36:39], s81 offen lds
  v_add_u32 v14, 77824, v1
  v_add_u32 v15, 125248, v1
  v_lshrrev_b32_e64 v3, 5, v0
  v_lshl_add_u32 v3, v3, 2, v2
  s_cmp_lg_u32 s79, 0
  s_cbranch_scc1 L_st2
  s_add_u32 m0, s96, 122176
  s_add_u32 s81, s97, 67600
  buffer_load_dwordx4 v1, s[36:39], s81 offen lds
  s_add_u32 m0, s96, 123200
  s_add_u32 s81, s97, 68624
  buffer_load_dwordx4 v31, s[36:39], s81 offen lds
  s_add_u32 m0, s96, 124224
  s_add_u32 s81, s97, 69464
  buffer_load_dwordx4 v1, s[36:39], s81 offen lds
L_st2:
  s_add_u32 m0, s95, 6144
  s_add_u32 s81, s95, 0
  buffer_load_dwordx4 v1, s[36:39], s81 offen lds
  s_add_u32 m0, s95, 10240
  s_add_u32 s81, s95, 4096
  buffer_load_dwordx4 v1, s[36:39], s81 offen lds
  s_add_u32 m0, s95, 14336
  s_add_u32 s81, s95, 8192
  buffer_load_dwordx4 v1, s[36:39], s81 offen lds
  s_add_u32 m0, s95, 18432
  s_add_u32 s81, s95, 12288
  buffer_load_dwordx4 v1, s[36:39], s81 offen lds
  s_waitcnt vmcnt(15)
  s_barrier
  ds_read_b128 v[224:227], v14 offset:0
  ds_read_b128 v[228:231], v14 offset:6144
  ds_read_b128 v[232:235], v15 offset:0
  ds_read_b128 v[4:7], v14 offset:3072
  ds_read_b128 v[8:11], v15 offset:2048
  ds_read_b128 v[20:23], v14 offset:1024
  ds_read_b128 v[24:27], v14 offset:2048
  ds_read_b128 v[216:219], v14 offset:4096
  ds_read_b128 v[220:223], v14 offset:5120
  ds_read_b128 v[236:239], v15 offset:1024
  s_add_u32 m0, s95, 22528
  s_add_u32 s81, s95, 16384
  buffer_load_dwordx4 v1, s[36:39], s81 offen lds
  s_add_u32 m0, s95, 26624
  s_add_u32 s81, s95, 20480
  buffer_load_dwordx4 v1, s[36:39], s81 offen lds
  s_add_u32 m0, s95, 30720
  s_add_u32 s81, s95, 24576
  buffer_load_dwordx4 v1, s[36:39], s81 offen lds
  s_add_u32 m0, s95, 34816
  s_add_u32 s81, s95, 28672
  buffer_load_dwordx4 v1, s[36:39], s81 offen lds
  s_cmp_eq_u32 s79, 3
  s_cbranch_scc1 L_st1
  s_add_u32 m0, s95, 38912
  s_add_u32 s81, s95, 32768
  buffer_load_dwordx4 v1, s[36:39], s81 offen lds
L_st1:
  s_waitcnt vmcnt(18)
  v_lshl_add_u32 v16, v16, 7, v29
  v_lshl_add_u32 v17, v17, 7, v29
  v_lshl_add_u32 v18, v18, 7, v29
  v_lshl_add_u32 v19, v19, 7, v29
  s_add_u32 m0, s76, 0
  s_mov_b32 exec_hi, 0xffffff
  buffer_load_dwordx4 v16, s[32:35], 0 offen lds
  s_add_u32 m0, s76, 1056
  s_nop 0
  buffer_load_dwordx4 v17, s[32:35], 0 offen lds
  s_add_u32 m0, s76, 2112
  s_mov_b32 exec_hi, 0xffff
  buffer_load_dwordx4 v18, s[32:35], 0 offen lds
  s_add_u32 m0, s76, 3168
  s_nop 0
  buffer_load_dwordx4 v19, s[32:35], 0 offen lds
  s_mov_b32 exec_hi, -1
  s_waitcnt vmcnt(21)
  v_lshl_add_u32 v104, v104, 7, v29
  v_lshl_add_u32 v105, v105, 7, v29
  v_lshl_add_u32 v106, v106, 7, v29
  v_lshl_add_u32 v107, v107, 7, v29
  s_add_u32 m0, s76, 16256
  s_mov_b32 exec_hi, 0xffffff
  buffer_load_dwordx4 v104, s[32:35], 0 offen lds
  s_add_u32 m0, s76, 17312
  s_nop 0
  buffer_load_dwordx4 v105, s[32:35], 0 offen lds
  s_add_u32 m0, s76, 18368
  s_mov_b32 exec_hi, 0xffff
  buffer_load_dwordx4 v106, s[32:35], 0 offen lds
  s_add_u32 m0, s76, 19424
  s_nop 0
  buffer_load_dwordx4 v107, s[32:35], 0 offen lds
  s_mov_b32 exec_hi, -1
  s_waitcnt lgkmcnt(9)
  v_add_u32 v225, s44, v225
  v_add_u32 v226, s44, v226
  v_add_u32 v227, s44, v227
  s_waitcnt lgkmcnt(8)
  v_add_u32 v228, s46, v228
  v_add_u32 v229, s46, v229
  v_add_u32 v231, s83, v231
  v_add_u32 v230, s101, v230
  s_waitcnt lgkmcnt(7)
  v_mad_u32_u24 v232, v233, s3, v232
  v_add_u32 v234, s47, v234
  v_mad_u32_u24 v233, v233, 8, v232
  v_add_u32 v246, s82, v235
  v_add_u32 v247, 2048, v246
  v_add_u32 v31, 0, v234
  v_and_b32 v31, 3, v31
  v_lshl_add_u32 v244, v31, 4, v232
  v_add_u32 v31, 1, v234
  v_and_b32 v31, 3, v31
  v_lshl_add_u32 v245, v31, 4, v232
  v_add_u32 v245, 1664, v245
  v_add_u32 v31, 0, v234
  v_and_b32 v31, 3, v31
  v_lshl_add_u32 v248, v31, 4, v233
  v_add_u32 v31, 1, v234
  v_and_b32 v31, 3, v31
  v_lshl_add_u32 v249, v31, 4, v233
  v_add_u32 v249, 1664, v249
  s_waitcnt lgkmcnt(5)
  v_add_u32 v10, s76, v10
  v_add_u32 v4, s76, v4
  v_add_u32 v5, s76, v5
  ds_write_b32 v10, v7 offset:2880
  v_add_u32 v11, s45, v11
  s_waitcnt lgkmcnt(5)
  v_add_u32 v20, s45, v20
  v_add_u32 v21, s45, v21
  v_add_u32 v22, s45, v22
  v_add_u32 v23, s45, v23
  s_waitcnt lgkmcnt(4)
  v_add_u32 v24, s45, v24
  v_add_u32 v25, s45, v25
  v_add_u32 v26, s45, v26
  v_add_u32_e64 v27, s45, v27
  s_waitcnt vmcnt(16)
  s_barrier
L_w2:
  ds_read2st64_b32 v[60:61], v228 offset0:0 offset1:6
  ds_read2st64_b32 v[62:63], v228 offset0:12 offset1:18
  ds_read2st64_b32 v[64:65], v228 offset0:24 offset1:30
  ds_read2st64_b32 v[66:67], v228 offset0:36 offset1:42
  ds_read2st64_b32 v[68:69], v228 offset0:96 offset1:102
  ds_read2st64_b32 v[70:71], v229 offset0:108 offset1:114
  ds_read2st64_b32 v[72:73], v229 offset0:120 offset1:126
  ds_read2st64_b32 v[74:75], v229 offset0:132 offset1:138
  s_cmp_ge_u32 s3, 5
  s_cbranch_scc1 L_u0
  v_add_u32 v228, 32, v228
  v_add_u32 v229, 32, v229
  ds_read2st64_b32 v[92:93], v228 offset0:0 offset1:6
  ds_read2st64_b32 v[94:95], v228 offset0:12 offset1:18
  ds_read2st64_b32 v[96:97], v228 offset0:24 offset1:30
  ds_read2st64_b32 v[98:99], v228 offset0:36 offset1:42
  ds_read2st64_b32 v[100:101], v228 offset0:96 offset1:102
  ds_read2st64_b32 v[102:103], v229 offset0:108 offset1:114
  ds_read2st64_b32 v[104:105], v229 offset0:120 offset1:126
  ds_read2st64_b32 v[106:107], v229 offset0:132 offset1:138
  s_waitcnt lgkmcnt(14)
  v_mfma_f32_16x16x32_bf16 v[28:31], v[60:63], v[60:63], 0
  s_waitcnt lgkmcnt(12)
  v_mfma_f32_16x16x32_bf16 v[28:31], v[64:67], v[64:67], v[28:31]
  s_waitcnt lgkmcnt(10)
  v_mfma_f32_16x16x32_bf16 v[28:31], v[68:71], v[68:71], v[28:31]
  s_waitcnt lgkmcnt(8)
  v_mfma_f32_16x16x32_bf16 v[28:31], v[72:75], v[72:75], v[28:31]
  v_perm_b32 v152, v61, v60, s99
  v_perm_b32 v153, v63, v62, s99
  v_perm_b32 v154, v65, v64, s99
  v_perm_b32 v155, v67, v66, s99
  v_perm_b32 v156, v69, v68, s99
  v_perm_b32 v157, v71, v70, s99
  v_perm_b32 v158, v73, v72, s99
  v_perm_b32 v159, v75, v74, s99
  v_perm_b32 v160, v61, v60, s100
  v_perm_b32 v161, v63, v62, s100
  v_perm_b32 v162, v65, v64, s100
  v_perm_b32 v163, v67, v66, s100
  v_perm_b32 v164, v69, v68, s100
  v_perm_b32 v165, v71, v70, s100
  v_perm_b32 v166, v73, v72, s100
  v_perm_b32 v167, v75, v74, s100
  s_waitcnt lgkmcnt(6)
  v_mfma_f32_16x16x32_bf16 v[28:31], v[92:95], v[92:95], v[28:31]
  s_waitcnt lgkmcnt(4)
  v_mfma_f32_16x16x32_bf16 v[28:31], v[96:99], v[96:99], v[28:31]
  s_waitcnt lgkmcnt(2)
  v_mfma_f32_16x16x32_bf16 v[28:31], v[100:103], v[100:103], v[28:31]
  s_waitcnt lgkmcnt(0)
  v_mfma_f32_16x16x32_bf16 v[28:31], v[104:107], v[104:107], v[28:31]
  v_perm_b32 v168, v93, v92, s99
  v_perm_b32 v169, v95, v94, s99
  v_perm_b32 v170, v97, v96, s99
  v_perm_b32 v171, v99, v98, s99
  s_nop 3
  v_max3_f32 v28, v28, v29, 0
  v_perm_b32 v172, v101, v100, s99
  v_perm_b32 v173, v103, v102, s99
  v_max3_f32 v28, v28, v30, v31
  v_perm_b32 v174, v105, v104, s99
  s_nop 0
  v_max_u32_dpp v28, v28, v28 row_shr:1 row_mask:0xf bank_mask:0xf
  v_perm_b32 v175, v107, v106, s99
  s_nop 0
  v_max_u32_dpp v28, v28, v28 row_shr:2 row_mask:0xf bank_mask:0xf
  v_perm_b32 v176, v93, v92, s100
  v_perm_b32 v177, v95, v94, s100
  v_max_u32_dpp v28, v28, v28 row_shr:4 row_mask:0xf bank_mask:0xf
  v_perm_b32 v178, v97, v96, s100
  s_nop 0
  v_max_u32_dpp v28, v28, v28 row_shr:8 row_mask:0xf bank_mask:0xf
  v_perm_b32 v179, v99, v98, s100
  s_nop 0
  v_max_u32_dpp v28, v28, v28 row_bcast:15 row_mask:0xa bank_mask:0xf
  v_perm_b32 v180, v101, v100, s100
  v_perm_b32 v181, v103, v102, s100
  v_max_u32_dpp v28, v28, v28 row_bcast:31 row_mask:0xc bank_mask:0xf
  v_perm_b32 v182, v105, v104, s100
  s_mov_b32 exec_lo, 0
  s_mov_b32 exec_hi, 0x80000000
  ds_max_u32 v2, v28 offset:20
  s_mov_b64 exec, -1
  v_perm_b32 v183, v107, v106, s100
  s_branch L_u1
L_u0:
  s_waitcnt lgkmcnt(6)
  v_mfma_f32_16x16x32_bf16 v[28:31], v[60:63], v[60:63], 0
  s_waitcnt lgkmcnt(4)
  v_mfma_f32_16x16x32_bf16 v[28:31], v[64:67], v[64:67], v[28:31]
  s_waitcnt lgkmcnt(2)
  v_mfma_f32_16x16x32_bf16 v[28:31], v[68:71], v[68:71], v[28:31]
  s_waitcnt lgkmcnt(0)
  v_mfma_f32_16x16x32_bf16 v[28:31], v[72:75], v[72:75], v[28:31]
  v_perm_b32 v152, v61, v60, s99
  v_perm_b32 v153, v63, v62, s99
  v_perm_b32 v154, v65, v64, s99
  v_perm_b32 v155, v67, v66, s99
  s_nop 3
  v_max3_f32 v28, v28, v29, 0
  v_perm_b32 v156, v69, v68, s99
  v_perm_b32 v157, v71, v70, s99
  v_max3_f32 v28, v28, v30, v31
  v_perm_b32 v158, v73, v72, s99
  s_nop 0
  v_max_u32_dpp v28, v28, v28 row_shr:1 row_mask:0xf bank_mask:0xf
  v_perm_b32 v159, v75, v74, s99
  s_nop 0
  v_max_u32_dpp v28, v28, v28 row_shr:2 row_mask:0xf bank_mask:0xf
  v_perm_b32 v160, v61, v60, s100
  v_perm_b32 v161, v63, v62, s100
  v_max_u32_dpp v28, v28, v28 row_shr:4 row_mask:0xf bank_mask:0xf
  v_perm_b32 v162, v65, v64, s100
  s_nop 0
  v_max_u32_dpp v28, v28, v28 row_shr:8 row_mask:0xf bank_mask:0xf
  v_perm_b32 v163, v67, v66, s100
  s_nop 0
  v_max_u32_dpp v28, v28, v28 row_bcast:15 row_mask:0xa bank_mask:0xf
  v_perm_b32 v164, v69, v68, s100
  v_perm_b32 v165, v71, v70, s100
  v_max_u32_dpp v28, v28, v28 row_bcast:31 row_mask:0xc bank_mask:0xf
  v_perm_b32 v166, v73, v72, s100
  s_mov_b32 exec_lo, 0
  s_mov_b32 exec_hi, 0x80000000
  ds_max_u32 v2, v28 offset:20
  s_mov_b64 exec, -1
  v_perm_b32 v167, v75, v74, s100
  v_add_u32 v248, 12288, v246
  v_add_u32 v249, 12288, v247
  s_cmp_lg_u32 s3, 7
  s_cbranch_scc1 L_u1
  s_mov_b32 exec_lo, 0xfffffff0
  s_mov_b32 exec_hi, 0xfffffff0
  v_mov_b32 v249, 1048576
  s_mov_b64 exec, -1
L_u1:
  s_waitcnt vmcnt(8) lgkmcnt(0)
  s_barrier
  ds_read_b128 v[108:111], v2 offset:16
  ds_read_b64_tr_b16 v[112:113], v224 offset:0
  ds_read_b64_tr_b16 v[114:115], v224 offset:256
  ds_read_b64_tr_b16 v[116:117], v224 offset:1024
  ds_read_b64_tr_b16 v[118:119], v224 offset:1280
  ds_read_b64_tr_b16 v[76:77], v225 offset:0
  ds_read_b64_tr_b16 v[78:79], v225 offset:5408
  ds_read_b64_tr_b16 v[80:81], v226 offset:0
  ds_read_b64_tr_b16 v[82:83], v227 offset:0
  ds_read_b64_tr_b16 v[84:85], v225 offset:64
  ds_read_b64_tr_b16 v[86:87], v225 offset:5472
  ds_read_b64_tr_b16 v[88:89], v226 offset:64
  ds_read_b64_tr_b16 v[90:91], v227 offset:64
  s_waitcnt lgkmcnt(12)
  v_add_u32 v109, 0x3f800000, v109
  v_lshrrev_b32 v109, 24, v109
  v_lshrrev_b32 v110, 23, v110
  v_lshrrev_b32 v111, 23, v111
  s_mov_b32 vcc_lo, 0x4000000
  s_mov_b32 vcc_hi, 0x4000000
  v_cndmask_b32 v250, v110, v111, vcc
  v_add_u32_e64 v250, v250, v109
  v_sub_u32 v250, 388, v250
  s_movk_i32 s98, 167
  v_med3_i32 v250, v250, 1, s98
  v_subrev_u32 v110, 127, v250
  v_lshlrev_b32 v250, 23, v250
  v_cmp_gt_i32 vcc, 0, v110
  v_mul_u32_u24 v110, 0x800080, v110
  s_cbranch_vccnz L_sdown
  s_waitcnt lgkmcnt(11)
  v_add_u32 v112, v112, v110
  v_add_u32 v113, v113, v110
  s_waitcnt lgkmcnt(10)
  v_add_u32 v114, v114, v110
  v_add_u32 v115, v115, v110
  s_waitcnt lgkmcnt(9)
  v_add_u32 v116, v116, v110
  v_add_u32 v117, v117, v110
  s_waitcnt lgkmcnt(8)
  v_add_u32 v118, v118, v110
  v_add_u32_e64 v119, v119, v110
L_scaled:
  s_cmp_ge_u32 s3, 5
  s_cbranch_scc1 L_u2
  v_mfma_f32_32x32x16_bf16 v[120:135], v[152:155], v[112:115], 0
  v_mfma_f32_32x32x16_bf16 v[120:135], v[156:159], v[116:119], v[120:135]
  s_waitcnt lgkmcnt(6)
  v_mfma_f32_16x16x32_bf16 v[28:31], v[76:79], v[76:79], 0
  s_waitcnt lgkmcnt(4)
  v_mfma_f32_16x16x32_bf16 v[28:31], v[80:83], v[80:83], v[28:31]
  s_waitcnt lgkmcnt(2)
  v_mfma_f32_16x16x32_bf16 v[28:31], v[84:87], v[84:87], v[28:31]
  s_waitcnt lgkmcnt(0)
  v_mfma_f32_16x16x32_bf16 v[28:31], v[88:91], v[88:91], v[28:31]
  v_mfma_f32_32x32x16_bf16 v[136:151], v[160:163], v[112:115], 0
  s_nop 2
  v_cvt_pk_f16_f32 v120, v120, v121
  v_cvt_pk_f16_f32 v121, v122, v123
  v_cvt_pk_f16_f32 v122, v124, v125
  v_cvt_pk_f16_f32 v123, v126, v127
  ds_write_b128 v244, v[120:123]
  v_xor_b32_e64 v244, 16, v244
  v_mfma_f32_32x32x16_bf16 v[136:151], v[164:167], v[116:119], v[136:151]
  v_cvt_pk_f16_f32 v124, v128, v129
  v_cvt_pk_f16_f32 v125, v130, v131
  v_cvt_pk_f16_f32 v126, v132, v133
  v_cvt_pk_f16_f32 v127, v134, v135
  ds_write_b128 v244, v[124:127]
  v_mfma_f32_32x32x16_bf16 v[184:199], v[168:171], v[112:115], 0
  v_max3_f32 v28, v28, v29, 0
  s_nop 4
  v_cvt_pk_f16_f32 v136, v136, v137
  v_cvt_pk_f16_f32 v137, v138, v139
  v_max3_f32 v28, v28, v30, v31
  v_cvt_pk_f16_f32 v138, v140, v141
  v_mfma_f32_32x32x16_bf16 v[184:199], v[172:175], v[116:119], v[184:199]
  v_max_u32_dpp v28, v28, v28 row_shr:1 row_mask:0xf bank_mask:0xf
  v_cvt_pk_f16_f32 v139, v142, v143
  s_nop 0
  v_max_u32_dpp v28, v28, v28 row_shr:2 row_mask:0xf bank_mask:0xf
  ds_write_b128 v245, v[136:139]
  s_nop 0
  v_max_u32_dpp v28, v28, v28 row_shr:4 row_mask:0xf bank_mask:0xf
  v_mfma_f32_32x32x16_bf16 v[200:215], v[176:179], v[112:115], 0
  v_xor_b32_e64 v245, 16, v245
  v_max_u32_dpp v28, v28, v28 row_shr:8 row_mask:0xf bank_mask:0xf
  v_cvt_pk_f16_f32 v140, v144, v145
  s_nop 0
  v_max_u32_dpp v28, v28, v28 row_bcast:15 row_mask:0xa bank_mask:0xf
  v_cvt_pk_f16_f32 v141, v146, v147
  v_mfma_f32_32x32x16_bf16 v[200:215], v[180:183], v[116:119], v[200:215]
  v_max_u32_dpp v28, v28, v28 row_bcast:31 row_mask:0xc bank_mask:0xf
  v_cvt_pk_f16_f32 v142, v148, v149
  s_mov_b32 exec_lo, 0
  s_mov_b32 exec_hi, 0x80000000
  ds_max_u32 v2, v28 offset:16
  s_mov_b64 exec, -1
  v_cvt_pk_f16_f32 v143, v150, v151
  ds_write_b128 v245, v[140:143]
  s_waitcnt lgkmcnt(1)
  s_barrier
  ds_read_b32 v108, v2 offset:16
  v_cvt_pk_f16_f32 v184, v184, v185
  v_cvt_pk_f16_f32 v185, v186, v187
  v_cvt_pk_f16_f32 v186, v188, v189
  v_cvt_pk_f16_f32 v187, v190, v191
  ds_write_b128 v248, v[184:187]
  v_xor_b32_e64 v248, 16, v248
  v_cvt_pk_f16_f32 v188, v192, v193
  v_cvt_pk_f16_f32 v189, v194, v195
  v_cvt_pk_f16_f32 v190, v196, v197
  v_cvt_pk_f16_f32 v191, v198, v199
  ds_write_b128 v248, v[188:191]
  s_waitcnt lgkmcnt(2)
  v_add_u32 v108, 0x3f800000, v108
  v_lshrrev_b32 v108, 24, v108
  v_sub_u32 v108, 267, v108
  v_min_u32 v108, 167, v108
  s_nop 0
  v_readfirstlane_b32 s74, v108
  v_mul_u32_u24 v108, 0x800080, v108
  v_and_b32 v216, v216, v108
  v_and_b32 v217, v217, v108
  v_and_b32 v218, v218, v108
  v_and_b32 v219, v219, v108
  v_and_b32 v220, v220, v108
  v_and_b32 v221, v221, v108
  v_and_b32 v222, v222, v108
  v_and_b32_e64 v223, v223, v108
  v_mfma_f32_32x32x16_bf16 v[152:167], v[216:219], v[76:79], 0
  v_cvt_pk_f16_f32 v200, v200, v201
  v_cvt_pk_f16_f32 v201, v202, v203
  v_cvt_pk_f16_f32 v202, v204, v205
  v_mfma_f32_32x32x16_bf16 v[152:167], v[220:223], v[80:83], v[152:167]
  v_cvt_pk_f16_f32 v203, v206, v207
  ds_write_b128 v249, v[200:203]
  v_xor_b32_e64 v249, 16, v249
  v_mfma_f32_32x32x16_bf16 v[168:183], v[216:219], v[84:87], 0
  v_cvt_pk_f16_f32 v204, v208, v209
  v_cvt_pk_f16_f32 v205, v210, v211
  v_cvt_pk_f16_f32 v206, v212, v213
  v_mfma_f32_32x32x16_bf16 v[168:183], v[220:223], v[88:91], v[168:183]
  v_cvt_pk_f16_f32 v207, v214, v215
  ds_write_b128 v249, v[204:207]
  s_branch L_u3
L_u2:
  ds_read_b64_tr_b16 v[92:93], v225 offset:384
  ds_read_b64_tr_b16 v[94:95], v225 offset:5792
  ds_read_b64_tr_b16 v[96:97], v226 offset:384
  ds_read_b64_tr_b16 v[98:99], v227 offset:384
  ds_read_b64_tr_b16 v[100:101], v225 offset:448
  ds_read_b64_tr_b16 v[102:103], v225 offset:5856
  ds_read_b64_tr_b16 v[104:105], v226 offset:448
  ds_read_b64_tr_b16 v[106:107], v227 offset:448
  v_mfma_f32_32x32x16_bf16 v[120:135], v[152:155], v[112:115], 0
  v_mfma_f32_32x32x16_bf16 v[120:135], v[156:159], v[116:119], v[120:135]
  v_mfma_f32_32x32x16_bf16 v[136:151], v[160:163], v[112:115], 0
  v_mfma_f32_32x32x16_bf16 v[136:151], v[164:167], v[116:119], v[136:151]
  s_waitcnt lgkmcnt(14)
  v_mfma_f32_16x16x32_bf16 v[28:31], v[76:79], v[76:79], 0
  s_nop 7
  v_cvt_pk_f16_f32 v120, v120, v121
  v_cvt_pk_f16_f32 v121, v122, v123
  s_waitcnt lgkmcnt(12)
  v_mfma_f32_16x16x32_bf16 v[28:31], v[80:83], v[80:83], v[28:31]
  v_cvt_pk_f16_f32 v122, v124, v125
  s_waitcnt lgkmcnt(10)
  v_mfma_f32_16x16x32_bf16 v[28:31], v[84:87], v[84:87], v[28:31]
  v_cvt_pk_f16_f32 v123, v126, v127
  ds_write_b128 v244, v[120:123]
  s_waitcnt lgkmcnt(9)
  v_mfma_f32_16x16x32_bf16 v[28:31], v[88:91], v[88:91], v[28:31]
  v_xor_b32 v244, 16, v244
  s_waitcnt lgkmcnt(7)
  v_mfma_f32_16x16x32_bf16 v[28:31], v[92:95], v[92:95], v[28:31]
  v_cvt_pk_f16_f32 v124, v128, v129
  s_waitcnt lgkmcnt(5)
  v_mfma_f32_16x16x32_bf16 v[28:31], v[96:99], v[96:99], v[28:31]
  v_cvt_pk_f16_f32 v125, v130, v131
  v_cvt_pk_f16_f32 v126, v132, v133
  s_waitcnt lgkmcnt(3)
  v_mfma_f32_16x16x32_bf16 v[28:31], v[100:103], v[100:103], v[28:31]
  s_nop 0
  v_cvt_pk_f16_f32 v127, v134, v135
  s_waitcnt lgkmcnt(1)
  v_mfma_f32_16x16x32_bf16 v[28:31], v[104:107], v[104:107], v[28:31]
  ds_write_b128 v244, v[124:127]
  s_nop 6
  v_max3_f32 v28, v28, v29, 0
  v_cvt_pk_f16_f32 v136, v136, v137
  v_cvt_pk_f16_f32 v137, v138, v139
  v_max3_f32 v28, v28, v30, v31
  v_cvt_pk_f16_f32 v138, v140, v141
  s_nop 0
  v_max_u32_dpp v28, v28, v28 row_shr:1 row_mask:0xf bank_mask:0xf
  v_cvt_pk_f16_f32 v139, v142, v143
  s_nop 0
  v_max_u32_dpp v28, v28, v28 row_shr:2 row_mask:0xf bank_mask:0xf
  ds_write_b128 v245, v[136:139]
  s_nop 0
  v_max_u32_dpp v28, v28, v28 row_shr:4 row_mask:0xf bank_mask:0xf
  v_xor_b32 v245, 16, v245
  s_nop 0
  v_max_u32_dpp v28, v28, v28 row_shr:8 row_mask:0xf bank_mask:0xf
  v_cvt_pk_f16_f32 v140, v144, v145
  s_nop 0
  v_max_u32_dpp v28, v28, v28 row_bcast:15 row_mask:0xa bank_mask:0xf
  v_cvt_pk_f16_f32 v141, v146, v147
  s_nop 0
  v_max_u32_dpp v28, v28, v28 row_bcast:31 row_mask:0xc bank_mask:0xf
  v_cvt_pk_f16_f32 v142, v148, v149
  s_mov_b32 exec_lo, 0
  s_mov_b32 exec_hi, 0x80000000
  ds_max_u32 v2, v28 offset:16
  s_mov_b64 exec, -1
  v_cvt_pk_f16_f32 v143, v150, v151
  ds_write_b128 v245, v[140:143]
  s_waitcnt lgkmcnt(1)
  s_barrier
  ds_read_b32 v108, v2 offset:16
  s_waitcnt lgkmcnt(0)
  v_add_u32 v108, 0x3f800000, v108
  v_lshrrev_b32 v108, 24, v108
  v_sub_u32 v108, 267, v108
  v_min_u32 v108, 167, v108
  s_nop 0
  v_readfirstlane_b32 s74, v108
  v_mul_u32_u24 v108, 0x800080, v108
  v_and_b32 v216, v216, v108
  v_and_b32 v217, v217, v108
  v_and_b32 v218, v218, v108
  v_and_b32 v219, v219, v108
  v_and_b32 v220, v220, v108
  v_and_b32 v221, v221, v108
  v_and_b32 v222, v222, v108
  v_and_b32 v223, v223, v108
  v_mfma_f32_32x32x16_bf16 v[184:199], v[216:219], v[92:95], 0
  s_nop 0
  v_mfma_f32_32x32x16_bf16 v[184:199], v[220:223], v[96:99], v[184:199]
  v_mfma_f32_32x32x16_bf16 v[200:215], v[216:219], v[100:103], 0
  v_mfma_f32_32x32x16_bf16 v[200:215], v[220:223], v[104:107], v[200:215]
  v_mfma_f32_32x32x16_bf16 v[152:167], v[216:219], v[76:79], 0
  s_nop 8
  v_cvt_pk_f16_f32 v184, v184, v185
  v_cvt_pk_f16_f32 v185, v186, v187
  v_cvt_pk_f16_f32 v186, v188, v189
  v_cvt_pk_f16_f32 v187, v190, v191
  ds_write_b128 v248, v[184:187]
  v_xor_b32 v248, 16, v248
  v_mfma_f32_32x32x16_bf16 v[152:167], v[220:223], v[80:83], v[152:167]
  v_cvt_pk_f16_f32 v188, v192, v193
  v_cvt_pk_f16_f32 v189, v194, v195
  v_cvt_pk_f16_f32 v190, v196, v197
  v_cvt_pk_f16_f32 v191, v198, v199
  ds_write_b128 v248, v[188:191]
  v_mfma_f32_32x32x16_bf16 v[168:183], v[216:219], v[84:87], 0
  v_cvt_pk_f16_f32 v200, v200, v201
  v_cvt_pk_f16_f32 v201, v202, v203
  v_cvt_pk_f16_f32 v202, v204, v205
  v_cvt_pk_f16_f32 v203, v206, v207
  ds_write_b128 v249, v[200:203]
  v_xor_b32_e64 v249, 16, v249
  v_mfma_f32_32x32x16_bf16 v[168:183], v[220:223], v[88:91], v[168:183]
  v_cvt_pk_f16_f32 v204, v208, v209
  v_cvt_pk_f16_f32 v205, v210, v211
  v_cvt_pk_f16_f32 v206, v212, v213
  v_cvt_pk_f16_f32 v207, v214, v215
  ds_write_b128 v249, v[204:207]
L_u3:
  s_nop 0
  v_cvt_pk_f16_f32 v152, v152, v153
  v_cvt_pk_f16_f32 v153, v154, v155
  v_cvt_pk_f16_f32 v154, v156, v157
  v_cvt_pk_f16_f32 v155, v158, v159
  ds_write_b128 v246, v[152:155]
  v_xor_b32 v246, 16, v246
  v_cvt_pk_f16_f32 v156, v160, v161
  v_cvt_pk_f16_f32 v157, v162, v163
  v_cvt_pk_f16_f32 v158, v164, v165
  v_cvt_pk_f16_f32 v159, v166, v167
  ds_write_b128 v246, v[156:159]
  v_cvt_pk_f16_f32 v168, v168, v169
  v_cvt_pk_f16_f32 v169, v170, v171
  v_cvt_pk_f16_f32 v170, v172, v173
  v_cvt_pk_f16_f32 v171, v174, v175
  ds_write_b128 v247, v[168:171]
  v_xor_b32_e64 v247, 16, v247
  v_cvt_pk_f16_f32 v172, v176, v177
  v_cvt_pk_f16_f32 v173, v178, v179
  v_cvt_pk_f16_f32 v174, v180, v181
  v_cvt_pk_f16_f32 v175, v182, v183
  ds_write_b128 v247, v[172:175]
  v_readlane_b32 s0, v250, 0
  v_readlane_b32 s1, v250, 26
  s_sub_u32 s75, 0x7f000000, s0
  s_sub_u32 s1, 0x7f000000, s1
  s_sub_u32 s74, 254, s74
  s_lshl_b32 s74, s74, 23
  s_mov_b32 s92, 0x88888888
  s_mov_b32 s93, 0x88888888
  s_mul_i32 s68, s3, 384
  v_lshrrev_b32 v29, 2, v0
  v_mul_u32_u24 v29, 24, v29
  v_add_u32 v29, s68, v29
  v_and_b32 v30, 3, v0
  v_lshlrev_b32 v30, 3, v30
  ds_read_b64 v[120:121], v29 offset:2048
  ds_read_b64 v[122:123], v29 offset:2056
  ds_read_b64 v[124:125], v29 offset:2064
  buffer_load_dwordx4 v[16:19], v6, s[28:31], s94 offen
  s_add_u32 s94, s94, 416
  buffer_load_dwordx4 v[216:219], v6, s[28:31], s94 offen
  s_add_u32 s94, s94, 416
  s_waitcnt lgkmcnt(2)
  v_xor_b32 v120, v120, v30
  v_xor_b32 v126, 32, v120
  v_xor_b32 v121, v121, v30
  v_xor_b32 v127, 32, v121
  s_waitcnt lgkmcnt(1)
  v_xor_b32 v122, v122, v30
  v_xor_b32 v128, 32, v122
  v_xor_b32 v123, v123, v30
  v_xor_b32 v129, 32, v123
  s_waitcnt lgkmcnt(0)
  v_xor_b32 v124, v124, v30
  v_xor_b32 v130, 32, v124
  v_xor_b32 v125, v125, v30
  v_xor_b32_e64 v131, 32, v125
  s_waitcnt lgkmcnt(0)
  s_barrier
  ds_read_b64_tr_b16 v[60:61], v120 offset:0
  ds_read_b64_tr_b16 v[62:63], v121 offset:0
  ds_read_b64_tr_b16 v[64:65], v126 offset:0
  ds_read_b64_tr_b16 v[66:67], v127 offset:0
  ds_read_b64_tr_b16 v[68:69], v120 offset:43328
  ds_read_b64_tr_b16 v[70:71], v121 offset:43328
  ds_read_b64_tr_b16 v[72:73], v126 offset:43328
  ds_read_b64_tr_b16 v[74:75], v127 offset:43328
  ds_read_b64_tr_b16 v[76:77], v122 offset:0
  ds_read_b64_tr_b16 v[78:79], v123 offset:0
  ds_read_b64_tr_b16 v[80:81], v128 offset:0
  ds_read_b64_tr_b16 v[82:83], v129 offset:0
  ds_read_b64_tr_b16 v[84:85], v122 offset:43328
  ds_read_b64_tr_b16 v[86:87], v123 offset:43328
  ds_read_b64_tr_b16 v[88:89], v128 offset:43328
  ds_read_b64_tr_b16 v[90:91], v129 offset:43328
  s_cmp_ge_u32 s3, 6
  s_cbranch_scc1 L_lin
  ds_read_b64_tr_b16 v[92:93], v124 offset:0
  ds_read_b64_tr_b16 v[94:95], v125 offset:0
  ds_read_b64_tr_b16 v[96:97], v130 offset:0
  ds_read_b64_tr_b16 v[98:99], v131 offset:0
  ds_read_b64_tr_b16 v[100:101], v124 offset:43328
  ds_read_b64_tr_b16 v[102:103], v125 offset:43328
  ds_read_b64_tr_b16 v[104:105], v130 offset:43328
  ds_read_b64_tr_b16 v[106:107], v131 offset:43328
  s_waitcnt lgkmcnt(6)
  v_pk_add_f16 v92, v92, v94
  v_pk_add_f16 v93, v93, v95
  ds_write_b64 v59, v[92:93] offset:30720
  s_waitcnt lgkmcnt(5)
  v_pk_add_f16 v96, v96, v98
  v_pk_add_f16 v97, v97, v99
  s_waitcnt lgkmcnt(3)
  v_pk_add_f16 v100, v100, v102
  v_pk_add_f16 v101, v101, v103
  ds_write_b64 v59, v[100:101] offset:32768
  s_waitcnt lgkmcnt(2)
  v_pk_add_f16 v104, v104, v106
  v_pk_add_f16 v105, v105, v107
  v_cndmask_b32 v96, v96, v104, s[92:93]
  v_cndmask_b32 v97, v97, v105, s[92:93]
  ds_write_b64 v59, v[96:97] offset:31744
  ds_write_b32 v230, v104 offset:3072
  ds_write_b32 v230, v105 offset:3088
  s_branch L_p2
L_lin:
  s_and_b32 s98, s3, 1
  s_cselect_b64 vcc, -1, 0
  s_lshl_b32 s99, s98, 5
  v_mov_b32 v31, 0
  v_xor_b32 v236, s99, v236
  v_xor_b32 v237, s99, v237
  v_cndmask_b32 v238, v238, v239, vcc
  ds_read_b64_tr_b16 v[92:93], v236
  ds_read_b64_tr_b16 v[94:95], v237
  ds_read_u16_d16_hi v31, v238
  s_lshl_b32 s98, s98, 10
  v_add_u32 v29, s98, v1
  s_waitcnt lgkmcnt(2)
  v_cvt_f32_f16 v96, v92
  v_cvt_f32_f16_sdwa v97, v92 dst_sel:DWORD dst_unused:UNUSED_PAD src0_sel:WORD_1
  v_mul_f32 v96, s1, v96
  v_mul_f32 v97, s1, v97
  v_mul_f32 v96, s0, v96
  v_mul_f32 v97, s0, v97
  v_cvt_pk_bf16_f32 v92, v96, v97
  v_cvt_f32_f16 v98, v93
  v_cvt_f32_f16_sdwa v99, v93 dst_sel:DWORD dst_unused:UNUSED_PAD src0_sel:WORD_1
  v_mul_f32 v98, s1, v98
  v_mul_f32 v99, s1, v99
  v_mul_f32 v98, s0, v98
  v_mul_f32_e64 v99, s0, v99
  v_cvt_pk_bf16_f32 v93, v98, v99
  s_waitcnt lgkmcnt(1)
  v_cvt_f32_f16 v100, v94
  v_cvt_f32_f16_sdwa v101, v94 dst_sel:DWORD dst_unused:UNUSED_PAD src0_sel:WORD_1
  v_mul_f32 v100, s1, v100
  v_mul_f32 v101, s1, v101
  v_mul_f32 v100, s0, v100
  v_mul_f32 v101, s0, v101
  v_cvt_pk_bf16_f32 v94, v100, v101
  v_cvt_f32_f16 v102, v95
  v_cvt_f32_f16_sdwa v103, v95 dst_sel:DWORD dst_unused:UNUSED_PAD src0_sel:WORD_1
  v_mul_f32 v102, s1, v102
  v_mul_f32 v103, s1, v103
  s_mov_b32 exec_lo, 0
  s_mov_b32 exec_hi, 0xffff
  s_waitcnt lgkmcnt(0)
  v_mov_b32 v102, v31
  s_mov_b64 exec, -1
  v_mul_f32 v102, s0, v102
  v_mul_f32_e64 v103, s0, v103
  v_cvt_pk_bf16_f32 v95, v102, v103
  ds_write_b128 v29, v[92:95] offset:39936
L_p2:
  v_pk_add_f16 v76, v76, v78
  v_pk_add_f16 v77, v77, v79
  ds_write_b64 v59, v[76:77] offset:18432
  v_pk_add_f16 v80, v80, v82
  v_pk_add_f16 v81, v81, v83
  v_pk_add_f16 v84, v84, v86
  v_pk_add_f16 v85, v85, v87
  ds_write_b64 v59, v[84:85] offset:20480
  v_pk_add_f16 v88, v88, v90
  v_pk_add_f16 v89, v89, v91
  v_cndmask_b32 v80, v80, v88, s[92:93]
  v_cndmask_b32 v81, v81, v89, s[92:93]
  ds_write_b64 v59, v[80:81] offset:19456
  ds_write_b32 v230, v88 offset:1024
  ds_write_b32 v230, v89 offset:1040
  v_pk_add_f16 v60, v60, v62
  v_pk_add_f16 v61, v61, v63
  ds_write_b64 v59, v[60:61] offset:6144
  v_pk_add_f16 v64, v64, v66
  v_pk_add_f16 v65, v65, v67
  v_pk_add_f16 v68, v68, v70
  v_pk_add_f16 v69, v69, v71
  ds_write_b64 v59, v[68:69] offset:8192
  v_pk_add_f16 v72, v72, v74
  v_pk_add_f16 v73, v73, v75
  v_cndmask_b32 v64, v64, v72, s[92:93]
  v_cndmask_b32 v65, v65, v73, s[92:93]
  ds_write_b64 v59, v[64:65] offset:7168
  s_cmp_lt_u32 s3, 2
  s_cbranch_scc1 L_p2d
  v_subrev_u32 v230, 1024, v230
  ds_write_b32 v230, v72 offset:0
  ds_write_b32 v230, v73 offset:16
  s_branch L_built
L_p2d:
  ds_write_b64 v231, v[72:73] offset:5120
L_built:
  s_mov_b32 s0, s74
  s_mov_b32 s1, s75
  s_mov_b32 s96, 0x3e000000
  s_mov_b32 s97, 0x43000000
  s_mov_b32 s51, 1
  s_mul_i32 s98, s3, 1536
  s_add_u32 s98, s98, 116736
  s_cmp_lg_u32 s84, 0
  s_cbranch_scc1 L_g1c
  s_sub_u32 s94, s94, 416
  s_waitcnt vmcnt(0)
  ds_read_u16_d16_hi v32, v10 offset:0
  ds_read_u16_d16_hi v33, v10 offset:2
  ds_read_u16_d16_hi v34, v10 offset:2112
  ds_read_u16_d16_hi v35, v10 offset:2114
  ds_read_u16_d16_hi v36, v10 offset:128
  ds_read_u16_d16_hi v37, v10 offset:130
  ds_read_u16_d16_hi v38, v10 offset:2240
  ds_read_u16_d16_hi v39, v10 offset:2242
  ds_read_u16_d16_hi v40, v10 offset:256
  ds_read_u16_d16_hi v41, v10 offset:258
  ds_read_u16_d16_hi v42, v10 offset:2368
  ds_read_u16_d16_hi v43, v10 offset:2370
  ds_read_u16_d16_hi v44, v10 offset:384
  ds_read_u16_d16_hi v45, v10 offset:386
  ds_read_u16_d16_hi v46, v10 offset:2496
  ds_read_u16_d16_hi v47, v10 offset:2498
  ds_read_u16_d16_hi v48, v10 offset:512
  ds_read_u16_d16_hi v49, v10 offset:514
  ds_read_u16_d16_hi v50, v10 offset:2624
  ds_read_u16_d16_hi v51, v10 offset:2626
  ds_read_u16_d16_hi v52, v10 offset:640
  ds_read_u16_d16_hi v53, v10 offset:642
  ds_read_u16_d16_hi v54, v10 offset:2752
  ds_read_u16_d16_hi v55, v10 offset:2754
  ds_read_u16_d16_hi v56, v10 offset:768
  ds_read_u16_d16_hi v57, v10 offset:770
  s_waitcnt lgkmcnt(14)
  v_max3_f32 v58, |v32|, |v33|, 0
  v_cvt_pk_f16_f32 v184, v32, v33
  v_max3_f32 v58, |v34|, |v35|, v58
  v_cvt_pk_f16_f32 v185, v34, v35
  v_max3_f32 v58, |v36|, |v37|, v58
  v_cvt_pk_f16_f32 v186, v36, v37
  v_max3_f32 v58, |v38|, |v39|, v58
  v_cvt_pk_f16_f32 v187, v38, v39
  v_max3_f32 v58, |v40|, |v41|, v58
  v_cvt_pk_f16_f32 v188, v40, v41
  v_max3_f32 v58, |v42|, |v43|, v58
  v_cvt_pk_f16_f32 v189, v42, v43
  s_waitcnt lgkmcnt(12)
  v_max3_f32 v58, |v44|, |v45|, v58
  v_cvt_pk_f16_f32 v190, v44, v45
  s_waitcnt lgkmcnt(10)
  v_max3_f32 v58, |v46|, |v47|, v58
  v_cvt_pk_f16_f32 v191, v46, v47
  s_waitcnt lgkmcnt(8)
  v_max3_f32 v58, |v48|, |v49|, v58
  v_cvt_pk_f16_f32 v192, v48, v49
  s_waitcnt lgkmcnt(6)
  v_max3_f32 v58, |v50|, |v51|, v58
  v_cvt_pk_f16_f32 v193, v50, v51
  s_waitcnt lgkmcnt(4)
  v_max3_f32 v58, |v52|, |v53|, v58
  v_cvt_pk_f16_f32 v194, v52, v53
  s_waitcnt lgkmcnt(2)
  v_max3_f32 v58, |v54|, |v55|, v58
  v_cvt_pk_f16_f32 v195, v54, v55
  s_waitcnt lgkmcnt(0)
  v_max3_f32 v58, |v56|, |v57|, v58
  v_cvt_pk_f16_f32 v196, v56, v57
  s_waitcnt lgkmcnt(0)
  s_barrier
  s_branch L_cin_go
L_g1c:
  s_waitcnt lgkmcnt(0)
  s_barrier
  s_add_u32 s76, s76, -63168
  s_waitcnt vmcnt(1)
  v_lshl_add_u32 v16, v16, 7, v8
  v_lshl_add_u32 v17, v17, 7, v8
  v_lshl_add_u32 v18, v18, 7, v8
  v_lshl_add_u32 v19, v19, 7, v8
  s_add_u32 m0, s76, 0
  s_mov_b32 exec_hi, 0xffffff
  buffer_load_dwordx4 v16, s[32:35], 0 offen lds
  s_add_u32 m0, s76, 1056
  s_nop 0
  buffer_load_dwordx4 v17, s[32:35], 0 offen lds
  s_add_u32 m0, s76, 2112
  s_mov_b32 exec_hi, 0xffff
  buffer_load_dwordx4 v18, s[32:35], 0 offen lds
  s_add_u32 m0, s76, 3168
  s_nop 0
  buffer_load_dwordx4 v19, s[32:35], 0 offen lds
  s_mov_b32 exec_hi, -1
  s_waitcnt vmcnt(4)
  v_lshl_add_u32 v216, v216, 7, v8
  v_lshl_add_u32 v217, v217, 7, v8
  v_lshl_add_u32 v218, v218, 7, v8
  v_lshl_add_u32 v219, v219, 7, v8
  s_add_u32 m0, s76, 16256
  s_mov_b32 exec_hi, 0xffffff
  buffer_load_dwordx4 v216, s[32:35], 0 offen lds
  s_add_u32 m0, s76, 17312
  s_nop 0
  buffer_load_dwordx4 v217, s[32:35], 0 offen lds
  s_add_u32 m0, s76, 18368
  s_mov_b32 exec_hi, 0xffff
  buffer_load_dwordx4 v218, s[32:35], 0 offen lds
  s_add_u32 m0, s76, 19424
  s_nop 0
  buffer_load_dwordx4 v219, s[32:35], 0 offen lds
  s_mov_b32 exec_hi, -1
  buffer_load_dwordx4 v[16:19], v6, s[28:31], s94 offen
  s_add_u32 s94, s94, 416
  v_add_u32 v10, -63168, v10
  v_add_u32 v4, -63168, v4
  v_add_u32 v5, -63168, v5
  ds_write_b32 v10, v7 offset:2880
  ds_write_b32 v10, v7 offset:19136
L_g1d:
  s_waitcnt vmcnt(5)
  ds_read_u16_d16_hi v32, v10 offset:0
  ds_read_u16_d16_hi v33, v10 offset:2
  ds_read_u16_d16_hi v34, v10 offset:2112
  ds_read_u16_d16_hi v35, v10 offset:2114
  ds_read_u16_d16_hi v36, v10 offset:128
  ds_read_u16_d16_hi v37, v10 offset:130
  ds_read_u16_d16_hi v38, v10 offset:2240
  ds_read_u16_d16_hi v39, v10 offset:2242
  ds_read_u16_d16_hi v40, v10 offset:256
  ds_read_u16_d16_hi v41, v10 offset:258
  ds_read_u16_d16_hi v42, v10 offset:2368
  ds_read_u16_d16_hi v43, v10 offset:2370
  ds_read_u16_d16_hi v44, v10 offset:384
  ds_read_u16_d16_hi v45, v10 offset:386
  ds_read_u16_d16_hi v46, v10 offset:2496
  ds_read_u16_d16_hi v47, v10 offset:2498
  ds_read_u16_d16_hi v48, v10 offset:512
  ds_read_u16_d16_hi v49, v10 offset:514
  ds_read_u16_d16_hi v50, v10 offset:2624
  ds_read_u16_d16_hi v51, v10 offset:2626
  ds_read_u16_d16_hi v52, v10 offset:640
  ds_read_u16_d16_hi v53, v10 offset:642
  ds_read_u16_d16_hi v54, v10 offset:2752
  ds_read_u16_d16_hi v55, v10 offset:2754
  ds_read_u16_d16_hi v56, v10 offset:768
  ds_read_u16_d16_hi v57, v10 offset:770
  s_waitcnt lgkmcnt(14)
  v_max3_f32 v58, |v32|, |v33|, 0
  v_cvt_pk_f16_f32 v184, v32, v33
  v_max3_f32 v58, |v34|, |v35|, v58
  v_cvt_pk_f16_f32 v185, v34, v35
  v_max3_f32 v58, |v36|, |v37|, v58
  v_cvt_pk_f16_f32 v186, v36, v37
  v_max3_f32 v58, |v38|, |v39|, v58
  v_cvt_pk_f16_f32 v187, v38, v39
  v_max3_f32 v58, |v40|, |v41|, v58
  v_cvt_pk_f16_f32 v188, v40, v41
  v_max3_f32 v58, |v42|, |v43|, v58
  v_cvt_pk_f16_f32 v189, v42, v43
  s_waitcnt lgkmcnt(12)
  v_max3_f32 v58, |v44|, |v45|, v58
  v_cvt_pk_f16_f32 v190, v44, v45
  s_waitcnt lgkmcnt(10)
  v_max3_f32 v58, |v46|, |v47|, v58
  v_cvt_pk_f16_f32 v191, v46, v47
  s_waitcnt lgkmcnt(8)
  v_max3_f32 v58, |v48|, |v49|, v58
  v_cvt_pk_f16_f32 v192, v48, v49
  s_waitcnt lgkmcnt(6)
  v_max3_f32 v58, |v50|, |v51|, v58
  v_cvt_pk_f16_f32 v193, v50, v51
  s_waitcnt lgkmcnt(4)
  v_max3_f32 v58, |v52|, |v53|, v58
  v_cvt_pk_f16_f32 v194, v52, v53
  s_waitcnt lgkmcnt(2)
  v_max3_f32 v58, |v54|, |v55|, v58
  v_cvt_pk_f16_f32 v195, v54, v55
  s_waitcnt lgkmcnt(0)
  v_max3_f32 v58, |v56|, |v57|, v58
  v_cvt_pk_f16_f32 v196, v56, v57
L_cin_go:
  ds_write_b32 v11, v184 offset:0
  ds_write_b32 v11, v185 offset:160
  ds_write_b32 v11, v186 offset:320
  ds_write_b32 v11, v187 offset:480
  ds_write_b32 v11, v188 offset:640
  ds_write_b32 v11, v189 offset:800
  ds_write_b32 v11, v190 offset:960
  ds_write_b32 v11, v191 offset:1120
  ds_write_b32 v11, v192 offset:1280
  ds_write_b32 v11, v193 offset:1440
  ds_write_b32 v11, v194 offset:1600
  ds_write_b32 v11, v195 offset:1760
  ds_write_b32 v11, v196 offset:1920
  s_mov_b32 s81, 16256
  s_add_u32 s76, s76, 16256
  v_lshlrev_b32 v7, 2, v0
  v_add_u32 v7, s98, v7
L_cin_loop:
  v_cmp_le_f32 s[90:91], s97, v58
  v_cmp_le_f32 vcc, s96, v58
  s_mov_b32 s49, s74
  s_mov_b32 s50, s75
  s_cmp_lg_u64 s[90:91], 0
  s_cbranch_scc1 L_cslow
  s_cbranch_vccz L_cslow
L_cconv:
  s_cmp_lg_u32 s51, 0
  s_cbranch_scc1 L_first
  ds_read_b64_tr_b16 v[60:61], v20 offset:0
  v_mul_f32 v116, v184, v192
  v_mul_f32 v117, v185, v193
  ds_read_b64_tr_b16 v[74:75], v20 offset:32
  v_mul_f32 v118, v186, v194
  ds_read_b64_tr_b16 v[88:89], v20 offset:64
  v_mul_f32 v119, v187, v195
  ds_read_b64_tr_b16 v[102:103], v20 offset:96
  v_fmac_f32 v116, v188, v191
  ds_read_b64_tr_b16 v[66:67], v23 offset:0
  v_fmac_f32 v117, v200, v208
  ds_read_b64_tr_b16 v[80:81], v23 offset:32
  v_fmac_f32 v118, v201, v209
  ds_read_b64_tr_b16 v[94:95], v23 offset:64
  v_fmac_f32 v119, v202, v210
  ds_read_b64_tr_b16 v[108:109], v23 offset:96
  v_fmac_f32 v116, v203, v211
  ds_read_b64_tr_b16 v[68:69], v24 offset:0
  v_fmac_f32 v117, v204, v207
  ds_read_b64_tr_b16 v[82:83], v24 offset:32
  v_fmac_f32_e64 v118, v216, v224
  ds_read_b64_tr_b16 v[96:97], v24 offset:64
  v_fmac_f32 v119, v217, v225
  ds_read_b64_tr_b16 v[110:111], v24 offset:96
  v_fmac_f32 v116, v218, v226
  ds_read_b64_tr_b16 v[124:125], v4 offset:0
  v_fmac_f32 v117, v219, v227
  ds_read_b64_tr_b16 v[126:127], v5 offset:0
  v_fmac_f32 v118, v220, v223
  v_fmac_f32 v119, v232, v240
  ds_read_b64_tr_b16 v[136:137], v4 offset:32
  v_fmac_f32 v116, v233, v241
  ds_read_b64_tr_b16 v[138:139], v5 offset:32
  v_fmac_f32 v117, v234, v242
  ds_read_b64_tr_b16 v[148:149], v4 offset:64
  v_fmac_f32 v118, v235, v243
  ds_read_b64_tr_b16 v[150:151], v5 offset:64
  v_fmac_f32 v119, v236, v239
  ds_read_b64_tr_b16 v[160:161], v4 offset:96
  v_fmac_f32 v116, v189, v196
  ds_read_b64_tr_b16 v[162:163], v5 offset:96
  v_fmac_f32_e64 v117, v189, v197
  ds_read_b128 v[164:167], v1 offset:39936
  v_fmac_f32 v118, v190, v198
  ds_read_b128 v[168:171], v1 offset:40960
  v_fmac_f32 v119, v190, v199
  ds_read_b128 v[172:175], v1 offset:8192
  v_fmac_f32 v116, v205, v212
  ds_read_b128 v[176:179], v1 offset:6144
  v_fmac_f32 v117, v205, v213
  ds_read_b64_tr_b16 v[70:71], v25 offset:0
  v_fmac_f32_e64 v118, v206, v214
  ds_read_b64_tr_b16 v[84:85], v25 offset:32
  v_fmac_f32 v119, v206, v215
  ds_read_b64_tr_b16 v[98:99], v25 offset:64
  v_fmac_f32 v116, v221, v228
  v_fmac_f32 v117, v221, v229
  ds_read_b64_tr_b16 v[112:113], v25 offset:96
  v_fmac_f32 v118, v222, v230
  ds_read_b64_tr_b16 v[72:73], v26 offset:0
  v_fmac_f32 v119, v222, v231
  ds_read_b64_tr_b16 v[86:87], v26 offset:32
  v_fmac_f32 v116, v237, v244
  ds_read_b64_tr_b16 v[100:101], v26 offset:64
  v_fmac_f32 v117, v237, v245
  ds_read_b64_tr_b16 v[114:115], v26 offset:96
  v_fmac_f32 v118, v238, v246
  ds_read_b64_tr_b16 v[62:63], v21 offset:0
  v_fmac_f32 v119, v238, v247
  ds_read_b64_tr_b16 v[76:77], v21 offset:32
  v_add_f32 v116, v116, v117
  ds_read_b64_tr_b16 v[90:91], v21 offset:64
  v_add_f32_e64 v118, v118, v119
  ds_read_b64_tr_b16 v[104:105], v21 offset:96
  v_add_f32 v116, v116, v118
  ds_read_b64_tr_b16 v[64:65], v22 offset:0
  v_mul_f32 v116, s49, v116
  ds_read_b64_tr_b16 v[78:79], v22 offset:32
  v_mul_f32_e64 v116, s50, v116
  ds_read_b64_tr_b16 v[92:93], v22 offset:64
  ds_write_b32 v7, v116
  ds_read_b64_tr_b16 v[106:107], v22 offset:96
  v_add_u32 v7, 256, v7
  s_waitcnt lgkmcnt(14)
  v_pk_mul_f16 v120, v60, v67 op_sel:[0,0] op_sel_hi:[0,1]
  v_pk_mul_f16 v121, v60, v67 op_sel:[1,0] op_sel_hi:[1,1]
  v_pk_mul_f16 v122, v60, v68 op_sel:[0,0] op_sel_hi:[0,1]
  v_pk_mul_f16 v123, v60, v68 op_sel:[1,0] op_sel_hi:[1,1]
  v_pk_mul_f16 v132, v74, v81 op_sel:[0,0] op_sel_hi:[0,1]
  v_pk_mul_f16 v133, v74, v81 op_sel:[1,0] op_sel_hi:[1,1]
  v_pk_mul_f16 v134, v74, v82 op_sel:[0,0] op_sel_hi:[0,1]
  v_pk_mul_f16 v135, v74, v82 op_sel:[1,0] op_sel_hi:[1,1]
  v_pk_mul_f16 v144, v88, v95 op_sel:[0,0] op_sel_hi:[0,1]
  v_pk_mul_f16 v145, v88, v95 op_sel:[1,0] op_sel_hi:[1,1]
  v_pk_mul_f16 v146, v88, v96 op_sel:[0,0] op_sel_hi:[0,1]
  v_pk_mul_f16 v147, v88, v96 op_sel:[1,0] op_sel_hi:[1,1]
  v_pk_mul_f16 v156, v102, v109 op_sel:[0,0] op_sel_hi:[0,1]
  v_pk_mul_f16 v157, v102, v109 op_sel:[1,0] op_sel_hi:[1,1]
  v_pk_mul_f16 v158, v102, v110 op_sel:[0,0] op_sel_hi:[0,1]
  v_pk_mul_f16 v159, v102, v110 op_sel:[1,0] op_sel_hi:[1,1]
  s_waitcnt vmcnt(0)
  v_lshl_add_u32 v16, v16, 7, v8
  v_lshl_add_u32 v17, v17, 7, v8
  v_lshl_add_u32 v18, v18, 7, v8
  v_lshl_add_u32 v19, v19, 7, v8
  s_add_u32 m0, s76, 0
  s_mov_b32 exec_hi, 0xffffff
  buffer_load_dwordx4 v16, s[32:35], 0 offen lds
  s_add_u32 m0, s76, 1056
  s_nop 0
  buffer_load_dwordx4 v17, s[32:35], 0 offen lds
  s_add_u32 m0, s76, 2112
  s_mov_b32 exec_hi, 0xffff
  buffer_load_dwordx4 v18, s[32:35], 0 offen lds
  s_add_u32 m0, s76, 3168
  s_nop 0
  buffer_load_dwordx4 v19, s[32:35], 0 offen lds
  s_mov_b32 exec_hi, -1
  buffer_load_dwordx4 v[16:19], v6, s[28:31], s94 offen
  s_add_u32 s94, s94, 416
L_novm:
  v_add_u32 v10, s81, v10
  v_add_u32 v4, s81, v4
  v_add_u32 v5, s81, v5
  s_sub_u32 s76, s76, s81
  s_sub_u32 s81, 0, s81
  s_mov_b32 s51, 0
  s_waitcnt lgkmcnt(14)
  s_setprio 1
  v_mfma_f32_16x16x32_bf16 v[184:187], v[164:167], v[124:127], 0
  ds_read_b128 v[180:183], v1 offset:7168
  v_pk_mul_f16 v116, v60, v69 op_sel:[0,0] op_sel_hi:[0,1]
  v_mfma_f32_16x16x32_bf16 v[200:203], v[164:167], v[136:139], 0
  v_pk_mul_f16 v117, v60, v69 op_sel:[1,0] op_sel_hi:[1,1]
  v_mfma_f32_16x16x32_bf16 v[216:219], v[164:167], v[148:151], 0
  v_pk_mul_f16 v118, v60, v70 op_sel:[0,0] op_sel_hi:[0,1]
  v_mfma_f32_16x16x32_bf16 v[232:235], v[164:167], v[160:163], 0
  v_pk_mul_f16 v119, v60, v70 op_sel:[1,0] op_sel_hi:[1,1]
  v_mfma_f32_16x16x32_bf16 v[188:191], v[168:171], v[124:127], 0
  ds_read_b128 v[164:167], v1 offset:5120
  v_pk_mul_f16 v128, v74, v83 op_sel:[0,0] op_sel_hi:[0,1]
  v_mfma_f32_16x16x32_bf16 v[204:207], v[168:171], v[136:139], 0
  v_pk_mul_f16 v129, v74, v83 op_sel:[1,0] op_sel_hi:[1,1]
  v_mfma_f32_16x16x32_bf16 v[220:223], v[168:171], v[148:151], 0
  v_pk_mul_f16 v130, v74, v84 op_sel:[0,0] op_sel_hi:[0,1]
  v_mfma_f32_16x16x32_bf16 v[236:239], v[168:171], v[160:163], 0
  v_pk_mul_f16 v131, v74, v84 op_sel:[1,0] op_sel_hi:[1,1]
  v_mfma_f32_16x16x32_f16 v[192:195], v[172:175], v[120:123], 0
  ds_read_b128 v[168:171], v1 offset:11264
  v_pk_mul_f16 v140, v88, v97 op_sel:[0,0] op_sel_hi:[0,1]
  v_mfma_f32_16x16x32_f16 v[208:211], v[172:175], v[132:135], 0
  v_pk_mul_f16 v141, v88, v97 op_sel:[1,0] op_sel_hi:[1,1]
  v_mfma_f32_16x16x32_f16 v[224:227], v[172:175], v[144:147], 0
  s_nop 0
  s_waitcnt lgkmcnt(14)
  v_pk_mul_f16 v142, v88, v98 op_sel:[0,0] op_sel_hi:[0,1]
  v_mfma_f32_16x16x32_f16 v[240:243], v[172:175], v[156:159], 0
  v_pk_mul_f16 v143, v88, v98 op_sel:[1,0] op_sel_hi:[1,1]
  v_mfma_f32_16x16x32_f16 v[184:187], v[176:179], v[120:123], v[184:187]
  ds_read_b128 v[172:175], v1 offset:9216
  v_pk_mul_f16 v152, v102, v111 op_sel:[0,0] op_sel_hi:[0,1]
  v_mfma_f32_16x16x32_f16 v[200:203], v[176:179], v[132:135], v[200:203]
  v_pk_mul_f16 v153, v102, v111 op_sel:[1,0] op_sel_hi:[1,1]
  v_mfma_f32_16x16x32_f16 v[216:219], v[176:179], v[144:147], v[216:219]
  s_setprio 2
  s_waitcnt lgkmcnt(14)
  v_pk_mul_f16 v154, v102, v112 op_sel:[0,0] op_sel_hi:[0,1]
  v_mfma_f32_16x16x32_f16 v[232:235], v[176:179], v[156:159], v[232:235]
  s_nop 0
  s_waitcnt lgkmcnt(3)
  v_pk_mul_f16 v155, v102, v112 op_sel:[1,0] op_sel_hi:[1,1]
  v_mfma_f32_16x16x32_f16 v[188:191], v[180:183], v[120:123], v[188:191]
  ds_read_b128 v[176:179], v1 offset:10240
  v_pk_mul_f16 v124, v61, v68 op_sel:[0,0] op_sel_hi:[0,1]
  v_mfma_f32_16x16x32_f16 v[204:207], v[180:183], v[132:135], v[204:207]
  v_pk_mul_f16 v125, v61, v68 op_sel:[1,0] op_sel_hi:[1,1]
  v_mfma_f32_16x16x32_f16 v[220:223], v[180:183], v[144:147], v[220:223]
  v_pk_mul_f16 v126, v61, v69 op_sel:[0,0] op_sel_hi:[0,1]
  v_mfma_f32_16x16x32_f16 v[236:239], v[180:183], v[156:159], v[236:239]
  s_nop 0
  s_waitcnt lgkmcnt(3)
  v_pk_mul_f16 v127, v61, v69 op_sel:[1,0] op_sel_hi:[1,1]
  v_mfma_f32_16x16x32_f16 v[196:199], v[164:167], v[120:123], 0
  ds_read_b128 v[180:183], v1 offset:14336
  v_pk_mul_f16 v136, v75, v82 op_sel:[0,0] op_sel_hi:[0,1]
  v_mfma_f32_16x16x32_f16 v[212:215], v[164:167], v[132:135], 0
  v_pk_mul_f16 v120, v60, v71 op_sel:[0,0] op_sel_hi:[0,1]
  v_mfma_f32_16x16x32_f16 v[228:231], v[164:167], v[144:147], 0
  v_pk_mul_f16 v121, v60, v71 op_sel:[1,0] op_sel_hi:[1,1]
  v_mfma_f32_16x16x32_f16 v[244:247], v[164:167], v[156:159], 0
  s_waitcnt lgkmcnt(3)
  v_pk_mul_f16 v122, v60, v66 op_sel:[0,1] op_sel_hi:[0,0]
  v_mfma_f32_16x16x32_f16 v[192:195], v[168:171], v[116:119], v[192:195]
  ds_read_b128 v[164:167], v1 offset:12288
  v_pk_mul_f16 v123, v60, v72 op_sel:[0,0] op_sel_hi:[1,0]
  v_mfma_f32_16x16x32_f16 v[208:211], v[168:171], v[128:131], v[208:211]
  v_pk_mul_f16 v132, v74, v85 op_sel:[0,0] op_sel_hi:[0,1]
  v_mfma_f32_16x16x32_f16 v[224:227], v[168:171], v[140:143], v[224:227]
  s_nop 0
  v_pk_mul_f16 v133, v74, v85 op_sel:[1,0] op_sel_hi:[1,1]
  v_mfma_f32_16x16x32_f16 v[240:243], v[168:171], v[152:155], v[240:243]
  s_waitcnt lgkmcnt(3)
  v_pk_mul_f16 v134, v74, v80 op_sel:[0,1] op_sel_hi:[0,0]
  v_mfma_f32_16x16x32_f16 v[184:187], v[172:175], v[116:119], v[184:187]
  ds_read_b128 v[168:171], v1 offset:13312
  v_pk_mul_f16 v135, v74, v86 op_sel:[0,0] op_sel_hi:[1,0]
  v_mfma_f32_16x16x32_f16 v[200:203], v[172:175], v[128:131], v[200:203]
  s_nop 0
  v_pk_mul_f16 v144, v88, v99 op_sel:[0,0] op_sel_hi:[0,1]
  v_mfma_f32_16x16x32_f16 v[216:219], v[172:175], v[140:143], v[216:219]
  v_pk_mul_f16 v145, v88, v99 op_sel:[1,0] op_sel_hi:[1,1]
  v_mfma_f32_16x16x32_f16 v[232:235], v[172:175], v[152:155], v[232:235]
  s_nop 0
  s_waitcnt lgkmcnt(3)
  v_pk_mul_f16 v146, v88, v94 op_sel:[0,1] op_sel_hi:[0,0]
  v_mfma_f32_16x16x32_f16 v[188:191], v[176:179], v[116:119], v[188:191]
  ds_read_b128 v[172:175], v1 offset:0
  v_pk_mul_f16 v147, v88, v100 op_sel:[0,0] op_sel_hi:[1,0]
  v_mfma_f32_16x16x32_f16 v[204:207], v[176:179], v[128:131], v[204:207]
  v_pk_mul_f16 v156, v102, v113 op_sel:[0,0] op_sel_hi:[0,1]
  v_mfma_f32_16x16x32_f16 v[220:223], v[176:179], v[140:143], v[220:223]
  v_pk_mul_f16 v157, v102, v113 op_sel:[1,0] op_sel_hi:[1,1]
  v_mfma_f32_16x16x32_f16 v[236:239], v[176:179], v[152:155], v[236:239]
  s_nop 0
  s_waitcnt lgkmcnt(3)
  v_pk_mul_f16 v158, v102, v108 op_sel:[0,1] op_sel_hi:[0,0]
  v_mfma_f32_16x16x32_f16 v[192:195], v[180:183], v[120:123], v[192:195]
  ds_read_b128 v[176:179], v1 offset:17408
  v_pk_mul_f16 v159, v102, v114 op_sel:[0,0] op_sel_hi:[1,0]
  v_mfma_f32_16x16x32_f16 v[208:211], v[180:183], v[132:135], v[208:211]
  v_pk_mul_f16 v137, v75, v82 op_sel:[1,0] op_sel_hi:[1,1]
  v_mfma_f32_16x16x32_f16 v[224:227], v[180:183], v[144:147], v[224:227]
  v_pk_mul_f16 v138, v75, v83 op_sel:[0,0] op_sel_hi:[0,1]
  v_mfma_f32_16x16x32_f16 v[240:243], v[180:183], v[156:159], v[240:243]
  s_waitcnt lgkmcnt(3)
  v_pk_mul_f16 v139, v75, v83 op_sel:[1,0] op_sel_hi:[1,1]
  v_mfma_f32_16x16x32_f16 v[184:187], v[164:167], v[120:123], v[184:187]
  ds_read_b128 v[180:183], v1 offset:15360
  v_pk_mul_f16 v148, v89, v96 op_sel:[0,0] op_sel_hi:[0,1]
  v_mfma_f32_16x16x32_f16 v[200:203], v[164:167], v[132:135], v[200:203]
  v_pk_mul_f16 v149, v89, v96 op_sel:[1,0] op_sel_hi:[1,1]
  v_mfma_f32_16x16x32_f16 v[216:219], v[164:167], v[144:147], v[216:219]
  s_nop 0
  v_pk_mul_f16 v150, v89, v97 op_sel:[0,0] op_sel_hi:[0,1]
  v_mfma_f32_16x16x32_f16 v[232:235], v[164:167], v[156:159], v[232:235]
  s_waitcnt lgkmcnt(3)
  v_pk_mul_f16 v151, v89, v97 op_sel:[1,0] op_sel_hi:[1,1]
  v_mfma_f32_16x16x32_f16 v[188:191], v[168:171], v[120:123], v[188:191]
  ds_read_b128 v[164:167], v1 offset:16384
  v_pk_mul_f16 v160, v103, v110 op_sel:[0,0] op_sel_hi:[0,1]
  v_mfma_f32_16x16x32_f16 v[204:207], v[168:171], v[132:135], v[204:207]
  s_nop 0
  v_pk_mul_f16 v161, v103, v110 op_sel:[1,0] op_sel_hi:[1,1]
  v_mfma_f32_16x16x32_f16 v[220:223], v[168:171], v[144:147], v[220:223]
  v_pk_mul_f16 v162, v103, v111 op_sel:[0,0] op_sel_hi:[0,1]
  v_mfma_f32_16x16x32_f16 v[236:239], v[168:171], v[156:159], v[236:239]
  s_waitcnt lgkmcnt(3)
  v_pk_mul_f16 v163, v103, v111 op_sel:[1,0] op_sel_hi:[1,1]
  v_smfmac_f32_16x16x64_f16 v[196:199], v[172:175], v[116:123], v9
  s_nop 0
  ds_read_b128 v[168:171], v1 offset:20480
  v_smfmac_f32_16x16x64_f16 v[212:215], v[172:175], v[128:135], v9
  v_pk_mul_f16 v120, v61, v70 op_sel:[0,0] op_sel_hi:[0,1]
  v_smfmac_f32_16x16x64_f16 v[228:231], v[172:175], v[140:147], v9
  v_pk_mul_f16 v121, v61, v70 op_sel:[1,0] op_sel_hi:[1,1]
  v_smfmac_f32_16x16x64_f16 v[244:247], v[172:175], v[152:159], v9
  s_nop 0
  s_waitcnt lgkmcnt(3)
  v_pk_mul_f16 v122, v61, v71 op_sel:[0,0] op_sel_hi:[0,1]
  v_mfma_f32_16x16x32_f16 v[192:195], v[176:179], v[124:127], v[192:195]
  ds_read_b128 v[172:175], v1 offset:18432
  v_pk_mul_f16 v123, v61, v71 op_sel:[1,0] op_sel_hi:[1,1]
  v_mfma_f32_16x16x32_f16 v[208:211], v[176:179], v[136:139], v[208:211]
  v_pk_mul_f16 v132, v75, v84 op_sel:[0,0] op_sel_hi:[0,1]
  v_mfma_f32_16x16x32_f16 v[224:227], v[176:179], v[148:151], v[224:227]
  v_pk_mul_f16 v133, v75, v84 op_sel:[1,0] op_sel_hi:[1,1]
  v_mfma_f32_16x16x32_f16 v[240:243], v[176:179], v[160:163], v[240:243]
  s_nop 0
  s_waitcnt lgkmcnt(3)
  v_pk_mul_f16 v134, v75, v85 op_sel:[0,0] op_sel_hi:[0,1]
  v_mfma_f32_16x16x32_f16 v[184:187], v[180:183], v[124:127], v[184:187]
  ds_read_b128 v[176:179], v1 offset:19456
  v_pk_mul_f16 v135, v75, v85 op_sel:[1,0] op_sel_hi:[1,1]
  v_mfma_f32_16x16x32_f16 v[200:203], v[180:183], v[136:139], v[200:203]
  v_pk_mul_f16 v144, v89, v98 op_sel:[0,0] op_sel_hi:[0,1]
  v_mfma_f32_16x16x32_f16 v[216:219], v[180:183], v[148:151], v[216:219]
  v_pk_mul_f16 v145, v89, v98 op_sel:[1,0] op_sel_hi:[1,1]
  v_mfma_f32_16x16x32_f16 v[232:235], v[180:183], v[160:163], v[232:235]
  s_waitcnt lgkmcnt(3)
  v_pk_mul_f16 v146, v89, v99 op_sel:[0,0] op_sel_hi:[0,1]
  v_mfma_f32_16x16x32_f16 v[188:191], v[164:167], v[124:127], v[188:191]
  ds_read_b128 v[180:183], v1 offset:1024
  v_pk_mul_f16 v147, v89, v99 op_sel:[1,0] op_sel_hi:[1,1]
  v_mfma_f32_16x16x32_f16 v[204:207], v[164:167], v[136:139], v[204:207]
  s_waitcnt vmcnt(1)
  ds_read_u16_d16_hi v32, v10 offset:0
  v_pk_mul_f16 v156, v103, v112 op_sel:[0,0] op_sel_hi:[0,1]
  v_mfma_f32_16x16x32_f16 v[220:223], v[164:167], v[148:151], v[220:223]
  ds_read_u16_d16_hi v33, v10 offset:2
  v_pk_mul_f16 v157, v103, v112 op_sel:[1,0] op_sel_hi:[1,1]
  v_mfma_f32_16x16x32_f16 v[236:239], v[164:167], v[160:163], v[236:239]
  s_nop 0
  s_waitcnt lgkmcnt(5)
  v_pk_mul_f16 v158, v103, v113 op_sel:[0,0] op_sel_hi:[0,1]
  v_mfma_f32_16x16x32_f16 v[192:195], v[168:171], v[120:123], v[192:195]
  ds_read_b128 v[164:167], v1 offset:23552
  v_pk_mul_f16 v159, v103, v113 op_sel:[1,0] op_sel_hi:[1,1]
  v_mfma_f32_16x16x32_f16 v[208:211], v[168:171], v[132:135], v[208:211]
  ds_read_u16_d16_hi v34, v10 offset:2112
  v_pk_mul_f16 v116, v61, v67 op_sel:[0,1] op_sel_hi:[0,0]
  v_mfma_f32_16x16x32_f16 v[224:227], v[168:171], v[144:147], v[224:227]
  ds_read_u16_d16_hi v35, v10 offset:2114
  v_pk_mul_f16 v117, v61, v72 op_sel:[0,0] op_sel_hi:[1,0]
  v_mfma_f32_16x16x32_f16 v[240:243], v[168:171], v[156:159], v[240:243]
  s_nop 0
  s_waitcnt lgkmcnt(7)
  v_pk_mul_f16 v118, v62, v69 op_sel:[0,0] op_sel_hi:[0,1]
  v_mfma_f32_16x16x32_f16 v[184:187], v[172:175], v[120:123], v[184:187]
  ds_read_b128 v[168:171], v1 offset:21504
  v_pk_mul_f16 v119, v62, v69 op_sel:[1,0] op_sel_hi:[1,1]
  v_mfma_f32_16x16x32_f16 v[200:203], v[172:175], v[132:135], v[200:203]
  ds_read_b64_tr_b16 v[60:61], v27 offset:0
  v_pk_mul_f16 v128, v75, v81 op_sel:[0,1] op_sel_hi:[0,0]
  v_mfma_f32_16x16x32_f16 v[216:219], v[172:175], v[144:147], v[216:219]
  ds_read_u16_d16_hi v36, v10 offset:128
  v_pk_mul_f16 v129, v75, v86 op_sel:[0,0] op_sel_hi:[1,0]
  v_mfma_f32_16x16x32_f16 v[232:235], v[172:175], v[156:159], v[232:235]
  s_waitcnt lgkmcnt(9)
  v_pk_mul_f16 v130, v76, v83 op_sel:[0,0] op_sel_hi:[0,1]
  v_pk_mul_f16 v131, v76, v83 op_sel:[1,0] op_sel_hi:[1,1]
  v_mfma_f32_16x16x32_f16 v[188:191], v[176:179], v[120:123], v[188:191]
  ds_read_b128 v[172:175], v1 offset:22528
  v_pk_mul_f16 v140, v89, v95 op_sel:[0,1] op_sel_hi:[0,0]
  v_mfma_f32_16x16x32_f16 v[204:207], v[176:179], v[132:135], v[204:207]
  ds_read_b64_tr_b16 v[74:75], v27 offset:32
  v_pk_mul_f16 v141, v89, v100 op_sel:[0,0] op_sel_hi:[1,0]
  v_mfma_f32_16x16x32_f16 v[220:223], v[176:179], v[144:147], v[220:223]
  ds_read_b64_tr_b16 v[88:89], v27 offset:64
  v_pk_mul_f16 v142, v90, v97 op_sel:[0,0] op_sel_hi:[0,1]
  v_mfma_f32_16x16x32_f16 v[236:239], v[176:179], v[156:159], v[236:239]
  s_waitcnt lgkmcnt(11)
  v_pk_mul_f16 v143, v90, v97 op_sel:[1,0] op_sel_hi:[1,1]
  v_pk_mul_f16 v152, v103, v109 op_sel:[0,1] op_sel_hi:[0,0]
  v_smfmac_f32_16x16x64_f16 v[196:199], v[180:183], v[120:127], v9
  ds_read_b128 v[176:179], v1 offset:26624
  v_pk_mul_f16 v153, v103, v114 op_sel:[0,0] op_sel_hi:[1,0]
  v_smfmac_f32_16x16x64_f16 v[212:215], v[180:183], v[132:139], v9
  ds_read_b64_tr_b16 v[102:103], v27 offset:96
  v_pk_mul_f16 v154, v104, v111 op_sel:[0,0] op_sel_hi:[0,1]
  v_smfmac_f32_16x16x64_f16 v[228:231], v[180:183], v[144:151], v9
  ds_read_u16_d16_hi v37, v10 offset:130
  v_pk_mul_f16 v155, v104, v111 op_sel:[1,0] op_sel_hi:[1,1]
  v_smfmac_f32_16x16x64_f16 v[244:247], v[180:183], v[156:163], v9
  s_nop 0
  s_waitcnt lgkmcnt(11)
  v_pk_mul_f16 v120, v62, v70 op_sel:[0,0] op_sel_hi:[0,1]
  v_mfma_f32_16x16x32_f16 v[192:195], v[164:167], v[116:119], v[192:195]
  ds_read_b128 v[180:183], v1 offset:24576
  v_pk_mul_f16 v121, v62, v70 op_sel:[1,0] op_sel_hi:[1,1]
  v_mfma_f32_16x16x32_f16 v[208:211], v[164:167], v[128:131], v[208:211]
  ds_read_u16_d16_hi v38, v10 offset:2240
  v_pk_mul_f16 v122, v62, v71 op_sel:[0,0] op_sel_hi:[0,1]
  v_mfma_f32_16x16x32_f16 v[224:227], v[164:167], v[140:143], v[224:227]
  ds_read_u16_d16_hi v39, v10 offset:2242
  v_pk_mul_f16 v123, v62, v71 op_sel:[1,0] op_sel_hi:[1,1]
  v_mfma_f32_16x16x32_f16 v[240:243], v[164:167], v[152:155], v[240:243]
  s_waitcnt lgkmcnt(11)
  v_pk_mul_f16 v132, v76, v84 op_sel:[0,0] op_sel_hi:[0,1]
  v_max3_f32 v58, |v32|, |v33|, 0
  v_mfma_f32_16x16x32_f16 v[184:187], v[168:171], v[116:119], v[184:187]
  ds_read_b128 v[164:167], v1 offset:25600
  v_pk_mul_f16 v133, v76, v84 op_sel:[1,0] op_sel_hi:[1,1]
  v_mfma_f32_16x16x32_f16 v[200:203], v[168:171], v[128:131], v[200:203]
  ds_read_u16_d16_hi v40, v10 offset:256
  v_pk_mul_f16 v134, v76, v85 op_sel:[0,0] op_sel_hi:[0,1]
  v_mfma_f32_16x16x32_f16 v[216:219], v[168:171], v[140:143], v[216:219]
  ds_read_u16_d16_hi v41, v10 offset:258
  v_pk_mul_f16 v135, v76, v85 op_sel:[1,0] op_sel_hi:[1,1]
  v_mfma_f32_16x16x32_f16 v[232:235], v[168:171], v[152:155], v[232:235]
  s_waitcnt lgkmcnt(11)
  v_pk_mul_f16 v144, v90, v98 op_sel:[0,0] op_sel_hi:[0,1]
  v_max3_f32 v58, |v34|, |v35|, v58
  v_mfma_f32_16x16x32_f16 v[188:191], v[172:175], v[116:119], v[188:191]
  ds_read_b128 v[168:171], v1 offset:2048
  v_pk_mul_f16 v145, v90, v98 op_sel:[1,0] op_sel_hi:[1,1]
  v_mfma_f32_16x16x32_f16 v[204:207], v[172:175], v[128:131], v[204:207]
  ds_read_u16_d16_hi v42, v10 offset:2368
  v_pk_mul_f16 v146, v90, v99 op_sel:[0,0] op_sel_hi:[0,1]
  v_mfma_f32_16x16x32_f16 v[220:223], v[172:175], v[140:143], v[220:223]
  ds_read_u16_d16_hi v43, v10 offset:2370
  v_pk_mul_f16 v147, v90, v99 op_sel:[1,0] op_sel_hi:[1,1]
  v_mfma_f32_16x16x32_f16 v[236:239], v[172:175], v[152:155], v[236:239]
  s_nop 0
  s_waitcnt lgkmcnt(11)
  v_pk_mul_f16 v156, v104, v112 op_sel:[0,0] op_sel_hi:[0,1]
  v_mfma_f32_16x16x32_f16 v[192:195], v[176:179], v[120:123], v[192:195]
  ds_read_b128 v[172:175], v1 offset:29696
  v_pk_mul_f16 v157, v104, v112 op_sel:[1,0] op_sel_hi:[1,1]
  v_mfma_f32_16x16x32_f16 v[208:211], v[176:179], v[132:135], v[208:211]
  ds_read_u16_d16_hi v44, v10 offset:384
  v_pk_mul_f16 v158, v104, v113 op_sel:[0,0] op_sel_hi:[0,1]
  v_mfma_f32_16x16x32_f16 v[224:227], v[176:179], v[144:147], v[224:227]
  ds_read_u16_d16_hi v45, v10 offset:386
  v_pk_mul_f16 v159, v104, v113 op_sel:[1,0] op_sel_hi:[1,1]
  s_nop 1
  v_mfma_f32_16x16x32_f16 v[240:243], v[176:179], v[156:159], v[240:243]
  s_waitcnt lgkmcnt(11)
  v_pk_mul_f16 v124, v62, v68 op_sel:[0,1] op_sel_hi:[0,0]
  v_mfma_f32_16x16x32_f16 v[184:187], v[180:183], v[120:123], v[184:187]
  ds_read_b128 v[176:179], v1 offset:27648
  v_pk_mul_f16 v125, v62, v72 op_sel:[0,0] op_sel_hi:[1,0]
  v_mfma_f32_16x16x32_f16 v[200:203], v[180:183], v[132:135], v[200:203]
  ds_read_u16_d16_hi v46, v10 offset:2496
  v_pk_mul_f16 v126, v63, v70 op_sel:[0,0] op_sel_hi:[0,1]
  v_mfma_f32_16x16x32_f16 v[216:219], v[180:183], v[144:147], v[216:219]
  ds_read_u16_d16_hi v47, v10 offset:2498
  v_pk_mul_f16 v127, v63, v70 op_sel:[1,0] op_sel_hi:[1,1]
  v_mfma_f32_16x16x32_f16 v[232:235], v[180:183], v[156:159], v[232:235]
  s_waitcnt lgkmcnt(11)
  v_pk_mul_f16 v136, v76, v82 op_sel:[0,1] op_sel_hi:[0,0]
  v_pk_mul_f16 v137, v76, v86 op_sel:[0,0] op_sel_hi:[1,0]
  v_mfma_f32_16x16x32_f16 v[188:191], v[164:167], v[120:123], v[188:191]
  ds_read_b128 v[180:183], v1 offset:28672
  v_pk_mul_f16 v138, v77, v84 op_sel:[0,0] op_sel_hi:[0,1]
  v_mfma_f32_16x16x32_f16 v[204:207], v[164:167], v[132:135], v[204:207]
  ds_read_u16_d16_hi v48, v10 offset:512
  v_pk_mul_f16 v139, v77, v84 op_sel:[1,0] op_sel_hi:[1,1]
  v_mfma_f32_16x16x32_f16 v[220:223], v[164:167], v[144:147], v[220:223]
  ds_read_u16_d16_hi v49, v10 offset:514
  v_pk_mul_f16 v148, v90, v96 op_sel:[0,1] op_sel_hi:[0,0]
  v_mfma_f32_16x16x32_f16 v[236:239], v[164:167], v[156:159], v[236:239]
  s_waitcnt lgkmcnt(11)
  v_pk_mul_f16 v149, v90, v100 op_sel:[0,0] op_sel_hi:[1,0]
  v_pk_mul_f16 v150, v91, v98 op_sel:[0,0] op_sel_hi:[0,1]
  v_smfmac_f32_16x16x64_f16 v[196:199], v[168:171], v[116:123], v9
  ds_read_b128 v[164:167], v1 offset:32768
  v_pk_mul_f16 v151, v91, v98 op_sel:[1,0] op_sel_hi:[1,1]
  v_smfmac_f32_16x16x64_f16 v[212:215], v[168:171], v[128:135], v9
  ds_read_u16_d16_hi v50, v10 offset:2624
  v_pk_mul_f16 v160, v104, v110 op_sel:[0,1] op_sel_hi:[0,0]
  v_smfmac_f32_16x16x64_f16 v[228:231], v[168:171], v[140:147], v9
  ds_read_u16_d16_hi v51, v10 offset:2626
  v_pk_mul_f16 v161, v104, v114 op_sel:[0,0] op_sel_hi:[1,0]
  v_smfmac_f32_16x16x64_f16 v[244:247], v[168:171], v[152:159], v9
  s_nop 0
  s_waitcnt lgkmcnt(11)
  v_pk_mul_f16 v162, v105, v112 op_sel:[0,0] op_sel_hi:[0,1]
  v_mfma_f32_16x16x32_f16 v[192:195], v[172:175], v[124:127], v[192:195]
  ds_read_b128 v[168:171], v1 offset:30720
  v_pk_mul_f16 v163, v105, v112 op_sel:[1,0] op_sel_hi:[1,1]
  v_mfma_f32_16x16x32_f16 v[208:211], v[172:175], v[136:139], v[208:211]
  ds_read_u16_d16_hi v52, v10 offset:640
  v_pk_mul_f16 v120, v63, v71 op_sel:[0,0] op_sel_hi:[0,1]
  v_mfma_f32_16x16x32_f16 v[224:227], v[172:175], v[148:151], v[224:227]
  ds_read_u16_d16_hi v53, v10 offset:642
  v_pk_mul_f16 v121, v63, v71 op_sel:[1,0] op_sel_hi:[1,1]
  v_mfma_f32_16x16x32_f16 v[240:243], v[172:175], v[160:163], v[240:243]
  s_waitcnt lgkmcnt(11)
  v_pk_mul_f16 v122, v63, v69 op_sel:[0,1] op_sel_hi:[1,1]
  v_pk_mul_f16 v123, v63, v72 op_sel:[0,0] op_sel_hi:[1,0]
  v_mfma_f32_16x16x32_f16 v[184:187], v[176:179], v[124:127], v[184:187]
  ds_read_b128 v[172:175], v1 offset:31744
  v_pk_mul_f16 v132, v77, v85 op_sel:[0,0] op_sel_hi:[0,1]
  v_mfma_f32_16x16x32_f16 v[200:203], v[176:179], v[136:139], v[200:203]
  ds_read_u16_d16_hi v54, v10 offset:2752
  v_pk_mul_f16 v133, v77, v85 op_sel:[1,0] op_sel_hi:[1,1]
  v_mfma_f32_16x16x32_f16 v[216:219], v[176:179], v[148:151], v[216:219]
  ds_read_u16_d16_hi v55, v10 offset:2754
  v_pk_mul_f16 v134, v77, v83 op_sel:[0,1] op_sel_hi:[1,1]
  v_mfma_f32_16x16x32_f16 v[232:235], v[176:179], v[160:163], v[232:235]
  s_waitcnt lgkmcnt(11)
  v_pk_mul_f16 v135, v77, v86 op_sel:[0,0] op_sel_hi:[1,0]
  v_pk_mul_f16 v144, v91, v99 op_sel:[0,0] op_sel_hi:[0,1]
  v_mfma_f32_16x16x32_f16 v[188:191], v[180:183], v[124:127], v[188:191]
  ds_read_b128 v[176:179], v1 offset:3072
  v_pk_mul_f16 v145, v91, v99 op_sel:[1,0] op_sel_hi:[1,1]
  v_mfma_f32_16x16x32_f16 v[204:207], v[180:183], v[136:139], v[204:207]
  ds_read_u16_d16_hi v56, v10 offset:768
  v_pk_mul_f16 v146, v91, v97 op_sel:[0,1] op_sel_hi:[1,1]
  v_mfma_f32_16x16x32_f16 v[220:223], v[180:183], v[148:151], v[220:223]
  ds_read_u16_d16_hi v57, v10 offset:770
  v_pk_mul_f16 v147, v91, v100 op_sel:[0,0] op_sel_hi:[1,0]
  v_mfma_f32_16x16x32_f16 v[236:239], v[180:183], v[160:163], v[236:239]
  s_waitcnt lgkmcnt(11)
  v_pk_mul_f16 v156, v105, v113 op_sel:[0,0] op_sel_hi:[0,1]
  v_max3_f32 v58, |v36|, |v37|, v58
  v_mfma_f32_16x16x32_f16 v[192:195], v[164:167], v[120:123], v[192:195]
  ds_read_b128 v[180:183], v1 offset:35840
  v_pk_mul_f16 v157, v105, v113 op_sel:[1,0] op_sel_hi:[1,1]
  v_mfma_f32_16x16x32_f16 v[208:211], v[164:167], v[132:135], v[208:211]
  s_nop 0
  v_pk_mul_f16 v158, v105, v111 op_sel:[0,1] op_sel_hi:[1,1]
  v_max3_f32 v58, |v38|, |v39|, v58
  v_mfma_f32_16x16x32_f16 v[224:227], v[164:167], v[144:147], v[224:227]
  v_pk_mul_f16 v159, v105, v114 op_sel:[0,0] op_sel_hi:[1,0]
  v_max3_f32 v58, |v40|, |v41|, v58
  s_nop 0
  v_mfma_f32_16x16x32_f16 v[240:243], v[164:167], v[156:159], v[240:243]
  s_waitcnt lgkmcnt(9)
  v_pk_mul_f16 v116, v64, v71 op_sel:[0,0] op_sel_hi:[0,1]
  v_mfma_f32_16x16x32_f16 v[184:187], v[168:171], v[120:123], v[184:187]
  ds_read_b128 v[164:167], v1 offset:33792
  v_pk_mul_f16 v117, v64, v71 op_sel:[1,0] op_sel_hi:[1,1]
  v_mfma_f32_16x16x32_f16 v[200:203], v[168:171], v[132:135], v[200:203]
  v_pk_mul_f16 v118, v64, v70 op_sel:[0,1] op_sel_hi:[1,1]
  v_max3_f32 v58, |v42|, |v43|, v58
  v_mfma_f32_16x16x32_f16 v[216:219], v[168:171], v[144:147], v[216:219]
  v_pk_mul_f16 v119, v64, v72 op_sel:[0,0] op_sel_hi:[1,0]
  v_pk_mul_f16 v128, v78, v85 op_sel:[0,0] op_sel_hi:[0,1]
  v_mfma_f32_16x16x32_f16 v[232:235], v[168:171], v[156:159], v[232:235]
  s_waitcnt lgkmcnt(7)
  v_pk_mul_f16 v129, v78, v85 op_sel:[1,0] op_sel_hi:[1,1]
  v_pk_mul_f16 v130, v78, v84 op_sel:[0,1] op_sel_hi:[1,1]
  v_mfma_f32_16x16x32_f16 v[188:191], v[172:175], v[120:123], v[188:191]
  ds_read_b128 v[168:171], v1 offset:34816
  v_pk_mul_f16 v131, v78, v86 op_sel:[0,0] op_sel_hi:[1,0]
  v_mfma_f32_16x16x32_f16 v[204:207], v[172:175], v[132:135], v[204:207]
  v_pk_mul_f16 v140, v92, v99 op_sel:[0,0] op_sel_hi:[0,1]
  v_pk_mul_f16 v141, v92, v99 op_sel:[1,0] op_sel_hi:[1,1]
  v_mfma_f32_16x16x32_f16 v[220:223], v[172:175], v[144:147], v[220:223]
  v_pk_mul_f16 v142, v92, v98 op_sel:[0,1] op_sel_hi:[1,1]
  v_pk_mul_f16 v143, v92, v100 op_sel:[0,0] op_sel_hi:[1,0]
  v_mfma_f32_16x16x32_f16 v[236:239], v[172:175], v[156:159], v[236:239]
  s_waitcnt lgkmcnt(5)
  v_pk_mul_f16 v152, v106, v113 op_sel:[0,0] op_sel_hi:[0,1]
  v_smfmac_f32_16x16x64_f16 v[196:199], v[176:179], v[120:127], v9
  ds_read_b128 v[172:175], v1 offset:38912
  v_pk_mul_f16 v153, v106, v113 op_sel:[1,0] op_sel_hi:[1,1]
  v_smfmac_f32_16x16x64_f16 v[212:215], v[176:179], v[132:139], v9
  v_pk_mul_f16 v154, v106, v112 op_sel:[0,1] op_sel_hi:[1,1]
  v_smfmac_f32_16x16x64_f16 v[228:231], v[176:179], v[144:151], v9
  v_pk_mul_f16 v155, v106, v114 op_sel:[0,0] op_sel_hi:[1,0]
  v_smfmac_f32_16x16x64_f16 v[244:247], v[176:179], v[156:163], v9
  s_waitcnt lgkmcnt(3)
  v_pk_mul_f16 v120, v65, v71 op_sel:[0,1] op_sel_hi:[1,1]
  v_mfma_f32_16x16x32_f16 v[192:195], v[180:183], v[116:119], v[192:195]
  ds_read_b128 v[176:179], v1 offset:36864
  v_pk_mul_f16 v121, v65, v72 op_sel:[0,0] op_sel_hi:[1,0]
  v_mfma_f32_16x16x32_f16 v[208:211], v[180:183], v[128:131], v[208:211]
  s_nop 0
  v_pk_mul_f16 v122, v72, v72 op_sel:[0,0] op_sel_hi:[1,1]
  v_max3_f32 v58, |v44|, |v45|, v58
  v_mfma_f32_16x16x32_f16 v[224:227], v[180:183], v[140:143], v[224:227]
  v_pk_mul_f16 v123, v60, v61 op_sel:[0,0] op_sel_hi:[1,1]
  v_max3_f32 v58, |v46|, |v47|, v58
  v_mfma_f32_16x16x32_f16 v[240:243], v[180:183], v[152:155], v[240:243]
  s_nop 0
  s_waitcnt lgkmcnt(3)
  v_pk_mul_f16 v132, v79, v85 op_sel:[0,1] op_sel_hi:[1,1]
  v_mfma_f32_16x16x32_f16 v[184:187], v[164:167], v[116:119], v[184:187]
  ds_read_b128 v[180:183], v1 offset:37888
  v_pk_mul_f16 v133, v79, v86 op_sel:[0,0] op_sel_hi:[1,0]
  v_mfma_f32_16x16x32_f16 v[200:203], v[164:167], v[128:131], v[200:203]
  v_pk_mul_f16 v134, v86, v86 op_sel:[0,0] op_sel_hi:[1,1]
  v_max3_f32 v58, |v48|, |v49|, v58
  v_mfma_f32_16x16x32_f16 v[216:219], v[164:167], v[140:143], v[216:219]
  v_pk_mul_f16 v135, v74, v75 op_sel:[0,0] op_sel_hi:[1,1]
  v_max3_f32 v58, |v50|, |v51|, v58
  v_mfma_f32_16x16x32_f16 v[232:235], v[164:167], v[152:155], v[232:235]
  s_waitcnt lgkmcnt(3)
  v_pk_mul_f16 v144, v93, v99 op_sel:[0,1] op_sel_hi:[1,1]
  v_mfma_f32_16x16x32_f16 v[188:191], v[168:171], v[116:119], v[188:191]
  ds_read_b128 v[164:167], v1 offset:4096
  v_pk_mul_f16 v145, v93, v100 op_sel:[0,0] op_sel_hi:[1,0]
  v_mfma_f32_16x16x32_f16 v[204:207], v[168:171], v[128:131], v[204:207]
  s_nop 0
  v_pk_mul_f16 v146, v100, v100 op_sel:[0,0] op_sel_hi:[1,1]
  v_max3_f32 v58, |v52|, |v53|, v58
  v_mfma_f32_16x16x32_f16 v[220:223], v[168:171], v[140:143], v[220:223]
  v_pk_mul_f16 v147, v88, v89 op_sel:[0,0] op_sel_hi:[1,1]
  v_max3_f32 v58, |v54|, |v55|, v58
  v_mfma_f32_16x16x32_f16 v[236:239], v[168:171], v[152:155], v[236:239]
  s_waitcnt lgkmcnt(3)
  v_pk_mul_f16 v156, v107, v113 op_sel:[0,1] op_sel_hi:[1,1]
  v_mfma_f32_16x16x32_f16 v[192:195], v[172:175], v[120:123], v[192:195]
  s_nop 0
  v_pk_mul_f16 v157, v107, v114 op_sel:[0,0] op_sel_hi:[1,0]
  v_max3_f32 v58, |v56|, |v57|, v58
  v_mfma_f32_16x16x32_f16 v[208:211], v[172:175], v[132:135], v[208:211]
  v_pk_mul_f16 v158, v114, v114 op_sel:[0,0] op_sel_hi:[1,1]
  v_cvt_pk_f16_f32 v62, v32, v33
  v_mfma_f32_16x16x32_f16 v[224:227], v[172:175], v[144:147], v[224:227]
  v_pk_mul_f16 v159, v102, v103 op_sel:[0,0] op_sel_hi:[1,1]
  s_nop 1
  v_mfma_f32_16x16x32_f16 v[240:243], v[172:175], v[156:159], v[240:243]
  s_waitcnt lgkmcnt(2)
  v_cvt_pk_f16_f32 v76, v34, v35
  v_cvt_pk_f16_f32 v90, v36, v37
  v_mfma_f32_16x16x32_f16 v[184:187], v[176:179], v[120:123], v[184:187]
  ds_write_b32 v11, v62 offset:0
  v_mfma_f32_16x16x32_f16 v[200:203], v[176:179], v[132:135], v[200:203]
  ds_write_b32 v11, v76 offset:160
  v_mfma_f32_16x16x32_f16 v[216:219], v[176:179], v[144:147], v[216:219]
  ds_write_b32 v11, v90 offset:320
  v_mfma_f32_16x16x32_f16 v[232:235], v[176:179], v[156:159], v[232:235]
  s_waitcnt lgkmcnt(4)
  v_cvt_pk_f16_f32 v104, v38, v39
  v_cvt_pk_f16_f32 v63, v40, v41
  v_mfma_f32_16x16x32_f16 v[188:191], v[180:183], v[120:123], v[188:191]
  ds_write_b32 v11, v104 offset:480
  v_mfma_f32_16x16x32_f16 v[204:207], v[180:183], v[132:135], v[204:207]
  ds_write_b32 v11, v63 offset:640
  v_mfma_f32_16x16x32_f16 v[220:223], v[180:183], v[144:147], v[220:223]
  v_cvt_pk_f16_f32 v77, v42, v43
  v_cvt_pk_f16_f32 v91, v44, v45
  v_mfma_f32_16x16x32_f16 v[236:239], v[180:183], v[156:159], v[236:239]
  s_waitcnt lgkmcnt(5)
  v_cvt_pk_f16_f32 v105, v46, v47
  v_cvt_pk_f16_f32 v66, v48, v49
  v_smfmac_f32_16x16x64_f16 v[196:199], v[164:167], v[116:123], v9
  ds_write_b32 v11, v77 offset:800
  v_smfmac_f32_16x16x64_f16 v[212:215], v[164:167], v[128:135], v9
  ds_write_b32 v11, v91 offset:960
  v_smfmac_f32_16x16x64_f16 v[228:231], v[164:167], v[140:147], v9
  ds_write_b32 v11, v105 offset:1120
  v_smfmac_f32_16x16x64_f16 v[244:247], v[164:167], v[152:159], v9
  ds_write_b32 v11, v66 offset:1280
  s_setprio 0
  s_sub_u32 s72, s72, 1
  s_cmp_eq_u32 s72, 0
  s_cbranch_scc1 L_cin_done
  v_cvt_pk_f16_f32 v80, v50, v51
  v_cvt_pk_f16_f32 v94, v52, v53
  v_cvt_pk_f16_f32 v108, v54, v55
  v_cvt_pk_f16_f32 v67, v56, v57
  ds_write_b32 v11, v80 offset:1440
  ds_write_b32 v11, v94 offset:1600
  ds_write_b32 v11, v108 offset:1760
  ds_write_b32 v11, v67 offset:1920
  s_branch L_cin_loop
L_cslow:
  v_max_f32_dpp v58, v58, v58 row_shr:1 row_mask:0xf bank_mask:0xf
  s_nop 1
  v_max_f32_dpp v58, v58, v58 row_shr:2 row_mask:0xf bank_mask:0xf
  s_nop 1
  v_max_f32_dpp v58, v58, v58 row_shr:4 row_mask:0xf bank_mask:0xf
  s_nop 1
  v_max_f32_dpp v58, v58, v58 row_shr:8 row_mask:0xf bank_mask:0xf
  s_nop 1
  v_max_f32_dpp v58, v58, v58 row_bcast:15 row_mask:0xa bank_mask:0xf
  s_nop 1
  v_max_f32_dpp v58, v58, v58 row_bcast:31 row_mask:0xc bank_mask:0xf
  s_nop 0
  v_readlane_b32 s98, v58, 63
  s_mov_b32 s97, 0
  s_lshr_b32 s98, s98, 23
  s_max_u32 s98, s98, 72
  s_min_u32 s98, s98, 182
  s_sub_u32 s99, 258, s98
  s_lshl_b32 s100, s99, 1
  s_sub_u32 s100, s100, 127
  s_sub_u32 s95, 254, s100
  s_lshl_b32 s95, s95, 23
  v_mov_b32 v60, s95
  v_mul_f32 v61, s0, v60
  v_mul_f32 v60, s1, v60
  v_readfirstlane_b32 s74, v61
  v_readfirstlane_b32 s75, v60
  s_lshl_b32 s99, s99, 23
  s_lshl_b32 s100, s100, 23
  v_mul_f32 v60, s99, v32
  v_mul_f32 v61, s99, v33
  v_mul_f32 v62, s100, v32
  v_mul_f32 v63, s100, v33
  v_cvt_pk_f16_f32 v80, v60, v61
  v_cvt_pk_bf16_f32 v64, v62, v63
  ds_write_b32 v11, v80 offset:0
  ds_write_b32 v10, v64 offset:0
  v_mul_f32 v60, s99, v34
  v_mul_f32 v61, s99, v35
  v_mul_f32 v62, s100, v34
  v_mul_f32 v63, s100, v35
  v_cvt_pk_f16_f32 v81, v60, v61
  v_cvt_pk_bf16_f32 v65, v62, v63
  ds_write_b32 v11, v81 offset:160
  ds_write_b32 v10, v65 offset:2112
  v_mul_f32 v60, s99, v36
  v_mul_f32 v61, s99, v37
  v_mul_f32 v62, s100, v36
  v_mul_f32 v63, s100, v37
  v_cvt_pk_f16_f32 v82, v60, v61
  v_cvt_pk_bf16_f32 v66, v62, v63
  ds_write_b32 v11, v82 offset:320
  ds_write_b32 v10, v66 offset:128
  v_mul_f32 v60, s99, v38
  v_mul_f32 v61, s99, v39
  v_mul_f32 v62, s100, v38
  v_mul_f32 v63, s100, v39
  v_cvt_pk_f16_f32 v83, v60, v61
  v_cvt_pk_bf16_f32 v67, v62, v63
  ds_write_b32 v11, v83 offset:480
  ds_write_b32 v10, v67 offset:2240
  v_mul_f32 v60, s99, v40
  v_mul_f32 v61, s99, v41
  v_mul_f32 v62, s100, v40
  v_mul_f32 v63, s100, v41
  v_cvt_pk_f16_f32 v84, v60, v61
  v_cvt_pk_bf16_f32 v68, v62, v63
  ds_write_b32 v11, v84 offset:640
  ds_write_b32 v10, v68 offset:256
  v_mul_f32 v60, s99, v42
  v_mul_f32 v61, s99, v43
  v_mul_f32 v62, s100, v42
  v_mul_f32 v63, s100, v43
  v_cvt_pk_f16_f32 v85, v60, v61
  v_cvt_pk_bf16_f32 v69, v62, v63
  ds_write_b32 v11, v85 offset:800
  ds_write_b32 v10, v69 offset:2368
  v_mul_f32 v60, s99, v44
  v_mul_f32 v61, s99, v45
  v_mul_f32 v62, s100, v44
  v_mul_f32 v63, s100, v45
  v_cvt_pk_f16_f32 v86, v60, v61
  v_cvt_pk_bf16_f32 v70, v62, v63
  ds_write_b32 v11, v86 offset:960
  ds_write_b32 v10, v70 offset:384
  v_mul_f32 v60, s99, v46
  v_mul_f32 v61, s99, v47
  v_mul_f32 v62, s100, v46
  v_mul_f32 v63, s100, v47
  v_cvt_pk_f16_f32 v87, v60, v61
  v_cvt_pk_bf16_f32 v71, v62, v63
  ds_write_b32 v11, v87 offset:1120
  ds_write_b32 v10, v71 offset:2496
  v_mul_f32 v60, s99, v48
  v_mul_f32 v61, s99, v49
  v_mul_f32 v62, s100, v48
  v_mul_f32 v63, s100, v49
  v_cvt_pk_f16_f32 v88, v60, v61
  v_cvt_pk_bf16_f32 v72, v62, v63
  ds_write_b32 v11, v88 offset:1280
  ds_write_b32 v10, v72 offset:512
  v_mul_f32 v60, s99, v50
  v_mul_f32 v61, s99, v51
  v_mul_f32 v62, s100, v50
  v_mul_f32 v63, s100, v51
  v_cvt_pk_f16_f32 v89, v60, v61
  v_cvt_pk_bf16_f32 v73, v62, v63
  ds_write_b32 v11, v89 offset:1440
  ds_write_b32 v10, v73 offset:2624
  v_mul_f32 v60, s99, v52
  v_mul_f32 v61, s99, v53
  v_mul_f32 v62, s100, v52
  v_mul_f32 v63, s100, v53
  v_cvt_pk_f16_f32 v90, v60, v61
  v_cvt_pk_bf16_f32 v74, v62, v63
  ds_write_b32 v11, v90 offset:1600
  ds_write_b32 v10, v74 offset:640
  v_mul_f32 v60, s99, v54
  v_mul_f32 v61, s99, v55
  v_mul_f32 v62, s100, v54
  v_mul_f32 v63, s100, v55
  v_cvt_pk_f16_f32 v91, v60, v61
  v_cvt_pk_bf16_f32 v75, v62, v63
  ds_write_b32 v11, v91 offset:1760
  ds_write_b32 v10, v75 offset:2752
  v_mul_f32 v60, s99, v56
  v_mul_f32 v61, s99, v57
  v_mul_f32 v62, s100, v56
  v_mul_f32 v63, s100, v57
  v_cvt_pk_f16_f32 v92, v60, v61
  v_cvt_pk_bf16_f32 v76, v62, v63
  ds_write_b32 v11, v92 offset:1920
  ds_write_b32 v10, v76 offset:768
  v_mov_b32 v60, s100
  v_cvt_pk_bf16_f32 v60, v60, v60
  s_mov_b32 exec_hi, 0
  ds_write_b32 v10, v60 offset:2880
  s_mov_b32 exec_hi, -1
  s_waitcnt lgkmcnt(0)
  s_branch L_cconv
L_sdown:
  s_waitcnt lgkmcnt(11)
  v_lshlrev_b32 v108, 16, v112
  v_and_b32 v109, 0xffff0000, v112
  v_mul_f32 v108, v108, v250
  v_mul_f32 v109, v109, v250
  v_cvt_pk_bf16_f32 v112, v108, v109
  v_lshlrev_b32 v108, 16, v113
  v_and_b32 v109, 0xffff0000, v113
  v_mul_f32 v108, v108, v250
  v_mul_f32 v109, v109, v250
  v_cvt_pk_bf16_f32 v113, v108, v109
  s_waitcnt lgkmcnt(10)
  v_lshlrev_b32 v108, 16, v114
  v_and_b32 v109, 0xffff0000, v114
  v_mul_f32 v108, v108, v250
  v_mul_f32 v109, v109, v250
  v_cvt_pk_bf16_f32 v114, v108, v109
  v_lshlrev_b32 v108, 16, v115
  v_and_b32 v109, 0xffff0000, v115
  v_mul_f32 v108, v108, v250
  v_mul_f32 v109, v109, v250
  v_cvt_pk_bf16_f32 v115, v108, v109
  s_waitcnt lgkmcnt(9)
  v_lshlrev_b32_e64 v108, 16, v116
  v_and_b32 v109, 0xffff0000, v116
  v_mul_f32 v108, v108, v250
  v_mul_f32 v109, v109, v250
  v_cvt_pk_bf16_f32 v116, v108, v109
  v_lshlrev_b32 v108, 16, v117
  v_and_b32 v109, 0xffff0000, v117
  v_mul_f32 v108, v108, v250
  v_mul_f32 v109, v109, v250
  v_cvt_pk_bf16_f32 v117, v108, v109
  s_waitcnt lgkmcnt(8)
  v_lshlrev_b32_e64 v108, 16, v118
  v_and_b32 v109, 0xffff0000, v118
  v_mul_f32 v108, v108, v250
  v_mul_f32 v109, v109, v250
  v_cvt_pk_bf16_f32 v118, v108, v109
  v_lshlrev_b32 v108, 16, v119
  v_and_b32 v109, 0xffff0000, v119
  v_mul_f32 v108, v108, v250
  v_mul_f32 v109, v109, v250
  v_cvt_pk_bf16_f32 v119, v108, v109
  s_branch L_scaled
L_first:
  ds_read_b64_tr_b16 v[60:61], v20 offset:0
  ds_read_b64_tr_b16 v[74:75], v20 offset:32
  ds_read_b64_tr_b16 v[88:89], v20 offset:64
  ds_read_b64_tr_b16 v[102:103], v20 offset:96
  ds_read_b64_tr_b16 v[66:67], v23 offset:0
  ds_read_b64_tr_b16 v[80:81], v23 offset:32
  ds_read_b64_tr_b16 v[94:95], v23 offset:64
  ds_read_b64_tr_b16 v[108:109], v23 offset:96
  ds_read_b64_tr_b16 v[68:69], v24 offset:0
  ds_read_b64_tr_b16 v[82:83], v24 offset:32
  ds_read_b64_tr_b16 v[96:97], v24 offset:64
  ds_read_b64_tr_b16 v[110:111], v24 offset:96
  ds_read_b64_tr_b16 v[124:125], v4 offset:0
  ds_read_b64_tr_b16 v[126:127], v5 offset:0
  ds_read_b64_tr_b16 v[136:137], v4 offset:32
  ds_read_b64_tr_b16 v[138:139], v5 offset:32
  ds_read_b64_tr_b16 v[148:149], v4 offset:64
  ds_read_b64_tr_b16 v[150:151], v5 offset:64
  ds_read_b64_tr_b16 v[160:161], v4 offset:96
  ds_read_b64_tr_b16 v[162:163], v5 offset:96
  ds_read_b128 v[164:167], v1 offset:39936
  ds_read_b128 v[168:171], v1 offset:40960
  ds_read_b128 v[172:175], v1 offset:8192
  ds_read_b128 v[176:179], v1 offset:6144
  ds_read_b64_tr_b16 v[70:71], v25 offset:0
  ds_read_b64_tr_b16 v[84:85], v25 offset:32
  ds_read_b64_tr_b16 v[98:99], v25 offset:64
  ds_read_b64_tr_b16 v[112:113], v25 offset:96
  ds_read_b64_tr_b16 v[72:73], v26 offset:0
  s_waitcnt lgkmcnt(14)
  v_pk_mul_f16 v120, v60, v67 op_sel:[0,0] op_sel_hi:[0,1]
  v_pk_mul_f16 v121, v60, v67 op_sel:[1,0] op_sel_hi:[1,1]
  ds_read_b64_tr_b16 v[86:87], v26 offset:32
  v_pk_mul_f16 v122, v60, v68 op_sel:[0,0] op_sel_hi:[0,1]
  ds_read_b64_tr_b16 v[100:101], v26 offset:64
  v_pk_mul_f16 v123, v60, v68 op_sel:[1,0] op_sel_hi:[1,1]
  ds_read_b64_tr_b16 v[114:115], v26 offset:96
  v_pk_mul_f16 v132, v74, v81 op_sel:[0,0] op_sel_hi:[0,1]
  v_pk_mul_f16 v133, v74, v81 op_sel:[1,0] op_sel_hi:[1,1]
  ds_read_b64_tr_b16 v[62:63], v21 offset:0
  v_pk_mul_f16 v134, v74, v82 op_sel:[0,0] op_sel_hi:[0,1]
  ds_read_b64_tr_b16 v[76:77], v21 offset:32
  v_pk_mul_f16 v135, v74, v82 op_sel:[1,0] op_sel_hi:[1,1]
  ds_read_b64_tr_b16 v[90:91], v21 offset:64
  v_pk_mul_f16 v144, v88, v95 op_sel:[0,0] op_sel_hi:[0,1]
  v_pk_mul_f16 v145, v88, v95 op_sel:[1,0] op_sel_hi:[1,1]
  ds_read_b64_tr_b16 v[104:105], v21 offset:96
  v_pk_mul_f16 v146, v88, v96 op_sel:[0,0] op_sel_hi:[0,1]
  ds_read_b64_tr_b16 v[64:65], v22 offset:0
  v_pk_mul_f16 v147, v88, v96 op_sel:[1,0] op_sel_hi:[1,1]
  ds_read_b64_tr_b16 v[78:79], v22 offset:32
  v_pk_mul_f16 v156, v102, v109 op_sel:[0,0] op_sel_hi:[0,1]
  v_pk_mul_f16 v157, v102, v109 op_sel:[1,0] op_sel_hi:[1,1]
  ds_read_b64_tr_b16 v[92:93], v22 offset:64
  v_pk_mul_f16 v158, v102, v110 op_sel:[0,0] op_sel_hi:[0,1]
  ds_read_b64_tr_b16 v[106:107], v22 offset:96
  v_pk_mul_f16 v159, v102, v110 op_sel:[1,0] op_sel_hi:[1,1]
  s_branch L_novm
L_end:
  s_endpgm
.p2align 8
L_tables:
.long 0x0, 0x1800, 0x6c80, 0x81a0, 0x8, 0x1808, 0x6c88, 0x81a8
.long 0x10, 0x1810, 0x6c90, 0x81b0, 0x18, 0x1818, 0x6c98, 0x81b8
.long 0x40, 0x1d48, 0x71c8, 0x86e8, 0x48, 0x1d50, 0x71d0, 0x86f0
.long 0x50, 0x1d58, 0x71d8, 0x86f8, 0x58, 0x1d60, 0x71e0, 0x8700
.long 0x80, 0x2290, 0x7710, 0x8c30, 0x88, 0x2298, 0x7718, 0x8c38
.long 0x90, 0x22a0, 0x7720, 0x8c40, 0x98, 0x22a8, 0x7728, 0x8c48
.long 0xc0, 0x27d8, 0x7c58, 0x9178, 0xc8, 0x27e0, 0x7c60, 0x9180
.long 0xd0, 0x27e8, 0x7c68, 0x9188, 0xd8, 0x27f0, 0x7c70, 0x9190
.long 0x20, 0x1820, 0x6ca0, 0x81c0, 0x28, 0x1828, 0x6ca8, 0x81c8
.long 0x30, 0x1830, 0x6cb0, 0x81d0, 0x38, 0x1838, 0x6cb8, 0x81d8
.long 0x60, 0x1d68, 0x71e8, 0x8708, 0x68, 0x1d70, 0x71f0, 0x8710
.long 0x70, 0x1d78, 0x71f8, 0x8718, 0x78, 0x1d80, 0x7200, 0x8720
.long 0xa0, 0x22b0, 0x7730, 0x8c50, 0xa8, 0x22b8, 0x7738, 0x8c58
.long 0xb0, 0x22c0, 0x7740, 0x8c60, 0xb8, 0x22c8, 0x7748, 0x8c68
.long 0xe0, 0x27f8, 0x7c78, 0x9198, 0xe8, 0x2800, 0x7c80, 0x91a0
.long 0xf0, 0x2808, 0x7c88, 0x91a8, 0xf8, 0x2810, 0x7c90, 0x91b0
.long 0x200, 0x4240, 0x96c0, 0x9c08, 0x208, 0x4248, 0x96c8, 0x9c10
.long 0x210, 0x4250, 0x96d0, 0x9c18, 0x218, 0x4258, 0x96d8, 0x9c20
.long 0x240, 0x4788, 0x9c08, 0x9c08, 0x248, 0x4790, 0x9c10, 0x9c10
.long 0x250, 0x4798, 0x9c18, 0x9c18, 0x258, 0x47a0, 0x9c20, 0x9c20
.long 0x280, 0x4cd0, 0x9c08, 0x9c08, 0x288, 0x4cd8, 0x9c10, 0x9c10
.long 0x290, 0x4ce0, 0x9c18, 0x9c18, 0x298, 0x4ce8, 0x9c20, 0x9c20
.long 0x2c0, 0x5218, 0x9c08, 0x9c08, 0x2c8, 0x5220, 0x9c10, 0x9c10
.long 0x2d0, 0x5228, 0x9c18, 0x9c18, 0x2d8, 0x5230, 0x9c20, 0x9c20
.long 0x220, 0x4260, 0x96e0, 0x9c28, 0x228, 0x4268, 0x96e8, 0x9c30
.long 0x230, 0x4270, 0x96f0, 0x9c38, 0x238, 0x4278, 0x96f8, 0x9c40
.long 0x260, 0x47a8, 0x9c28, 0x9c28, 0x268, 0x47b0, 0x9c30, 0x9c30
.long 0x270, 0x47b8, 0x9c38, 0x9c38, 0x278, 0x47c0, 0x9c40, 0x9c40
.long 0x2a0, 0x4cf0, 0x9c28, 0x9c28, 0x2a8, 0x4cf8, 0x9c30, 0x9c30
.long 0x2b0, 0x4d00, 0x9c38, 0x9c38, 0x2b8, 0x4d08, 0x9c40, 0x9c40
.long 0x2e0, 0x5238, 0x9c28, 0x9c28, 0x2e8, 0x5240, 0x9c30, 0x9c30
.long 0x2f0, 0x5248, 0x9c38, 0x9c38, 0x2f8, 0x5250, 0x9c40, 0x9c40
.long 0xaae0, 0xa680, 0xa900, 0xaae0, 0xaae8, 0xa688, 0xa908, 0xaae8
.long 0xaaf0, 0xa690, 0xa910, 0xaaf0, 0xaaf8, 0xa698, 0xa918, 0xaaf8
.long 0xaa40, 0xa860, 0xa9a0, 0xaa40, 0xaa48, 0xa868, 0xa9a8, 0xaa48
.long 0xaa50, 0xa870, 0xa9b0, 0xaa50, 0xaa58, 0xa878, 0xa9b8, 0xaa58
.long 0xa400, 0xa7c0, 0xa540, 0xa400, 0xa408, 0xa7c8, 0xa548, 0xa408
.long 0xa410, 0xa7d0, 0xa550, 0xa410, 0xa418, 0xa7d8, 0xa558, 0xa418
.long 0xa4a0, 0xa720, 0xa5e0, 0xa4a0, 0xa4a8, 0xa728, 0xa5e8, 0xa4a8
.long 0xa4b0, 0xa730, 0xa5f0, 0xa4b0, 0xa4b8, 0xa738, 0xa5f8, 0xa4b8
.long 0xb260, 0xb4e0, 0xb6c0, 0xb260, 0xb268, 0xb4e8, 0xb6c8, 0xb268
.long 0xb270, 0xb4f0, 0xb6d0, 0xb270, 0xb278, 0xb4f8, 0xb6d8, 0xb278
.long 0xb1c0, 0xb300, 0xb760, 0xb1c0, 0xb1c8, 0xb308, 0xb768, 0xb1c8
.long 0xb1d0, 0xb310, 0xb770, 0xb1d0, 0xb1d8, 0xb318, 0xb778, 0xb1d8
.long 0xb580, 0xb440, 0xb080, 0xb580, 0xb588, 0xb448, 0xb088, 0xb588
.long 0xb590, 0xb450, 0xb090, 0xb590, 0xb598, 0xb458, 0xb098, 0xb598
.long 0xb620, 0xb3a0, 0xb120, 0xb620, 0xb628, 0xb3a8, 0xb128, 0xb628
.long 0xb630, 0xb3b0, 0xb130, 0xb630, 0xb638, 0xb3b8, 0xb138, 0xb638
.long 0xa900, 0xa400, 0xaae0, 0xb620, 0xa908, 0xa408, 0xaae8, 0xb628
.long 0xa910, 0xa410, 0xaaf0, 0xb630, 0xa918, 0xa418, 0xaaf8, 0xb638
.long 0xa9a0, 0xa4a0, 0xab80, 0xb800, 0xa9a8, 0xa4a8, 0xab88, 0xb808
.long 0xa9b0, 0xa4b0, 0xab90, 0xb810, 0xa9b8, 0xa4b8, 0xab98, 0xb818
.long 0xaa40, 0xa680, 0xa860, 0xb3a0, 0xaa48, 0xa688, 0xa868, 0xb3a8
.long 0xaa50, 0xa690, 0xa870, 0xb3b0, 0xaa58, 0xa698, 0xa878, 0xb3b8
.long 0xa720, 0xa540, 0xa7c0, 0xb1c0, 0xa728, 0xa548, 0xa7c8, 0xb1c8
.long 0xa730, 0xa550, 0xa7d0, 0xb1d0, 0xa738, 0xa558, 0xa7d8, 0xb1d8
.long 0xa5e0, 0xaae0, 0xa400, 0xb080, 0xa5e8, 0xaae8, 0xa408, 0xb088
.long 0xa5f0, 0xaaf0, 0xa410, 0xb090, 0xa5f8, 0xaaf8, 0xa418, 0xb098
.long 0xa7c0, 0xa540, 0xa720, 0xb760, 0xa7c8, 0xa548, 0xa728, 0xb768
.long 0xa7d0, 0xa550, 0xa730, 0xb770, 0xa7d8, 0xa558, 0xa738, 0xb778
.long 0xa860, 0xa680, 0xaa40, 0xb440, 0xa868, 0xa688, 0xaa48, 0xb448
.long 0xa870, 0xa690, 0xaa50, 0xb450, 0xa878, 0xa698, 0xaa58, 0xb458
.long 0xab80, 0xa4a0, 0xa9a0, 0xb4e0, 0xab88, 0xa4a8, 0xa9a8, 0xb4e8
.long 0xab90, 0xa4b0, 0xa9b0, 0xb4f0, 0xab98, 0xa4b8, 0xa9b8, 0xb4f8
.long 0xa680, 0xa900, 0xab80, 0xa4a0, 0xa688, 0xa908, 0xab88, 0xa4a8
.long 0xa690, 0xa910, 0xab90, 0xa4b0, 0xa698, 0xa918, 0xab98, 0xa4b8
.long 0xa860, 0xa9a0, 0xb1c0, 0xb440, 0xa868, 0xa9a8, 0xb1c8, 0xb448
.long 0xa870, 0xa9b0, 0xb1d0, 0xb450, 0xa878, 0xa9b8, 0xb1d8, 0xb458
.long 0xa7c0, 0xa540, 0xab80, 0xa4a0, 0xa7c8, 0xa548, 0xab88, 0xa4a8
.long 0xa7d0, 0xa550, 0xab90, 0xa4b0, 0xa7d8, 0xa558, 0xab98, 0xa4b8
.long 0xa720, 0xa5e0, 0xb1c0, 0xb440, 0xa728, 0xa5e8, 0xb1c8, 0xb448
.long 0xa730, 0xa5f0, 0xb1d0, 0xb450, 0xa738, 0xa5f8, 0xb1d8, 0xb458
.long 0xb4e0, 0xb6c0, 0xb800, 0xa860, 0xb4e8, 0xb6c8, 0xb808, 0xa868
.long 0xb4f0, 0xb6d0, 0xb810, 0xa870, 0xb4f8, 0xb6d8, 0xb818, 0xa878
.long 0xb300, 0xb760, 0xa540, 0xa900, 0xb308, 0xb768, 0xa548, 0xa908
.long 0xb310, 0xb770, 0xa550, 0xa910, 0xb318, 0xb778, 0xa558, 0xa918
.long 0xb440, 0xb080, 0xb800, 0xa860, 0xb448, 0xb088, 0xb808, 0xa868
.long 0xb450, 0xb090, 0xb810, 0xa870, 0xb458, 0xb098, 0xb818, 0xa878
.long 0xb3a0, 0xb120, 0xa540, 0xa900, 0xb3a8, 0xb128, 0xa548, 0xa908
.long 0xb3b0, 0xb130, 0xa550, 0xa910, 0xb3b8, 0xb138, 0xa558, 0xa918
.long 0xb120, 0xb580, 0xb080, 0xb300, 0xb128, 0xb588, 0xb088, 0xb308
.long 0xb130, 0xb590, 0xb090, 0xb310, 0xb138, 0xb598, 0xb098, 0xb318
.long 0xb6c0, 0xb4e0, 0xaa40, 0xb6c0, 0xb6c8, 0xb4e8, 0xaa48, 0xb6c8
.long 0xb6d0, 0xb4f0, 0xaa50, 0xb6d0, 0xb6d8, 0xb4f8, 0xaa58, 0xb6d8
.long 0xb300, 0xb440, 0xb080, 0xb300, 0xb308, 0xb448, 0xb088, 0xb308
.long 0xb310, 0xb450, 0xb090, 0xb310, 0xb318, 0xb458, 0xb098, 0xb318
.long 0xb260, 0xb760, 0xaa40, 0xb6c0, 0xb268, 0xb768, 0xaa48, 0xb6c8
.long 0xb270, 0xb770, 0xaa50, 0xb6d0, 0xb278, 0xb778, 0xaa58, 0xb6d8
.long 0xb580, 0xb120, 0xb620, 0xa680, 0xb588, 0xb128, 0xb628, 0xa688
.long 0xb590, 0xb130, 0xb630, 0xa690, 0xb598, 0xb138, 0xb638, 0xa698
.long 0xb260, 0xb1c0, 0xa7c0, 0xa680, 0xb268, 0xb1c8, 0xa7c8, 0xa688
.long 0xb270, 0xb1d0, 0xa7d0, 0xa690, 0xb278, 0xb1d8, 0xa7d8, 0xa698
.long 0xb300, 0xb3a0, 0xb620, 0xb300, 0xb308, 0xb3a8, 0xb628, 0xb308
.long 0xb310, 0xb3b0, 0xb630, 0xb310, 0xb318, 0xb3b8, 0xb638, 0xb318
.long 0xb6c0, 0xb800, 0xa7c0, 0xb300, 0xb6c8, 0xb808, 0xa7c8, 0xb308
.long 0xb6d0, 0xb810, 0xa7d0, 0xb310, 0xb6d8, 0xb818, 0xa7d8, 0xb318
.long 0x0, 0x200, 0x0, 0x3f803f80, 0x8, 0x208, 0x0, 0x3f803f80
.long 0x10, 0x210, 0x0, 0x3f803f80, 0x18, 0x218, 0x0, 0x3f803f80
.long 0x420, 0x620, 0x0, 0x3f803f80, 0x428, 0x628, 0x0, 0x3f803f80
.long 0x430, 0x630, 0x0, 0x3f803f80, 0x438, 0x638, 0x0, 0x3f803f80
.long 0x840, 0xa40, 0x10, 0x3f803f80, 0x848, 0xa48, 0x10, 0x3f803f80
.long 0x850, 0xa50, 0x10, 0x3f803f80, 0x858, 0xa58, 0x10, 0x3f803f80
.long 0xc60, 0xe60, 0x10, 0x3f803f80, 0xc68, 0xe68, 0x10, 0x3f803f80
.long 0xc70, 0xe70, 0x10, 0x3f803f80, 0xc78, 0xe78, 0x10, 0x3f803f80
.long 0x80, 0x280, 0x20, 0x3f803f80, 0x88, 0x288, 0x20, 0x3f803f80
.long 0x90, 0x290, 0x20, 0x3f803f80, 0x98, 0x298, 0x20, 0x3f803f80
.long 0x4a0, 0x6a0, 0x20, 0x3f803f80, 0x4a8, 0x6a8, 0x20, 0x3f803f80
.long 0x4b0, 0x6b0, 0x20, 0x3f803f80, 0x4b8, 0x6b8, 0x20, 0x3f803f80
.long 0x8c0, 0xac0, 0x30, 0x3f803f80, 0x8c8, 0xac8, 0x30, 0x3f803f80
.long 0x8d0, 0xad0, 0x30, 0x3f803f80, 0x8d8, 0xad8, 0x30, 0x3f803f80
.long 0xce0, 0xee0, 0x30, 0x3f803f80, 0xce8, 0xee8, 0x30, 0x3f803f80
.long 0xcf0, 0xef0, 0x30, 0x3f803f80, 0xcf8, 0xef8, 0x30, 0x3f803f80
.long 0x100, 0x300, 0x40, 0x0, 0x108, 0x308, 0x40, 0x0
.long 0x110, 0x310, 0x40, 0x0, 0x118, 0x318, 0x40, 0x0
.long 0x520, 0x720, 0x40, 0x0, 0x528, 0x728, 0x40, 0x0
.long 0x530, 0x730, 0x40, 0x0, 0x538, 0x738, 0x40, 0x0
.long 0x940, 0xb40, 0x50, 0x0, 0x948, 0xb48, 0x50, 0x0
.long 0x950, 0xb50, 0x50, 0x0, 0x958, 0xb58, 0x50, 0x0
.long 0xd60, 0xf60, 0x50, 0x0, 0xd68, 0xf68, 0x50, 0x0
.long 0xd70, 0xf70, 0x50, 0x0, 0xd78, 0xf78, 0x50, 0x0
.long 0x180, 0xf60, 0x60, 0x0, 0x188, 0xf68, 0x60, 0x0
.long 0x190, 0xf70, 0x60, 0x0, 0x198, 0xf78, 0x60, 0x0
.long 0x5a0, 0xf60, 0x60, 0x0, 0x5a8, 0xf68, 0x60, 0x0
.long 0x5b0, 0xf70, 0x60, 0x0, 0x5b8, 0xf78, 0x60, 0x0
.long 0x9c0, 0xf60, 0x70, 0x0, 0x9c8, 0xf68, 0x70, 0x0
.long 0x9d0, 0xf70, 0x70, 0x0, 0x9d8, 0xf78, 0x70, 0x0
.long 0xde0, 0xf60, 0x70, 0x0, 0xde8, 0xf68, 0x70, 0x0
.long 0xdf0, 0xf70, 0x70, 0x0, 0xdf8, 0xf78, 0x70, 0x0
.long 0xffff, 0x0, 0x0, 0x0, 0x0, 0x0, 0xffff, 0x0
.long 0x0, 0x0, 0x0, 0x0, 0x0, 0x0, 0x0, 0x0
.long 0x0, 0x0, 0x0, 0x0, 0x0, 0x0, 0x0, 0x0
.long 0x0, 0x0, 0x0, 0x0, 0x0, 0x0, 0x0, 0x0
.long 0xffff0000, 0x0, 0x0, 0x0, 0x0, 0x0, 0xffff0000, 0x0
.long 0x0, 0x0, 0x0, 0x0, 0x0, 0x0, 0x0, 0x0
.long 0x0, 0x0, 0x0, 0x0, 0x0, 0x0, 0x0, 0x0
.long 0x0, 0x0, 0x0, 0x0, 0x0, 0x0, 0x0, 0x0
.long 0x0, 0xffff, 0x0, 0x0, 0x0, 0x0, 0x0, 0xffff
.long 0x0, 0x0, 0x0, 0x0, 0x0, 0x0, 0x0, 0x0
.long 0x0, 0x0, 0x0, 0x0, 0x0, 0x0, 0x0, 0x0
.long 0x0, 0x0, 0x0, 0x0, 0x0, 0x0, 0x0, 0x0
.long 0x0, 0xffff0000, 0x0, 0x0, 0x0, 0x0, 0x0, 0xffff0000
.long 0x0, 0x0, 0x0, 0x0, 0x0, 0x0, 0x0, 0x0
.long 0x0, 0x0, 0x0, 0x0, 0x0, 0x0, 0x0, 0x0
.long 0x0, 0x0, 0x0, 0x0, 0x0, 0x0, 0x0, 0x0
.long 0x0, 0x0, 0x0, 0x0, 0x0, 0x0, 0x0, 0x0
.long 0xffff, 0x0, 0x0, 0x0, 0x0, 0x0, 0xffff, 0x0
.long 0x0, 0x0, 0x0, 0x0, 0x0, 0x0, 0x0, 0x0
.long 0x0, 0x0, 0x0, 0x0, 0x0, 0x0, 0x0, 0x0
.long 0x0, 0x0, 0x0, 0x0, 0x0, 0x0, 0x0, 0x0
.long 0xffff0000, 0x0, 0x0, 0x0, 0x0, 0x0, 0xffff0000, 0x0
.long 0x0, 0x0, 0x0, 0x0, 0x0, 0x0, 0x0, 0x0
.long 0x0, 0x0, 0x0, 0x0, 0x0, 0x0, 0x0, 0x0
.long 0x0, 0x0, 0x0, 0x0, 0x0, 0x0, 0x0, 0x0
.long 0x0, 0xffff, 0x0, 0x0, 0x0, 0x0, 0x0, 0xffff
.long 0x0, 0x0, 0x0, 0x0, 0x0, 0x0, 0x0, 0x0
.long 0x0, 0x0, 0x0, 0x0, 0x0, 0x0, 0x0, 0x0
.long 0x0, 0x0, 0x0, 0x0, 0x0, 0x0, 0x0, 0x0
.long 0x0, 0xffff0000, 0x0, 0x0, 0x0, 0x0, 0x0, 0xffff0000
.long 0x0, 0x0, 0x0, 0x0, 0x0, 0x0, 0x0, 0x0
.long 0x0, 0x0, 0x0, 0x0, 0x0, 0x0, 0x0, 0x0
.long 0x0, 0x0, 0x0, 0x0, 0x0, 0x0, 0x0, 0x0
.long 0x0, 0x0, 0x0, 0x0, 0x0, 0x0, 0x0, 0x0
.long 0x0, 0x0, 0xffff, 0x0, 0x0, 0x0, 0x0, 0x0
.long 0x0, 0x0, 0x0, 0x0, 0xffff, 0x0, 0x0, 0x0
.long 0x0, 0x0, 0x0, 0x0, 0x0, 0x0, 0x0, 0x0
.long 0x0, 0x0, 0x0, 0x0, 0x0, 0x0, 0x0, 0x0
.long 0x0, 0x0, 0xffff0000, 0x0, 0x0, 0x0, 0x0, 0x0
.long 0x0, 0x0, 0x0, 0x0, 0xffff0000, 0x0, 0x0, 0x0
.long 0x0, 0x0, 0x0, 0x0, 0x0, 0x0, 0x0, 0x0
.long 0x0, 0x0, 0x0, 0x0, 0x0, 0x0, 0x0, 0x0
.long 0x0, 0x0, 0x0, 0xffff, 0x0, 0x0, 0x0, 0x0
.long 0x0, 0x0, 0x0, 0x0, 0x0, 0xffff, 0x0, 0x0
.long 0x0, 0x0, 0x0, 0x0, 0x0, 0x0, 0x0, 0x0
.long 0x0, 0x0, 0x0, 0x0, 0x0, 0x0, 0x0, 0x0
.long 0x0, 0x0, 0x0, 0xffff0000, 0x0, 0x0, 0x0, 0x0
.long 0x0, 0x0, 0x0, 0x0, 0x0, 0xffff0000, 0x0, 0x0
.long 0x0, 0x0, 0x0, 0x0, 0x0, 0x0, 0x0, 0x0
.long 0x0, 0x0, 0x0, 0x0, 0x0, 0x0, 0x0, 0x0
.long 0x0, 0x0, 0x0, 0x0, 0xffff, 0x0, 0x0, 0x0
.long 0x0, 0x0, 0x0, 0x0, 0x0, 0x0, 0x0, 0x0
.long 0x0, 0x0, 0x0, 0x0, 0x0, 0x0, 0x0, 0x0
.long 0x0, 0x0, 0x0, 0x0, 0x0, 0x0, 0x0, 0x0
.long 0x0, 0x0, 0x0, 0x0, 0xffff0000, 0x0, 0x0, 0x0
.long 0x0, 0x0, 0x0, 0x0, 0x0, 0x0, 0x0, 0x0
.long 0x0, 0x0, 0x0, 0x0, 0x0, 0x0, 0x0, 0x0
.long 0x0, 0x0, 0x0, 0x0, 0x0, 0x0, 0x0, 0x0
.long 0x0, 0x0, 0x0, 0x0, 0x0, 0x0, 0x0, 0x0
.long 0x0, 0x0, 0x0, 0x0, 0x0, 0x0, 0x0, 0x0
.long 0x0, 0x0, 0x0, 0x0, 0x0, 0x0, 0x0, 0x0
.long 0x0, 0x0, 0x0, 0x0, 0x0, 0x0, 0x0, 0x0
.long 0x0, 0x0, 0x0, 0x0, 0x0, 0x0, 0x0, 0x0
.long 0x0, 0x0, 0x0, 0x0, 0x0, 0x0, 0x0, 0x0
.long 0x14d40, 0x14d40, 0x0, 0x0, 0x14e10, 0x14e10, 0x20, 0x20
.long 0x14ee0, 0x14ee0, 0x100000, 0x100000, 0x14fb0, 0x14fb0, 0x100020, 0x100020
.long 0x15080, 0x15080, 0x40, 0x40, 0x15150, 0x15150, 0x60, 0x60
.long 0x15220, 0x15220, 0x100040, 0x100040, 0x100000, 0x100000, 0x100060, 0x100060
.long 0x14d74, 0x14d74, 0x80, 0x80, 0x14e44, 0x14e44, 0xa0, 0xa0
.long 0x14f14, 0x14f14, 0x100080, 0x100080, 0x14fe4, 0x14fe4, 0x1000a0, 0x1000a0
.long 0x150b4, 0x150b4, 0xc0, 0xc0, 0x15184, 0x15184, 0xe0, 0xe0
.long 0x15254, 0x15254, 0x1000c0, 0x1000c0, 0x100000, 0x100000, 0x1000e0, 0x1000e0
.long 0x14da8, 0x14da8, 0x8, 0x100, 0x14e78, 0x14e78, 0x28, 0x120
.long 0x14f48, 0x14f48, 0x100008, 0x100100, 0x15018, 0x15018, 0x100028, 0x100120
.long 0x150e8, 0x150e8, 0x48, 0x140, 0x151b8, 0x151b8, 0x68, 0x160
.long 0x100000, 0x100000, 0x100048, 0x100140, 0x100000, 0x100000, 0x100068, 0x100160
.long 0x14ddc, 0x14ddc, 0x88, 0x180, 0x14eac, 0x14eac, 0xa8, 0x1a0
.long 0x14f7c, 0x14f7c, 0x100088, 0x100180, 0x1504c, 0x1504c, 0x1000a8, 0x1001a0
.long 0x1511c, 0x1511c, 0xc8, 0x1c0, 0x151ec, 0x151ec, 0xe8, 0x1e0
.long 0x100000, 0x100000, 0x1000c8, 0x1001c0, 0x100000, 0x100000, 0x1000e8, 0x1001e0
.long 0x17d40, 0x114d40, 0x100, 0x200, 0x17e10, 0x114e10, 0x120, 0x220
.long 0x17ee0, 0x114ee0, 0x100100, 0x100200, 0x17fb0, 0x114fb0, 0x100120, 0x100220
.long 0x18080, 0x115080, 0x140, 0x240, 0x18150, 0x115150, 0x160, 0x260
.long 0x18220, 0x115220, 0x100140, 0x100240, 0x103000, 0x200000, 0x100160, 0x100260
.long 0x17d74, 0x114d74, 0x180, 0x280, 0x17e44, 0x114e44, 0x1a0, 0x2a0
.long 0x17f14, 0x114f14, 0x100180, 0x100280, 0x17fe4, 0x114fe4, 0x1001a0, 0x1002a0
.long 0x180b4, 0x1150b4, 0x1c0, 0x2c0, 0x18184, 0x115184, 0x1e0, 0x2e0
.long 0x18254, 0x115254, 0x1001c0, 0x1002c0, 0x103000, 0x200000, 0x1001e0, 0x1002e0
.long 0x17da8, 0x114da8, 0x108, 0x300, 0x17e78, 0x114e78, 0x128, 0x320
.long 0x17f48, 0x114f48, 0x100108, 0x100300, 0x18018, 0x115018, 0x100128, 0x100320
.long 0x180e8, 0x1150e8, 0x148, 0x340, 0x181b8, 0x1151b8, 0x168, 0x360
.long 0x103000, 0x200000, 0x100148, 0x100340, 0x103000, 0x200000, 0x100168, 0x100360
.long 0x17ddc, 0x114ddc, 0x188, 0x380, 0x17eac, 0x114eac, 0x1a8, 0x3a0
.long 0x17f7c, 0x114f7c, 0x100188, 0x100380, 0x1804c, 0x11504c, 0x1001a8, 0x1003a0
.long 0x1811c, 0x11511c, 0x1c8, 0x3c0, 0x181ec, 0x1151ec, 0x1e8, 0x3e0
.long 0x103000, 0x200000, 0x1001c8, 0x1003c0, 0x103000, 0x200000, 0x1001e8, 0x1003e0
.long 0xa400, 0xd00, 0x0, 0x14d40, 0xa440, 0xd00, 0x0, 0x14d80
.long 0xa480, 0xd00, 0x1, 0x14dd0, 0xa4c0, 0xd00, 0x1, 0x14e10
.long 0xa500, 0xd00, 0x2, 0x14e60, 0xa540, 0xd00, 0x2, 0x14ea0
.long 0xa580, 0xd00, 0x3, 0x14ef0, 0xa5c0, 0xd00, 0x3, 0x14f30
.long 0xa600, 0xd00, 0x4, 0x14f40, 0xa640, 0xd00, 0x4, 0x14f80
.long 0xa680, 0xd00, 0x5, 0x14fd0, 0xa6c0, 0xd00, 0x5, 0x15010
.long 0xa700, 0xd00, 0x6, 0x15060, 0xa740, 0xd00, 0x6, 0x150a0
.long 0xa780, 0xd00, 0x7, 0x150f0, 0xa7c0, 0xd00, 0x7, 0x15130
.long 0xa800, 0xd00, 0x8, 0x15140, 0xa840, 0xd00, 0x8, 0x15180
.long 0xa880, 0xd00, 0x9, 0x151d0, 0xa8c0, 0xd00, 0x9, 0x15210
.long 0xa900, 0xd00, 0xa, 0x15260, 0xa940, 0xd00, 0xa, 0x152a0
.long 0xa980, 0xd00, 0xb, 0x152f0, 0xa9c0, 0xd00, 0xb, 0x15330
.long 0xaa00, 0xd00, 0xc, 0x15340, 0xaa40, 0xd00, 0xc, 0x15380
.long 0x1f680, 0x40, 0xd, 0x153d0, 0x100000, 0xd00, 0xd, 0x15410
.long 0x100000, 0xd00, 0xe, 0x15460, 0x100000, 0xd00, 0xe, 0x154a0
.long 0x100000, 0xd00, 0xf, 0x154f0, 0x100000, 0xd00, 0xf, 0x15530
.long 0xa400, 0xd00, 0x2, 0x14d60, 0xa440, 0xd00, 0x2, 0x14da0
.long 0xa480, 0xd00, 0x3, 0x14df0, 0xa4c0, 0xd00, 0x3, 0x14e30
.long 0xa500, 0xd00, 0x4, 0x14e40, 0xa540, 0xd00, 0x4, 0x14e80
.long 0xa580, 0xd00, 0x5, 0x14ed0, 0xa5c0, 0xd00, 0x5, 0x14f10
.long 0xa600, 0xd00, 0x6, 0x14f60, 0xa640, 0xd00, 0x6, 0x14fa0
.long 0xa680, 0xd00, 0x7, 0x14ff0, 0xa6c0, 0xd00, 0x7, 0x15030
.long 0xa700, 0xd00, 0x8, 0x15040, 0xa740, 0xd00, 0x8, 0x15080
.long 0xa780, 0xd00, 0x9, 0x150d0, 0xa7c0, 0xd00, 0x9, 0x15110
.long 0xa800, 0xd00, 0xa, 0x15160, 0xa840, 0xd00, 0xa, 0x151a0
.long 0xa880, 0xd00, 0xb, 0x151f0, 0xa8c0, 0xd00, 0xb, 0x15230
.long 0xa900, 0xd00, 0xc, 0x15240, 0xa940, 0xd00, 0xc, 0x15280
.long 0xa980, 0xd00, 0xd, 0x152d0, 0xa9c0, 0xd00, 0xd, 0x15310
.long 0xaa00, 0xd00, 0xe, 0x15360, 0xaa40, 0xd00, 0xe, 0x153a0
.long 0x1f680, 0x40, 0xf, 0x153f0, 0x100000, 0xd00, 0xf, 0x15430
.long 0x100000, 0xd00, 0x10, 0x15440, 0x100000, 0xd00, 0x10, 0x15480
.long 0x100000, 0xd00, 0x11, 0x154d0, 0x100000, 0xd00, 0x11, 0x15510
.long 0x1f690, 0x1f890, 0x1f9c0, 0x1f9e0, 0x1f698, 0x1f898, 0x1f9c8, 0x1f9e8
.long 0x1f680, 0x1f880, 0x1f9d0, 0x1f9f0, 0x1f688, 0x1f888, 0x1f9d8, 0x100000
.long 0x1fd20, 0x1ff20, 0x1f9c2, 0x1f9e2, 0x1fd28, 0x1ff28, 0x1f9ca, 0x1f9ea
.long 0x1fd30, 0x1ff30, 0x1f9d2, 0x1f9f2, 0x1fd38, 0x1ff38, 0x1f9da, 0x100000
.long 0x1f6f0, 0x1f8f0, 0x1f9c4, 0x1f9e4, 0x1f6f8, 0x1f8f8, 0x1f9cc, 0x1f9ec
.long 0x1f6e0, 0x1f8e0, 0x1f9d4, 0x100000, 0x1f6e8, 0x1f8e8, 0x1f9dc, 0x100000
.long 0x1fd40, 0x1ff40, 0x1f9c6, 0x1f9e6, 0x1fd48, 0x1ff48, 0x1f9ce, 0x1f9ee
.long 0x1fd50, 0x1ff50, 0x1f9d6, 0x100000, 0x1fd58, 0x1ff58, 0x1f9de, 0x100000
.long 0x1f710, 0x1f910, 0x1f9c0, 0x1f9e0, 0x1f718, 0x1f918, 0x1f9c8, 0x1f9e8
.long 0x1f700, 0x1f900, 0x1f9d0, 0x1f9f0, 0x1f708, 0x1f908, 0x1f9d8, 0x100000
.long 0x1fda0, 0x1ffa0, 0x1f9c2, 0x1f9e2, 0x1fda8, 0x1ffa8, 0x1f9ca, 0x1f9ea
.long 0x1fdb0, 0x1ffb0, 0x1f9d2, 0x1f9f2, 0x1fdb8, 0x1ffb8, 0x1f9da, 0x100000
.long 0x1f770, 0x1f970, 0x1f9c4, 0x1f9e4, 0x1f778, 0x1f978, 0x1f9cc, 0x1f9ec
.long 0x1f760, 0x1f960, 0x1f9d4, 0x100000, 0x1f768, 0x1f968, 0x1f9dc, 0x100000
.long 0x1fdc0, 0x1ffc0, 0x1f9c6, 0x1f9e6, 0x1fdc8, 0x1ffc8, 0x1f9ce, 0x1f9ee
.long 0x1fdd0, 0x1ffd0, 0x1f9d6, 0x100000, 0x1fdd8, 0x1ffd8, 0x1f9de, 0x100000
.long 0x1f790, 0x1f990, 0x1f9c0, 0x1f9e0, 0x1f798, 0x1f998, 0x1f9c8, 0x1f9e8
.long 0x1f780, 0x1f980, 0x1f9d0, 0x1f9f0, 0x1f788, 0x1f988, 0x1f9d8, 0x100000
.long 0x1fe20, 0x20020, 0x1f9c2, 0x1f9e2, 0x1fe28, 0x20028, 0x1f9ca, 0x1f9ea
.long 0x1fe30, 0x20030, 0x1f9d2, 0x1f9f2, 0x1fe38, 0x20038, 0x1f9da, 0x100000
.long 0x1f7f0, 0x14d00, 0x1f9c4, 0x1f9e4, 0x1f7f8, 0x14d08, 0x1f9cc, 0x1f9ec
.long 0x1f7e0, 0x14d10, 0x1f9d4, 0x100000, 0x1f7e8, 0x14d18, 0x1f9dc, 0x100000
.long 0x1fe40, 0x14d00, 0x1f9c6, 0x1f9e6, 0x1fe48, 0x14d08, 0x1f9ce, 0x1f9ee
.long 0x1fe50, 0x14d10, 0x1f9d6, 0x100000, 0x1fe58, 0x14d18, 0x1f9de, 0x100000
.long 0x1f810, 0x14d00, 0x1f9c0, 0x1f9e0, 0x1f818, 0x14d08, 0x1f9c8, 0x1f9e8
.long 0x1f800, 0x14d10, 0x1f9d0, 0x1f9f0, 0x1f808, 0x14d18, 0x1f9d8, 0x100000
.long 0x1fea0, 0x14d00, 0x1f9c2, 0x1f9e2, 0x1fea8, 0x14d08, 0x1f9ca, 0x1f9ea
.long 0x1feb0, 0x14d10, 0x1f9d2, 0x1f9f2, 0x1feb8, 0x14d18, 0x1f9da, 0x100000
.long 0x1f870, 0x14d00, 0x1f9c4, 0x1f9e4, 0x1f878, 0x14d08, 0x1f9cc, 0x1f9ec
.long 0x1f860, 0x14d10, 0x1f9d4, 0x100000, 0x1f868, 0x14d18, 0x1f9dc, 0x100000
.long 0x1fec0, 0x14d00, 0x1f9c6, 0x1f9e6, 0x1fec8, 0x14d08, 0x1f9ce, 0x1f9ee
.long 0x1fed0, 0x14d10, 0x1f9d6, 0x100000, 0x1fed8, 0x14d18, 0x1f9de, 0x100000
.long 0x0, 0x4444, 0x0, 0xa400, 0x10, 0xeeee, 0x4, 0xa404
.long 0x20, 0x4444, 0x8, 0xa408, 0x30, 0xeeee, 0xc, 0xa40c
.long 0x40, 0x4444, 0x10, 0xa410, 0x50, 0xeeee, 0x14, 0xa414
.long 0x60, 0x4444, 0x18, 0xa418, 0x70, 0xeeee, 0x1c, 0xa41c
.long 0x0, 0x4444, 0x20, 0xa420, 0x10, 0xeeee, 0x24, 0xa424
.long 0x20, 0x4444, 0x28, 0xa428, 0x30, 0xeeee, 0x2c, 0xa42c
.long 0x40, 0x4444, 0x30, 0xa430, 0x50, 0xeeee, 0x34, 0xa434
.long 0x60, 0x4444, 0x38, 0xa438, 0x70, 0xeeee, 0x3c, 0xa43c
.long 0x0, 0x4444, 0x40, 0xa440, 0x10, 0xeeee, 0x44, 0xa444
.long 0x20, 0x4444, 0x48, 0xa448, 0x30, 0xeeee, 0x4c, 0xa44c
.long 0x40, 0x4444, 0x50, 0xa450, 0x50, 0xeeee, 0x54, 0xa454
.long 0x60, 0x4444, 0x58, 0xa458, 0x70, 0xeeee, 0x5c, 0xa45c
.long 0x0, 0x4444, 0x60, 0xa460, 0x10, 0xeeee, 0x64, 0xa464
.long 0x20, 0x4444, 0x68, 0xa468, 0x30, 0xeeee, 0x6c, 0xa46c
.long 0x40, 0x4444, 0x70, 0xa470, 0x50, 0xeeee, 0x74, 0xa474
.long 0x60, 0x4444, 0x78, 0xa478, 0x70, 0xeeee, 0x7c, 0xa47c
.long 0x0, 0x4444, 0x420, 0xb080, 0x10, 0xeeee, 0x424, 0xb084
.long 0x20, 0x4444, 0x428, 0xb088, 0x30, 0xeeee, 0x42c, 0xb08c
.long 0x40, 0x4444, 0x430, 0xb090, 0x50, 0xeeee, 0x434, 0xb094
.long 0x60, 0x4444, 0x438, 0xb098, 0x70, 0xeeee, 0x43c, 0xb09c
.long 0x0, 0x4444, 0x440, 0xb0a0, 0x10, 0xeeee, 0x444, 0xb0a4
.long 0x20, 0x4444, 0x448, 0xb0a8, 0x30, 0xeeee, 0x44c, 0xb0ac
.long 0x40, 0x4444, 0x450, 0xb0b0, 0x50, 0xeeee, 0x454, 0xb0b4
.long 0x60, 0x4444, 0x458, 0xb0b8, 0x70, 0xeeee, 0x45c, 0xb0bc
.long 0x0, 0x4444, 0x460, 0xb0c0, 0x10, 0xeeee, 0x464, 0xb0c4
.long 0x20, 0x4444, 0x468, 0xb0c8, 0x30, 0xeeee, 0x46c, 0xb0cc
.long 0x40, 0x4444, 0x470, 0xb0d0, 0x50, 0xeeee, 0x474, 0xb0d4
.long 0x60, 0x4444, 0x478, 0xb0d8, 0x70, 0xeeee, 0x47c, 0xb0dc
.long 0x0, 0x4444, 0x480, 0xb0e0, 0x10, 0xeeee, 0x484, 0xb0e4
.long 0x20, 0x4444, 0x488, 0xb0e8, 0x30, 0xeeee, 0x48c, 0xb0ec
.long 0x40, 0x4444, 0x490, 0xb0f0, 0x50, 0xeeee, 0x494, 0xb0f4
.long 0x60, 0x4444, 0x498, 0xb0f8, 0x70, 0xeeee, 0x49c, 0xb0fc
.long 0x1fa28, 0x1f9f4, 0x34, 0x14d00, 0x1fa28, 0x1f9f6, 0x74, 0x14d04
.long 0x1fa28, 0x1f9f8, 0xb4, 0x14d08, 0x1fa28, 0x1f9fa, 0xf4, 0x14d0c
.long 0x1fa28, 0x1f9fc, 0x134, 0x14d10, 0x1fa28, 0x1f9fe, 0x174, 0x14d14
.long 0x1fa28, 0x1fa00, 0x1b4, 0x14d18, 0x1fa28, 0x1fa02, 0x1f4, 0x14d1c
.long 0x1fa28, 0x1fa04, 0x234, 0x14d20, 0x1fa28, 0x1fa06, 0x274, 0x14d24
.long 0x1fa28, 0x1fa08, 0x2b4, 0x14d28, 0x1fa28, 0x1fa0a, 0x2f4, 0x14d2c
.long 0x1fa28, 0x1fa0c, 0x334, 0x14d30, 0x1fa28, 0x1fa0e, 0x374, 0x14d34
.long 0x1fa28, 0x1fa10, 0x3b4, 0x14d38, 0x1fa28, 0x1fa12, 0x3f4, 0x14d3c
.long 0x1fa28, 0x1fa14, 0x434, 0x14d00, 0x1fa28, 0x1fa16, 0x474, 0x14d04
.long 0x1fa28, 0x1fa18, 0x4b4, 0x14d08, 0x1fa28, 0x1fa1a, 0x4f4, 0x14d0c
.long 0x1fa28, 0x1fa1c, 0x534, 0x14d10, 0x1fa28, 0x1fa1e, 0x574, 0x14d14
.long 0x1fa28, 0x1fa20, 0x5b4, 0x14d18, 0x1fa28, 0x1fa22, 0x5f4, 0x14d1c
.long 0x1fa28, 0x1fa24, 0x634, 0x14d20, 0x1fa28, 0x1fa26, 0x674, 0x14d24
.long 0x1fa28, 0x1fa28, 0x6b4, 0x14d28, 0x1fa28, 0x1fa2a, 0x6f4, 0x14d2c
.long 0x1fa28, 0x1fa2c, 0x734, 0x14d30, 0x1fa28, 0x1fa2e, 0x774, 0x14d34
.long 0x1fa28, 0x1fa30, 0x7b4, 0x14d38, 0x1fa28, 0x1fa32, 0x7f4, 0x14d3c
.long 0x1fa38, 0x1fa34, 0x834, 0x14d00, 0x1fa38, 0x1fa36, 0x874, 0x14d04
.long 0x1fa38, 0x1fa38, 0x8b4, 0x14d08, 0x1fa38, 0x1fa3a, 0x8f4, 0x14d0c
.long 0x1fa38, 0x1fa3c, 0x934, 0x14d10, 0x1fa38, 0x1fa3e, 0x974, 0x14d14
.long 0x1fa38, 0x1fa40, 0x9b4, 0x14d18, 0x1fa38, 0x1fa42, 0x9f4, 0x14d1c
.long 0x1fa38, 0x1fa44, 0xa34, 0x14d20, 0x1fa38, 0x1fa46, 0xa74, 0x14d24
.long 0x1fa38, 0x1fa48, 0xab4, 0x14d28, 0x1fa38, 0x1fa4a, 0xaf4, 0x14d2c
.long 0x1fa38, 0x1fa4c, 0xb34, 0x14d30, 0x1fa38, 0x1fa4e, 0xb74, 0x14d34
.long 0x1fa38, 0x1fa50, 0xbb4, 0x14d38, 0x1fa38, 0x1fa52, 0xbf4, 0x14d3c
.long 0x1fa38, 0x1fa54, 0xc34, 0x14d00, 0x1fa38, 0x1fa56, 0xc74, 0x14d04
.long 0x1fa38, 0x1fa58, 0xcb4, 0x14d08, 0x1fa38, 0x1fa5a, 0xcf4, 0x14d0c
.long 0x1fa38, 0x1fa5c, 0xd34, 0x14d10, 0x1fa38, 0x1fa5e, 0xd74, 0x14d14
.long 0x1fa38, 0x1fa60, 0xdb4, 0x14d18, 0x1fa38, 0x1fa62, 0xdf4, 0x14d1c
.long 0x1fa38, 0x1fa64, 0xe34, 0x14d20, 0x1fa38, 0x1fa66, 0xe74, 0x14d24
.long 0x1fa38, 0x1fa68, 0xeb4, 0x14d28, 0x1fa38, 0x1fa6a, 0xef4, 0x14d2c
.long 0x1fa38, 0x1fa6c, 0xf34, 0x14d30, 0x1fa38, 0x1fa6e, 0xf74, 0x14d34
.long 0x1fa38, 0x1fa70, 0xfb4, 0x14d38, 0x1fa38, 0x1fa72, 0xff4, 0x14d3c
.long 0x0, 0x0, 0x0, 0x0, 0x0, 0x0, 0x0, 0x0
.long 0x0, 0x0, 0x0, 0x0, 0x0, 0x0, 0x0, 0x0
.long 0x0, 0x0, 0x0, 0x0, 0x0, 0x0, 0x0, 0x0
.long 0x0, 0x0, 0x0, 0x0, 0x0, 0x0, 0x0, 0x0
.long 0x0, 0x0, 0x0, 0x0, 0x0, 0x0, 0x0, 0x0
.long 0x0, 0x0, 0x0, 0x0, 0x0, 0x0, 0x0, 0x0
.long 0x0, 0x0, 0x0, 0x0, 0x0, 0x0, 0x0, 0x0
.long 0x0, 0x0, 0x0, 0x0, 0x0, 0x0, 0x0, 0x0
.long 0x0, 0x0, 0x0, 0x0, 0x0, 0x0, 0x0, 0x0
.long 0x0, 0x0, 0x0, 0x0, 0x0, 0x0, 0x0, 0x0
.long 0x0, 0x0, 0x0, 0x0, 0x0, 0x0, 0x0, 0x0
.long 0x0, 0x0, 0x0, 0x0, 0x0, 0x0, 0x0, 0x0
.long 0x0, 0x0, 0x0, 0x0, 0x0, 0x0, 0x0, 0x0
.long 0x0, 0x0, 0x0, 0x0, 0x0, 0x0, 0x0, 0x0
.long 0x0, 0x0, 0x0, 0x0, 0x0, 0x0, 0x0, 0x0
.long 0x0, 0x0, 0x0, 0x0, 0x0, 0x0, 0x0, 0x0
.long 0x0, 0x0, 0x0, 0x0, 0x0, 0x0, 0x0, 0x0
.long 0x0, 0x0, 0x0, 0x0, 0x0, 0x0, 0x0, 0x0
.long 0x0, 0x0, 0x0, 0x0, 0x0, 0x0, 0x0, 0x0
.long 0x0, 0x0, 0x0, 0x0, 0x0, 0x0, 0x0, 0x0
.long 0x0, 0x0, 0x0, 0x0, 0x0, 0x0, 0x0, 0x0
.long 0x0, 0x0, 0x0, 0x0, 0x0, 0x0, 0x0, 0x0
.long 0x0, 0x0, 0x0, 0x0, 0x0, 0x0, 0x0, 0x0
.long 0x0, 0x0, 0x0, 0x0, 0x0, 0x0, 0x0, 0x0
.long 0x0, 0x0, 0x0, 0x0, 0x0, 0x0, 0x0, 0x0
.long 0x0, 0x0, 0x0, 0x0, 0x0, 0x0, 0x0, 0x0
.long 0x0, 0x0, 0x0, 0x0, 0x0, 0x0, 0x0, 0x0
.long 0x0, 0x0, 0x0, 0x0, 0x0, 0x0, 0x0, 0x0
.long 0x0, 0x0, 0x0, 0x0, 0x0, 0x0, 0x0, 0x0
.long 0x0, 0x0, 0x0, 0x0, 0x0, 0x0, 0x0, 0x0
.long 0x0, 0x0, 0x0, 0x0, 0x0, 0x0, 0x0, 0x0
.long 0x0, 0x0, 0x0, 0x0, 0x0, 0x0, 0x0, 0x0
.long 0x13320, 0xa9b0, 0xa800, 0x10c00, 0xf320, 0xc120, 0x133b0, 0xb690
.long 0xa890, 0x11920, 0xf3b0, 0xce00, 0x12600, 0xa920, 0xb520, 0x10c90
.long 0xe600, 0xc090, 0x12690, 0xb600, 0xb5b0, 0x119b0, 0xe690, 0xcdb0
.long 0xd5f0, 0x11440, 0x117f0, 0x130d0, 0xf8d0, 0xadf0, 0xd640, 0x12160
.long 0x11840, 0x13df0, 0xf960, 0xbad0, 0xc8d0, 0x113f0, 0x124d0, 0x13160
.long 0xebf0, 0xad60, 0xc960, 0x120d0, 0x12560, 0x13e40, 0xec40, 0xba40
.long 0xefb0, 0x10ed0, 0x117b0, 0x12a40, 0xfa90, 0xdb60, 0xc890, 0x10d60
.long 0x10a90, 0x129f0, 0x13bb0, 0xddf0, 0xf000, 0x11bf0, 0x11520, 0xe960
.long 0xc160, 0xf9b0, 0xc920, 0x11a40, 0x10800, 0xe8d0, 0xc3f0, 0x13a90
.long 0xce40, 0xfa00, 0xfff0, 0xbb20, 0xedb0, 0xdad0, 0xced0, 0x10720
.long 0x10040, 0xc800, 0x14890, 0xde40, 0xf560, 0xfbb0, 0x140d0, 0xbdb0
.long 0xb3f0, 0xec00, 0xf5f0, 0x10890, 0x14160, 0xca90, 0xb760, 0x14720
.long 0x13520, 0xddb0, 0xa520, 0xbe00, 0xf490, 0xe800, 0x13690, 0x10490
.long 0xa5b0, 0xcb20, 0xe7b0, 0x14d00, 0x12800, 0xdd20, 0xb200, 0xbe90
.long 0xf800, 0x14320, 0x129b0, 0x10400, 0xb290, 0xcbb0, 0xeb20, 0x14290
.long 0xd560, 0x10760, 0x112d0, 0xaed0, 0xfb60, 0xeed0, 0xd3f0, 0xe040
.long 0x11360, 0xbbf0, 0xee40, 0x14d00, 0xc840, 0x106d0, 0x11ff0, 0xaf60
.long 0xfed0, 0x149f0, 0xc6d0, 0xdff0, 0x12040, 0xbc40, 0xf1f0, 0x14960
.long 0xbbb0, 0x10cd0, 0xfdb0, 0x12960, 0xd3b0, 0xd9f0, 0x13090, 0x11160
.long 0x13e90, 0x12bf0, 0xbff0, 0xd290, 0xbc00, 0x119f0, 0xfb20, 0xe840
.long 0xac90, 0xd840, 0x13120, 0x11e40, 0x13c00, 0xead0, 0xbe40, 0xabb0
.long 0xcf60, 0x11400, 0x101f0, 0xef20, 0x12e90, 0xdd60, 0xccd0, 0xd320
.long 0x10560, 0x14a00, 0xb640, 0x12d20, 0xf640, 0x115b0, 0x142d0, 0xf1b0
.long 0x121b0, 0xdcd0, 0xf3f0, 0xd490, 0x14640, 0x14c90, 0xb5f0, 0x12000
.long 0x13600, 0xf7b0, 0xa490, 0xb120, 0x10d20, 0xc200, 0x135b0, 0xea90
.long 0xa400, 0x14d00, 0x10db0, 0xcf20, 0x12920, 0xf720, 0xaa00, 0x14000
.long 0x11a00, 0xc290, 0x12890, 0xea00, 0xb720, 0x14090, 0x11a90, 0xcfb0
.long 0xd4d0, 0xfa40, 0x11760, 0x123f0, 0x12cd0, 0xaff0, 0xd440, 0xed60
.long 0x116d0, 0x14d00, 0x12d60, 0xbcd0, 0xc7f0, 0xf9f0, 0x118d0, 0x14ad0
.long 0x139f0, 0xb040, 0xc760, 0xecd0, 0x125f0, 0x14b60, 0x13a40, 0xbd60
.long 0xe290, 0x10e40, 0xc9b0, 0x12760, 0xfe00, 0x13640, 0x10df0, 0xd5b0
.long 0xf090, 0x128d0, 0x13f20, 0x138d0, 0xe320, 0x11b60, 0x12640, 0xafb0
.long 0xfe90, 0x14360, 0x11ad0, 0xd600, 0xe560, 0xad20, 0x13fb0, 0x145f0
.long 0xe000, 0xcd60, 0x10920, 0x102d0, 0xa6d0, 0xebb0, 0xd040, 0x12e00
.long 0xfc00, 0x10240, 0xaa40, 0x14690, 0xe1b0, 0xf440, 0x103f0, 0x12320
.long 0xe7f0, 0xee00, 0xf760, 0x12fb0, 0x144d0, 0x125b0, 0xeb60, 0x14920
.long 0x13720, 0x111b0, 0xdb20, 0xf400, 0x11090, 0x11d20, 0x137b0, 0x11e90
.long 0xda90, 0xe720, 0x11db0, 0x14d00, 0x12a00, 0x11120, 0x10200, 0xf5b0
.long 0x11200, 0x14400, 0x12a90, 0x11e00, 0x101b0, 0xe890, 0x11f20, 0x14490
.long 0xd6d0, 0x12e40, 0x108d0, 0xfc40, 0x13240, 0x13ed0, 0xd760, 0x13b60
.long 0x10840, 0xef60, 0x13f60, 0x14d00, 0xc9f0, 0x12df0, 0xe1f0, 0xfad0
.long 0x132d0, 0x14bf0, 0xca40, 0x13ad0, 0xe160, 0xedf0, 0x13ff0, 0x14c40
.long 0x11690, 0x11040, 0xde90, 0xa640, 0x10b20, 0x136d0, 0x109b0, 0x10ff0
.long 0xa5f0, 0xd1b0, 0x10bb0, 0x143f0, 0x11720, 0x11d60, 0xdf20, 0xb360
.long 0xb000, 0x13360, 0x10a00, 0x11cd0, 0xb2d0, 0xd200, 0xb090, 0x14040
.long 0xcbf0, 0xb920, 0xe400, 0x13560, 0xa560, 0xc490, 0xcc40, 0xc600
.long 0x13840, 0x13200, 0xe640, 0xc720, 0xf2d0, 0xba90, 0xdfb0, 0xc040
.long 0xa8d0, 0x11fb0, 0xf360, 0xc7b0, 0xc360, 0x12db0, 0xe9f0, 0x12200
.long 0x13400, 0xc3b0, 0xdc00, 0x10e00, 0xbfb0, 0xcc00, 0x13490, 0xd090
.long 0xdc90, 0x11b20, 0xcc90, 0x14d00, 0x12720, 0xc320, 0x10320, 0x10fb0
.long 0xc400, 0x14120, 0x127b0, 0xd000, 0x103b0, 0x11c90, 0xd120, 0x141b0
.long 0xd1f0, 0xac40, 0x10ad0, 0x13040, 0xab60, 0xb7f0, 0xd240, 0xb960
.long 0x10b60, 0x13d60, 0xb840, 0x14d00, 0xc4d0, 0xabf0, 0xe3f0, 0x12ed0
.long 0xb0d0, 0x146d0, 0xc560, 0xb8d0, 0xe440, 0x13bf0, 0xbdf0, 0x14760
.long 0xfc90, 0x10f60, 0x11290, 0xa840, 0x13d20, 0x104d0, 0x13db0, 0x111f0
.long 0x105b0, 0xa7f0, 0x13c90, 0xf7f0, 0xfd20, 0x11c40, 0x11320, 0xb560
.long 0xae00, 0xff60, 0x13e00, 0x11ed0, 0x10600, 0xb4d0, 0xadb0, 0xf240
.long 0xcdf0, 0xed20, 0x133f0, 0xbd20, 0x12c40, 0x14bb0, 0xd160, 0x14800
.long 0x13440, 0xca00, 0x11f60, 0x14b20, 0xf4d0, 0xee90, 0xbed0, 0xb890
.long 0x12ad0, 0x12490, 0xf840, 0x149b0, 0xbf60, 0xc5b0, 0x11df0, 0x12400
.long 0x12bb0, 0x13800, 0xd920, 0xc000, 0x14600, 0x14d00, 0x13890, 0x14d00
.long 0xd9b0, 0xcd20, 0xc5f0, 0x14d00, 0x13920, 0x145b0, 0x10000, 0xc1b0
.long 0xb1b0, 0x14d00, 0x12c00, 0x14520, 0x10090, 0xce90, 0xfbf0, 0x14d00
.long 0xc640, 0xd2d0, 0x105f0, 0xae40, 0x14cd0, 0x14d00, 0xd360, 0x14d00
.long 0x10640, 0xbb60, 0xbf20, 0x14d00, 0xd7f0, 0x14840, 0xded0, 0xacd0
.long 0x10290, 0x14d00, 0xcad0, 0x147f0, 0xdf60, 0xb9f0, 0x11000, 0x14d00
.long 0x14a90, 0x11240, 0xf890, 0xa760, 0x14d00, 0xaad0, 0x123b0, 0x110d0
.long 0x139b0, 0xa9f0, 0x14d00, 0x12b20, 0x10c40, 0xae90, 0xf920, 0xb440
.long 0xe0d0, 0x14d00, 0x11960, 0xaf20, 0x13a00, 0xb6d0, 0x131f0, 0x14d00
.long 0x13b20, 0xd0d0, 0x135f0, 0xf120, 0x14d00, 0x12440, 0xac00, 0xcb60
.long 0x13960, 0x14c00, 0xf520, 0x14d00, 0xcff0, 0x12120, 0xc0d0, 0xec90
.long 0xda40, 0xe090, 0xf6d0, 0x12290, 0xc440, 0x147b0, 0x14d00, 0x14d00
.long 0xa600, 0xd800, 0xdbb0, 0x10120, 0x0, 0x0, 0xa7b0, 0xff20
.long 0xda00, 0x14d00, 0x0, 0x0, 0xb320, 0xd890, 0xde00, 0x14200
.long 0x0, 0x0, 0xb490, 0xffb0, 0x10520, 0x143b0, 0x0, 0x0
.long 0x11640, 0x109f0, 0x107f0, 0xe240, 0x0, 0x0, 0x114d0, 0xe2d0
.long 0x10960, 0x14d00, 0x0, 0x0, 0x12360, 0x10a40, 0x10bf0, 0x14a40
.long 0x0, 0x0, 0x121f0, 0xe360, 0xe4d0, 0x148d0, 0x0, 0x0
.long 0xbc90, 0x126d0, 0x12c90, 0xa960, 0x0, 0x0, 0x131b0, 0x12b60
.long 0xb7b0, 0xa4d0, 0x0, 0x0, 0xba00, 0xe5f0, 0xa440, 0xaa90
.long 0x0, 0x0, 0x12f20, 0xea40, 0xb160, 0xab20, 0x0, 0x0
.long 0x10360, 0x11600, 0xd720, 0x134d0, 0x0, 0x0, 0x100d0, 0xd520
.long 0x11800, 0x13760, 0x0, 0x0, 0x14440, 0x11890, 0x137f0, 0x12520
.long 0x0, 0x0, 0x141f0, 0xd7b0, 0xc2d0, 0x12090, 0x0, 0x0
.long 0xa720, 0xf200, 0xf600, 0x10f20, 0x0, 0x0, 0xa690, 0xe520
.long 0xf690, 0x11c00, 0x0, 0x0, 0xb400, 0xf290, 0xe920, 0x10e90
.long 0x0, 0x0, 0xb3b0, 0xe5b0, 0xe9b0, 0x11bb0, 0x0, 0x0
.long 0x115f0, 0xfcd0, 0xfdf0, 0x12ff0, 0x0, 0x0, 0x11560, 0xeff0
.long 0xfe40, 0x13cd0, 0x0, 0x0, 0x122d0, 0xfd60, 0xf0d0, 0x12f60
.long 0x0, 0x0, 0x12240, 0xf040, 0xf160, 0x13c40, 0x0, 0x0
.long 0xe3b0, 0x12840, 0x11490, 0xdc40, 0x0, 0x0, 0x127f0, 0xd690
.long 0x107b0, 0xdbf0, 0x0, 0x0, 0xe120, 0xe760, 0xc240, 0x113b0
.long 0x0, 0x0, 0xe6d0, 0xd400, 0xc1f0, 0x10690, 0x0, 0x0
.long 0xe200, 0x10160, 0xb9b0, 0xd8d0, 0x0, 0x0, 0x10440, 0x13000
.long 0xc690, 0xd960, 0x0, 0x0, 0xe490, 0x14240, 0xb1f0, 0xb800
.long 0x0, 0x0, 0x14560, 0x13290, 0xb240, 0xc520, 0x0, 0x0
.long 0x0, 0x0, 0x0, 0x0, 0x0, 0x0, 0x0, 0x0
.long 0x0, 0x0, 0x0, 0x0, 0x0, 0x0, 0x0, 0x0
.long 0x0, 0x0, 0x0, 0x0, 0x0, 0x0, 0x0, 0x0
.long 0x0, 0x0, 0x0, 0x0, 0x0, 0x0, 0x0, 0x0
.long 0x0, 0x0, 0x0, 0x0, 0x0, 0x0, 0x0, 0x0
.long 0x0, 0x0, 0x0, 0x0, 0x0, 0x0, 0x0, 0x0
.long 0x0, 0x0, 0x0, 0x0, 0x0, 0x0, 0x0, 0x0
.long 0x0, 0x0, 0x0, 0x0, 0x0, 0x0, 0x0, 0x0
.long 0x0, 0x0, 0x0, 0x0, 0x0, 0x0, 0x0, 0x0
.long 0x0, 0x0, 0x0, 0x0, 0x0, 0x0, 0x0, 0x0
.long 0x0, 0x0, 0x0, 0x0, 0x0, 0x0, 0x0, 0x0
.long 0x0, 0x0, 0x0, 0x0, 0x0, 0x0, 0x0, 0x0
.long 0x0, 0x0, 0x0, 0x0, 0x0, 0x0, 0x0, 0x0
.long 0x0, 0x0, 0x0, 0x0, 0x0, 0x0, 0x0, 0x0
.long 0x0, 0x0, 0x0, 0x0, 0x0, 0x0, 0x0, 0x0
.long 0x0, 0x0, 0x0, 0x0, 0x0, 0x0, 0x0, 0x0
.long 0x0, 0x0, 0x0, 0x0, 0x0, 0x0, 0x0, 0x0
.long 0x0, 0x0, 0x0, 0x0, 0x0, 0x0, 0x0, 0x0
.long 0x0, 0x0, 0x0, 0x0, 0x0, 0x0, 0x0, 0x0
.long 0x0, 0x0, 0x0, 0x0, 0x0, 0x0, 0x0, 0x0
.long 0x0, 0x0, 0x0, 0x0, 0x0, 0x0, 0x0, 0x0
.long 0x0, 0x0, 0x0, 0x0, 0x0, 0x0, 0x0, 0x0
.long 0x0, 0x0, 0x0, 0x0, 0x0, 0x0, 0x0, 0x0
.long 0x0, 0x0, 0x0, 0x0, 0x0, 0x0, 0x0, 0x0
.long 0x0, 0x0, 0x0, 0x0, 0x0, 0x0, 0x0, 0x0
.long 0x0, 0x0, 0x0, 0x0, 0x0, 0x0, 0x0, 0x0
.long 0x0, 0x0, 0x0, 0x0, 0x0, 0x0, 0x0, 0x0
.long 0x0, 0x0, 0x0, 0x0, 0x0, 0x0, 0x0, 0x0
.long 0x0, 0x0, 0x0, 0x0, 0x0, 0x0, 0x0, 0x0
.long 0x0, 0x0, 0x0, 0x0, 0x0, 0x0, 0x0, 0x0
.long 0x0, 0x0, 0x0, 0x0, 0x0, 0x0, 0x0, 0x0
.long 0x0, 0x0, 0x0, 0x0, 0x0, 0x0, 0x0, 0x0
.section .rodata,"a"
.p2align 6
.amdhsa_kernel standalone__deep_cross_xdeepfm__recsys_kernel
  .amdhsa_next_free_vgpr 256
  .amdhsa_next_free_sgpr 102
  .amdhsa_accum_offset 256
  .amdhsa_group_segment_fixed_size 0
  .amdhsa_kernarg_size 88
  .amdhsa_user_sgpr_count 2
  .amdhsa_user_sgpr_kernarg_segment_ptr 1
  .amdhsa_system_sgpr_workgroup_id_x 1
  .amdhsa_float_denorm_mode_32 3
.end_amdhsa_kernel
```

```asm
; @launch grid=(256,1,1) block=(512,1,1) lds=163840
.amdgcn_target "amdgcn-amd-amdhsa--gfx950"
.text
.globl standalone__deep_cross_xdeepfm__recsys_kernel
.p2align 8
.type standalone__deep_cross_xdeepfm__recsys_kernel,@function
standalone__deep_cross_xdeepfm__recsys_kernel:
  s_cmp_ge_u32 s2, 256
  s_cbranch_scc1 L_end
  s_load_dwordx16 s[4:19], s[0:1], 0
  s_load_dwordx4 s[20:23], s[0:1], 64
  s_load_dwordx2 s[24:25], s[0:1], 80
  v_lshrrev_b32 v1, 6, v0
  s_getpc_b64 s[92:93]
L_pc:
  s_and_b32 s68, s2, 0xf8
  v_add_u32 v2, s68, v1
  v_and_b32_e64 v3, 32, v0
  v_lshl_add_u32 v2, v3, 3, v2
  v_lshlrev_b32 v2, 7, v2
  v_min_u32 v2, L_end-L_pc, v2
  v_mov_b32 v3, s93
  v_add_co_u32 v2, vcc, s92, v2
  s_nop 1
  v_addc_co_u32 v3, vcc, 0, v3, vcc
  global_load_dword v251, v[2:3], off
  v_and_b32_e64 v0, 63, v0
  v_readfirstlane_b32 s3, v1
  s_and_b32 s68, s2, 7
  s_lshr_b32 s69, s2, 3
  s_and_b32 s80, s2, 0xf8
  s_add_u32 s80, s80, s3
  s_lshl_b32 s80, s80, 0
  s_min_u32 s70, s68, 1
  s_add_u32 s71, s69, s70
  s_cmp_ge_u32 s71, 22
  s_cbranch_scc1 L_cin
  s_mul_i32 s68, s68, 21
  s_add_u32 s68, s68, s71
  s_mul_i32 s26, s68, 5042
  s_lshr_b32 s26, s26, 16
  s_mul_i32 s69, s26, 13
  s_sub_u32 s27, s68, s69
  s_lshl_b32 s77, s27, 8
  s_mul_i32 s71, s26, 320
  v_lshrrev_b32 v116, 4, v0
  v_lshlrev_b32 v11, 4, v0
  s_and_b32 s79, s3, 3
  s_cmp_lt_u32 s3, 4
  s_cbranch_scc1 L_cmp
  s_lshr_b32 s68, s79, 1
  s_mul_i32 s68, s68, 20
  s_and_b32 s69, s79, 1
  s_add_u32 s68, s68, s69
  s_lshl_b32 s76, s68, 10
  s_mul_i32 s78, s71, 104
  s_mul_i32 s68, s68, 832
  s_add_u32 s94, s78, s68
  v_mul_u32_u24 v118, 48, v116
  v_sub_u32 v12, v11, v118
  s_add_u32 s95, s94, 3328
  s_add_u32 s96, s94, 6656
  s_add_u32 s97, s94, 9984
  s_add_u32 s98, s94, 13312
  s_and_b32 s70, s79, 1
  s_lshl_b32 s70, s70, 3
  v_lshlrev_b32 v117, 1, v116
  v_or_b32 v117, s70, v117
  v_xor_b32 v117, v117, v0
  v_and_b32_e64 v117, 15, v117
  v_mul_u32_u24 v4, 3328, v116
  v_lshl_add_u32 v4, v117, 4, v4
  v_add_u32 v5, 13312, v4
  s_mul_i32 s74, s79, 26624
  s_add_u32 s74, s74, s77
  s_lshl_b32 s75, s79, 11
  s_waitcnt lgkmcnt(0)
  s_mov_b32 s28, s4
  s_and_b32 s29, s5, 0xffff
  s_mov_b32 s30, 425984
  s_mov_b32 s31, 0x20000
  buffer_load_dwordx4 v[16:19], v12, s[28:31], s94 offen offset:0
  s_mov_b32 s32, s6
  s_and_b32 s33, s7, 0xffff
  s_mov_b32 s34, 12800000
  s_mov_b32 s35, 0x20000
  s_mov_b32 s44, s12
  s_and_b32 s45, s13, 0xffff
  s_mov_b32 s46, 5537792
  s_mov_b32 s47, 0x20000
  s_add_u32 m0, s75, 131072
  s_nop 0
  buffer_load_dwordx4 v4, s[44:47], s74 offen lds
  s_add_u32 m0, s75, 132096
  s_nop 0
  buffer_load_dwordx4 v5, s[44:47], s74 offen lds
  s_add_u32 s74, s74, 106496
  s_add_u32 m0, s75, 139264
  s_nop 0
  buffer_load_dwordx4 v4, s[44:47], s74 offen lds
  s_add_u32 m0, s75, 140288
  s_nop 0
  buffer_load_dwordx4 v5, s[44:47], s74 offen lds
  s_add_u32 s74, s74, 106496
  buffer_load_dwordx4 v[20:23], v12, s[28:31], s94 offen offset:1664
  buffer_load_dwordx4 v[24:27], v12, s[28:31], s95 offen offset:0
  buffer_load_dwordx4 v[28:31], v12, s[28:31], s95 offen offset:1664
  buffer_load_dwordx4 v[32:35], v12, s[28:31], s96 offen offset:0
  buffer_load_dwordx4 v[36:39], v12, s[28:31], s96 offen offset:1664
  buffer_load_dwordx4 v[40:43], v12, s[28:31], s97 offen offset:0
  buffer_load_dwordx4 v[44:47], v12, s[28:31], s97 offen offset:1664
  buffer_load_dwordx4 v[48:51], v12, s[28:31], s98 offen offset:0
  buffer_load_dwordx4 v[52:55], v12, s[28:31], s98 offen offset:1664
  s_lshl_b32 s70, s69, 6
  v_and_b32 v118, 7, v0
  v_xor_b32 v118, v118, v116
  v_lshlrev_b32 v118, 4, v118
  v_xor_b32 v2, s70, v118
  v_xor_b32 v3, 64, v2
  s_mov_b32 s72, 0
  s_mul_i32 s70, s79, 13
  s_add_u32 s70, s70, s27
  s_min_u32 s70, s70, 39
  s_lshl_b32 s70, s70, 3
  s_add_u32 s70, s70, s71
  s_mul_i32 s84, s70, 104
  v_lshrrev_b32 v118, 2, v0
  v_min_u32 v118, 7, v118
  v_mul_u32_u24 v118, 104, v118
  v_and_b32 v117, 3, v0
  v_lshl_add_u32 v7, v117, 2, v118
  s_lshl_b32 s70, s26, 2
  s_add_u32 s70, s70, s79
  s_add_u32 s70, s70, 384
  s_mul_i32 s85, s70, 3328
  s_add_u32 s85, s85, s77
  s_mov_b32 s70, 173056
  v_lshrrev_b32 v118, 1, v0
  v_mul_lo_u32 v118, s70, v118
  v_and_b32 v117, 1, v0
  v_lshl_add_u32 v76, v117, 7, v118
  s_mov_b32 s52, s16
  s_and_b32 s53, s17, 0xffff
  s_mov_b32 s54, 3328
  s_mov_b32 s55, 0x20000
  s_mul_i32 s70, s79, 2560
  s_add_u32 s70, s70, L_tail-L_pc
  v_lshlrev_b32 v8, 7, v0
  v_add_u32 v8, s70, v8
  v_mov_b32 v9, s93
  v_add_co_u32 v8, vcc, s92, v8
  s_nop 1
  v_addc_co_u32 v9, vcc, 0, v9, vcc
  s_waitcnt vmcnt(13)
  v_lshlrev_b32 v16, 7, v16
  v_lshlrev_b32 v18, 7, v18
  v_lshlrev_b32 v17, 7, v17
  v_lshlrev_b32_e64 v19, 7, v19
  v_add_u32_dpp v56, v16, v2 row_newbcast:0 row_mask:0xf bank_mask:0x3
  s_nop 1
  v_add_u32_dpp v56, v18, v2 row_newbcast:6 row_mask:0xf bank_mask:0xc
  s_add_u32 m0, s76, 0
  s_nop 0
  buffer_load_dwordx4 v56, s[32:35], 0 offen lds
  s_waitcnt vmcnt(10)
  s_barrier
  s_waitcnt vmcnt(9)
  v_lshlrev_b32 v20, 7, v20
  v_lshlrev_b32 v22, 7, v22
  v_lshlrev_b32 v21, 7, v21
  v_lshlrev_b32 v23, 7, v23
  v_add_u32_dpp v57, v20, v2 row_newbcast:0 row_mask:0xf bank_mask:0x3
  s_nop 1
  v_add_u32_dpp v57, v22, v2 row_newbcast:6 row_mask:0xf bank_mask:0xc
  s_add_u32 m0, s76, 2048
  s_nop 0
  buffer_load_dwordx4 v57, s[32:35], 0 offen lds
  s_waitcnt vmcnt(9)
  v_lshlrev_b32 v24, 7, v24
  v_lshlrev_b32 v26, 7, v26
  v_lshlrev_b32 v25, 7, v25
  v_lshlrev_b32 v27, 7, v27
  v_add_u32_dpp v58, v24, v2 row_newbcast:0 row_mask:0xf bank_mask:0x3
  s_nop 1
  v_add_u32_dpp v58, v26, v2 row_newbcast:6 row_mask:0xf bank_mask:0xc
  s_add_u32 m0, s76, 4096
  s_nop 0
  buffer_load_dwordx4 v58, s[32:35], 0 offen lds
  s_waitcnt vmcnt(9)
  v_lshlrev_b32 v28, 7, v28
  v_lshlrev_b32 v30, 7, v30
  v_lshlrev_b32 v29, 7, v29
  v_lshlrev_b32_e64 v31, 7, v31
  v_add_u32_dpp v59, v28, v2 row_newbcast:0 row_mask:0xf bank_mask:0x3
  s_nop 1
  v_add_u32_dpp v59, v30, v2 row_newbcast:6 row_mask:0xf bank_mask:0xc
  s_add_u32 m0, s76, 6144
  s_nop 0
  buffer_load_dwordx4 v59, s[32:35], 0 offen lds
  s_waitcnt vmcnt(9)
  v_lshlrev_b32 v32, 7, v32
  v_lshlrev_b32 v34, 7, v34
  v_lshlrev_b32 v33, 7, v33
  v_lshlrev_b32_e64 v35, 7, v35
  v_add_u32_dpp v60, v32, v2 row_newbcast:0 row_mask:0xf bank_mask:0x3
  s_nop 1
  v_add_u32_dpp v60, v34, v2 row_newbcast:6 row_mask:0xf bank_mask:0xc
  s_add_u32 m0, s76, 8192
  s_nop 0
  buffer_load_dwordx4 v60, s[32:35], 0 offen lds
  s_waitcnt vmcnt(9)
  v_lshlrev_b32 v36, 7, v36
  v_lshlrev_b32 v38, 7, v38
  v_lshlrev_b32 v37, 7, v37
  v_lshlrev_b32_e64 v39, 7, v39
  v_add_u32_dpp v61, v36, v2 row_newbcast:0 row_mask:0xf bank_mask:0x3
  s_nop 1
  v_add_u32_dpp v61, v38, v2 row_newbcast:6 row_mask:0xf bank_mask:0xc
  s_add_u32 m0, s76, 10240
  s_nop 0
  buffer_load_dwordx4 v61, s[32:35], 0 offen lds
  s_waitcnt vmcnt(9)
  v_lshlrev_b32 v40, 7, v40
  v_lshlrev_b32 v42, 7, v42
  v_lshlrev_b32 v41, 7, v41
  v_lshlrev_b32_e64 v43, 7, v43
  v_add_u32_dpp v62, v40, v2 row_newbcast:0 row_mask:0xf bank_mask:0x3
  s_nop 1
  v_add_u32_dpp v62, v42, v2 row_newbcast:6 row_mask:0xf bank_mask:0xc
  s_add_u32 m0, s76, 12288
  s_nop 0
  buffer_load_dwordx4 v62, s[32:35], 0 offen lds
  s_waitcnt vmcnt(9)
  v_lshlrev_b32 v44, 7, v44
  v_lshlrev_b32 v46, 7, v46
  v_lshlrev_b32 v45, 7, v45
  v_lshlrev_b32_e64 v47, 7, v47
  v_add_u32_dpp v63, v44, v2 row_newbcast:0 row_mask:0xf bank_mask:0x3
  s_nop 1
  v_add_u32_dpp v63, v46, v2 row_newbcast:6 row_mask:0xf bank_mask:0xc
  s_add_u32 m0, s76, 14336
  s_nop 0
  buffer_load_dwordx4 v63, s[32:35], 0 offen lds
  s_waitcnt vmcnt(9)
  v_lshlrev_b32 v48, 7, v48
  v_lshlrev_b32 v50, 7, v50
  v_lshlrev_b32 v49, 7, v49
  v_lshlrev_b32_e64 v51, 7, v51
  v_add_u32_dpp v64, v48, v2 row_newbcast:0 row_mask:0xf bank_mask:0x3
  s_nop 1
  v_add_u32_dpp v64, v50, v2 row_newbcast:6 row_mask:0xf bank_mask:0xc
  s_add_u32 m0, s76, 16384
  s_nop 0
  buffer_load_dwordx4 v64, s[32:35], 0 offen lds
  s_waitcnt vmcnt(9)
  v_lshlrev_b32 v52, 7, v52
  v_lshlrev_b32 v54, 7, v54
  v_lshlrev_b32 v53, 7, v53
  v_lshlrev_b32_e64 v55, 7, v55
  v_add_u32_dpp v65, v52, v2 row_newbcast:0 row_mask:0xf bank_mask:0x3
  s_nop 1
  v_add_u32_dpp v65, v54, v2 row_newbcast:6 row_mask:0xf bank_mask:0xc
  s_add_u32 m0, s76, 18432
  s_nop 0
  buffer_load_dwordx4 v65, s[32:35], 0 offen lds
  v_add_u32_dpp v56, v17, v2 row_newbcast:0 row_mask:0xf bank_mask:0x3
  s_nop 1
  v_add_u32_dpp v56, v19, v2 row_newbcast:6 row_mask:0xf bank_mask:0xc
  s_add_u32 m0, s76, 40960
  s_nop 0
  buffer_load_dwordx4 v56, s[32:35], 0 offen lds
  v_add_u32_dpp v57, v21, v2 row_newbcast:0 row_mask:0xf bank_mask:0x3
  s_nop 1
  v_add_u32_dpp v57, v23, v2 row_newbcast:6 row_mask:0xf bank_mask:0xc
  s_add_u32 m0, s76, 43008
  s_nop 0
  buffer_load_dwordx4 v57, s[32:35], 0 offen lds
  v_add_u32_dpp v58, v25, v2 row_newbcast:0 row_mask:0xf bank_mask:0x3
  s_nop 1
  v_add_u32_dpp v58, v27, v2 row_newbcast:6 row_mask:0xf bank_mask:0xc
  s_add_u32 m0, s76, 45056
  s_nop 0
  buffer_load_dwordx4 v58, s[32:35], 0 offen lds
  v_add_u32_dpp v59, v29, v2 row_newbcast:0 row_mask:0xf bank_mask:0x3
  s_nop 1
  v_add_u32_dpp v59, v31, v2 row_newbcast:6 row_mask:0xf bank_mask:0xc
  s_add_u32 m0, s76, 47104
  s_nop 0
  buffer_load_dwordx4 v59, s[32:35], 0 offen lds
  v_add_u32_dpp v60, v33, v2 row_newbcast:0 row_mask:0xf bank_mask:0x3
  s_nop 1
  v_add_u32_dpp v60, v35, v2 row_newbcast:6 row_mask:0xf bank_mask:0xc
  s_add_u32 m0, s76, 49152
  s_nop 0
  buffer_load_dwordx4 v60, s[32:35], 0 offen lds
  s_waitcnt vmcnt(11)
  s_barrier
  v_add_u32_dpp v61, v37, v2 row_newbcast:0 row_mask:0xf bank_mask:0x3
  s_nop 1
  v_add_u32_dpp v61, v39, v2 row_newbcast:6 row_mask:0xf bank_mask:0xc
  s_add_u32 m0, s76, 51200
  s_nop 0
  buffer_load_dwordx4 v61, s[32:35], 0 offen lds
  v_add_u32_dpp v62, v41, v2 row_newbcast:0 row_mask:0xf bank_mask:0x3
  s_nop 1
  v_add_u32_dpp v62, v43, v2 row_newbcast:6 row_mask:0xf bank_mask:0xc
  s_add_u32 m0, s76, 53248
  s_nop 0
  buffer_load_dwordx4 v62, s[32:35], 0 offen lds
  v_add_u32_dpp v63, v45, v2 row_newbcast:0 row_mask:0xf bank_mask:0x3
  s_nop 1
  v_add_u32_dpp v63, v47, v2 row_newbcast:6 row_mask:0xf bank_mask:0xc
  s_add_u32 m0, s76, 55296
  s_nop 0
  buffer_load_dwordx4 v63, s[32:35], 0 offen lds
  v_add_u32_dpp v64, v49, v2 row_newbcast:0 row_mask:0xf bank_mask:0x3
  s_nop 1
  v_add_u32_dpp v64, v51, v2 row_newbcast:6 row_mask:0xf bank_mask:0xc
  s_add_u32 m0, s76, 57344
  s_nop 0
  buffer_load_dwordx4 v64, s[32:35], 0 offen lds
  v_add_u32_dpp v65, v53, v2 row_newbcast:0 row_mask:0xf bank_mask:0x3
  s_nop 1
  v_add_u32_dpp v65, v55, v2 row_newbcast:6 row_mask:0xf bank_mask:0xc
  s_add_u32 m0, s76, 59392
  s_nop 0
  buffer_load_dwordx4 v65, s[32:35], 0 offen lds
  s_waitcnt vmcnt(10)
  s_barrier
  s_add_u32 m0, s75, 147456
  s_nop 0
  buffer_load_dwordx4 v4, s[44:47], s74 offen lds
  s_add_u32 m0, s75, 148480
  s_nop 0
  buffer_load_dwordx4 v5, s[44:47], s74 offen lds
  s_add_u32 s74, s74, 106496
  s_add_u32 m0, s75, 155648
  s_nop 0
  buffer_load_dwordx4 v4, s[44:47], s74 offen lds
  s_add_u32 m0, s75, 156672
  s_nop 0
  buffer_load_dwordx4 v5, s[44:47], s74 offen lds
  s_add_u32 s74, s74, 106496
  v_add_u32_dpp v56, v18, v2 row_newbcast:0 row_mask:0xf bank_mask:0x3
  v_add_u32_dpp v57, v22, v2 row_newbcast:0 row_mask:0xf bank_mask:0x3
  v_add_u32_dpp v58, v26, v2 row_newbcast:0 row_mask:0xf bank_mask:0x3
  v_add_u32_dpp v59, v30, v2 row_newbcast:0 row_mask:0xf bank_mask:0x3
  v_add_u32_dpp v60, v34, v2 row_newbcast:0 row_mask:0xf bank_mask:0x3
  v_add_u32_dpp v61, v38, v2 row_newbcast:0 row_mask:0xf bank_mask:0x3
  v_add_u32_dpp v62, v42, v2 row_newbcast:0 row_mask:0xf bank_mask:0x3
  v_add_u32_dpp v63, v46, v2 row_newbcast:0 row_mask:0xf bank_mask:0x3
  v_add_u32_dpp v64, v50, v2 row_newbcast:0 row_mask:0xf bank_mask:0x3
  v_add_u32_dpp v65, v54, v2 row_newbcast:0 row_mask:0xf bank_mask:0x3
  v_add_u32_dpp v56, v16, v2 row_newbcast:7 row_mask:0xf bank_mask:0xc
  v_add_u32_dpp v57, v20, v2 row_newbcast:7 row_mask:0xf bank_mask:0xc
  v_add_u32_dpp v58, v24, v2 row_newbcast:7 row_mask:0xf bank_mask:0xc
  v_add_u32_dpp v59, v28, v2 row_newbcast:7 row_mask:0xf bank_mask:0xc
  v_add_u32_dpp v60, v32, v2 row_newbcast:7 row_mask:0xf bank_mask:0xc
  v_add_u32_dpp v61, v36, v2 row_newbcast:7 row_mask:0xf bank_mask:0xc
  v_add_u32_dpp v62, v40, v2 row_newbcast:7 row_mask:0xf bank_mask:0xc
  v_add_u32_dpp v63, v44, v2 row_newbcast:7 row_mask:0xf bank_mask:0xc
  v_add_u32_dpp v64, v48, v2 row_newbcast:7 row_mask:0xf bank_mask:0xc
  v_add_u32_dpp v65, v52, v2 row_newbcast:7 row_mask:0xf bank_mask:0xc
  s_add_u32 m0, s76, 81920
  s_nop 0
  buffer_load_dwordx4 v56, s[32:35], 0 offen lds
  s_add_u32 m0, s76, 83968
  s_nop 0
  buffer_load_dwordx4 v57, s[32:35], 0 offen lds
  s_add_u32 m0, s76, 86016
  s_nop 0
  buffer_load_dwordx4 v58, s[32:35], 0 offen lds
  s_add_u32 m0, s76, 88064
  s_nop 0
  buffer_load_dwordx4 v59, s[32:35], 0 offen lds
  s_add_u32 m0, s76, 90112
  s_nop 0
  buffer_load_dwordx4 v60, s[32:35], 0 offen lds
  s_add_u32 m0, s76, 92160
  s_nop 0
  buffer_load_dwordx4 v61, s[32:35], 0 offen lds
  s_add_u32 m0, s76, 94208
  s_nop 0
  buffer_load_dwordx4 v62, s[32:35], 0 offen lds
  s_add_u32 m0, s76, 96256
  s_nop 0
  buffer_load_dwordx4 v63, s[32:35], 0 offen lds
  s_waitcnt vmcnt(8)
  s_barrier
  s_add_u32 m0, s76, 98304
  s_nop 0
  buffer_load_dwordx4 v64, s[32:35], 0 offen lds
  s_add_u32 m0, s76, 100352
  s_nop 0
  buffer_load_dwordx4 v65, s[32:35], 0 offen lds
  v_add_u32_dpp v56, v19, v2 row_newbcast:0 row_mask:0xf bank_mask:0x3
  v_add_u32_dpp v57, v23, v2 row_newbcast:0 row_mask:0xf bank_mask:0x3
  v_add_u32_dpp v58, v27, v2 row_newbcast:0 row_mask:0xf bank_mask:0x3
  v_add_u32_dpp v59, v31, v2 row_newbcast:0 row_mask:0xf bank_mask:0x3
  v_add_u32_dpp v60, v35, v2 row_newbcast:0 row_mask:0xf bank_mask:0x3
  v_add_u32_dpp v61, v39, v2 row_newbcast:0 row_mask:0xf bank_mask:0x3
  v_add_u32_dpp v62, v43, v2 row_newbcast:0 row_mask:0xf bank_mask:0x3
  v_add_u32_dpp v63, v47, v2 row_newbcast:0 row_mask:0xf bank_mask:0x3
  v_add_u32_dpp v64, v51, v2 row_newbcast:0 row_mask:0xf bank_mask:0x3
  v_add_u32_dpp v65, v55, v2 row_newbcast:0 row_mask:0xf bank_mask:0x3
  v_add_u32_dpp v56, v17, v2 row_newbcast:7 row_mask:0xf bank_mask:0xc
  v_add_u32_dpp v57, v21, v2 row_newbcast:7 row_mask:0xf bank_mask:0xc
  v_add_u32_dpp v58, v25, v2 row_newbcast:7 row_mask:0xf bank_mask:0xc
  v_add_u32_dpp v59, v29, v2 row_newbcast:7 row_mask:0xf bank_mask:0xc
  v_add_u32_dpp v60, v33, v2 row_newbcast:7 row_mask:0xf bank_mask:0xc
  v_add_u32_dpp v61, v37, v2 row_newbcast:7 row_mask:0xf bank_mask:0xc
  v_add_u32_dpp v62, v41, v2 row_newbcast:7 row_mask:0xf bank_mask:0xc
  v_add_u32_dpp v63, v45, v2 row_newbcast:7 row_mask:0xf bank_mask:0xc
  v_add_u32_dpp v64, v49, v2 row_newbcast:7 row_mask:0xf bank_mask:0xc
  v_add_u32_dpp v65, v53, v2 row_newbcast:7 row_mask:0xf bank_mask:0xc
  s_setprio 0
  s_branch L_ld_in
L_cmp:
  s_mul_i32 s70, s3, 13
  v_min_u32 v118, 12, v0
  v_add_u32 v118, s70, v118
  v_lshrrev_b32 v117, 1, v118
  v_mul_u32_u24 v117, 96, v117
  v_lshl_add_u32 v118, v118, 2, v117
  s_mul_i32 s78, s27, 25
  s_min_u32 s78, s78, 294
  s_add_u32 s78, s78, s71
  s_mul_i32 s78, s78, 104
  s_waitcnt lgkmcnt(0)
  s_mov_b32 s28, s4
  s_and_b32 s29, s5, 0xffff
  s_mov_b32 s30, 425984
  s_mov_b32 s31, 0x20000
  s_mov_b32 s32, s6
  s_and_b32 s33, s7, 0xffff
  s_mov_b32 s34, 12800000
  s_mov_b32 s35, 0x20000
  s_mov_b32 s48, s14
  s_and_b32 s49, s15, 0xffff
  s_mov_b32 s50, 3328
  s_mov_b32 s51, 0x20000
  s_mov_b32 m0, 122880
  s_mov_b64 exec, 0xffff
  buffer_load_dwordx4 v11, s[48:51], s77 offen lds
  s_mov_b64 exec, -1
  s_and_b32 s68, s3, 1
  s_lshr_b32 s69, s3, 1
  v_bfe_u32 v117, v0, 2, 2
  v_lshl_add_u32 v118, v116, 3, v117
  v_lshlrev_b32 v118, 8, v118
  v_bfe_u32 v117, v0, 2, 3
  s_lshl_b32 s70, s69, 2
  v_xor_b32 v117, s70, v117
  v_lshl_add_u32 v118, v117, 5, v118
  v_and_b32 v117, 3, v0
  v_lshl_add_u32 v118, v117, 3, v118
  v_add_u32 v1, 131072, v118
  v_xor_b32 v2, 32, v1
  v_xor_b32 v3, 64, v1
  v_xor_b32 v4, 96, v1
  s_lshl_b32 s70, s69, 7
  s_add_u32 s70, s70, 122880
  v_lshlrev_b32 v118, 3, v116
  v_add_u32 v9, s70, v118
  v_and_b32 v118, 15, v0
  v_lshlrev_b32 v118, 7, v118
  v_bfe_u32 v117, v0, 1, 3
  v_xor_b32 v117, v117, v116
  v_lshl_add_u32 v118, v117, 4, v118
  s_mul_i32 s70, s68, 20480
  v_add_u32 v5, s70, v118
  v_xor_b32_e64 v7, 64, v5
  v_add_u32 v6, 81920, v5
  v_add_u32 v8, 81920, v7
  s_mul_i32 s70, s3, 640
  s_add_u32 s70, s70, 123392
  v_and_b32 v118, 15, v0
  v_lshlrev_b32 v118, 2, v118
  v_add_u32 v118, s70, v118
  v_lshrrev_b32_e64 v117, 5, v0
  v_lshl_add_u32 v118, v117, 6, v118
  v_bfe_u32 v117, v0, 4, 1
  v_lshl_add_u32 v10, v117, 7, v118
  s_mov_b32 s72, 0
  v_mov_b32 v12, 0xc0135761
  v_mov_b32 v13, 0xc0135761
  v_mov_b32 v14, 0xbdd2d3e8
  v_mov_b32 v15, 0xbdd2d3e8
  s_waitcnt vmcnt(0)
  ds_read_b64 v[18:19], v9 offset:0
  ds_read_b64 v[22:23], v9 offset:32
  ds_read_b64 v[26:27], v9 offset:64
  ds_read_b64 v[30:31], v9 offset:96
  s_waitcnt lgkmcnt(3)
  v_lshlrev_b32 v16, 16, v18
  v_and_b32 v17, 0xffff0000, v18
  v_lshlrev_b32 v18, 16, v19
  v_and_b32 v19, 0xffff0000, v19
  s_waitcnt lgkmcnt(2)
  v_lshlrev_b32 v20, 16, v22
  v_and_b32 v21, 0xffff0000, v22
  v_lshlrev_b32 v22, 16, v23
  v_and_b32 v23, 0xffff0000, v23
  s_waitcnt lgkmcnt(1)
  v_lshlrev_b32_e64 v24, 16, v26
  v_and_b32 v25, 0xffff0000, v26
  v_lshlrev_b32 v26, 16, v27
  v_and_b32 v27, 0xffff0000, v27
  s_waitcnt lgkmcnt(0)
  v_lshlrev_b32 v28, 16, v30
  v_and_b32 v29, 0xffff0000, v30
  v_lshlrev_b32 v30, 16, v31
  v_and_b32 v31, 0xffff0000, v31
  v_mov_b64 v[88:89], v[16:17]
  v_mov_b64 v[90:91], v[18:19]
  v_mov_b64 v[92:93], v[20:21]
  v_mov_b64 v[94:95], v[22:23]
  v_mov_b64 v[96:97], v[24:25]
  v_mov_b64 v[98:99], v[26:27]
  v_mov_b64 v[100:101], v[28:29]
  v_mov_b64 v[102:103], v[30:31]
  v_mov_b64 v[104:105], v[16:17]
  v_mov_b64 v[106:107], v[18:19]
  v_mov_b64 v[108:109], v[20:21]
  v_mov_b64 v[110:111], v[22:23]
  v_mov_b64 v[112:113], v[24:25]
  v_mov_b64 v[114:115], v[26:27]
  v_mov_b64 v[116:117], v[28:29]
  v_mov_b64 v[118:119], v[30:31]
  v_mov_b64 v[120:121], v[16:17]
  v_mov_b64 v[122:123], v[18:19]
  v_mov_b64 v[124:125], v[20:21]
  v_mov_b64 v[126:127], v[22:23]
  v_mov_b64 v[128:129], v[24:25]
  v_mov_b64 v[130:131], v[26:27]
  v_mov_b64 v[132:133], v[28:29]
  v_mov_b64 v[134:135], v[30:31]
  v_mov_b64 v[136:137], v[16:17]
  v_mov_b64 v[138:139], v[18:19]
  v_mov_b64 v[140:141], v[20:21]
  v_mov_b64 v[142:143], v[22:23]
  v_mov_b64 v[144:145], v[24:25]
  v_mov_b64 v[146:147], v[26:27]
  v_mov_b64 v[148:149], v[28:29]
  v_mov_b64 v[150:151], v[30:31]
  v_mov_b64 v[152:153], v[16:17]
  v_mov_b64 v[154:155], v[18:19]
  v_mov_b64 v[156:157], v[20:21]
  v_mov_b64 v[158:159], v[22:23]
  v_mov_b64 v[160:161], v[24:25]
  v_mov_b64 v[162:163], v[26:27]
  v_mov_b64 v[164:165], v[28:29]
  v_mov_b64 v[166:167], v[30:31]
  v_mov_b64 v[168:169], v[16:17]
  v_mov_b64 v[170:171], v[18:19]
  v_mov_b64 v[172:173], v[20:21]
  v_mov_b64 v[174:175], v[22:23]
  v_mov_b64 v[176:177], v[24:25]
  v_mov_b64 v[178:179], v[26:27]
  v_mov_b64 v[180:181], v[28:29]
  v_mov_b64 v[182:183], v[30:31]
  v_mov_b64 v[184:185], v[16:17]
  v_mov_b64 v[186:187], v[18:19]
  v_mov_b64 v[188:189], v[20:21]
  v_mov_b64 v[190:191], v[22:23]
  v_mov_b64 v[192:193], v[24:25]
  v_mov_b64 v[194:195], v[26:27]
  v_mov_b64 v[196:197], v[28:29]
  v_mov_b64 v[198:199], v[30:31]
  v_mov_b64 v[200:201], v[16:17]
  v_mov_b64 v[202:203], v[18:19]
  v_mov_b64 v[204:205], v[20:21]
  v_mov_b64 v[206:207], v[22:23]
  v_mov_b64 v[208:209], v[24:25]
  v_mov_b64 v[210:211], v[26:27]
  v_mov_b64 v[212:213], v[28:29]
  v_mov_b64 v[214:215], v[30:31]
  v_mov_b64 v[216:217], v[16:17]
  v_mov_b64 v[218:219], v[18:19]
  v_mov_b64 v[220:221], v[20:21]
  v_mov_b64 v[222:223], v[22:23]
  v_mov_b64 v[224:225], v[24:25]
  v_mov_b64 v[226:227], v[26:27]
  v_mov_b64 v[228:229], v[28:29]
  v_mov_b64 v[230:231], v[30:31]
  v_mov_b64 v[232:233], v[16:17]
  v_mov_b64 v[234:235], v[18:19]
  v_mov_b64 v[236:237], v[20:21]
  v_mov_b64 v[238:239], v[22:23]
  v_mov_b64 v[240:241], v[24:25]
  v_mov_b64 v[242:243], v[26:27]
  v_mov_b64 v[244:245], v[28:29]
  v_mov_b64 v[246:247], v[30:31]
  s_barrier
  ds_read_b64_tr_b16 v[16:17], v1 offset:0
  ds_read_b64_tr_b16 v[18:19], v1 offset:1024
  ds_read_b64_tr_b16 v[32:33], v1 offset:8192
  ds_read_b64_tr_b16 v[34:35], v1 offset:9216
  ds_read_b64_tr_b16 v[20:21], v2 offset:0
  ds_read_b64_tr_b16 v[22:23], v2 offset:1024
  ds_read_b64_tr_b16 v[36:37], v2 offset:8192
  ds_read_b64_tr_b16 v[38:39], v2 offset:9216
  ds_read_b64_tr_b16 v[24:25], v3 offset:0
  ds_read_b64_tr_b16 v[26:27], v3 offset:1024
  ds_read_b64_tr_b16 v[40:41], v3 offset:8192
  ds_read_b64_tr_b16 v[42:43], v3 offset:9216
  ds_read_b64_tr_b16 v[28:29], v4 offset:0
  ds_read_b64_tr_b16 v[30:31], v4 offset:1024
  ds_read_b64_tr_b16 v[44:45], v4 offset:8192
  ds_read_b64_tr_b16 v[46:47], v4 offset:9216
  s_waitcnt lgkmcnt(0)
  s_setprio 1
  s_barrier
  ds_read_b128 v[48:51], v5 offset:0
  ds_read_b128 v[52:55], v7 offset:0
  ds_read_b128 v[56:59], v5 offset:2048
  ds_read_b128 v[60:63], v7 offset:2048
  ds_read_b128 v[64:67], v5 offset:4096
  ds_read_b128 v[68:71], v7 offset:4096
  ds_read_b128 v[72:75], v5 offset:6144
  ds_read_b128 v[76:79], v7 offset:6144
  s_waitcnt lgkmcnt(7)
  v_mfma_f32_16x16x32_bf16 v[88:91], v[16:19], v[48:51], v[88:91]
  s_waitcnt lgkmcnt(4)
  v_mfma_f32_16x16x32_bf16 v[88:91], v[32:35], v[52:55], v[88:91]
  v_mfma_f32_16x16x32_bf16 v[104:107], v[16:19], v[56:59], v[104:107]
  v_mfma_f32_16x16x32_bf16 v[104:107], v[32:35], v[60:63], v[104:107]
  v_mfma_f32_16x16x32_bf16 v[92:95], v[20:23], v[48:51], v[92:95]
  v_mfma_f32_16x16x32_bf16 v[92:95], v[36:39], v[52:55], v[92:95]
  v_mfma_f32_16x16x32_bf16 v[108:111], v[20:23], v[56:59], v[108:111]
  v_mfma_f32_16x16x32_bf16 v[108:111], v[36:39], v[60:63], v[108:111]
  v_mfma_f32_16x16x32_bf16 v[96:99], v[24:27], v[48:51], v[96:99]
  v_xor_b32 v1, 16384, v1
  v_mfma_f32_16x16x32_bf16 v[96:99], v[40:43], v[52:55], v[96:99]
  v_xor_b32 v2, 16384, v2
  v_mfma_f32_16x16x32_bf16 v[112:115], v[24:27], v[56:59], v[112:115]
  v_xor_b32 v3, 16384, v3
  v_mfma_f32_16x16x32_bf16 v[112:115], v[40:43], v[60:63], v[112:115]
  v_xor_b32 v4, 16384, v4
  v_mfma_f32_16x16x32_bf16 v[100:103], v[28:31], v[48:51], v[100:103]
  v_mfma_f32_16x16x32_bf16 v[100:103], v[44:47], v[52:55], v[100:103]
  v_mfma_f32_16x16x32_bf16 v[116:119], v[28:31], v[56:59], v[116:119]
  s_waitcnt lgkmcnt(2)
  v_mfma_f32_16x16x32_bf16 v[116:119], v[44:47], v[60:63], v[116:119]
  s_nop 0
  v_mfma_f32_16x16x32_bf16 v[120:123], v[16:19], v[64:67], v[120:123]
  s_barrier
  s_waitcnt lgkmcnt(0)
  v_mfma_f32_16x16x32_bf16 v[120:123], v[32:35], v[68:71], v[120:123]
  ds_read_b128 v[80:83], v5 offset:8192
  v_mfma_f32_16x16x32_bf16 v[136:139], v[16:19], v[72:75], v[136:139]
  ds_read_b128 v[84:87], v7 offset:8192
  v_mfma_f32_16x16x32_bf16 v[136:139], v[32:35], v[76:79], v[136:139]
  ds_read_b128 v[48:51], v5 offset:10240
  v_mfma_f32_16x16x32_bf16 v[124:127], v[20:23], v[64:67], v[124:127]
  ds_read_b128 v[52:55], v7 offset:10240
  v_mfma_f32_16x16x32_bf16 v[124:127], v[36:39], v[68:71], v[124:127]
  ds_read_b128 v[56:59], v5 offset:12288
  v_mfma_f32_16x16x32_bf16 v[140:143], v[20:23], v[72:75], v[140:143]
  ds_read_b128 v[60:63], v7 offset:12288
  v_mfma_f32_16x16x32_bf16 v[140:143], v[36:39], v[76:79], v[140:143]
  v_mfma_f32_16x16x32_bf16 v[128:131], v[24:27], v[64:67], v[128:131]
  v_mfma_f32_16x16x32_bf16 v[128:131], v[40:43], v[68:71], v[128:131]
  v_mfma_f32_16x16x32_bf16 v[144:147], v[24:27], v[72:75], v[144:147]
  v_mfma_f32_16x16x32_bf16 v[144:147], v[40:43], v[76:79], v[144:147]
  v_mfma_f32_16x16x32_bf16 v[132:135], v[28:31], v[64:67], v[132:135]
  ds_read_b128 v[64:67], v5 offset:14336
  v_mfma_f32_16x16x32_bf16 v[132:135], v[44:47], v[68:71], v[132:135]
  s_nop 0
  ds_read_b128 v[68:71], v7 offset:14336
  v_mfma_f32_16x16x32_bf16 v[148:151], v[28:31], v[72:75], v[148:151]
  ds_read_b128 v[72:75], v5 offset:16384
  s_waitcnt lgkmcnt(7)
  v_mfma_f32_16x16x32_bf16 v[148:151], v[44:47], v[76:79], v[148:151]
  ds_read_b128 v[76:79], v7 offset:16384
  v_mfma_f32_16x16x32_bf16 v[152:155], v[16:19], v[80:83], v[152:155]
  s_waitcnt lgkmcnt(6)
  v_mfma_f32_16x16x32_bf16 v[152:155], v[32:35], v[84:87], v[152:155]
  v_mfma_f32_16x16x32_bf16 v[168:171], v[16:19], v[48:51], v[168:171]
  v_mfma_f32_16x16x32_bf16 v[168:171], v[32:35], v[52:55], v[168:171]
  v_mfma_f32_16x16x32_bf16 v[156:159], v[20:23], v[80:83], v[156:159]
  s_nop 0
  v_mfma_f32_16x16x32_bf16 v[156:159], v[36:39], v[84:87], v[156:159]
  v_mfma_f32_16x16x32_bf16 v[172:175], v[20:23], v[48:51], v[172:175]
  v_mfma_f32_16x16x32_bf16 v[172:175], v[36:39], v[52:55], v[172:175]
  v_mfma_f32_16x16x32_bf16 v[160:163], v[24:27], v[80:83], v[160:163]
  v_mfma_f32_16x16x32_bf16 v[160:163], v[40:43], v[84:87], v[160:163]
  v_mfma_f32_16x16x32_bf16 v[176:179], v[24:27], v[48:51], v[176:179]
  v_mfma_f32_16x16x32_bf16 v[176:179], v[40:43], v[52:55], v[176:179]
  v_mfma_f32_16x16x32_bf16 v[164:167], v[28:31], v[80:83], v[164:167]
  ds_read_b128 v[80:83], v5 offset:18432
  v_mfma_f32_16x16x32_bf16 v[164:167], v[44:47], v[84:87], v[164:167]
  ds_read_b128 v[84:87], v7 offset:18432
  v_mfma_f32_16x16x32_bf16 v[180:183], v[28:31], v[48:51], v[180:183]
  s_waitcnt lgkmcnt(6)
  v_mfma_f32_16x16x32_bf16 v[180:183], v[44:47], v[52:55], v[180:183]
  v_mfma_f32_16x16x32_bf16 v[184:187], v[16:19], v[56:59], v[184:187]
  s_waitcnt lgkmcnt(4)
  v_mfma_f32_16x16x32_bf16 v[184:187], v[32:35], v[60:63], v[184:187]
  v_mfma_f32_16x16x32_bf16 v[200:203], v[16:19], v[64:67], v[200:203]
  v_mfma_f32_16x16x32_bf16 v[200:203], v[32:35], v[68:71], v[200:203]
  v_mfma_f32_16x16x32_bf16 v[188:191], v[20:23], v[56:59], v[188:191]
  v_mfma_f32_16x16x32_bf16 v[188:191], v[36:39], v[60:63], v[188:191]
  s_waitcnt lgkmcnt(0)
  s_barrier
  v_mfma_f32_16x16x32_bf16 v[204:207], v[20:23], v[64:67], v[204:207]
  ds_read_b128 v[48:51], v5 offset:40960
  v_mfma_f32_16x16x32_bf16 v[204:207], v[36:39], v[68:71], v[204:207]
  ds_read_b128 v[52:55], v7 offset:40960
  v_mfma_f32_16x16x32_bf16 v[192:195], v[24:27], v[56:59], v[192:195]
  v_mfma_f32_16x16x32_bf16 v[192:195], v[40:43], v[60:63], v[192:195]
  v_mfma_f32_16x16x32_bf16 v[208:211], v[24:27], v[64:67], v[208:211]
  v_mfma_f32_16x16x32_bf16 v[208:211], v[40:43], v[68:71], v[208:211]
  v_mfma_f32_16x16x32_bf16 v[196:199], v[28:31], v[56:59], v[196:199]
  ds_read_b128 v[56:59], v5 offset:43008
  v_mfma_f32_16x16x32_bf16 v[196:199], v[44:47], v[60:63], v[196:199]
  ds_read_b128 v[60:63], v7 offset:43008
  v_mfma_f32_16x16x32_bf16 v[212:215], v[28:31], v[64:67], v[212:215]
  ds_read_b128 v[64:67], v5 offset:45056
  v_mfma_f32_16x16x32_bf16 v[212:215], v[44:47], v[68:71], v[212:215]
  ds_read_b128 v[68:71], v7 offset:45056
  v_mfma_f32_16x16x32_bf16 v[216:219], v[16:19], v[72:75], v[216:219]
  v_mfma_f32_16x16x32_bf16 v[216:219], v[32:35], v[76:79], v[216:219]
  v_mfma_f32_16x16x32_bf16 v[232:235], v[16:19], v[80:83], v[232:235]
  ds_read_b64_tr_b16 v[16:17], v1 offset:0
  v_mfma_f32_16x16x32_bf16 v[232:235], v[32:35], v[84:87], v[232:235]
  ds_read_b64_tr_b16 v[18:19], v1 offset:1024
  v_mfma_f32_16x16x32_bf16 v[220:223], v[20:23], v[72:75], v[220:223]
  ds_read_b64_tr_b16 v[32:33], v1 offset:8192
  v_mfma_f32_16x16x32_bf16 v[220:223], v[36:39], v[76:79], v[220:223]
  ds_read_b64_tr_b16 v[34:35], v1 offset:9216
  v_mfma_f32_16x16x32_bf16 v[236:239], v[20:23], v[80:83], v[236:239]
  ds_read_b64_tr_b16 v[20:21], v2 offset:0
  v_mfma_f32_16x16x32_bf16 v[236:239], v[36:39], v[84:87], v[236:239]
  ds_read_b64_tr_b16 v[22:23], v2 offset:1024
  v_mfma_f32_16x16x32_bf16 v[224:227], v[24:27], v[72:75], v[224:227]
  ds_read_b64_tr_b16 v[36:37], v2 offset:8192
  v_mfma_f32_16x16x32_bf16 v[224:227], v[40:43], v[76:79], v[224:227]
  ds_read_b64_tr_b16 v[38:39], v2 offset:9216
  v_mfma_f32_16x16x32_bf16 v[240:243], v[24:27], v[80:83], v[240:243]
  ds_read_b64_tr_b16 v[24:25], v3 offset:0
  v_mfma_f32_16x16x32_bf16 v[240:243], v[40:43], v[84:87], v[240:243]
  ds_read_b64_tr_b16 v[26:27], v3 offset:1024
  v_mfma_f32_16x16x32_bf16 v[228:231], v[28:31], v[72:75], v[228:231]
  ds_read_b64_tr_b16 v[40:41], v3 offset:8192
  v_mfma_f32_16x16x32_bf16 v[228:231], v[44:47], v[76:79], v[228:231]
  ds_read_b64_tr_b16 v[42:43], v3 offset:9216
  v_mfma_f32_16x16x32_bf16 v[244:247], v[28:31], v[80:83], v[244:247]
  ds_read_b64_tr_b16 v[28:29], v4 offset:0
  s_waitcnt lgkmcnt(9)
  v_mfma_f32_16x16x32_bf16 v[244:247], v[44:47], v[84:87], v[244:247]
  ds_read_b64_tr_b16 v[30:31], v4 offset:1024
L_dnn_loop0:
  v_mfma_f32_16x16x32_bf16 v[88:91], v[16:19], v[48:51], v[88:91]
  ds_read_b64_tr_b16 v[44:45], v4 offset:8192
  v_mfma_f32_16x16x32_bf16 v[88:91], v[32:35], v[52:55], v[88:91]
  s_nop 0
  ds_read_b64_tr_b16 v[46:47], v4 offset:9216
  v_mfma_f32_16x16x32_bf16 v[104:107], v[16:19], v[56:59], v[104:107]
  ds_read_b128 v[72:75], v5 offset:47104
  s_waitcnt lgkmcnt(9)
  v_mfma_f32_16x16x32_bf16 v[104:107], v[32:35], v[60:63], v[104:107]
  ds_read_b128 v[76:79], v7 offset:47104
  v_mfma_f32_16x16x32_bf16 v[92:95], v[20:23], v[48:51], v[92:95]
  ds_read_b128 v[80:83], v5 offset:49152
  v_mfma_f32_16x16x32_bf16 v[92:95], v[36:39], v[52:55], v[92:95]
  s_nop 0
  ds_read_b128 v[84:87], v7 offset:49152
  v_mfma_f32_16x16x32_bf16 v[108:111], v[20:23], v[56:59], v[108:111]
  s_waitcnt lgkmcnt(8)
  v_mfma_f32_16x16x32_bf16 v[108:111], v[36:39], v[60:63], v[108:111]
  v_mfma_f32_16x16x32_bf16 v[96:99], v[24:27], v[48:51], v[96:99]
  v_xor_b32 v1, 16384, v1
  v_mfma_f32_16x16x32_bf16 v[96:99], v[40:43], v[52:55], v[96:99]
  s_nop 0
  v_xor_b32 v2, 16384, v2
  v_mfma_f32_16x16x32_bf16 v[112:115], v[24:27], v[56:59], v[112:115]
  v_xor_b32 v3, 16384, v3
  s_waitcnt lgkmcnt(4)
  v_mfma_f32_16x16x32_bf16 v[112:115], v[40:43], v[60:63], v[112:115]
  v_xor_b32 v4, 16384, v4
  v_mfma_f32_16x16x32_bf16 v[100:103], v[28:31], v[48:51], v[100:103]
  ds_read_b128 v[48:51], v5 offset:51200
  v_mfma_f32_16x16x32_bf16 v[100:103], v[44:47], v[52:55], v[100:103]
  s_nop 0
  ds_read_b128 v[52:55], v7 offset:51200
  v_mfma_f32_16x16x32_bf16 v[116:119], v[28:31], v[56:59], v[116:119]
  ds_read_b128 v[56:59], v5 offset:53248
  v_mfma_f32_16x16x32_bf16 v[116:119], v[44:47], v[60:63], v[116:119]
  ds_read_b128 v[60:63], v7 offset:53248
  v_mfma_f32_16x16x32_bf16 v[120:123], v[16:19], v[64:67], v[120:123]
  s_waitcnt lgkmcnt(6)
  v_mfma_f32_16x16x32_bf16 v[120:123], v[32:35], v[68:71], v[120:123]
  s_nop 0
  v_mfma_f32_16x16x32_bf16 v[136:139], v[16:19], v[72:75], v[136:139]
  v_mfma_f32_16x16x32_bf16 v[136:139], v[32:35], v[76:79], v[136:139]
  v_mfma_f32_16x16x32_bf16 v[124:127], v[20:23], v[64:67], v[124:127]
  v_mfma_f32_16x16x32_bf16 v[124:127], v[36:39], v[68:71], v[124:127]
  v_mfma_f32_16x16x32_bf16 v[140:143], v[20:23], v[72:75], v[140:143]
  v_mfma_f32_16x16x32_bf16 v[140:143], v[36:39], v[76:79], v[140:143]
  v_mfma_f32_16x16x32_bf16 v[128:131], v[24:27], v[64:67], v[128:131]
  v_mfma_f32_16x16x32_bf16 v[128:131], v[40:43], v[68:71], v[128:131]
  v_mfma_f32_16x16x32_bf16 v[144:147], v[24:27], v[72:75], v[144:147]
  v_mfma_f32_16x16x32_bf16 v[144:147], v[40:43], v[76:79], v[144:147]
  v_mfma_f32_16x16x32_bf16 v[132:135], v[28:31], v[64:67], v[132:135]
  ds_read_b128 v[64:67], v5 offset:55296
  v_mfma_f32_16x16x32_bf16 v[132:135], v[44:47], v[68:71], v[132:135]
  ds_read_b128 v[68:71], v7 offset:55296
  v_mfma_f32_16x16x32_bf16 v[148:151], v[28:31], v[72:75], v[148:151]
  ds_read_b128 v[72:75], v5 offset:57344
  s_waitcnt lgkmcnt(7)
  v_mfma_f32_16x16x32_bf16 v[148:151], v[44:47], v[76:79], v[148:151]
  ds_read_b128 v[76:79], v7 offset:57344
  v_mfma_f32_16x16x32_bf16 v[152:155], v[16:19], v[80:83], v[152:155]
  s_waitcnt lgkmcnt(6)
  v_mfma_f32_16x16x32_bf16 v[152:155], v[32:35], v[84:87], v[152:155]
  v_mfma_f32_16x16x32_bf16 v[168:171], v[16:19], v[48:51], v[168:171]
  v_mfma_f32_16x16x32_bf16 v[168:171], v[32:35], v[52:55], v[168:171]
  v_mfma_f32_16x16x32_bf16 v[156:159], v[20:23], v[80:83], v[156:159]
  v_mfma_f32_16x16x32_bf16 v[156:159], v[36:39], v[84:87], v[156:159]
  v_mfma_f32_16x16x32_bf16 v[172:175], v[20:23], v[48:51], v[172:175]
  v_mfma_f32_16x16x32_bf16 v[172:175], v[36:39], v[52:55], v[172:175]
  v_mfma_f32_16x16x32_bf16 v[160:163], v[24:27], v[80:83], v[160:163]
  v_mfma_f32_16x16x32_bf16 v[160:163], v[40:43], v[84:87], v[160:163]
  v_mfma_f32_16x16x32_bf16 v[176:179], v[24:27], v[48:51], v[176:179]
  v_mfma_f32_16x16x32_bf16 v[176:179], v[40:43], v[52:55], v[176:179]
  v_mfma_f32_16x16x32_bf16 v[164:167], v[28:31], v[80:83], v[164:167]
  ds_read_b128 v[80:83], v5 offset:59392
  v_mfma_f32_16x16x32_bf16 v[164:167], v[44:47], v[84:87], v[164:167]
  ds_read_b128 v[84:87], v7 offset:59392
  v_mfma_f32_16x16x32_bf16 v[180:183], v[28:31], v[48:51], v[180:183]
  s_waitcnt lgkmcnt(6)
  v_mfma_f32_16x16x32_bf16 v[180:183], v[44:47], v[52:55], v[180:183]
  v_mfma_f32_16x16x32_bf16 v[184:187], v[16:19], v[56:59], v[184:187]
  s_waitcnt lgkmcnt(4)
  v_mfma_f32_16x16x32_bf16 v[184:187], v[32:35], v[60:63], v[184:187]
  v_mfma_f32_16x16x32_bf16 v[200:203], v[16:19], v[64:67], v[200:203]
  v_mfma_f32_16x16x32_bf16 v[200:203], v[32:35], v[68:71], v[200:203]
  v_mfma_f32_16x16x32_bf16 v[188:191], v[20:23], v[56:59], v[188:191]
  v_mfma_f32_16x16x32_bf16 v[188:191], v[36:39], v[60:63], v[188:191]
  s_waitcnt lgkmcnt(0)
  s_barrier
  v_mfma_f32_16x16x32_bf16 v[204:207], v[20:23], v[64:67], v[204:207]
  ds_read_b128 v[48:51], v6 offset:0
  v_mfma_f32_16x16x32_bf16 v[204:207], v[36:39], v[68:71], v[204:207]
  ds_read_b128 v[52:55], v8 offset:0
  v_mfma_f32_16x16x32_bf16 v[192:195], v[24:27], v[56:59], v[192:195]
  v_mfma_f32_16x16x32_bf16 v[192:195], v[40:43], v[60:63], v[192:195]
  v_mfma_f32_16x16x32_bf16 v[208:211], v[24:27], v[64:67], v[208:211]
  v_mfma_f32_16x16x32_bf16 v[208:211], v[40:43], v[68:71], v[208:211]
  v_mfma_f32_16x16x32_bf16 v[196:199], v[28:31], v[56:59], v[196:199]
  ds_read_b128 v[56:59], v6 offset:2048
  v_mfma_f32_16x16x32_bf16 v[196:199], v[44:47], v[60:63], v[196:199]
  ds_read_b128 v[60:63], v8 offset:2048
  v_mfma_f32_16x16x32_bf16 v[212:215], v[28:31], v[64:67], v[212:215]
  ds_read_b128 v[64:67], v6 offset:4096
  v_mfma_f32_16x16x32_bf16 v[212:215], v[44:47], v[68:71], v[212:215]
  ds_read_b128 v[68:71], v8 offset:4096
  v_mfma_f32_16x16x32_bf16 v[216:219], v[16:19], v[72:75], v[216:219]
  v_mfma_f32_16x16x32_bf16 v[216:219], v[32:35], v[76:79], v[216:219]
  v_mfma_f32_16x16x32_bf16 v[232:235], v[16:19], v[80:83], v[232:235]
  ds_read_b64_tr_b16 v[16:17], v1 offset:0
  v_mfma_f32_16x16x32_bf16 v[232:235], v[32:35], v[84:87], v[232:235]
  ds_read_b64_tr_b16 v[18:19], v1 offset:1024
  v_mfma_f32_16x16x32_bf16 v[220:223], v[20:23], v[72:75], v[220:223]
  ds_read_b64_tr_b16 v[32:33], v1 offset:8192
  v_mfma_f32_16x16x32_bf16 v[220:223], v[36:39], v[76:79], v[220:223]
  ds_read_b64_tr_b16 v[34:35], v1 offset:9216
  v_mfma_f32_16x16x32_bf16 v[236:239], v[20:23], v[80:83], v[236:239]
  ds_read_b64_tr_b16 v[20:21], v2 offset:0
  v_mfma_f32_16x16x32_bf16 v[236:239], v[36:39], v[84:87], v[236:239]
  ds_read_b64_tr_b16 v[22:23], v2 offset:1024
  v_mfma_f32_16x16x32_bf16 v[224:227], v[24:27], v[72:75], v[224:227]
  ds_read_b64_tr_b16 v[36:37], v2 offset:8192
  v_mfma_f32_16x16x32_bf16 v[224:227], v[40:43], v[76:79], v[224:227]
  ds_read_b64_tr_b16 v[38:39], v2 offset:9216
  v_mfma_f32_16x16x32_bf16 v[240:243], v[24:27], v[80:83], v[240:243]
  ds_read_b64_tr_b16 v[24:25], v3 offset:0
  v_mfma_f32_16x16x32_bf16 v[240:243], v[40:43], v[84:87], v[240:243]
  ds_read_b64_tr_b16 v[26:27], v3 offset:1024
  v_mfma_f32_16x16x32_bf16 v[228:231], v[28:31], v[72:75], v[228:231]
  ds_read_b64_tr_b16 v[40:41], v3 offset:8192
  v_mfma_f32_16x16x32_bf16 v[228:231], v[44:47], v[76:79], v[228:231]
  ds_read_b64_tr_b16 v[42:43], v3 offset:9216
  v_mfma_f32_16x16x32_bf16 v[244:247], v[28:31], v[80:83], v[244:247]
  ds_read_b64_tr_b16 v[28:29], v4 offset:0
  s_waitcnt lgkmcnt(9)
  v_mfma_f32_16x16x32_bf16 v[244:247], v[44:47], v[84:87], v[244:247]
  ds_read_b64_tr_b16 v[30:31], v4 offset:1024
  v_mfma_f32_16x16x32_bf16 v[88:91], v[16:19], v[48:51], v[88:91]
  ds_read_b64_tr_b16 v[44:45], v4 offset:8192
  v_mfma_f32_16x16x32_bf16 v[88:91], v[32:35], v[52:55], v[88:91]
  s_nop 0
  ds_read_b64_tr_b16 v[46:47], v4 offset:9216
  v_mfma_f32_16x16x32_bf16 v[104:107], v[16:19], v[56:59], v[104:107]
  ds_read_b128 v[72:75], v6 offset:6144
  s_waitcnt lgkmcnt(9)
  v_mfma_f32_16x16x32_bf16 v[104:107], v[32:35], v[60:63], v[104:107]
  ds_read_b128 v[76:79], v8 offset:6144
  v_mfma_f32_16x16x32_bf16 v[92:95], v[20:23], v[48:51], v[92:95]
  ds_read_b128 v[80:83], v6 offset:8192
  v_mfma_f32_16x16x32_bf16 v[92:95], v[36:39], v[52:55], v[92:95]
  s_nop 0
  ds_read_b128 v[84:87], v8 offset:8192
  v_mfma_f32_16x16x32_bf16 v[108:111], v[20:23], v[56:59], v[108:111]
  s_waitcnt lgkmcnt(8)
  v_mfma_f32_16x16x32_bf16 v[108:111], v[36:39], v[60:63], v[108:111]
  v_mfma_f32_16x16x32_bf16 v[96:99], v[24:27], v[48:51], v[96:99]
  v_xor_b32 v1, 16384, v1
  v_mfma_f32_16x16x32_bf16 v[96:99], v[40:43], v[52:55], v[96:99]
  s_nop 0
  v_xor_b32 v2, 16384, v2
  v_mfma_f32_16x16x32_bf16 v[112:115], v[24:27], v[56:59], v[112:115]
  v_xor_b32 v3, 16384, v3
  s_waitcnt lgkmcnt(4)
  v_mfma_f32_16x16x32_bf16 v[112:115], v[40:43], v[60:63], v[112:115]
  v_xor_b32 v4, 16384, v4
  v_mfma_f32_16x16x32_bf16 v[100:103], v[28:31], v[48:51], v[100:103]
  ds_read_b128 v[48:51], v6 offset:10240
  v_mfma_f32_16x16x32_bf16 v[100:103], v[44:47], v[52:55], v[100:103]
  s_nop 0
  ds_read_b128 v[52:55], v8 offset:10240
  v_mfma_f32_16x16x32_bf16 v[116:119], v[28:31], v[56:59], v[116:119]
  ds_read_b128 v[56:59], v6 offset:12288
  v_mfma_f32_16x16x32_bf16 v[116:119], v[44:47], v[60:63], v[116:119]
  ds_read_b128 v[60:63], v8 offset:12288
  v_mfma_f32_16x16x32_bf16 v[120:123], v[16:19], v[64:67], v[120:123]
  s_waitcnt lgkmcnt(6)
  v_mfma_f32_16x16x32_bf16 v[120:123], v[32:35], v[68:71], v[120:123]
  s_nop 0
  v_mfma_f32_16x16x32_bf16 v[136:139], v[16:19], v[72:75], v[136:139]
  v_mfma_f32_16x16x32_bf16 v[136:139], v[32:35], v[76:79], v[136:139]
  v_mfma_f32_16x16x32_bf16 v[124:127], v[20:23], v[64:67], v[124:127]
  v_mfma_f32_16x16x32_bf16 v[124:127], v[36:39], v[68:71], v[124:127]
  v_mfma_f32_16x16x32_bf16 v[140:143], v[20:23], v[72:75], v[140:143]
  v_mfma_f32_16x16x32_bf16 v[140:143], v[36:39], v[76:79], v[140:143]
  v_mfma_f32_16x16x32_bf16 v[128:131], v[24:27], v[64:67], v[128:131]
  v_mfma_f32_16x16x32_bf16 v[128:131], v[40:43], v[68:71], v[128:131]
  v_mfma_f32_16x16x32_bf16 v[144:147], v[24:27], v[72:75], v[144:147]
  v_mfma_f32_16x16x32_bf16 v[144:147], v[40:43], v[76:79], v[144:147]
  v_mfma_f32_16x16x32_bf16 v[132:135], v[28:31], v[64:67], v[132:135]
  ds_read_b128 v[64:67], v6 offset:14336
  v_mfma_f32_16x16x32_bf16 v[132:135], v[44:47], v[68:71], v[132:135]
  ds_read_b128 v[68:71], v8 offset:14336
  v_mfma_f32_16x16x32_bf16 v[148:151], v[28:31], v[72:75], v[148:151]
  ds_read_b128 v[72:75], v6 offset:16384
  s_waitcnt lgkmcnt(7)
  v_mfma_f32_16x16x32_bf16 v[148:151], v[44:47], v[76:79], v[148:151]
  ds_read_b128 v[76:79], v8 offset:16384
  v_mfma_f32_16x16x32_bf16 v[152:155], v[16:19], v[80:83], v[152:155]
  s_waitcnt lgkmcnt(6)
  v_mfma_f32_16x16x32_bf16 v[152:155], v[32:35], v[84:87], v[152:155]
  v_mfma_f32_16x16x32_bf16 v[168:171], v[16:19], v[48:51], v[168:171]
  v_mfma_f32_16x16x32_bf16 v[168:171], v[32:35], v[52:55], v[168:171]
  v_mfma_f32_16x16x32_bf16 v[156:159], v[20:23], v[80:83], v[156:159]
  v_mfma_f32_16x16x32_bf16 v[156:159], v[36:39], v[84:87], v[156:159]
  v_mfma_f32_16x16x32_bf16 v[172:175], v[20:23], v[48:51], v[172:175]
  v_mfma_f32_16x16x32_bf16 v[172:175], v[36:39], v[52:55], v[172:175]
  v_mfma_f32_16x16x32_bf16 v[160:163], v[24:27], v[80:83], v[160:163]
  v_mfma_f32_16x16x32_bf16 v[160:163], v[40:43], v[84:87], v[160:163]
  v_mfma_f32_16x16x32_bf16 v[176:179], v[24:27], v[48:51], v[176:179]
  v_mfma_f32_16x16x32_bf16 v[176:179], v[40:43], v[52:55], v[176:179]
  v_mfma_f32_16x16x32_bf16 v[164:167], v[28:31], v[80:83], v[164:167]
  ds_read_b128 v[80:83], v6 offset:18432
  v_mfma_f32_16x16x32_bf16 v[164:167], v[44:47], v[84:87], v[164:167]
  ds_read_b128 v[84:87], v8 offset:18432
  v_mfma_f32_16x16x32_bf16 v[180:183], v[28:31], v[48:51], v[180:183]
  s_waitcnt lgkmcnt(6)
  v_mfma_f32_16x16x32_bf16 v[180:183], v[44:47], v[52:55], v[180:183]
  v_mfma_f32_16x16x32_bf16 v[184:187], v[16:19], v[56:59], v[184:187]
  s_waitcnt lgkmcnt(4)
  v_mfma_f32_16x16x32_bf16 v[184:187], v[32:35], v[60:63], v[184:187]
  v_mfma_f32_16x16x32_bf16 v[200:203], v[16:19], v[64:67], v[200:203]
  v_mfma_f32_16x16x32_bf16 v[200:203], v[32:35], v[68:71], v[200:203]
  v_mfma_f32_16x16x32_bf16 v[188:191], v[20:23], v[56:59], v[188:191]
  v_mfma_f32_16x16x32_bf16 v[188:191], v[36:39], v[60:63], v[188:191]
  s_waitcnt lgkmcnt(0)
  s_barrier
  v_mfma_f32_16x16x32_bf16 v[204:207], v[20:23], v[64:67], v[204:207]
  ds_read_b128 v[48:51], v5 offset:0
  v_mfma_f32_16x16x32_bf16 v[204:207], v[36:39], v[68:71], v[204:207]
  ds_read_b128 v[52:55], v7 offset:0
  v_mfma_f32_16x16x32_bf16 v[192:195], v[24:27], v[56:59], v[192:195]
  v_mfma_f32_16x16x32_bf16 v[192:195], v[40:43], v[60:63], v[192:195]
  v_mfma_f32_16x16x32_bf16 v[208:211], v[24:27], v[64:67], v[208:211]
  v_mfma_f32_16x16x32_bf16 v[208:211], v[40:43], v[68:71], v[208:211]
  v_mfma_f32_16x16x32_bf16 v[196:199], v[28:31], v[56:59], v[196:199]
  ds_read_b128 v[56:59], v5 offset:2048
  v_mfma_f32_16x16x32_bf16 v[196:199], v[44:47], v[60:63], v[196:199]
  ds_read_b128 v[60:63], v7 offset:2048
  v_mfma_f32_16x16x32_bf16 v[212:215], v[28:31], v[64:67], v[212:215]
  ds_read_b128 v[64:67], v5 offset:4096
  v_mfma_f32_16x16x32_bf16 v[212:215], v[44:47], v[68:71], v[212:215]
  ds_read_b128 v[68:71], v7 offset:4096
  v_mfma_f32_16x16x32_bf16 v[216:219], v[16:19], v[72:75], v[216:219]
  v_mfma_f32_16x16x32_bf16 v[216:219], v[32:35], v[76:79], v[216:219]
  v_mfma_f32_16x16x32_bf16 v[232:235], v[16:19], v[80:83], v[232:235]
  ds_read_b64_tr_b16 v[16:17], v1 offset:0
  v_mfma_f32_16x16x32_bf16 v[232:235], v[32:35], v[84:87], v[232:235]
  ds_read_b64_tr_b16 v[18:19], v1 offset:1024
  v_mfma_f32_16x16x32_bf16 v[220:223], v[20:23], v[72:75], v[220:223]
  ds_read_b64_tr_b16 v[32:33], v1 offset:8192
  v_mfma_f32_16x16x32_bf16 v[220:223], v[36:39], v[76:79], v[220:223]
  ds_read_b64_tr_b16 v[34:35], v1 offset:9216
  v_mfma_f32_16x16x32_bf16 v[236:239], v[20:23], v[80:83], v[236:239]
  ds_read_b64_tr_b16 v[20:21], v2 offset:0
  v_mfma_f32_16x16x32_bf16 v[236:239], v[36:39], v[84:87], v[236:239]
  ds_read_b64_tr_b16 v[22:23], v2 offset:1024
  v_mfma_f32_16x16x32_bf16 v[224:227], v[24:27], v[72:75], v[224:227]
  ds_read_b64_tr_b16 v[36:37], v2 offset:8192
  v_mfma_f32_16x16x32_bf16 v[224:227], v[40:43], v[76:79], v[224:227]
  ds_read_b64_tr_b16 v[38:39], v2 offset:9216
  v_mfma_f32_16x16x32_bf16 v[240:243], v[24:27], v[80:83], v[240:243]
  ds_read_b64_tr_b16 v[24:25], v3 offset:0
  v_mfma_f32_16x16x32_bf16 v[240:243], v[40:43], v[84:87], v[240:243]
  ds_read_b64_tr_b16 v[26:27], v3 offset:1024
  v_mfma_f32_16x16x32_bf16 v[228:231], v[28:31], v[72:75], v[228:231]
  ds_read_b64_tr_b16 v[40:41], v3 offset:8192
  v_mfma_f32_16x16x32_bf16 v[228:231], v[44:47], v[76:79], v[228:231]
  ds_read_b64_tr_b16 v[42:43], v3 offset:9216
  v_mfma_f32_16x16x32_bf16 v[244:247], v[28:31], v[80:83], v[244:247]
  ds_read_b64_tr_b16 v[28:29], v4 offset:0
  s_waitcnt lgkmcnt(9)
  v_mfma_f32_16x16x32_bf16 v[244:247], v[44:47], v[84:87], v[244:247]
  ds_read_b64_tr_b16 v[30:31], v4 offset:1024
  v_mfma_f32_16x16x32_bf16 v[88:91], v[16:19], v[48:51], v[88:91]
  ds_read_b64_tr_b16 v[44:45], v4 offset:8192
  v_mfma_f32_16x16x32_bf16 v[88:91], v[32:35], v[52:55], v[88:91]
  s_nop 0
  ds_read_b64_tr_b16 v[46:47], v4 offset:9216
  v_mfma_f32_16x16x32_bf16 v[104:107], v[16:19], v[56:59], v[104:107]
  ds_read_b128 v[72:75], v5 offset:6144
  s_waitcnt lgkmcnt(9)
  v_mfma_f32_16x16x32_bf16 v[104:107], v[32:35], v[60:63], v[104:107]
  ds_read_b128 v[76:79], v7 offset:6144
  v_mfma_f32_16x16x32_bf16 v[92:95], v[20:23], v[48:51], v[92:95]
  ds_read_b128 v[80:83], v5 offset:8192
  v_mfma_f32_16x16x32_bf16 v[92:95], v[36:39], v[52:55], v[92:95]
  s_nop 0
  ds_read_b128 v[84:87], v7 offset:8192
  v_mfma_f32_16x16x32_bf16 v[108:111], v[20:23], v[56:59], v[108:111]
  s_waitcnt lgkmcnt(8)
  v_mfma_f32_16x16x32_bf16 v[108:111], v[36:39], v[60:63], v[108:111]
  v_mfma_f32_16x16x32_bf16 v[96:99], v[24:27], v[48:51], v[96:99]
  v_xor_b32 v1, 16384, v1
  v_mfma_f32_16x16x32_bf16 v[96:99], v[40:43], v[52:55], v[96:99]
  s_nop 0
  v_xor_b32 v2, 16384, v2
  v_mfma_f32_16x16x32_bf16 v[112:115], v[24:27], v[56:59], v[112:115]
  v_xor_b32 v3, 16384, v3
  s_waitcnt lgkmcnt(4)
  v_mfma_f32_16x16x32_bf16 v[112:115], v[40:43], v[60:63], v[112:115]
  v_xor_b32 v4, 16384, v4
  v_mfma_f32_16x16x32_bf16 v[100:103], v[28:31], v[48:51], v[100:103]
  ds_read_b128 v[48:51], v5 offset:10240
  v_mfma_f32_16x16x32_bf16 v[100:103], v[44:47], v[52:55], v[100:103]
  s_nop 0
  ds_read_b128 v[52:55], v7 offset:10240
  v_mfma_f32_16x16x32_bf16 v[116:119], v[28:31], v[56:59], v[116:119]
  ds_read_b128 v[56:59], v5 offset:12288
  v_mfma_f32_16x16x32_bf16 v[116:119], v[44:47], v[60:63], v[116:119]
  ds_read_b128 v[60:63], v7 offset:12288
  v_mfma_f32_16x16x32_bf16 v[120:123], v[16:19], v[64:67], v[120:123]
  s_waitcnt lgkmcnt(6)
  v_mfma_f32_16x16x32_bf16 v[120:123], v[32:35], v[68:71], v[120:123]
  s_nop 0
  v_mfma_f32_16x16x32_bf16 v[136:139], v[16:19], v[72:75], v[136:139]
  v_mfma_f32_16x16x32_bf16 v[136:139], v[32:35], v[76:79], v[136:139]
  v_mfma_f32_16x16x32_bf16 v[124:127], v[20:23], v[64:67], v[124:127]
  v_mfma_f32_16x16x32_bf16 v[124:127], v[36:39], v[68:71], v[124:127]
  v_mfma_f32_16x16x32_bf16 v[140:143], v[20:23], v[72:75], v[140:143]
  v_mfma_f32_16x16x32_bf16 v[140:143], v[36:39], v[76:79], v[140:143]
  v_mfma_f32_16x16x32_bf16 v[128:131], v[24:27], v[64:67], v[128:131]
  v_mfma_f32_16x16x32_bf16 v[128:131], v[40:43], v[68:71], v[128:131]
  v_mfma_f32_16x16x32_bf16 v[144:147], v[24:27], v[72:75], v[144:147]
  v_mfma_f32_16x16x32_bf16 v[144:147], v[40:43], v[76:79], v[144:147]
  v_mfma_f32_16x16x32_bf16 v[132:135], v[28:31], v[64:67], v[132:135]
  ds_read_b128 v[64:67], v5 offset:14336
  v_mfma_f32_16x16x32_bf16 v[132:135], v[44:47], v[68:71], v[132:135]
  ds_read_b128 v[68:71], v7 offset:14336
  v_mfma_f32_16x16x32_bf16 v[148:151], v[28:31], v[72:75], v[148:151]
  ds_read_b128 v[72:75], v5 offset:16384
  s_waitcnt lgkmcnt(7)
  v_mfma_f32_16x16x32_bf16 v[148:151], v[44:47], v[76:79], v[148:151]
  ds_read_b128 v[76:79], v7 offset:16384
  v_mfma_f32_16x16x32_bf16 v[152:155], v[16:19], v[80:83], v[152:155]
  s_waitcnt lgkmcnt(6)
  v_mfma_f32_16x16x32_bf16 v[152:155], v[32:35], v[84:87], v[152:155]
  v_mfma_f32_16x16x32_bf16 v[168:171], v[16:19], v[48:51], v[168:171]
  v_mfma_f32_16x16x32_bf16 v[168:171], v[32:35], v[52:55], v[168:171]
  v_mfma_f32_16x16x32_bf16 v[156:159], v[20:23], v[80:83], v[156:159]
  v_mfma_f32_16x16x32_bf16 v[156:159], v[36:39], v[84:87], v[156:159]
  v_mfma_f32_16x16x32_bf16 v[172:175], v[20:23], v[48:51], v[172:175]
  v_mfma_f32_16x16x32_bf16 v[172:175], v[36:39], v[52:55], v[172:175]
  v_mfma_f32_16x16x32_bf16 v[160:163], v[24:27], v[80:83], v[160:163]
  v_mfma_f32_16x16x32_bf16 v[160:163], v[40:43], v[84:87], v[160:163]
  v_mfma_f32_16x16x32_bf16 v[176:179], v[24:27], v[48:51], v[176:179]
  v_mfma_f32_16x16x32_bf16 v[176:179], v[40:43], v[52:55], v[176:179]
  v_mfma_f32_16x16x32_bf16 v[164:167], v[28:31], v[80:83], v[164:167]
  ds_read_b128 v[80:83], v5 offset:18432
  v_mfma_f32_16x16x32_bf16 v[164:167], v[44:47], v[84:87], v[164:167]
  ds_read_b128 v[84:87], v7 offset:18432
  v_mfma_f32_16x16x32_bf16 v[180:183], v[28:31], v[48:51], v[180:183]
  s_waitcnt lgkmcnt(6)
  v_mfma_f32_16x16x32_bf16 v[180:183], v[44:47], v[52:55], v[180:183]
  v_mfma_f32_16x16x32_bf16 v[184:187], v[16:19], v[56:59], v[184:187]
  s_waitcnt lgkmcnt(4)
  s_add_u32 s72, s72, 1
  s_cmp_lt_u32 s72, 8
  v_mfma_f32_16x16x32_bf16 v[184:187], v[32:35], v[60:63], v[184:187]
  v_mfma_f32_16x16x32_bf16 v[200:203], v[16:19], v[64:67], v[200:203]
  v_mfma_f32_16x16x32_bf16 v[200:203], v[32:35], v[68:71], v[200:203]
  v_mfma_f32_16x16x32_bf16 v[188:191], v[20:23], v[56:59], v[188:191]
  v_mfma_f32_16x16x32_bf16 v[188:191], v[36:39], v[60:63], v[188:191]
  s_waitcnt lgkmcnt(0)
  s_barrier
  v_mfma_f32_16x16x32_bf16 v[204:207], v[20:23], v[64:67], v[204:207]
  ds_read_b128 v[48:51], v5 offset:40960
  v_mfma_f32_16x16x32_bf16 v[204:207], v[36:39], v[68:71], v[204:207]
  ds_read_b128 v[52:55], v7 offset:40960
  v_mfma_f32_16x16x32_bf16 v[192:195], v[24:27], v[56:59], v[192:195]
  v_mfma_f32_16x16x32_bf16 v[192:195], v[40:43], v[60:63], v[192:195]
  v_mfma_f32_16x16x32_bf16 v[208:211], v[24:27], v[64:67], v[208:211]
  v_mfma_f32_16x16x32_bf16 v[208:211], v[40:43], v[68:71], v[208:211]
  v_mfma_f32_16x16x32_bf16 v[196:199], v[28:31], v[56:59], v[196:199]
  ds_read_b128 v[56:59], v5 offset:43008
  v_mfma_f32_16x16x32_bf16 v[196:199], v[44:47], v[60:63], v[196:199]
  ds_read_b128 v[60:63], v7 offset:43008
  v_mfma_f32_16x16x32_bf16 v[212:215], v[28:31], v[64:67], v[212:215]
  ds_read_b128 v[64:67], v5 offset:45056
  v_mfma_f32_16x16x32_bf16 v[212:215], v[44:47], v[68:71], v[212:215]
  ds_read_b128 v[68:71], v7 offset:45056
  v_mfma_f32_16x16x32_bf16 v[216:219], v[16:19], v[72:75], v[216:219]
  v_mfma_f32_16x16x32_bf16 v[216:219], v[32:35], v[76:79], v[216:219]
  v_mfma_f32_16x16x32_bf16 v[232:235], v[16:19], v[80:83], v[232:235]
  ds_read_b64_tr_b16 v[16:17], v1 offset:0
  v_mfma_f32_16x16x32_bf16 v[232:235], v[32:35], v[84:87], v[232:235]
  ds_read_b64_tr_b16 v[18:19], v1 offset:1024
  v_mfma_f32_16x16x32_bf16 v[220:223], v[20:23], v[72:75], v[220:223]
  ds_read_b64_tr_b16 v[32:33], v1 offset:8192
  v_mfma_f32_16x16x32_bf16 v[220:223], v[36:39], v[76:79], v[220:223]
  ds_read_b64_tr_b16 v[34:35], v1 offset:9216
  v_mfma_f32_16x16x32_bf16 v[236:239], v[20:23], v[80:83], v[236:239]
  ds_read_b64_tr_b16 v[20:21], v2 offset:0
  v_mfma_f32_16x16x32_bf16 v[236:239], v[36:39], v[84:87], v[236:239]
  ds_read_b64_tr_b16 v[22:23], v2 offset:1024
  v_mfma_f32_16x16x32_bf16 v[224:227], v[24:27], v[72:75], v[224:227]
  ds_read_b64_tr_b16 v[36:37], v2 offset:8192
  v_mfma_f32_16x16x32_bf16 v[224:227], v[40:43], v[76:79], v[224:227]
  ds_read_b64_tr_b16 v[38:39], v2 offset:9216
  v_mfma_f32_16x16x32_bf16 v[240:243], v[24:27], v[80:83], v[240:243]
  ds_read_b64_tr_b16 v[24:25], v3 offset:0
  v_mfma_f32_16x16x32_bf16 v[240:243], v[40:43], v[84:87], v[240:243]
  ds_read_b64_tr_b16 v[26:27], v3 offset:1024
  v_mfma_f32_16x16x32_bf16 v[228:231], v[28:31], v[72:75], v[228:231]
  ds_read_b64_tr_b16 v[40:41], v3 offset:8192
  v_mfma_f32_16x16x32_bf16 v[228:231], v[44:47], v[76:79], v[228:231]
  ds_read_b64_tr_b16 v[42:43], v3 offset:9216
  v_mfma_f32_16x16x32_bf16 v[244:247], v[28:31], v[80:83], v[244:247]
  ds_read_b64_tr_b16 v[28:29], v4 offset:0
  s_waitcnt lgkmcnt(9)
  v_mfma_f32_16x16x32_bf16 v[244:247], v[44:47], v[84:87], v[244:247]
  ds_read_b64_tr_b16 v[30:31], v4 offset:1024
  s_cbranch_scc1 L_dnn_loop0
L_tail:
  v_mfma_f32_16x16x32_bf16 v[88:91], v[16:19], v[48:51], v[88:91]
  ds_read_b64_tr_b16 v[44:45], v4 offset:8192
  v_mfma_f32_16x16x32_bf16 v[88:91], v[32:35], v[52:55], v[88:91]
  ds_read_b64_tr_b16 v[46:47], v4 offset:9216
  v_mfma_f32_16x16x32_bf16 v[104:107], v[16:19], v[56:59], v[104:107]
  ds_read_b128 v[72:75], v5 offset:47104
  s_waitcnt lgkmcnt(9)
  v_mfma_f32_16x16x32_bf16 v[104:107], v[32:35], v[60:63], v[104:107]
  ds_read_b128 v[76:79], v7 offset:47104
  v_mfma_f32_16x16x32_bf16 v[92:95], v[20:23], v[48:51], v[92:95]
  s_nop 0
  ds_read_b128 v[80:83], v5 offset:49152
  v_mfma_f32_16x16x32_bf16 v[92:95], v[36:39], v[52:55], v[92:95]
  ds_read_b128 v[84:87], v7 offset:49152
  v_mul_f32 v11, v88, v88
  v_mfma_f32_16x16x32_bf16 v[108:111], v[20:23], v[56:59], v[108:111]
  s_waitcnt lgkmcnt(8)
  v_mul_f32 v248, v89, v89
  v_mul_f32 v249, v90, v90
  v_mfma_f32_16x16x32_bf16 v[108:111], v[36:39], v[60:63], v[108:111]
  v_mul_f32_e64 v250, v91, v91
  v_fma_f32 v11, v11, v14, v12
  v_mfma_f32_16x16x32_bf16 v[96:99], v[24:27], v[48:51], v[96:99]
  v_fma_f32 v248, v248, v14, v12
  v_fma_f32 v249, v249, v14, v12
  v_mfma_f32_16x16x32_bf16 v[96:99], v[40:43], v[52:55], v[96:99]
  v_fma_f32 v250, v250, v14, v12
  v_mul_f32 v11, v11, v88
  v_mfma_f32_16x16x32_bf16 v[112:115], v[24:27], v[56:59], v[112:115]
  s_waitcnt lgkmcnt(4)
  v_mul_f32 v248, v248, v89
  v_mul_f32 v249, v249, v90
  v_mfma_f32_16x16x32_bf16 v[112:115], v[40:43], v[60:63], v[112:115]
  v_mul_f32_e64 v250, v250, v91
  v_mfma_f32_16x16x32_bf16 v[100:103], v[28:31], v[48:51], v[100:103]
  ds_read_b128 v[48:51], v5 offset:51200
  v_mfma_f32_16x16x32_bf16 v[100:103], v[44:47], v[52:55], v[100:103]
  ds_read_b128 v[52:55], v7 offset:51200
  v_mfma_f32_16x16x32_bf16 v[116:119], v[28:31], v[56:59], v[116:119]
  ds_read_b128 v[56:59], v5 offset:53248
  v_mfma_f32_16x16x32_bf16 v[116:119], v[44:47], v[60:63], v[116:119]
  ds_read_b128 v[60:63], v7 offset:53248
  v_mfma_f32_16x16x32_bf16 v[120:123], v[16:19], v[64:67], v[120:123]
  s_waitcnt lgkmcnt(6)
  v_exp_f32 v11, v11
  v_mfma_f32_16x16x32_bf16 v[120:123], v[32:35], v[68:71], v[120:123]
  v_exp_f32 v248, v248
  v_mfma_f32_16x16x32_bf16 v[136:139], v[16:19], v[72:75], v[136:139]
  v_exp_f32 v249, v249
  v_mfma_f32_16x16x32_bf16 v[136:139], v[32:35], v[76:79], v[136:139]
  v_exp_f32 v250, v250
  v_mfma_f32_16x16x32_bf16 v[124:127], v[20:23], v[64:67], v[124:127]
  v_add_f32 v11, 1.0, v11
  v_add_f32 v248, 1.0, v248
  v_mfma_f32_16x16x32_bf16 v[124:127], v[36:39], v[68:71], v[124:127]
  v_add_f32 v249, 1.0, v249
  v_add_f32 v250, 1.0, v250
  v_mfma_f32_16x16x32_bf16 v[140:143], v[20:23], v[72:75], v[140:143]
  v_rcp_f32 v11, v11
  v_mfma_f32_16x16x32_bf16 v[140:143], v[36:39], v[76:79], v[140:143]
  v_rcp_f32_e64 v248, v248
  v_mfma_f32_16x16x32_bf16 v[128:131], v[24:27], v[64:67], v[128:131]
  v_rcp_f32 v249, v249
  v_mfma_f32_16x16x32_bf16 v[128:131], v[40:43], v[68:71], v[128:131]
  v_rcp_f32 v250, v250
  v_mfma_f32_16x16x32_bf16 v[144:147], v[24:27], v[72:75], v[144:147]
  v_mul_f32 v88, v88, v11
  v_mul_f32 v89, v89, v248
  v_mfma_f32_16x16x32_bf16 v[144:147], v[40:43], v[76:79], v[144:147]
  v_mul_f32 v90, v90, v249
  v_mul_f32 v91, v91, v250
  v_mfma_f32_16x16x32_bf16 v[132:135], v[28:31], v[64:67], v[132:135]
  ds_read_b128 v[64:67], v5 offset:55296
  v_mul_f32 v11, v92, v92
  v_mfma_f32_16x16x32_bf16 v[132:135], v[44:47], v[68:71], v[132:135]
  ds_read_b128 v[68:71], v7 offset:55296
  v_mul_f32 v248, v93, v93
  v_mfma_f32_16x16x32_bf16 v[148:151], v[28:31], v[72:75], v[148:151]
  ds_read_b128 v[72:75], v5 offset:57344
  s_waitcnt lgkmcnt(7)
  v_mul_f32 v249, v94, v94
  v_mfma_f32_16x16x32_bf16 v[148:151], v[44:47], v[76:79], v[148:151]
  ds_read_b128 v[76:79], v7 offset:57344
  v_mul_f32 v250, v95, v95
  v_mfma_f32_16x16x32_bf16 v[152:155], v[16:19], v[80:83], v[152:155]
  s_waitcnt lgkmcnt(6)
  v_fma_f32 v11, v11, v14, v12
  v_fma_f32 v248, v248, v14, v12
  v_mfma_f32_16x16x32_bf16 v[152:155], v[32:35], v[84:87], v[152:155]
  v_fma_f32 v249, v249, v14, v12
  v_fma_f32 v250, v250, v14, v12
  v_mfma_f32_16x16x32_bf16 v[168:171], v[16:19], v[48:51], v[168:171]
  v_mul_f32 v11, v11, v92
  v_mul_f32 v248, v248, v93
  v_mfma_f32_16x16x32_bf16 v[168:171], v[32:35], v[52:55], v[168:171]
  v_mul_f32 v249, v249, v94
  v_mul_f32 v250, v250, v95
  v_mfma_f32_16x16x32_bf16 v[156:159], v[20:23], v[80:83], v[156:159]
  v_exp_f32 v11, v11
  v_mfma_f32_16x16x32_bf16 v[156:159], v[36:39], v[84:87], v[156:159]
  v_exp_f32 v248, v248
  v_mfma_f32_16x16x32_bf16 v[172:175], v[20:23], v[48:51], v[172:175]
  v_exp_f32 v249, v249
  v_mfma_f32_16x16x32_bf16 v[172:175], v[36:39], v[52:55], v[172:175]
  v_exp_f32 v250, v250
  v_mfma_f32_16x16x32_bf16 v[160:163], v[24:27], v[80:83], v[160:163]
  v_add_f32 v11, 1.0, v11
  v_add_f32 v248, 1.0, v248
  v_mfma_f32_16x16x32_bf16 v[160:163], v[40:43], v[84:87], v[160:163]
  v_add_f32 v249, 1.0, v249
  v_add_f32 v250, 1.0, v250
  v_mfma_f32_16x16x32_bf16 v[176:179], v[24:27], v[48:51], v[176:179]
  v_rcp_f32_e64 v11, v11
  v_mfma_f32_16x16x32_bf16 v[176:179], v[40:43], v[52:55], v[176:179]
  v_rcp_f32 v248, v248
  v_mfma_f32_16x16x32_bf16 v[164:167], v[28:31], v[80:83], v[164:167]
  ds_read_b128 v[80:83], v5 offset:59392
  v_mfma_f32_16x16x32_bf16 v[164:167], v[44:47], v[84:87], v[164:167]
  ds_read_b128 v[84:87], v7 offset:59392
  v_mfma_f32_16x16x32_bf16 v[180:183], v[28:31], v[48:51], v[180:183]
  s_waitcnt lgkmcnt(6)
  v_rcp_f32_e64 v249, v249
  v_mfma_f32_16x16x32_bf16 v[180:183], v[44:47], v[52:55], v[180:183]
  v_rcp_f32 v250, v250
  v_mfma_f32_16x16x32_bf16 v[184:187], v[16:19], v[56:59], v[184:187]
  s_waitcnt lgkmcnt(4)
  v_mul_f32 v92, v92, v11
  v_mul_f32 v93, v93, v248
  v_mfma_f32_16x16x32_bf16 v[184:187], v[32:35], v[60:63], v[184:187]
  v_mul_f32 v94, v94, v249
  v_mul_f32 v95, v95, v250
  v_mfma_f32_16x16x32_bf16 v[200:203], v[16:19], v[64:67], v[200:203]
  v_mul_f32 v11, v96, v96
  v_mul_f32 v248, v97, v97
  v_mfma_f32_16x16x32_bf16 v[200:203], v[32:35], v[68:71], v[200:203]
  v_mul_f32 v249, v98, v98
  v_mul_f32 v250, v99, v99
  v_mfma_f32_16x16x32_bf16 v[188:191], v[20:23], v[56:59], v[188:191]
  v_fma_f32 v11, v11, v14, v12
  v_fma_f32 v248, v248, v14, v12
  v_mfma_f32_16x16x32_bf16 v[188:191], v[36:39], v[60:63], v[188:191]
  v_fma_f32 v249, v249, v14, v12
  v_fma_f32 v250, v250, v14, v12
  v_mfma_f32_16x16x32_bf16 v[204:207], v[20:23], v[64:67], v[204:207]
  v_mul_f32 v11, v11, v96
  v_mul_f32 v248, v248, v97
  v_mfma_f32_16x16x32_bf16 v[204:207], v[36:39], v[68:71], v[204:207]
  v_mul_f32 v249, v249, v98
  v_mul_f32 v250, v250, v99
  v_mfma_f32_16x16x32_bf16 v[192:195], v[24:27], v[56:59], v[192:195]
  v_exp_f32 v11, v11
  v_mfma_f32_16x16x32_bf16 v[192:195], v[40:43], v[60:63], v[192:195]
  v_exp_f32 v248, v248
  v_mfma_f32_16x16x32_bf16 v[208:211], v[24:27], v[64:67], v[208:211]
  v_exp_f32 v249, v249
  v_mfma_f32_16x16x32_bf16 v[208:211], v[40:43], v[68:71], v[208:211]
  v_exp_f32 v250, v250
  v_mfma_f32_16x16x32_bf16 v[196:199], v[28:31], v[56:59], v[196:199]
  v_add_f32 v11, 1.0, v11
  v_add_f32 v248, 1.0, v248
  v_mfma_f32_16x16x32_bf16 v[196:199], v[44:47], v[60:63], v[196:199]
  v_add_f32 v249, 1.0, v249
  v_add_f32 v250, 1.0, v250
  v_mfma_f32_16x16x32_bf16 v[212:215], v[28:31], v[64:67], v[212:215]
  s_waitcnt lgkmcnt(2)
  v_rcp_f32 v11, v11
  v_mfma_f32_16x16x32_bf16 v[212:215], v[44:47], v[68:71], v[212:215]
  v_rcp_f32 v248, v248
  v_mfma_f32_16x16x32_bf16 v[216:219], v[16:19], v[72:75], v[216:219]
  s_waitcnt lgkmcnt(0)
  v_rcp_f32 v249, v249
  v_mfma_f32_16x16x32_bf16 v[216:219], v[32:35], v[76:79], v[216:219]
  v_rcp_f32 v250, v250
  v_mfma_f32_16x16x32_bf16 v[232:235], v[16:19], v[80:83], v[232:235]
  v_mul_f32 v96, v96, v11
  v_mul_f32 v97, v97, v248
  v_mfma_f32_16x16x32_bf16 v[232:235], v[32:35], v[84:87], v[232:235]
  v_mul_f32 v98, v98, v249
  v_mul_f32 v99, v99, v250
  v_mfma_f32_16x16x32_bf16 v[220:223], v[20:23], v[72:75], v[220:223]
  v_mul_f32 v11, v100, v100
  v_mul_f32 v248, v101, v101
  v_mfma_f32_16x16x32_bf16 v[220:223], v[36:39], v[76:79], v[220:223]
  v_mul_f32 v249, v102, v102
  v_mul_f32 v250, v103, v103
  v_mfma_f32_16x16x32_bf16 v[236:239], v[20:23], v[80:83], v[236:239]
  v_fma_f32 v11, v11, v14, v12
  v_fma_f32 v248, v248, v14, v12
  v_mfma_f32_16x16x32_bf16 v[236:239], v[36:39], v[84:87], v[236:239]
  v_fma_f32 v249, v249, v14, v12
  v_fma_f32 v250, v250, v14, v12
  v_mfma_f32_16x16x32_bf16 v[224:227], v[24:27], v[72:75], v[224:227]
  v_mul_f32 v11, v11, v100
  v_mul_f32 v248, v248, v101
  v_mfma_f32_16x16x32_bf16 v[224:227], v[40:43], v[76:79], v[224:227]
  v_mul_f32 v249, v249, v102
  v_mul_f32 v250, v250, v103
  v_mfma_f32_16x16x32_bf16 v[240:243], v[24:27], v[80:83], v[240:243]
  v_exp_f32 v11, v11
  v_mfma_f32_16x16x32_bf16 v[240:243], v[40:43], v[84:87], v[240:243]
  v_exp_f32 v248, v248
  v_mfma_f32_16x16x32_bf16 v[228:231], v[28:31], v[72:75], v[228:231]
  v_exp_f32 v249, v249
  v_mfma_f32_16x16x32_bf16 v[228:231], v[44:47], v[76:79], v[228:231]
  v_exp_f32 v250, v250
  v_mfma_f32_16x16x32_bf16 v[244:247], v[28:31], v[80:83], v[244:247]
  v_add_f32 v11, 1.0, v11
  v_add_f32 v248, 1.0, v248
  v_mfma_f32_16x16x32_bf16 v[244:247], v[44:47], v[84:87], v[244:247]
  v_add_f32 v249, 1.0, v249
  v_add_f32 v250, 1.0, v250
  v_rcp_f32 v11, v11
  v_rcp_f32 v248, v248
  v_rcp_f32 v249, v249
  v_rcp_f32 v250, v250
  v_mul_f32 v100, v100, v11
  v_mul_f32 v101, v101, v248
  v_mul_f32 v102, v102, v249
  v_mul_f32 v103, v103, v250
  ds_read_b64 v[18:19], v9 offset:256
  ds_read_b64 v[22:23], v9 offset:288
  ds_read_b64 v[26:27], v9 offset:320
  ds_read_b64 v[30:31], v9 offset:352
  v_mov_b32 v248, 1.0
  v_mov_b32 v249, 1.0
L_epi:
  v_pk_mul_f32 v[52:53], v[104:105], v[104:105]
  v_pk_mul_f32 v[56:57], v[106:107], v[106:107]
  v_pk_mul_f32 v[60:61], v[108:109], v[108:109]
  v_pk_mul_f32 v[64:65], v[110:111], v[110:111]
  v_pk_fma_f32 v[52:53], v[52:53], v[14:15], v[12:13]
  v_pk_fma_f32 v[56:57], v[56:57], v[14:15], v[12:13]
  v_pk_fma_f32 v[60:61], v[60:61], v[14:15], v[12:13]
  v_pk_fma_f32 v[64:65], v[64:65], v[14:15], v[12:13]
  v_pk_mul_f32 v[52:53], v[52:53], v[104:105]
  v_pk_mul_f32 v[56:57], v[56:57], v[106:107]
  v_pk_mul_f32 v[60:61], v[60:61], v[108:109]
  v_pk_mul_f32 v[64:65], v[64:65], v[110:111]
  v_exp_f32 v52, v52
  v_exp_f32 v53, v53
  v_exp_f32 v56, v56
  v_exp_f32 v57, v57
  v_exp_f32 v60, v60
  v_exp_f32 v61, v61
  v_exp_f32 v64, v64
  v_exp_f32 v65, v65
  s_waitcnt lgkmcnt(3)
  v_lshlrev_b32 v16, 16, v18
  v_and_b32 v17, 0xffff0000, v18
  v_lshlrev_b32 v18, 16, v19
  v_and_b32 v19, 0xffff0000, v19
  s_waitcnt lgkmcnt(2)
  v_lshlrev_b32 v20, 16, v22
  v_and_b32 v21, 0xffff0000, v22
  v_lshlrev_b32 v22, 16, v23
  v_and_b32 v23, 0xffff0000, v23
  s_waitcnt lgkmcnt(1)
  v_lshlrev_b32 v24, 16, v26
  v_and_b32 v25, 0xffff0000, v26
  v_lshlrev_b32 v26, 16, v27
  v_and_b32 v27, 0xffff0000, v27
  s_waitcnt lgkmcnt(0)
  v_lshlrev_b32 v28, 16, v30
  v_and_b32 v29, 0xffff0000, v30
  v_lshlrev_b32 v30, 16, v31
  v_and_b32 v31, 0xffff0000, v31
  v_pk_mul_f32 v[54:55], v[104:105], v[16:17]
  v_pk_mul_f32 v[58:59], v[106:107], v[18:19]
  v_pk_mul_f32 v[62:63], v[108:109], v[20:21]
  v_pk_mul_f32 v[66:67], v[110:111], v[22:23]
  v_pk_add_f32 v[52:53], v[52:53], v[248:249]
  v_pk_add_f32 v[56:57], v[56:57], v[248:249]
  v_pk_add_f32 v[60:61], v[60:61], v[248:249]
  v_pk_add_f32 v[64:65], v[64:65], v[248:249]
  v_rcp_f32 v52, v52
  v_rcp_f32 v53, v53
  v_rcp_f32 v56, v56
  v_rcp_f32 v57, v57
  v_rcp_f32 v60, v60
  v_rcp_f32 v61, v61
  v_rcp_f32 v64, v64
  v_rcp_f32 v65, v65
  v_pk_mul_f32 v[34:35], v[52:53], v[54:55]
  v_pk_fma_f32 v[34:35], v[56:57], v[58:59], v[34:35]
  v_pk_fma_f32 v[34:35], v[60:61], v[62:63], v[34:35]
  v_pk_fma_f32 v[34:35], v[64:65], v[66:67], v[34:35]
  v_pk_mul_f32 v[68:69], v[112:113], v[112:113]
  v_pk_mul_f32 v[72:73], v[114:115], v[114:115]
  v_pk_mul_f32 v[76:77], v[116:117], v[116:117]
  v_pk_mul_f32 v[80:81], v[118:119], v[118:119]
  v_pk_fma_f32 v[68:69], v[68:69], v[14:15], v[12:13]
  v_pk_fma_f32 v[72:73], v[72:73], v[14:15], v[12:13]
  v_pk_fma_f32 v[76:77], v[76:77], v[14:15], v[12:13]
  v_pk_fma_f32 v[80:81], v[80:81], v[14:15], v[12:13]
  v_pk_mul_f32 v[68:69], v[68:69], v[112:113]
  v_pk_mul_f32 v[72:73], v[72:73], v[114:115]
  v_pk_mul_f32 v[76:77], v[76:77], v[116:117]
  v_pk_mul_f32 v[80:81], v[80:81], v[118:119]
  v_exp_f32 v68, v68
  v_exp_f32 v69, v69
  v_exp_f32 v72, v72
  v_exp_f32 v73, v73
  v_exp_f32 v76, v76
  v_exp_f32 v77, v77
  v_exp_f32 v80, v80
  v_exp_f32 v81, v81
  v_pk_mul_f32 v[70:71], v[112:113], v[24:25]
  v_pk_mul_f32 v[74:75], v[114:115], v[26:27]
  v_pk_mul_f32 v[78:79], v[116:117], v[28:29]
  v_pk_mul_f32 v[82:83], v[118:119], v[30:31]
  v_pk_add_f32 v[68:69], v[68:69], v[248:249]
  v_pk_add_f32 v[72:73], v[72:73], v[248:249]
  v_pk_add_f32 v[76:77], v[76:77], v[248:249]
  v_pk_add_f32 v[80:81], v[80:81], v[248:249]
  v_rcp_f32 v68, v68
  v_rcp_f32 v69, v69
  v_rcp_f32 v72, v72
  v_rcp_f32 v73, v73
  v_rcp_f32 v76, v76
  v_rcp_f32 v77, v77
  v_rcp_f32 v80, v80
  v_rcp_f32 v81, v81
  v_pk_fma_f32 v[34:35], v[68:69], v[70:71], v[34:35]
  v_pk_fma_f32 v[34:35], v[72:73], v[74:75], v[34:35]
  v_pk_fma_f32 v[34:35], v[76:77], v[78:79], v[34:35]
  v_pk_fma_f32 v[34:35], v[80:81], v[82:83], v[34:35]
  v_pk_mul_f32 v[52:53], v[120:121], v[120:121]
  v_pk_mul_f32 v[56:57], v[136:137], v[136:137]
  v_pk_mul_f32 v[60:61], v[122:123], v[122:123]
  v_pk_mul_f32 v[64:65], v[138:139], v[138:139]
  v_pk_fma_f32 v[52:53], v[52:53], v[14:15], v[12:13]
  v_pk_fma_f32 v[56:57], v[56:57], v[14:15], v[12:13]
  v_pk_fma_f32 v[60:61], v[60:61], v[14:15], v[12:13]
  v_pk_fma_f32 v[64:65], v[64:65], v[14:15], v[12:13]
  v_pk_mul_f32 v[52:53], v[52:53], v[120:121]
  v_pk_mul_f32 v[56:57], v[56:57], v[136:137]
  v_pk_mul_f32 v[60:61], v[60:61], v[122:123]
  v_pk_mul_f32 v[64:65], v[64:65], v[138:139]
  v_exp_f32 v52, v52
  v_exp_f32 v53, v53
  v_exp_f32 v56, v56
  v_exp_f32 v57, v57
  v_exp_f32 v60, v60
  v_exp_f32 v61, v61
  v_exp_f32 v64, v64
  v_exp_f32 v65, v65
  v_pk_mul_f32 v[54:55], v[120:121], v[16:17]
  v_pk_mul_f32 v[58:59], v[136:137], v[16:17]
  v_pk_mul_f32 v[62:63], v[122:123], v[18:19]
  v_pk_mul_f32 v[66:67], v[138:139], v[18:19]
  v_pk_add_f32 v[52:53], v[52:53], v[248:249]
  v_pk_add_f32 v[56:57], v[56:57], v[248:249]
  v_pk_add_f32 v[60:61], v[60:61], v[248:249]
  v_pk_add_f32 v[64:65], v[64:65], v[248:249]
  v_rcp_f32 v52, v52
  v_rcp_f32 v53, v53
  v_rcp_f32 v56, v56
  v_rcp_f32 v57, v57
  v_rcp_f32 v60, v60
  v_rcp_f32 v61, v61
  v_rcp_f32 v64, v64
  v_rcp_f32 v65, v65
  v_pk_mul_f32 v[36:37], v[52:53], v[54:55]
  v_pk_mul_f32 v[38:39], v[56:57], v[58:59]
  v_pk_fma_f32 v[36:37], v[60:61], v[62:63], v[36:37]
  v_pk_fma_f32 v[38:39], v[64:65], v[66:67], v[38:39]
  v_pk_mul_f32 v[68:69], v[124:125], v[124:125]
  v_pk_mul_f32 v[72:73], v[140:141], v[140:141]
  v_pk_mul_f32 v[76:77], v[126:127], v[126:127]
  v_pk_mul_f32 v[80:81], v[142:143], v[142:143]
  v_pk_fma_f32 v[68:69], v[68:69], v[14:15], v[12:13]
  v_pk_fma_f32 v[72:73], v[72:73], v[14:15], v[12:13]
  v_pk_fma_f32 v[76:77], v[76:77], v[14:15], v[12:13]
  v_pk_fma_f32 v[80:81], v[80:81], v[14:15], v[12:13]
  v_pk_mul_f32 v[68:69], v[68:69], v[124:125]
  v_pk_mul_f32 v[72:73], v[72:73], v[140:141]
  v_pk_mul_f32 v[76:77], v[76:77], v[126:127]
  v_pk_mul_f32 v[80:81], v[80:81], v[142:143]
  v_exp_f32 v68, v68
  v_exp_f32 v69, v69
  v_exp_f32 v72, v72
  v_exp_f32 v73, v73
  v_exp_f32 v76, v76
  v_exp_f32 v77, v77
  v_exp_f32 v80, v80
  v_exp_f32 v81, v81
  v_pk_mul_f32 v[70:71], v[124:125], v[20:21]
  v_pk_mul_f32 v[74:75], v[140:141], v[20:21]
  v_pk_mul_f32 v[78:79], v[126:127], v[22:23]
  v_pk_mul_f32 v[82:83], v[142:143], v[22:23]
  v_pk_add_f32 v[68:69], v[68:69], v[248:249]
  v_pk_add_f32 v[72:73], v[72:73], v[248:249]
  v_pk_add_f32 v[76:77], v[76:77], v[248:249]
  v_pk_add_f32 v[80:81], v[80:81], v[248:249]
  v_rcp_f32 v68, v68
  v_rcp_f32 v69, v69
  v_rcp_f32 v72, v72
  v_rcp_f32 v73, v73
  v_rcp_f32 v76, v76
  v_rcp_f32 v77, v77
  v_rcp_f32 v80, v80
  v_rcp_f32 v81, v81
  v_pk_fma_f32 v[36:37], v[68:69], v[70:71], v[36:37]
  v_pk_fma_f32 v[38:39], v[72:73], v[74:75], v[38:39]
  v_pk_fma_f32 v[36:37], v[76:77], v[78:79], v[36:37]
  v_pk_fma_f32 v[38:39], v[80:81], v[82:83], v[38:39]
  v_pk_mul_f32 v[52:53], v[128:129], v[128:129]
  v_pk_mul_f32 v[56:57], v[144:145], v[144:145]
  v_pk_mul_f32 v[60:61], v[130:131], v[130:131]
  v_pk_mul_f32 v[64:65], v[146:147], v[146:147]
  v_pk_fma_f32 v[52:53], v[52:53], v[14:15], v[12:13]
  v_pk_fma_f32 v[56:57], v[56:57], v[14:15], v[12:13]
  v_pk_fma_f32 v[60:61], v[60:61], v[14:15], v[12:13]
  v_pk_fma_f32 v[64:65], v[64:65], v[14:15], v[12:13]
  v_pk_mul_f32 v[52:53], v[52:53], v[128:129]
  v_pk_mul_f32 v[56:57], v[56:57], v[144:145]
  v_pk_mul_f32 v[60:61], v[60:61], v[130:131]
  v_pk_mul_f32 v[64:65], v[64:65], v[146:147]
  v_exp_f32 v52, v52
  v_exp_f32 v53, v53
  v_exp_f32 v56, v56
  v_exp_f32 v57, v57
  v_exp_f32 v60, v60
  v_exp_f32 v61, v61
  v_exp_f32 v64, v64
  v_exp_f32 v65, v65
  v_pk_mul_f32 v[54:55], v[128:129], v[24:25]
  v_pk_mul_f32 v[58:59], v[144:145], v[24:25]
  v_pk_mul_f32 v[62:63], v[130:131], v[26:27]
  v_pk_mul_f32 v[66:67], v[146:147], v[26:27]
  v_pk_add_f32 v[52:53], v[52:53], v[248:249]
  v_pk_add_f32 v[56:57], v[56:57], v[248:249]
  v_pk_add_f32 v[60:61], v[60:61], v[248:249]
  v_pk_add_f32 v[64:65], v[64:65], v[248:249]
  v_rcp_f32 v52, v52
  v_rcp_f32 v53, v53
  v_rcp_f32 v56, v56
  v_rcp_f32 v57, v57
  v_rcp_f32 v60, v60
  v_rcp_f32 v61, v61
  v_rcp_f32 v64, v64
  v_rcp_f32 v65, v65
  v_pk_fma_f32 v[36:37], v[52:53], v[54:55], v[36:37]
  v_pk_fma_f32 v[38:39], v[56:57], v[58:59], v[38:39]
  v_pk_fma_f32 v[36:37], v[60:61], v[62:63], v[36:37]
  v_pk_fma_f32 v[38:39], v[64:65], v[66:67], v[38:39]
  v_pk_mul_f32 v[68:69], v[132:133], v[132:133]
  v_pk_mul_f32 v[72:73], v[148:149], v[148:149]
  v_pk_mul_f32 v[76:77], v[134:135], v[134:135]
  v_pk_mul_f32 v[80:81], v[150:151], v[150:151]
  v_pk_fma_f32 v[68:69], v[68:69], v[14:15], v[12:13]
  v_pk_fma_f32 v[72:73], v[72:73], v[14:15], v[12:13]
  v_pk_fma_f32 v[76:77], v[76:77], v[14:15], v[12:13]
  v_pk_fma_f32 v[80:81], v[80:81], v[14:15], v[12:13]
  v_pk_mul_f32 v[68:69], v[68:69], v[132:133]
  v_pk_mul_f32 v[72:73], v[72:73], v[148:149]
  v_pk_mul_f32 v[76:77], v[76:77], v[134:135]
  v_pk_mul_f32 v[80:81], v[80:81], v[150:151]
  v_exp_f32 v68, v68
  v_exp_f32 v69, v69
  v_exp_f32 v72, v72
  v_exp_f32 v73, v73
  v_exp_f32 v76, v76
  v_exp_f32 v77, v77
  v_exp_f32 v80, v80
  v_exp_f32 v81, v81
  v_pk_mul_f32 v[70:71], v[132:133], v[28:29]
  v_pk_mul_f32 v[74:75], v[148:149], v[28:29]
  v_pk_mul_f32 v[78:79], v[134:135], v[30:31]
  v_pk_mul_f32 v[82:83], v[150:151], v[30:31]
  v_pk_add_f32 v[68:69], v[68:69], v[248:249]
  v_pk_add_f32 v[72:73], v[72:73], v[248:249]
  v_pk_add_f32 v[76:77], v[76:77], v[248:249]
  v_pk_add_f32 v[80:81], v[80:81], v[248:249]
  v_rcp_f32 v68, v68
  v_rcp_f32 v69, v69
  v_rcp_f32 v72, v72
  v_rcp_f32 v73, v73
  v_rcp_f32 v76, v76
  v_rcp_f32 v77, v77
  v_rcp_f32 v80, v80
  v_rcp_f32 v81, v81
  v_pk_fma_f32 v[36:37], v[68:69], v[70:71], v[36:37]
  v_pk_fma_f32 v[38:39], v[72:73], v[74:75], v[38:39]
  v_pk_fma_f32 v[36:37], v[76:77], v[78:79], v[36:37]
  v_pk_fma_f32 v[38:39], v[80:81], v[82:83], v[38:39]
  v_pk_mul_f32 v[52:53], v[152:153], v[152:153]
  v_pk_mul_f32 v[56:57], v[168:169], v[168:169]
  v_pk_mul_f32 v[60:61], v[154:155], v[154:155]
  v_pk_mul_f32 v[64:65], v[170:171], v[170:171]
  v_pk_fma_f32 v[52:53], v[52:53], v[14:15], v[12:13]
  v_pk_fma_f32 v[56:57], v[56:57], v[14:15], v[12:13]
  v_pk_fma_f32 v[60:61], v[60:61], v[14:15], v[12:13]
  v_pk_fma_f32 v[64:65], v[64:65], v[14:15], v[12:13]
  v_pk_mul_f32 v[52:53], v[52:53], v[152:153]
  v_pk_mul_f32 v[56:57], v[56:57], v[168:169]
  v_pk_mul_f32 v[60:61], v[60:61], v[154:155]
  v_pk_mul_f32 v[64:65], v[64:65], v[170:171]
  v_exp_f32 v52, v52
  v_exp_f32 v53, v53
  v_exp_f32 v56, v56
  v_exp_f32 v57, v57
  v_exp_f32 v60, v60
  v_exp_f32 v61, v61
  v_exp_f32 v64, v64
  v_exp_f32 v65, v65
  v_pk_mul_f32 v[54:55], v[152:153], v[16:17]
  v_pk_mul_f32 v[58:59], v[168:169], v[16:17]
  v_pk_mul_f32 v[62:63], v[154:155], v[18:19]
  v_pk_mul_f32 v[66:67], v[170:171], v[18:19]
  v_pk_add_f32 v[52:53], v[52:53], v[248:249]
  v_pk_add_f32 v[56:57], v[56:57], v[248:249]
  v_pk_add_f32 v[60:61], v[60:61], v[248:249]
  v_pk_add_f32 v[64:65], v[64:65], v[248:249]
  v_rcp_f32 v52, v52
  v_rcp_f32 v53, v53
  v_rcp_f32 v56, v56
  v_rcp_f32 v57, v57
  v_rcp_f32 v60, v60
  v_rcp_f32 v61, v61
  v_rcp_f32 v64, v64
  v_rcp_f32 v65, v65
  v_pk_mul_f32 v[40:41], v[52:53], v[54:55]
  v_pk_mul_f32 v[42:43], v[56:57], v[58:59]
  v_pk_fma_f32 v[40:41], v[60:61], v[62:63], v[40:41]
  v_pk_fma_f32 v[42:43], v[64:65], v[66:67], v[42:43]
  v_pk_mul_f32 v[68:69], v[156:157], v[156:157]
  v_pk_mul_f32 v[72:73], v[172:173], v[172:173]
  v_pk_mul_f32 v[76:77], v[158:159], v[158:159]
  v_pk_mul_f32 v[80:81], v[174:175], v[174:175]
  v_pk_fma_f32 v[68:69], v[68:69], v[14:15], v[12:13]
  v_pk_fma_f32 v[72:73], v[72:73], v[14:15], v[12:13]
  v_pk_fma_f32 v[76:77], v[76:77], v[14:15], v[12:13]
  v_pk_fma_f32 v[80:81], v[80:81], v[14:15], v[12:13]
  v_pk_mul_f32 v[68:69], v[68:69], v[156:157]
  v_pk_mul_f32 v[72:73], v[72:73], v[172:173]
  v_pk_mul_f32 v[76:77], v[76:77], v[158:159]
  v_pk_mul_f32 v[80:81], v[80:81], v[174:175]
  v_exp_f32 v68, v68
  v_exp_f32 v69, v69
  v_exp_f32 v72, v72
  v_exp_f32 v73, v73
  v_exp_f32 v76, v76
  v_exp_f32 v77, v77
  v_exp_f32 v80, v80
  v_exp_f32 v81, v81
  v_pk_mul_f32 v[70:71], v[156:157], v[20:21]
  v_pk_mul_f32 v[74:75], v[172:173], v[20:21]
  v_pk_mul_f32 v[78:79], v[158:159], v[22:23]
  v_pk_mul_f32 v[82:83], v[174:175], v[22:23]
  v_pk_add_f32 v[68:69], v[68:69], v[248:249]
  v_pk_add_f32 v[72:73], v[72:73], v[248:249]
  v_pk_add_f32 v[76:77], v[76:77], v[248:249]
  v_pk_add_f32 v[80:81], v[80:81], v[248:249]
  v_rcp_f32 v68, v68
  v_rcp_f32 v69, v69
  v_rcp_f32 v72, v72
  v_rcp_f32 v73, v73
  v_rcp_f32 v76, v76
  v_rcp_f32 v77, v77
  v_rcp_f32 v80, v80
  v_rcp_f32 v81, v81
  v_pk_fma_f32 v[40:41], v[68:69], v[70:71], v[40:41]
  v_pk_fma_f32 v[42:43], v[72:73], v[74:75], v[42:43]
  v_pk_fma_f32 v[40:41], v[76:77], v[78:79], v[40:41]
  v_pk_fma_f32 v[42:43], v[80:81], v[82:83], v[42:43]
  v_pk_mul_f32 v[52:53], v[160:161], v[160:161]
  v_pk_mul_f32 v[56:57], v[176:177], v[176:177]
  v_pk_mul_f32 v[60:61], v[162:163], v[162:163]
  v_pk_mul_f32 v[64:65], v[178:179], v[178:179]
  v_pk_fma_f32 v[52:53], v[52:53], v[14:15], v[12:13]
  v_pk_fma_f32 v[56:57], v[56:57], v[14:15], v[12:13]
  v_pk_fma_f32 v[60:61], v[60:61], v[14:15], v[12:13]
  v_pk_fma_f32 v[64:65], v[64:65], v[14:15], v[12:13]
  v_pk_mul_f32 v[52:53], v[52:53], v[160:161]
  v_pk_mul_f32 v[56:57], v[56:57], v[176:177]
  v_pk_mul_f32 v[60:61], v[60:61], v[162:163]
  v_pk_mul_f32 v[64:65], v[64:65], v[178:179]
  v_exp_f32 v52, v52
  v_exp_f32 v53, v53
  v_exp_f32 v56, v56
  v_exp_f32 v57, v57
  v_exp_f32 v60, v60
  v_exp_f32 v61, v61
  v_exp_f32 v64, v64
  v_exp_f32 v65, v65
  v_pk_mul_f32 v[54:55], v[160:161], v[24:25]
  v_pk_mul_f32 v[58:59], v[176:177], v[24:25]
  v_pk_mul_f32 v[62:63], v[162:163], v[26:27]
  v_pk_mul_f32 v[66:67], v[178:179], v[26:27]
  v_pk_add_f32 v[52:53], v[52:53], v[248:249]
  v_pk_add_f32 v[56:57], v[56:57], v[248:249]
  v_pk_add_f32 v[60:61], v[60:61], v[248:249]
  v_pk_add_f32 v[64:65], v[64:65], v[248:249]
  v_rcp_f32 v52, v52
  v_rcp_f32 v53, v53
  v_rcp_f32 v56, v56
  v_rcp_f32 v57, v57
  v_rcp_f32 v60, v60
  v_rcp_f32 v61, v61
  v_rcp_f32 v64, v64
  v_rcp_f32 v65, v65
  v_pk_fma_f32 v[40:41], v[52:53], v[54:55], v[40:41]
  v_pk_fma_f32 v[42:43], v[56:57], v[58:59], v[42:43]
  v_pk_fma_f32 v[40:41], v[60:61], v[62:63], v[40:41]
  v_pk_fma_f32 v[42:43], v[64:65], v[66:67], v[42:43]
  v_pk_mul_f32 v[68:69], v[164:165], v[164:165]
  v_pk_mul_f32 v[72:73], v[180:181], v[180:181]
  v_pk_mul_f32 v[76:77], v[166:167], v[166:167]
  v_pk_mul_f32 v[80:81], v[182:183], v[182:183]
  v_pk_fma_f32 v[68:69], v[68:69], v[14:15], v[12:13]
  v_pk_fma_f32 v[72:73], v[72:73], v[14:15], v[12:13]
  v_pk_fma_f32 v[76:77], v[76:77], v[14:15], v[12:13]
  v_pk_fma_f32 v[80:81], v[80:81], v[14:15], v[12:13]
  v_pk_mul_f32 v[68:69], v[68:69], v[164:165]
  v_pk_mul_f32 v[72:73], v[72:73], v[180:181]
  v_pk_mul_f32 v[76:77], v[76:77], v[166:167]
  v_pk_mul_f32 v[80:81], v[80:81], v[182:183]
  v_exp_f32 v68, v68
  v_exp_f32 v69, v69
  v_exp_f32 v72, v72
  v_exp_f32 v73, v73
  v_exp_f32 v76, v76
  v_exp_f32 v77, v77
  v_exp_f32 v80, v80
  v_exp_f32 v81, v81
  v_pk_mul_f32 v[70:71], v[164:165], v[28:29]
  v_pk_mul_f32 v[74:75], v[180:181], v[28:29]
  v_pk_mul_f32 v[78:79], v[166:167], v[30:31]
  v_pk_mul_f32 v[82:83], v[182:183], v[30:31]
  v_pk_add_f32 v[68:69], v[68:69], v[248:249]
  v_pk_add_f32 v[72:73], v[72:73], v[248:249]
  v_pk_add_f32 v[76:77], v[76:77], v[248:249]
  v_pk_add_f32 v[80:81], v[80:81], v[248:249]
  v_rcp_f32 v68, v68
  v_rcp_f32 v69, v69
  v_rcp_f32 v72, v72
  v_rcp_f32 v73, v73
  v_rcp_f32 v76, v76
  v_rcp_f32 v77, v77
  v_rcp_f32 v80, v80
  v_rcp_f32 v81, v81
  v_pk_fma_f32 v[40:41], v[68:69], v[70:71], v[40:41]
  v_pk_fma_f32 v[42:43], v[72:73], v[74:75], v[42:43]
  v_pk_fma_f32 v[40:41], v[76:77], v[78:79], v[40:41]
  v_pk_fma_f32 v[42:43], v[80:81], v[82:83], v[42:43]
  v_pk_mul_f32 v[52:53], v[184:185], v[184:185]
  v_pk_mul_f32 v[56:57], v[200:201], v[200:201]
  v_pk_mul_f32 v[60:61], v[186:187], v[186:187]
  v_pk_mul_f32 v[64:65], v[202:203], v[202:203]
  v_pk_fma_f32 v[52:53], v[52:53], v[14:15], v[12:13]
  v_pk_fma_f32 v[56:57], v[56:57], v[14:15], v[12:13]
  v_pk_fma_f32 v[60:61], v[60:61], v[14:15], v[12:13]
  v_pk_fma_f32 v[64:65], v[64:65], v[14:15], v[12:13]
  v_pk_mul_f32 v[52:53], v[52:53], v[184:185]
  v_pk_mul_f32 v[56:57], v[56:57], v[200:201]
  v_pk_mul_f32 v[60:61], v[60:61], v[186:187]
  v_pk_mul_f32 v[64:65], v[64:65], v[202:203]
  v_exp_f32 v52, v52
  v_exp_f32 v53, v53
  v_exp_f32 v56, v56
  v_exp_f32 v57, v57
  v_exp_f32 v60, v60
  v_exp_f32 v61, v61
  v_exp_f32 v64, v64
  v_exp_f32 v65, v65
  v_pk_mul_f32 v[54:55], v[184:185], v[16:17]
  v_pk_mul_f32 v[58:59], v[200:201], v[16:17]
  v_pk_mul_f32 v[62:63], v[186:187], v[18:19]
  v_pk_mul_f32 v[66:67], v[202:203], v[18:19]
  v_pk_add_f32 v[52:53], v[52:53], v[248:249]
  v_pk_add_f32 v[56:57], v[56:57], v[248:249]
  v_pk_add_f32 v[60:61], v[60:61], v[248:249]
  v_pk_add_f32 v[64:65], v[64:65], v[248:249]
  v_rcp_f32 v52, v52
  v_rcp_f32 v53, v53
  v_rcp_f32 v56, v56
  v_rcp_f32 v57, v57
  v_rcp_f32 v60, v60
  v_rcp_f32 v61, v61
  v_rcp_f32 v64, v64
  v_rcp_f32 v65, v65
  v_pk_mul_f32 v[44:45], v[52:53], v[54:55]
  v_pk_mul_f32 v[46:47], v[56:57], v[58:59]
  v_pk_fma_f32 v[44:45], v[60:61], v[62:63], v[44:45]
  v_pk_fma_f32 v[46:47], v[64:65], v[66:67], v[46:47]
  v_pk_mul_f32 v[68:69], v[188:189], v[188:189]
  v_pk_mul_f32 v[72:73], v[204:205], v[204:205]
  v_pk_mul_f32 v[76:77], v[190:191], v[190:191]
  v_pk_mul_f32 v[80:81], v[206:207], v[206:207]
  v_pk_fma_f32 v[68:69], v[68:69], v[14:15], v[12:13]
  v_pk_fma_f32 v[72:73], v[72:73], v[14:15], v[12:13]
  v_pk_fma_f32 v[76:77], v[76:77], v[14:15], v[12:13]
  v_pk_fma_f32 v[80:81], v[80:81], v[14:15], v[12:13]
  v_pk_mul_f32 v[68:69], v[68:69], v[188:189]
  v_pk_mul_f32 v[72:73], v[72:73], v[204:205]
  v_pk_mul_f32 v[76:77], v[76:77], v[190:191]
  v_pk_mul_f32 v[80:81], v[80:81], v[206:207]
  v_exp_f32 v68, v68
  v_exp_f32 v69, v69
  v_exp_f32 v72, v72
  v_exp_f32 v73, v73
  v_exp_f32 v76, v76
  v_exp_f32 v77, v77
  v_exp_f32 v80, v80
  v_exp_f32 v81, v81
  v_pk_mul_f32 v[70:71], v[188:189], v[20:21]
  v_pk_mul_f32 v[74:75], v[204:205], v[20:21]
  v_pk_mul_f32 v[78:79], v[190:191], v[22:23]
  v_pk_mul_f32 v[82:83], v[206:207], v[22:23]
  v_pk_add_f32 v[68:69], v[68:69], v[248:249]
  v_pk_add_f32 v[72:73], v[72:73], v[248:249]
  v_pk_add_f32 v[76:77], v[76:77], v[248:249]
  v_pk_add_f32 v[80:81], v[80:81], v[248:249]
  v_rcp_f32 v68, v68
  v_rcp_f32 v69, v69
  v_rcp_f32 v72, v72
  v_rcp_f32 v73, v73
  v_rcp_f32 v76, v76
  v_rcp_f32 v77, v77
  v_rcp_f32 v80, v80
  v_rcp_f32 v81, v81
  v_pk_fma_f32 v[44:45], v[68:69], v[70:71], v[44:45]
  v_pk_fma_f32 v[46:47], v[72:73], v[74:75], v[46:47]
  v_pk_fma_f32 v[44:45], v[76:77], v[78:79], v[44:45]
  v_pk_fma_f32 v[46:47], v[80:81], v[82:83], v[46:47]
  v_pk_mul_f32 v[52:53], v[192:193], v[192:193]
  v_pk_mul_f32 v[56:57], v[208:209], v[208:209]
  v_pk_mul_f32 v[60:61], v[194:195], v[194:195]
  v_pk_mul_f32 v[64:65], v[210:211], v[210:211]
  v_pk_fma_f32 v[52:53], v[52:53], v[14:15], v[12:13]
  v_pk_fma_f32 v[56:57], v[56:57], v[14:15], v[12:13]
  v_pk_fma_f32 v[60:61], v[60:61], v[14:15], v[12:13]
  v_pk_fma_f32 v[64:65], v[64:65], v[14:15], v[12:13]
  v_pk_mul_f32 v[52:53], v[52:53], v[192:193]
  v_pk_mul_f32 v[56:57], v[56:57], v[208:209]
  v_pk_mul_f32 v[60:61], v[60:61], v[194:195]
  v_pk_mul_f32 v[64:65], v[64:65], v[210:211]
  v_exp_f32 v52, v52
  v_exp_f32 v53, v53
  v_exp_f32 v56, v56
  v_exp_f32 v57, v57
  v_exp_f32 v60, v60
  v_exp_f32 v61, v61
  v_exp_f32 v64, v64
  v_exp_f32 v65, v65
  v_pk_mul_f32 v[54:55], v[192:193], v[24:25]
  v_pk_mul_f32 v[58:59], v[208:209], v[24:25]
  v_pk_mul_f32 v[62:63], v[194:195], v[26:27]
  v_pk_mul_f32 v[66:67], v[210:211], v[26:27]
  v_pk_add_f32 v[52:53], v[52:53], v[248:249]
  v_pk_add_f32 v[56:57], v[56:57], v[248:249]
  v_pk_add_f32 v[60:61], v[60:61], v[248:249]
  v_pk_add_f32 v[64:65], v[64:65], v[248:249]
  v_rcp_f32 v52, v52
  v_rcp_f32 v53, v53
  v_rcp_f32 v56, v56
  v_rcp_f32 v57, v57
  v_rcp_f32 v60, v60
  v_rcp_f32 v61, v61
  v_rcp_f32 v64, v64
  v_rcp_f32 v65, v65
  v_pk_fma_f32 v[44:45], v[52:53], v[54:55], v[44:45]
  v_pk_fma_f32 v[46:47], v[56:57], v[58:59], v[46:47]
  v_pk_fma_f32 v[44:45], v[60:61], v[62:63], v[44:45]
  v_pk_fma_f32 v[46:47], v[64:65], v[66:67], v[46:47]
  v_pk_mul_f32 v[68:69], v[196:197], v[196:197]
  v_pk_mul_f32 v[72:73], v[212:213], v[212:213]
  v_pk_mul_f32 v[76:77], v[198:199], v[198:199]
  v_pk_mul_f32 v[80:81], v[214:215], v[214:215]
  v_pk_fma_f32 v[68:69], v[68:69], v[14:15], v[12:13]
  v_pk_fma_f32 v[72:73], v[72:73], v[14:15], v[12:13]
  v_pk_fma_f32 v[76:77], v[76:77], v[14:15], v[12:13]
  v_pk_fma_f32 v[80:81], v[80:81], v[14:15], v[12:13]
  v_pk_mul_f32 v[68:69], v[68:69], v[196:197]
  v_pk_mul_f32 v[72:73], v[72:73], v[212:213]
  v_pk_mul_f32 v[76:77], v[76:77], v[198:199]
  v_pk_mul_f32 v[80:81], v[80:81], v[214:215]
  v_exp_f32 v68, v68
  v_exp_f32 v69, v69
  v_exp_f32 v72, v72
  v_exp_f32 v73, v73
  v_exp_f32 v76, v76
  v_exp_f32 v77, v77
  v_exp_f32 v80, v80
  v_exp_f32 v81, v81
  v_pk_mul_f32 v[70:71], v[196:197], v[28:29]
  v_pk_mul_f32 v[74:75], v[212:213], v[28:29]
  v_pk_mul_f32 v[78:79], v[198:199], v[30:31]
  v_pk_mul_f32 v[82:83], v[214:215], v[30:31]
  v_pk_add_f32 v[68:69], v[68:69], v[248:249]
  v_pk_add_f32 v[72:73], v[72:73], v[248:249]
  v_pk_add_f32 v[76:77], v[76:77], v[248:249]
  v_pk_add_f32 v[80:81], v[80:81], v[248:249]
  v_rcp_f32 v68, v68
  v_rcp_f32 v69, v69
  v_rcp_f32 v72, v72
  v_rcp_f32 v73, v73
  v_rcp_f32 v76, v76
  v_rcp_f32 v77, v77
  v_rcp_f32 v80, v80
  v_rcp_f32 v81, v81
  v_pk_fma_f32 v[44:45], v[68:69], v[70:71], v[44:45]
  v_pk_fma_f32 v[46:47], v[72:73], v[74:75], v[46:47]
  v_pk_fma_f32 v[44:45], v[76:77], v[78:79], v[44:45]
  v_pk_fma_f32 v[46:47], v[80:81], v[82:83], v[46:47]
  v_pk_mul_f32 v[52:53], v[216:217], v[216:217]
  v_pk_mul_f32 v[56:57], v[232:233], v[232:233]
  v_pk_mul_f32 v[60:61], v[218:219], v[218:219]
  v_pk_mul_f32 v[64:65], v[234:235], v[234:235]
  v_pk_fma_f32 v[52:53], v[52:53], v[14:15], v[12:13]
  v_pk_fma_f32 v[56:57], v[56:57], v[14:15], v[12:13]
  v_pk_fma_f32 v[60:61], v[60:61], v[14:15], v[12:13]
  v_pk_fma_f32 v[64:65], v[64:65], v[14:15], v[12:13]
  v_pk_mul_f32 v[52:53], v[52:53], v[216:217]
  v_pk_mul_f32 v[56:57], v[56:57], v[232:233]
  v_pk_mul_f32 v[60:61], v[60:61], v[218:219]
  v_pk_mul_f32 v[64:65], v[64:65], v[234:235]
  v_exp_f32 v52, v52
  v_exp_f32 v53, v53
  v_exp_f32 v56, v56
  v_exp_f32 v57, v57
  v_exp_f32 v60, v60
  v_exp_f32 v61, v61
  v_exp_f32 v64, v64
  v_exp_f32 v65, v65
  v_pk_mul_f32 v[54:55], v[216:217], v[16:17]
  v_pk_mul_f32 v[58:59], v[232:233], v[16:17]
  v_pk_mul_f32 v[62:63], v[218:219], v[18:19]
  v_pk_mul_f32 v[66:67], v[234:235], v[18:19]
  v_pk_add_f32 v[52:53], v[52:53], v[248:249]
  v_pk_add_f32 v[56:57], v[56:57], v[248:249]
  v_pk_add_f32 v[60:61], v[60:61], v[248:249]
  v_pk_add_f32 v[64:65], v[64:65], v[248:249]
  v_rcp_f32 v52, v52
  v_rcp_f32 v53, v53
  v_rcp_f32 v56, v56
  v_rcp_f32 v57, v57
  v_rcp_f32 v60, v60
  v_rcp_f32 v61, v61
  v_rcp_f32 v64, v64
  v_rcp_f32 v65, v65
  v_pk_mul_f32 v[48:49], v[52:53], v[54:55]
  v_pk_mul_f32 v[50:51], v[56:57], v[58:59]
  v_pk_fma_f32 v[48:49], v[60:61], v[62:63], v[48:49]
  v_pk_fma_f32 v[50:51], v[64:65], v[66:67], v[50:51]
  v_pk_mul_f32 v[68:69], v[220:221], v[220:221]
  v_pk_mul_f32 v[72:73], v[236:237], v[236:237]
  v_pk_mul_f32 v[76:77], v[222:223], v[222:223]
  v_pk_mul_f32 v[80:81], v[238:239], v[238:239]
  v_pk_fma_f32 v[68:69], v[68:69], v[14:15], v[12:13]
  v_pk_fma_f32 v[72:73], v[72:73], v[14:15], v[12:13]
  v_pk_fma_f32 v[76:77], v[76:77], v[14:15], v[12:13]
  v_pk_fma_f32 v[80:81], v[80:81], v[14:15], v[12:13]
  v_pk_mul_f32 v[68:69], v[68:69], v[220:221]
  v_pk_mul_f32 v[72:73], v[72:73], v[236:237]
  v_pk_mul_f32 v[76:77], v[76:77], v[222:223]
  v_pk_mul_f32 v[80:81], v[80:81], v[238:239]
  v_exp_f32 v68, v68
  v_exp_f32 v69, v69
  v_exp_f32 v72, v72
  v_exp_f32 v73, v73
  v_exp_f32 v76, v76
  v_exp_f32 v77, v77
  v_exp_f32 v80, v80
  v_exp_f32 v81, v81
  v_pk_mul_f32 v[70:71], v[220:221], v[20:21]
  v_pk_mul_f32 v[74:75], v[236:237], v[20:21]
  v_pk_mul_f32 v[78:79], v[222:223], v[22:23]
  v_pk_mul_f32 v[82:83], v[238:239], v[22:23]
  v_pk_add_f32 v[68:69], v[68:69], v[248:249]
  v_pk_add_f32 v[72:73], v[72:73], v[248:249]
  v_pk_add_f32 v[76:77], v[76:77], v[248:249]
  v_pk_add_f32 v[80:81], v[80:81], v[248:249]
  v_rcp_f32 v68, v68
  v_rcp_f32 v69, v69
  v_rcp_f32 v72, v72
  v_rcp_f32 v73, v73
  v_rcp_f32 v76, v76
  v_rcp_f32 v77, v77
  v_rcp_f32 v80, v80
  v_rcp_f32 v81, v81
  v_pk_fma_f32 v[48:49], v[68:69], v[70:71], v[48:49]
  v_pk_fma_f32 v[50:51], v[72:73], v[74:75], v[50:51]
  v_pk_fma_f32 v[48:49], v[76:77], v[78:79], v[48:49]
  v_pk_fma_f32 v[50:51], v[80:81], v[82:83], v[50:51]
  v_pk_mul_f32 v[52:53], v[224:225], v[224:225]
  v_pk_mul_f32 v[56:57], v[240:241], v[240:241]
  v_pk_mul_f32 v[60:61], v[226:227], v[226:227]
  v_pk_mul_f32 v[64:65], v[242:243], v[242:243]
  v_pk_fma_f32 v[52:53], v[52:53], v[14:15], v[12:13]
  v_pk_fma_f32 v[56:57], v[56:57], v[14:15], v[12:13]
  v_pk_fma_f32 v[60:61], v[60:61], v[14:15], v[12:13]
  v_pk_fma_f32 v[64:65], v[64:65], v[14:15], v[12:13]
  v_pk_mul_f32 v[52:53], v[52:53], v[224:225]
  v_pk_mul_f32 v[56:57], v[56:57], v[240:241]
  v_pk_mul_f32 v[60:61], v[60:61], v[226:227]
  v_pk_mul_f32 v[64:65], v[64:65], v[242:243]
  v_exp_f32 v52, v52
  v_exp_f32 v53, v53
  v_exp_f32 v56, v56
  v_exp_f32 v57, v57
  v_exp_f32 v60, v60
  v_exp_f32 v61, v61
  v_exp_f32 v64, v64
  v_exp_f32 v65, v65
  v_pk_mul_f32 v[54:55], v[224:225], v[24:25]
  v_pk_mul_f32 v[58:59], v[240:241], v[24:25]
  v_pk_mul_f32 v[62:63], v[226:227], v[26:27]
  v_pk_mul_f32 v[66:67], v[242:243], v[26:27]
  v_pk_add_f32 v[52:53], v[52:53], v[248:249]
  v_pk_add_f32 v[56:57], v[56:57], v[248:249]
  v_pk_add_f32 v[60:61], v[60:61], v[248:249]
  v_pk_add_f32 v[64:65], v[64:65], v[248:249]
  v_rcp_f32 v52, v52
  v_rcp_f32 v53, v53
  v_rcp_f32 v56, v56
  v_rcp_f32 v57, v57
  v_rcp_f32 v60, v60
  v_rcp_f32 v61, v61
  v_rcp_f32 v64, v64
  v_rcp_f32 v65, v65
  v_pk_fma_f32 v[48:49], v[52:53], v[54:55], v[48:49]
  v_pk_fma_f32 v[50:51], v[56:57], v[58:59], v[50:51]
  v_pk_fma_f32 v[48:49], v[60:61], v[62:63], v[48:49]
  v_pk_fma_f32 v[50:51], v[64:65], v[66:67], v[50:51]
  v_pk_mul_f32 v[68:69], v[228:229], v[228:229]
  v_pk_mul_f32 v[72:73], v[244:245], v[244:245]
  v_pk_mul_f32 v[76:77], v[230:231], v[230:231]
  v_pk_mul_f32 v[80:81], v[246:247], v[246:247]
  v_pk_fma_f32 v[68:69], v[68:69], v[14:15], v[12:13]
  v_pk_fma_f32 v[72:73], v[72:73], v[14:15], v[12:13]
  v_pk_fma_f32 v[76:77], v[76:77], v[14:15], v[12:13]
  v_pk_fma_f32 v[80:81], v[80:81], v[14:15], v[12:13]
  v_pk_mul_f32 v[68:69], v[68:69], v[228:229]
  v_pk_mul_f32 v[72:73], v[72:73], v[244:245]
  v_pk_mul_f32 v[76:77], v[76:77], v[230:231]
  v_pk_mul_f32 v[80:81], v[80:81], v[246:247]
  v_exp_f32 v68, v68
  v_exp_f32 v69, v69
  v_exp_f32 v72, v72
  v_exp_f32 v73, v73
  v_exp_f32 v76, v76
  v_exp_f32 v77, v77
  v_exp_f32 v80, v80
  v_exp_f32 v81, v81
  v_pk_mul_f32 v[70:71], v[228:229], v[28:29]
  v_pk_mul_f32 v[74:75], v[244:245], v[28:29]
  v_pk_mul_f32 v[78:79], v[230:231], v[30:31]
  v_pk_mul_f32 v[82:83], v[246:247], v[30:31]
  v_pk_add_f32 v[68:69], v[68:69], v[248:249]
  v_pk_add_f32 v[72:73], v[72:73], v[248:249]
  v_pk_add_f32 v[76:77], v[76:77], v[248:249]
  v_pk_add_f32 v[80:81], v[80:81], v[248:249]
  v_rcp_f32 v68, v68
  v_rcp_f32 v69, v69
  v_rcp_f32 v72, v72
  v_rcp_f32 v73, v73
  v_rcp_f32 v76, v76
  v_rcp_f32 v77, v77
  v_rcp_f32 v80, v80
  v_rcp_f32 v81, v81
  v_pk_fma_f32 v[48:49], v[68:69], v[70:71], v[48:49]
  v_pk_fma_f32 v[50:51], v[72:73], v[74:75], v[50:51]
  v_pk_fma_f32 v[48:49], v[76:77], v[78:79], v[48:49]
  v_pk_fma_f32 v[50:51], v[80:81], v[82:83], v[50:51]
  v_pk_mul_f32 v[32:33], v[88:89], v[16:17]
  v_pk_fma_f32 v[32:33], v[90:91], v[18:19], v[32:33]
  v_pk_fma_f32 v[32:33], v[92:93], v[20:21], v[32:33]
  v_pk_fma_f32 v[32:33], v[94:95], v[22:23], v[32:33]
  v_pk_fma_f32 v[32:33], v[96:97], v[24:25], v[32:33]
  v_pk_fma_f32 v[32:33], v[98:99], v[26:27], v[32:33]
  v_pk_fma_f32 v[32:33], v[100:101], v[28:29], v[32:33]
  v_pk_fma_f32 v[32:33], v[102:103], v[30:31], v[32:33]
  v_add_f32 v32, v32, v33
  v_add_f32 v34, v34, v35
  v_add_f32 v36, v36, v37
  v_add_f32 v38, v38, v39
  v_add_f32 v40, v40, v41
  v_add_f32 v42, v42, v43
  v_add_f32 v44, v44, v45
  v_add_f32 v46, v46, v47
  v_add_f32 v48, v48, v49
  v_add_f32 v50, v50, v51
  v_permlane32_swap_b32 v32, v34
  v_permlane32_swap_b32 v36, v38
  v_permlane32_swap_b32 v40, v42
  v_permlane32_swap_b32 v44, v46
  v_permlane32_swap_b32 v48, v50
  v_add_f32 v48, v48, v50
  v_add_f32 v32, v32, v34
  v_add_f32 v36, v36, v38
  v_add_f32 v40, v40, v42
  v_add_f32 v44, v44, v46
  v_mov_b32 v50, v48
  v_permlane16_swap_b32 v32, v36
  v_permlane16_swap_b32 v40, v44
  v_permlane16_swap_b32 v48, v50
  v_add_f32 v32, v32, v36
  v_add_f32 v40, v40, v44
  v_add_f32_e64 v48, v48, v50
  ds_write_b32 v10, v32
  ds_write_b32 v10, v40 offset:256
  s_mov_b32 exec_lo, 0xffff
  s_mov_b32 exec_hi, 0xffff
  ds_write_b32 v10, v48 offset:512
  s_mov_b64 exec, -1
  s_waitcnt lgkmcnt(0)
  s_barrier
  s_endpgm
L_ld_tail:
  s_barrier
  s_mov_b32 s60, s24
  s_and_b32 s61, s25, 0xffff
  s_mov_b32 s62, 268435456
  s_mov_b32 s63, 0x20000
  s_mov_b32 s56, s20
  s_and_b32 s57, s21, 0xffff
  s_mov_b32 s58, 8192
  s_mov_b32 s59, 0x20000
  s_mov_b32 s64, s22
  s_and_b32 s65, s23, 0xffff
  s_mov_b32 s66, 256
  s_mov_b32 s67, 0x20000
  s_load_dword s80, s[18:19], 0
  v_mov_b32 v100, 0
  s_mov_b64 exec, 1
  s_mov_b32 s81, 0x80000
  buffer_load_dword v101, v100, s[60:63], s81 offen
  buffer_load_dword v102, v100, s[56:59], 0 offen
  s_mov_b64 exec, -1
  s_mov_b64 exec, 1
  buffer_load_dword v250, v100, s[64:67], 0 offen offset:240 sc1
  s_mov_b64 exec, -1
  s_cmp_lg_u32 s3, 4
  s_cbranch_scc1 L_end
  v_lshlrev_b32 v3, 4, v0
  v_lshlrev_b32 v4, 2, v0
  v_add_u32 v1, 123392, v3
  v_add_u32 v2, 124416, v4
  v_add_u32 v4, 1024, v4
  v_mov_b32 v5, 32
  v_mov_b32 v7, s26
  s_mul_i32 s68, s26, 1280
  s_mul_i32 s69, s27, 16640
  s_add_u32 s69, s69, s68
  s_setprio 3
  v_mov_b32 v64, -1
  v_mov_b32 v65, -1
  v_mov_b32 v66, -1
  v_mov_b32_e64 v67, -1
  buffer_store_dwordx4 v[64:67], v3, s[60:63], s69 offen sc1
  buffer_store_dword v64, v4, s[60:63], s69 offen sc1
  s_waitcnt vmcnt(0)
  s_barrier
  ds_read_b128 v[64:67], v1
  ds_read_b128 v[72:75], v1 offset:1280
  ds_read2st64_b32 v[68:69], v2 offset0:0 offset1:5
  s_waitcnt lgkmcnt(0)
  v_pk_add_f32 v[64:65], v[64:65], v[72:73]
  v_pk_add_f32 v[66:67], v[66:67], v[74:75]
  v_add_f32 v68, v68, v69
  v_min_u32 v64, -2, v64
  v_min_u32 v65, -2, v65
  v_min_u32 v66, -2, v66
  v_min_u32 v67, -2, v67
  v_min_u32_e64 v68, -2, v68
  buffer_store_dwordx4 v[64:67], v3, s[60:63], s69 offen sc1
  buffer_store_dword v68, v4, s[60:63], s69 offen sc1
  s_mov_b64 exec, 1
L_pub:
  v_lshlrev_b32 v6, 4, v7
  v_mov_b32 v13, v5
  buffer_atomic_add v5, v6, s[64:67], 0 offen sc0
  v_cmp_eq_u32 vcc, 12, v7
  v_mov_b32 v8, 436
  v_mov_b32 v9, 434
  v_cndmask_b32 v8, v8, v9, vcc
  v_sub_u32_e64 v8, v8, v13
  s_waitcnt vmcnt(0) lgkmcnt(0)
  v_cmp_eq_u32 s[82:83], v5, v8
  s_mov_b64 exec, -1
  s_lshl_b32 s80, s80, 16
  v_lshrrev_b32 v1, 1, v3
  v_lshrrev_b32_e64 v2, 1, v4
L_fin:
  s_cmp_eq_u32 s82, 0
  s_cbranch_scc1 L_done
  s_ff1_i32_b32 s70, s82
  s_bitset0_b32 s82, s70
  v_readlane_b32 s71, v7, s70
  s_waitcnt vmcnt(0)
L_again:
  s_mul_i32 s68, s71, 1280
  buffer_load_dwordx4 v[64:67], v3, s[60:63], s68 offen sc1
  buffer_load_dword v68, v4, s[60:63], s68 offen sc1
  s_add_u32 s68, s68, 16640
  buffer_load_dwordx4 v[72:75], v3, s[60:63], s68 offen sc1
  buffer_load_dword v76, v4, s[60:63], s68 offen sc1
  s_add_u32 s68, s68, 16640
  buffer_load_dwordx4 v[80:83], v3, s[60:63], s68 offen sc1
  buffer_load_dword v84, v4, s[60:63], s68 offen sc1
  s_add_u32 s68, s68, 16640
  buffer_load_dwordx4 v[88:91], v3, s[60:63], s68 offen sc1
  buffer_load_dword v92, v4, s[60:63], s68 offen sc1
  s_add_u32 s68, s68, 16640
  buffer_load_dwordx4 v[96:99], v3, s[60:63], s68 offen sc1
  buffer_load_dword v100, v4, s[60:63], s68 offen sc1
  s_add_u32 s68, s68, 16640
  buffer_load_dwordx4 v[104:107], v3, s[60:63], s68 offen sc1
  buffer_load_dword v108, v4, s[60:63], s68 offen sc1
  s_add_u32 s68, s68, 16640
  buffer_load_dwordx4 v[112:115], v3, s[60:63], s68 offen sc1
  buffer_load_dword v116, v4, s[60:63], s68 offen sc1
  s_add_u32 s68, s68, 16640
  buffer_load_dwordx4 v[120:123], v3, s[60:63], s68 offen sc1
  buffer_load_dword v124, v4, s[60:63], s68 offen sc1
  s_add_u32 s68, s68, 16640
  buffer_load_dwordx4 v[128:131], v3, s[60:63], s68 offen sc1
  buffer_load_dword v132, v4, s[60:63], s68 offen sc1
  s_add_u32 s68, s68, 16640
  buffer_load_dwordx4 v[136:139], v3, s[60:63], s68 offen sc1
  buffer_load_dword v140, v4, s[60:63], s68 offen sc1
  s_add_u32 s68, s68, 16640
  buffer_load_dwordx4 v[144:147], v3, s[60:63], s68 offen sc1
  buffer_load_dword v148, v4, s[60:63], s68 offen sc1
  s_add_u32 s68, s68, 16640
  buffer_load_dwordx4 v[152:155], v3, s[60:63], s68 offen sc1
  buffer_load_dword v156, v4, s[60:63], s68 offen sc1
  s_add_u32 s68, s68, 16640
  buffer_load_dwordx4 v[160:163], v3, s[60:63], s68 offen sc1
  buffer_load_dword v164, v4, s[60:63], s68 offen sc1
  s_add_u32 s68, s68, 16640
  buffer_load_dwordx4 v[168:171], v3, s[60:63], s68 offen sc1
  buffer_load_dword v172, v4, s[60:63], s68 offen sc1
  s_add_u32 s68, s68, 16640
L_sum:
  s_waitcnt vmcnt(25)
  v_pk_add_f32 v[56:57], v[64:65], v[72:73]
  v_pk_add_f32 v[58:59], v[66:67], v[74:75]
  s_waitcnt vmcnt(24)
  v_add_f32 v60, v68, v76
  s_waitcnt vmcnt(23)
  v_pk_add_f32 v[56:57], v[56:57], v[80:81]
  v_pk_add_f32 v[58:59], v[58:59], v[82:83]
  s_waitcnt vmcnt(22)
  v_add_f32 v60, v60, v84
  s_waitcnt vmcnt(21)
  v_pk_add_f32 v[56:57], v[56:57], v[88:89]
  v_pk_add_f32 v[58:59], v[58:59], v[90:91]
  s_waitcnt vmcnt(20)
  v_add_f32 v60, v60, v92
  s_waitcnt vmcnt(19)
  v_pk_add_f32 v[56:57], v[56:57], v[96:97]
  v_pk_add_f32 v[58:59], v[58:59], v[98:99]
  s_waitcnt vmcnt(18)
  v_add_f32 v60, v60, v100
  s_waitcnt vmcnt(17)
  v_pk_add_f32 v[56:57], v[56:57], v[104:105]
  v_pk_add_f32 v[58:59], v[58:59], v[106:107]
  s_waitcnt vmcnt(16)
  v_add_f32 v60, v60, v108
  s_waitcnt vmcnt(15)
  v_pk_add_f32 v[56:57], v[56:57], v[112:113]
  v_pk_add_f32 v[58:59], v[58:59], v[114:115]
  s_waitcnt vmcnt(14)
  v_add_f32_e64 v60, v60, v116
  s_waitcnt vmcnt(13)
  v_pk_add_f32 v[56:57], v[56:57], v[120:121]
  v_pk_add_f32 v[58:59], v[58:59], v[122:123]
  s_waitcnt vmcnt(12)
  v_add_f32 v60, v60, v124
  s_waitcnt vmcnt(11)
  v_pk_add_f32 v[56:57], v[56:57], v[128:129]
  v_pk_add_f32 v[58:59], v[58:59], v[130:131]
  s_waitcnt vmcnt(10)
  v_add_f32 v60, v60, v132
  s_waitcnt vmcnt(9)
  v_pk_add_f32 v[56:57], v[56:57], v[136:137]
  v_pk_add_f32 v[58:59], v[58:59], v[138:139]
  s_waitcnt vmcnt(8)
  v_add_f32 v60, v60, v140
  s_waitcnt vmcnt(7)
  v_pk_add_f32 v[56:57], v[56:57], v[144:145]
  v_pk_add_f32 v[58:59], v[58:59], v[146:147]
  s_waitcnt vmcnt(6)
  v_add_f32 v60, v60, v148
  s_waitcnt vmcnt(5)
  v_pk_add_f32 v[56:57], v[56:57], v[152:153]
  v_pk_add_f32 v[58:59], v[58:59], v[154:155]
  s_waitcnt vmcnt(4)
  v_add_f32 v60, v60, v156
  s_waitcnt vmcnt(3)
  v_pk_add_f32 v[56:57], v[56:57], v[160:161]
  v_pk_add_f32 v[58:59], v[58:59], v[162:163]
  s_waitcnt vmcnt(2)
  v_add_f32 v60, v60, v164
  s_waitcnt vmcnt(1)
  v_pk_add_f32 v[56:57], v[56:57], v[168:169]
  v_pk_add_f32 v[58:59], v[58:59], v[170:171]
  s_waitcnt vmcnt(0)
  v_add_f32 v60, v60, v172
  v_cmp_u_f32 vcc, v56, v57
  v_cmp_u_f32 s[92:93], v58, v59
  s_nop 0
  s_or_b64 s[92:93], s[92:93], vcc
  v_cmp_u_f32 vcc, v60, v60
  s_nop 0
  s_or_b64 vcc, s[92:93], vcc
  s_cbranch_vccnz L_chk
L_ok:
  s_mul_i32 s71, s71, 640
  v_add_f32 v56, s80, v56
  v_add_f32 v57, s80, v57
  v_add_f32 v58, s80, v58
  v_add_f32 v59, s80, v59
  v_add_f32 v60, s80, v60
  v_cvt_pk_bf16_f32 v10, v56, v57
  v_cvt_pk_bf16_f32 v11, v58, v59
  v_cvt_pk_bf16_f32 v12, v60, v60
  buffer_store_dwordx2 v[10:11], v1, s[56:59], s71 offen
  buffer_store_short v12, v2, s[56:59], s71 offen
  s_branch L_fin
L_chk:
  v_mov_b32 v14, 0
  v_mov_b32_e64 v15, 0
  v_max3_u32 v14, v14, v64, v65
  v_max3_u32 v14, v14, v66, v67
  v_max_u32 v15, v15, v68
  v_max3_u32 v14, v14, v72, v73
  v_max3_u32 v14, v14, v74, v75
  v_max_u32 v15, v15, v76
  v_max3_u32 v14, v14, v80, v81
  v_max3_u32 v14, v14, v82, v83
  v_max_u32_e64 v15, v15, v84
  v_max3_u32 v14, v14, v88, v89
  v_max3_u32 v14, v14, v90, v91
  v_max_u32 v15, v15, v92
  v_max3_u32 v14, v14, v96, v97
  v_max3_u32 v14, v14, v98, v99
  v_max_u32 v15, v15, v100
  v_max3_u32 v14, v14, v104, v105
  v_max3_u32 v14, v14, v106, v107
  v_max_u32_e64 v15, v15, v108
  v_max3_u32 v14, v14, v112, v113
  v_max3_u32 v14, v14, v114, v115
  v_max_u32 v15, v15, v116
  v_max3_u32 v14, v14, v120, v121
  v_max3_u32 v14, v14, v122, v123
  v_max_u32 v15, v15, v124
  v_max3_u32 v14, v14, v128, v129
  v_max3_u32 v14, v14, v130, v131
  v_max_u32_e64 v15, v15, v132
  v_max3_u32 v14, v14, v136, v137
  v_max3_u32 v14, v14, v138, v139
  v_max_u32 v15, v15, v140
  v_max3_u32 v14, v14, v144, v145
  v_max3_u32 v14, v14, v146, v147
  v_max_u32 v15, v15, v148
  v_max3_u32 v14, v14, v152, v153
  v_max3_u32 v14, v14, v154, v155
  v_max_u32_e64 v15, v15, v156
  v_max3_u32 v14, v14, v160, v161
  v_max3_u32 v14, v14, v162, v163
  v_max_u32 v15, v15, v164
  v_max3_u32 v14, v14, v168, v169
  v_max3_u32 v14, v14, v170, v171
  v_max_u32 v15, v15, v172
  s_cmp_eq_u32 s71, 12
  s_cselect_b32 s68, 0, -1
  v_and_b32 v15, s68, v15
  v_max_u32 v14, v14, v15
  v_cmp_eq_u32 vcc, -1, v14
  s_cbranch_vccnz L_again
  s_branch L_ok
L_done:
  s_endpgm
L_cin_done:
  s_mul_i32 s98, s3, 1536
  s_add_u32 s98, s98, 116736
  v_lshlrev_b32 v120, 5, v0
  v_add_u32 v120, s98, v120
  ds_read_b128 v[60:63], v120
  ds_read_b128 v[64:67], v120 offset:16
  v_mul_f32 v116, v184, v192
  v_mul_f32 v117, v185, v193
  v_mul_f32 v118, v186, v194
  v_mul_f32 v119, v187, v195
  v_fmac_f32 v116, v188, v191
  v_fmac_f32 v117, v200, v208
  v_fmac_f32 v118, v201, v209
  v_fmac_f32 v119, v202, v210
  v_fmac_f32 v116, v203, v211
  v_fmac_f32 v117, v204, v207
  v_fmac_f32 v118, v216, v224
  v_fmac_f32 v119, v217, v225
  v_fmac_f32 v116, v218, v226
  v_fmac_f32 v117, v219, v227
  v_fmac_f32 v118, v220, v223
  v_fmac_f32 v119, v232, v240
  v_fmac_f32 v116, v233, v241
  v_fmac_f32 v117, v234, v242
  v_fmac_f32 v118, v235, v243
  v_fmac_f32 v119, v236, v239
  v_fmac_f32 v116, v189, v196
  v_fmac_f32 v117, v189, v197
  v_fmac_f32 v118, v190, v198
  v_fmac_f32 v119, v190, v199
  v_fmac_f32 v116, v205, v212
  v_fmac_f32 v117, v205, v213
  v_fmac_f32 v118, v206, v214
  v_fmac_f32 v119, v206, v215
  v_fmac_f32 v116, v221, v228
  v_fmac_f32 v117, v221, v229
  v_fmac_f32 v118, v222, v230
  v_fmac_f32 v119, v222, v231
  v_fmac_f32 v116, v237, v244
  v_fmac_f32 v117, v237, v245
  v_fmac_f32 v118, v238, v246
  v_fmac_f32 v119, v238, v247
  v_add_f32 v116, v116, v117
  v_add_f32 v118, v118, v119
  v_add_f32 v116, v116, v118
  v_mul_f32 v116, s74, v116
  v_mul_f32 v116, s75, v116
  s_nop 1
  v_add_f32_dpp v116, v116, v116 row_shr:1 row_mask:0xf bank_mask:0xf
  v_subrev_u32 v122, s98, v7
  v_lshrrev_b32 v122, 8, v122
  v_lshrrev_b32 v121, 3, v0
  v_add_f32_dpp v116, v116, v116 row_shr:2 row_mask:0xf bank_mask:0xf
  v_cmp_gt_u32 vcc, v122, v121
  v_min_u32 v121, v121, v122
  v_lshlrev_b32 v121, 4, v121
  v_add_f32_dpp v116, v116, v116 row_shr:4 row_mask:0xf bank_mask:0xf
  v_add_u32 v121, s85, v121
  s_waitcnt lgkmcnt(1)
  v_add_f32 v60, v60, v61
  v_add_f32 v62, v62, v63
  v_add_f32_dpp v116, v116, v116 row_shr:8 row_mask:0xf bank_mask:0xf
  s_waitcnt lgkmcnt(0)
  v_add_f32 v64, v64, v65
  v_add_f32 v66, v66, v67
  v_add_f32 v60, v60, v62
  v_add_f32_dpp v116, v116, v116 row_bcast:15 row_mask:0xa bank_mask:0xf
  v_add_f32 v64, v64, v66
  v_add_f32_e64 v60, v60, v64
  s_nop 1
  v_add_f32_dpp v60, v60, v60 quad_perm:[1,0,3,2] row_mask:0xf bank_mask:0xf
  v_add_f32_dpp v116, v116, v116 row_bcast:31 row_mask:0xc bank_mask:0xf
  s_nop 0
  v_add_f32_dpp v60, v60, v60 quad_perm:[2,3,0,1] row_mask:0xf bank_mask:0xf
  s_nop 1
  v_add_f32_dpp v60, v60, v60 row_half_mirror row_mask:0xf bank_mask:0xf
  v_cndmask_b32 v60, v116, v60, vcc
  s_bitset1_b32 vcc_hi, 31
  s_mov_b64 exec, vcc
  ds_write_b32 v121, v60
  s_mov_b64 exec, -1
  s_cmp_eq_u32 s3, 0
  s_cbranch_scc1 L_cpub
  s_waitcnt lgkmcnt(0)
  s_barrier
  s_endpgm
L_cpub:
  s_load_dword s80, s[18:19], 0
  s_mov_b32 s60, s24
  s_and_b32 s61, s25, 0xffff
  s_mov_b32 s62, 268435456
  s_mov_b32 s63, 0x20000
  s_mov_b32 s56, s20
  s_and_b32 s57, s21, 0xffff
  s_mov_b32 s58, 8192
  s_mov_b32 s59, 0x20000
  s_mov_b32 s64, s22
  s_and_b32 s65, s23, 0xffff
  s_mov_b32 s66, 256
  s_mov_b32 s67, 0x20000
  v_lshlrev_b32_e64 v6, 2, v0
  v_add_u32 v2, 129728, v6
  v_add_u32 v4, 1024, v6
  s_mul_i32 s69, s26, 192
  s_add_u32 s69, s69, 216320
  v_mov_b32 v13, -1
  s_mov_b32 exec_hi, 0xffff
  buffer_store_dword v13, v6, s[60:63], s69 offen sc1
  s_mov_b64 exec, 1
  buffer_load_dword v250, v6, s[56:59], 0 offen
  buffer_load_dword v251, v6, s[64:67], 0 offen offset:240 sc1
  s_mov_b64 exec, -1
  s_mul_i32 s68, s26, 3
  s_mul_i32 s70, s68, 3277
  s_lshr_b32 s70, s70, 16
  v_add_u32 v7, s70, v0
  s_mul_i32 s70, s70, 20
  s_add_u32 s70, s70, 20
  s_sub_u32 s70, s70, s68
  s_min_u32 s70, s70, 3
  s_sub_u32 s68, 3, s70
  v_mov_b32 v5, s68
  v_writelane_b32 v5, s70, 0
  s_cmp_eq_u32 s68, 0
  s_cselect_b32 s68, 1, 3
  v_lshlrev_b32 v3, 4, v0
  s_mov_b32 exec_hi, 0xffff
  s_waitcnt vmcnt(0) lgkmcnt(0)
  s_barrier
  ds_read_b32 v64, v2
  s_waitcnt lgkmcnt(0)
  v_min_u32_e64 v64, -2, v64
  buffer_store_dword v64, v6, s[60:63], s69 offen sc1
  s_mov_b32 exec_lo, s68
  s_mov_b32 exec_hi, 0
  s_branch L_pub
L_dnn_loop1:
  s_barrier
L_ld_in:
  s_add_u32 m0, s75, 131072
  s_nop 0
  buffer_load_dwordx4 v4, s[44:47], s74 offen lds
  s_add_u32 m0, s75, 132096
  s_nop 0
  buffer_load_dwordx4 v5, s[44:47], s74 offen lds
  s_add_u32 s74, s74, 106496
  s_add_u32 m0, s75, 139264
  s_nop 0
  buffer_load_dwordx4 v4, s[44:47], s74 offen lds
  s_add_u32 m0, s75, 140288
  s_nop 0
  buffer_load_dwordx4 v5, s[44:47], s74 offen lds
  s_add_u32 s74, s74, 106496
  s_add_u32 m0, s76, 0
  s_nop 0
  buffer_load_dwordx4 v56, s[32:35], 0 offen lds
  s_add_u32 m0, s76, 2048
  v_add_u32_dpp v56, v16, v2 row_newbcast:1 row_mask:0xf bank_mask:0x3
  buffer_load_dwordx4 v57, s[32:35], 0 offen lds
  s_nop 0
  v_add_u32_dpp v56, v18, v2 row_newbcast:7 row_mask:0xf bank_mask:0xc
  s_add_u32 m0, s76, 4096
  v_add_u32_dpp v57, v20, v2 row_newbcast:1 row_mask:0xf bank_mask:0x3
  buffer_load_dwordx4 v58, s[32:35], 0 offen lds
  s_nop 0
  v_add_u32_dpp v57, v22, v2 row_newbcast:7 row_mask:0xf bank_mask:0xc
  s_add_u32 m0, s76, 6144
  v_add_u32_dpp v58, v24, v2 row_newbcast:1 row_mask:0xf bank_mask:0x3
  buffer_load_dwordx4 v59, s[32:35], 0 offen lds
  s_nop 0
  v_add_u32_dpp v58, v26, v2 row_newbcast:7 row_mask:0xf bank_mask:0xc
  s_add_u32 m0, s76, 8192
  v_add_u32_dpp v59, v28, v2 row_newbcast:1 row_mask:0xf bank_mask:0x3
  buffer_load_dwordx4 v60, s[32:35], 0 offen lds
  s_nop 0
  v_add_u32_dpp v59, v30, v2 row_newbcast:7 row_mask:0xf bank_mask:0xc
  s_add_u32 m0, s76, 10240
  v_add_u32_dpp v60, v32, v2 row_newbcast:1 row_mask:0xf bank_mask:0x3
  buffer_load_dwordx4 v61, s[32:35], 0 offen lds
  s_nop 0
  v_add_u32_dpp v60, v34, v2 row_newbcast:7 row_mask:0xf bank_mask:0xc
  s_add_u32 m0, s76, 12288
  v_add_u32_dpp v61, v36, v2 row_newbcast:1 row_mask:0xf bank_mask:0x3
  buffer_load_dwordx4 v62, s[32:35], 0 offen lds
  s_nop 0
  v_add_u32_dpp v61, v38, v2 row_newbcast:7 row_mask:0xf bank_mask:0xc
  s_add_u32 m0, s76, 14336
  v_add_u32_dpp v62, v40, v2 row_newbcast:1 row_mask:0xf bank_mask:0x3
  buffer_load_dwordx4 v63, s[32:35], 0 offen lds
  s_nop 0
  v_add_u32_dpp v62, v42, v2 row_newbcast:7 row_mask:0xf bank_mask:0xc
  s_add_u32 m0, s76, 16384
  v_add_u32_dpp v63, v44, v2 row_newbcast:1 row_mask:0xf bank_mask:0x3
  buffer_load_dwordx4 v64, s[32:35], 0 offen lds
  s_nop 0
  v_add_u32_dpp v63, v46, v2 row_newbcast:7 row_mask:0xf bank_mask:0xc
  s_add_u32 m0, s76, 18432
  v_add_u32_dpp v64, v48, v2 row_newbcast:1 row_mask:0xf bank_mask:0x3
  buffer_load_dwordx4 v65, s[32:35], 0 offen lds
  s_nop 0
  v_add_u32_dpp v64, v50, v2 row_newbcast:7 row_mask:0xf bank_mask:0xc
  v_add_u32_dpp v65, v52, v2 row_newbcast:1 row_mask:0xf bank_mask:0x3
  s_nop 1
  v_add_u32_dpp v65, v54, v2 row_newbcast:7 row_mask:0xf bank_mask:0xc
  s_waitcnt vmcnt(10)
  s_barrier
  s_add_u32 m0, s75, 147456
  s_nop 0
  buffer_load_dwordx4 v4, s[44:47], s74 offen lds
  s_add_u32 m0, s75, 148480
  s_nop 0
  buffer_load_dwordx4 v5, s[44:47], s74 offen lds
  s_add_u32 s74, s74, 106496
  s_add_u32 m0, s75, 155648
  s_nop 0
  buffer_load_dwordx4 v4, s[44:47], s74 offen lds
  s_add_u32 m0, s75, 156672
  s_nop 0
  buffer_load_dwordx4 v5, s[44:47], s74 offen lds
  s_add_u32 s74, s74, 106496
  s_add_u32 m0, s76, 40960
  s_nop 0
  buffer_load_dwordx4 v56, s[32:35], 0 offen lds
  s_add_u32 m0, s76, 43008
  v_add_u32_dpp v56, v17, v2 row_newbcast:1 row_mask:0xf bank_mask:0x3
  buffer_load_dwordx4 v57, s[32:35], 0 offen lds
  s_nop 0
  v_add_u32_dpp v56, v19, v2 row_newbcast:7 row_mask:0xf bank_mask:0xc
  s_add_u32 m0, s76, 45056
  v_add_u32_dpp v57, v21, v2 row_newbcast:1 row_mask:0xf bank_mask:0x3
  buffer_load_dwordx4 v58, s[32:35], 0 offen lds
  s_nop 0
  v_add_u32_dpp v57, v23, v2 row_newbcast:7 row_mask:0xf bank_mask:0xc
  s_add_u32 m0, s76, 47104
  v_add_u32_dpp v58, v25, v2 row_newbcast:1 row_mask:0xf bank_mask:0x3
  buffer_load_dwordx4 v59, s[32:35], 0 offen lds
  s_nop 0
  v_add_u32_dpp v58, v27, v2 row_newbcast:7 row_mask:0xf bank_mask:0xc
  s_add_u32 m0, s76, 49152
  v_add_u32_dpp v59, v29, v2 row_newbcast:1 row_mask:0xf bank_mask:0x3
  buffer_load_dwordx4 v60, s[32:35], 0 offen lds
  s_nop 0
  v_add_u32_dpp v59, v31, v2 row_newbcast:7 row_mask:0xf bank_mask:0xc
  s_add_u32 m0, s76, 51200
  v_add_u32_dpp v60, v33, v2 row_newbcast:1 row_mask:0xf bank_mask:0x3
  buffer_load_dwordx4 v61, s[32:35], 0 offen lds
  s_nop 0
  v_add_u32_dpp v60, v35, v2 row_newbcast:7 row_mask:0xf bank_mask:0xc
  s_add_u32 m0, s76, 53248
  v_add_u32_dpp v61, v37, v2 row_newbcast:1 row_mask:0xf bank_mask:0x3
  buffer_load_dwordx4 v62, s[32:35], 0 offen lds
  s_nop 0
  v_add_u32_dpp v61, v39, v2 row_newbcast:7 row_mask:0xf bank_mask:0xc
  s_add_u32 m0, s76, 55296
  v_add_u32_dpp v62, v41, v2 row_newbcast:1 row_mask:0xf bank_mask:0x3
  buffer_load_dwordx4 v63, s[32:35], 0 offen lds
  s_nop 0
  v_add_u32_dpp v62, v43, v2 row_newbcast:7 row_mask:0xf bank_mask:0xc
  s_add_u32 m0, s76, 57344
  v_add_u32_dpp v63, v45, v2 row_newbcast:1 row_mask:0xf bank_mask:0x3
  buffer_load_dwordx4 v64, s[32:35], 0 offen lds
  s_nop 0
  v_add_u32_dpp v63, v47, v2 row_newbcast:7 row_mask:0xf bank_mask:0xc
  s_add_u32 m0, s76, 59392
  v_add_u32_dpp v64, v49, v2 row_newbcast:1 row_mask:0xf bank_mask:0x3
  buffer_load_dwordx4 v65, s[32:35], 0 offen lds
  s_nop 0
  v_add_u32_dpp v64, v51, v2 row_newbcast:7 row_mask:0xf bank_mask:0xc
  v_add_u32_dpp v65, v53, v2 row_newbcast:1 row_mask:0xf bank_mask:0x3
  s_nop 1
  v_add_u32_dpp v65, v55, v2 row_newbcast:7 row_mask:0xf bank_mask:0xc
  s_waitcnt vmcnt(10)
  s_barrier
  s_add_u32 m0, s75, 131072
  s_nop 0
  buffer_load_dwordx4 v4, s[44:47], s74 offen lds
  s_add_u32 m0, s75, 132096
  s_nop 0
  buffer_load_dwordx4 v5, s[44:47], s74 offen lds
  s_add_u32 s74, s74, 106496
  s_add_u32 m0, s75, 139264
  s_nop 0
  buffer_load_dwordx4 v4, s[44:47], s74 offen lds
  s_add_u32 m0, s75, 140288
  s_nop 0
  buffer_load_dwordx4 v5, s[44:47], s74 offen lds
  s_add_u32 s74, s74, 106496
  s_add_u32 m0, s76, 81920
  s_nop 0
  buffer_load_dwordx4 v56, s[32:35], 0 offen lds
  s_add_u32 m0, s76, 83968
  v_add_u32_dpp v56, v18, v2 row_newbcast:1 row_mask:0xf bank_mask:0x3
  buffer_load_dwordx4 v57, s[32:35], 0 offen lds
  s_nop 0
  v_add_u32_dpp v56, v16, v2 row_newbcast:8 row_mask:0xf bank_mask:0xc
  s_add_u32 m0, s76, 86016
  v_add_u32_dpp v57, v22, v2 row_newbcast:1 row_mask:0xf bank_mask:0x3
  buffer_load_dwordx4 v58, s[32:35], 0 offen lds
  s_nop 0
  v_add_u32_dpp v57, v20, v2 row_newbcast:8 row_mask:0xf bank_mask:0xc
  s_add_u32 m0, s76, 88064
  v_add_u32_dpp v58, v26, v2 row_newbcast:1 row_mask:0xf bank_mask:0x3
  buffer_load_dwordx4 v59, s[32:35], 0 offen lds
  s_nop 0
  v_add_u32_dpp v58, v24, v2 row_newbcast:8 row_mask:0xf bank_mask:0xc
  s_add_u32 m0, s76, 90112
  v_add_u32_dpp v59, v30, v2 row_newbcast:1 row_mask:0xf bank_mask:0x3
  buffer_load_dwordx4 v60, s[32:35], 0 offen lds
  s_nop 0
  v_add_u32_dpp v59, v28, v2 row_newbcast:8 row_mask:0xf bank_mask:0xc
  s_add_u32 m0, s76, 92160
  v_add_u32_dpp v60, v34, v2 row_newbcast:1 row_mask:0xf bank_mask:0x3
  buffer_load_dwordx4 v61, s[32:35], 0 offen lds
  s_nop 0
  v_add_u32_dpp v60, v32, v2 row_newbcast:8 row_mask:0xf bank_mask:0xc
  s_add_u32 m0, s76, 94208
  v_add_u32_dpp v61, v38, v2 row_newbcast:1 row_mask:0xf bank_mask:0x3
  buffer_load_dwordx4 v62, s[32:35], 0 offen lds
  s_nop 0
  v_add_u32_dpp v61, v36, v2 row_newbcast:8 row_mask:0xf bank_mask:0xc
  s_add_u32 m0, s76, 96256
  v_add_u32_dpp v62, v42, v2 row_newbcast:1 row_mask:0xf bank_mask:0x3
  buffer_load_dwordx4 v63, s[32:35], 0 offen lds
  s_nop 0
  v_add_u32_dpp v62, v40, v2 row_newbcast:8 row_mask:0xf bank_mask:0xc
  s_add_u32 m0, s76, 98304
  v_add_u32_dpp v63, v46, v2 row_newbcast:1 row_mask:0xf bank_mask:0x3
  buffer_load_dwordx4 v64, s[32:35], 0 offen lds
  s_nop 0
  v_add_u32_dpp v63, v44, v2 row_newbcast:8 row_mask:0xf bank_mask:0xc
  s_add_u32 m0, s76, 100352
  v_add_u32_dpp v64, v50, v2 row_newbcast:1 row_mask:0xf bank_mask:0x3
  buffer_load_dwordx4 v65, s[32:35], 0 offen lds
  s_nop 0
  v_add_u32_dpp v64, v48, v2 row_newbcast:8 row_mask:0xf bank_mask:0xc
  v_add_u32_dpp v65, v54, v2 row_newbcast:1 row_mask:0xf bank_mask:0x3
  s_nop 1
  v_add_u32_dpp v65, v52, v2 row_newbcast:8 row_mask:0xf bank_mask:0xc
  s_waitcnt vmcnt(10)
  s_barrier
  s_add_u32 m0, s75, 147456
  s_nop 0
  buffer_load_dwordx4 v4, s[44:47], s74 offen lds
  s_add_u32 m0, s75, 148480
  s_nop 0
  buffer_load_dwordx4 v5, s[44:47], s74 offen lds
  s_add_u32 s74, s74, 106496
  s_add_u32 m0, s75, 155648
  s_nop 0
  buffer_load_dwordx4 v4, s[44:47], s74 offen lds
  s_add_u32 m0, s75, 156672
  s_nop 0
  buffer_load_dwordx4 v5, s[44:47], s74 offen lds
  s_add_u32 s74, s74, 106496
  s_add_u32 m0, s76, 0
  s_nop 0
  buffer_load_dwordx4 v56, s[32:35], 0 offen lds
  s_add_u32 m0, s76, 2048
  v_add_u32_dpp v56, v19, v2 row_newbcast:1 row_mask:0xf bank_mask:0x3
  buffer_load_dwordx4 v57, s[32:35], 0 offen lds
  s_nop 0
  v_add_u32_dpp v56, v17, v2 row_newbcast:8 row_mask:0xf bank_mask:0xc
  s_add_u32 m0, s76, 4096
  v_add_u32_dpp v57, v23, v2 row_newbcast:1 row_mask:0xf bank_mask:0x3
  buffer_load_dwordx4 v58, s[32:35], 0 offen lds
  s_nop 0
  v_add_u32_dpp v57, v21, v2 row_newbcast:8 row_mask:0xf bank_mask:0xc
  s_add_u32 m0, s76, 6144
  v_add_u32_dpp v58, v27, v2 row_newbcast:1 row_mask:0xf bank_mask:0x3
  buffer_load_dwordx4 v59, s[32:35], 0 offen lds
  s_nop 0
  v_add_u32_dpp v58, v25, v2 row_newbcast:8 row_mask:0xf bank_mask:0xc
  s_add_u32 m0, s76, 8192
  v_add_u32_dpp v59, v31, v2 row_newbcast:1 row_mask:0xf bank_mask:0x3
  buffer_load_dwordx4 v60, s[32:35], 0 offen lds
  s_nop 0
  v_add_u32_dpp v59, v29, v2 row_newbcast:8 row_mask:0xf bank_mask:0xc
  s_add_u32 m0, s76, 10240
  v_add_u32_dpp v60, v35, v2 row_newbcast:1 row_mask:0xf bank_mask:0x3
  buffer_load_dwordx4 v61, s[32:35], 0 offen lds
  s_nop 0
  v_add_u32_dpp v60, v33, v2 row_newbcast:8 row_mask:0xf bank_mask:0xc
  s_add_u32 m0, s76, 12288
  v_add_u32_dpp v61, v39, v2 row_newbcast:1 row_mask:0xf bank_mask:0x3
  buffer_load_dwordx4 v62, s[32:35], 0 offen lds
  s_nop 0
  v_add_u32_dpp v61, v37, v2 row_newbcast:8 row_mask:0xf bank_mask:0xc
  s_add_u32 m0, s76, 14336
  v_add_u32_dpp v62, v43, v2 row_newbcast:1 row_mask:0xf bank_mask:0x3
  buffer_load_dwordx4 v63, s[32:35], 0 offen lds
  s_nop 0
  v_add_u32_dpp v62, v41, v2 row_newbcast:8 row_mask:0xf bank_mask:0xc
  s_add_u32 m0, s76, 16384
  v_add_u32_dpp v63, v47, v2 row_newbcast:1 row_mask:0xf bank_mask:0x3
  buffer_load_dwordx4 v64, s[32:35], 0 offen lds
  s_nop 0
  v_add_u32_dpp v63, v45, v2 row_newbcast:8 row_mask:0xf bank_mask:0xc
  s_add_u32 m0, s76, 18432
  v_add_u32_dpp v64, v51, v2 row_newbcast:1 row_mask:0xf bank_mask:0x3
  buffer_load_dwordx4 v65, s[32:35], 0 offen lds
  s_nop 0
  v_add_u32_dpp v64, v49, v2 row_newbcast:8 row_mask:0xf bank_mask:0xc
  v_add_u32_dpp v65, v55, v2 row_newbcast:1 row_mask:0xf bank_mask:0x3
  s_nop 1
  v_add_u32_dpp v65, v53, v2 row_newbcast:8 row_mask:0xf bank_mask:0xc
  s_waitcnt vmcnt(10)
  s_barrier
  s_add_u32 m0, s75, 131072
  s_nop 0
  buffer_load_dwordx4 v4, s[44:47], s74 offen lds
  s_add_u32 m0, s75, 132096
  s_nop 0
  buffer_load_dwordx4 v5, s[44:47], s74 offen lds
  s_add_u32 s74, s74, 106496
  s_add_u32 m0, s75, 139264
  s_nop 0
  buffer_load_dwordx4 v4, s[44:47], s74 offen lds
  s_add_u32 m0, s75, 140288
  s_nop 0
  buffer_load_dwordx4 v5, s[44:47], s74 offen lds
  s_add_u32 s74, s74, 106496
  s_add_u32 m0, s76, 40960
  s_nop 0
  buffer_load_dwordx4 v56, s[32:35], 0 offen lds
  s_add_u32 m0, s76, 43008
  v_add_u32_dpp v56, v16, v2 row_newbcast:2 row_mask:0xf bank_mask:0x3
  buffer_load_dwordx4 v57, s[32:35], 0 offen lds
  s_nop 0
  v_add_u32_dpp v56, v18, v2 row_newbcast:8 row_mask:0xf bank_mask:0xc
  s_add_u32 m0, s76, 45056
  v_add_u32_dpp v57, v20, v2 row_newbcast:2 row_mask:0xf bank_mask:0x3
  buffer_load_dwordx4 v58, s[32:35], 0 offen lds
  s_nop 0
  v_add_u32_dpp v57, v22, v2 row_newbcast:8 row_mask:0xf bank_mask:0xc
  s_add_u32 m0, s76, 47104
  v_add_u32_dpp v58, v24, v2 row_newbcast:2 row_mask:0xf bank_mask:0x3
  buffer_load_dwordx4 v59, s[32:35], 0 offen lds
  s_nop 0
  v_add_u32_dpp v58, v26, v2 row_newbcast:8 row_mask:0xf bank_mask:0xc
  s_add_u32 m0, s76, 49152
  v_add_u32_dpp v59, v28, v2 row_newbcast:2 row_mask:0xf bank_mask:0x3
  buffer_load_dwordx4 v60, s[32:35], 0 offen lds
  s_nop 0
  v_add_u32_dpp v59, v30, v2 row_newbcast:8 row_mask:0xf bank_mask:0xc
  s_add_u32 m0, s76, 51200
  v_add_u32_dpp v60, v32, v2 row_newbcast:2 row_mask:0xf bank_mask:0x3
  buffer_load_dwordx4 v61, s[32:35], 0 offen lds
  s_nop 0
  v_add_u32_dpp v60, v34, v2 row_newbcast:8 row_mask:0xf bank_mask:0xc
  s_add_u32 m0, s76, 53248
  v_add_u32_dpp v61, v36, v2 row_newbcast:2 row_mask:0xf bank_mask:0x3
  buffer_load_dwordx4 v62, s[32:35], 0 offen lds
  s_nop 0
  v_add_u32_dpp v61, v38, v2 row_newbcast:8 row_mask:0xf bank_mask:0xc
  s_add_u32 m0, s76, 55296
  v_add_u32_dpp v62, v40, v2 row_newbcast:2 row_mask:0xf bank_mask:0x3
  buffer_load_dwordx4 v63, s[32:35], 0 offen lds
  s_nop 0
  v_add_u32_dpp v62, v42, v2 row_newbcast:8 row_mask:0xf bank_mask:0xc
  s_add_u32 m0, s76, 57344
  v_add_u32_dpp v63, v44, v2 row_newbcast:2 row_mask:0xf bank_mask:0x3
  buffer_load_dwordx4 v64, s[32:35], 0 offen lds
  s_nop 0
  v_add_u32_dpp v63, v46, v2 row_newbcast:8 row_mask:0xf bank_mask:0xc
  s_add_u32 m0, s76, 59392
  v_add_u32_dpp v64, v48, v2 row_newbcast:2 row_mask:0xf bank_mask:0x3
  buffer_load_dwordx4 v65, s[32:35], 0 offen lds
  s_nop 0
  v_add_u32_dpp v64, v50, v2 row_newbcast:8 row_mask:0xf bank_mask:0xc
  v_add_u32_dpp v65, v52, v2 row_newbcast:2 row_mask:0xf bank_mask:0x3
  s_nop 1
  v_add_u32_dpp v65, v54, v2 row_newbcast:8 row_mask:0xf bank_mask:0xc
  s_waitcnt vmcnt(10)
  s_barrier
  s_add_u32 m0, s75, 147456
  s_nop 0
  buffer_load_dwordx4 v4, s[44:47], s74 offen lds
  s_add_u32 m0, s75, 148480
  s_nop 0
  buffer_load_dwordx4 v5, s[44:47], s74 offen lds
  s_add_u32 s74, s74, 106496
  s_add_u32 m0, s75, 155648
  s_nop 0
  buffer_load_dwordx4 v4, s[44:47], s74 offen lds
  s_add_u32 m0, s75, 156672
  s_nop 0
  buffer_load_dwordx4 v5, s[44:47], s74 offen lds
  s_add_u32 s74, s74, 106496
  s_add_u32 m0, s76, 81920
  s_nop 0
  buffer_load_dwordx4 v56, s[32:35], 0 offen lds
  s_add_u32 m0, s76, 83968
  v_add_u32_dpp v56, v17, v2 row_newbcast:2 row_mask:0xf bank_mask:0x3
  buffer_load_dwordx4 v57, s[32:35], 0 offen lds
  s_nop 0
  v_add_u32_dpp v56, v19, v2 row_newbcast:8 row_mask:0xf bank_mask:0xc
  s_add_u32 m0, s76, 86016
  v_add_u32_dpp v57, v21, v2 row_newbcast:2 row_mask:0xf bank_mask:0x3
  buffer_load_dwordx4 v58, s[32:35], 0 offen lds
  s_nop 0
  v_add_u32_dpp v57, v23, v2 row_newbcast:8 row_mask:0xf bank_mask:0xc
  s_add_u32 m0, s76, 88064
  v_add_u32_dpp v58, v25, v2 row_newbcast:2 row_mask:0xf bank_mask:0x3
  buffer_load_dwordx4 v59, s[32:35], 0 offen lds
  s_nop 0
  v_add_u32_dpp v58, v27, v2 row_newbcast:8 row_mask:0xf bank_mask:0xc
  s_add_u32 m0, s76, 90112
  v_add_u32_dpp v59, v29, v2 row_newbcast:2 row_mask:0xf bank_mask:0x3
  buffer_load_dwordx4 v60, s[32:35], 0 offen lds
  s_nop 0
  v_add_u32_dpp v59, v31, v2 row_newbcast:8 row_mask:0xf bank_mask:0xc
  s_add_u32 m0, s76, 92160
  v_add_u32_dpp v60, v33, v2 row_newbcast:2 row_mask:0xf bank_mask:0x3
  buffer_load_dwordx4 v61, s[32:35], 0 offen lds
  s_nop 0
  v_add_u32_dpp v60, v35, v2 row_newbcast:8 row_mask:0xf bank_mask:0xc
  s_add_u32 m0, s76, 94208
  v_add_u32_dpp v61, v37, v2 row_newbcast:2 row_mask:0xf bank_mask:0x3
  buffer_load_dwordx4 v62, s[32:35], 0 offen lds
  s_nop 0
  v_add_u32_dpp v61, v39, v2 row_newbcast:8 row_mask:0xf bank_mask:0xc
  s_add_u32 m0, s76, 96256
  v_add_u32_dpp v62, v41, v2 row_newbcast:2 row_mask:0xf bank_mask:0x3
  buffer_load_dwordx4 v63, s[32:35], 0 offen lds
  s_nop 0
  v_add_u32_dpp v62, v43, v2 row_newbcast:8 row_mask:0xf bank_mask:0xc
  s_add_u32 m0, s76, 98304
  v_add_u32_dpp v63, v45, v2 row_newbcast:2 row_mask:0xf bank_mask:0x3
  buffer_load_dwordx4 v64, s[32:35], 0 offen lds
  s_nop 0
  v_add_u32_dpp v63, v47, v2 row_newbcast:8 row_mask:0xf bank_mask:0xc
  s_add_u32 m0, s76, 100352
  v_add_u32_dpp v64, v49, v2 row_newbcast:2 row_mask:0xf bank_mask:0x3
  buffer_load_dwordx4 v65, s[32:35], 0 offen lds
  s_nop 0
  v_add_u32_dpp v64, v51, v2 row_newbcast:8 row_mask:0xf bank_mask:0xc
  v_add_u32_dpp v65, v53, v2 row_newbcast:2 row_mask:0xf bank_mask:0x3
  s_nop 1
  v_add_u32_dpp v65, v55, v2 row_newbcast:8 row_mask:0xf bank_mask:0xc
  s_waitcnt vmcnt(10)
  s_barrier
  s_add_u32 m0, s75, 131072
  s_nop 0
  buffer_load_dwordx4 v4, s[44:47], s74 offen lds
  s_add_u32 m0, s75, 132096
  s_nop 0
  buffer_load_dwordx4 v5, s[44:47], s74 offen lds
  s_add_u32 s74, s74, 106496
  s_add_u32 m0, s75, 139264
  s_nop 0
  buffer_load_dwordx4 v4, s[44:47], s74 offen lds
  s_add_u32 m0, s75, 140288
  s_nop 0
  buffer_load_dwordx4 v5, s[44:47], s74 offen lds
  s_add_u32 s74, s74, 106496
  s_add_u32 m0, s76, 0
  s_nop 0
  buffer_load_dwordx4 v56, s[32:35], 0 offen lds
  s_add_u32 m0, s76, 2048
  v_add_u32_dpp v56, v18, v2 row_newbcast:2 row_mask:0xf bank_mask:0x3
  buffer_load_dwordx4 v57, s[32:35], 0 offen lds
  s_nop 0
  v_add_u32_dpp v56, v16, v2 row_newbcast:9 row_mask:0xf bank_mask:0xc
  s_add_u32 m0, s76, 4096
  v_add_u32_dpp v57, v22, v2 row_newbcast:2 row_mask:0xf bank_mask:0x3
  buffer_load_dwordx4 v58, s[32:35], 0 offen lds
  s_nop 0
  v_add_u32_dpp v57, v20, v2 row_newbcast:9 row_mask:0xf bank_mask:0xc
  s_add_u32 m0, s76, 6144
  v_add_u32_dpp v58, v26, v2 row_newbcast:2 row_mask:0xf bank_mask:0x3
  buffer_load_dwordx4 v59, s[32:35], 0 offen lds
  s_nop 0
  v_add_u32_dpp v58, v24, v2 row_newbcast:9 row_mask:0xf bank_mask:0xc
  s_add_u32 m0, s76, 8192
  v_add_u32_dpp v59, v30, v2 row_newbcast:2 row_mask:0xf bank_mask:0x3
  buffer_load_dwordx4 v60, s[32:35], 0 offen lds
  s_nop 0
  v_add_u32_dpp v59, v28, v2 row_newbcast:9 row_mask:0xf bank_mask:0xc
  s_add_u32 m0, s76, 10240
  v_add_u32_dpp v60, v34, v2 row_newbcast:2 row_mask:0xf bank_mask:0x3
  buffer_load_dwordx4 v61, s[32:35], 0 offen lds
  s_nop 0
  v_add_u32_dpp v60, v32, v2 row_newbcast:9 row_mask:0xf bank_mask:0xc
  s_add_u32 m0, s76, 12288
  v_add_u32_dpp v61, v38, v2 row_newbcast:2 row_mask:0xf bank_mask:0x3
  buffer_load_dwordx4 v62, s[32:35], 0 offen lds
  s_nop 0
  v_add_u32_dpp v61, v36, v2 row_newbcast:9 row_mask:0xf bank_mask:0xc
  s_add_u32 m0, s76, 14336
  v_add_u32_dpp v62, v42, v2 row_newbcast:2 row_mask:0xf bank_mask:0x3
  buffer_load_dwordx4 v63, s[32:35], 0 offen lds
  s_nop 0
  v_add_u32_dpp v62, v40, v2 row_newbcast:9 row_mask:0xf bank_mask:0xc
  s_add_u32 m0, s76, 16384
  v_add_u32_dpp v63, v46, v2 row_newbcast:2 row_mask:0xf bank_mask:0x3
  buffer_load_dwordx4 v64, s[32:35], 0 offen lds
  s_nop 0
  v_add_u32_dpp v63, v44, v2 row_newbcast:9 row_mask:0xf bank_mask:0xc
  s_add_u32 m0, s76, 18432
  v_add_u32_dpp v64, v50, v2 row_newbcast:2 row_mask:0xf bank_mask:0x3
  buffer_load_dwordx4 v65, s[32:35], 0 offen lds
  s_nop 0
  v_add_u32_dpp v64, v48, v2 row_newbcast:9 row_mask:0xf bank_mask:0xc
  v_add_u32_dpp v65, v54, v2 row_newbcast:2 row_mask:0xf bank_mask:0x3
  s_nop 1
  v_add_u32_dpp v65, v52, v2 row_newbcast:9 row_mask:0xf bank_mask:0xc
  s_waitcnt vmcnt(10)
  s_barrier
  s_add_u32 m0, s75, 147456
  s_nop 0
  buffer_load_dwordx4 v4, s[44:47], s74 offen lds
  s_add_u32 m0, s75, 148480
  s_nop 0
  buffer_load_dwordx4 v5, s[44:47], s74 offen lds
  s_add_u32 s74, s74, 106496
  s_add_u32 m0, s75, 155648
  s_nop 0
  buffer_load_dwordx4 v4, s[44:47], s74 offen lds
  s_add_u32 m0, s75, 156672
  s_nop 0
  buffer_load_dwordx4 v5, s[44:47], s74 offen lds
  s_add_u32 s74, s74, 106496
  s_add_u32 m0, s76, 40960
  s_nop 0
  buffer_load_dwordx4 v56, s[32:35], 0 offen lds
  s_add_u32 m0, s76, 43008
  v_add_u32_dpp v56, v19, v2 row_newbcast:2 row_mask:0xf bank_mask:0x3
  buffer_load_dwordx4 v57, s[32:35], 0 offen lds
  s_nop 0
  v_add_u32_dpp v56, v17, v2 row_newbcast:9 row_mask:0xf bank_mask:0xc
  s_add_u32 m0, s76, 45056
  v_add_u32_dpp v57, v23, v2 row_newbcast:2 row_mask:0xf bank_mask:0x3
  buffer_load_dwordx4 v58, s[32:35], 0 offen lds
  s_nop 0
  v_add_u32_dpp v57, v21, v2 row_newbcast:9 row_mask:0xf bank_mask:0xc
  s_add_u32 m0, s76, 47104
  v_add_u32_dpp v58, v27, v2 row_newbcast:2 row_mask:0xf bank_mask:0x3
  buffer_load_dwordx4 v59, s[32:35], 0 offen lds
  s_nop 0
  v_add_u32_dpp v58, v25, v2 row_newbcast:9 row_mask:0xf bank_mask:0xc
  s_add_u32 m0, s76, 49152
  v_add_u32_dpp v59, v31, v2 row_newbcast:2 row_mask:0xf bank_mask:0x3
  buffer_load_dwordx4 v60, s[32:35], 0 offen lds
  s_nop 0
  v_add_u32_dpp v59, v29, v2 row_newbcast:9 row_mask:0xf bank_mask:0xc
  s_add_u32 m0, s76, 51200
  v_add_u32_dpp v60, v35, v2 row_newbcast:2 row_mask:0xf bank_mask:0x3
  buffer_load_dwordx4 v61, s[32:35], 0 offen lds
  s_nop 0
  v_add_u32_dpp v60, v33, v2 row_newbcast:9 row_mask:0xf bank_mask:0xc
  s_add_u32 m0, s76, 53248
  v_add_u32_dpp v61, v39, v2 row_newbcast:2 row_mask:0xf bank_mask:0x3
  buffer_load_dwordx4 v62, s[32:35], 0 offen lds
  s_nop 0
  v_add_u32_dpp v61, v37, v2 row_newbcast:9 row_mask:0xf bank_mask:0xc
  s_add_u32 m0, s76, 55296
  v_add_u32_dpp v62, v43, v2 row_newbcast:2 row_mask:0xf bank_mask:0x3
  buffer_load_dwordx4 v63, s[32:35], 0 offen lds
  s_nop 0
  v_add_u32_dpp v62, v41, v2 row_newbcast:9 row_mask:0xf bank_mask:0xc
  s_add_u32 m0, s76, 57344
  v_add_u32_dpp v63, v47, v2 row_newbcast:2 row_mask:0xf bank_mask:0x3
  buffer_load_dwordx4 v64, s[32:35], 0 offen lds
  s_nop 0
  v_add_u32_dpp v63, v45, v2 row_newbcast:9 row_mask:0xf bank_mask:0xc
  s_add_u32 m0, s76, 59392
  v_add_u32_dpp v64, v51, v2 row_newbcast:2 row_mask:0xf bank_mask:0x3
  buffer_load_dwordx4 v65, s[32:35], 0 offen lds
  s_nop 0
  v_add_u32_dpp v64, v49, v2 row_newbcast:9 row_mask:0xf bank_mask:0xc
  v_add_u32_dpp v65, v55, v2 row_newbcast:2 row_mask:0xf bank_mask:0x3
  s_nop 1
  v_add_u32_dpp v65, v53, v2 row_newbcast:9 row_mask:0xf bank_mask:0xc
  s_waitcnt vmcnt(10)
  s_cmp_lg_u32 s72, 1
  s_cbranch_scc1 L_nolpf
  s_mov_b64 exec, 1048575
  global_load_dword v10, v[8:9], off
  s_mov_b64 exec, -1
  s_mov_b32 m0, 123136
  s_mov_b64 exec, 0xffff
  buffer_load_dwordx4 v11, s[52:55], s77 offen lds
  s_mov_b64 exec, -1
L_nolpf:
  s_barrier
  s_add_u32 m0, s75, 131072
  s_nop 0
  buffer_load_dwordx4 v4, s[44:47], s74 offen lds
  s_add_u32 m0, s75, 132096
  s_nop 0
  buffer_load_dwordx4 v5, s[44:47], s74 offen lds
  s_add_u32 s74, s74, 106496
  s_add_u32 m0, s75, 139264
  s_nop 0
  buffer_load_dwordx4 v4, s[44:47], s74 offen lds
  s_add_u32 m0, s75, 140288
  s_nop 0
  buffer_load_dwordx4 v5, s[44:47], s74 offen lds
  s_add_u32 s74, s74, 106496
  s_add_u32 m0, s76, 81920
  s_nop 0
  buffer_load_dwordx4 v56, s[32:35], 0 offen lds
  s_add_u32 m0, s76, 83968
  v_add_u32_dpp v56, v16, v2 row_newbcast:3 row_mask:0xf bank_mask:0x3
  buffer_load_dwordx4 v57, s[32:35], 0 offen lds
  s_nop 0
  v_add_u32_dpp v56, v18, v2 row_newbcast:9 row_mask:0xf bank_mask:0xc
  s_add_u32 m0, s76, 86016
  v_add_u32_dpp v57, v20, v2 row_newbcast:3 row_mask:0xf bank_mask:0x3
  buffer_load_dwordx4 v58, s[32:35], 0 offen lds
  s_nop 0
  v_add_u32_dpp v57, v22, v2 row_newbcast:9 row_mask:0xf bank_mask:0xc
  s_add_u32 m0, s76, 88064
  v_add_u32_dpp v58, v24, v2 row_newbcast:3 row_mask:0xf bank_mask:0x3
  buffer_load_dwordx4 v59, s[32:35], 0 offen lds
  s_nop 0
  v_add_u32_dpp v58, v26, v2 row_newbcast:9 row_mask:0xf bank_mask:0xc
  s_add_u32 m0, s76, 90112
  v_add_u32_dpp v59, v28, v2 row_newbcast:3 row_mask:0xf bank_mask:0x3
  buffer_load_dwordx4 v60, s[32:35], 0 offen lds
  s_nop 0
  v_add_u32_dpp v59, v30, v2 row_newbcast:9 row_mask:0xf bank_mask:0xc
  s_add_u32 m0, s76, 92160
  v_add_u32_dpp v60, v32, v2 row_newbcast:3 row_mask:0xf bank_mask:0x3
  buffer_load_dwordx4 v61, s[32:35], 0 offen lds
  s_nop 0
  v_add_u32_dpp v60, v34, v2 row_newbcast:9 row_mask:0xf bank_mask:0xc
  s_add_u32 m0, s76, 94208
  v_add_u32_dpp v61, v36, v2 row_newbcast:3 row_mask:0xf bank_mask:0x3
  buffer_load_dwordx4 v62, s[32:35], 0 offen lds
  s_nop 0
  v_add_u32_dpp v61, v38, v2 row_newbcast:9 row_mask:0xf bank_mask:0xc
  s_add_u32 m0, s76, 96256
  v_add_u32_dpp v62, v40, v2 row_newbcast:3 row_mask:0xf bank_mask:0x3
  buffer_load_dwordx4 v63, s[32:35], 0 offen lds
  s_nop 0
  v_add_u32_dpp v62, v42, v2 row_newbcast:9 row_mask:0xf bank_mask:0xc
  s_add_u32 m0, s76, 98304
  v_add_u32_dpp v63, v44, v2 row_newbcast:3 row_mask:0xf bank_mask:0x3
  buffer_load_dwordx4 v64, s[32:35], 0 offen lds
  s_nop 0
  v_add_u32_dpp v63, v46, v2 row_newbcast:9 row_mask:0xf bank_mask:0xc
  s_add_u32 m0, s76, 100352
  v_add_u32_dpp v64, v48, v2 row_newbcast:3 row_mask:0xf bank_mask:0x3
  buffer_load_dwordx4 v65, s[32:35], 0 offen lds
  s_nop 0
  v_add_u32_dpp v64, v50, v2 row_newbcast:9 row_mask:0xf bank_mask:0xc
  v_add_u32_dpp v65, v52, v2 row_newbcast:3 row_mask:0xf bank_mask:0x3
  s_nop 1
  v_add_u32_dpp v65, v54, v2 row_newbcast:9 row_mask:0xf bank_mask:0xc
  s_waitcnt vmcnt(10)
  s_barrier
  s_add_u32 m0, s75, 147456
  s_nop 0
  buffer_load_dwordx4 v4, s[44:47], s74 offen lds
  s_add_u32 m0, s75, 148480
  s_nop 0
  buffer_load_dwordx4 v5, s[44:47], s74 offen lds
  s_add_u32 s74, s74, 106496
  s_add_u32 m0, s75, 155648
  s_nop 0
  buffer_load_dwordx4 v4, s[44:47], s74 offen lds
  s_add_u32 m0, s75, 156672
  s_nop 0
  buffer_load_dwordx4 v5, s[44:47], s74 offen lds
  s_add_u32 s74, s74, 106496
  s_add_u32 m0, s76, 0
  s_nop 0
  buffer_load_dwordx4 v56, s[32:35], 0 offen lds
  s_add_u32 m0, s76, 2048
  v_add_u32_dpp v56, v17, v2 row_newbcast:3 row_mask:0xf bank_mask:0x3
  buffer_load_dwordx4 v57, s[32:35], 0 offen lds
  s_nop 0
  v_add_u32_dpp v56, v19, v2 row_newbcast:9 row_mask:0xf bank_mask:0xc
  s_add_u32 m0, s76, 4096
  v_add_u32_dpp v57, v21, v2 row_newbcast:3 row_mask:0xf bank_mask:0x3
  buffer_load_dwordx4 v58, s[32:35], 0 offen lds
  s_nop 0
  v_add_u32_dpp v57, v23, v2 row_newbcast:9 row_mask:0xf bank_mask:0xc
  s_add_u32 m0, s76, 6144
  v_add_u32_dpp v58, v25, v2 row_newbcast:3 row_mask:0xf bank_mask:0x3
  buffer_load_dwordx4 v59, s[32:35], 0 offen lds
  s_nop 0
  v_add_u32_dpp v58, v27, v2 row_newbcast:9 row_mask:0xf bank_mask:0xc
  s_add_u32 m0, s76, 8192
  v_add_u32_dpp v59, v29, v2 row_newbcast:3 row_mask:0xf bank_mask:0x3
  buffer_load_dwordx4 v60, s[32:35], 0 offen lds
  s_nop 0
  v_add_u32_dpp v59, v31, v2 row_newbcast:9 row_mask:0xf bank_mask:0xc
  s_add_u32 m0, s76, 10240
  v_add_u32_dpp v60, v33, v2 row_newbcast:3 row_mask:0xf bank_mask:0x3
  buffer_load_dwordx4 v61, s[32:35], 0 offen lds
  s_nop 0
  v_add_u32_dpp v60, v35, v2 row_newbcast:9 row_mask:0xf bank_mask:0xc
  s_add_u32 m0, s76, 12288
  v_add_u32_dpp v61, v37, v2 row_newbcast:3 row_mask:0xf bank_mask:0x3
  buffer_load_dwordx4 v62, s[32:35], 0 offen lds
  s_nop 0
  v_add_u32_dpp v61, v39, v2 row_newbcast:9 row_mask:0xf bank_mask:0xc
  s_add_u32 m0, s76, 14336
  v_add_u32_dpp v62, v41, v2 row_newbcast:3 row_mask:0xf bank_mask:0x3
  buffer_load_dwordx4 v63, s[32:35], 0 offen lds
  s_nop 0
  v_add_u32_dpp v62, v43, v2 row_newbcast:9 row_mask:0xf bank_mask:0xc
  s_add_u32 m0, s76, 16384
  v_add_u32_dpp v63, v45, v2 row_newbcast:3 row_mask:0xf bank_mask:0x3
  buffer_load_dwordx4 v64, s[32:35], 0 offen lds
  s_nop 0
  v_add_u32_dpp v63, v47, v2 row_newbcast:9 row_mask:0xf bank_mask:0xc
  s_add_u32 m0, s76, 18432
  v_add_u32_dpp v64, v49, v2 row_newbcast:3 row_mask:0xf bank_mask:0x3
  buffer_load_dwordx4 v65, s[32:35], 0 offen lds
  s_nop 0
  v_add_u32_dpp v64, v51, v2 row_newbcast:9 row_mask:0xf bank_mask:0xc
  v_add_u32_dpp v65, v53, v2 row_newbcast:3 row_mask:0xf bank_mask:0x3
  s_nop 1
  v_add_u32_dpp v65, v55, v2 row_newbcast:9 row_mask:0xf bank_mask:0xc
  s_waitcnt vmcnt(10)
  s_barrier
  s_add_u32 m0, s75, 131072
  s_nop 0
  buffer_load_dwordx4 v4, s[44:47], s74 offen lds
  s_add_u32 m0, s75, 132096
  s_nop 0
  buffer_load_dwordx4 v5, s[44:47], s74 offen lds
  s_add_u32 s74, s74, 106496
  s_add_u32 m0, s75, 139264
  s_nop 0
  buffer_load_dwordx4 v4, s[44:47], s74 offen lds
  s_add_u32 m0, s75, 140288
  s_nop 0
  buffer_load_dwordx4 v5, s[44:47], s74 offen lds
  s_add_u32 s74, s74, 106496
  s_add_u32 m0, s76, 40960
  s_nop 0
  buffer_load_dwordx4 v56, s[32:35], 0 offen lds
  s_add_u32 m0, s76, 43008
  v_add_u32_dpp v56, v18, v2 row_newbcast:3 row_mask:0xf bank_mask:0x3
  buffer_load_dwordx4 v57, s[32:35], 0 offen lds
  s_nop 0
  v_add_u32_dpp v56, v16, v2 row_newbcast:10 row_mask:0xf bank_mask:0xc
  s_add_u32 m0, s76, 45056
  v_add_u32_dpp v57, v22, v2 row_newbcast:3 row_mask:0xf bank_mask:0x3
  buffer_load_dwordx4 v58, s[32:35], 0 offen lds
  s_nop 0
  v_add_u32_dpp v57, v20, v2 row_newbcast:10 row_mask:0xf bank_mask:0xc
  s_add_u32 m0, s76, 47104
  v_add_u32_dpp v58, v26, v2 row_newbcast:3 row_mask:0xf bank_mask:0x3
  buffer_load_dwordx4 v59, s[32:35], 0 offen lds
  s_nop 0
  v_add_u32_dpp v58, v24, v2 row_newbcast:10 row_mask:0xf bank_mask:0xc
  s_add_u32 m0, s76, 49152
  v_add_u32_dpp v59, v30, v2 row_newbcast:3 row_mask:0xf bank_mask:0x3
  buffer_load_dwordx4 v60, s[32:35], 0 offen lds
  s_nop 0
  v_add_u32_dpp v59, v28, v2 row_newbcast:10 row_mask:0xf bank_mask:0xc
  s_add_u32 m0, s76, 51200
  v_add_u32_dpp v60, v34, v2 row_newbcast:3 row_mask:0xf bank_mask:0x3
  buffer_load_dwordx4 v61, s[32:35], 0 offen lds
  s_nop 0
  v_add_u32_dpp v60, v32, v2 row_newbcast:10 row_mask:0xf bank_mask:0xc
  s_add_u32 m0, s76, 53248
  v_add_u32_dpp v61, v38, v2 row_newbcast:3 row_mask:0xf bank_mask:0x3
  buffer_load_dwordx4 v62, s[32:35], 0 offen lds
  s_nop 0
  v_add_u32_dpp v61, v36, v2 row_newbcast:10 row_mask:0xf bank_mask:0xc
  s_add_u32 m0, s76, 55296
  v_add_u32_dpp v62, v42, v2 row_newbcast:3 row_mask:0xf bank_mask:0x3
  buffer_load_dwordx4 v63, s[32:35], 0 offen lds
  s_nop 0
  v_add_u32_dpp v62, v40, v2 row_newbcast:10 row_mask:0xf bank_mask:0xc
  s_add_u32 m0, s76, 57344
  v_add_u32_dpp v63, v46, v2 row_newbcast:3 row_mask:0xf bank_mask:0x3
  buffer_load_dwordx4 v64, s[32:35], 0 offen lds
  s_nop 0
  v_add_u32_dpp v63, v44, v2 row_newbcast:10 row_mask:0xf bank_mask:0xc
  s_add_u32 m0, s76, 59392
  v_add_u32_dpp v64, v50, v2 row_newbcast:3 row_mask:0xf bank_mask:0x3
  buffer_load_dwordx4 v65, s[32:35], 0 offen lds
  s_nop 0
  v_add_u32_dpp v64, v48, v2 row_newbcast:10 row_mask:0xf bank_mask:0xc
  v_add_u32_dpp v65, v54, v2 row_newbcast:3 row_mask:0xf bank_mask:0x3
  s_nop 1
  v_add_u32_dpp v65, v52, v2 row_newbcast:10 row_mask:0xf bank_mask:0xc
  v_mov_b32_dpp v16, v16 row_shl:3 row_mask:0xf bank_mask:0xf
  v_mov_b32_dpp v18, v18 row_shl:3 row_mask:0xf bank_mask:0xf
  v_mov_b32_dpp v20, v20 row_shl:3 row_mask:0xf bank_mask:0xf
  v_mov_b32_dpp v22, v22 row_shl:3 row_mask:0xf bank_mask:0xf
  v_mov_b32_dpp v24, v24 row_shl:3 row_mask:0xf bank_mask:0xf
  v_mov_b32_dpp v26, v26 row_shl:3 row_mask:0xf bank_mask:0xf
  v_mov_b32_dpp v28, v28 row_shl:3 row_mask:0xf bank_mask:0xf
  v_mov_b32_dpp v30, v30 row_shl:3 row_mask:0xf bank_mask:0xf
  v_mov_b32_dpp v32, v32 row_shl:3 row_mask:0xf bank_mask:0xf
  v_mov_b32_dpp v34, v34 row_shl:3 row_mask:0xf bank_mask:0xf
  v_mov_b32_dpp v36, v36 row_shl:3 row_mask:0xf bank_mask:0xf
  v_mov_b32_dpp v38, v38 row_shl:3 row_mask:0xf bank_mask:0xf
  v_mov_b32_dpp v40, v40 row_shl:3 row_mask:0xf bank_mask:0xf
  v_mov_b32_dpp v42, v42 row_shl:3 row_mask:0xf bank_mask:0xf
  v_mov_b32_dpp v44, v44 row_shl:3 row_mask:0xf bank_mask:0xf
  v_mov_b32_dpp v46, v46 row_shl:3 row_mask:0xf bank_mask:0xf
  v_mov_b32_dpp v48, v48 row_shl:3 row_mask:0xf bank_mask:0xf
  v_mov_b32_dpp v50, v50 row_shl:3 row_mask:0xf bank_mask:0xf
  v_mov_b32_dpp v52, v52 row_shl:3 row_mask:0xf bank_mask:0xf
  v_mov_b32_dpp v54, v54 row_shl:3 row_mask:0xf bank_mask:0xf
  s_waitcnt vmcnt(10)
  s_barrier
  s_add_u32 m0, s75, 147456
  s_nop 0
  buffer_load_dwordx4 v4, s[44:47], s74 offen lds
  s_add_u32 m0, s75, 148480
  s_nop 0
  buffer_load_dwordx4 v5, s[44:47], s74 offen lds
  s_add_u32 s74, s74, 106496
  s_add_u32 m0, s75, 155648
  s_nop 0
  buffer_load_dwordx4 v4, s[44:47], s74 offen lds
  s_add_u32 m0, s75, 156672
  s_nop 0
  buffer_load_dwordx4 v5, s[44:47], s74 offen lds
  s_add_u32 s74, s74, 106496
  s_add_u32 m0, s76, 81920
  s_nop 0
  buffer_load_dwordx4 v56, s[32:35], 0 offen lds
  s_add_u32 m0, s76, 83968
  v_add_u32_dpp v56, v19, v2 row_newbcast:3 row_mask:0xf bank_mask:0x3
  buffer_load_dwordx4 v57, s[32:35], 0 offen lds
  s_nop 0
  v_add_u32_dpp v56, v17, v2 row_newbcast:10 row_mask:0xf bank_mask:0xc
  s_add_u32 m0, s76, 86016
  v_add_u32_dpp v57, v23, v2 row_newbcast:3 row_mask:0xf bank_mask:0x3
  buffer_load_dwordx4 v58, s[32:35], 0 offen lds
  s_nop 0
  v_add_u32_dpp v57, v21, v2 row_newbcast:10 row_mask:0xf bank_mask:0xc
  s_add_u32 m0, s76, 88064
  v_add_u32_dpp v58, v27, v2 row_newbcast:3 row_mask:0xf bank_mask:0x3
  buffer_load_dwordx4 v59, s[32:35], 0 offen lds
  s_nop 0
  v_add_u32_dpp v58, v25, v2 row_newbcast:10 row_mask:0xf bank_mask:0xc
  s_add_u32 m0, s76, 90112
  v_add_u32_dpp v59, v31, v2 row_newbcast:3 row_mask:0xf bank_mask:0x3
  buffer_load_dwordx4 v60, s[32:35], 0 offen lds
  s_nop 0
  v_add_u32_dpp v59, v29, v2 row_newbcast:10 row_mask:0xf bank_mask:0xc
  s_add_u32 m0, s76, 92160
  v_add_u32_dpp v60, v35, v2 row_newbcast:3 row_mask:0xf bank_mask:0x3
  buffer_load_dwordx4 v61, s[32:35], 0 offen lds
  s_nop 0
  v_add_u32_dpp v60, v33, v2 row_newbcast:10 row_mask:0xf bank_mask:0xc
  s_add_u32 m0, s76, 94208
  v_add_u32_dpp v61, v39, v2 row_newbcast:3 row_mask:0xf bank_mask:0x3
  buffer_load_dwordx4 v62, s[32:35], 0 offen lds
  s_nop 0
  v_add_u32_dpp v61, v37, v2 row_newbcast:10 row_mask:0xf bank_mask:0xc
  s_add_u32 m0, s76, 96256
  v_add_u32_dpp v62, v43, v2 row_newbcast:3 row_mask:0xf bank_mask:0x3
  buffer_load_dwordx4 v63, s[32:35], 0 offen lds
  s_nop 0
  v_add_u32_dpp v62, v41, v2 row_newbcast:10 row_mask:0xf bank_mask:0xc
  s_add_u32 m0, s76, 98304
  v_add_u32_dpp v63, v47, v2 row_newbcast:3 row_mask:0xf bank_mask:0x3
  buffer_load_dwordx4 v64, s[32:35], 0 offen lds
  s_nop 0
  v_add_u32_dpp v63, v45, v2 row_newbcast:10 row_mask:0xf bank_mask:0xc
  s_add_u32 m0, s76, 100352
  v_add_u32_dpp v64, v51, v2 row_newbcast:3 row_mask:0xf bank_mask:0x3
  buffer_load_dwordx4 v65, s[32:35], 0 offen lds
  s_nop 0
  v_add_u32_dpp v64, v49, v2 row_newbcast:10 row_mask:0xf bank_mask:0xc
  v_add_u32_dpp v65, v55, v2 row_newbcast:3 row_mask:0xf bank_mask:0x3
  s_nop 1
  v_add_u32_dpp v65, v53, v2 row_newbcast:10 row_mask:0xf bank_mask:0xc
  v_mov_b32_dpp v17, v17 row_shl:3 row_mask:0xf bank_mask:0xf
  v_mov_b32_dpp v19, v19 row_shl:3 row_mask:0xf bank_mask:0xf
  v_mov_b32_dpp v21, v21 row_shl:3 row_mask:0xf bank_mask:0xf
  v_mov_b32_dpp v23, v23 row_shl:3 row_mask:0xf bank_mask:0xf
  v_mov_b32_dpp v25, v25 row_shl:3 row_mask:0xf bank_mask:0xf
  v_mov_b32_dpp v27, v27 row_shl:3 row_mask:0xf bank_mask:0xf
  v_mov_b32_dpp v29, v29 row_shl:3 row_mask:0xf bank_mask:0xf
  v_mov_b32_dpp v31, v31 row_shl:3 row_mask:0xf bank_mask:0xf
  v_mov_b32_dpp v33, v33 row_shl:3 row_mask:0xf bank_mask:0xf
  v_mov_b32_dpp v35, v35 row_shl:3 row_mask:0xf bank_mask:0xf
  v_mov_b32_dpp v37, v37 row_shl:3 row_mask:0xf bank_mask:0xf
  v_mov_b32_dpp v39, v39 row_shl:3 row_mask:0xf bank_mask:0xf
  v_mov_b32_dpp v41, v41 row_shl:3 row_mask:0xf bank_mask:0xf
  v_mov_b32_dpp v43, v43 row_shl:3 row_mask:0xf bank_mask:0xf
  v_mov_b32_dpp v45, v45 row_shl:3 row_mask:0xf bank_mask:0xf
  v_mov_b32_dpp v47, v47 row_shl:3 row_mask:0xf bank_mask:0xf
  v_mov_b32_dpp v49, v49 row_shl:3 row_mask:0xf bank_mask:0xf
  v_mov_b32_dpp v51, v51 row_shl:3 row_mask:0xf bank_mask:0xf
  v_mov_b32_dpp v53, v53 row_shl:3 row_mask:0xf bank_mask:0xf
  v_mov_b32_dpp v55, v55 row_shl:3 row_mask:0xf bank_mask:0xf
  s_add_u32 s72, s72, 1
  s_cmp_lt_u32 s72, 2
  s_waitcnt vmcnt(10)
  s_cbranch_scc1 L_dnn_loop1
  s_branch L_ld_tail
L_cin:
  v_lshlrev_b32 v1, 4, v0
  s_and_b32 s79, s3, 3
  s_lshr_b32 s84, s3, 2
  s_lshl_b32 s95, s79, 10
  s_mul_i32 s26, s68, 11
  s_add_u32 s26, s26, s69
  s_sub_u32 s26, s26, 22
  s_cmp_eq_u32 s26, 86
  s_cbranch_scc1 L_end
  s_cmp_eq_u32 s84, 0
  s_cbranch_scc1 L_sc
  s_setprio 2
  v_add_u32 v2, L_tables-L_pc+4096, v1
  v_mov_b32_e64 v3, s93
  v_add_co_u32 v2, vcc, s92, v2
  s_nop 1
  v_addc_co_u32 v3, vcc, 0, v3, vcc
  v_add_co_u32 v32, vcc, s95, v2
  s_nop 1
  v_addc_co_u32 v33, vcc, 0, v3, vcc
  global_load_dwordx4 v[224:227], v[2:3], off offset:-4096
  v_add_co_u32 v2, vcc, 0x1800, v2
  s_nop 1
  v_addc_co_u32 v3, vcc, 0, v3, vcc
  global_load_dwordx4 v[240:243], v[2:3], off
  s_cmp_lt_u32 s79, 3
  s_mov_b32 s70, 122176
  s_cselect_b32 s70, 81920, s70
  s_add_u32 m0, s95, 81920
  s_nop 0
  global_load_lds_dwordx4 v[32:33], off offset:-4096
  s_add_u32 m0, s95, s70
  s_nop 0
  global_load_lds_dwordx4 v[32:33], off offset:0
  v_add_co_u32 v32, vcc, 0x2000, v32
  s_nop 1
  v_addc_co_u32 v33, vcc, 0, v33, vcc
  s_add_u32 m0, s95, 2048
  s_nop 0
  global_load_lds_dwordx4 v[32:33], off offset:0
  s_add_u32 m0, s95, 130368
  s_cmp_ge_u32 s79, 2
  s_cbranch_scc1 L_sc
  global_load_lds_dwordx4 v[32:33], off offset:-4096
L_sc:
  s_mul_i32 s85, s84, 20
  s_add_u32 s85, s85, s3
  s_mul_i32 s94, s26, 48
  s_add_u32 s94, s94, s85
  s_mul_i32 s94, s94, 104
  v_lshrrev_b32 v30, 3, v0
  v_lshlrev_b32_e64 v30, 4, v30
  v_and_b32 v29, 0x70, v1
  s_mul_i32 s76, s3, 4064
  s_add_u32 s76, s76, 131136
  s_cmp_eq_u32 s84, 0
  s_cbranch_scc1 L_g0
  s_waitcnt lgkmcnt(0)
  s_mov_b32 s40, s10
  s_and_b32 s41, s11, 0xffff
  s_mov_b32 s42, 156
  s_mov_b32 s43, 0x20000
  s_mov_b32 m0, 129472
  s_mov_b64 exec, 0x7ff
  buffer_load_dwordx4 v1, s[40:43], 0 offen lds
  s_mov_b64 exec, -1
  s_lshl_b32 s85, s85, 2
  s_add_u32 s85, s85, 129728
  s_mul_i32 s72, s84, 3
  s_sub_u32 s72, 4, s72
  s_cmp_eq_u32 s26, 85
  s_cselect_b32 s72, s72, 6
  s_lshl_b32 s44, s3, 7
  s_mul_i32 s45, s3, 5280
  s_lshl_b32 s46, s3, 2
  s_lshl_b32 s47, s3, 1
  s_lshl_b32 s82, s3, 12
  s_and_b32 s98, s3, 1
  s_lshr_b32 s99, s3, 1
  s_mul_i32 s68, s99, 3072
  s_lshl_b32 s83, s98, 3
  s_add_u32 s68, s68, s83
  v_add_u32 v59, s68, v1
  s_lshl_b32 s69, s99, 3
  s_lshr_b32 s69, 0x05030200, s69
  s_and_b32 s69, s69, 0xff
  s_lshl_b32 s69, s69, 9
  s_lshl_b32 s70, s98, 2
  s_add_u32 s101, s69, s70
  s_mov_b32 s99, 0x05040100
  s_mov_b32 s100, 0x07060302
  v_mov_b32 v2, 129664
  v_mov_b32 v109, 0
  v_mov_b32 v108, 0
  v_mov_b64 v[32:33], 0
  v_mov_b64 v[34:35], 0
  v_mov_b64 v[36:37], 0
  v_mov_b64 v[38:39], 0
  v_mov_b64 v[40:41], 0
  v_mov_b64 v[42:43], 0
  v_mov_b64 v[44:45], 0
  v_mov_b64 v[46:47], 0
  v_mov_b64 v[48:49], 0
  v_mov_b64 v[50:51], 0
  v_mov_b64 v[52:53], 0
  v_mov_b64 v[54:55], 0
  v_mov_b64 v[56:57], 0
  v_add_u32 v14, 77824, v1
  v_add_u32 v15, 125248, v1
  v_lshrrev_b32_e64 v3, 5, v0
  v_lshl_add_u32 v3, v3, 2, v2
  s_mov_b32 s28, s4
  s_and_b32 s29, s5, 0xffff
  s_mov_b32 s30, 425984
  s_mov_b32 s31, 0x20000
  s_mov_b32 s32, s6
  s_and_b32 s33, s7, 0xffff
  s_mov_b32 s34, 12800000
  s_mov_b32 s35, 0x20000
  ds_write_b128 v2, v[32:35] offset:16
  s_lshl_b32 s68, s79, 6
  v_add_u32 v29, s68, v0
  v_mul_u32_u24 v30, 2521, v29
  v_lshrrev_b32 v30, 16, v30
  v_mul_u32_u24 v30, 12, v30
  v_lshl_add_u32 v28, v29, 1, v30
  v_add_u32 v29, 256, v29
  v_mul_u32_u24 v30, 2521, v29
  v_lshrrev_b32 v30, 16, v30
  v_mul_u32_u24_e64 v30, 12, v30
  v_lshl_add_u32 v58, v29, 1, v30
  v_add_u32 v29, 256, v29
  v_mul_u32_u24 v30, 2521, v29
  v_lshrrev_b32 v30, 16, v30
  v_mul_u32_u24 v30, 12, v30
  v_lshl_add_u32 v111, v29, 1, v30
  v_cmp_gt_u32 vcc, 676, v29
  s_nop 0
  s_mov_b64 s[92:93], vcc
  v_lshlrev_b32_e64 v29, 3, v0
  s_mov_b32 exec_hi, 0xffff
  ds_write_b64 v29, v[32:33] offset:1664
  s_mov_b32 exec_hi, -1
  s_waitcnt vmcnt(4)
  ds_write_b32 v243, v32
  ds_write_b32 v243, v32 offset:43328
  s_waitcnt vmcnt(0)
  ds_read_b64 v[112:113], v240 offset:0
  ds_read_b64 v[114:115], v240 offset:8
  ds_read_b64 v[116:117], v240 offset:32
  ds_read_b64 v[118:119], v240 offset:40
  ds_read_u16 v110, v241
  s_mov_b64 exec, 0x3ffffff
  s_waitcnt lgkmcnt(0)
  ds_write_b16 v242, v110
  v_lshlrev_b32 v109, 17, v110
  v_lshrrev_b32 v109, 1, v109
  s_mov_b64 exec, -1
  v_add_u32 v225, s44, v225
  v_add_u32 v226, s44, v226
  v_add_u32 v227, s44, v227
  s_waitcnt lgkmcnt(0)
  s_barrier
  ds_read_b64_tr_b16 v[60:61], v225 offset:35328
  ds_read_b64_tr_b16 v[62:63], v225 offset:40736
  ds_read_b64_tr_b16 v[64:65], v226 offset:35328
  ds_read_b64_tr_b16 v[66:67], v227 offset:35328
  ds_read_b64_tr_b16 v[68:69], v225 offset:35392
  ds_read_b64_tr_b16 v[70:71], v225 offset:40800
  ds_read_b64_tr_b16 v[72:73], v226 offset:35392
  ds_read_b64_tr_b16 v[74:75], v227 offset:35392
  ds_read_b64_tr_b16 v[76:77], v225 offset:35840
  ds_read_b64_tr_b16 v[78:79], v225 offset:41248
  ds_read_b64_tr_b16 v[80:81], v226 offset:35840
  ds_read_b64_tr_b16 v[82:83], v227 offset:35840
  ds_read_b64_tr_b16 v[84:85], v225 offset:35904
  ds_read_b64_tr_b16 v[86:87], v225 offset:41312
  ds_read_b64_tr_b16 v[88:89], v226 offset:35904
  ds_read_b64_tr_b16 v[90:91], v227 offset:35904
  s_waitcnt lgkmcnt(14)
  v_mfma_f32_32x32x16_bf16 v[120:135], v[112:115], v[60:63], 0
  s_waitcnt lgkmcnt(12)
  v_mfma_f32_32x32x16_bf16 v[120:135], v[116:119], v[64:67], v[120:135]
  ds_read_b64_tr_b16 v[92:93], v225 offset:36352
  ds_read_b64_tr_b16 v[94:95], v225 offset:41760
  ds_read_b64_tr_b16 v[96:97], v226 offset:36352
  ds_read_b64_tr_b16 v[98:99], v227 offset:36352
  s_waitcnt lgkmcnt(14)
  v_mfma_f32_32x32x16_bf16 v[136:151], v[112:115], v[68:71], 0
  s_waitcnt lgkmcnt(12)
  v_mfma_f32_32x32x16_bf16 v[136:151], v[116:119], v[72:75], v[136:151]
  ds_read_b64_tr_b16 v[100:101], v225 offset:36416
  ds_read_b64_tr_b16 v[102:103], v225 offset:41824
  ds_read_b64_tr_b16 v[104:105], v226 offset:36416
  ds_read_b64_tr_b16 v[106:107], v227 offset:36416
  s_waitcnt lgkmcnt(14)
  v_mfma_f32_32x32x16_bf16 v[152:167], v[112:115], v[76:79], 0
  s_waitcnt lgkmcnt(12)
  v_mfma_f32_32x32x16_bf16 v[152:167], v[116:119], v[80:83], v[152:167]
  s_waitcnt lgkmcnt(10)
  v_mfma_f32_32x32x16_bf16 v[168:183], v[112:115], v[84:87], 0
  s_waitcnt lgkmcnt(8)
  v_mfma_f32_32x32x16_bf16 v[168:183], v[116:119], v[88:91], v[168:183]
  ds_read_b128 v[228:231], v14 offset:6144
  ds_read_b128 v[232:235], v15 offset:0
  ds_read_b128 v[4:7], v14 offset:3072
  ds_read_b128 v[8:11], v15 offset:2048
  ds_read_b128 v[20:23], v14 offset:1024
  ds_read_b128 v[24:27], v14 offset:2048
  ds_read_b128 v[216:219], v14 offset:4096
  ds_read_b128 v[220:223], v14 offset:5120
  ds_read_b128 v[236:239], v15 offset:1024
  s_waitcnt lgkmcnt(14)
  v_mfma_f32_32x32x16_bf16 v[184:199], v[112:115], v[92:95], 0
  s_waitcnt lgkmcnt(13)
  v_mfma_f32_32x32x16_bf16 v[184:199], v[116:119], v[96:99], v[184:199]
  s_waitcnt lgkmcnt(11)
  v_mfma_f32_32x32x16_bf16 v[200:215], v[112:115], v[100:103], 0
  s_waitcnt lgkmcnt(9)
  v_mfma_f32_32x32x16_bf16 v[200:215], v[116:119], v[104:107], v[200:215]
  s_waitcnt lgkmcnt(8)
  v_add_u32 v228, s46, v228
  v_add_u32 v229, s46, v229
  v_add_u32 v231, s83, v231
  v_add_u32 v230, s101, v230
  s_waitcnt lgkmcnt(7)
  v_mad_u32_u24 v232, v233, s3, v232
  v_add_u32_e64 v234, s47, v234
  v_mad_u32_u24 v233, v233, 8, v232
  v_add_u32 v246, s82, v235
  v_add_u32 v247, 2048, v246
  v_add_u32 v31, 0, v234
  v_and_b32 v31, 3, v31
  v_lshl_add_u32 v244, v31, 4, v232
  v_add_u32 v31, 1, v234
  v_and_b32 v31, 3, v31
  v_lshl_add_u32 v245, v31, 4, v232
  v_add_u32 v245, 1664, v245
  v_add_u32 v31, 0, v234
  v_and_b32 v31, 3, v31
  v_lshl_add_u32 v248, v31, 4, v233
  v_add_u32 v31, 1, v234
  v_and_b32 v31, 3, v31
  v_lshl_add_u32 v249, v31, 4, v233
  v_add_u32 v249, 1664, v249
  s_waitcnt lgkmcnt(5)
  v_add_u32 v10, s76, v10
  v_add_u32 v4, s76, v4
  v_add_u32 v5, s76, v5
  ds_write_b32 v10, v7 offset:2880
  v_add_u32 v11, s45, v11
  s_waitcnt lgkmcnt(5)
  v_add_u32 v20, s45, v20
  v_add_u32 v21, s45, v21
  v_add_u32 v22, s45, v22
  v_add_u32 v23, s45, v23
  s_waitcnt lgkmcnt(4)
  v_add_u32 v24, s45, v24
  v_add_u32 v25, s45, v25
  v_add_u32 v26, s45, v26
  v_add_u32 v27, s45, v27
  s_mov_b32 exec_lo, 0
  v_mov_b32_e64 v120, v136
  s_mov_b32 exec_lo, -1
  v_cvt_pk_bf16_f32 v60, 0, v120
  ds_write_b16_d16_hi v28, v60
  v_max_f32 v108, |v60|, v108
  s_mov_b32 exec_lo, 0
  v_mov_b32 v152, v168
  s_mov_b32 exec_lo, -1
  v_cvt_pk_bf16_f32 v61, 0, v152
  ds_write_b16_d16_hi v58, v61
  v_max_f32 v108, |v61|, v108
  s_mov_b32 exec_lo, 0
  v_mov_b32 v184, v200
  s_mov_b32 exec_lo, -1
  v_cvt_pk_bf16_f32 v62, 0, v184
  s_mov_b64 exec, s[92:93]
  ds_write_b16_d16_hi v111, v62
  v_max_f32 v108, |v62|, v108
  s_mov_b64 exec, -1
  s_nop 0
  v_permlane32_swap_b32 v108, v109
  v_max_u32_e64 v108, v108, v109
  s_nop 1
  v_max_u32_dpp v108, v108, v108 row_shr:1 row_mask:0xf bank_mask:0xf
  s_nop 1
  v_max_u32_dpp v108, v108, v108 row_shr:2 row_mask:0xf bank_mask:0xf
  s_nop 1
  v_max_u32_dpp v108, v108, v108 row_shr:4 row_mask:0xf bank_mask:0xf
  s_nop 1
  v_max_u32_dpp v108, v108, v108 row_shr:8 row_mask:0xf bank_mask:0xf
  s_nop 1
  v_max_u32_dpp v108, v108, v108 row_bcast:15 row_mask:0xa bank_mask:0xf
  s_mov_b32 exec_lo, 0x80000000
  s_mov_b32 exec_hi, 0x80000000
  ds_max_u32 v3, v108 offset:24
  s_mov_b64 exec, -1
  s_setprio 0
  s_barrier
  s_branch L_w2
L_g0:
  s_waitcnt lgkmcnt(0)
  s_mov_b32 s36, s8
  s_and_b32 s37, s9, 0xffff
  s_mov_b32 s38, 105456
  s_mov_b32 s39, 0x20000
  s_add_u32 m0, s95, 41984
  s_add_u32 s81, s95, 70304
  buffer_load_dwordx4 v1, s[36:39], s81 offen lds
  s_add_u32 m0, s95, 46080
  s_add_u32 s81, s95, 74400
  buffer_load_dwordx4 v1, s[36:39], s81 offen lds
  s_add_u32 m0, s95, 50176
  s_add_u32 s81, s95, 78496
  buffer_load_dwordx4 v1, s[36:39], s81 offen lds
  s_add_u32 m0, s95, 54272
  s_add_u32 s81, s95, 82592
  buffer_load_dwordx4 v1, s[36:39], s81 offen lds
  s_add_u32 m0, s95, 58368
  s_add_u32 s81, s95, 86688
  buffer_load_dwordx4 v1, s[36:39], s81 offen lds
  s_add_u32 m0, s95, 62464
  s_add_u32 s81, s95, 90784
  buffer_load_dwordx4 v1, s[36:39], s81 offen lds
  s_add_u32 m0, s95, 66560
  s_add_u32 s81, s95, 94880
  buffer_load_dwordx4 v1, s[36:39], s81 offen lds
  s_add_u32 m0, s95, 70656
  s_add_u32 s81, s95, 98976
  buffer_load_dwordx4 v1, s[36:39], s81 offen lds
  s_cmp_eq_u32 s79, 3
  s_cbranch_scc1 L_st3
  s_add_u32 m0, s95, 74752
  s_add_u32 s81, s95, 103072
  buffer_load_dwordx4 v1, s[36:39], s81 offen lds
L_st3:
  s_mov_b32 s28, s4
  s_and_b32 s29, s5, 0xffff
  s_mov_b32 s30, 425984
  s_mov_b32 s31, 0x20000
  buffer_load_dwordx4 v[16:19], v30, s[28:31], s94 offen
  s_add_u32 s94, s94, 416
  buffer_load_dwordx4 v[104:107], v30, s[28:31], s94 offen
  s_add_u32 s94, s94, 416
  s_mov_b32 s32, s6
  s_and_b32 s33, s7, 0xffff
  s_mov_b32 s34, 12800000
  s_mov_b32 s35, 0x20000
  s_mul_i32 s96, s79, 3072
  s_mul_i32 s97, s79, 2704
  v_lshrrev_b32 v31, 5, v0
  v_mul_u32_u24 v31, 184, v31
  v_sub_u32 v31, v1, v31
  s_add_u32 m0, s96, 85312
  s_add_u32 s81, s97, 35152
  buffer_load_dwordx4 v1, s[36:39], s81 offen lds
  s_lshl_b32 s85, s85, 2
  s_add_u32 s85, s85, 129728
  s_mul_i32 s72, s84, 3
  s_sub_u32 s72, 4, s72
  s_cmp_eq_u32 s26, 85
  s_cselect_b32 s72, s72, 6
  s_add_u32 m0, s96, 86336
  s_add_u32 s81, s97, 36176
  buffer_load_dwordx4 v31, s[36:39], s81 offen lds
  s_lshl_b32 s44, s3, 7
  s_mul_i32 s45, s3, 5280
  s_lshl_b32 s46, s3, 2
  s_lshl_b32 s47, s3, 1
  s_lshl_b32 s82, s3, 12
  s_add_u32 m0, s96, 87360
  s_add_u32 s81, s97, 37016
  buffer_load_dwordx4 v1, s[36:39], s81 offen lds
  s_and_b32 s98, s3, 1
  s_lshr_b32 s99, s3, 1
  s_mul_i32 s68, s99, 3072
  s_lshl_b32 s83, s98, 3
  s_add_u32 s68, s68, s83
  s_add_u32 m0, s96, 97600
  s_add_u32 s81, s97, 45968
  buffer_load_dwordx4 v1, s[36:39], s81 offen lds
  v_add_u32 v59, s68, v1
  s_lshl_b32 s69, s99, 3
  s_lshr_b32 s69, 0x05030200, s69
  s_and_b32 s69, s69, 0xff
  s_lshl_b32 s69, s69, 9
  s_add_u32 m0, s96, 98624
  s_add_u32 s81, s97, 46992
  buffer_load_dwordx4 v31, s[36:39], s81 offen lds
  s_lshl_b32 s70, s98, 2
  s_add_u32 s101, s69, s70
  s_mov_b32 s99, 0x05040100
  s_mov_b32 s100, 0x07060302
  v_mov_b32 v2, 129664
  s_add_u32 m0, s96, 99648
  s_add_u32 s81, s97, 47832
  buffer_load_dwordx4 v1, s[36:39], s81 offen lds
  v_mov_b32 v109, 0
  v_mov_b32_e64 v108, 0
  v_mov_b64 v[32:33], 0
  v_mov_b64 v[34:35], 0
  v_mov_b64 v[36:37], 0
  s_add_u32 m0, s96, 109888
  s_add_u32 s81, s97, 56784
  buffer_load_dwordx4 v1, s[36:39], s81 offen lds
  v_mov_b64 v[38:39], 0
  v_mov_b64 v[40:41], 0
  v_mov_b64 v[42:43], 0
  v_mov_b64 v[44:45], 0
  v_mov_b64 v[46:47], 0
  s_add_u32 m0, s96, 110912
  s_add_u32 s81, s97, 57808
  buffer_load_dwordx4 v31, s[36:39], s81 offen lds
  v_mov_b64 v[48:49], 0
  v_mov_b64 v[50:51], 0
  v_mov_b64 v[52:53], 0
  v_mov_b64 v[54:55], 0
  v_mov_b64 v[56:57], 0
  s_add_u32 m0, s96, 111936
  s_add_u32 s81, s97, 58648
  buffer_load_dwordx4 v1, s[36:39], s81 offen lds
  v_add_u32 v14, 77824, v1
  v_add_u32 v15, 125248, v1
  v_lshrrev_b32_e64 v3, 5, v0
  v_lshl_add_u32 v3, v3, 2, v2
  s_cmp_lg_u32 s79, 0
  s_cbranch_scc1 L_st2
  s_add_u32 m0, s96, 122176
  s_add_u32 s81, s97, 67600
  buffer_load_dwordx4 v1, s[36:39], s81 offen lds
  s_add_u32 m0, s96, 123200
  s_add_u32 s81, s97, 68624
  buffer_load_dwordx4 v31, s[36:39], s81 offen lds
  s_add_u32 m0, s96, 124224
  s_add_u32 s81, s97, 69464
  buffer_load_dwordx4 v1, s[36:39], s81 offen lds
L_st2:
  s_add_u32 m0, s95, 6144
  s_add_u32 s81, s95, 0
  buffer_load_dwordx4 v1, s[36:39], s81 offen lds
  s_add_u32 m0, s95, 10240
  s_add_u32 s81, s95, 4096
  buffer_load_dwordx4 v1, s[36:39], s81 offen lds
  s_add_u32 m0, s95, 14336
  s_add_u32 s81, s95, 8192
  buffer_load_dwordx4 v1, s[36:39], s81 offen lds
  s_add_u32 m0, s95, 18432
  s_add_u32 s81, s95, 12288
  buffer_load_dwordx4 v1, s[36:39], s81 offen lds
  s_waitcnt vmcnt(15)
  s_barrier
  ds_read_b128 v[224:227], v14 offset:0
  ds_read_b128 v[228:231], v14 offset:6144
  ds_read_b128 v[232:235], v15 offset:0
  ds_read_b128 v[4:7], v14 offset:3072
  ds_read_b128 v[8:11], v15 offset:2048
  ds_read_b128 v[20:23], v14 offset:1024
  ds_read_b128 v[24:27], v14 offset:2048
  ds_read_b128 v[216:219], v14 offset:4096
  ds_read_b128 v[220:223], v14 offset:5120
  ds_read_b128 v[236:239], v15 offset:1024
  s_add_u32 m0, s95, 22528
  s_add_u32 s81, s95, 16384
  buffer_load_dwordx4 v1, s[36:39], s81 offen lds
  s_add_u32 m0, s95, 26624
  s_add_u32 s81, s95, 20480
  buffer_load_dwordx4 v1, s[36:39], s81 offen lds
  s_add_u32 m0, s95, 30720
  s_add_u32 s81, s95, 24576
  buffer_load_dwordx4 v1, s[36:39], s81 offen lds
  s_add_u32 m0, s95, 34816
  s_add_u32 s81, s95, 28672
  buffer_load_dwordx4 v1, s[36:39], s81 offen lds
  s_cmp_eq_u32 s79, 3
  s_cbranch_scc1 L_st1
  s_add_u32 m0, s95, 38912
  s_add_u32 s81, s95, 32768
  buffer_load_dwordx4 v1, s[36:39], s81 offen lds
L_st1:
  s_waitcnt vmcnt(18)
  v_lshl_add_u32 v16, v16, 7, v29
  v_lshl_add_u32 v17, v17, 7, v29
  v_lshl_add_u32 v18, v18, 7, v29
  v_lshl_add_u32 v19, v19, 7, v29
  s_add_u32 m0, s76, 0
  s_mov_b32 exec_hi, 0xffffff
  buffer_load_dwordx4 v16, s[32:35], 0 offen lds
  s_add_u32 m0, s76, 1056
  s_nop 0
  buffer_load_dwordx4 v17, s[32:35], 0 offen lds
  s_add_u32 m0, s76, 2112
  s_mov_b32 exec_hi, 0xffff
  buffer_load_dwordx4 v18, s[32:35], 0 offen lds
  s_add_u32 m0, s76, 3168
  s_nop 0
  buffer_load_dwordx4 v19, s[32:35], 0 offen lds
  s_mov_b32 exec_hi, -1
  s_waitcnt vmcnt(21)
  v_lshl_add_u32 v104, v104, 7, v29
  v_lshl_add_u32 v105, v105, 7, v29
  v_lshl_add_u32 v106, v106, 7, v29
  v_lshl_add_u32 v107, v107, 7, v29
  s_add_u32 m0, s76, 16256
  s_mov_b32 exec_hi, 0xffffff
  buffer_load_dwordx4 v104, s[32:35], 0 offen lds
  s_add_u32 m0, s76, 17312
  s_nop 0
  buffer_load_dwordx4 v105, s[32:35], 0 offen lds
  s_add_u32 m0, s76, 18368
  s_mov_b32 exec_hi, 0xffff
  buffer_load_dwordx4 v106, s[32:35], 0 offen lds
  s_add_u32 m0, s76, 19424
  s_nop 0
  buffer_load_dwordx4 v107, s[32:35], 0 offen lds
  s_mov_b32 exec_hi, -1
  s_waitcnt lgkmcnt(9)
  v_add_u32 v225, s44, v225
  v_add_u32 v226, s44, v226
  v_add_u32 v227, s44, v227
  s_waitcnt lgkmcnt(8)
  v_add_u32 v228, s46, v228
  v_add_u32 v229, s46, v229
  v_add_u32 v231, s83, v231
  v_add_u32 v230, s101, v230
  s_waitcnt lgkmcnt(7)
  v_mad_u32_u24 v232, v233, s3, v232
  v_add_u32 v234, s47, v234
  v_mad_u32_u24 v233, v233, 8, v232
  v_add_u32 v246, s82, v235
  v_add_u32 v247, 2048, v246
  v_add_u32 v31, 0, v234
  v_and_b32 v31, 3, v31
  v_lshl_add_u32 v244, v31, 4, v232
  v_add_u32 v31, 1, v234
  v_and_b32 v31, 3, v31
  v_lshl_add_u32 v245, v31, 4, v232
  v_add_u32 v245, 1664, v245
  v_add_u32 v31, 0, v234
  v_and_b32 v31, 3, v31
  v_lshl_add_u32 v248, v31, 4, v233
  v_add_u32 v31, 1, v234
  v_and_b32 v31, 3, v31
  v_lshl_add_u32 v249, v31, 4, v233
  v_add_u32 v249, 1664, v249
  s_waitcnt lgkmcnt(5)
  v_add_u32 v10, s76, v10
  v_add_u32 v4, s76, v4
  v_add_u32 v5, s76, v5
  ds_write_b32 v10, v7 offset:2880
  v_add_u32 v11, s45, v11
  s_waitcnt lgkmcnt(5)
  v_add_u32 v20, s45, v20
  v_add_u32 v21, s45, v21
  v_add_u32 v22, s45, v22
  v_add_u32 v23, s45, v23
  s_waitcnt lgkmcnt(4)
  v_add_u32 v24, s45, v24
  v_add_u32 v25, s45, v25
  v_add_u32 v26, s45, v26
  v_add_u32_e64 v27, s45, v27
  s_waitcnt vmcnt(16)
  s_barrier
L_w2:
  ds_read2st64_b32 v[60:61], v228 offset0:0 offset1:6
  ds_read2st64_b32 v[62:63], v228 offset0:12 offset1:18
  ds_read2st64_b32 v[64:65], v228 offset0:24 offset1:30
  ds_read2st64_b32 v[66:67], v228 offset0:36 offset1:42
  ds_read2st64_b32 v[68:69], v228 offset0:96 offset1:102
  ds_read2st64_b32 v[70:71], v229 offset0:108 offset1:114
  ds_read2st64_b32 v[72:73], v229 offset0:120 offset1:126
  ds_read2st64_b32 v[74:75], v229 offset0:132 offset1:138
  s_cmp_ge_u32 s3, 5
  s_cbranch_scc1 L_u0
  v_add_u32 v228, 32, v228
  v_add_u32 v229, 32, v229
  ds_read2st64_b32 v[92:93], v228 offset0:0 offset1:6
  ds_read2st64_b32 v[94:95], v228 offset0:12 offset1:18
  ds_read2st64_b32 v[96:97], v228 offset0:24 offset1:30
  ds_read2st64_b32 v[98:99], v228 offset0:36 offset1:42
  ds_read2st64_b32 v[100:101], v228 offset0:96 offset1:102
  ds_read2st64_b32 v[102:103], v229 offset0:108 offset1:114
  ds_read2st64_b32 v[104:105], v229 offset0:120 offset1:126
  ds_read2st64_b32 v[106:107], v229 offset0:132 offset1:138
  s_waitcnt lgkmcnt(14)
  v_mfma_f32_16x16x32_bf16 v[28:31], v[60:63], v[60:63], 0
  s_waitcnt lgkmcnt(12)
  v_mfma_f32_16x16x32_bf16 v[28:31], v[64:67], v[64:67], v[28:31]
  s_waitcnt lgkmcnt(10)
  v_mfma_f32_16x16x32_bf16 v[28:31], v[68:71], v[68:71], v[28:31]
  s_waitcnt lgkmcnt(8)
  v_mfma_f32_16x16x32_bf16 v[28:31], v[72:75], v[72:75], v[28:31]
  v_perm_b32 v152, v61, v60, s99
  v_perm_b32 v153, v63, v62, s99
  v_perm_b32 v154, v65, v64, s99
  v_perm_b32 v155, v67, v66, s99
  v_perm_b32 v156, v69, v68, s99
  v_perm_b32 v157, v71, v70, s99
  v_perm_b32 v158, v73, v72, s99
  v_perm_b32 v159, v75, v74, s99
  v_perm_b32 v160, v61, v60, s100
  v_perm_b32 v161, v63, v62, s100
  v_perm_b32 v162, v65, v64, s100
  v_perm_b32 v163, v67, v66, s100
  v_perm_b32 v164, v69, v68, s100
  v_perm_b32 v165, v71, v70, s100
  v_perm_b32 v166, v73, v72, s100
  v_perm_b32 v167, v75, v74, s100
  s_waitcnt lgkmcnt(6)
  v_mfma_f32_16x16x32_bf16 v[28:31], v[92:95], v[92:95], v[28:31]
  s_waitcnt lgkmcnt(4)
  v_mfma_f32_16x16x32_bf16 v[28:31], v[96:99], v[96:99], v[28:31]
  s_waitcnt lgkmcnt(2)
  v_mfma_f32_16x16x32_bf16 v[28:31], v[100:103], v[100:103], v[28:31]
  s_waitcnt lgkmcnt(0)
  v_mfma_f32_16x16x32_bf16 v[28:31], v[104:107], v[104:107], v[28:31]
  v_perm_b32 v168, v93, v92, s99
  v_perm_b32 v169, v95, v94, s99
  v_perm_b32 v170, v97, v96, s99
  v_perm_b32 v171, v99, v98, s99
  s_nop 3
  v_max3_f32 v28, v28, v29, 0
  v_perm_b32 v172, v101, v100, s99
  v_perm_b32 v173, v103, v102, s99
  v_max3_f32 v28, v28, v30, v31
  v_perm_b32 v174, v105, v104, s99
  s_nop 0
  v_max_u32_dpp v28, v28, v28 row_shr:1 row_mask:0xf bank_mask:0xf
  v_perm_b32 v175, v107, v106, s99
  s_nop 0
  v_max_u32_dpp v28, v28, v28 row_shr:2 row_mask:0xf bank_mask:0xf
  v_perm_b32 v176, v93, v92, s100
  v_perm_b32 v177, v95, v94, s100
  v_max_u32_dpp v28, v28, v28 row_shr:4 row_mask:0xf bank_mask:0xf
  v_perm_b32 v178, v97, v96, s100
  s_nop 0
  v_max_u32_dpp v28, v28, v28 row_shr:8 row_mask:0xf bank_mask:0xf
  v_perm_b32 v179, v99, v98, s100
  s_nop 0
  v_max_u32_dpp v28, v28, v28 row_bcast:15 row_mask:0xa bank_mask:0xf
  v_perm_b32 v180, v101, v100, s100
  v_perm_b32 v181, v103, v102, s100
  v_max_u32_dpp v28, v28, v28 row_bcast:31 row_mask:0xc bank_mask:0xf
  v_perm_b32 v182, v105, v104, s100
  s_mov_b32 exec_lo, 0
  s_mov_b32 exec_hi, 0x80000000
  ds_max_u32 v2, v28 offset:20
  s_mov_b64 exec, -1
  v_perm_b32 v183, v107, v106, s100
  s_branch L_u1
L_u0:
  s_waitcnt lgkmcnt(6)
  v_mfma_f32_16x16x32_bf16 v[28:31], v[60:63], v[60:63], 0
  s_waitcnt lgkmcnt(4)
  v_mfma_f32_16x16x32_bf16 v[28:31], v[64:67], v[64:67], v[28:31]
  s_waitcnt lgkmcnt(2)
  v_mfma_f32_16x16x32_bf16 v[28:31], v[68:71], v[68:71], v[28:31]
  s_waitcnt lgkmcnt(0)
  v_mfma_f32_16x16x32_bf16 v[28:31], v[72:75], v[72:75], v[28:31]
  v_perm_b32 v152, v61, v60, s99
  v_perm_b32 v153, v63, v62, s99
  v_perm_b32 v154, v65, v64, s99
  v_perm_b32 v155, v67, v66, s99
  s_nop 3
  v_max3_f32 v28, v28, v29, 0
  v_perm_b32 v156, v69, v68, s99
  v_perm_b32 v157, v71, v70, s99
  v_max3_f32 v28, v28, v30, v31
  v_perm_b32 v158, v73, v72, s99
  s_nop 0
  v_max_u32_dpp v28, v28, v28 row_shr:1 row_mask:0xf bank_mask:0xf
  v_perm_b32 v159, v75, v74, s99
  s_nop 0
  v_max_u32_dpp v28, v28, v28 row_shr:2 row_mask:0xf bank_mask:0xf
  v_perm_b32 v160, v61, v60, s100
  v_perm_b32 v161, v63, v62, s100
  v_max_u32_dpp v28, v28, v28 row_shr:4 row_mask:0xf bank_mask:0xf
  v_perm_b32 v162, v65, v64, s100
  s_nop 0
  v_max_u32_dpp v28, v28, v28 row_shr:8 row_mask:0xf bank_mask:0xf
  v_perm_b32 v163, v67, v66, s100
  s_nop 0
  v_max_u32_dpp v28, v28, v28 row_bcast:15 row_mask:0xa bank_mask:0xf
  v_perm_b32 v164, v69, v68, s100
  v_perm_b32 v165, v71, v70, s100
  v_max_u32_dpp v28, v28, v28 row_bcast:31 row_mask:0xc bank_mask:0xf
  v_perm_b32 v166, v73, v72, s100
  s_mov_b32 exec_lo, 0
  s_mov_b32 exec_hi, 0x80000000
  ds_max_u32 v2, v28 offset:20
  s_mov_b64 exec, -1
  v_perm_b32 v167, v75, v74, s100
  v_add_u32 v248, 12288, v246
  v_add_u32 v249, 12288, v247
  s_cmp_lg_u32 s3, 7
  s_cbranch_scc1 L_u1
  s_mov_b32 exec_lo, 0xfffffff0
  s_mov_b32 exec_hi, 0xfffffff0
  v_mov_b32 v249, 1048576
  s_mov_b64 exec, -1
L_u1:
  s_waitcnt vmcnt(8) lgkmcnt(0)
  s_barrier
  ds_read_b128 v[108:111], v2 offset:16
  ds_read_b64_tr_b16 v[112:113], v224 offset:0
  ds_read_b64_tr_b16 v[114:115], v224 offset:256
  ds_read_b64_tr_b16 v[116:117], v224 offset:1024
  ds_read_b64_tr_b16 v[118:119], v224 offset:1280
  ds_read_b64_tr_b16 v[76:77], v225 offset:0
  ds_read_b64_tr_b16 v[78:79], v225 offset:5408
  ds_read_b64_tr_b16 v[80:81], v226 offset:0
  ds_read_b64_tr_b16 v[82:83], v227 offset:0
  ds_read_b64_tr_b16 v[84:85], v225 offset:64
  ds_read_b64_tr_b16 v[86:87], v225 offset:5472
  ds_read_b64_tr_b16 v[88:89], v226 offset:64
  ds_read_b64_tr_b16 v[90:91], v227 offset:64
  s_waitcnt lgkmcnt(12)
  v_add_u32 v109, 0x3f800000, v109
  v_lshrrev_b32 v109, 24, v109
  v_lshrrev_b32 v110, 23, v110
  v_lshrrev_b32 v111, 23, v111
  s_mov_b32 vcc_lo, 0x4000000
  s_mov_b32 vcc_hi, 0x4000000
  v_cndmask_b32 v250, v110, v111, vcc
  v_add_u32_e64 v250, v250, v109
  v_sub_u32 v250, 388, v250
  s_movk_i32 s98, 167
  v_med3_i32 v250, v250, 1, s98
  v_subrev_u32 v110, 127, v250
  v_lshlrev_b32 v250, 23, v250
  v_cmp_gt_i32 vcc, 0, v110
  v_mul_u32_u24 v110, 0x800080, v110
  s_cbranch_vccnz L_sdown
  s_waitcnt lgkmcnt(11)
  v_add_u32 v112, v112, v110
  v_add_u32 v113, v113, v110
  s_waitcnt lgkmcnt(10)
  v_add_u32 v114, v114, v110
  v_add_u32 v115, v115, v110
  s_waitcnt lgkmcnt(9)
  v_add_u32 v116, v116, v110
  v_add_u32 v117, v117, v110
  s_waitcnt lgkmcnt(8)
  v_add_u32 v118, v118, v110
  v_add_u32_e64 v119, v119, v110
L_scaled:
  s_cmp_ge_u32 s3, 5
  s_cbranch_scc1 L_u2
  v_mfma_f32_32x32x16_bf16 v[120:135], v[152:155], v[112:115], 0
  v_mfma_f32_32x32x16_bf16 v[120:135], v[156:159], v[116:119], v[120:135]
  s_waitcnt lgkmcnt(6)
  v_mfma_f32_16x16x32_bf16 v[28:31], v[76:79], v[76:79], 0
  s_waitcnt lgkmcnt(4)
  v_mfma_f32_16x16x32_bf16 v[28:31], v[80:83], v[80:83], v[28:31]
  s_waitcnt lgkmcnt(2)
  v_mfma_f32_16x16x32_bf16 v[28:31], v[84:87], v[84:87], v[28:31]
  s_waitcnt lgkmcnt(0)
  v_mfma_f32_16x16x32_bf16 v[28:31], v[88:91], v[88:91], v[28:31]
  v_mfma_f32_32x32x16_bf16 v[136:151], v[160:163], v[112:115], 0
  s_nop 2
  v_cvt_pk_f16_f32 v120, v120, v121
  v_cvt_pk_f16_f32 v121, v122, v123
  v_cvt_pk_f16_f32 v122, v124, v125
  v_cvt_pk_f16_f32 v123, v126, v127
  ds_write_b128 v244, v[120:123]
  v_xor_b32_e64 v244, 16, v244
  v_mfma_f32_32x32x16_bf16 v[136:151], v[164:167], v[116:119], v[136:151]
  v_cvt_pk_f16_f32 v124, v128, v129
  v_cvt_pk_f16_f32 v125, v130, v131
  v_cvt_pk_f16_f32 v126, v132, v133
  v_cvt_pk_f16_f32 v127, v134, v135
  ds_write_b128 v244, v[124:127]
  v_mfma_f32_32x32x16_bf16 v[184:199], v[168:171], v[112:115], 0
  v_max3_f32 v28, v28, v29, 0
  s_nop 4
  v_cvt_pk_f16_f32 v136, v136, v137
  v_cvt_pk_f16_f32 v137, v138, v139
  v_max3_f32 v28, v28, v30, v31
  v_cvt_pk_f16_f32 v138, v140, v141
  v_mfma_f32_32x32x16_bf16 v[184:199], v[172:175], v[116:119], v[184:199]
  v_max_u32_dpp v28, v28, v28 row_shr:1 row_mask:0xf bank_mask:0xf
  v_cvt_pk_f16_f32 v139, v142, v143
  s_nop 0
  v_max_u32_dpp v28, v28, v28 row_shr:2 row_mask:0xf bank_mask:0xf
  ds_write_b128 v245, v[136:139]
  s_nop 0
  v_max_u32_dpp v28, v28, v28 row_shr:4 row_mask:0xf bank_mask:0xf
  v_mfma_f32_32x32x16_bf16 v[200:215], v[176:179], v[112:115], 0
  v_xor_b32_e64 v245, 16, v245
  v_max_u32_dpp v28, v28, v28 row_shr:8 row_mask:0xf bank_mask:0xf
  v_cvt_pk_f16_f32 v140, v144, v145
  s_nop 0
  v_max_u32_dpp v28, v28, v28 row_bcast:15 row_mask:0xa bank_mask:0xf
  v_cvt_pk_f16_f32 v141, v146, v147
  v_mfma_f32_32x32x16_bf16 v[200:215], v[180:183], v[116:119], v[200:215]
  v_max_u32_dpp v28, v28, v28 row_bcast:31 row_mask:0xc bank_mask:0xf
  v_cvt_pk_f16_f32 v142, v148, v149
  s_mov_b32 exec_lo, 0
  s_mov_b32 exec_hi, 0x80000000
  ds_max_u32 v2, v28 offset:16
  s_mov_b64 exec, -1
  v_cvt_pk_f16_f32 v143, v150, v151
  ds_write_b128 v245, v[140:143]
  s_waitcnt lgkmcnt(1)
  s_barrier
  ds_read_b32 v108, v2 offset:16
  v_cvt_pk_f16_f32 v184, v184, v185
  v_cvt_pk_f16_f32 v185, v186, v187
  v_cvt_pk_f16_f32 v186, v188, v189
  v_cvt_pk_f16_f32 v187, v190, v191
  ds_write_b128 v248, v[184:187]
  v_xor_b32_e64 v248, 16, v248
  v_cvt_pk_f16_f32 v188, v192, v193
  v_cvt_pk_f16_f32 v189, v194, v195
  v_cvt_pk_f16_f32 v190, v196, v197
  v_cvt_pk_f16_f32 v191, v198, v199
  ds_write_b128 v248, v[188:191]
  s_waitcnt lgkmcnt(2)
  v_add_u32 v108, 0x3f800000, v108
  v_lshrrev_b32 v108, 24, v108
  v_sub_u32 v108, 267, v108
  v_min_u32 v108, 167, v108
  s_nop 0
  v_readfirstlane_b32 s74, v108
  v_mul_u32_u24 v108, 0x800080, v108
  v_and_b32 v216, v216, v108
  v_and_b32 v217, v217, v108
  v_and_b32 v218, v218, v108
  v_and_b32 v219, v219, v108
  v_and_b32 v220, v220, v108
  v_and_b32 v221, v221, v108
  v_and_b32 v222, v222, v108
  v_and_b32_e64 v223, v223, v108
  v_mfma_f32_32x32x16_bf16 v[152:167], v[216:219], v[76:79], 0
  v_cvt_pk_f16_f32 v200, v200, v201
  v_cvt_pk_f16_f32 v201, v202, v203
  v_cvt_pk_f16_f32 v202, v204, v205
  v_mfma_f32_32x32x16_bf16 v[152:167], v[220:223], v[80:83], v[152:167]
  v_cvt_pk_f16_f32 v203, v206, v207
  ds_write_b128 v249, v[200:203]
  v_xor_b32_e64 v249, 16, v249
  v_mfma_f32_32x32x16_bf16 v[168:183], v[216:219], v[84:87], 0
  v_cvt_pk_f16_f32 v204, v208, v209
  v_cvt_pk_f16_f32 v205, v210, v211
  v_cvt_pk_f16_f32 v206, v212, v213
  v_mfma_f32_32x32x16_bf16 v[168:183], v[220:223], v[88:91], v[168:183]
  v_cvt_pk_f16_f32 v207, v214, v215
  ds_write_b128 v249, v[204:207]
  s_branch L_u3
L_u2:
  ds_read_b64_tr_b16 v[92:93], v225 offset:384
  ds_read_b64_tr_b16 v[94:95], v225 offset:5792
  ds_read_b64_tr_b16 v[96:97], v226 offset:384
  ds_read_b64_tr_b16 v[98:99], v227 offset:384
  ds_read_b64_tr_b16 v[100:101], v225 offset:448
  ds_read_b64_tr_b16 v[102:103], v225 offset:5856
  ds_read_b64_tr_b16 v[104:105], v226 offset:448
  ds_read_b64_tr_b16 v[106:107], v227 offset:448
  v_mfma_f32_32x32x16_bf16 v[120:135], v[152:155], v[112:115], 0
  v_mfma_f32_32x32x16_bf16 v[120:135], v[156:159], v[116:119], v[120:135]
  v_mfma_f32_32x32x16_bf16 v[136:151], v[160:163], v[112:115], 0
  v_mfma_f32_32x32x16_bf16 v[136:151], v[164:167], v[116:119], v[136:151]
  s_waitcnt lgkmcnt(14)
  v_mfma_f32_16x16x32_bf16 v[28:31], v[76:79], v[76:79], 0
  s_nop 7
  v_cvt_pk_f16_f32 v120, v120, v121
  v_cvt_pk_f16_f32 v121, v122, v123
  s_waitcnt lgkmcnt(12)
  v_mfma_f32_16x16x32_bf16 v[28:31], v[80:83], v[80:83], v[28:31]
  v_cvt_pk_f16_f32 v122, v124, v125
  s_waitcnt lgkmcnt(10)
  v_mfma_f32_16x16x32_bf16 v[28:31], v[84:87], v[84:87], v[28:31]
  v_cvt_pk_f16_f32 v123, v126, v127
  ds_write_b128 v244, v[120:123]
  s_waitcnt lgkmcnt(9)
  v_mfma_f32_16x16x32_bf16 v[28:31], v[88:91], v[88:91], v[28:31]
  v_xor_b32 v244, 16, v244
  s_waitcnt lgkmcnt(7)
  v_mfma_f32_16x16x32_bf16 v[28:31], v[92:95], v[92:95], v[28:31]
  v_cvt_pk_f16_f32 v124, v128, v129
  s_waitcnt lgkmcnt(5)
  v_mfma_f32_16x16x32_bf16 v[28:31], v[96:99], v[96:99], v[28:31]
  v_cvt_pk_f16_f32 v125, v130, v131
  v_cvt_pk_f16_f32 v126, v132, v133
  s_waitcnt lgkmcnt(3)
  v_mfma_f32_16x16x32_bf16 v[28:31], v[100:103], v[100:103], v[28:31]
  s_nop 0
  v_cvt_pk_f16_f32 v127, v134, v135
  s_waitcnt lgkmcnt(1)
  v_mfma_f32_16x16x32_bf16 v[28:31], v[104:107], v[104:107], v[28:31]
  ds_write_b128 v244, v[124:127]
  s_nop 6
  v_max3_f32 v28, v28, v29, 0
  v_cvt_pk_f16_f32 v136, v136, v137
  v_cvt_pk_f16_f32 v137, v138, v139
  v_max3_f32 v28, v28, v30, v31
  v_cvt_pk_f16_f32 v138, v140, v141
  s_nop 0
  v_max_u32_dpp v28, v28, v28 row_shr:1 row_mask:0xf bank_mask:0xf
  v_cvt_pk_f16_f32 v139, v142, v143
  s_nop 0
  v_max_u32_dpp v28, v28, v28 row_shr:2 row_mask:0xf bank_mask:0xf
  ds_write_b128 v245, v[136:139]
  s_nop 0
  v_max_u32_dpp v28, v28, v28 row_shr:4 row_mask:0xf bank_mask:0xf
  v_xor_b32 v245, 16, v245
  s_nop 0
  v_max_u32_dpp v28, v28, v28 row_shr:8 row_mask:0xf bank_mask:0xf
  v_cvt_pk_f16_f32 v140, v144, v145
  s_nop 0
  v_max_u32_dpp v28, v28, v28 row_bcast:15 row_mask:0xa bank_mask:0xf
  v_cvt_pk_f16_f32 v141, v146, v147
  s_nop 0
  v_max_u32_dpp v28, v28, v28 row_bcast:31 row_mask:0xc bank_mask:0xf
  v_cvt_pk_f16_f32 v142, v148, v149
  s_mov_b32 exec_lo, 0
  s_mov_b32 exec_hi, 0x80000000
  ds_max_u32 v2, v28 offset:16
  s_mov_b64 exec, -1
  v_cvt_pk_f16_f32 v143, v150, v151
  ds_write_b128 v245, v[140:143]
  s_waitcnt lgkmcnt(1)
  s_barrier
  ds_read_b32 v108, v2 offset:16
  s_waitcnt lgkmcnt(0)
  v_add_u32 v108, 0x3f800000, v108
  v_lshrrev_b32 v108, 24, v108
  v_sub_u32 v108, 267, v108
  v_min_u32 v108, 167, v108
  s_nop 0
  v_readfirstlane_b32 s74, v108
  v_mul_u32_u24 v108, 0x800080, v108
  v_and_b32 v216, v216, v108
  v_and_b32 v217, v217, v108
  v_and_b32 v218, v218, v108
  v_and_b32 v219, v219, v108
  v_and_b32 v220, v220, v108
  v_and_b32 v221, v221, v108
  v_and_b32 v222, v222, v108
  v_and_b32 v223, v223, v108
  v_mfma_f32_32x32x16_bf16 v[184:199], v[216:219], v[92:95], 0
  s_nop 0
  v_mfma_f32_32x32x16_bf16 v[184:199], v[220:223], v[96:99], v[184:199]
  v_mfma_f32_32x32x16_bf16 v[200:215], v[216:219], v[100:103], 0
  v_mfma_f32_32x32x16_bf16 v[200:215], v[220:223], v[104:107], v[200:215]
  v_mfma_f32_32x32x16_bf16 v[152:167], v[216:219], v[76:79], 0
  s_nop 8
  v_cvt_pk_f16_f32 v184, v184, v185
  v_cvt_pk_f16_f32 v185, v186, v187
  v_cvt_pk_f16_f32 v186, v188, v189
  v_cvt_pk_f16_f32 v187, v190, v191
  ds_write_b128 v248, v[184:187]
  v_xor_b32 v248, 16, v248
  v_mfma_f32_32x32x16_bf16 v[152:167], v[220:223], v[80:83], v[152:167]
  v_cvt_pk_f16_f32 v188, v192, v193
  v_cvt_pk_f16_f32 v189, v194, v195
  v_cvt_pk_f16_f32 v190, v196, v197
  v_cvt_pk_f16_f32 v191, v198, v199
  ds_write_b128 v248, v[188:191]
  v_mfma_f32_32x32x16_bf16 v[168:183], v[216:219], v[84:87], 0
  v_cvt_pk_f16_f32 v200, v200, v201
  v_cvt_pk_f16_f32 v201, v202, v203
  v_cvt_pk_f16_f32 v202, v204, v205
  v_cvt_pk_f16_f32 v203, v206, v207
  ds_write_b128 v249, v[200:203]
  v_xor_b32_e64 v249, 16, v249
  v_mfma_f32_32x32x16_bf16 v[168:183], v[220:223], v[88:91], v[168:183]
  v_cvt_pk_f16_f32 v204, v208, v209
  v_cvt_pk_f16_f32 v205, v210, v211
  v_cvt_pk_f16_f32 v206, v212, v213
  v_cvt_pk_f16_f32 v207, v214, v215
  ds_write_b128 v249, v[204:207]
L_u3:
  s_nop 0
  v_cvt_pk_f16_f32 v152, v152, v153
  v_cvt_pk_f16_f32 v153, v154, v155
  v_cvt_pk_f16_f32 v154, v156, v157
  v_cvt_pk_f16_f32 v155, v158, v159
  ds_write_b128 v246, v[152:155]
  v_xor_b32 v246, 16, v246
  v_cvt_pk_f16_f32 v156, v160, v161
  v_cvt_pk_f16_f32 v157, v162, v163
  v_cvt_pk_f16_f32 v158, v164, v165
  v_cvt_pk_f16_f32 v159, v166, v167
  ds_write_b128 v246, v[156:159]
  v_cvt_pk_f16_f32 v168, v168, v169
  v_cvt_pk_f16_f32 v169, v170, v171
  v_cvt_pk_f16_f32 v170, v172, v173
  v_cvt_pk_f16_f32 v171, v174, v175
  ds_write_b128 v247, v[168:171]
  v_xor_b32_e64 v247, 16, v247
  v_cvt_pk_f16_f32 v172, v176, v177
  v_cvt_pk_f16_f32 v173, v178, v179
  v_cvt_pk_f16_f32 v174, v180, v181
  v_cvt_pk_f16_f32 v175, v182, v183
  ds_write_b128 v247, v[172:175]
  v_readlane_b32 s0, v250, 0
  v_readlane_b32 s1, v250, 26
  s_sub_u32 s75, 0x7f000000, s0
  s_sub_u32 s1, 0x7f000000, s1
  s_sub_u32 s74, 254, s74
  s_lshl_b32 s74, s74, 23
  s_mov_b32 s92, 0x88888888
  s_mov_b32 s93, 0x88888888
  s_mul_i32 s68, s3, 384
  v_lshrrev_b32 v29, 2, v0
  v_mul_u32_u24 v29, 24, v29
  v_add_u32 v29, s68, v29
  v_and_b32 v30, 3, v0
  v_lshlrev_b32 v30, 3, v30
  ds_read_b64 v[120:121], v29 offset:2048
  ds_read_b64 v[122:123], v29 offset:2056
  ds_read_b64 v[124:125], v29 offset:2064
  buffer_load_dwordx4 v[16:19], v6, s[28:31], s94 offen
  s_add_u32 s94, s94, 416
  buffer_load_dwordx4 v[216:219], v6, s[28:31], s94 offen
  s_add_u32 s94, s94, 416
  s_waitcnt lgkmcnt(2)
  v_xor_b32 v120, v120, v30
  v_xor_b32 v126, 32, v120
  v_xor_b32 v121, v121, v30
  v_xor_b32 v127, 32, v121
  s_waitcnt lgkmcnt(1)
  v_xor_b32 v122, v122, v30
  v_xor_b32 v128, 32, v122
  v_xor_b32 v123, v123, v30
  v_xor_b32 v129, 32, v123
  s_waitcnt lgkmcnt(0)
  v_xor_b32 v124, v124, v30
  v_xor_b32 v130, 32, v124
  v_xor_b32 v125, v125, v30
  v_xor_b32_e64 v131, 32, v125
  s_waitcnt lgkmcnt(0)
  s_barrier
  ds_read_b64_tr_b16 v[60:61], v120 offset:0
  ds_read_b64_tr_b16 v[62:63], v121 offset:0
  ds_read_b64_tr_b16 v[64:65], v126 offset:0
  ds_read_b64_tr_b16 v[66:67], v127 offset:0
  ds_read_b64_tr_b16 v[68:69], v120 offset:43328
  ds_read_b64_tr_b16 v[70:71], v121 offset:43328
  ds_read_b64_tr_b16 v[72:73], v126 offset:43328
  ds_read_b64_tr_b16 v[74:75], v127 offset:43328
  ds_read_b64_tr_b16 v[76:77], v122 offset:0
  ds_read_b64_tr_b16 v[78:79], v123 offset:0
  ds_read_b64_tr_b16 v[80:81], v128 offset:0
  ds_read_b64_tr_b16 v[82:83], v129 offset:0
  ds_read_b64_tr_b16 v[84:85], v122 offset:43328
  ds_read_b64_tr_b16 v[86:87], v123 offset:43328
  ds_read_b64_tr_b16 v[88:89], v128 offset:43328
  ds_read_b64_tr_b16 v[90:91], v129 offset:43328
  s_cmp_ge_u32 s3, 6
  s_cbranch_scc1 L_lin
  ds_read_b64_tr_b16 v[92:93], v124 offset:0
  ds_read_b64_tr_b16 v[94:95], v125 offset:0
  ds_read_b64_tr_b16 v[96:97], v130 offset:0
  ds_read_b64_tr_b16 v[98:99], v131 offset:0
  ds_read_b64_tr_b16 v[100:101], v124 offset:43328
  ds_read_b64_tr_b16 v[102:103], v125 offset:43328
  ds_read_b64_tr_b16 v[104:105], v130 offset:43328
  ds_read_b64_tr_b16 v[106:107], v131 offset:43328
  s_waitcnt lgkmcnt(6)
  v_pk_add_f16 v92, v92, v94
  v_pk_add_f16 v93, v93, v95
  ds_write_b64 v59, v[92:93] offset:30720
  s_waitcnt lgkmcnt(5)
  v_pk_add_f16 v96, v96, v98
  v_pk_add_f16 v97, v97, v99
  s_waitcnt lgkmcnt(3)
  v_pk_add_f16 v100, v100, v102
  v_pk_add_f16 v101, v101, v103
  ds_write_b64 v59, v[100:101] offset:32768
  s_waitcnt lgkmcnt(2)
  v_pk_add_f16 v104, v104, v106
  v_pk_add_f16 v105, v105, v107
  v_cndmask_b32 v96, v96, v104, s[92:93]
  v_cndmask_b32 v97, v97, v105, s[92:93]
  ds_write_b64 v59, v[96:97] offset:31744
  ds_write_b32 v230, v104 offset:3072
  ds_write_b32 v230, v105 offset:3088
  s_branch L_p2
L_lin:
  s_and_b32 s98, s3, 1
  s_cselect_b64 vcc, -1, 0
  s_lshl_b32 s99, s98, 5
  v_mov_b32 v31, 0
  v_xor_b32 v236, s99, v236
  v_xor_b32 v237, s99, v237
  v_cndmask_b32 v238, v238, v239, vcc
  ds_read_b64_tr_b16 v[92:93], v236
  ds_read_b64_tr_b16 v[94:95], v237
  ds_read_u16_d16_hi v31, v238
  s_lshl_b32 s98, s98, 10
  v_add_u32 v29, s98, v1
  s_waitcnt lgkmcnt(2)
  v_cvt_f32_f16 v96, v92
  v_cvt_f32_f16_sdwa v97, v92 dst_sel:DWORD dst_unused:UNUSED_PAD src0_sel:WORD_1
  v_mul_f32 v96, s1, v96
  v_mul_f32 v97, s1, v97
  v_mul_f32 v96, s0, v96
  v_mul_f32 v97, s0, v97
  v_cvt_pk_bf16_f32 v92, v96, v97
  v_cvt_f32_f16 v98, v93
  v_cvt_f32_f16_sdwa v99, v93 dst_sel:DWORD dst_unused:UNUSED_PAD src0_sel:WORD_1
  v_mul_f32 v98, s1, v98
  v_mul_f32 v99, s1, v99
  v_mul_f32 v98, s0, v98
  v_mul_f32_e64 v99, s0, v99
  v_cvt_pk_bf16_f32 v93, v98, v99
  s_waitcnt lgkmcnt(1)
  v_cvt_f32_f16 v100, v94
  v_cvt_f32_f16_sdwa v101, v94 dst_sel:DWORD dst_unused:UNUSED_PAD src0_sel:WORD_1
  v_mul_f32 v100, s1, v100
  v_mul_f32 v101, s1, v101
  v_mul_f32 v100, s0, v100
  v_mul_f32 v101, s0, v101
  v_cvt_pk_bf16_f32 v94, v100, v101
  v_cvt_f32_f16 v102, v95
  v_cvt_f32_f16_sdwa v103, v95 dst_sel:DWORD dst_unused:UNUSED_PAD src0_sel:WORD_1
  v_mul_f32 v102, s1, v102
  v_mul_f32 v103, s1, v103
  s_mov_b32 exec_lo, 0
  s_mov_b32 exec_hi, 0xffff
  s_waitcnt lgkmcnt(0)
  v_mov_b32 v102, v31
  s_mov_b64 exec, -1
  v_mul_f32 v102, s0, v102
  v_mul_f32_e64 v103, s0, v103
  v_cvt_pk_bf16_f32 v95, v102, v103
  ds_write_b128 v29, v[92:95] offset:39936
L_p2:
  v_pk_add_f16 v76, v76, v78
  v_pk_add_f16 v77, v77, v79
  ds_write_b64 v59, v[76:77] offset:18432
  v_pk_add_f16 v80, v80, v82
  v_pk_add_f16 v81, v81, v83
  v_pk_add_f16 v84, v84, v86
  v_pk_add_f16 v85, v85, v87
  ds_write_b64 v59, v[84:85] offset:20480
  v_pk_add_f16 v88, v88, v90
  v_pk_add_f16 v89, v89, v91
  v_cndmask_b32 v80, v80, v88, s[92:93]
  v_cndmask_b32 v81, v81, v89, s[92:93]
  ds_write_b64 v59, v[80:81] offset:19456
  ds_write_b32 v230, v88 offset:1024
  ds_write_b32 v230, v89 offset:1040
  v_pk_add_f16 v60, v60, v62
  v_pk_add_f16 v61, v61, v63
  ds_write_b64 v59, v[60:61] offset:6144
  v_pk_add_f16 v64, v64, v66
  v_pk_add_f16 v65, v65, v67
  v_pk_add_f16 v68, v68, v70
  v_pk_add_f16 v69, v69, v71
  ds_write_b64 v59, v[68:69] offset:8192
  v_pk_add_f16 v72, v72, v74
  v_pk_add_f16 v73, v73, v75
  v_cndmask_b32 v64, v64, v72, s[92:93]
  v_cndmask_b32 v65, v65, v73, s[92:93]
  ds_write_b64 v59, v[64:65] offset:7168
  s_cmp_lt_u32 s3, 2
  s_cbranch_scc1 L_p2d
  v_subrev_u32 v230, 1024, v230
  ds_write_b32 v230, v72 offset:0
  ds_write_b32 v230, v73 offset:16
  s_branch L_built
L_p2d:
  ds_write_b64 v231, v[72:73] offset:5120
L_built:
  s_mov_b32 s0, s74
  s_mov_b32 s1, s75
  s_mov_b32 s96, 0x3e000000
  s_mov_b32 s97, 0x43000000
  s_mov_b32 s51, 1
  s_mul_i32 s98, s3, 1536
  s_add_u32 s98, s98, 116736
  s_cmp_lg_u32 s84, 0
  s_cbranch_scc1 L_g1c
  s_sub_u32 s94, s94, 416
  s_waitcnt vmcnt(0)
  ds_read_u16_d16_hi v32, v10 offset:0
  ds_read_u16_d16_hi v33, v10 offset:2
  ds_read_u16_d16_hi v34, v10 offset:2112
  ds_read_u16_d16_hi v35, v10 offset:2114
  ds_read_u16_d16_hi v36, v10 offset:128
  ds_read_u16_d16_hi v37, v10 offset:130
  ds_read_u16_d16_hi v38, v10 offset:2240
  ds_read_u16_d16_hi v39, v10 offset:2242
  ds_read_u16_d16_hi v40, v10 offset:256
  ds_read_u16_d16_hi v41, v10 offset:258
  ds_read_u16_d16_hi v42, v10 offset:2368
  ds_read_u16_d16_hi v43, v10 offset:2370
  ds_read_u16_d16_hi v44, v10 offset:384
  ds_read_u16_d16_hi v45, v10 offset:386
  ds_read_u16_d16_hi v46, v10 offset:2496
  ds_read_u16_d16_hi v47, v10 offset:2498
  ds_read_u16_d16_hi v48, v10 offset:512
  ds_read_u16_d16_hi v49, v10 offset:514
  ds_read_u16_d16_hi v50, v10 offset:2624
  ds_read_u16_d16_hi v51, v10 offset:2626
  ds_read_u16_d16_hi v52, v10 offset:640
  ds_read_u16_d16_hi v53, v10 offset:642
  ds_read_u16_d16_hi v54, v10 offset:2752
  ds_read_u16_d16_hi v55, v10 offset:2754
  ds_read_u16_d16_hi v56, v10 offset:768
  ds_read_u16_d16_hi v57, v10 offset:770
  s_waitcnt lgkmcnt(14)
  v_max3_f32 v58, |v32|, |v33|, 0
  v_cvt_pk_f16_f32 v184, v32, v33
  v_max3_f32 v58, |v34|, |v35|, v58
  v_cvt_pk_f16_f32 v185, v34, v35
  v_max3_f32 v58, |v36|, |v37|, v58
  v_cvt_pk_f16_f32 v186, v36, v37
  v_max3_f32 v58, |v38|, |v39|, v58
  v_cvt_pk_f16_f32 v187, v38, v39
  v_max3_f32 v58, |v40|, |v41|, v58
  v_cvt_pk_f16_f32 v188, v40, v41
  v_max3_f32 v58, |v42|, |v43|, v58
  v_cvt_pk_f16_f32 v189, v42, v43
  s_waitcnt lgkmcnt(12)
  v_max3_f32 v58, |v44|, |v45|, v58
  v_cvt_pk_f16_f32 v190, v44, v45
  s_waitcnt lgkmcnt(10)
  v_max3_f32 v58, |v46|, |v47|, v58
  v_cvt_pk_f16_f32 v191, v46, v47
  s_waitcnt lgkmcnt(8)
  v_max3_f32 v58, |v48|, |v49|, v58
  v_cvt_pk_f16_f32 v192, v48, v49
  s_waitcnt lgkmcnt(6)
  v_max3_f32 v58, |v50|, |v51|, v58
  v_cvt_pk_f16_f32 v193, v50, v51
  s_waitcnt lgkmcnt(4)
  v_max3_f32 v58, |v52|, |v53|, v58
  v_cvt_pk_f16_f32 v194, v52, v53
  s_waitcnt lgkmcnt(2)
  v_max3_f32 v58, |v54|, |v55|, v58
  v_cvt_pk_f16_f32 v195, v54, v55
  s_waitcnt lgkmcnt(0)
  v_max3_f32 v58, |v56|, |v57|, v58
  v_cvt_pk_f16_f32 v196, v56, v57
  s_waitcnt lgkmcnt(0)
  s_barrier
  s_branch L_cin_go
L_g1c:
  s_waitcnt lgkmcnt(0)
  s_barrier
  s_add_u32 s76, s76, -63168
  s_waitcnt vmcnt(1)
  v_lshl_add_u32 v16, v16, 7, v8
  v_lshl_add_u32 v17, v17, 7, v8
  v_lshl_add_u32 v18, v18, 7, v8
  v_lshl_add_u32 v19, v19, 7, v8
  s_add_u32 m0, s76, 0
  s_mov_b32 exec_hi, 0xffffff
  buffer_load_dwordx4 v16, s[32:35], 0 offen lds
  s_add_u32 m0, s76, 1056
  s_nop 0
  buffer_load_dwordx4 v17, s[32:35], 0 offen lds
  s_add_u32 m0, s76, 2112
  s_mov_b32 exec_hi, 0xffff
  buffer_load_dwordx4 v18, s[32:35], 0 offen lds
  s_add_u32 m0, s76, 3168
  s_nop 0
  buffer_load_dwordx4 v19, s[32:35], 0 offen lds
  s_mov_b32 exec_hi, -1
  s_waitcnt vmcnt(4)
  v_lshl_add_u32 v216, v216, 7, v8
  v_lshl_add_u32 v217, v217, 7, v8
  v_lshl_add_u32 v218, v218, 7, v8
  v_lshl_add_u32 v219, v219, 7, v8
  s_add_u32 m0, s76, 16256
  s_mov_b32 exec_hi, 0xffffff
  buffer_load_dwordx4 v216, s[32:35], 0 offen lds
  s_add_u32 m0, s76, 17312
  s_nop 0
  buffer_load_dwordx4 v217, s[32:35], 0 offen lds
  s_add_u32 m0, s76, 18368
  s_mov_b32 exec_hi, 0xffff
  buffer_load_dwordx4 v218, s[32:35], 0 offen lds
  s_add_u32 m0, s76, 19424
  s_nop 0
  buffer_load_dwordx4 v219, s[32:35], 0 offen lds
  s_mov_b32 exec_hi, -1
  buffer_load_dwordx4 v[16:19], v6, s[28:31], s94 offen
  s_add_u32 s94, s94, 416
  v_add_u32 v10, -63168, v10
  v_add_u32 v4, -63168, v4
  v_add_u32 v5, -63168, v5
  ds_write_b32 v10, v7 offset:2880
  ds_write_b32 v10, v7 offset:19136
L_g1d:
  s_waitcnt vmcnt(5)
  ds_read_u16_d16_hi v32, v10 offset:0
  ds_read_u16_d16_hi v33, v10 offset:2
  ds_read_u16_d16_hi v34, v10 offset:2112
  ds_read_u16_d16_hi v35, v10 offset:2114
  ds_read_u16_d16_hi v36, v10 offset:128
  ds_read_u16_d16_hi v37, v10 offset:130
  ds_read_u16_d16_hi v38, v10 offset:2240
  ds_read_u16_d16_hi v39, v10 offset:2242
  ds_read_u16_d16_hi v40, v10 offset:256
  ds_read_u16_d16_hi v41, v10 offset:258
  ds_read_u16_d16_hi v42, v10 offset:2368
  ds_read_u16_d16_hi v43, v10 offset:2370
  ds_read_u16_d16_hi v44, v10 offset:384
  ds_read_u16_d16_hi v45, v10 offset:386
  ds_read_u16_d16_hi v46, v10 offset:2496
  ds_read_u16_d16_hi v47, v10 offset:2498
  ds_read_u16_d16_hi v48, v10 offset:512
  ds_read_u16_d16_hi v49, v10 offset:514
  ds_read_u16_d16_hi v50, v10 offset:2624
  ds_read_u16_d16_hi v51, v10 offset:2626
  ds_read_u16_d16_hi v52, v10 offset:640
  ds_read_u16_d16_hi v53, v10 offset:642
  ds_read_u16_d16_hi v54, v10 offset:2752
  ds_read_u16_d16_hi v55, v10 offset:2754
  ds_read_u16_d16_hi v56, v10 offset:768
  ds_read_u16_d16_hi v57, v10 offset:770
  s_waitcnt lgkmcnt(14)
  v_max3_f32 v58, |v32|, |v33|, 0
  v_cvt_pk_f16_f32 v184, v32, v33
  v_max3_f32 v58, |v34|, |v35|, v58
  v_cvt_pk_f16_f32 v185, v34, v35
  v_max3_f32 v58, |v36|, |v37|, v58
  v_cvt_pk_f16_f32 v186, v36, v37
  v_max3_f32 v58, |v38|, |v39|, v58
  v_cvt_pk_f16_f32 v187, v38, v39
  v_max3_f32 v58, |v40|, |v41|, v58
  v_cvt_pk_f16_f32 v188, v40, v41
  v_max3_f32 v58, |v42|, |v43|, v58
  v_cvt_pk_f16_f32 v189, v42, v43
  s_waitcnt lgkmcnt(12)
  v_max3_f32 v58, |v44|, |v45|, v58
  v_cvt_pk_f16_f32 v190, v44, v45
  s_waitcnt lgkmcnt(10)
  v_max3_f32 v58, |v46|, |v47|, v58
  v_cvt_pk_f16_f32 v191, v46, v47
  s_waitcnt lgkmcnt(8)
  v_max3_f32 v58, |v48|, |v49|, v58
  v_cvt_pk_f16_f32 v192, v48, v49
  s_waitcnt lgkmcnt(6)
  v_max3_f32 v58, |v50|, |v51|, v58
  v_cvt_pk_f16_f32 v193, v50, v51
  s_waitcnt lgkmcnt(4)
  v_max3_f32 v58, |v52|, |v53|, v58
  v_cvt_pk_f16_f32 v194, v52, v53
  s_waitcnt lgkmcnt(2)
  v_max3_f32 v58, |v54|, |v55|, v58
  v_cvt_pk_f16_f32 v195, v54, v55
  s_waitcnt lgkmcnt(0)
  v_max3_f32 v58, |v56|, |v57|, v58
  v_cvt_pk_f16_f32 v196, v56, v57
L_cin_go:
  ds_write_b32 v11, v184 offset:0
  ds_write_b32 v11, v185 offset:160
  ds_write_b32 v11, v186 offset:320
  ds_write_b32 v11, v187 offset:480
  ds_write_b32 v11, v188 offset:640
  ds_write_b32 v11, v189 offset:800
  ds_write_b32 v11, v190 offset:960
  ds_write_b32 v11, v191 offset:1120
  ds_write_b32 v11, v192 offset:1280
  ds_write_b32 v11, v193 offset:1440
  ds_write_b32 v11, v194 offset:1600
  ds_write_b32 v11, v195 offset:1760
  ds_write_b32 v11, v196 offset:1920
  s_mov_b32 s81, 16256
  s_add_u32 s76, s76, 16256
  v_lshlrev_b32 v7, 2, v0
  v_add_u32 v7, s98, v7
L_cin_loop:
  v_cmp_le_f32 s[90:91], s97, v58
  v_cmp_le_f32 vcc, s96, v58
  s_mov_b32 s49, s74
  s_mov_b32 s50, s75
  s_cmp_lg_u64 s[90:91], 0
  s_cbranch_scc1 L_cslow
  s_cbranch_vccz L_cslow
L_cconv:
  s_cmp_lg_u32 s51, 0
  s_cbranch_scc1 L_first
  ds_read_b64_tr_b16 v[60:61], v20 offset:0
  v_mul_f32 v116, v184, v192
  v_mul_f32 v117, v185, v193
  ds_read_b64_tr_b16 v[74:75], v20 offset:32
  v_mul_f32 v118, v186, v194
  ds_read_b64_tr_b16 v[88:89], v20 offset:64
  v_mul_f32 v119, v187, v195
  ds_read_b64_tr_b16 v[102:103], v20 offset:96
  v_fmac_f32 v116, v188, v191
  ds_read_b64_tr_b16 v[66:67], v23 offset:0
  v_fmac_f32 v117, v200, v208
  ds_read_b64_tr_b16 v[80:81], v23 offset:32
  v_fmac_f32 v118, v201, v209
  ds_read_b64_tr_b16 v[94:95], v23 offset:64
  v_fmac_f32 v119, v202, v210
  ds_read_b64_tr_b16 v[108:109], v23 offset:96
  v_fmac_f32 v116, v203, v211
  ds_read_b64_tr_b16 v[68:69], v24 offset:0
  v_fmac_f32 v117, v204, v207
  ds_read_b64_tr_b16 v[82:83], v24 offset:32
  v_fmac_f32_e64 v118, v216, v224
  ds_read_b64_tr_b16 v[96:97], v24 offset:64
  v_fmac_f32 v119, v217, v225
  ds_read_b64_tr_b16 v[110:111], v24 offset:96
  v_fmac_f32 v116, v218, v226
  ds_read_b64_tr_b16 v[124:125], v4 offset:0
  v_fmac_f32 v117, v219, v227
  ds_read_b64_tr_b16 v[126:127], v5 offset:0
  v_fmac_f32 v118, v220, v223
  v_fmac_f32 v119, v232, v240
  ds_read_b64_tr_b16 v[136:137], v4 offset:32
  v_fmac_f32 v116, v233, v241
  ds_read_b64_tr_b16 v[138:139], v5 offset:32
  v_fmac_f32 v117, v234, v242
  ds_read_b64_tr_b16 v[148:149], v4 offset:64
  v_fmac_f32 v118, v235, v243
  ds_read_b64_tr_b16 v[150:151], v5 offset:64
  v_fmac_f32 v119, v236, v239
  ds_read_b64_tr_b16 v[160:161], v4 offset:96
  v_fmac_f32 v116, v189, v196
  ds_read_b64_tr_b16 v[162:163], v5 offset:96
  v_fmac_f32_e64 v117, v189, v197
  ds_read_b128 v[164:167], v1 offset:39936
  v_fmac_f32 v118, v190, v198
  ds_read_b128 v[168:171], v1 offset:40960
  v_fmac_f32 v119, v190, v199
  ds_read_b128 v[172:175], v1 offset:8192
  v_fmac_f32 v116, v205, v212
  ds_read_b128 v[176:179], v1 offset:6144
  v_fmac_f32 v117, v205, v213
  ds_read_b64_tr_b16 v[70:71], v25 offset:0
  v_fmac_f32_e64 v118, v206, v214
  ds_read_b64_tr_b16 v[84:85], v25 offset:32
  v_fmac_f32 v119, v206, v215
  ds_read_b64_tr_b16 v[98:99], v25 offset:64
  v_fmac_f32 v116, v221, v228
  v_fmac_f32 v117, v221, v229
  ds_read_b64_tr_b16 v[112:113], v25 offset:96
  v_fmac_f32 v118, v222, v230
  ds_read_b64_tr_b16 v[72:73], v26 offset:0
  v_fmac_f32 v119, v222, v231
  ds_read_b64_tr_b16 v[86:87], v26 offset:32
  v_fmac_f32 v116, v237, v244
  ds_read_b64_tr_b16 v[100:101], v26 offset:64
  v_fmac_f32 v117, v237, v245
  ds_read_b64_tr_b16 v[114:115], v26 offset:96
  v_fmac_f32 v118, v238, v246
  ds_read_b64_tr_b16 v[62:63], v21 offset:0
  v_fmac_f32 v119, v238, v247
  ds_read_b64_tr_b16 v[76:77], v21 offset:32
  v_add_f32 v116, v116, v117
  ds_read_b64_tr_b16 v[90:91], v21 offset:64
  v_add_f32_e64 v118, v118, v119
  ds_read_b64_tr_b16 v[104:105], v21 offset:96
  v_add_f32 v116, v116, v118
  ds_read_b64_tr_b16 v[64:65], v22 offset:0
  v_mul_f32 v116, s49, v116
  ds_read_b64_tr_b16 v[78:79], v22 offset:32
  v_mul_f32_e64 v116, s50, v116
  ds_read_b64_tr_b16 v[92:93], v22 offset:64
  ds_write_b32 v7, v116
  ds_read_b64_tr_b16 v[106:107], v22 offset:96
  v_add_u32 v7, 256, v7
  s_waitcnt lgkmcnt(14)
  v_pk_mul_f16 v120, v60, v67 op_sel:[0,0] op_sel_hi:[0,1]
  v_pk_mul_f16 v121, v60, v67 op_sel:[1,0] op_sel_hi:[1,1]
  v_pk_mul_f16 v122, v60, v68 op_sel:[0,0] op_sel_hi:[0,1]
  v_pk_mul_f16 v123, v60, v68 op_sel:[1,0] op_sel_hi:[1,1]
  v_pk_mul_f16 v132, v74, v81 op_sel:[0,0] op_sel_hi:[0,1]
  v_pk_mul_f16 v133, v74, v81 op_sel:[1,0] op_sel_hi:[1,1]
  v_pk_mul_f16 v134, v74, v82 op_sel:[0,0] op_sel_hi:[0,1]
  v_pk_mul_f16 v135, v74, v82 op_sel:[1,0] op_sel_hi:[1,1]
  v_pk_mul_f16 v144, v88, v95 op_sel:[0,0] op_sel_hi:[0,1]
  v_pk_mul_f16 v145, v88, v95 op_sel:[1,0] op_sel_hi:[1,1]
  v_pk_mul_f16 v146, v88, v96 op_sel:[0,0] op_sel_hi:[0,1]
  v_pk_mul_f16 v147, v88, v96 op_sel:[1,0] op_sel_hi:[1,1]
  v_pk_mul_f16 v156, v102, v109 op_sel:[0,0] op_sel_hi:[0,1]
  v_pk_mul_f16 v157, v102, v109 op_sel:[1,0] op_sel_hi:[1,1]
  v_pk_mul_f16 v158, v102, v110 op_sel:[0,0] op_sel_hi:[0,1]
  v_pk_mul_f16 v159, v102, v110 op_sel:[1,0] op_sel_hi:[1,1]
  s_waitcnt vmcnt(0)
  v_lshl_add_u32 v16, v16, 7, v8
  v_lshl_add_u32 v17, v17, 7, v8
  v_lshl_add_u32 v18, v18, 7, v8
  v_lshl_add_u32 v19, v19, 7, v8
  s_add_u32 m0, s76, 0
  s_mov_b32 exec_hi, 0xffffff
  buffer_load_dwordx4 v16, s[32:35], 0 offen lds
  s_add_u32 m0, s76, 1056
  s_nop 0
  buffer_load_dwordx4 v17, s[32:35], 0 offen lds
  s_add_u32 m0, s76, 2112
  s_mov_b32 exec_hi, 0xffff
  buffer_load_dwordx4 v18, s[32:35], 0 offen lds
  s_add_u32 m0, s76, 3168
  s_nop 0
  buffer_load_dwordx4 v19, s[32:35], 0 offen lds
  s_mov_b32 exec_hi, -1
  buffer_load_dwordx4 v[16:19], v6, s[28:31], s94 offen
  s_add_u32 s94, s94, 416
L_novm:
  v_add_u32 v10, s81, v10
  v_add_u32 v4, s81, v4
  v_add_u32 v5, s81, v5
  s_sub_u32 s76, s76, s81
  s_sub_u32 s81, 0, s81
  s_mov_b32 s51, 0
  s_waitcnt lgkmcnt(14)
  s_setprio 1
  v_mfma_f32_16x16x32_bf16 v[184:187], v[164:167], v[124:127], 0
  ds_read_b128 v[180:183], v1 offset:7168
  v_pk_mul_f16 v116, v60, v69 op_sel:[0,0] op_sel_hi:[0,1]
  v_mfma_f32_16x16x32_bf16 v[200:203], v[164:167], v[136:139], 0
  v_pk_mul_f16 v117, v60, v69 op_sel:[1,0] op_sel_hi:[1,1]
  v_mfma_f32_16x16x32_bf16 v[216:219], v[164:167], v[148:151], 0
  v_pk_mul_f16 v118, v60, v70 op_sel:[0,0] op_sel_hi:[0,1]
  v_mfma_f32_16x16x32_bf16 v[232:235], v[164:167], v[160:163], 0
  v_pk_mul_f16 v119, v60, v70 op_sel:[1,0] op_sel_hi:[1,1]
  v_mfma_f32_16x16x32_bf16 v[188:191], v[168:171], v[124:127], 0
  ds_read_b128 v[164:167], v1 offset:5120
  v_pk_mul_f16 v128, v74, v83 op_sel:[0,0] op_sel_hi:[0,1]
  v_mfma_f32_16x16x32_bf16 v[204:207], v[168:171], v[136:139], 0
  v_pk_mul_f16 v129, v74, v83 op_sel:[1,0] op_sel_hi:[1,1]
  v_mfma_f32_16x16x32_bf16 v[220:223], v[168:171], v[148:151], 0
  v_pk_mul_f16 v130, v74, v84 op_sel:[0,0] op_sel_hi:[0,1]
  v_mfma_f32_16x16x32_bf16 v[236:239], v[168:171], v[160:163], 0
  v_pk_mul_f16 v131, v74, v84 op_sel:[1,0] op_sel_hi:[1,1]
  v_mfma_f32_16x16x32_f16 v[192:195], v[172:175], v[120:123], 0
  ds_read_b128 v[168:171], v1 offset:11264
  v_pk_mul_f16 v140, v88, v97 op_sel:[0,0] op_sel_hi:[0,1]
  v_mfma_f32_16x16x32_f16 v[208:211], v[172:175], v[132:135], 0
  v_pk_mul_f16 v141, v88, v97 op_sel:[1,0] op_sel_hi:[1,1]
  v_mfma_f32_16x16x32_f16 v[224:227], v[172:175], v[144:147], 0
  s_nop 0
  s_waitcnt lgkmcnt(14)
  v_pk_mul_f16 v142, v88, v98 op_sel:[0,0] op_sel_hi:[0,1]
  v_mfma_f32_16x16x32_f16 v[240:243], v[172:175], v[156:159], 0
  v_pk_mul_f16 v143, v88, v98 op_sel:[1,0] op_sel_hi:[1,1]
  v_mfma_f32_16x16x32_f16 v[184:187], v[176:179], v[120:123], v[184:187]
  ds_read_b128 v[172:175], v1 offset:9216
  v_pk_mul_f16 v152, v102, v111 op_sel:[0,0] op_sel_hi:[0,1]
  v_mfma_f32_16x16x32_f16 v[200:203], v[176:179], v[132:135], v[200:203]
  v_pk_mul_f16 v153, v102, v111 op_sel:[1,0] op_sel_hi:[1,1]
  v_mfma_f32_16x16x32_f16 v[216:219], v[176:179], v[144:147], v[216:219]
  s_setprio 2
  s_waitcnt lgkmcnt(14)
  v_pk_mul_f16 v154, v102, v112 op_sel:[0,0] op_sel_hi:[0,1]
  v_mfma_f32_16x16x32_f16 v[232:235], v[176:179], v[156:159], v[232:235]
  s_nop 0
  s_waitcnt lgkmcnt(3)
  v_pk_mul_f16 v155, v102, v112 op_sel:[1,0] op_sel_hi:[1,1]
  v_mfma_f32_16x16x32_f16 v[188:191], v[180:183], v[120:123], v[188:191]
  ds_read_b128 v[176:179], v1 offset:10240
  v_pk_mul_f16 v124, v61, v68 op_sel:[0,0] op_sel_hi:[0,1]
  v_mfma_f32_16x16x32_f16 v[204:207], v[180:183], v[132:135], v[204:207]
  v_pk_mul_f16 v125, v61, v68 op_sel:[1,0] op_sel_hi:[1,1]
  v_mfma_f32_16x16x32_f16 v[220:223], v[180:183], v[144:147], v[220:223]
  v_pk_mul_f16 v126, v61, v69 op_sel:[0,0] op_sel_hi:[0,1]
  v_mfma_f32_16x16x32_f16 v[236:239], v[180:183], v[156:159], v[236:239]
  s_nop 0
  s_waitcnt lgkmcnt(3)
  v_pk_mul_f16 v127, v61, v69 op_sel:[1,0] op_sel_hi:[1,1]
  v_mfma_f32_16x16x32_f16 v[196:199], v[164:167], v[120:123], 0
  ds_read_b128 v[180:183], v1 offset:14336
  v_pk_mul_f16 v136, v75, v82 op_sel:[0,0] op_sel_hi:[0,1]
  v_mfma_f32_16x16x32_f16 v[212:215], v[164:167], v[132:135], 0
  v_pk_mul_f16 v120, v60, v71 op_sel:[0,0] op_sel_hi:[0,1]
  v_mfma_f32_16x16x32_f16 v[228:231], v[164:167], v[144:147], 0
  v_pk_mul_f16 v121, v60, v71 op_sel:[1,0] op_sel_hi:[1,1]
  v_mfma_f32_16x16x32_f16 v[244:247], v[164:167], v[156:159], 0
  s_waitcnt lgkmcnt(3)
  v_pk_mul_f16 v122, v60, v66 op_sel:[0,1] op_sel_hi:[0,0]
  v_mfma_f32_16x16x32_f16 v[192:195], v[168:171], v[116:119], v[192:195]
  ds_read_b128 v[164:167], v1 offset:12288
  v_pk_mul_f16 v123, v60, v72 op_sel:[0,0] op_sel_hi:[1,0]
  v_mfma_f32_16x16x32_f16 v[208:211], v[168:171], v[128:131], v[208:211]
  v_pk_mul_f16 v132, v74, v85 op_sel:[0,0] op_sel_hi:[0,1]
  v_mfma_f32_16x16x32_f16 v[224:227], v[168:171], v[140:143], v[224:227]
  s_nop 0
  v_pk_mul_f16 v133, v74, v85 op_sel:[1,0] op_sel_hi:[1,1]
  v_mfma_f32_16x16x32_f16 v[240:243], v[168:171], v[152:155], v[240:243]
  s_waitcnt lgkmcnt(3)
  v_pk_mul_f16 v134, v74, v80 op_sel:[0,1] op_sel_hi:[0,0]
  v_mfma_f32_16x16x32_f16 v[184:187], v[172:175], v[116:119], v[184:187]
  ds_read_b128 v[168:171], v1 offset:13312
  v_pk_mul_f16 v135, v74, v86 op_sel:[0,0] op_sel_hi:[1,0]
  v_mfma_f32_16x16x32_f16 v[200:203], v[172:175], v[128:131], v[200:203]
  s_nop 0
  v_pk_mul_f16 v144, v88, v99 op_sel:[0,0] op_sel_hi:[0,1]
  v_mfma_f32_16x16x32_f16 v[216:219], v[172:175], v[140:143], v[216:219]
  v_pk_mul_f16 v145, v88, v99 op_sel:[1,0] op_sel_hi:[1,1]
  v_mfma_f32_16x16x32_f16 v[232:235], v[172:175], v[152:155], v[232:235]
  s_nop 0
  s_waitcnt lgkmcnt(3)
  v_pk_mul_f16 v146, v88, v94 op_sel:[0,1] op_sel_hi:[0,0]
  v_mfma_f32_16x16x32_f16 v[188:191], v[176:179], v[116:119], v[188:191]
  ds_read_b128 v[172:175], v1 offset:0
  v_pk_mul_f16 v147, v88, v100 op_sel:[0,0] op_sel_hi:[1,0]
  v_mfma_f32_16x16x32_f16 v[204:207], v[176:179], v[128:131], v[204:207]
  v_pk_mul_f16 v156, v102, v113 op_sel:[0,0] op_sel_hi:[0,1]
  v_mfma_f32_16x16x32_f16 v[220:223], v[176:179], v[140:143], v[220:223]
  v_pk_mul_f16 v157, v102, v113 op_sel:[1,0] op_sel_hi:[1,1]
  v_mfma_f32_16x16x32_f16 v[236:239], v[176:179], v[152:155], v[236:239]
  s_nop 0
  s_waitcnt lgkmcnt(3)
  v_pk_mul_f16 v158, v102, v108 op_sel:[0,1] op_sel_hi:[0,0]
  v_mfma_f32_16x16x32_f16 v[192:195], v[180:183], v[120:123], v[192:195]
  ds_read_b128 v[176:179], v1 offset:17408
  v_pk_mul_f16 v159, v102, v114 op_sel:[0,0] op_sel_hi:[1,0]
  v_mfma_f32_16x16x32_f16 v[208:211], v[180:183], v[132:135], v[208:211]
  v_pk_mul_f16 v137, v75, v82 op_sel:[1,0] op_sel_hi:[1,1]
  v_mfma_f32_16x16x32_f16 v[224:227], v[180:183], v[144:147], v[224:227]
  v_pk_mul_f16 v138, v75, v83 op_sel:[0,0] op_sel_hi:[0,1]
  v_mfma_f32_16x16x32_f16 v[240:243], v[180:183], v[156:159], v[240:243]
  s_waitcnt lgkmcnt(3)
  v_pk_mul_f16 v139, v75, v83 op_sel:[1,0] op_sel_hi:[1,1]
  v_mfma_f32_16x16x32_f16 v[184:187], v[164:167], v[120:123], v[184:187]
  ds_read_b128 v[180:183], v1 offset:15360
  v_pk_mul_f16 v148, v89, v96 op_sel:[0,0] op_sel_hi:[0,1]
  v_mfma_f32_16x16x32_f16 v[200:203], v[164:167], v[132:135], v[200:203]
  v_pk_mul_f16 v149, v89, v96 op_sel:[1,0] op_sel_hi:[1,1]
  v_mfma_f32_16x16x32_f16 v[216:219], v[164:167], v[144:147], v[216:219]
  s_nop 0
  v_pk_mul_f16 v150, v89, v97 op_sel:[0,0] op_sel_hi:[0,1]
  v_mfma_f32_16x16x32_f16 v[232:235], v[164:167], v[156:159], v[232:235]
  s_waitcnt lgkmcnt(3)
  v_pk_mul_f16 v151, v89, v97 op_sel:[1,0] op_sel_hi:[1,1]
  v_mfma_f32_16x16x32_f16 v[188:191], v[168:171], v[120:123], v[188:191]
  ds_read_b128 v[164:167], v1 offset:16384
  v_pk_mul_f16 v160, v103, v110 op_sel:[0,0] op_sel_hi:[0,1]
  v_mfma_f32_16x16x32_f16 v[204:207], v[168:171], v[132:135], v[204:207]
  s_nop 0
  v_pk_mul_f16 v161, v103, v110 op_sel:[1,0] op_sel_hi:[1,1]
  v_mfma_f32_16x16x32_f16 v[220:223], v[168:171], v[144:147], v[220:223]
  v_pk_mul_f16 v162, v103, v111 op_sel:[0,0] op_sel_hi:[0,1]
  v_mfma_f32_16x16x32_f16 v[236:239], v[168:171], v[156:159], v[236:239]
  s_waitcnt lgkmcnt(3)
  v_pk_mul_f16 v163, v103, v111 op_sel:[1,0] op_sel_hi:[1,1]
  v_smfmac_f32_16x16x64_f16 v[196:199], v[172:175], v[116:123], v9
  s_nop 0
  ds_read_b128 v[168:171], v1 offset:20480
  v_smfmac_f32_16x16x64_f16 v[212:215], v[172:175], v[128:135], v9
  v_pk_mul_f16 v120, v61, v70 op_sel:[0,0] op_sel_hi:[0,1]
  v_smfmac_f32_16x16x64_f16 v[228:231], v[172:175], v[140:147], v9
  v_pk_mul_f16 v121, v61, v70 op_sel:[1,0] op_sel_hi:[1,1]
  v_smfmac_f32_16x16x64_f16 v[244:247], v[172:175], v[152:159], v9
  s_nop 0
  s_waitcnt lgkmcnt(3)
  v_pk_mul_f16 v122, v61, v71 op_sel:[0,0] op_sel_hi:[0,1]
  v_mfma_f32_16x16x32_f16 v[192:195], v[176:179], v[124:127], v[192:195]
  ds_read_b128 v[172:175], v1 offset:18432
  v_pk_mul_f16 v123, v61, v71 op_sel:[1,0] op_sel_hi:[1,1]
  v_mfma_f32_16x16x32_f16 v[208:211], v[176:179], v[136:139], v[208:211]
  v_pk_mul_f16 v132, v75, v84 op_sel:[0,0] op_sel_hi:[0,1]
  v_mfma_f32_16x16x32_f16 v[224:227], v[176:179], v[148:151], v[224:227]
  v_pk_mul_f16 v133, v75, v84 op_sel:[1,0] op_sel_hi:[1,1]
  v_mfma_f32_16x16x32_f16 v[240:243], v[176:179], v[160:163], v[240:243]
  s_nop 0
  s_waitcnt lgkmcnt(3)
  v_pk_mul_f16 v134, v75, v85 op_sel:[0,0] op_sel_hi:[0,1]
  v_mfma_f32_16x16x32_f16 v[184:187], v[180:183], v[124:127], v[184:187]
  ds_read_b128 v[176:179], v1 offset:19456
  v_pk_mul_f16 v135, v75, v85 op_sel:[1,0] op_sel_hi:[1,1]
  v_mfma_f32_16x16x32_f16 v[200:203], v[180:183], v[136:139], v[200:203]
  v_pk_mul_f16 v144, v89, v98 op_sel:[0,0] op_sel_hi:[0,1]
  v_mfma_f32_16x16x32_f16 v[216:219], v[180:183], v[148:151], v[216:219]
  v_pk_mul_f16 v145, v89, v98 op_sel:[1,0] op_sel_hi:[1,1]
  v_mfma_f32_16x16x32_f16 v[232:235], v[180:183], v[160:163], v[232:235]
  s_waitcnt lgkmcnt(3)
  v_pk_mul_f16 v146, v89, v99 op_sel:[0,0] op_sel_hi:[0,1]
  v_mfma_f32_16x16x32_f16 v[188:191], v[164:167], v[124:127], v[188:191]
  ds_read_b128 v[180:183], v1 offset:1024
  v_pk_mul_f16 v147, v89, v99 op_sel:[1,0] op_sel_hi:[1,1]
  v_mfma_f32_16x16x32_f16 v[204:207], v[164:167], v[136:139], v[204:207]
  s_waitcnt vmcnt(1)
  ds_read_u16_d16_hi v32, v10 offset:0
  v_pk_mul_f16 v156, v103, v112 op_sel:[0,0] op_sel_hi:[0,1]
  v_mfma_f32_16x16x32_f16 v[220:223], v[164:167], v[148:151], v[220:223]
  ds_read_u16_d16_hi v33, v10 offset:2
  v_pk_mul_f16 v157, v103, v112 op_sel:[1,0] op_sel_hi:[1,1]
  v_mfma_f32_16x16x32_f16 v[236:239], v[164:167], v[160:163], v[236:239]
  s_nop 0
  s_waitcnt lgkmcnt(5)
  v_pk_mul_f16 v158, v103, v113 op_sel:[0,0] op_sel_hi:[0,1]
  v_mfma_f32_16x16x32_f16 v[192:195], v[168:171], v[120:123], v[192:195]
  ds_read_b128 v[164:167], v1 offset:23552
  v_pk_mul_f16 v159, v103, v113 op_sel:[1,0] op_sel_hi:[1,1]
  v_mfma_f32_16x16x32_f16 v[208:211], v[168:171], v[132:135], v[208:211]
  ds_read_u16_d16_hi v34, v10 offset:2112
  v_pk_mul_f16 v116, v61, v67 op_sel:[0,1] op_sel_hi:[0,0]
  v_mfma_f32_16x16x32_f16 v[224:227], v[168:171], v[144:147], v[224:227]
  ds_read_u16_d16_hi v35, v10 offset:2114
  v_pk_mul_f16 v117, v61, v72 op_sel:[0,0] op_sel_hi:[1,0]
  v_mfma_f32_16x16x32_f16 v[240:243], v[168:171], v[156:159], v[240:243]
  s_nop 0
  s_waitcnt lgkmcnt(7)
  v_pk_mul_f16 v118, v62, v69 op_sel:[0,0] op_sel_hi:[0,1]
  v_mfma_f32_16x16x32_f16 v[184:187], v[172:175], v[120:123], v[184:187]
  ds_read_b128 v[168:171], v1 offset:21504
  v_pk_mul_f16 v119, v62, v69 op_sel:[1,0] op_sel_hi:[1,1]
  v_mfma_f32_16x16x32_f16 v[200:203], v[172:175], v[132:135], v[200:203]
  ds_read_b64_tr_b16 v[60:61], v27 offset:0
  v_pk_mul_f16 v128, v75, v81 op_sel:[0,1] op_sel_hi:[0,0]
  v_mfma_f32_16x16x32_f16 v[216:219], v[172:175], v[144:147], v[216:219]
  ds_read_u16_d16_hi v36, v10 offset:128
  v_pk_mul_f16 v129, v75, v86 op_sel:[0,0] op_sel_hi:[1,0]
  v_mfma_f32_16x16x32_f16 v[232:235], v[172:175], v[156:159], v[232:235]
  s_waitcnt lgkmcnt(9)
  v_pk_mul_f16 v130, v76, v83 op_sel:[0,0] op_sel_hi:[0,1]
  v_pk_mul_f16 v131, v76, v83 op_sel:[1,0] op_sel_hi:[1,1]
  v_mfma_f32_16x16x32_f16 v[188:191], v[176:179], v[120:123], v[188:191]
  ds_read_b128 v[172:175], v1 offset:22528
  v_pk_mul_f16 v140, v89, v95 op_sel:[0,1] op_sel_hi:[0,0]
  v_mfma_f32_16x16x32_f16 v[204:207], v[176:179], v[132:135], v[204:207]
  ds_read_b64_tr_b16 v[74:75], v27 offset:32
  v_pk_mul_f16 v141, v89, v100 op_sel:[0,0] op_sel_hi:[1,0]
  v_mfma_f32_16x16x32_f16 v[220:223], v[176:179], v[144:147], v[220:223]
  ds_read_b64_tr_b16 v[88:89], v27 offset:64
  v_pk_mul_f16 v142, v90, v97 op_sel:[0,0] op_sel_hi:[0,1]
  v_mfma_f32_16x16x32_f16 v[236:239], v[176:179], v[156:159], v[236:239]
  s_waitcnt lgkmcnt(11)
  v_pk_mul_f16 v143, v90, v97 op_sel:[1,0] op_sel_hi:[1,1]
  v_pk_mul_f16 v152, v103, v109 op_sel:[0,1] op_sel_hi:[0,0]
  v_smfmac_f32_16x16x64_f16 v[196:199], v[180:183], v[120:127], v9
  ds_read_b128 v[176:179], v1 offset:26624
  v_pk_mul_f16 v153, v103, v114 op_sel:[0,0] op_sel_hi:[1,0]
  v_smfmac_f32_16x16x64_f16 v[212:215], v[180:183], v[132:139], v9
  ds_read_b64_tr_b16 v[102:103], v27 offset:96
  v_pk_mul_f16 v154, v104, v111 op_sel:[0,0] op_sel_hi:[0,1]
  v_smfmac_f32_16x16x64_f16 v[228:231], v[180:183], v[144:151], v9
  ds_read_u16_d16_hi v37, v10 offset:130
  v_pk_mul_f16 v155, v104, v111 op_sel:[1,0] op_sel_hi:[1,1]
  v_smfmac_f32_16x16x64_f16 v[244:247], v[180:183], v[156:163], v9
  s_nop 0
  s_waitcnt lgkmcnt(11)
  v_pk_mul_f16 v120, v62, v70 op_sel:[0,0] op_sel_hi:[0,1]
  v_mfma_f32_16x16x32_f16 v[192:195], v[164:167], v[116:119], v[192:195]
  ds_read_b128 v[180:183], v1 offset:24576
  v_pk_mul_f16 v121, v62, v70 op_sel:[1,0] op_sel_hi:[1,1]
  v_mfma_f32_16x16x32_f16 v[208:211], v[164:167], v[128:131], v[208:211]
  ds_read_u16_d16_hi v38, v10 offset:2240
  v_pk_mul_f16 v122, v62, v71 op_sel:[0,0] op_sel_hi:[0,1]
  v_mfma_f32_16x16x32_f16 v[224:227], v[164:167], v[140:143], v[224:227]
  ds_read_u16_d16_hi v39, v10 offset:2242
  v_pk_mul_f16 v123, v62, v71 op_sel:[1,0] op_sel_hi:[1,1]
  v_mfma_f32_16x16x32_f16 v[240:243], v[164:167], v[152:155], v[240:243]
  s_waitcnt lgkmcnt(11)
  v_pk_mul_f16 v132, v76, v84 op_sel:[0,0] op_sel_hi:[0,1]
  v_max3_f32 v58, |v32|, |v33|, 0
  v_mfma_f32_16x16x32_f16 v[184:187], v[168:171], v[116:119], v[184:187]
  ds_read_b128 v[164:167], v1 offset:25600
  v_pk_mul_f16 v133, v76, v84 op_sel:[1,0] op_sel_hi:[1,1]
  v_mfma_f32_16x16x32_f16 v[200:203], v[168:171], v[128:131], v[200:203]
  ds_read_u16_d16_hi v40, v10 offset:256
  v_pk_mul_f16 v134, v76, v85 op_sel:[0,0] op_sel_hi:[0,1]
  v_mfma_f32_16x16x32_f16 v[216:219], v[168:171], v[140:143], v[216:219]
  ds_read_u16_d16_hi v41, v10 offset:258
  v_pk_mul_f16 v135, v76, v85 op_sel:[1,0] op_sel_hi:[1,1]
  v_mfma_f32_16x16x32_f16 v[232:235], v[168:171], v[152:155], v[232:235]
  s_waitcnt lgkmcnt(11)
  v_pk_mul_f16 v144, v90, v98 op_sel:[0,0] op_sel_hi:[0,1]
  v_max3_f32 v58, |v34|, |v35|, v58
  v_mfma_f32_16x16x32_f16 v[188:191], v[172:175], v[116:119], v[188:191]
  ds_read_b128 v[168:171], v1 offset:2048
  v_pk_mul_f16 v145, v90, v98 op_sel:[1,0] op_sel_hi:[1,1]
  v_mfma_f32_16x16x32_f16 v[204:207], v[172:175], v[128:131], v[204:207]
  ds_read_u16_d16_hi v42, v10 offset:2368
  v_pk_mul_f16 v146, v90, v99 op_sel:[0,0] op_sel_hi:[0,1]
  v_mfma_f32_16x16x32_f16 v[220:223], v[172:175], v[140:143], v[220:223]
  ds_read_u16_d16_hi v43, v10 offset:2370
  v_pk_mul_f16 v147, v90, v99 op_sel:[1,0] op_sel_hi:[1,1]
  v_mfma_f32_16x16x32_f16 v[236:239], v[172:175], v[152:155], v[236:239]
  s_nop 0
  s_waitcnt lgkmcnt(11)
  v_pk_mul_f16 v156, v104, v112 op_sel:[0,0] op_sel_hi:[0,1]
  v_mfma_f32_16x16x32_f16 v[192:195], v[176:179], v[120:123], v[192:195]
  ds_read_b128 v[172:175], v1 offset:29696
  v_pk_mul_f16 v157, v104, v112 op_sel:[1,0] op_sel_hi:[1,1]
  v_mfma_f32_16x16x32_f16 v[208:211], v[176:179], v[132:135], v[208:211]
  ds_read_u16_d16_hi v44, v10 offset:384
  v_pk_mul_f16 v158, v104, v113 op_sel:[0,0] op_sel_hi:[0,1]
  v_mfma_f32_16x16x32_f16 v[224:227], v[176:179], v[144:147], v[224:227]
  ds_read_u16_d16_hi v45, v10 offset:386
  v_pk_mul_f16 v159, v104, v113 op_sel:[1,0] op_sel_hi:[1,1]
  s_nop 1
  v_mfma_f32_16x16x32_f16 v[240:243], v[176:179], v[156:159], v[240:243]
  s_waitcnt lgkmcnt(11)
  v_pk_mul_f16 v124, v62, v68 op_sel:[0,1] op_sel_hi:[0,0]
  v_mfma_f32_16x16x32_f16 v[184:187], v[180:183], v[120:123], v[184:187]
  ds_read_b128 v[176:179], v1 offset:27648
  v_pk_mul_f16 v125, v62, v72 op_sel:[0,0] op_sel_hi:[1,0]
  v_mfma_f32_16x16x32_f16 v[200:203], v[180:183], v[132:135], v[200:203]
  ds_read_u16_d16_hi v46, v10 offset:2496
  v_pk_mul_f16 v126, v63, v70 op_sel:[0,0] op_sel_hi:[0,1]
  v_mfma_f32_16x16x32_f16 v[216:219], v[180:183], v[144:147], v[216:219]
  ds_read_u16_d16_hi v47, v10 offset:2498
  v_pk_mul_f16 v127, v63, v70 op_sel:[1,0] op_sel_hi:[1,1]
  v_mfma_f32_16x16x32_f16 v[232:235], v[180:183], v[156:159], v[232:235]
  s_waitcnt lgkmcnt(11)
  v_pk_mul_f16 v136, v76, v82 op_sel:[0,1] op_sel_hi:[0,0]
  v_pk_mul_f16 v137, v76, v86 op_sel:[0,0] op_sel_hi:[1,0]
  v_mfma_f32_16x16x32_f16 v[188:191], v[164:167], v[120:123], v[188:191]
  ds_read_b128 v[180:183], v1 offset:28672
  v_pk_mul_f16 v138, v77, v84 op_sel:[0,0] op_sel_hi:[0,1]
  v_mfma_f32_16x16x32_f16 v[204:207], v[164:167], v[132:135], v[204:207]
  ds_read_u16_d16_hi v48, v10 offset:512
  v_pk_mul_f16 v139, v77, v84 op_sel:[1,0] op_sel_hi:[1,1]
  v_mfma_f32_16x16x32_f16 v[220:223], v[164:167], v[144:147], v[220:223]
  ds_read_u16_d16_hi v49, v10 offset:514
  v_pk_mul_f16 v148, v90, v96 op_sel:[0,1] op_sel_hi:[0,0]
  v_mfma_f32_16x16x32_f16 v[236:239], v[164:167], v[156:159], v[236:239]
  s_waitcnt lgkmcnt(11)
  v_pk_mul_f16 v149, v90, v100 op_sel:[0,0] op_sel_hi:[1,0]
  v_pk_mul_f16 v150, v91, v98 op_sel:[0,0] op_sel_hi:[0,1]
  v_smfmac_f32_16x16x64_f16 v[196:199], v[168:171], v[116:123], v9
  ds_read_b128 v[164:167], v1 offset:32768
  v_pk_mul_f16 v151, v91, v98 op_sel:[1,0] op_sel_hi:[1,1]
  v_smfmac_f32_16x16x64_f16 v[212:215], v[168:171], v[128:135], v9
  ds_read_u16_d16_hi v50, v10 offset:2624
  v_pk_mul_f16 v160, v104, v110 op_sel:[0,1] op_sel_hi:[0,0]
  v_smfmac_f32_16x16x64_f16 v[228:231], v[168:171], v[140:147], v9
  ds_read_u16_d16_hi v51, v10 offset:2626
  v_pk_mul_f16 v161, v104, v114 op_sel:[0,0] op_sel_hi:[1,0]
  v_smfmac_f32_16x16x64_f16 v[244:247], v[168:171], v[152:159], v9
  s_nop 0
  s_waitcnt lgkmcnt(11)
  v_pk_mul_f16 v162, v105, v112 op_sel:[0,0] op_sel_hi:[0,1]
  v_mfma_f32_16x16x32_f16 v[192:195], v[172:175], v[124:127], v[192:195]
  ds_read_b128 v[168:171], v1 offset:30720
  v_pk_mul_f16 v163, v105, v112 op_sel:[1,0] op_sel_hi:[1,1]
  v_mfma_f32_16x16x32_f16 v[208:211], v[172:175], v[136:139], v[208:211]
  ds_read_u16_d16_hi v52, v10 offset:640
  v_pk_mul_f16 v120, v63, v71 op_sel:[0,0] op_sel_hi:[0,1]
  v_mfma_f32_16x16x32_f16 v[224:227], v[172:175], v[148:151], v[224:227]
  ds_read_u16_d16_hi v53, v10 offset:642
  v_pk_mul_f16 v121, v63, v71 op_sel:[1,0] op_sel_hi:[1,1]
  v_mfma_f32_16x16x32_f16 v[240:243], v[172:175], v[160:163], v[240:243]
  s_waitcnt lgkmcnt(11)
  v_pk_mul_f16 v122, v63, v69 op_sel:[0,1] op_sel_hi:[1,1]
  v_pk_mul_f16 v123, v63, v72 op_sel:[0,0] op_sel_hi:[1,0]
  v_mfma_f32_16x16x32_f16 v[184:187], v[176:179], v[124:127], v[184:187]
  ds_read_b128 v[172:175], v1 offset:31744
  v_pk_mul_f16 v132, v77, v85 op_sel:[0,0] op_sel_hi:[0,1]
  v_mfma_f32_16x16x32_f16 v[200:203], v[176:179], v[136:139], v[200:203]
  ds_read_u16_d16_hi v54, v10 offset:2752
  v_pk_mul_f16 v133, v77, v85 op_sel:[1,0] op_sel_hi:[1,1]
  v_mfma_f32_16x16x32_f16 v[216:219], v[176:179], v[148:151], v[216:219]
  ds_read_u16_d16_hi v55, v10 offset:2754
  v_pk_mul_f16 v134, v77, v83 op_sel:[0,1] op_sel_hi:[1,1]
  v_mfma_f32_16x16x32_f16 v[232:235], v[176:179], v[160:163], v[232:235]
  s_waitcnt lgkmcnt(11)
  v_pk_mul_f16 v135, v77, v86 op_sel:[0,0] op_sel_hi:[1,0]
  v_pk_mul_f16 v144, v91, v99 op_sel:[0,0] op_sel_hi:[0,1]
  v_mfma_f32_16x16x32_f16 v[188:191], v[180:183], v[124:127], v[188:191]
  ds_read_b128 v[176:179], v1 offset:3072
  v_pk_mul_f16 v145, v91, v99 op_sel:[1,0] op_sel_hi:[1,1]
  v_mfma_f32_16x16x32_f16 v[204:207], v[180:183], v[136:139], v[204:207]
  ds_read_u16_d16_hi v56, v10 offset:768
  v_pk_mul_f16 v146, v91, v97 op_sel:[0,1] op_sel_hi:[1,1]
  v_mfma_f32_16x16x32_f16 v[220:223], v[180:183], v[148:151], v[220:223]
  ds_read_u16_d16_hi v57, v10 offset:770
  v_pk_mul_f16 v147, v91, v100 op_sel:[0,0] op_sel_hi:[1,0]
  v_mfma_f32_16x16x32_f16 v[236:239], v[180:183], v[160:163], v[236:239]
  s_waitcnt lgkmcnt(11)
  v_pk_mul_f16 v156, v105, v113 op_sel:[0,0] op_sel_hi:[0,1]
  v_max3_f32 v58, |v36|, |v37|, v58
  v_mfma_f32_16x16x32_f16 v[192:195], v[164:167], v[120:123], v[192:195]
  ds_read_b128 v[180:183], v1 offset:35840
  v_pk_mul_f16 v157, v105, v113 op_sel:[1,0] op_sel_hi:[1,1]
  v_mfma_f32_16x16x32_f16 v[208:211], v[164:167], v[132:135], v[208:211]
  s_nop 0
  v_pk_mul_f16 v158, v105, v111 op_sel:[0,1] op_sel_hi:[1,1]
  v_max3_f32 v58, |v38|, |v39|, v58
  v_mfma_f32_16x16x32_f16 v[224:227], v[164:167], v[144:147], v[224:227]
  v_pk_mul_f16 v159, v105, v114 op_sel:[0,0] op_sel_hi:[1,0]
  v_max3_f32 v58, |v40|, |v41|, v58
  s_nop 0
  v_mfma_f32_16x16x32_f16 v[240:243], v[164:167], v[156:159], v[240:243]
  s_waitcnt lgkmcnt(9)
  v_pk_mul_f16 v116, v64, v71 op_sel:[0,0] op_sel_hi:[0,1]
  v_mfma_f32_16x16x32_f16 v[184:187], v[168:171], v[120:123], v[184:187]
  ds_read_b128 v[164:167], v1 offset:33792
  v_pk_mul_f16 v117, v64, v71 op_sel:[1,0] op_sel_hi:[1,1]
  v_mfma_f32_16x16x32_f16 v[200:203], v[168:171], v[132:135], v[200:203]
  v_pk_mul_f16 v118, v64, v70 op_sel:[0,1] op_sel_hi:[1,1]
  v_max3_f32 v58, |v42|, |v43|, v58
  v_mfma_f32_16x16x32_f16 v[216:219], v[168:171], v[144:147], v[216:219]
  v_pk_mul_f16 v119, v64, v72 op_sel:[0,0] op_sel_hi:[1,0]
  v_pk_mul_f16 v128, v78, v85 op_sel:[0,0] op_sel_hi:[0,1]
  v_mfma_f32_16x16x32_f16 v[232:235], v[168:171], v[156:159], v[232:235]
  s_waitcnt lgkmcnt(7)
  v_pk_mul_f16 v129, v78, v85 op_sel:[1,0] op_sel_hi:[1,1]
  v_pk_mul_f16 v130, v78, v84 op_sel:[0,1] op_sel_hi:[1,1]
  v_mfma_f32_16x16x32_f16 v[188:191], v[172:175], v[120:123], v[188:191]
  ds_read_b128 v[168:171], v1 offset:34816
  v_pk_mul_f16 v131, v78, v86 op_sel:[0,0] op_sel_hi:[1,0]
  v_mfma_f32_16x16x32_f16 v[204:207], v[172:175], v[132:135], v[204:207]
  v_pk_mul_f16 v140, v92, v99 op_sel:[0,0] op_sel_hi:[0,1]
  v_pk_mul_f16 v141, v92, v99 op_sel:[1,0] op_sel_hi:[1,1]
  v_mfma_f32_16x16x32_f16 v[220:223], v[172:175], v[144:147], v[220:223]
  v_pk_mul_f16 v142, v92, v98 op_sel:[0,1] op_sel_hi:[1,1]
  v_pk_mul_f16 v143, v92, v100 op_sel:[0,0] op_sel_hi:[1,0]
  v_mfma_f32_16x16x32_f16 v[236:239], v[172:175], v[156:159], v[236:239]
  s_waitcnt lgkmcnt(5)
  v_pk_mul_f16 v152, v106, v113 op_sel:[0,0] op_sel_hi:[0,1]
  v_smfmac_f32_16x16x64_f16 v[196:199], v[176:179], v[120:127], v9
  ds_read_b128 v[172:175], v1 offset:38912
  v_pk_mul_f16 v153, v106, v113 op_sel:[1,0] op_sel_hi:[1,1]
  v_smfmac_f32_16x16x64_f16 v[212:215], v[176:179], v[132:139], v9
  v_pk_mul_f16 v154, v106, v112 op_sel:[0,1] op_sel_hi:[1,1]
  v_smfmac_f32_16x16x64_f16 v[228:231], v[176:179], v[144:151], v9
  v_pk_mul_f16 v155, v106, v114 op_sel:[0,0] op_sel_hi:[1,0]
  v_smfmac_f32_16x16x64_f16 v[244:247], v[176:179], v[156:163], v9
  s_waitcnt lgkmcnt(3)
  v_pk_mul_f16 v120, v65, v71 op_sel:[0,1] op_sel_hi:[1,1]
  v_mfma_f32_16x16x32_f16 v[192:195], v[180:183], v[116:119], v[192:195]
  ds_read_b128 v[176:179], v1 offset:36864
  v_pk_mul_f16 v121, v65, v72 op_sel:[0,0] op_sel_hi:[1,0]
  v_mfma_f32_16x16x32_f16 v[208:211], v[180:183], v[128:131], v[208:211]
  s_nop 0
  v_pk_mul_f16 v122, v72, v72 op_sel:[0,0] op_sel_hi:[1,1]
  v_max3_f32 v58, |v44|, |v45|, v58
  v_mfma_f32_16x16x32_f16 v[224:227], v[180:183], v[140:143], v[224:227]
  v_pk_mul_f16 v123, v60, v61 op_sel:[0,0] op_sel_hi:[1,1]
  v_max3_f32 v58, |v46|, |v47|, v58
  v_mfma_f32_16x16x32_f16 v[240:243], v[180:183], v[152:155], v[240:243]
  s_nop 0
  s_waitcnt lgkmcnt(3)
  v_pk_mul_f16 v132, v79, v85 op_sel:[0,1] op_sel_hi:[1,1]
  v_mfma_f32_16x16x32_f16 v[184:187], v[164:167], v[116:119], v[184:187]
  ds_read_b128 v[180:183], v1 offset:37888
  v_pk_mul_f16 v133, v79, v86 op_sel:[0,0] op_sel_hi:[1,0]
  v_mfma_f32_16x16x32_f16 v[200:203], v[164:167], v[128:131], v[200:203]
  v_pk_mul_f16 v134, v86, v86 op_sel:[0,0] op_sel_hi:[1,1]
  v_max3_f32 v58, |v48|, |v49|, v58
  v_mfma_f32_16x16x32_f16 v[216:219], v[164:167], v[140:143], v[216:219]
  v_pk_mul_f16 v135, v74, v75 op_sel:[0,0] op_sel_hi:[1,1]
  v_max3_f32 v58, |v50|, |v51|, v58
  v_mfma_f32_16x16x32_f16 v[232:235], v[164:167], v[152:155], v[232:235]
  s_waitcnt lgkmcnt(3)
  v_pk_mul_f16 v144, v93, v99 op_sel:[0,1] op_sel_hi:[1,1]
  v_mfma_f32_16x16x32_f16 v[188:191], v[168:171], v[116:119], v[188:191]
  ds_read_b128 v[164:167], v1 offset:4096
  v_pk_mul_f16 v145, v93, v100 op_sel:[0,0] op_sel_hi:[1,0]
  v_mfma_f32_16x16x32_f16 v[204:207], v[168:171], v[128:131], v[204:207]
  s_nop 0
  v_pk_mul_f16 v146, v100, v100 op_sel:[0,0] op_sel_hi:[1,1]
  v_max3_f32 v58, |v52|, |v53|, v58
  v_mfma_f32_16x16x32_f16 v[220:223], v[168:171], v[140:143], v[220:223]
  v_pk_mul_f16 v147, v88, v89 op_sel:[0,0] op_sel_hi:[1,1]
  v_max3_f32 v58, |v54|, |v55|, v58
  v_mfma_f32_16x16x32_f16 v[236:239], v[168:171], v[152:155], v[236:239]
  s_waitcnt lgkmcnt(3)
  v_pk_mul_f16 v156, v107, v113 op_sel:[0,1] op_sel_hi:[1,1]
  v_mfma_f32_16x16x32_f16 v[192:195], v[172:175], v[120:123], v[192:195]
  s_nop 0
  v_pk_mul_f16 v157, v107, v114 op_sel:[0,0] op_sel_hi:[1,0]
  v_max3_f32 v58, |v56|, |v57|, v58
  v_mfma_f32_16x16x32_f16 v[208:211], v[172:175], v[132:135], v[208:211]
  v_pk_mul_f16 v158, v114, v114 op_sel:[0,0] op_sel_hi:[1,1]
  v_cvt_pk_f16_f32 v62, v32, v33
  v_mfma_f32_16x16x32_f16 v[224:227], v[172:175], v[144:147], v[224:227]
  v_pk_mul_f16 v159, v102, v103 op_sel:[0,0] op_sel_hi:[1,1]
  s_nop 1
  v_mfma_f32_16x16x32_f16 v[240:243], v[172:175], v[156:159], v[240:243]
  s_waitcnt lgkmcnt(2)
  v_cvt_pk_f16_f32 v76, v34, v35
  v_cvt_pk_f16_f32 v90, v36, v37
  v_mfma_f32_16x16x32_f16 v[184:187], v[176:179], v[120:123], v[184:187]
  ds_write_b32 v11, v62 offset:0
  v_mfma_f32_16x16x32_f16 v[200:203], v[176:179], v[132:135], v[200:203]
  ds_write_b32 v11, v76 offset:160
  v_mfma_f32_16x16x32_f16 v[216:219], v[176:179], v[144:147], v[216:219]
  ds_write_b32 v11, v90 offset:320
  v_mfma_f32_16x16x32_f16 v[232:235], v[176:179], v[156:159], v[232:235]
  s_waitcnt lgkmcnt(4)
  v_cvt_pk_f16_f32 v104, v38, v39
  v_cvt_pk_f16_f32 v63, v40, v41
  v_mfma_f32_16x16x32_f16 v[188:191], v[180:183], v[120:123], v[188:191]
  ds_write_b32 v11, v104 offset:480
  v_mfma_f32_16x16x32_f16 v[204:207], v[180:183], v[132:135], v[204:207]
  ds_write_b32 v11, v63 offset:640
  v_mfma_f32_16x16x32_f16 v[220:223], v[180:183], v[144:147], v[220:223]
  v_cvt_pk_f16_f32 v77, v42, v43
  v_cvt_pk_f16_f32 v91, v44, v45
  v_mfma_f32_16x16x32_f16 v[236:239], v[180:183], v[156:159], v[236:239]
  s_waitcnt lgkmcnt(5)
  v_cvt_pk_f16_f32 v105, v46, v47
  v_cvt_pk_f16_f32 v66, v48, v49
  v_smfmac_f32_16x16x64_f16 v[196:199], v[164:167], v[116:123], v9
  ds_write_b32 v11, v77 offset:800
  v_smfmac_f32_16x16x64_f16 v[212:215], v[164:167], v[128:135], v9
  ds_write_b32 v11, v91 offset:960
  v_smfmac_f32_16x16x64_f16 v[228:231], v[164:167], v[140:147], v9
  ds_write_b32 v11, v105 offset:1120
  v_smfmac_f32_16x16x64_f16 v[244:247], v[164:167], v[152:159], v9
  ds_write_b32 v11, v66 offset:1280
  s_setprio 0
  s_sub_u32 s72, s72, 1
  s_cmp_eq_u32 s72, 0
  s_cbranch_scc1 L_cin_done
  v_cvt_pk_f16_f32 v80, v50, v51
  v_cvt_pk_f16_f32 v94, v52, v53
  v_cvt_pk_f16_f32 v108, v54, v55
  v_cvt_pk_f16_f32 v67, v56, v57
  ds_write_b32 v11, v80 offset:1440
  ds_write_b32 v11, v94 offset:1600
  ds_write_b32 v11, v108 offset:1760
  ds_write_b32 v11, v67 offset:1920
  s_branch L_cin_loop
L_cslow:
  v_max_f32_dpp v58, v58, v58 row_shr:1 row_mask:0xf bank_mask:0xf
  s_nop 1
  v_max_f32_dpp v58, v58, v58 row_shr:2 row_mask:0xf bank_mask:0xf
  s_nop 1
  v_max_f32_dpp v58, v58, v58 row_shr:4 row_mask:0xf bank_mask:0xf
  s_nop 1
  v_max_f32_dpp v58, v58, v58 row_shr:8 row_mask:0xf bank_mask:0xf
  s_nop 1
  v_max_f32_dpp v58, v58, v58 row_bcast:15 row_mask:0xa bank_mask:0xf
  s_nop 1
  v_max_f32_dpp v58, v58, v58 row_bcast:31 row_mask:0xc bank_mask:0xf
  s_nop 0
  v_readlane_b32 s98, v58, 63
  s_mov_b32 s97, 0
  s_lshr_b32 s98, s98, 23
  s_min_u32 s98, s98, 182
  s_lshr_b32 s99, s1, 23
  s_sub_u32 s99, s99, 47
  s_lshr_b32 s99, s99, 1
  s_min_u32 s99, s99, 59
  s_sub_u32 s99, 131, s99
  s_max_u32 s98, s98, s99
  s_sub_u32 s99, 258, s98
  s_lshl_b32 s100, s99, 1
  s_sub_u32 s100, s100, 127
  s_sub_u32 s95, 254, s100
  s_lshl_b32 s95, s95, 23
  v_mov_b32 v60, s95
  v_mul_f32 v61, s0, v60
  v_mul_f32 v60, s1, v60
  v_readfirstlane_b32 s74, v61
  v_readfirstlane_b32 s75, v60
  s_lshl_b32 s99, s99, 23
  s_lshl_b32 s100, s100, 23
  v_mul_f32 v60, s99, v32
  v_mul_f32 v61, s99, v33
  v_mul_f32 v62, s100, v32
  v_mul_f32 v63, s100, v33
  v_cvt_pk_f16_f32 v80, v60, v61
  v_cvt_pk_bf16_f32 v64, v62, v63
  ds_write_b32 v11, v80 offset:0
  ds_write_b32 v10, v64 offset:0
  v_mul_f32 v60, s99, v34
  v_mul_f32 v61, s99, v35
  v_mul_f32 v62, s100, v34
  v_mul_f32_e64 v63, s100, v35
  v_cvt_pk_f16_f32 v81, v60, v61
  v_cvt_pk_bf16_f32 v65, v62, v63
  ds_write_b32 v11, v81 offset:160
  ds_write_b32 v10, v65 offset:2112
  v_mul_f32 v60, s99, v36
  v_mul_f32 v61, s99, v37
  v_mul_f32 v62, s100, v36
  v_mul_f32 v63, s100, v37
  v_cvt_pk_f16_f32 v82, v60, v61
  v_cvt_pk_bf16_f32 v66, v62, v63
  ds_write_b32 v11, v82 offset:320
  ds_write_b32 v10, v66 offset:128
  v_mul_f32 v60, s99, v38
  v_mul_f32 v61, s99, v39
  v_mul_f32 v62, s100, v38
  v_mul_f32 v63, s100, v39
  v_cvt_pk_f16_f32 v83, v60, v61
  v_cvt_pk_bf16_f32 v67, v62, v63
  ds_write_b32 v11, v83 offset:480
  ds_write_b32 v10, v67 offset:2240
  v_mul_f32 v60, s99, v40
  v_mul_f32 v61, s99, v41
  v_mul_f32 v62, s100, v40
  v_mul_f32 v63, s100, v41
  v_cvt_pk_f16_f32 v84, v60, v61
  v_cvt_pk_bf16_f32 v68, v62, v63
  ds_write_b32 v11, v84 offset:640
  ds_write_b32 v10, v68 offset:256
  v_mul_f32 v60, s99, v42
  v_mul_f32 v61, s99, v43
  v_mul_f32 v62, s100, v42
  v_mul_f32 v63, s100, v43
  v_cvt_pk_f16_f32 v85, v60, v61
  v_cvt_pk_bf16_f32 v69, v62, v63
  ds_write_b32 v11, v85 offset:800
  ds_write_b32 v10, v69 offset:2368
  v_mul_f32 v60, s99, v44
  v_mul_f32 v61, s99, v45
  v_mul_f32 v62, s100, v44
  v_mul_f32 v63, s100, v45
  v_cvt_pk_f16_f32 v86, v60, v61
  v_cvt_pk_bf16_f32 v70, v62, v63
  ds_write_b32 v11, v86 offset:960
  ds_write_b32 v10, v70 offset:384
  v_mul_f32 v60, s99, v46
  v_mul_f32 v61, s99, v47
  v_mul_f32 v62, s100, v46
  v_mul_f32 v63, s100, v47
  v_cvt_pk_f16_f32 v87, v60, v61
  v_cvt_pk_bf16_f32 v71, v62, v63
  ds_write_b32 v11, v87 offset:1120
  ds_write_b32 v10, v71 offset:2496
  v_mul_f32 v60, s99, v48
  v_mul_f32 v61, s99, v49
  v_mul_f32 v62, s100, v48
  v_mul_f32 v63, s100, v49
  v_cvt_pk_f16_f32 v88, v60, v61
  v_cvt_pk_bf16_f32 v72, v62, v63
  ds_write_b32 v11, v88 offset:1280
  ds_write_b32 v10, v72 offset:512
  v_mul_f32 v60, s99, v50
  v_mul_f32 v61, s99, v51
  v_mul_f32 v62, s100, v50
  v_mul_f32 v63, s100, v51
  v_cvt_pk_f16_f32 v89, v60, v61
  v_cvt_pk_bf16_f32 v73, v62, v63
  ds_write_b32 v11, v89 offset:1440
  ds_write_b32 v10, v73 offset:2624
  v_mul_f32 v60, s99, v52
  v_mul_f32 v61, s99, v53
  v_mul_f32 v62, s100, v52
  v_mul_f32 v63, s100, v53
  v_cvt_pk_f16_f32 v90, v60, v61
  v_cvt_pk_bf16_f32 v74, v62, v63
  ds_write_b32 v11, v90 offset:1600
  ds_write_b32 v10, v74 offset:640
  v_mul_f32 v60, s99, v54
  v_mul_f32 v61, s99, v55
  v_mul_f32 v62, s100, v54
  v_mul_f32 v63, s100, v55
  v_cvt_pk_f16_f32 v91, v60, v61
  v_cvt_pk_bf16_f32 v75, v62, v63
  ds_write_b32 v11, v91 offset:1760
  ds_write_b32 v10, v75 offset:2752
  v_mul_f32 v60, s99, v56
  v_mul_f32 v61, s99, v57
  v_mul_f32 v62, s100, v56
  v_mul_f32 v63, s100, v57
  v_cvt_pk_f16_f32 v92, v60, v61
  v_cvt_pk_bf16_f32 v76, v62, v63
  ds_write_b32 v11, v92 offset:1920
  ds_write_b32 v10, v76 offset:768
  v_mov_b32 v60, s100
  v_cvt_pk_bf16_f32 v60, v60, v60
  s_mov_b32 exec_hi, 0
  ds_write_b32 v10, v60 offset:2880
  s_mov_b32 exec_hi, -1
  s_waitcnt lgkmcnt(0)
  s_branch L_cconv
L_sdown:
  s_waitcnt lgkmcnt(11)
  v_lshlrev_b32 v108, 16, v112
  v_and_b32 v109, 0xffff0000, v112
  v_mul_f32 v108, v108, v250
  v_mul_f32 v109, v109, v250
  v_cvt_pk_bf16_f32 v112, v108, v109
  v_lshlrev_b32 v108, 16, v113
  v_and_b32 v109, 0xffff0000, v113
  v_mul_f32 v108, v108, v250
  v_mul_f32 v109, v109, v250
  v_cvt_pk_bf16_f32 v113, v108, v109
  s_waitcnt lgkmcnt(10)
  v_lshlrev_b32 v108, 16, v114
  v_and_b32 v109, 0xffff0000, v114
  v_mul_f32 v108, v108, v250
  v_mul_f32 v109, v109, v250
  v_cvt_pk_bf16_f32 v114, v108, v109
  v_lshlrev_b32 v108, 16, v115
  v_and_b32 v109, 0xffff0000, v115
  v_mul_f32 v108, v108, v250
  v_mul_f32 v109, v109, v250
  v_cvt_pk_bf16_f32 v115, v108, v109
  s_waitcnt lgkmcnt(9)
  v_lshlrev_b32 v108, 16, v116
  v_and_b32 v109, 0xffff0000, v116
  v_mul_f32 v108, v108, v250
  v_mul_f32 v109, v109, v250
  v_cvt_pk_bf16_f32 v116, v108, v109
  v_lshlrev_b32 v108, 16, v117
  v_and_b32 v109, 0xffff0000, v117
  v_mul_f32 v108, v108, v250
  v_mul_f32 v109, v109, v250
  v_cvt_pk_bf16_f32 v117, v108, v109
  s_waitcnt lgkmcnt(8)
  v_lshlrev_b32 v108, 16, v118
  v_and_b32 v109, 0xffff0000, v118
  v_mul_f32 v108, v108, v250
  v_mul_f32 v109, v109, v250
  v_cvt_pk_bf16_f32 v118, v108, v109
  v_lshlrev_b32 v108, 16, v119
  v_and_b32 v109, 0xffff0000, v119
  v_mul_f32 v108, v108, v250
  v_mul_f32_e64 v109, v109, v250
  v_cvt_pk_bf16_f32 v119, v108, v109
  s_branch L_scaled
L_first:
  ds_read_b64_tr_b16 v[60:61], v20 offset:0
  ds_read_b64_tr_b16 v[74:75], v20 offset:32
  ds_read_b64_tr_b16 v[88:89], v20 offset:64
  ds_read_b64_tr_b16 v[102:103], v20 offset:96
  ds_read_b64_tr_b16 v[66:67], v23 offset:0
  ds_read_b64_tr_b16 v[80:81], v23 offset:32
  ds_read_b64_tr_b16 v[94:95], v23 offset:64
  ds_read_b64_tr_b16 v[108:109], v23 offset:96
  ds_read_b64_tr_b16 v[68:69], v24 offset:0
  ds_read_b64_tr_b16 v[82:83], v24 offset:32
  ds_read_b64_tr_b16 v[96:97], v24 offset:64
  ds_read_b64_tr_b16 v[110:111], v24 offset:96
  ds_read_b64_tr_b16 v[124:125], v4 offset:0
  ds_read_b64_tr_b16 v[126:127], v5 offset:0
  ds_read_b64_tr_b16 v[136:137], v4 offset:32
  ds_read_b64_tr_b16 v[138:139], v5 offset:32
  ds_read_b64_tr_b16 v[148:149], v4 offset:64
  ds_read_b64_tr_b16 v[150:151], v5 offset:64
  ds_read_b64_tr_b16 v[160:161], v4 offset:96
  ds_read_b64_tr_b16 v[162:163], v5 offset:96
  ds_read_b128 v[164:167], v1 offset:39936
  ds_read_b128 v[168:171], v1 offset:40960
  ds_read_b128 v[172:175], v1 offset:8192
  ds_read_b128 v[176:179], v1 offset:6144
  ds_read_b64_tr_b16 v[70:71], v25 offset:0
  ds_read_b64_tr_b16 v[84:85], v25 offset:32
  ds_read_b64_tr_b16 v[98:99], v25 offset:64
  ds_read_b64_tr_b16 v[112:113], v25 offset:96
  ds_read_b64_tr_b16 v[72:73], v26 offset:0
  s_waitcnt lgkmcnt(14)
  v_pk_mul_f16 v120, v60, v67 op_sel:[0,0] op_sel_hi:[0,1]
  v_pk_mul_f16 v121, v60, v67 op_sel:[1,0] op_sel_hi:[1,1]
  ds_read_b64_tr_b16 v[86:87], v26 offset:32
  v_pk_mul_f16 v122, v60, v68 op_sel:[0,0] op_sel_hi:[0,1]
  ds_read_b64_tr_b16 v[100:101], v26 offset:64
  v_pk_mul_f16 v123, v60, v68 op_sel:[1,0] op_sel_hi:[1,1]
  ds_read_b64_tr_b16 v[114:115], v26 offset:96
  v_pk_mul_f16 v132, v74, v81 op_sel:[0,0] op_sel_hi:[0,1]
  v_pk_mul_f16 v133, v74, v81 op_sel:[1,0] op_sel_hi:[1,1]
  ds_read_b64_tr_b16 v[62:63], v21 offset:0
  v_pk_mul_f16 v134, v74, v82 op_sel:[0,0] op_sel_hi:[0,1]
  ds_read_b64_tr_b16 v[76:77], v21 offset:32
  v_pk_mul_f16 v135, v74, v82 op_sel:[1,0] op_sel_hi:[1,1]
  ds_read_b64_tr_b16 v[90:91], v21 offset:64
  v_pk_mul_f16 v144, v88, v95 op_sel:[0,0] op_sel_hi:[0,1]
  v_pk_mul_f16 v145, v88, v95 op_sel:[1,0] op_sel_hi:[1,1]
  ds_read_b64_tr_b16 v[104:105], v21 offset:96
  v_pk_mul_f16 v146, v88, v96 op_sel:[0,0] op_sel_hi:[0,1]
  ds_read_b64_tr_b16 v[64:65], v22 offset:0
  v_pk_mul_f16 v147, v88, v96 op_sel:[1,0] op_sel_hi:[1,1]
  ds_read_b64_tr_b16 v[78:79], v22 offset:32
  v_pk_mul_f16 v156, v102, v109 op_sel:[0,0] op_sel_hi:[0,1]
  v_pk_mul_f16 v157, v102, v109 op_sel:[1,0] op_sel_hi:[1,1]
  ds_read_b64_tr_b16 v[92:93], v22 offset:64
  v_pk_mul_f16 v158, v102, v110 op_sel:[0,0] op_sel_hi:[0,1]
  ds_read_b64_tr_b16 v[106:107], v22 offset:96
  v_pk_mul_f16 v159, v102, v110 op_sel:[1,0] op_sel_hi:[1,1]
  s_branch L_novm
L_end:
  s_endpgm
.p2align 8
L_tables:
.long 0x0, 0x1800, 0x6c80, 0x81a0, 0x8, 0x1808, 0x6c88, 0x81a8
.long 0x10, 0x1810, 0x6c90, 0x81b0, 0x18, 0x1818, 0x6c98, 0x81b8
.long 0x40, 0x1d48, 0x71c8, 0x86e8, 0x48, 0x1d50, 0x71d0, 0x86f0
.long 0x50, 0x1d58, 0x71d8, 0x86f8, 0x58, 0x1d60, 0x71e0, 0x8700
.long 0x80, 0x2290, 0x7710, 0x8c30, 0x88, 0x2298, 0x7718, 0x8c38
.long 0x90, 0x22a0, 0x7720, 0x8c40, 0x98, 0x22a8, 0x7728, 0x8c48
.long 0xc0, 0x27d8, 0x7c58, 0x9178, 0xc8, 0x27e0, 0x7c60, 0x9180
.long 0xd0, 0x27e8, 0x7c68, 0x9188, 0xd8, 0x27f0, 0x7c70, 0x9190
.long 0x20, 0x1820, 0x6ca0, 0x81c0, 0x28, 0x1828, 0x6ca8, 0x81c8
.long 0x30, 0x1830, 0x6cb0, 0x81d0, 0x38, 0x1838, 0x6cb8, 0x81d8
.long 0x60, 0x1d68, 0x71e8, 0x8708, 0x68, 0x1d70, 0x71f0, 0x8710
.long 0x70, 0x1d78, 0x71f8, 0x8718, 0x78, 0x1d80, 0x7200, 0x8720
.long 0xa0, 0x22b0, 0x7730, 0x8c50, 0xa8, 0x22b8, 0x7738, 0x8c58
.long 0xb0, 0x22c0, 0x7740, 0x8c60, 0xb8, 0x22c8, 0x7748, 0x8c68
.long 0xe0, 0x27f8, 0x7c78, 0x9198, 0xe8, 0x2800, 0x7c80, 0x91a0
.long 0xf0, 0x2808, 0x7c88, 0x91a8, 0xf8, 0x2810, 0x7c90, 0x91b0
.long 0x200, 0x4240, 0x96c0, 0x9c08, 0x208, 0x4248, 0x96c8, 0x9c10
.long 0x210, 0x4250, 0x96d0, 0x9c18, 0x218, 0x4258, 0x96d8, 0x9c20
.long 0x240, 0x4788, 0x9c08, 0x9c08, 0x248, 0x4790, 0x9c10, 0x9c10
.long 0x250, 0x4798, 0x9c18, 0x9c18, 0x258, 0x47a0, 0x9c20, 0x9c20
.long 0x280, 0x4cd0, 0x9c08, 0x9c08, 0x288, 0x4cd8, 0x9c10, 0x9c10
.long 0x290, 0x4ce0, 0x9c18, 0x9c18, 0x298, 0x4ce8, 0x9c20, 0x9c20
.long 0x2c0, 0x5218, 0x9c08, 0x9c08, 0x2c8, 0x5220, 0x9c10, 0x9c10
.long 0x2d0, 0x5228, 0x9c18, 0x9c18, 0x2d8, 0x5230, 0x9c20, 0x9c20
.long 0x220, 0x4260, 0x96e0, 0x9c28, 0x228, 0x4268, 0x96e8, 0x9c30
.long 0x230, 0x4270, 0x96f0, 0x9c38, 0x238, 0x4278, 0x96f8, 0x9c40
.long 0x260, 0x47a8, 0x9c28, 0x9c28, 0x268, 0x47b0, 0x9c30, 0x9c30
.long 0x270, 0x47b8, 0x9c38, 0x9c38, 0x278, 0x47c0, 0x9c40, 0x9c40
.long 0x2a0, 0x4cf0, 0x9c28, 0x9c28, 0x2a8, 0x4cf8, 0x9c30, 0x9c30
.long 0x2b0, 0x4d00, 0x9c38, 0x9c38, 0x2b8, 0x4d08, 0x9c40, 0x9c40
.long 0x2e0, 0x5238, 0x9c28, 0x9c28, 0x2e8, 0x5240, 0x9c30, 0x9c30
.long 0x2f0, 0x5248, 0x9c38, 0x9c38, 0x2f8, 0x5250, 0x9c40, 0x9c40
.long 0xaae0, 0xa680, 0xa900, 0xaae0, 0xaae8, 0xa688, 0xa908, 0xaae8
.long 0xaaf0, 0xa690, 0xa910, 0xaaf0, 0xaaf8, 0xa698, 0xa918, 0xaaf8
.long 0xaa40, 0xa860, 0xa9a0, 0xaa40, 0xaa48, 0xa868, 0xa9a8, 0xaa48
.long 0xaa50, 0xa870, 0xa9b0, 0xaa50, 0xaa58, 0xa878, 0xa9b8, 0xaa58
.long 0xa400, 0xa7c0, 0xa540, 0xa400, 0xa408, 0xa7c8, 0xa548, 0xa408
.long 0xa410, 0xa7d0, 0xa550, 0xa410, 0xa418, 0xa7d8, 0xa558, 0xa418
.long 0xa4a0, 0xa720, 0xa5e0, 0xa4a0, 0xa4a8, 0xa728, 0xa5e8, 0xa4a8
.long 0xa4b0, 0xa730, 0xa5f0, 0xa4b0, 0xa4b8, 0xa738, 0xa5f8, 0xa4b8
.long 0xb260, 0xb4e0, 0xb6c0, 0xb260, 0xb268, 0xb4e8, 0xb6c8, 0xb268
.long 0xb270, 0xb4f0, 0xb6d0, 0xb270, 0xb278, 0xb4f8, 0xb6d8, 0xb278
.long 0xb1c0, 0xb300, 0xb760, 0xb1c0, 0xb1c8, 0xb308, 0xb768, 0xb1c8
.long 0xb1d0, 0xb310, 0xb770, 0xb1d0, 0xb1d8, 0xb318, 0xb778, 0xb1d8
.long 0xb580, 0xb440, 0xb080, 0xb580, 0xb588, 0xb448, 0xb088, 0xb588
.long 0xb590, 0xb450, 0xb090, 0xb590, 0xb598, 0xb458, 0xb098, 0xb598
.long 0xb620, 0xb3a0, 0xb120, 0xb620, 0xb628, 0xb3a8, 0xb128, 0xb628
.long 0xb630, 0xb3b0, 0xb130, 0xb630, 0xb638, 0xb3b8, 0xb138, 0xb638
.long 0xa900, 0xa400, 0xaae0, 0xb620, 0xa908, 0xa408, 0xaae8, 0xb628
.long 0xa910, 0xa410, 0xaaf0, 0xb630, 0xa918, 0xa418, 0xaaf8, 0xb638
.long 0xa9a0, 0xa4a0, 0xab80, 0xb800, 0xa9a8, 0xa4a8, 0xab88, 0xb808
.long 0xa9b0, 0xa4b0, 0xab90, 0xb810, 0xa9b8, 0xa4b8, 0xab98, 0xb818
.long 0xaa40, 0xa680, 0xa860, 0xb3a0, 0xaa48, 0xa688, 0xa868, 0xb3a8
.long 0xaa50, 0xa690, 0xa870, 0xb3b0, 0xaa58, 0xa698, 0xa878, 0xb3b8
.long 0xa720, 0xa540, 0xa7c0, 0xb1c0, 0xa728, 0xa548, 0xa7c8, 0xb1c8
.long 0xa730, 0xa550, 0xa7d0, 0xb1d0, 0xa738, 0xa558, 0xa7d8, 0xb1d8
.long 0xa5e0, 0xaae0, 0xa400, 0xb080, 0xa5e8, 0xaae8, 0xa408, 0xb088
.long 0xa5f0, 0xaaf0, 0xa410, 0xb090, 0xa5f8, 0xaaf8, 0xa418, 0xb098
.long 0xa7c0, 0xa540, 0xa720, 0xb760, 0xa7c8, 0xa548, 0xa728, 0xb768
.long 0xa7d0, 0xa550, 0xa730, 0xb770, 0xa7d8, 0xa558, 0xa738, 0xb778
.long 0xa860, 0xa680, 0xaa40, 0xb440, 0xa868, 0xa688, 0xaa48, 0xb448
.long 0xa870, 0xa690, 0xaa50, 0xb450, 0xa878, 0xa698, 0xaa58, 0xb458
.long 0xab80, 0xa4a0, 0xa9a0, 0xb4e0, 0xab88, 0xa4a8, 0xa9a8, 0xb4e8
.long 0xab90, 0xa4b0, 0xa9b0, 0xb4f0, 0xab98, 0xa4b8, 0xa9b8, 0xb4f8
.long 0xa680, 0xa900, 0xab80, 0xa4a0, 0xa688, 0xa908, 0xab88, 0xa4a8
.long 0xa690, 0xa910, 0xab90, 0xa4b0, 0xa698, 0xa918, 0xab98, 0xa4b8
.long 0xa860, 0xa9a0, 0xb1c0, 0xb440, 0xa868, 0xa9a8, 0xb1c8, 0xb448
.long 0xa870, 0xa9b0, 0xb1d0, 0xb450, 0xa878, 0xa9b8, 0xb1d8, 0xb458
.long 0xa7c0, 0xa540, 0xab80, 0xa4a0, 0xa7c8, 0xa548, 0xab88, 0xa4a8
.long 0xa7d0, 0xa550, 0xab90, 0xa4b0, 0xa7d8, 0xa558, 0xab98, 0xa4b8
.long 0xa720, 0xa5e0, 0xb1c0, 0xb440, 0xa728, 0xa5e8, 0xb1c8, 0xb448
.long 0xa730, 0xa5f0, 0xb1d0, 0xb450, 0xa738, 0xa5f8, 0xb1d8, 0xb458
.long 0xb4e0, 0xb6c0, 0xb800, 0xa860, 0xb4e8, 0xb6c8, 0xb808, 0xa868
.long 0xb4f0, 0xb6d0, 0xb810, 0xa870, 0xb4f8, 0xb6d8, 0xb818, 0xa878
.long 0xb300, 0xb760, 0xa540, 0xa900, 0xb308, 0xb768, 0xa548, 0xa908
.long 0xb310, 0xb770, 0xa550, 0xa910, 0xb318, 0xb778, 0xa558, 0xa918
.long 0xb440, 0xb080, 0xb800, 0xa860, 0xb448, 0xb088, 0xb808, 0xa868
.long 0xb450, 0xb090, 0xb810, 0xa870, 0xb458, 0xb098, 0xb818, 0xa878
.long 0xb3a0, 0xb120, 0xa540, 0xa900, 0xb3a8, 0xb128, 0xa548, 0xa908
.long 0xb3b0, 0xb130, 0xa550, 0xa910, 0xb3b8, 0xb138, 0xa558, 0xa918
.long 0xb120, 0xb580, 0xb080, 0xb300, 0xb128, 0xb588, 0xb088, 0xb308
.long 0xb130, 0xb590, 0xb090, 0xb310, 0xb138, 0xb598, 0xb098, 0xb318
.long 0xb6c0, 0xb4e0, 0xaa40, 0xb6c0, 0xb6c8, 0xb4e8, 0xaa48, 0xb6c8
.long 0xb6d0, 0xb4f0, 0xaa50, 0xb6d0, 0xb6d8, 0xb4f8, 0xaa58, 0xb6d8
.long 0xb300, 0xb440, 0xb080, 0xb300, 0xb308, 0xb448, 0xb088, 0xb308
.long 0xb310, 0xb450, 0xb090, 0xb310, 0xb318, 0xb458, 0xb098, 0xb318
.long 0xb260, 0xb760, 0xaa40, 0xb6c0, 0xb268, 0xb768, 0xaa48, 0xb6c8
.long 0xb270, 0xb770, 0xaa50, 0xb6d0, 0xb278, 0xb778, 0xaa58, 0xb6d8
.long 0xb580, 0xb120, 0xb620, 0xa680, 0xb588, 0xb128, 0xb628, 0xa688
.long 0xb590, 0xb130, 0xb630, 0xa690, 0xb598, 0xb138, 0xb638, 0xa698
.long 0xb260, 0xb1c0, 0xa7c0, 0xa680, 0xb268, 0xb1c8, 0xa7c8, 0xa688
.long 0xb270, 0xb1d0, 0xa7d0, 0xa690, 0xb278, 0xb1d8, 0xa7d8, 0xa698
.long 0xb300, 0xb3a0, 0xb620, 0xb300, 0xb308, 0xb3a8, 0xb628, 0xb308
.long 0xb310, 0xb3b0, 0xb630, 0xb310, 0xb318, 0xb3b8, 0xb638, 0xb318
.long 0xb6c0, 0xb800, 0xa7c0, 0xb300, 0xb6c8, 0xb808, 0xa7c8, 0xb308
.long 0xb6d0, 0xb810, 0xa7d0, 0xb310, 0xb6d8, 0xb818, 0xa7d8, 0xb318
.long 0x0, 0x200, 0x0, 0x3f803f80, 0x8, 0x208, 0x0, 0x3f803f80
.long 0x10, 0x210, 0x0, 0x3f803f80, 0x18, 0x218, 0x0, 0x3f803f80
.long 0x420, 0x620, 0x0, 0x3f803f80, 0x428, 0x628, 0x0, 0x3f803f80
.long 0x430, 0x630, 0x0, 0x3f803f80, 0x438, 0x638, 0x0, 0x3f803f80
.long 0x840, 0xa40, 0x10, 0x3f803f80, 0x848, 0xa48, 0x10, 0x3f803f80
.long 0x850, 0xa50, 0x10, 0x3f803f80, 0x858, 0xa58, 0x10, 0x3f803f80
.long 0xc60, 0xe60, 0x10, 0x3f803f80, 0xc68, 0xe68, 0x10, 0x3f803f80
.long 0xc70, 0xe70, 0x10, 0x3f803f80, 0xc78, 0xe78, 0x10, 0x3f803f80
.long 0x80, 0x280, 0x20, 0x3f803f80, 0x88, 0x288, 0x20, 0x3f803f80
.long 0x90, 0x290, 0x20, 0x3f803f80, 0x98, 0x298, 0x20, 0x3f803f80
.long 0x4a0, 0x6a0, 0x20, 0x3f803f80, 0x4a8, 0x6a8, 0x20, 0x3f803f80
.long 0x4b0, 0x6b0, 0x20, 0x3f803f80, 0x4b8, 0x6b8, 0x20, 0x3f803f80
.long 0x8c0, 0xac0, 0x30, 0x3f803f80, 0x8c8, 0xac8, 0x30, 0x3f803f80
.long 0x8d0, 0xad0, 0x30, 0x3f803f80, 0x8d8, 0xad8, 0x30, 0x3f803f80
.long 0xce0, 0xee0, 0x30, 0x3f803f80, 0xce8, 0xee8, 0x30, 0x3f803f80
.long 0xcf0, 0xef0, 0x30, 0x3f803f80, 0xcf8, 0xef8, 0x30, 0x3f803f80
.long 0x100, 0x300, 0x40, 0x0, 0x108, 0x308, 0x40, 0x0
.long 0x110, 0x310, 0x40, 0x0, 0x118, 0x318, 0x40, 0x0
.long 0x520, 0x720, 0x40, 0x0, 0x528, 0x728, 0x40, 0x0
.long 0x530, 0x730, 0x40, 0x0, 0x538, 0x738, 0x40, 0x0
.long 0x940, 0xb40, 0x50, 0x0, 0x948, 0xb48, 0x50, 0x0
.long 0x950, 0xb50, 0x50, 0x0, 0x958, 0xb58, 0x50, 0x0
.long 0xd60, 0xf60, 0x50, 0x0, 0xd68, 0xf68, 0x50, 0x0
.long 0xd70, 0xf70, 0x50, 0x0, 0xd78, 0xf78, 0x50, 0x0
.long 0x180, 0xf60, 0x60, 0x0, 0x188, 0xf68, 0x60, 0x0
.long 0x190, 0xf70, 0x60, 0x0, 0x198, 0xf78, 0x60, 0x0
.long 0x5a0, 0xf60, 0x60, 0x0, 0x5a8, 0xf68, 0x60, 0x0
.long 0x5b0, 0xf70, 0x60, 0x0, 0x5b8, 0xf78, 0x60, 0x0
.long 0x9c0, 0xf60, 0x70, 0x0, 0x9c8, 0xf68, 0x70, 0x0
.long 0x9d0, 0xf70, 0x70, 0x0, 0x9d8, 0xf78, 0x70, 0x0
.long 0xde0, 0xf60, 0x70, 0x0, 0xde8, 0xf68, 0x70, 0x0
.long 0xdf0, 0xf70, 0x70, 0x0, 0xdf8, 0xf78, 0x70, 0x0
.long 0xffff, 0x0, 0x0, 0x0, 0x0, 0x0, 0xffff, 0x0
.long 0x0, 0x0, 0x0, 0x0, 0x0, 0x0, 0x0, 0x0
.long 0x0, 0x0, 0x0, 0x0, 0x0, 0x0, 0x0, 0x0
.long 0x0, 0x0, 0x0, 0x0, 0x0, 0x0, 0x0, 0x0
.long 0xffff0000, 0x0, 0x0, 0x0, 0x0, 0x0, 0xffff0000, 0x0
.long 0x0, 0x0, 0x0, 0x0, 0x0, 0x0, 0x0, 0x0
.long 0x0, 0x0, 0x0, 0x0, 0x0, 0x0, 0x0, 0x0
.long 0x0, 0x0, 0x0, 0x0, 0x0, 0x0, 0x0, 0x0
.long 0x0, 0xffff, 0x0, 0x0, 0x0, 0x0, 0x0, 0xffff
.long 0x0, 0x0, 0x0, 0x0, 0x0, 0x0, 0x0, 0x0
.long 0x0, 0x0, 0x0, 0x0, 0x0, 0x0, 0x0, 0x0
.long 0x0, 0x0, 0x0, 0x0, 0x0, 0x0, 0x0, 0x0
.long 0x0, 0xffff0000, 0x0, 0x0, 0x0, 0x0, 0x0, 0xffff0000
.long 0x0, 0x0, 0x0, 0x0, 0x0, 0x0, 0x0, 0x0
.long 0x0, 0x0, 0x0, 0x0, 0x0, 0x0, 0x0, 0x0
.long 0x0, 0x0, 0x0, 0x0, 0x0, 0x0, 0x0, 0x0
.long 0x0, 0x0, 0x0, 0x0, 0x0, 0x0, 0x0, 0x0
.long 0xffff, 0x0, 0x0, 0x0, 0x0, 0x0, 0xffff, 0x0
.long 0x0, 0x0, 0x0, 0x0, 0x0, 0x0, 0x0, 0x0
.long 0x0, 0x0, 0x0, 0x0, 0x0, 0x0, 0x0, 0x0
.long 0x0, 0x0, 0x0, 0x0, 0x0, 0x0, 0x0, 0x0
.long 0xffff0000, 0x0, 0x0, 0x0, 0x0, 0x0, 0xffff0000, 0x0
.long 0x0, 0x0, 0x0, 0x0, 0x0, 0x0, 0x0, 0x0
.long 0x0, 0x0, 0x0, 0x0, 0x0, 0x0, 0x0, 0x0
.long 0x0, 0x0, 0x0, 0x0, 0x0, 0x0, 0x0, 0x0
.long 0x0, 0xffff, 0x0, 0x0, 0x0, 0x0, 0x0, 0xffff
.long 0x0, 0x0, 0x0, 0x0, 0x0, 0x0, 0x0, 0x0
.long 0x0, 0x0, 0x0, 0x0, 0x0, 0x0, 0x0, 0x0
.long 0x0, 0x0, 0x0, 0x0, 0x0, 0x0, 0x0, 0x0
.long 0x0, 0xffff0000, 0x0, 0x0, 0x0, 0x0, 0x0, 0xffff0000
.long 0x0, 0x0, 0x0, 0x0, 0x0, 0x0, 0x0, 0x0
.long 0x0, 0x0, 0x0, 0x0, 0x0, 0x0, 0x0, 0x0
.long 0x0, 0x0, 0x0, 0x0, 0x0, 0x0, 0x0, 0x0
.long 0x0, 0x0, 0x0, 0x0, 0x0, 0x0, 0x0, 0x0
.long 0x0, 0x0, 0xffff, 0x0, 0x0, 0x0, 0x0, 0x0
.long 0x0, 0x0, 0x0, 0x0, 0xffff, 0x0, 0x0, 0x0
.long 0x0, 0x0, 0x0, 0x0, 0x0, 0x0, 0x0, 0x0
.long 0x0, 0x0, 0x0, 0x0, 0x0, 0x0, 0x0, 0x0
.long 0x0, 0x0, 0xffff0000, 0x0, 0x0, 0x0, 0x0, 0x0
.long 0x0, 0x0, 0x0, 0x0, 0xffff0000, 0x0, 0x0, 0x0
.long 0x0, 0x0, 0x0, 0x0, 0x0, 0x0, 0x0, 0x0
.long 0x0, 0x0, 0x0, 0x0, 0x0, 0x0, 0x0, 0x0
.long 0x0, 0x0, 0x0, 0xffff, 0x0, 0x0, 0x0, 0x0
.long 0x0, 0x0, 0x0, 0x0, 0x0, 0xffff, 0x0, 0x0
.long 0x0, 0x0, 0x0, 0x0, 0x0, 0x0, 0x0, 0x0
.long 0x0, 0x0, 0x0, 0x0, 0x0, 0x0, 0x0, 0x0
.long 0x0, 0x0, 0x0, 0xffff0000, 0x0, 0x0, 0x0, 0x0
.long 0x0, 0x0, 0x0, 0x0, 0x0, 0xffff0000, 0x0, 0x0
.long 0x0, 0x0, 0x0, 0x0, 0x0, 0x0, 0x0, 0x0
.long 0x0, 0x0, 0x0, 0x0, 0x0, 0x0, 0x0, 0x0
.long 0x0, 0x0, 0x0, 0x0, 0xffff, 0x0, 0x0, 0x0
.long 0x0, 0x0, 0x0, 0x0, 0x0, 0x0, 0x0, 0x0
.long 0x0, 0x0, 0x0, 0x0, 0x0, 0x0, 0x0, 0x0
.long 0x0, 0x0, 0x0, 0x0, 0x0, 0x0, 0x0, 0x0
.long 0x0, 0x0, 0x0, 0x0, 0xffff0000, 0x0, 0x0, 0x0
.long 0x0, 0x0, 0x0, 0x0, 0x0, 0x0, 0x0, 0x0
.long 0x0, 0x0, 0x0, 0x0, 0x0, 0x0, 0x0, 0x0
.long 0x0, 0x0, 0x0, 0x0, 0x0, 0x0, 0x0, 0x0
.long 0x0, 0x0, 0x0, 0x0, 0x0, 0x0, 0x0, 0x0
.long 0x0, 0x0, 0x0, 0x0, 0x0, 0x0, 0x0, 0x0
.long 0x0, 0x0, 0x0, 0x0, 0x0, 0x0, 0x0, 0x0
.long 0x0, 0x0, 0x0, 0x0, 0x0, 0x0, 0x0, 0x0
.long 0x0, 0x0, 0x0, 0x0, 0x0, 0x0, 0x0, 0x0
.long 0x0, 0x0, 0x0, 0x0, 0x0, 0x0, 0x0, 0x0
.long 0x14d40, 0x14d40, 0x0, 0x0, 0x14e10, 0x14e10, 0x20, 0x20
.long 0x14ee0, 0x14ee0, 0x100000, 0x100000, 0x14fb0, 0x14fb0, 0x100020, 0x100020
.long 0x15080, 0x15080, 0x40, 0x40, 0x15150, 0x15150, 0x60, 0x60
.long 0x15220, 0x15220, 0x100040, 0x100040, 0x100000, 0x100000, 0x100060, 0x100060
.long 0x14d74, 0x14d74, 0x80, 0x80, 0x14e44, 0x14e44, 0xa0, 0xa0
.long 0x14f14, 0x14f14, 0x100080, 0x100080, 0x14fe4, 0x14fe4, 0x1000a0, 0x1000a0
.long 0x150b4, 0x150b4, 0xc0, 0xc0, 0x15184, 0x15184, 0xe0, 0xe0
.long 0x15254, 0x15254, 0x1000c0, 0x1000c0, 0x100000, 0x100000, 0x1000e0, 0x1000e0
.long 0x14da8, 0x14da8, 0x8, 0x100, 0x14e78, 0x14e78, 0x28, 0x120
.long 0x14f48, 0x14f48, 0x100008, 0x100100, 0x15018, 0x15018, 0x100028, 0x100120
.long 0x150e8, 0x150e8, 0x48, 0x140, 0x151b8, 0x151b8, 0x68, 0x160
.long 0x100000, 0x100000, 0x100048, 0x100140, 0x100000, 0x100000, 0x100068, 0x100160
.long 0x14ddc, 0x14ddc, 0x88, 0x180, 0x14eac, 0x14eac, 0xa8, 0x1a0
.long 0x14f7c, 0x14f7c, 0x100088, 0x100180, 0x1504c, 0x1504c, 0x1000a8, 0x1001a0
.long 0x1511c, 0x1511c, 0xc8, 0x1c0, 0x151ec, 0x151ec, 0xe8, 0x1e0
.long 0x100000, 0x100000, 0x1000c8, 0x1001c0, 0x100000, 0x100000, 0x1000e8, 0x1001e0
.long 0x17d40, 0x114d40, 0x100, 0x200, 0x17e10, 0x114e10, 0x120, 0x220
.long 0x17ee0, 0x114ee0, 0x100100, 0x100200, 0x17fb0, 0x114fb0, 0x100120, 0x100220
.long 0x18080, 0x115080, 0x140, 0x240, 0x18150, 0x115150, 0x160, 0x260
.long 0x18220, 0x115220, 0x100140, 0x100240, 0x103000, 0x200000, 0x100160, 0x100260
.long 0x17d74, 0x114d74, 0x180, 0x280, 0x17e44, 0x114e44, 0x1a0, 0x2a0
.long 0x17f14, 0x114f14, 0x100180, 0x100280, 0x17fe4, 0x114fe4, 0x1001a0, 0x1002a0
.long 0x180b4, 0x1150b4, 0x1c0, 0x2c0, 0x18184, 0x115184, 0x1e0, 0x2e0
.long 0x18254, 0x115254, 0x1001c0, 0x1002c0, 0x103000, 0x200000, 0x1001e0, 0x1002e0
.long 0x17da8, 0x114da8, 0x108, 0x300, 0x17e78, 0x114e78, 0x128, 0x320
.long 0x17f48, 0x114f48, 0x100108, 0x100300, 0x18018, 0x115018, 0x100128, 0x100320
.long 0x180e8, 0x1150e8, 0x148, 0x340, 0x181b8, 0x1151b8, 0x168, 0x360
.long 0x103000, 0x200000, 0x100148, 0x100340, 0x103000, 0x200000, 0x100168, 0x100360
.long 0x17ddc, 0x114ddc, 0x188, 0x380, 0x17eac, 0x114eac, 0x1a8, 0x3a0
.long 0x17f7c, 0x114f7c, 0x100188, 0x100380, 0x1804c, 0x11504c, 0x1001a8, 0x1003a0
.long 0x1811c, 0x11511c, 0x1c8, 0x3c0, 0x181ec, 0x1151ec, 0x1e8, 0x3e0
.long 0x103000, 0x200000, 0x1001c8, 0x1003c0, 0x103000, 0x200000, 0x1001e8, 0x1003e0
.long 0xa400, 0xd00, 0x0, 0x14d40, 0xa440, 0xd00, 0x0, 0x14d80
.long 0xa480, 0xd00, 0x1, 0x14dd0, 0xa4c0, 0xd00, 0x1, 0x14e10
.long 0xa500, 0xd00, 0x2, 0x14e60, 0xa540, 0xd00, 0x2, 0x14ea0
.long 0xa580, 0xd00, 0x3, 0x14ef0, 0xa5c0, 0xd00, 0x3, 0x14f30
.long 0xa600, 0xd00, 0x4, 0x14f40, 0xa640, 0xd00, 0x4, 0x14f80
.long 0xa680, 0xd00, 0x5, 0x14fd0, 0xa6c0, 0xd00, 0x5, 0x15010
.long 0xa700, 0xd00, 0x6, 0x15060, 0xa740, 0xd00, 0x6, 0x150a0
.long 0xa780, 0xd00, 0x7, 0x150f0, 0xa7c0, 0xd00, 0x7, 0x15130
.long 0xa800, 0xd00, 0x8, 0x15140, 0xa840, 0xd00, 0x8, 0x15180
.long 0xa880, 0xd00, 0x9, 0x151d0, 0xa8c0, 0xd00, 0x9, 0x15210
.long 0xa900, 0xd00, 0xa, 0x15260, 0xa940, 0xd00, 0xa, 0x152a0
.long 0xa980, 0xd00, 0xb, 0x152f0, 0xa9c0, 0xd00, 0xb, 0x15330
.long 0xaa00, 0xd00, 0xc, 0x15340, 0xaa40, 0xd00, 0xc, 0x15380
.long 0x1f680, 0x40, 0xd, 0x153d0, 0x100000, 0xd00, 0xd, 0x15410
.long 0x100000, 0xd00, 0xe, 0x15460, 0x100000, 0xd00, 0xe, 0x154a0
.long 0x100000, 0xd00, 0xf, 0x154f0, 0x100000, 0xd00, 0xf, 0x15530
.long 0xa400, 0xd00, 0x2, 0x14d60, 0xa440, 0xd00, 0x2, 0x14da0
.long 0xa480, 0xd00, 0x3, 0x14df0, 0xa4c0, 0xd00, 0x3, 0x14e30
.long 0xa500, 0xd00, 0x4, 0x14e40, 0xa540, 0xd00, 0x4, 0x14e80
.long 0xa580, 0xd00, 0x5, 0x14ed0, 0xa5c0, 0xd00, 0x5, 0x14f10
.long 0xa600, 0xd00, 0x6, 0x14f60, 0xa640, 0xd00, 0x6, 0x14fa0
.long 0xa680, 0xd00, 0x7, 0x14ff0, 0xa6c0, 0xd00, 0x7, 0x15030
.long 0xa700, 0xd00, 0x8, 0x15040, 0xa740, 0xd00, 0x8, 0x15080
.long 0xa780, 0xd00, 0x9, 0x150d0, 0xa7c0, 0xd00, 0x9, 0x15110
.long 0xa800, 0xd00, 0xa, 0x15160, 0xa840, 0xd00, 0xa, 0x151a0
.long 0xa880, 0xd00, 0xb, 0x151f0, 0xa8c0, 0xd00, 0xb, 0x15230
.long 0xa900, 0xd00, 0xc, 0x15240, 0xa940, 0xd00, 0xc, 0x15280
.long 0xa980, 0xd00, 0xd, 0x152d0, 0xa9c0, 0xd00, 0xd, 0x15310
.long 0xaa00, 0xd00, 0xe, 0x15360, 0xaa40, 0xd00, 0xe, 0x153a0
.long 0x1f680, 0x40, 0xf, 0x153f0, 0x100000, 0xd00, 0xf, 0x15430
.long 0x100000, 0xd00, 0x10, 0x15440, 0x100000, 0xd00, 0x10, 0x15480
.long 0x100000, 0xd00, 0x11, 0x154d0, 0x100000, 0xd00, 0x11, 0x15510
.long 0x1f690, 0x1f890, 0x1f9c0, 0x1f9e0, 0x1f698, 0x1f898, 0x1f9c8, 0x1f9e8
.long 0x1f680, 0x1f880, 0x1f9d0, 0x1f9f0, 0x1f688, 0x1f888, 0x1f9d8, 0x100000
.long 0x1fd20, 0x1ff20, 0x1f9c2, 0x1f9e2, 0x1fd28, 0x1ff28, 0x1f9ca, 0x1f9ea
.long 0x1fd30, 0x1ff30, 0x1f9d2, 0x1f9f2, 0x1fd38, 0x1ff38, 0x1f9da, 0x100000
.long 0x1f6f0, 0x1f8f0, 0x1f9c4, 0x1f9e4, 0x1f6f8, 0x1f8f8, 0x1f9cc, 0x1f9ec
.long 0x1f6e0, 0x1f8e0, 0x1f9d4, 0x100000, 0x1f6e8, 0x1f8e8, 0x1f9dc, 0x100000
.long 0x1fd40, 0x1ff40, 0x1f9c6, 0x1f9e6, 0x1fd48, 0x1ff48, 0x1f9ce, 0x1f9ee
.long 0x1fd50, 0x1ff50, 0x1f9d6, 0x100000, 0x1fd58, 0x1ff58, 0x1f9de, 0x100000
.long 0x1f710, 0x1f910, 0x1f9c0, 0x1f9e0, 0x1f718, 0x1f918, 0x1f9c8, 0x1f9e8
.long 0x1f700, 0x1f900, 0x1f9d0, 0x1f9f0, 0x1f708, 0x1f908, 0x1f9d8, 0x100000
.long 0x1fda0, 0x1ffa0, 0x1f9c2, 0x1f9e2, 0x1fda8, 0x1ffa8, 0x1f9ca, 0x1f9ea
.long 0x1fdb0, 0x1ffb0, 0x1f9d2, 0x1f9f2, 0x1fdb8, 0x1ffb8, 0x1f9da, 0x100000
.long 0x1f770, 0x1f970, 0x1f9c4, 0x1f9e4, 0x1f778, 0x1f978, 0x1f9cc, 0x1f9ec
.long 0x1f760, 0x1f960, 0x1f9d4, 0x100000, 0x1f768, 0x1f968, 0x1f9dc, 0x100000
.long 0x1fdc0, 0x1ffc0, 0x1f9c6, 0x1f9e6, 0x1fdc8, 0x1ffc8, 0x1f9ce, 0x1f9ee
.long 0x1fdd0, 0x1ffd0, 0x1f9d6, 0x100000, 0x1fdd8, 0x1ffd8, 0x1f9de, 0x100000
.long 0x1f790, 0x1f990, 0x1f9c0, 0x1f9e0, 0x1f798, 0x1f998, 0x1f9c8, 0x1f9e8
.long 0x1f780, 0x1f980, 0x1f9d0, 0x1f9f0, 0x1f788, 0x1f988, 0x1f9d8, 0x100000
.long 0x1fe20, 0x20020, 0x1f9c2, 0x1f9e2, 0x1fe28, 0x20028, 0x1f9ca, 0x1f9ea
.long 0x1fe30, 0x20030, 0x1f9d2, 0x1f9f2, 0x1fe38, 0x20038, 0x1f9da, 0x100000
.long 0x1f7f0, 0x14d00, 0x1f9c4, 0x1f9e4, 0x1f7f8, 0x14d08, 0x1f9cc, 0x1f9ec
.long 0x1f7e0, 0x14d10, 0x1f9d4, 0x100000, 0x1f7e8, 0x14d18, 0x1f9dc, 0x100000
.long 0x1fe40, 0x14d00, 0x1f9c6, 0x1f9e6, 0x1fe48, 0x14d08, 0x1f9ce, 0x1f9ee
.long 0x1fe50, 0x14d10, 0x1f9d6, 0x100000, 0x1fe58, 0x14d18, 0x1f9de, 0x100000
.long 0x1f810, 0x14d00, 0x1f9c0, 0x1f9e0, 0x1f818, 0x14d08, 0x1f9c8, 0x1f9e8
.long 0x1f800, 0x14d10, 0x1f9d0, 0x1f9f0, 0x1f808, 0x14d18, 0x1f9d8, 0x100000
.long 0x1fea0, 0x14d00, 0x1f9c2, 0x1f9e2, 0x1fea8, 0x14d08, 0x1f9ca, 0x1f9ea
.long 0x1feb0, 0x14d10, 0x1f9d2, 0x1f9f2, 0x1feb8, 0x14d18, 0x1f9da, 0x100000
.long 0x1f870, 0x14d00, 0x1f9c4, 0x1f9e4, 0x1f878, 0x14d08, 0x1f9cc, 0x1f9ec
.long 0x1f860, 0x14d10, 0x1f9d4, 0x100000, 0x1f868, 0x14d18, 0x1f9dc, 0x100000
.long 0x1fec0, 0x14d00, 0x1f9c6, 0x1f9e6, 0x1fec8, 0x14d08, 0x1f9ce, 0x1f9ee
.long 0x1fed0, 0x14d10, 0x1f9d6, 0x100000, 0x1fed8, 0x14d18, 0x1f9de, 0x100000
.long 0x0, 0x4444, 0x0, 0xa400, 0x10, 0xeeee, 0x4, 0xa404
.long 0x20, 0x4444, 0x8, 0xa408, 0x30, 0xeeee, 0xc, 0xa40c
.long 0x40, 0x4444, 0x10, 0xa410, 0x50, 0xeeee, 0x14, 0xa414
.long 0x60, 0x4444, 0x18, 0xa418, 0x70, 0xeeee, 0x1c, 0xa41c
.long 0x0, 0x4444, 0x20, 0xa420, 0x10, 0xeeee, 0x24, 0xa424
.long 0x20, 0x4444, 0x28, 0xa428, 0x30, 0xeeee, 0x2c, 0xa42c
.long 0x40, 0x4444, 0x30, 0xa430, 0x50, 0xeeee, 0x34, 0xa434
.long 0x60, 0x4444, 0x38, 0xa438, 0x70, 0xeeee, 0x3c, 0xa43c
.long 0x0, 0x4444, 0x40, 0xa440, 0x10, 0xeeee, 0x44, 0xa444
.long 0x20, 0x4444, 0x48, 0xa448, 0x30, 0xeeee, 0x4c, 0xa44c
.long 0x40, 0x4444, 0x50, 0xa450, 0x50, 0xeeee, 0x54, 0xa454
.long 0x60, 0x4444, 0x58, 0xa458, 0x70, 0xeeee, 0x5c, 0xa45c
.long 0x0, 0x4444, 0x60, 0xa460, 0x10, 0xeeee, 0x64, 0xa464
.long 0x20, 0x4444, 0x68, 0xa468, 0x30, 0xeeee, 0x6c, 0xa46c
.long 0x40, 0x4444, 0x70, 0xa470, 0x50, 0xeeee, 0x74, 0xa474
.long 0x60, 0x4444, 0x78, 0xa478, 0x70, 0xeeee, 0x7c, 0xa47c
.long 0x0, 0x4444, 0x420, 0xb080, 0x10, 0xeeee, 0x424, 0xb084
.long 0x20, 0x4444, 0x428, 0xb088, 0x30, 0xeeee, 0x42c, 0xb08c
.long 0x40, 0x4444, 0x430, 0xb090, 0x50, 0xeeee, 0x434, 0xb094
.long 0x60, 0x4444, 0x438, 0xb098, 0x70, 0xeeee, 0x43c, 0xb09c
.long 0x0, 0x4444, 0x440, 0xb0a0, 0x10, 0xeeee, 0x444, 0xb0a4
.long 0x20, 0x4444, 0x448, 0xb0a8, 0x30, 0xeeee, 0x44c, 0xb0ac
.long 0x40, 0x4444, 0x450, 0xb0b0, 0x50, 0xeeee, 0x454, 0xb0b4
.long 0x60, 0x4444, 0x458, 0xb0b8, 0x70, 0xeeee, 0x45c, 0xb0bc
.long 0x0, 0x4444, 0x460, 0xb0c0, 0x10, 0xeeee, 0x464, 0xb0c4
.long 0x20, 0x4444, 0x468, 0xb0c8, 0x30, 0xeeee, 0x46c, 0xb0cc
.long 0x40, 0x4444, 0x470, 0xb0d0, 0x50, 0xeeee, 0x474, 0xb0d4
.long 0x60, 0x4444, 0x478, 0xb0d8, 0x70, 0xeeee, 0x47c, 0xb0dc
.long 0x0, 0x4444, 0x480, 0xb0e0, 0x10, 0xeeee, 0x484, 0xb0e4
.long 0x20, 0x4444, 0x488, 0xb0e8, 0x30, 0xeeee, 0x48c, 0xb0ec
.long 0x40, 0x4444, 0x490, 0xb0f0, 0x50, 0xeeee, 0x494, 0xb0f4
.long 0x60, 0x4444, 0x498, 0xb0f8, 0x70, 0xeeee, 0x49c, 0xb0fc
.long 0x1fa28, 0x1f9f4, 0x34, 0x14d00, 0x1fa28, 0x1f9f6, 0x74, 0x14d04
.long 0x1fa28, 0x1f9f8, 0xb4, 0x14d08, 0x1fa28, 0x1f9fa, 0xf4, 0x14d0c
.long 0x1fa28, 0x1f9fc, 0x134, 0x14d10, 0x1fa28, 0x1f9fe, 0x174, 0x14d14
.long 0x1fa28, 0x1fa00, 0x1b4, 0x14d18, 0x1fa28, 0x1fa02, 0x1f4, 0x14d1c
.long 0x1fa28, 0x1fa04, 0x234, 0x14d20, 0x1fa28, 0x1fa06, 0x274, 0x14d24
.long 0x1fa28, 0x1fa08, 0x2b4, 0x14d28, 0x1fa28, 0x1fa0a, 0x2f4, 0x14d2c
.long 0x1fa28, 0x1fa0c, 0x334, 0x14d30, 0x1fa28, 0x1fa0e, 0x374, 0x14d34
.long 0x1fa28, 0x1fa10, 0x3b4, 0x14d38, 0x1fa28, 0x1fa12, 0x3f4, 0x14d3c
.long 0x1fa28, 0x1fa14, 0x434, 0x14d00, 0x1fa28, 0x1fa16, 0x474, 0x14d04
.long 0x1fa28, 0x1fa18, 0x4b4, 0x14d08, 0x1fa28, 0x1fa1a, 0x4f4, 0x14d0c
.long 0x1fa28, 0x1fa1c, 0x534, 0x14d10, 0x1fa28, 0x1fa1e, 0x574, 0x14d14
.long 0x1fa28, 0x1fa20, 0x5b4, 0x14d18, 0x1fa28, 0x1fa22, 0x5f4, 0x14d1c
.long 0x1fa28, 0x1fa24, 0x634, 0x14d20, 0x1fa28, 0x1fa26, 0x674, 0x14d24
.long 0x1fa28, 0x1fa28, 0x6b4, 0x14d28, 0x1fa28, 0x1fa2a, 0x6f4, 0x14d2c
.long 0x1fa28, 0x1fa2c, 0x734, 0x14d30, 0x1fa28, 0x1fa2e, 0x774, 0x14d34
.long 0x1fa28, 0x1fa30, 0x7b4, 0x14d38, 0x1fa28, 0x1fa32, 0x7f4, 0x14d3c
.long 0x1fa38, 0x1fa34, 0x834, 0x14d00, 0x1fa38, 0x1fa36, 0x874, 0x14d04
.long 0x1fa38, 0x1fa38, 0x8b4, 0x14d08, 0x1fa38, 0x1fa3a, 0x8f4, 0x14d0c
.long 0x1fa38, 0x1fa3c, 0x934, 0x14d10, 0x1fa38, 0x1fa3e, 0x974, 0x14d14
.long 0x1fa38, 0x1fa40, 0x9b4, 0x14d18, 0x1fa38, 0x1fa42, 0x9f4, 0x14d1c
.long 0x1fa38, 0x1fa44, 0xa34, 0x14d20, 0x1fa38, 0x1fa46, 0xa74, 0x14d24
.long 0x1fa38, 0x1fa48, 0xab4, 0x14d28, 0x1fa38, 0x1fa4a, 0xaf4, 0x14d2c
.long 0x1fa38, 0x1fa4c, 0xb34, 0x14d30, 0x1fa38, 0x1fa4e, 0xb74, 0x14d34
.long 0x1fa38, 0x1fa50, 0xbb4, 0x14d38, 0x1fa38, 0x1fa52, 0xbf4, 0x14d3c
.long 0x1fa38, 0x1fa54, 0xc34, 0x14d00, 0x1fa38, 0x1fa56, 0xc74, 0x14d04
.long 0x1fa38, 0x1fa58, 0xcb4, 0x14d08, 0x1fa38, 0x1fa5a, 0xcf4, 0x14d0c
.long 0x1fa38, 0x1fa5c, 0xd34, 0x14d10, 0x1fa38, 0x1fa5e, 0xd74, 0x14d14
.long 0x1fa38, 0x1fa60, 0xdb4, 0x14d18, 0x1fa38, 0x1fa62, 0xdf4, 0x14d1c
.long 0x1fa38, 0x1fa64, 0xe34, 0x14d20, 0x1fa38, 0x1fa66, 0xe74, 0x14d24
.long 0x1fa38, 0x1fa68, 0xeb4, 0x14d28, 0x1fa38, 0x1fa6a, 0xef4, 0x14d2c
.long 0x1fa38, 0x1fa6c, 0xf34, 0x14d30, 0x1fa38, 0x1fa6e, 0xf74, 0x14d34
.long 0x1fa38, 0x1fa70, 0xfb4, 0x14d38, 0x1fa38, 0x1fa72, 0xff4, 0x14d3c
.long 0x0, 0x0, 0x0, 0x0, 0x0, 0x0, 0x0, 0x0
.long 0x0, 0x0, 0x0, 0x0, 0x0, 0x0, 0x0, 0x0
.long 0x0, 0x0, 0x0, 0x0, 0x0, 0x0, 0x0, 0x0
.long 0x0, 0x0, 0x0, 0x0, 0x0, 0x0, 0x0, 0x0
.long 0x0, 0x0, 0x0, 0x0, 0x0, 0x0, 0x0, 0x0
.long 0x0, 0x0, 0x0, 0x0, 0x0, 0x0, 0x0, 0x0
.long 0x0, 0x0, 0x0, 0x0, 0x0, 0x0, 0x0, 0x0
.long 0x0, 0x0, 0x0, 0x0, 0x0, 0x0, 0x0, 0x0
.long 0x0, 0x0, 0x0, 0x0, 0x0, 0x0, 0x0, 0x0
.long 0x0, 0x0, 0x0, 0x0, 0x0, 0x0, 0x0, 0x0
.long 0x0, 0x0, 0x0, 0x0, 0x0, 0x0, 0x0, 0x0
.long 0x0, 0x0, 0x0, 0x0, 0x0, 0x0, 0x0, 0x0
.long 0x0, 0x0, 0x0, 0x0, 0x0, 0x0, 0x0, 0x0
.long 0x0, 0x0, 0x0, 0x0, 0x0, 0x0, 0x0, 0x0
.long 0x0, 0x0, 0x0, 0x0, 0x0, 0x0, 0x0, 0x0
.long 0x0, 0x0, 0x0, 0x0, 0x0, 0x0, 0x0, 0x0
.long 0x0, 0x0, 0x0, 0x0, 0x0, 0x0, 0x0, 0x0
.long 0x0, 0x0, 0x0, 0x0, 0x0, 0x0, 0x0, 0x0
.long 0x0, 0x0, 0x0, 0x0, 0x0, 0x0, 0x0, 0x0
.long 0x0, 0x0, 0x0, 0x0, 0x0, 0x0, 0x0, 0x0
.long 0x0, 0x0, 0x0, 0x0, 0x0, 0x0, 0x0, 0x0
.long 0x0, 0x0, 0x0, 0x0, 0x0, 0x0, 0x0, 0x0
.long 0x0, 0x0, 0x0, 0x0, 0x0, 0x0, 0x0, 0x0
.long 0x0, 0x0, 0x0, 0x0, 0x0, 0x0, 0x0, 0x0
.long 0x0, 0x0, 0x0, 0x0, 0x0, 0x0, 0x0, 0x0
.long 0x0, 0x0, 0x0, 0x0, 0x0, 0x0, 0x0, 0x0
.long 0x0, 0x0, 0x0, 0x0, 0x0, 0x0, 0x0, 0x0
.long 0x0, 0x0, 0x0, 0x0, 0x0, 0x0, 0x0, 0x0
.long 0x0, 0x0, 0x0, 0x0, 0x0, 0x0, 0x0, 0x0
.long 0x0, 0x0, 0x0, 0x0, 0x0, 0x0, 0x0, 0x0
.long 0x0, 0x0, 0x0, 0x0, 0x0, 0x0, 0x0, 0x0
.long 0x0, 0x0, 0x0, 0x0, 0x0, 0x0, 0x0, 0x0
.long 0x13320, 0xa9b0, 0xa800, 0x10c00, 0xf320, 0xc120, 0x133b0, 0xb690
.long 0xa890, 0x11920, 0xf3b0, 0xce00, 0x12600, 0xa920, 0xb520, 0x10c90
.long 0xe600, 0xc090, 0x12690, 0xb600, 0xb5b0, 0x119b0, 0xe690, 0xcdb0
.long 0xd5f0, 0x11440, 0x117f0, 0x130d0, 0xf8d0, 0xadf0, 0xd640, 0x12160
.long 0x11840, 0x13df0, 0xf960, 0xbad0, 0xc8d0, 0x113f0, 0x124d0, 0x13160
.long 0xebf0, 0xad60, 0xc960, 0x120d0, 0x12560, 0x13e40, 0xec40, 0xba40
.long 0xefb0, 0x10ed0, 0x117b0, 0x12a40, 0xfa90, 0xdb60, 0xc890, 0x10d60
.long 0x10a90, 0x129f0, 0x13bb0, 0xddf0, 0xf000, 0x11bf0, 0x11520, 0xe960
.long 0xc160, 0xf9b0, 0xc920, 0x11a40, 0x10800, 0xe8d0, 0xc3f0, 0x13a90
.long 0xce40, 0xfa00, 0xfff0, 0xbb20, 0xedb0, 0xdad0, 0xced0, 0x10720
.long 0x10040, 0xc800, 0x14890, 0xde40, 0xf560, 0xfbb0, 0x140d0, 0xbdb0
.long 0xb3f0, 0xec00, 0xf5f0, 0x10890, 0x14160, 0xca90, 0xb760, 0x14720
.long 0x13520, 0xddb0, 0xa520, 0xbe00, 0xf490, 0xe800, 0x13690, 0x10490
.long 0xa5b0, 0xcb20, 0xe7b0, 0x14d00, 0x12800, 0xdd20, 0xb200, 0xbe90
.long 0xf800, 0x14320, 0x129b0, 0x10400, 0xb290, 0xcbb0, 0xeb20, 0x14290
.long 0xd560, 0x10760, 0x112d0, 0xaed0, 0xfb60, 0xeed0, 0xd3f0, 0xe040
.long 0x11360, 0xbbf0, 0xee40, 0x14d00, 0xc840, 0x106d0, 0x11ff0, 0xaf60
.long 0xfed0, 0x149f0, 0xc6d0, 0xdff0, 0x12040, 0xbc40, 0xf1f0, 0x14960
.long 0xbbb0, 0x10cd0, 0xfdb0, 0x12960, 0xd3b0, 0xd9f0, 0x13090, 0x11160
.long 0x13e90, 0x12bf0, 0xbff0, 0xd290, 0xbc00, 0x119f0, 0xfb20, 0xe840
.long 0xac90, 0xd840, 0x13120, 0x11e40, 0x13c00, 0xead0, 0xbe40, 0xabb0
.long 0xcf60, 0x11400, 0x101f0, 0xef20, 0x12e90, 0xdd60, 0xccd0, 0xd320
.long 0x10560, 0x14a00, 0xb640, 0x12d20, 0xf640, 0x115b0, 0x142d0, 0xf1b0
.long 0x121b0, 0xdcd0, 0xf3f0, 0xd490, 0x14640, 0x14c90, 0xb5f0, 0x12000
.long 0x13600, 0xf7b0, 0xa490, 0xb120, 0x10d20, 0xc200, 0x135b0, 0xea90
.long 0xa400, 0x14d00, 0x10db0, 0xcf20, 0x12920, 0xf720, 0xaa00, 0x14000
.long 0x11a00, 0xc290, 0x12890, 0xea00, 0xb720, 0x14090, 0x11a90, 0xcfb0
.long 0xd4d0, 0xfa40, 0x11760, 0x123f0, 0x12cd0, 0xaff0, 0xd440, 0xed60
.long 0x116d0, 0x14d00, 0x12d60, 0xbcd0, 0xc7f0, 0xf9f0, 0x118d0, 0x14ad0
.long 0x139f0, 0xb040, 0xc760, 0xecd0, 0x125f0, 0x14b60, 0x13a40, 0xbd60
.long 0xe290, 0x10e40, 0xc9b0, 0x12760, 0xfe00, 0x13640, 0x10df0, 0xd5b0
.long 0xf090, 0x128d0, 0x13f20, 0x138d0, 0xe320, 0x11b60, 0x12640, 0xafb0
.long 0xfe90, 0x14360, 0x11ad0, 0xd600, 0xe560, 0xad20, 0x13fb0, 0x145f0
.long 0xe000, 0xcd60, 0x10920, 0x102d0, 0xa6d0, 0xebb0, 0xd040, 0x12e00
.long 0xfc00, 0x10240, 0xaa40, 0x14690, 0xe1b0, 0xf440, 0x103f0, 0x12320
.long 0xe7f0, 0xee00, 0xf760, 0x12fb0, 0x144d0, 0x125b0, 0xeb60, 0x14920
.long 0x13720, 0x111b0, 0xdb20, 0xf400, 0x11090, 0x11d20, 0x137b0, 0x11e90
.long 0xda90, 0xe720, 0x11db0, 0x14d00, 0x12a00, 0x11120, 0x10200, 0xf5b0
.long 0x11200, 0x14400, 0x12a90, 0x11e00, 0x101b0, 0xe890, 0x11f20, 0x14490
.long 0xd6d0, 0x12e40, 0x108d0, 0xfc40, 0x13240, 0x13ed0, 0xd760, 0x13b60
.long 0x10840, 0xef60, 0x13f60, 0x14d00, 0xc9f0, 0x12df0, 0xe1f0, 0xfad0
.long 0x132d0, 0x14bf0, 0xca40, 0x13ad0, 0xe160, 0xedf0, 0x13ff0, 0x14c40
.long 0x11690, 0x11040, 0xde90, 0xa640, 0x10b20, 0x136d0, 0x109b0, 0x10ff0
.long 0xa5f0, 0xd1b0, 0x10bb0, 0x143f0, 0x11720, 0x11d60, 0xdf20, 0xb360
.long 0xb000, 0x13360, 0x10a00, 0x11cd0, 0xb2d0, 0xd200, 0xb090, 0x14040
.long 0xcbf0, 0xb920, 0xe400, 0x13560, 0xa560, 0xc490, 0xcc40, 0xc600
.long 0x13840, 0x13200, 0xe640, 0xc720, 0xf2d0, 0xba90, 0xdfb0, 0xc040
.long 0xa8d0, 0x11fb0, 0xf360, 0xc7b0, 0xc360, 0x12db0, 0xe9f0, 0x12200
.long 0x13400, 0xc3b0, 0xdc00, 0x10e00, 0xbfb0, 0xcc00, 0x13490, 0xd090
.long 0xdc90, 0x11b20, 0xcc90, 0x14d00, 0x12720, 0xc320, 0x10320, 0x10fb0
.long 0xc400, 0x14120, 0x127b0, 0xd000, 0x103b0, 0x11c90, 0xd120, 0x141b0
.long 0xd1f0, 0xac40, 0x10ad0, 0x13040, 0xab60, 0xb7f0, 0xd240, 0xb960
.long 0x10b60, 0x13d60, 0xb840, 0x14d00, 0xc4d0, 0xabf0, 0xe3f0, 0x12ed0
.long 0xb0d0, 0x146d0, 0xc560, 0xb8d0, 0xe440, 0x13bf0, 0xbdf0, 0x14760
.long 0xfc90, 0x10f60, 0x11290, 0xa840, 0x13d20, 0x104d0, 0x13db0, 0x111f0
.long 0x105b0, 0xa7f0, 0x13c90, 0xf7f0, 0xfd20, 0x11c40, 0x11320, 0xb560
.long 0xae00, 0xff60, 0x13e00, 0x11ed0, 0x10600, 0xb4d0, 0xadb0, 0xf240
.long 0xcdf0, 0xed20, 0x133f0, 0xbd20, 0x12c40, 0x14bb0, 0xd160, 0x14800
.long 0x13440, 0xca00, 0x11f60, 0x14b20, 0xf4d0, 0xee90, 0xbed0, 0xb890
.long 0x12ad0, 0x12490, 0xf840, 0x149b0, 0xbf60, 0xc5b0, 0x11df0, 0x12400
.long 0x12bb0, 0x13800, 0xd920, 0xc000, 0x14600, 0x14d00, 0x13890, 0x14d00
.long 0xd9b0, 0xcd20, 0xc5f0, 0x14d00, 0x13920, 0x145b0, 0x10000, 0xc1b0
.long 0xb1b0, 0x14d00, 0x12c00, 0x14520, 0x10090, 0xce90, 0xfbf0, 0x14d00
.long 0xc640, 0xd2d0, 0x105f0, 0xae40, 0x14cd0, 0x14d00, 0xd360, 0x14d00
.long 0x10640, 0xbb60, 0xbf20, 0x14d00, 0xd7f0, 0x14840, 0xded0, 0xacd0
.long 0x10290, 0x14d00, 0xcad0, 0x147f0, 0xdf60, 0xb9f0, 0x11000, 0x14d00
.long 0x14a90, 0x11240, 0xf890, 0xa760, 0x14d00, 0xaad0, 0x123b0, 0x110d0
.long 0x139b0, 0xa9f0, 0x14d00, 0x12b20, 0x10c40, 0xae90, 0xf920, 0xb440
.long 0xe0d0, 0x14d00, 0x11960, 0xaf20, 0x13a00, 0xb6d0, 0x131f0, 0x14d00
.long 0x13b20, 0xd0d0, 0x135f0, 0xf120, 0x14d00, 0x12440, 0xac00, 0xcb60
.long 0x13960, 0x14c00, 0xf520, 0x14d00, 0xcff0, 0x12120, 0xc0d0, 0xec90
.long 0xda40, 0xe090, 0xf6d0, 0x12290, 0xc440, 0x147b0, 0x14d00, 0x14d00
.long 0xa600, 0xd800, 0xdbb0, 0x10120, 0x0, 0x0, 0xa7b0, 0xff20
.long 0xda00, 0x14d00, 0x0, 0x0, 0xb320, 0xd890, 0xde00, 0x14200
.long 0x0, 0x0, 0xb490, 0xffb0, 0x10520, 0x143b0, 0x0, 0x0
.long 0x11640, 0x109f0, 0x107f0, 0xe240, 0x0, 0x0, 0x114d0, 0xe2d0
.long 0x10960, 0x14d00, 0x0, 0x0, 0x12360, 0x10a40, 0x10bf0, 0x14a40
.long 0x0, 0x0, 0x121f0, 0xe360, 0xe4d0, 0x148d0, 0x0, 0x0
.long 0xbc90, 0x126d0, 0x12c90, 0xa960, 0x0, 0x0, 0x131b0, 0x12b60
.long 0xb7b0, 0xa4d0, 0x0, 0x0, 0xba00, 0xe5f0, 0xa440, 0xaa90
.long 0x0, 0x0, 0x12f20, 0xea40, 0xb160, 0xab20, 0x0, 0x0
.long 0x10360, 0x11600, 0xd720, 0x134d0, 0x0, 0x0, 0x100d0, 0xd520
.long 0x11800, 0x13760, 0x0, 0x0, 0x14440, 0x11890, 0x137f0, 0x12520
.long 0x0, 0x0, 0x141f0, 0xd7b0, 0xc2d0, 0x12090, 0x0, 0x0
.long 0xa720, 0xf200, 0xf600, 0x10f20, 0x0, 0x0, 0xa690, 0xe520
.long 0xf690, 0x11c00, 0x0, 0x0, 0xb400, 0xf290, 0xe920, 0x10e90
.long 0x0, 0x0, 0xb3b0, 0xe5b0, 0xe9b0, 0x11bb0, 0x0, 0x0
.long 0x115f0, 0xfcd0, 0xfdf0, 0x12ff0, 0x0, 0x0, 0x11560, 0xeff0
.long 0xfe40, 0x13cd0, 0x0, 0x0, 0x122d0, 0xfd60, 0xf0d0, 0x12f60
.long 0x0, 0x0, 0x12240, 0xf040, 0xf160, 0x13c40, 0x0, 0x0
.long 0xe3b0, 0x12840, 0x11490, 0xdc40, 0x0, 0x0, 0x127f0, 0xd690
.long 0x107b0, 0xdbf0, 0x0, 0x0, 0xe120, 0xe760, 0xc240, 0x113b0
.long 0x0, 0x0, 0xe6d0, 0xd400, 0xc1f0, 0x10690, 0x0, 0x0
.long 0xe200, 0x10160, 0xb9b0, 0xd8d0, 0x0, 0x0, 0x10440, 0x13000
.long 0xc690, 0xd960, 0x0, 0x0, 0xe490, 0x14240, 0xb1f0, 0xb800
.long 0x0, 0x0, 0x14560, 0x13290, 0xb240, 0xc520, 0x0, 0x0
.long 0x0, 0x0, 0x0, 0x0, 0x0, 0x0, 0x0, 0x0
.long 0x0, 0x0, 0x0, 0x0, 0x0, 0x0, 0x0, 0x0
.long 0x0, 0x0, 0x0, 0x0, 0x0, 0x0, 0x0, 0x0
.long 0x0, 0x0, 0x0, 0x0, 0x0, 0x0, 0x0, 0x0
.long 0x0, 0x0, 0x0, 0x0, 0x0, 0x0, 0x0, 0x0
.long 0x0, 0x0, 0x0, 0x0, 0x0, 0x0, 0x0, 0x0
.long 0x0, 0x0, 0x0, 0x0, 0x0, 0x0, 0x0, 0x0
.long 0x0, 0x0, 0x0, 0x0, 0x0, 0x0, 0x0, 0x0
.long 0x0, 0x0, 0x0, 0x0, 0x0, 0x0, 0x0, 0x0
.long 0x0, 0x0, 0x0, 0x0, 0x0, 0x0, 0x0, 0x0
.long 0x0, 0x0, 0x0, 0x0, 0x0, 0x0, 0x0, 0x0
.long 0x0, 0x0, 0x0, 0x0, 0x0, 0x0, 0x0, 0x0
.long 0x0, 0x0, 0x0, 0x0, 0x0, 0x0, 0x0, 0x0
.long 0x0, 0x0, 0x0, 0x0, 0x0, 0x0, 0x0, 0x0
.long 0x0, 0x0, 0x0, 0x0, 0x0, 0x0, 0x0, 0x0
.long 0x0, 0x0, 0x0, 0x0, 0x0, 0x0, 0x0, 0x0
.long 0x0, 0x0, 0x0, 0x0, 0x0, 0x0, 0x0, 0x0
.long 0x0, 0x0, 0x0, 0x0, 0x0, 0x0, 0x0, 0x0
.long 0x0, 0x0, 0x0, 0x0, 0x0, 0x0, 0x0, 0x0
.long 0x0, 0x0, 0x0, 0x0, 0x0, 0x0, 0x0, 0x0
.long 0x0, 0x0, 0x0, 0x0, 0x0, 0x0, 0x0, 0x0
.long 0x0, 0x0, 0x0, 0x0, 0x0, 0x0, 0x0, 0x0
.long 0x0, 0x0, 0x0, 0x0, 0x0, 0x0, 0x0, 0x0
.long 0x0, 0x0, 0x0, 0x0, 0x0, 0x0, 0x0, 0x0
.long 0x0, 0x0, 0x0, 0x0, 0x0, 0x0, 0x0, 0x0
.long 0x0, 0x0, 0x0, 0x0, 0x0, 0x0, 0x0, 0x0
.long 0x0, 0x0, 0x0, 0x0, 0x0, 0x0, 0x0, 0x0
.long 0x0, 0x0, 0x0, 0x0, 0x0, 0x0, 0x0, 0x0
.long 0x0, 0x0, 0x0, 0x0, 0x0, 0x0, 0x0, 0x0
.long 0x0, 0x0, 0x0, 0x0, 0x0, 0x0, 0x0, 0x0
.long 0x0, 0x0, 0x0, 0x0, 0x0, 0x0, 0x0, 0x0
.long 0x0, 0x0, 0x0, 0x0, 0x0, 0x0, 0x0, 0x0
.section .rodata,"a"
.p2align 6
.amdhsa_kernel standalone__deep_cross_xdeepfm__recsys_kernel
  .amdhsa_next_free_vgpr 256
  .amdhsa_next_free_sgpr 102
  .amdhsa_accum_offset 256
  .amdhsa_group_segment_fixed_size 0
  .amdhsa_kernarg_size 88
  .amdhsa_user_sgpr_count 2
  .amdhsa_user_sgpr_kernarg_segment_ptr 1
  .amdhsa_system_sgpr_workgroup_id_x 1
  .amdhsa_float_denorm_mode_32 3
.end_amdhsa_kernel
```

```asm
; @launch grid=(256,1,1) block=(512,1,1) lds=163840
.amdgcn_target "amdgcn-amd-amdhsa--gfx950"
.text
.globl standalone__deep_cross_xdeepfm__recsys_kernel
.p2align 8
.type standalone__deep_cross_xdeepfm__recsys_kernel,@function
standalone__deep_cross_xdeepfm__recsys_kernel:
  s_cmp_ge_u32 s2, 256
  s_cbranch_scc1 L_end
  s_load_dwordx16 s[4:19], s[0:1], 0
  s_load_dwordx4 s[20:23], s[0:1], 64
  s_load_dwordx2 s[24:25], s[0:1], 80
  v_lshrrev_b32 v1, 6, v0
  s_getpc_b64 s[92:93]
L_pc:
  s_and_b32 s68, s2, 0xf8
  v_add_u32 v2, s68, v1
  v_and_b32_e64 v3, 32, v0
  v_lshl_add_u32 v2, v3, 3, v2
  v_lshlrev_b32 v2, 7, v2
  v_min_u32 v2, L_end-L_pc, v2
  v_mov_b32 v3, s93
  v_add_co_u32 v2, vcc, s92, v2
  s_nop 1
  v_addc_co_u32 v3, vcc, 0, v3, vcc
  global_load_dword v251, v[2:3], off
  v_and_b32 v0, 63, v0
  v_readfirstlane_b32 s3, v1
  s_and_b32 s68, s2, 7
  s_lshr_b32 s69, s2, 3
  s_xor_b32 s69, s69, 31
  s_and_b32 s80, s2, 0xf8
  s_add_u32 s80, s80, s3
  s_lshl_b32 s80, s80, 0
  s_min_u32 s70, s68, 1
  s_add_u32 s71, s69, s70
  s_cmp_ge_u32 s71, 22
  s_cbranch_scc1 L_cin
  s_mul_i32 s68, s68, 21
  s_add_u32 s68, s68, s71
  s_mul_i32 s26, s68, 5042
  s_lshr_b32 s26, s26, 16
  s_mul_i32 s69, s26, 13
  s_sub_u32 s27, s68, s69
  s_lshl_b32 s77, s27, 8
  s_mul_i32 s71, s26, 320
  v_lshrrev_b32 v116, 4, v0
  v_lshlrev_b32 v11, 4, v0
  s_and_b32 s79, s3, 3
  s_cmp_lt_u32 s3, 4
  s_cbranch_scc1 L_cmp
  s_lshr_b32 s68, s79, 1
  s_mul_i32 s68, s68, 20
  s_and_b32 s69, s79, 1
  s_add_u32 s68, s68, s69
  s_lshl_b32 s76, s68, 10
  s_mul_i32 s78, s71, 104
  s_mul_i32 s68, s68, 832
  s_add_u32 s94, s78, s68
  v_mul_u32_u24 v118, 48, v116
  v_sub_u32 v12, v11, v118
  s_add_u32 s95, s94, 3328
  s_add_u32 s96, s94, 6656
  s_add_u32 s97, s94, 9984
  s_add_u32 s98, s94, 13312
  s_and_b32 s70, s79, 1
  s_lshl_b32 s70, s70, 3
  v_lshlrev_b32 v117, 1, v116
  v_or_b32 v117, s70, v117
  v_xor_b32 v117, v117, v0
  v_and_b32_e64 v117, 15, v117
  v_mul_u32_u24 v4, 3328, v116
  v_lshl_add_u32 v4, v117, 4, v4
  v_add_u32 v5, 13312, v4
  s_mul_i32 s74, s79, 26624
  s_add_u32 s74, s74, s77
  s_lshl_b32 s75, s79, 11
  s_waitcnt lgkmcnt(0)
  s_mov_b32 s28, s4
  s_and_b32 s29, s5, 0xffff
  s_mov_b32 s30, 425984
  s_mov_b32 s31, 0x20000
  buffer_load_dwordx4 v[16:19], v12, s[28:31], s94 offen offset:0
  s_mov_b32 s32, s6
  s_and_b32 s33, s7, 0xffff
  s_mov_b32 s34, 12800000
  s_mov_b32 s35, 0x20000
  s_mov_b32 s44, s12
  s_and_b32 s45, s13, 0xffff
  s_mov_b32 s46, 5537792
  s_mov_b32 s47, 0x20000
  s_add_u32 m0, s75, 131072
  s_nop 0
  buffer_load_dwordx4 v4, s[44:47], s74 offen lds
  s_add_u32 m0, s75, 132096
  s_nop 0
  buffer_load_dwordx4 v5, s[44:47], s74 offen lds
  s_add_u32 s74, s74, 106496
  s_add_u32 m0, s75, 139264
  s_nop 0
  buffer_load_dwordx4 v4, s[44:47], s74 offen lds
  s_add_u32 m0, s75, 140288
  s_nop 0
  buffer_load_dwordx4 v5, s[44:47], s74 offen lds
  s_add_u32 s74, s74, 106496
  buffer_load_dwordx4 v[20:23], v12, s[28:31], s94 offen offset:1664
  buffer_load_dwordx4 v[24:27], v12, s[28:31], s95 offen offset:0
  buffer_load_dwordx4 v[28:31], v12, s[28:31], s95 offen offset:1664
  buffer_load_dwordx4 v[32:35], v12, s[28:31], s96 offen offset:0
  buffer_load_dwordx4 v[36:39], v12, s[28:31], s96 offen offset:1664
  buffer_load_dwordx4 v[40:43], v12, s[28:31], s97 offen offset:0
  buffer_load_dwordx4 v[44:47], v12, s[28:31], s97 offen offset:1664
  buffer_load_dwordx4 v[48:51], v12, s[28:31], s98 offen offset:0
  buffer_load_dwordx4 v[52:55], v12, s[28:31], s98 offen offset:1664
  s_lshl_b32 s70, s69, 6
  v_and_b32 v118, 7, v0
  v_xor_b32 v118, v118, v116
  v_lshlrev_b32 v118, 4, v118
  v_xor_b32 v2, s70, v118
  v_xor_b32 v3, 64, v2
  s_mov_b32 s72, 0
  s_mul_i32 s70, s79, 13
  s_add_u32 s70, s70, s27
  s_min_u32 s70, s70, 39
  s_lshl_b32 s70, s70, 3
  s_add_u32 s70, s70, s71
  s_mul_i32 s84, s70, 104
  v_lshrrev_b32 v118, 2, v0
  v_min_u32 v118, 7, v118
  v_mul_u32_u24 v118, 104, v118
  v_and_b32 v117, 3, v0
  v_lshl_add_u32 v7, v117, 2, v118
  s_lshl_b32 s70, s26, 2
  s_add_u32 s70, s70, s79
  s_add_u32 s70, s70, 384
  s_mul_i32 s85, s70, 3328
  s_add_u32 s85, s85, s77
  s_mov_b32 s70, 173056
  v_lshrrev_b32 v118, 1, v0
  v_mul_lo_u32 v118, s70, v118
  v_and_b32 v117, 1, v0
  v_lshl_add_u32 v76, v117, 7, v118
  s_mov_b32 s52, s16
  s_and_b32 s53, s17, 0xffff
  s_mov_b32 s54, 3328
  s_mov_b32 s55, 0x20000
  s_mul_i32 s70, s79, 2560
  s_add_u32 s70, s70, L_tail-L_pc
  v_lshlrev_b32 v8, 7, v0
  v_add_u32 v8, s70, v8
  v_mov_b32 v9, s93
  v_add_co_u32 v8, vcc, s92, v8
  s_nop 1
  v_addc_co_u32 v9, vcc, 0, v9, vcc
  s_waitcnt vmcnt(13)
  v_lshlrev_b32 v16, 7, v16
  v_lshlrev_b32 v18, 7, v18
  v_lshlrev_b32 v17, 7, v17
  v_lshlrev_b32_e64 v19, 7, v19
  v_add_u32_dpp v56, v16, v2 row_newbcast:0 row_mask:0xf bank_mask:0x3
  s_nop 1
  v_add_u32_dpp v56, v18, v2 row_newbcast:6 row_mask:0xf bank_mask:0xc
  s_add_u32 m0, s76, 0
  s_nop 0
  buffer_load_dwordx4 v56, s[32:35], 0 offen lds
  s_waitcnt vmcnt(10)
  s_barrier
  s_waitcnt vmcnt(9)
  v_lshlrev_b32 v20, 7, v20
  v_lshlrev_b32 v22, 7, v22
  v_lshlrev_b32 v21, 7, v21
  v_lshlrev_b32 v23, 7, v23
  v_add_u32_dpp v57, v20, v2 row_newbcast:0 row_mask:0xf bank_mask:0x3
  s_nop 1
  v_add_u32_dpp v57, v22, v2 row_newbcast:6 row_mask:0xf bank_mask:0xc
  s_add_u32 m0, s76, 2048
  s_nop 0
  buffer_load_dwordx4 v57, s[32:35], 0 offen lds
  s_waitcnt vmcnt(9)
  v_lshlrev_b32 v24, 7, v24
  v_lshlrev_b32 v26, 7, v26
  v_lshlrev_b32 v25, 7, v25
  v_lshlrev_b32 v27, 7, v27
  v_add_u32_dpp v58, v24, v2 row_newbcast:0 row_mask:0xf bank_mask:0x3
  s_nop 1
  v_add_u32_dpp v58, v26, v2 row_newbcast:6 row_mask:0xf bank_mask:0xc
  s_add_u32 m0, s76, 4096
  s_nop 0
  buffer_load_dwordx4 v58, s[32:35], 0 offen lds
  s_waitcnt vmcnt(9)
  v_lshlrev_b32 v28, 7, v28
  v_lshlrev_b32 v30, 7, v30
  v_lshlrev_b32 v29, 7, v29
  v_lshlrev_b32_e64 v31, 7, v31
  v_add_u32_dpp v59, v28, v2 row_newbcast:0 row_mask:0xf bank_mask:0x3
  s_nop 1
  v_add_u32_dpp v59, v30, v2 row_newbcast:6 row_mask:0xf bank_mask:0xc
  s_add_u32 m0, s76, 6144
  s_nop 0
  buffer_load_dwordx4 v59, s[32:35], 0 offen lds
  s_waitcnt vmcnt(9)
  v_lshlrev_b32 v32, 7, v32
  v_lshlrev_b32 v34, 7, v34
  v_lshlrev_b32 v33, 7, v33
  v_lshlrev_b32_e64 v35, 7, v35
  v_add_u32_dpp v60, v32, v2 row_newbcast:0 row_mask:0xf bank_mask:0x3
  s_nop 1
  v_add_u32_dpp v60, v34, v2 row_newbcast:6 row_mask:0xf bank_mask:0xc
  s_add_u32 m0, s76, 8192
  s_nop 0
  buffer_load_dwordx4 v60, s[32:35], 0 offen lds
  s_waitcnt vmcnt(9)
  v_lshlrev_b32 v36, 7, v36
  v_lshlrev_b32 v38, 7, v38
  v_lshlrev_b32 v37, 7, v37
  v_lshlrev_b32_e64 v39, 7, v39
  v_add_u32_dpp v61, v36, v2 row_newbcast:0 row_mask:0xf bank_mask:0x3
  s_nop 1
  v_add_u32_dpp v61, v38, v2 row_newbcast:6 row_mask:0xf bank_mask:0xc
  s_add_u32 m0, s76, 10240
  s_nop 0
  buffer_load_dwordx4 v61, s[32:35], 0 offen lds
  s_waitcnt vmcnt(9)
  v_lshlrev_b32 v40, 7, v40
  v_lshlrev_b32 v42, 7, v42
  v_lshlrev_b32 v41, 7, v41
  v_lshlrev_b32_e64 v43, 7, v43
  v_add_u32_dpp v62, v40, v2 row_newbcast:0 row_mask:0xf bank_mask:0x3
  s_nop 1
  v_add_u32_dpp v62, v42, v2 row_newbcast:6 row_mask:0xf bank_mask:0xc
  s_add_u32 m0, s76, 12288
  s_nop 0
  buffer_load_dwordx4 v62, s[32:35], 0 offen lds
  s_waitcnt vmcnt(9)
  v_lshlrev_b32 v44, 7, v44
  v_lshlrev_b32 v46, 7, v46
  v_lshlrev_b32 v45, 7, v45
  v_lshlrev_b32_e64 v47, 7, v47
  v_add_u32_dpp v63, v44, v2 row_newbcast:0 row_mask:0xf bank_mask:0x3
  s_nop 1
  v_add_u32_dpp v63, v46, v2 row_newbcast:6 row_mask:0xf bank_mask:0xc
  s_add_u32 m0, s76, 14336
  s_nop 0
  buffer_load_dwordx4 v63, s[32:35], 0 offen lds
  s_waitcnt vmcnt(9)
  v_lshlrev_b32 v48, 7, v48
  v_lshlrev_b32 v50, 7, v50
  v_lshlrev_b32 v49, 7, v49
  v_lshlrev_b32_e64 v51, 7, v51
  v_add_u32_dpp v64, v48, v2 row_newbcast:0 row_mask:0xf bank_mask:0x3
  s_nop 1
  v_add_u32_dpp v64, v50, v2 row_newbcast:6 row_mask:0xf bank_mask:0xc
  s_add_u32 m0, s76, 16384
  s_nop 0
  buffer_load_dwordx4 v64, s[32:35], 0 offen lds
  s_waitcnt vmcnt(9)
  v_lshlrev_b32 v52, 7, v52
  v_lshlrev_b32 v54, 7, v54
  v_lshlrev_b32 v53, 7, v53
  v_lshlrev_b32_e64 v55, 7, v55
  v_add_u32_dpp v65, v52, v2 row_newbcast:0 row_mask:0xf bank_mask:0x3
  s_nop 1
  v_add_u32_dpp v65, v54, v2 row_newbcast:6 row_mask:0xf bank_mask:0xc
  s_add_u32 m0, s76, 18432
  s_nop 0
  buffer_load_dwordx4 v65, s[32:35], 0 offen lds
  v_add_u32_dpp v56, v17, v2 row_newbcast:0 row_mask:0xf bank_mask:0x3
  s_nop 1
  v_add_u32_dpp v56, v19, v2 row_newbcast:6 row_mask:0xf bank_mask:0xc
  s_add_u32 m0, s76, 40960
  s_nop 0
  buffer_load_dwordx4 v56, s[32:35], 0 offen lds
  v_add_u32_dpp v57, v21, v2 row_newbcast:0 row_mask:0xf bank_mask:0x3
  s_nop 1
  v_add_u32_dpp v57, v23, v2 row_newbcast:6 row_mask:0xf bank_mask:0xc
  s_add_u32 m0, s76, 43008
  s_nop 0
  buffer_load_dwordx4 v57, s[32:35], 0 offen lds
  v_add_u32_dpp v58, v25, v2 row_newbcast:0 row_mask:0xf bank_mask:0x3
  s_nop 1
  v_add_u32_dpp v58, v27, v2 row_newbcast:6 row_mask:0xf bank_mask:0xc
  s_add_u32 m0, s76, 45056
  s_nop 0
  buffer_load_dwordx4 v58, s[32:35], 0 offen lds
  v_add_u32_dpp v59, v29, v2 row_newbcast:0 row_mask:0xf bank_mask:0x3
  s_nop 1
  v_add_u32_dpp v59, v31, v2 row_newbcast:6 row_mask:0xf bank_mask:0xc
  s_add_u32 m0, s76, 47104
  s_nop 0
  buffer_load_dwordx4 v59, s[32:35], 0 offen lds
  v_add_u32_dpp v60, v33, v2 row_newbcast:0 row_mask:0xf bank_mask:0x3
  s_nop 1
  v_add_u32_dpp v60, v35, v2 row_newbcast:6 row_mask:0xf bank_mask:0xc
  s_add_u32 m0, s76, 49152
  s_nop 0
  buffer_load_dwordx4 v60, s[32:35], 0 offen lds
  s_waitcnt vmcnt(11)
  s_barrier
  v_add_u32_dpp v61, v37, v2 row_newbcast:0 row_mask:0xf bank_mask:0x3
  s_nop 1
  v_add_u32_dpp v61, v39, v2 row_newbcast:6 row_mask:0xf bank_mask:0xc
  s_add_u32 m0, s76, 51200
  s_nop 0
  buffer_load_dwordx4 v61, s[32:35], 0 offen lds
  v_add_u32_dpp v62, v41, v2 row_newbcast:0 row_mask:0xf bank_mask:0x3
  s_nop 1
  v_add_u32_dpp v62, v43, v2 row_newbcast:6 row_mask:0xf bank_mask:0xc
  s_add_u32 m0, s76, 53248
  s_nop 0
  buffer_load_dwordx4 v62, s[32:35], 0 offen lds
  v_add_u32_dpp v63, v45, v2 row_newbcast:0 row_mask:0xf bank_mask:0x3
  s_nop 1
  v_add_u32_dpp v63, v47, v2 row_newbcast:6 row_mask:0xf bank_mask:0xc
  s_add_u32 m0, s76, 55296
  s_nop 0
  buffer_load_dwordx4 v63, s[32:35], 0 offen lds
  v_add_u32_dpp v64, v49, v2 row_newbcast:0 row_mask:0xf bank_mask:0x3
  s_nop 1
  v_add_u32_dpp v64, v51, v2 row_newbcast:6 row_mask:0xf bank_mask:0xc
  s_add_u32 m0, s76, 57344
  s_nop 0
  buffer_load_dwordx4 v64, s[32:35], 0 offen lds
  v_add_u32_dpp v65, v53, v2 row_newbcast:0 row_mask:0xf bank_mask:0x3
  s_nop 1
  v_add_u32_dpp v65, v55, v2 row_newbcast:6 row_mask:0xf bank_mask:0xc
  s_add_u32 m0, s76, 59392
  s_nop 0
  buffer_load_dwordx4 v65, s[32:35], 0 offen lds
  s_waitcnt vmcnt(10)
  s_barrier
  s_add_u32 m0, s75, 147456
  s_nop 0
  buffer_load_dwordx4 v4, s[44:47], s74 offen lds
  s_add_u32 m0, s75, 148480
  s_nop 0
  buffer_load_dwordx4 v5, s[44:47], s74 offen lds
  s_add_u32 s74, s74, 106496
  s_add_u32 m0, s75, 155648
  s_nop 0
  buffer_load_dwordx4 v4, s[44:47], s74 offen lds
  s_add_u32 m0, s75, 156672
  s_nop 0
  buffer_load_dwordx4 v5, s[44:47], s74 offen lds
  s_add_u32 s74, s74, 106496
  v_add_u32_dpp v56, v18, v2 row_newbcast:0 row_mask:0xf bank_mask:0x3
  v_add_u32_dpp v57, v22, v2 row_newbcast:0 row_mask:0xf bank_mask:0x3
  v_add_u32_dpp v58, v26, v2 row_newbcast:0 row_mask:0xf bank_mask:0x3
  v_add_u32_dpp v59, v30, v2 row_newbcast:0 row_mask:0xf bank_mask:0x3
  v_add_u32_dpp v60, v34, v2 row_newbcast:0 row_mask:0xf bank_mask:0x3
  v_add_u32_dpp v61, v38, v2 row_newbcast:0 row_mask:0xf bank_mask:0x3
  v_add_u32_dpp v62, v42, v2 row_newbcast:0 row_mask:0xf bank_mask:0x3
  v_add_u32_dpp v63, v46, v2 row_newbcast:0 row_mask:0xf bank_mask:0x3
  v_add_u32_dpp v64, v50, v2 row_newbcast:0 row_mask:0xf bank_mask:0x3
  v_add_u32_dpp v65, v54, v2 row_newbcast:0 row_mask:0xf bank_mask:0x3
  v_add_u32_dpp v56, v16, v2 row_newbcast:7 row_mask:0xf bank_mask:0xc
  v_add_u32_dpp v57, v20, v2 row_newbcast:7 row_mask:0xf bank_mask:0xc
  v_add_u32_dpp v58, v24, v2 row_newbcast:7 row_mask:0xf bank_mask:0xc
  v_add_u32_dpp v59, v28, v2 row_newbcast:7 row_mask:0xf bank_mask:0xc
  v_add_u32_dpp v60, v32, v2 row_newbcast:7 row_mask:0xf bank_mask:0xc
  v_add_u32_dpp v61, v36, v2 row_newbcast:7 row_mask:0xf bank_mask:0xc
  v_add_u32_dpp v62, v40, v2 row_newbcast:7 row_mask:0xf bank_mask:0xc
  v_add_u32_dpp v63, v44, v2 row_newbcast:7 row_mask:0xf bank_mask:0xc
  v_add_u32_dpp v64, v48, v2 row_newbcast:7 row_mask:0xf bank_mask:0xc
  v_add_u32_dpp v65, v52, v2 row_newbcast:7 row_mask:0xf bank_mask:0xc
  s_add_u32 m0, s76, 81920
  s_nop 0
  buffer_load_dwordx4 v56, s[32:35], 0 offen lds
  s_add_u32 m0, s76, 83968
  s_nop 0
  buffer_load_dwordx4 v57, s[32:35], 0 offen lds
  s_add_u32 m0, s76, 86016
  s_nop 0
  buffer_load_dwordx4 v58, s[32:35], 0 offen lds
  s_add_u32 m0, s76, 88064
  s_nop 0
  buffer_load_dwordx4 v59, s[32:35], 0 offen lds
  s_add_u32 m0, s76, 90112
  s_nop 0
  buffer_load_dwordx4 v60, s[32:35], 0 offen lds
  s_add_u32 m0, s76, 92160
  s_nop 0
  buffer_load_dwordx4 v61, s[32:35], 0 offen lds
  s_add_u32 m0, s76, 94208
  s_nop 0
  buffer_load_dwordx4 v62, s[32:35], 0 offen lds
  s_add_u32 m0, s76, 96256
  s_nop 0
  buffer_load_dwordx4 v63, s[32:35], 0 offen lds
  s_waitcnt vmcnt(8)
  s_barrier
  s_add_u32 m0, s76, 98304
  s_nop 0
  buffer_load_dwordx4 v64, s[32:35], 0 offen lds
  s_add_u32 m0, s76, 100352
  s_nop 0
  buffer_load_dwordx4 v65, s[32:35], 0 offen lds
  v_add_u32_dpp v56, v19, v2 row_newbcast:0 row_mask:0xf bank_mask:0x3
  v_add_u32_dpp v57, v23, v2 row_newbcast:0 row_mask:0xf bank_mask:0x3
  v_add_u32_dpp v58, v27, v2 row_newbcast:0 row_mask:0xf bank_mask:0x3
  v_add_u32_dpp v59, v31, v2 row_newbcast:0 row_mask:0xf bank_mask:0x3
  v_add_u32_dpp v60, v35, v2 row_newbcast:0 row_mask:0xf bank_mask:0x3
  v_add_u32_dpp v61, v39, v2 row_newbcast:0 row_mask:0xf bank_mask:0x3
  v_add_u32_dpp v62, v43, v2 row_newbcast:0 row_mask:0xf bank_mask:0x3
  v_add_u32_dpp v63, v47, v2 row_newbcast:0 row_mask:0xf bank_mask:0x3
  v_add_u32_dpp v64, v51, v2 row_newbcast:0 row_mask:0xf bank_mask:0x3
  v_add_u32_dpp v65, v55, v2 row_newbcast:0 row_mask:0xf bank_mask:0x3
  v_add_u32_dpp v56, v17, v2 row_newbcast:7 row_mask:0xf bank_mask:0xc
  v_add_u32_dpp v57, v21, v2 row_newbcast:7 row_mask:0xf bank_mask:0xc
  v_add_u32_dpp v58, v25, v2 row_newbcast:7 row_mask:0xf bank_mask:0xc
  v_add_u32_dpp v59, v29, v2 row_newbcast:7 row_mask:0xf bank_mask:0xc
  v_add_u32_dpp v60, v33, v2 row_newbcast:7 row_mask:0xf bank_mask:0xc
  v_add_u32_dpp v61, v37, v2 row_newbcast:7 row_mask:0xf bank_mask:0xc
  v_add_u32_dpp v62, v41, v2 row_newbcast:7 row_mask:0xf bank_mask:0xc
  v_add_u32_dpp v63, v45, v2 row_newbcast:7 row_mask:0xf bank_mask:0xc
  v_add_u32_dpp v64, v49, v2 row_newbcast:7 row_mask:0xf bank_mask:0xc
  v_add_u32_dpp v65, v53, v2 row_newbcast:7 row_mask:0xf bank_mask:0xc
  s_setprio 0
  s_branch L_ld_in
L_cmp:
  s_mul_i32 s70, s3, 13
  v_min_u32 v118, 12, v0
  v_add_u32 v118, s70, v118
  v_lshrrev_b32 v117, 1, v118
  v_mul_u32_u24 v117, 96, v117
  v_lshl_add_u32 v118, v118, 2, v117
  s_mul_i32 s78, s27, 25
  s_min_u32 s78, s78, 294
  s_add_u32 s78, s78, s71
  s_mul_i32 s78, s78, 104
  s_waitcnt lgkmcnt(0)
  s_mov_b32 s28, s4
  s_and_b32 s29, s5, 0xffff
  s_mov_b32 s30, 425984
  s_mov_b32 s31, 0x20000
  s_mov_b32 s32, s6
  s_and_b32 s33, s7, 0xffff
  s_mov_b32 s34, 12800000
  s_mov_b32 s35, 0x20000
  s_mov_b32 s48, s14
  s_and_b32 s49, s15, 0xffff
  s_mov_b32 s50, 3328
  s_mov_b32 s51, 0x20000
  s_mov_b32 m0, 122880
  s_mov_b64 exec, 0xffff
  buffer_load_dwordx4 v11, s[48:51], s77 offen lds
  s_mov_b64 exec, -1
  s_and_b32 s68, s3, 1
  s_lshr_b32 s69, s3, 1
  v_bfe_u32 v117, v0, 2, 2
  v_lshl_add_u32 v118, v116, 3, v117
  v_lshlrev_b32 v118, 8, v118
  v_bfe_u32 v117, v0, 2, 3
  s_lshl_b32 s70, s69, 2
  v_xor_b32 v117, s70, v117
  v_lshl_add_u32 v118, v117, 5, v118
  v_and_b32 v117, 3, v0
  v_lshl_add_u32 v118, v117, 3, v118
  v_add_u32 v1, 131072, v118
  v_xor_b32 v2, 32, v1
  v_xor_b32 v3, 64, v1
  v_xor_b32 v4, 96, v1
  s_lshl_b32 s70, s69, 7
  s_add_u32 s70, s70, 122880
  v_lshlrev_b32 v118, 3, v116
  v_add_u32 v9, s70, v118
  v_and_b32 v118, 15, v0
  v_lshlrev_b32 v118, 7, v118
  v_bfe_u32 v117, v0, 1, 3
  v_xor_b32 v117, v117, v116
  v_lshl_add_u32 v118, v117, 4, v118
  s_mul_i32 s70, s68, 20480
  v_add_u32 v5, s70, v118
  v_xor_b32_e64 v7, 64, v5
  v_add_u32 v6, 81920, v5
  v_add_u32 v8, 81920, v7
  s_mul_i32 s70, s3, 640
  s_add_u32 s70, s70, 123392
  v_and_b32 v118, 15, v0
  v_lshlrev_b32 v118, 2, v118
  v_add_u32 v118, s70, v118
  v_lshrrev_b32_e64 v117, 5, v0
  v_lshl_add_u32 v118, v117, 6, v118
  v_bfe_u32 v117, v0, 4, 1
  v_lshl_add_u32 v10, v117, 7, v118
  s_mov_b32 s72, 0
  v_mov_b32 v12, 0xc0135761
  v_mov_b32 v13, 0xc0135761
  v_mov_b32 v14, 0xbdd2d3e8
  v_mov_b32 v15, 0xbdd2d3e8
  s_waitcnt vmcnt(0)
  ds_read_b64 v[18:19], v9 offset:0
  ds_read_b64 v[22:23], v9 offset:32
  ds_read_b64 v[26:27], v9 offset:64
  ds_read_b64 v[30:31], v9 offset:96
  s_waitcnt lgkmcnt(3)
  v_lshlrev_b32 v16, 16, v18
  v_and_b32 v17, 0xffff0000, v18
  v_lshlrev_b32 v18, 16, v19
  v_and_b32 v19, 0xffff0000, v19
  s_waitcnt lgkmcnt(2)
  v_lshlrev_b32 v20, 16, v22
  v_and_b32 v21, 0xffff0000, v22
  v_lshlrev_b32 v22, 16, v23
  v_and_b32 v23, 0xffff0000, v23
  s_waitcnt lgkmcnt(1)
  v_lshlrev_b32_e64 v24, 16, v26
  v_and_b32 v25, 0xffff0000, v26
  v_lshlrev_b32 v26, 16, v27
  v_and_b32 v27, 0xffff0000, v27
  s_waitcnt lgkmcnt(0)
  v_lshlrev_b32 v28, 16, v30
  v_and_b32 v29, 0xffff0000, v30
  v_lshlrev_b32 v30, 16, v31
  v_and_b32 v31, 0xffff0000, v31
  v_mov_b64 v[88:89], v[16:17]
  v_mov_b64 v[90:91], v[18:19]
  v_mov_b64 v[92:93], v[20:21]
  v_mov_b64 v[94:95], v[22:23]
  v_mov_b64 v[96:97], v[24:25]
  v_mov_b64 v[98:99], v[26:27]
  v_mov_b64 v[100:101], v[28:29]
  v_mov_b64 v[102:103], v[30:31]
  v_mov_b64 v[104:105], v[16:17]
  v_mov_b64 v[106:107], v[18:19]
  v_mov_b64 v[108:109], v[20:21]
  v_mov_b64 v[110:111], v[22:23]
  v_mov_b64 v[112:113], v[24:25]
  v_mov_b64 v[114:115], v[26:27]
  v_mov_b64 v[116:117], v[28:29]
  v_mov_b64 v[118:119], v[30:31]
  v_mov_b64 v[120:121], v[16:17]
  v_mov_b64 v[122:123], v[18:19]
  v_mov_b64 v[124:125], v[20:21]
  v_mov_b64 v[126:127], v[22:23]
  v_mov_b64 v[128:129], v[24:25]
  v_mov_b64 v[130:131], v[26:27]
  v_mov_b64 v[132:133], v[28:29]
  v_mov_b64 v[134:135], v[30:31]
  v_mov_b64 v[136:137], v[16:17]
  v_mov_b64 v[138:139], v[18:19]
  v_mov_b64 v[140:141], v[20:21]
  v_mov_b64 v[142:143], v[22:23]
  v_mov_b64 v[144:145], v[24:25]
  v_mov_b64 v[146:147], v[26:27]
  v_mov_b64 v[148:149], v[28:29]
  v_mov_b64 v[150:151], v[30:31]
  v_mov_b64 v[152:153], v[16:17]
  v_mov_b64 v[154:155], v[18:19]
  v_mov_b64 v[156:157], v[20:21]
  v_mov_b64 v[158:159], v[22:23]
  v_mov_b64 v[160:161], v[24:25]
  v_mov_b64 v[162:163], v[26:27]
  v_mov_b64 v[164:165], v[28:29]
  v_mov_b64 v[166:167], v[30:31]
  v_mov_b64 v[168:169], v[16:17]
  v_mov_b64 v[170:171], v[18:19]
  v_mov_b64 v[172:173], v[20:21]
  v_mov_b64 v[174:175], v[22:23]
  v_mov_b64 v[176:177], v[24:25]
  v_mov_b64 v[178:179], v[26:27]
  v_mov_b64 v[180:181], v[28:29]
  v_mov_b64 v[182:183], v[30:31]
  v_mov_b64 v[184:185], v[16:17]
  v_mov_b64 v[186:187], v[18:19]
  v_mov_b64 v[188:189], v[20:21]
  v_mov_b64 v[190:191], v[22:23]
  v_mov_b64 v[192:193], v[24:25]
  v_mov_b64 v[194:195], v[26:27]
  v_mov_b64 v[196:197], v[28:29]
  v_mov_b64 v[198:199], v[30:31]
  v_mov_b64 v[200:201], v[16:17]
  v_mov_b64 v[202:203], v[18:19]
  v_mov_b64 v[204:205], v[20:21]
  v_mov_b64 v[206:207], v[22:23]
  v_mov_b64 v[208:209], v[24:25]
  v_mov_b64 v[210:211], v[26:27]
  v_mov_b64 v[212:213], v[28:29]
  v_mov_b64 v[214:215], v[30:31]
  v_mov_b64 v[216:217], v[16:17]
  v_mov_b64 v[218:219], v[18:19]
  v_mov_b64 v[220:221], v[20:21]
  v_mov_b64 v[222:223], v[22:23]
  v_mov_b64 v[224:225], v[24:25]
  v_mov_b64 v[226:227], v[26:27]
  v_mov_b64 v[228:229], v[28:29]
  v_mov_b64 v[230:231], v[30:31]
  v_mov_b64 v[232:233], v[16:17]
  v_mov_b64 v[234:235], v[18:19]
  v_mov_b64 v[236:237], v[20:21]
  v_mov_b64 v[238:239], v[22:23]
  v_mov_b64 v[240:241], v[24:25]
  v_mov_b64 v[242:243], v[26:27]
  v_mov_b64 v[244:245], v[28:29]
  v_mov_b64 v[246:247], v[30:31]
  s_barrier
  ds_read_b64_tr_b16 v[16:17], v1 offset:0
  ds_read_b64_tr_b16 v[18:19], v1 offset:1024
  ds_read_b64_tr_b16 v[32:33], v1 offset:8192
  ds_read_b64_tr_b16 v[34:35], v1 offset:9216
  ds_read_b64_tr_b16 v[20:21], v2 offset:0
  ds_read_b64_tr_b16 v[22:23], v2 offset:1024
  ds_read_b64_tr_b16 v[36:37], v2 offset:8192
  ds_read_b64_tr_b16 v[38:39], v2 offset:9216
  ds_read_b64_tr_b16 v[24:25], v3 offset:0
  ds_read_b64_tr_b16 v[26:27], v3 offset:1024
  ds_read_b64_tr_b16 v[40:41], v3 offset:8192
  ds_read_b64_tr_b16 v[42:43], v3 offset:9216
  ds_read_b64_tr_b16 v[28:29], v4 offset:0
  ds_read_b64_tr_b16 v[30:31], v4 offset:1024
  ds_read_b64_tr_b16 v[44:45], v4 offset:8192
  ds_read_b64_tr_b16 v[46:47], v4 offset:9216
  s_waitcnt lgkmcnt(0)
  s_setprio 1
  s_barrier
  ds_read_b128 v[48:51], v5 offset:0
  ds_read_b128 v[52:55], v7 offset:0
  ds_read_b128 v[56:59], v5 offset:2048
  ds_read_b128 v[60:63], v7 offset:2048
  ds_read_b128 v[64:67], v5 offset:4096
  ds_read_b128 v[68:71], v7 offset:4096
  ds_read_b128 v[72:75], v5 offset:6144
  ds_read_b128 v[76:79], v7 offset:6144
  s_waitcnt lgkmcnt(7)
  v_mfma_f32_16x16x32_bf16 v[88:91], v[16:19], v[48:51], v[88:91]
  s_waitcnt lgkmcnt(4)
  v_mfma_f32_16x16x32_bf16 v[88:91], v[32:35], v[52:55], v[88:91]
  v_mfma_f32_16x16x32_bf16 v[104:107], v[32:35], v[60:63], v[104:107]
  v_mfma_f32_16x16x32_bf16 v[104:107], v[16:19], v[56:59], v[104:107]
  v_mfma_f32_16x16x32_bf16 v[108:111], v[20:23], v[56:59], v[108:111]
  v_mfma_f32_16x16x32_bf16 v[108:111], v[36:39], v[60:63], v[108:111]
  v_mfma_f32_16x16x32_bf16 v[92:95], v[36:39], v[52:55], v[92:95]
  v_mfma_f32_16x16x32_bf16 v[92:95], v[20:23], v[48:51], v[92:95]
  v_mfma_f32_16x16x32_bf16 v[96:99], v[24:27], v[48:51], v[96:99]
  v_xor_b32 v1, 16384, v1
  v_mfma_f32_16x16x32_bf16 v[96:99], v[40:43], v[52:55], v[96:99]
  v_xor_b32 v2, 16384, v2
  v_mfma_f32_16x16x32_bf16 v[112:115], v[40:43], v[60:63], v[112:115]
  v_xor_b32 v3, 16384, v3
  v_mfma_f32_16x16x32_bf16 v[112:115], v[24:27], v[56:59], v[112:115]
  v_xor_b32 v4, 16384, v4
  v_mfma_f32_16x16x32_bf16 v[116:119], v[28:31], v[56:59], v[116:119]
  v_mfma_f32_16x16x32_bf16 v[116:119], v[44:47], v[60:63], v[116:119]
  v_mfma_f32_16x16x32_bf16 v[100:103], v[44:47], v[52:55], v[100:103]
  s_waitcnt lgkmcnt(2)
  v_mfma_f32_16x16x32_bf16 v[100:103], v[28:31], v[48:51], v[100:103]
  s_nop 0
  v_mfma_f32_16x16x32_bf16 v[120:123], v[16:19], v[64:67], v[120:123]
  s_barrier
  s_waitcnt lgkmcnt(0)
  v_mfma_f32_16x16x32_bf16 v[120:123], v[32:35], v[68:71], v[120:123]
  ds_read_b128 v[80:83], v5 offset:8192
  v_mfma_f32_16x16x32_bf16 v[136:139], v[32:35], v[76:79], v[136:139]
  ds_read_b128 v[84:87], v7 offset:8192
  v_mfma_f32_16x16x32_bf16 v[136:139], v[16:19], v[72:75], v[136:139]
  ds_read_b128 v[48:51], v5 offset:10240
  v_mfma_f32_16x16x32_bf16 v[140:143], v[20:23], v[72:75], v[140:143]
  ds_read_b128 v[52:55], v7 offset:10240
  v_mfma_f32_16x16x32_bf16 v[140:143], v[36:39], v[76:79], v[140:143]
  ds_read_b128 v[56:59], v5 offset:12288
  v_mfma_f32_16x16x32_bf16 v[124:127], v[36:39], v[68:71], v[124:127]
  ds_read_b128 v[60:63], v7 offset:12288
  v_mfma_f32_16x16x32_bf16 v[124:127], v[20:23], v[64:67], v[124:127]
  v_mfma_f32_16x16x32_bf16 v[128:131], v[24:27], v[64:67], v[128:131]
  v_mfma_f32_16x16x32_bf16 v[128:131], v[40:43], v[68:71], v[128:131]
  v_mfma_f32_16x16x32_bf16 v[144:147], v[40:43], v[76:79], v[144:147]
  v_mfma_f32_16x16x32_bf16 v[144:147], v[24:27], v[72:75], v[144:147]
  v_mfma_f32_16x16x32_bf16 v[148:151], v[28:31], v[72:75], v[148:151]
  ds_read_b128 v[72:75], v5 offset:16384
  v_mfma_f32_16x16x32_bf16 v[148:151], v[44:47], v[76:79], v[148:151]
  s_nop 0
  ds_read_b128 v[76:79], v7 offset:16384
  v_mfma_f32_16x16x32_bf16 v[132:135], v[44:47], v[68:71], v[132:135]
  ds_read_b128 v[68:71], v7 offset:14336
  s_waitcnt lgkmcnt(7)
  v_mfma_f32_16x16x32_bf16 v[132:135], v[28:31], v[64:67], v[132:135]
  ds_read_b128 v[64:67], v5 offset:14336
  v_mfma_f32_16x16x32_bf16 v[152:155], v[16:19], v[80:83], v[152:155]
  s_waitcnt lgkmcnt(6)
  v_mfma_f32_16x16x32_bf16 v[152:155], v[32:35], v[84:87], v[152:155]
  v_mfma_f32_16x16x32_bf16 v[168:171], v[32:35], v[52:55], v[168:171]
  v_mfma_f32_16x16x32_bf16 v[168:171], v[16:19], v[48:51], v[168:171]
  v_mfma_f32_16x16x32_bf16 v[172:175], v[20:23], v[48:51], v[172:175]
  s_nop 0
  v_mfma_f32_16x16x32_bf16 v[172:175], v[36:39], v[52:55], v[172:175]
  v_mfma_f32_16x16x32_bf16 v[156:159], v[36:39], v[84:87], v[156:159]
  v_mfma_f32_16x16x32_bf16 v[156:159], v[20:23], v[80:83], v[156:159]
  v_mfma_f32_16x16x32_bf16 v[160:163], v[24:27], v[80:83], v[160:163]
  v_mfma_f32_16x16x32_bf16 v[160:163], v[40:43], v[84:87], v[160:163]
  v_mfma_f32_16x16x32_bf16 v[176:179], v[40:43], v[52:55], v[176:179]
  v_mfma_f32_16x16x32_bf16 v[176:179], v[24:27], v[48:51], v[176:179]
  v_mfma_f32_16x16x32_bf16 v[180:183], v[28:31], v[48:51], v[180:183]
  v_mfma_f32_16x16x32_bf16 v[180:183], v[44:47], v[52:55], v[180:183]
  v_mfma_f32_16x16x32_bf16 v[164:167], v[44:47], v[84:87], v[164:167]
  ds_read_b128 v[84:87], v7 offset:18432
  s_waitcnt lgkmcnt(5)
  v_mfma_f32_16x16x32_bf16 v[164:167], v[28:31], v[80:83], v[164:167]
  ds_read_b128 v[80:83], v5 offset:18432
  v_mfma_f32_16x16x32_bf16 v[184:187], v[16:19], v[56:59], v[184:187]
  s_waitcnt lgkmcnt(2)
  v_mfma_f32_16x16x32_bf16 v[184:187], v[32:35], v[60:63], v[184:187]
  v_mfma_f32_16x16x32_bf16 v[200:203], v[32:35], v[68:71], v[200:203]
  v_mfma_f32_16x16x32_bf16 v[200:203], v[16:19], v[64:67], v[200:203]
  v_mfma_f32_16x16x32_bf16 v[204:207], v[20:23], v[64:67], v[204:207]
  v_mfma_f32_16x16x32_bf16 v[204:207], v[36:39], v[68:71], v[204:207]
  s_waitcnt lgkmcnt(0)
  s_barrier
  v_mfma_f32_16x16x32_bf16 v[188:191], v[36:39], v[60:63], v[188:191]
  ds_read_b128 v[48:51], v5 offset:40960
  v_mfma_f32_16x16x32_bf16 v[188:191], v[20:23], v[56:59], v[188:191]
  ds_read_b128 v[52:55], v7 offset:40960
  v_mfma_f32_16x16x32_bf16 v[192:195], v[24:27], v[56:59], v[192:195]
  v_mfma_f32_16x16x32_bf16 v[192:195], v[40:43], v[60:63], v[192:195]
  v_mfma_f32_16x16x32_bf16 v[208:211], v[40:43], v[68:71], v[208:211]
  v_mfma_f32_16x16x32_bf16 v[208:211], v[24:27], v[64:67], v[208:211]
  v_mfma_f32_16x16x32_bf16 v[212:215], v[28:31], v[64:67], v[212:215]
  ds_read_b128 v[64:67], v5 offset:45056
  v_mfma_f32_16x16x32_bf16 v[212:215], v[44:47], v[68:71], v[212:215]
  ds_read_b128 v[68:71], v7 offset:45056
  v_mfma_f32_16x16x32_bf16 v[196:199], v[44:47], v[60:63], v[196:199]
  ds_read_b128 v[60:63], v7 offset:43008
  v_mfma_f32_16x16x32_bf16 v[196:199], v[28:31], v[56:59], v[196:199]
  ds_read_b128 v[56:59], v5 offset:43008
  v_mfma_f32_16x16x32_bf16 v[216:219], v[32:35], v[76:79], v[216:219]
  v_mfma_f32_16x16x32_bf16 v[216:219], v[16:19], v[72:75], v[216:219]
  v_mfma_f32_16x16x32_bf16 v[232:235], v[16:19], v[80:83], v[232:235]
  ds_read_b64_tr_b16 v[16:17], v1 offset:0
  v_mfma_f32_16x16x32_bf16 v[232:235], v[32:35], v[84:87], v[232:235]
  ds_read_b64_tr_b16 v[18:19], v1 offset:1024
  v_mfma_f32_16x16x32_bf16 v[236:239], v[36:39], v[84:87], v[236:239]
  ds_read_b64_tr_b16 v[32:33], v1 offset:8192
  v_mfma_f32_16x16x32_bf16 v[236:239], v[20:23], v[80:83], v[236:239]
  ds_read_b64_tr_b16 v[34:35], v1 offset:9216
  v_mfma_f32_16x16x32_bf16 v[220:223], v[20:23], v[72:75], v[220:223]
  ds_read_b64_tr_b16 v[20:21], v2 offset:0
  v_mfma_f32_16x16x32_bf16 v[220:223], v[36:39], v[76:79], v[220:223]
  ds_read_b64_tr_b16 v[22:23], v2 offset:1024
  v_mfma_f32_16x16x32_bf16 v[224:227], v[40:43], v[76:79], v[224:227]
  ds_read_b64_tr_b16 v[36:37], v2 offset:8192
  v_mfma_f32_16x16x32_bf16 v[224:227], v[24:27], v[72:75], v[224:227]
  ds_read_b64_tr_b16 v[38:39], v2 offset:9216
  v_mfma_f32_16x16x32_bf16 v[240:243], v[24:27], v[80:83], v[240:243]
  ds_read_b64_tr_b16 v[24:25], v3 offset:0
  v_mfma_f32_16x16x32_bf16 v[240:243], v[40:43], v[84:87], v[240:243]
  ds_read_b64_tr_b16 v[26:27], v3 offset:1024
  v_mfma_f32_16x16x32_bf16 v[244:247], v[44:47], v[84:87], v[244:247]
  ds_read_b64_tr_b16 v[40:41], v3 offset:8192
  v_mfma_f32_16x16x32_bf16 v[244:247], v[28:31], v[80:83], v[244:247]
  ds_read_b64_tr_b16 v[42:43], v3 offset:9216
  v_mfma_f32_16x16x32_bf16 v[228:231], v[28:31], v[72:75], v[228:231]
  ds_read_b64_tr_b16 v[28:29], v4 offset:0
  s_waitcnt lgkmcnt(9)
  v_mfma_f32_16x16x32_bf16 v[228:231], v[44:47], v[76:79], v[228:231]
  ds_read_b64_tr_b16 v[30:31], v4 offset:1024
L_dnn_loop0:
  v_mfma_f32_16x16x32_bf16 v[88:91], v[16:19], v[48:51], v[88:91]
  ds_read_b64_tr_b16 v[44:45], v4 offset:8192
  v_mfma_f32_16x16x32_bf16 v[88:91], v[32:35], v[52:55], v[88:91]
  s_nop 0
  ds_read_b64_tr_b16 v[46:47], v4 offset:9216
  v_mfma_f32_16x16x32_bf16 v[104:107], v[32:35], v[60:63], v[104:107]
  ds_read_b128 v[72:75], v5 offset:47104
  s_waitcnt lgkmcnt(9)
  v_mfma_f32_16x16x32_bf16 v[104:107], v[16:19], v[56:59], v[104:107]
  ds_read_b128 v[76:79], v7 offset:47104
  v_mfma_f32_16x16x32_bf16 v[108:111], v[20:23], v[56:59], v[108:111]
  ds_read_b128 v[80:83], v5 offset:49152
  v_mfma_f32_16x16x32_bf16 v[108:111], v[36:39], v[60:63], v[108:111]
  s_nop 0
  ds_read_b128 v[84:87], v7 offset:49152
  v_mfma_f32_16x16x32_bf16 v[92:95], v[36:39], v[52:55], v[92:95]
  s_waitcnt lgkmcnt(8)
  v_mfma_f32_16x16x32_bf16 v[92:95], v[20:23], v[48:51], v[92:95]
  v_mfma_f32_16x16x32_bf16 v[96:99], v[24:27], v[48:51], v[96:99]
  v_xor_b32 v1, 16384, v1
  v_mfma_f32_16x16x32_bf16 v[96:99], v[40:43], v[52:55], v[96:99]
  s_nop 0
  v_xor_b32 v2, 16384, v2
  v_mfma_f32_16x16x32_bf16 v[112:115], v[40:43], v[60:63], v[112:115]
  v_xor_b32 v3, 16384, v3
  s_waitcnt lgkmcnt(4)
  v_mfma_f32_16x16x32_bf16 v[112:115], v[24:27], v[56:59], v[112:115]
  v_xor_b32 v4, 16384, v4
  v_mfma_f32_16x16x32_bf16 v[116:119], v[28:31], v[56:59], v[116:119]
  ds_read_b128 v[56:59], v5 offset:53248
  v_mfma_f32_16x16x32_bf16 v[116:119], v[44:47], v[60:63], v[116:119]
  s_nop 0
  ds_read_b128 v[60:63], v7 offset:53248
  v_mfma_f32_16x16x32_bf16 v[100:103], v[44:47], v[52:55], v[100:103]
  ds_read_b128 v[52:55], v7 offset:51200
  v_mfma_f32_16x16x32_bf16 v[100:103], v[28:31], v[48:51], v[100:103]
  ds_read_b128 v[48:51], v5 offset:51200
  v_mfma_f32_16x16x32_bf16 v[120:123], v[16:19], v[64:67], v[120:123]
  s_waitcnt lgkmcnt(6)
  v_mfma_f32_16x16x32_bf16 v[120:123], v[32:35], v[68:71], v[120:123]
  s_nop 0
  v_mfma_f32_16x16x32_bf16 v[136:139], v[32:35], v[76:79], v[136:139]
  v_mfma_f32_16x16x32_bf16 v[136:139], v[16:19], v[72:75], v[136:139]
  v_mfma_f32_16x16x32_bf16 v[140:143], v[20:23], v[72:75], v[140:143]
  v_mfma_f32_16x16x32_bf16 v[140:143], v[36:39], v[76:79], v[140:143]
  v_mfma_f32_16x16x32_bf16 v[124:127], v[36:39], v[68:71], v[124:127]
  v_mfma_f32_16x16x32_bf16 v[124:127], v[20:23], v[64:67], v[124:127]
  v_mfma_f32_16x16x32_bf16 v[128:131], v[24:27], v[64:67], v[128:131]
  v_mfma_f32_16x16x32_bf16 v[128:131], v[40:43], v[68:71], v[128:131]
  v_mfma_f32_16x16x32_bf16 v[144:147], v[40:43], v[76:79], v[144:147]
  v_mfma_f32_16x16x32_bf16 v[144:147], v[24:27], v[72:75], v[144:147]
  v_mfma_f32_16x16x32_bf16 v[148:151], v[28:31], v[72:75], v[148:151]
  ds_read_b128 v[72:75], v5 offset:57344
  v_mfma_f32_16x16x32_bf16 v[148:151], v[44:47], v[76:79], v[148:151]
  ds_read_b128 v[76:79], v7 offset:57344
  v_mfma_f32_16x16x32_bf16 v[132:135], v[44:47], v[68:71], v[132:135]
  ds_read_b128 v[68:71], v7 offset:55296
  s_waitcnt lgkmcnt(7)
  v_mfma_f32_16x16x32_bf16 v[132:135], v[28:31], v[64:67], v[132:135]
  ds_read_b128 v[64:67], v5 offset:55296
  v_mfma_f32_16x16x32_bf16 v[152:155], v[16:19], v[80:83], v[152:155]
  s_waitcnt lgkmcnt(4)
  v_mfma_f32_16x16x32_bf16 v[152:155], v[32:35], v[84:87], v[152:155]
  v_mfma_f32_16x16x32_bf16 v[168:171], v[32:35], v[52:55], v[168:171]
  v_mfma_f32_16x16x32_bf16 v[168:171], v[16:19], v[48:51], v[168:171]
  v_mfma_f32_16x16x32_bf16 v[172:175], v[20:23], v[48:51], v[172:175]
  v_mfma_f32_16x16x32_bf16 v[172:175], v[36:39], v[52:55], v[172:175]
  v_mfma_f32_16x16x32_bf16 v[156:159], v[36:39], v[84:87], v[156:159]
  v_mfma_f32_16x16x32_bf16 v[156:159], v[20:23], v[80:83], v[156:159]
  v_mfma_f32_16x16x32_bf16 v[160:163], v[24:27], v[80:83], v[160:163]
  v_mfma_f32_16x16x32_bf16 v[160:163], v[40:43], v[84:87], v[160:163]
  v_mfma_f32_16x16x32_bf16 v[176:179], v[40:43], v[52:55], v[176:179]
  v_mfma_f32_16x16x32_bf16 v[176:179], v[24:27], v[48:51], v[176:179]
  v_mfma_f32_16x16x32_bf16 v[180:183], v[28:31], v[48:51], v[180:183]
  v_mfma_f32_16x16x32_bf16 v[180:183], v[44:47], v[52:55], v[180:183]
  v_mfma_f32_16x16x32_bf16 v[164:167], v[44:47], v[84:87], v[164:167]
  ds_read_b128 v[84:87], v7 offset:59392
  v_mfma_f32_16x16x32_bf16 v[164:167], v[28:31], v[80:83], v[164:167]
  ds_read_b128 v[80:83], v5 offset:59392
  v_mfma_f32_16x16x32_bf16 v[184:187], v[16:19], v[56:59], v[184:187]
  s_waitcnt lgkmcnt(2)
  v_mfma_f32_16x16x32_bf16 v[184:187], v[32:35], v[60:63], v[184:187]
  s_nop 0
  v_mfma_f32_16x16x32_bf16 v[200:203], v[32:35], v[68:71], v[200:203]
  v_mfma_f32_16x16x32_bf16 v[200:203], v[16:19], v[64:67], v[200:203]
  v_mfma_f32_16x16x32_bf16 v[204:207], v[20:23], v[64:67], v[204:207]
  v_mfma_f32_16x16x32_bf16 v[204:207], v[36:39], v[68:71], v[204:207]
  s_waitcnt lgkmcnt(0)
  s_barrier
  v_mfma_f32_16x16x32_bf16 v[188:191], v[36:39], v[60:63], v[188:191]
  ds_read_b128 v[48:51], v6 offset:0
  v_mfma_f32_16x16x32_bf16 v[188:191], v[20:23], v[56:59], v[188:191]
  ds_read_b128 v[52:55], v8 offset:0
  v_mfma_f32_16x16x32_bf16 v[192:195], v[24:27], v[56:59], v[192:195]
  v_mfma_f32_16x16x32_bf16 v[192:195], v[40:43], v[60:63], v[192:195]
  v_mfma_f32_16x16x32_bf16 v[208:211], v[40:43], v[68:71], v[208:211]
  v_mfma_f32_16x16x32_bf16 v[208:211], v[24:27], v[64:67], v[208:211]
  v_mfma_f32_16x16x32_bf16 v[212:215], v[28:31], v[64:67], v[212:215]
  ds_read_b128 v[64:67], v6 offset:4096
  v_mfma_f32_16x16x32_bf16 v[212:215], v[44:47], v[68:71], v[212:215]
  ds_read_b128 v[68:71], v8 offset:4096
  v_mfma_f32_16x16x32_bf16 v[196:199], v[44:47], v[60:63], v[196:199]
  ds_read_b128 v[60:63], v8 offset:2048
  v_mfma_f32_16x16x32_bf16 v[196:199], v[28:31], v[56:59], v[196:199]
  ds_read_b128 v[56:59], v6 offset:2048
  v_mfma_f32_16x16x32_bf16 v[216:219], v[32:35], v[76:79], v[216:219]
  v_mfma_f32_16x16x32_bf16 v[216:219], v[16:19], v[72:75], v[216:219]
  v_mfma_f32_16x16x32_bf16 v[232:235], v[16:19], v[80:83], v[232:235]
  ds_read_b64_tr_b16 v[16:17], v1 offset:0
  v_mfma_f32_16x16x32_bf16 v[232:235], v[32:35], v[84:87], v[232:235]
  ds_read_b64_tr_b16 v[18:19], v1 offset:1024
  v_mfma_f32_16x16x32_bf16 v[236:239], v[36:39], v[84:87], v[236:239]
  ds_read_b64_tr_b16 v[32:33], v1 offset:8192
  v_mfma_f32_16x16x32_bf16 v[236:239], v[20:23], v[80:83], v[236:239]
  ds_read_b64_tr_b16 v[34:35], v1 offset:9216
  v_mfma_f32_16x16x32_bf16 v[220:223], v[20:23], v[72:75], v[220:223]
  ds_read_b64_tr_b16 v[20:21], v2 offset:0
  v_mfma_f32_16x16x32_bf16 v[220:223], v[36:39], v[76:79], v[220:223]
  ds_read_b64_tr_b16 v[22:23], v2 offset:1024
  v_mfma_f32_16x16x32_bf16 v[224:227], v[40:43], v[76:79], v[224:227]
  ds_read_b64_tr_b16 v[36:37], v2 offset:8192
  v_mfma_f32_16x16x32_bf16 v[224:227], v[24:27], v[72:75], v[224:227]
  ds_read_b64_tr_b16 v[38:39], v2 offset:9216
  v_mfma_f32_16x16x32_bf16 v[240:243], v[24:27], v[80:83], v[240:243]
  ds_read_b64_tr_b16 v[24:25], v3 offset:0
  v_mfma_f32_16x16x32_bf16 v[240:243], v[40:43], v[84:87], v[240:243]
  ds_read_b64_tr_b16 v[26:27], v3 offset:1024
  v_mfma_f32_16x16x32_bf16 v[244:247], v[44:47], v[84:87], v[244:247]
  ds_read_b64_tr_b16 v[40:41], v3 offset:8192
  v_mfma_f32_16x16x32_bf16 v[244:247], v[28:31], v[80:83], v[244:247]
  ds_read_b64_tr_b16 v[42:43], v3 offset:9216
  v_mfma_f32_16x16x32_bf16 v[228:231], v[28:31], v[72:75], v[228:231]
  ds_read_b64_tr_b16 v[28:29], v4 offset:0
  s_waitcnt lgkmcnt(9)
  v_mfma_f32_16x16x32_bf16 v[228:231], v[44:47], v[76:79], v[228:231]
  ds_read_b64_tr_b16 v[30:31], v4 offset:1024
  v_mfma_f32_16x16x32_bf16 v[88:91], v[16:19], v[48:51], v[88:91]
  ds_read_b64_tr_b16 v[44:45], v4 offset:8192
  v_mfma_f32_16x16x32_bf16 v[88:91], v[32:35], v[52:55], v[88:91]
  s_nop 0
  ds_read_b64_tr_b16 v[46:47], v4 offset:9216
  v_mfma_f32_16x16x32_bf16 v[104:107], v[32:35], v[60:63], v[104:107]
  ds_read_b128 v[72:75], v6 offset:6144
  s_waitcnt lgkmcnt(9)
  v_mfma_f32_16x16x32_bf16 v[104:107], v[16:19], v[56:59], v[104:107]
  ds_read_b128 v[76:79], v8 offset:6144
  v_mfma_f32_16x16x32_bf16 v[108:111], v[20:23], v[56:59], v[108:111]
  ds_read_b128 v[80:83], v6 offset:8192
  v_mfma_f32_16x16x32_bf16 v[108:111], v[36:39], v[60:63], v[108:111]
  s_nop 0
  ds_read_b128 v[84:87], v8 offset:8192
  v_mfma_f32_16x16x32_bf16 v[92:95], v[36:39], v[52:55], v[92:95]
  s_waitcnt lgkmcnt(8)
  v_mfma_f32_16x16x32_bf16 v[92:95], v[20:23], v[48:51], v[92:95]
  v_mfma_f32_16x16x32_bf16 v[96:99], v[24:27], v[48:51], v[96:99]
  v_xor_b32 v1, 16384, v1
  v_mfma_f32_16x16x32_bf16 v[96:99], v[40:43], v[52:55], v[96:99]
  s_nop 0
  v_xor_b32 v2, 16384, v2
  v_mfma_f32_16x16x32_bf16 v[112:115], v[40:43], v[60:63], v[112:115]
  v_xor_b32 v3, 16384, v3
  s_waitcnt lgkmcnt(4)
  v_mfma_f32_16x16x32_bf16 v[112:115], v[24:27], v[56:59], v[112:115]
  v_xor_b32 v4, 16384, v4
  v_mfma_f32_16x16x32_bf16 v[116:119], v[28:31], v[56:59], v[116:119]
  ds_read_b128 v[56:59], v6 offset:12288
  v_mfma_f32_16x16x32_bf16 v[116:119], v[44:47], v[60:63], v[116:119]
  s_nop 0
  ds_read_b128 v[60:63], v8 offset:12288
  v_mfma_f32_16x16x32_bf16 v[100:103], v[44:47], v[52:55], v[100:103]
  ds_read_b128 v[52:55], v8 offset:10240
  v_mfma_f32_16x16x32_bf16 v[100:103], v[28:31], v[48:51], v[100:103]
  ds_read_b128 v[48:51], v6 offset:10240
  v_mfma_f32_16x16x32_bf16 v[120:123], v[16:19], v[64:67], v[120:123]
  s_waitcnt lgkmcnt(6)
  v_mfma_f32_16x16x32_bf16 v[120:123], v[32:35], v[68:71], v[120:123]
  s_nop 0
  v_mfma_f32_16x16x32_bf16 v[136:139], v[32:35], v[76:79], v[136:139]
  v_mfma_f32_16x16x32_bf16 v[136:139], v[16:19], v[72:75], v[136:139]
  v_mfma_f32_16x16x32_bf16 v[140:143], v[20:23], v[72:75], v[140:143]
  v_mfma_f32_16x16x32_bf16 v[140:143], v[36:39], v[76:79], v[140:143]
  v_mfma_f32_16x16x32_bf16 v[124:127], v[36:39], v[68:71], v[124:127]
  v_mfma_f32_16x16x32_bf16 v[124:127], v[20:23], v[64:67], v[124:127]
  v_mfma_f32_16x16x32_bf16 v[128:131], v[24:27], v[64:67], v[128:131]
  v_mfma_f32_16x16x32_bf16 v[128:131], v[40:43], v[68:71], v[128:131]
  v_mfma_f32_16x16x32_bf16 v[144:147], v[40:43], v[76:79], v[144:147]
  v_mfma_f32_16x16x32_bf16 v[144:147], v[24:27], v[72:75], v[144:147]
  v_mfma_f32_16x16x32_bf16 v[148:151], v[28:31], v[72:75], v[148:151]
  ds_read_b128 v[72:75], v6 offset:16384
  v_mfma_f32_16x16x32_bf16 v[148:151], v[44:47], v[76:79], v[148:151]
  ds_read_b128 v[76:79], v8 offset:16384
  v_mfma_f32_16x16x32_bf16 v[132:135], v[44:47], v[68:71], v[132:135]
  ds_read_b128 v[68:71], v8 offset:14336
  s_waitcnt lgkmcnt(7)
  v_mfma_f32_16x16x32_bf16 v[132:135], v[28:31], v[64:67], v[132:135]
  ds_read_b128 v[64:67], v6 offset:14336
  v_mfma_f32_16x16x32_bf16 v[152:155], v[16:19], v[80:83], v[152:155]
  s_waitcnt lgkmcnt(4)
  v_mfma_f32_16x16x32_bf16 v[152:155], v[32:35], v[84:87], v[152:155]
  v_mfma_f32_16x16x32_bf16 v[168:171], v[32:35], v[52:55], v[168:171]
  v_mfma_f32_16x16x32_bf16 v[168:171], v[16:19], v[48:51], v[168:171]
  v_mfma_f32_16x16x32_bf16 v[172:175], v[20:23], v[48:51], v[172:175]
  v_mfma_f32_16x16x32_bf16 v[172:175], v[36:39], v[52:55], v[172:175]
  v_mfma_f32_16x16x32_bf16 v[156:159], v[36:39], v[84:87], v[156:159]
  v_mfma_f32_16x16x32_bf16 v[156:159], v[20:23], v[80:83], v[156:159]
  v_mfma_f32_16x16x32_bf16 v[160:163], v[24:27], v[80:83], v[160:163]
  v_mfma_f32_16x16x32_bf16 v[160:163], v[40:43], v[84:87], v[160:163]
  v_mfma_f32_16x16x32_bf16 v[176:179], v[40:43], v[52:55], v[176:179]
  v_mfma_f32_16x16x32_bf16 v[176:179], v[24:27], v[48:51], v[176:179]
  v_mfma_f32_16x16x32_bf16 v[180:183], v[28:31], v[48:51], v[180:183]
  v_mfma_f32_16x16x32_bf16 v[180:183], v[44:47], v[52:55], v[180:183]
  v_mfma_f32_16x16x32_bf16 v[164:167], v[44:47], v[84:87], v[164:167]
  ds_read_b128 v[84:87], v8 offset:18432
  v_mfma_f32_16x16x32_bf16 v[164:167], v[28:31], v[80:83], v[164:167]
  ds_read_b128 v[80:83], v6 offset:18432
  v_mfma_f32_16x16x32_bf16 v[184:187], v[16:19], v[56:59], v[184:187]
  s_waitcnt lgkmcnt(2)
  v_mfma_f32_16x16x32_bf16 v[184:187], v[32:35], v[60:63], v[184:187]
  s_nop 0
  v_mfma_f32_16x16x32_bf16 v[200:203], v[32:35], v[68:71], v[200:203]
  v_mfma_f32_16x16x32_bf16 v[200:203], v[16:19], v[64:67], v[200:203]
  v_mfma_f32_16x16x32_bf16 v[204:207], v[20:23], v[64:67], v[204:207]
  v_mfma_f32_16x16x32_bf16 v[204:207], v[36:39], v[68:71], v[204:207]
  s_waitcnt lgkmcnt(0)
  s_barrier
  v_mfma_f32_16x16x32_bf16 v[188:191], v[36:39], v[60:63], v[188:191]
  ds_read_b128 v[48:51], v5 offset:0
  v_mfma_f32_16x16x32_bf16 v[188:191], v[20:23], v[56:59], v[188:191]
  ds_read_b128 v[52:55], v7 offset:0
  v_mfma_f32_16x16x32_bf16 v[192:195], v[24:27], v[56:59], v[192:195]
  v_mfma_f32_16x16x32_bf16 v[192:195], v[40:43], v[60:63], v[192:195]
  v_mfma_f32_16x16x32_bf16 v[208:211], v[40:43], v[68:71], v[208:211]
  v_mfma_f32_16x16x32_bf16 v[208:211], v[24:27], v[64:67], v[208:211]
  v_mfma_f32_16x16x32_bf16 v[212:215], v[28:31], v[64:67], v[212:215]
  ds_read_b128 v[64:67], v5 offset:4096
  v_mfma_f32_16x16x32_bf16 v[212:215], v[44:47], v[68:71], v[212:215]
  ds_read_b128 v[68:71], v7 offset:4096
  v_mfma_f32_16x16x32_bf16 v[196:199], v[44:47], v[60:63], v[196:199]
  ds_read_b128 v[60:63], v7 offset:2048
  v_mfma_f32_16x16x32_bf16 v[196:199], v[28:31], v[56:59], v[196:199]
  ds_read_b128 v[56:59], v5 offset:2048
  v_mfma_f32_16x16x32_bf16 v[216:219], v[32:35], v[76:79], v[216:219]
  v_mfma_f32_16x16x32_bf16 v[216:219], v[16:19], v[72:75], v[216:219]
  v_mfma_f32_16x16x32_bf16 v[232:235], v[16:19], v[80:83], v[232:235]
  ds_read_b64_tr_b16 v[16:17], v1 offset:0
  v_mfma_f32_16x16x32_bf16 v[232:235], v[32:35], v[84:87], v[232:235]
  ds_read_b64_tr_b16 v[18:19], v1 offset:1024
  v_mfma_f32_16x16x32_bf16 v[236:239], v[36:39], v[84:87], v[236:239]
  ds_read_b64_tr_b16 v[32:33], v1 offset:8192
  v_mfma_f32_16x16x32_bf16 v[236:239], v[20:23], v[80:83], v[236:239]
  ds_read_b64_tr_b16 v[34:35], v1 offset:9216
  v_mfma_f32_16x16x32_bf16 v[220:223], v[20:23], v[72:75], v[220:223]
  ds_read_b64_tr_b16 v[20:21], v2 offset:0
  v_mfma_f32_16x16x32_bf16 v[220:223], v[36:39], v[76:79], v[220:223]
  ds_read_b64_tr_b16 v[22:23], v2 offset:1024
  v_mfma_f32_16x16x32_bf16 v[224:227], v[40:43], v[76:79], v[224:227]
  ds_read_b64_tr_b16 v[36:37], v2 offset:8192
  v_mfma_f32_16x16x32_bf16 v[224:227], v[24:27], v[72:75], v[224:227]
  ds_read_b64_tr_b16 v[38:39], v2 offset:9216
  v_mfma_f32_16x16x32_bf16 v[240:243], v[24:27], v[80:83], v[240:243]
  ds_read_b64_tr_b16 v[24:25], v3 offset:0
  v_mfma_f32_16x16x32_bf16 v[240:243], v[40:43], v[84:87], v[240:243]
  ds_read_b64_tr_b16 v[26:27], v3 offset:1024
  v_mfma_f32_16x16x32_bf16 v[244:247], v[44:47], v[84:87], v[244:247]
  ds_read_b64_tr_b16 v[40:41], v3 offset:8192
  v_mfma_f32_16x16x32_bf16 v[244:247], v[28:31], v[80:83], v[244:247]
  ds_read_b64_tr_b16 v[42:43], v3 offset:9216
  v_mfma_f32_16x16x32_bf16 v[228:231], v[28:31], v[72:75], v[228:231]
  ds_read_b64_tr_b16 v[28:29], v4 offset:0
  s_waitcnt lgkmcnt(9)
  v_mfma_f32_16x16x32_bf16 v[228:231], v[44:47], v[76:79], v[228:231]
  ds_read_b64_tr_b16 v[30:31], v4 offset:1024
  v_mfma_f32_16x16x32_bf16 v[88:91], v[16:19], v[48:51], v[88:91]
  ds_read_b64_tr_b16 v[44:45], v4 offset:8192
  v_mfma_f32_16x16x32_bf16 v[88:91], v[32:35], v[52:55], v[88:91]
  s_nop 0
  ds_read_b64_tr_b16 v[46:47], v4 offset:9216
  v_mfma_f32_16x16x32_bf16 v[104:107], v[32:35], v[60:63], v[104:107]
  ds_read_b128 v[72:75], v5 offset:6144
  s_waitcnt lgkmcnt(9)
  v_mfma_f32_16x16x32_bf16 v[104:107], v[16:19], v[56:59], v[104:107]
  ds_read_b128 v[76:79], v7 offset:6144
  v_mfma_f32_16x16x32_bf16 v[108:111], v[20:23], v[56:59], v[108:111]
  ds_read_b128 v[80:83], v5 offset:8192
  v_mfma_f32_16x16x32_bf16 v[108:111], v[36:39], v[60:63], v[108:111]
  s_nop 0
  ds_read_b128 v[84:87], v7 offset:8192
  v_mfma_f32_16x16x32_bf16 v[92:95], v[36:39], v[52:55], v[92:95]
  s_waitcnt lgkmcnt(8)
  v_mfma_f32_16x16x32_bf16 v[92:95], v[20:23], v[48:51], v[92:95]
  v_mfma_f32_16x16x32_bf16 v[96:99], v[24:27], v[48:51], v[96:99]
  v_xor_b32 v1, 16384, v1
  v_mfma_f32_16x16x32_bf16 v[96:99], v[40:43], v[52:55], v[96:99]
  s_nop 0
  v_xor_b32 v2, 16384, v2
  v_mfma_f32_16x16x32_bf16 v[112:115], v[40:43], v[60:63], v[112:115]
  v_xor_b32 v3, 16384, v3
  s_waitcnt lgkmcnt(4)
  v_mfma_f32_16x16x32_bf16 v[112:115], v[24:27], v[56:59], v[112:115]
  v_xor_b32 v4, 16384, v4
  v_mfma_f32_16x16x32_bf16 v[116:119], v[28:31], v[56:59], v[116:119]
  ds_read_b128 v[56:59], v5 offset:12288
  v_mfma_f32_16x16x32_bf16 v[116:119], v[44:47], v[60:63], v[116:119]
  s_nop 0
  ds_read_b128 v[60:63], v7 offset:12288
  v_mfma_f32_16x16x32_bf16 v[100:103], v[44:47], v[52:55], v[100:103]
  ds_read_b128 v[52:55], v7 offset:10240
  v_mfma_f32_16x16x32_bf16 v[100:103], v[28:31], v[48:51], v[100:103]
  ds_read_b128 v[48:51], v5 offset:10240
  v_mfma_f32_16x16x32_bf16 v[120:123], v[16:19], v[64:67], v[120:123]
  s_waitcnt lgkmcnt(6)
  v_mfma_f32_16x16x32_bf16 v[120:123], v[32:35], v[68:71], v[120:123]
  s_nop 0
  v_mfma_f32_16x16x32_bf16 v[136:139], v[32:35], v[76:79], v[136:139]
  v_mfma_f32_16x16x32_bf16 v[136:139], v[16:19], v[72:75], v[136:139]
  v_mfma_f32_16x16x32_bf16 v[140:143], v[20:23], v[72:75], v[140:143]
  v_mfma_f32_16x16x32_bf16 v[140:143], v[36:39], v[76:79], v[140:143]
  v_mfma_f32_16x16x32_bf16 v[124:127], v[36:39], v[68:71], v[124:127]
  v_mfma_f32_16x16x32_bf16 v[124:127], v[20:23], v[64:67], v[124:127]
  v_mfma_f32_16x16x32_bf16 v[128:131], v[24:27], v[64:67], v[128:131]
  v_mfma_f32_16x16x32_bf16 v[128:131], v[40:43], v[68:71], v[128:131]
  v_mfma_f32_16x16x32_bf16 v[144:147], v[40:43], v[76:79], v[144:147]
  v_mfma_f32_16x16x32_bf16 v[144:147], v[24:27], v[72:75], v[144:147]
  v_mfma_f32_16x16x32_bf16 v[148:151], v[28:31], v[72:75], v[148:151]
  ds_read_b128 v[72:75], v5 offset:16384
  v_mfma_f32_16x16x32_bf16 v[148:151], v[44:47], v[76:79], v[148:151]
  ds_read_b128 v[76:79], v7 offset:16384
  v_mfma_f32_16x16x32_bf16 v[132:135], v[44:47], v[68:71], v[132:135]
  ds_read_b128 v[68:71], v7 offset:14336
  s_waitcnt lgkmcnt(7)
  v_mfma_f32_16x16x32_bf16 v[132:135], v[28:31], v[64:67], v[132:135]
  ds_read_b128 v[64:67], v5 offset:14336
  v_mfma_f32_16x16x32_bf16 v[152:155], v[16:19], v[80:83], v[152:155]
  s_waitcnt lgkmcnt(4)
  v_mfma_f32_16x16x32_bf16 v[152:155], v[32:35], v[84:87], v[152:155]
  v_mfma_f32_16x16x32_bf16 v[168:171], v[32:35], v[52:55], v[168:171]
  v_mfma_f32_16x16x32_bf16 v[168:171], v[16:19], v[48:51], v[168:171]
  v_mfma_f32_16x16x32_bf16 v[172:175], v[20:23], v[48:51], v[172:175]
  v_mfma_f32_16x16x32_bf16 v[172:175], v[36:39], v[52:55], v[172:175]
  v_mfma_f32_16x16x32_bf16 v[156:159], v[36:39], v[84:87], v[156:159]
  v_mfma_f32_16x16x32_bf16 v[156:159], v[20:23], v[80:83], v[156:159]
  v_mfma_f32_16x16x32_bf16 v[160:163], v[24:27], v[80:83], v[160:163]
  v_mfma_f32_16x16x32_bf16 v[160:163], v[40:43], v[84:87], v[160:163]
  v_mfma_f32_16x16x32_bf16 v[176:179], v[40:43], v[52:55], v[176:179]
  v_mfma_f32_16x16x32_bf16 v[176:179], v[24:27], v[48:51], v[176:179]
  v_mfma_f32_16x16x32_bf16 v[180:183], v[28:31], v[48:51], v[180:183]
  v_mfma_f32_16x16x32_bf16 v[180:183], v[44:47], v[52:55], v[180:183]
  v_mfma_f32_16x16x32_bf16 v[164:167], v[44:47], v[84:87], v[164:167]
  ds_read_b128 v[84:87], v7 offset:18432
  v_mfma_f32_16x16x32_bf16 v[164:167], v[28:31], v[80:83], v[164:167]
  s_nop 0
  ds_read_b128 v[80:83], v5 offset:18432
  v_mfma_f32_16x16x32_bf16 v[184:187], v[16:19], v[56:59], v[184:187]
  s_waitcnt lgkmcnt(2)
  s_add_u32 s72, s72, 1
  s_cmp_lt_u32 s72, 8
  v_mfma_f32_16x16x32_bf16 v[184:187], v[32:35], v[60:63], v[184:187]
  v_mfma_f32_16x16x32_bf16 v[200:203], v[32:35], v[68:71], v[200:203]
  v_mfma_f32_16x16x32_bf16 v[200:203], v[16:19], v[64:67], v[200:203]
  v_mfma_f32_16x16x32_bf16 v[204:207], v[20:23], v[64:67], v[204:207]
  v_mfma_f32_16x16x32_bf16 v[204:207], v[36:39], v[68:71], v[204:207]
  s_waitcnt lgkmcnt(0)
  s_barrier
  v_mfma_f32_16x16x32_bf16 v[188:191], v[36:39], v[60:63], v[188:191]
  ds_read_b128 v[48:51], v5 offset:40960
  v_mfma_f32_16x16x32_bf16 v[188:191], v[20:23], v[56:59], v[188:191]
  ds_read_b128 v[52:55], v7 offset:40960
  v_mfma_f32_16x16x32_bf16 v[192:195], v[24:27], v[56:59], v[192:195]
  v_mfma_f32_16x16x32_bf16 v[192:195], v[40:43], v[60:63], v[192:195]
  v_mfma_f32_16x16x32_bf16 v[208:211], v[40:43], v[68:71], v[208:211]
  v_mfma_f32_16x16x32_bf16 v[208:211], v[24:27], v[64:67], v[208:211]
  v_mfma_f32_16x16x32_bf16 v[212:215], v[28:31], v[64:67], v[212:215]
  ds_read_b128 v[64:67], v5 offset:45056
  v_mfma_f32_16x16x32_bf16 v[212:215], v[44:47], v[68:71], v[212:215]
  ds_read_b128 v[68:71], v7 offset:45056
  v_mfma_f32_16x16x32_bf16 v[196:199], v[44:47], v[60:63], v[196:199]
  ds_read_b128 v[60:63], v7 offset:43008
  v_mfma_f32_16x16x32_bf16 v[196:199], v[28:31], v[56:59], v[196:199]
  ds_read_b128 v[56:59], v5 offset:43008
  v_mfma_f32_16x16x32_bf16 v[216:219], v[32:35], v[76:79], v[216:219]
  v_mfma_f32_16x16x32_bf16 v[216:219], v[16:19], v[72:75], v[216:219]
  v_mfma_f32_16x16x32_bf16 v[232:235], v[16:19], v[80:83], v[232:235]
  ds_read_b64_tr_b16 v[16:17], v1 offset:0
  v_mfma_f32_16x16x32_bf16 v[232:235], v[32:35], v[84:87], v[232:235]
  ds_read_b64_tr_b16 v[18:19], v1 offset:1024
  v_mfma_f32_16x16x32_bf16 v[236:239], v[36:39], v[84:87], v[236:239]
  ds_read_b64_tr_b16 v[32:33], v1 offset:8192
  v_mfma_f32_16x16x32_bf16 v[236:239], v[20:23], v[80:83], v[236:239]
  ds_read_b64_tr_b16 v[34:35], v1 offset:9216
  v_mfma_f32_16x16x32_bf16 v[220:223], v[20:23], v[72:75], v[220:223]
  ds_read_b64_tr_b16 v[20:21], v2 offset:0
  v_mfma_f32_16x16x32_bf16 v[220:223], v[36:39], v[76:79], v[220:223]
  ds_read_b64_tr_b16 v[22:23], v2 offset:1024
  v_mfma_f32_16x16x32_bf16 v[224:227], v[40:43], v[76:79], v[224:227]
  ds_read_b64_tr_b16 v[36:37], v2 offset:8192
  v_mfma_f32_16x16x32_bf16 v[224:227], v[24:27], v[72:75], v[224:227]
  ds_read_b64_tr_b16 v[38:39], v2 offset:9216
  v_mfma_f32_16x16x32_bf16 v[240:243], v[24:27], v[80:83], v[240:243]
  ds_read_b64_tr_b16 v[24:25], v3 offset:0
  v_mfma_f32_16x16x32_bf16 v[240:243], v[40:43], v[84:87], v[240:243]
  ds_read_b64_tr_b16 v[26:27], v3 offset:1024
  v_mfma_f32_16x16x32_bf16 v[244:247], v[44:47], v[84:87], v[244:247]
  ds_read_b64_tr_b16 v[40:41], v3 offset:8192
  v_mfma_f32_16x16x32_bf16 v[244:247], v[28:31], v[80:83], v[244:247]
  ds_read_b64_tr_b16 v[42:43], v3 offset:9216
  v_mfma_f32_16x16x32_bf16 v[228:231], v[28:31], v[72:75], v[228:231]
  ds_read_b64_tr_b16 v[28:29], v4 offset:0
  s_waitcnt lgkmcnt(9)
  v_mfma_f32_16x16x32_bf16 v[228:231], v[44:47], v[76:79], v[228:231]
  ds_read_b64_tr_b16 v[30:31], v4 offset:1024
  s_cbranch_scc1 L_dnn_loop0
L_tail:
  v_mfma_f32_16x16x32_bf16 v[88:91], v[16:19], v[48:51], v[88:91]
  ds_read_b64_tr_b16 v[44:45], v4 offset:8192
  v_mfma_f32_16x16x32_bf16 v[88:91], v[32:35], v[52:55], v[88:91]
  ds_read_b64_tr_b16 v[46:47], v4 offset:9216
  v_mfma_f32_16x16x32_bf16 v[104:107], v[32:35], v[60:63], v[104:107]
  ds_read_b128 v[72:75], v5 offset:47104
  s_waitcnt lgkmcnt(9)
  v_mfma_f32_16x16x32_bf16 v[104:107], v[16:19], v[56:59], v[104:107]
  ds_read_b128 v[76:79], v7 offset:47104
  v_mfma_f32_16x16x32_bf16 v[108:111], v[20:23], v[56:59], v[108:111]
  s_nop 0
  ds_read_b128 v[80:83], v5 offset:49152
  v_mfma_f32_16x16x32_bf16 v[108:111], v[36:39], v[60:63], v[108:111]
  ds_read_b128 v[84:87], v7 offset:49152
  v_mul_f32 v11, v88, v88
  v_mfma_f32_16x16x32_bf16 v[92:95], v[36:39], v[52:55], v[92:95]
  s_waitcnt lgkmcnt(8)
  v_mul_f32 v248, v89, v89
  v_mul_f32 v249, v90, v90
  v_mfma_f32_16x16x32_bf16 v[92:95], v[20:23], v[48:51], v[92:95]
  v_mul_f32_e64 v250, v91, v91
  v_fma_f32 v11, v11, v14, v12
  v_mfma_f32_16x16x32_bf16 v[96:99], v[24:27], v[48:51], v[96:99]
  v_fma_f32 v248, v248, v14, v12
  v_fma_f32 v249, v249, v14, v12
  v_mfma_f32_16x16x32_bf16 v[96:99], v[40:43], v[52:55], v[96:99]
  v_fma_f32 v250, v250, v14, v12
  v_mul_f32 v11, v11, v88
  v_mfma_f32_16x16x32_bf16 v[112:115], v[40:43], v[60:63], v[112:115]
  s_waitcnt lgkmcnt(4)
  v_mul_f32 v248, v248, v89
  v_mul_f32 v249, v249, v90
  v_mfma_f32_16x16x32_bf16 v[112:115], v[24:27], v[56:59], v[112:115]
  v_mul_f32_e64 v250, v250, v91
  v_mfma_f32_16x16x32_bf16 v[116:119], v[28:31], v[56:59], v[116:119]
  ds_read_b128 v[56:59], v5 offset:53248
  v_mfma_f32_16x16x32_bf16 v[116:119], v[44:47], v[60:63], v[116:119]
  ds_read_b128 v[60:63], v7 offset:53248
  v_mfma_f32_16x16x32_bf16 v[100:103], v[44:47], v[52:55], v[100:103]
  ds_read_b128 v[52:55], v7 offset:51200
  v_mfma_f32_16x16x32_bf16 v[100:103], v[28:31], v[48:51], v[100:103]
  ds_read_b128 v[48:51], v5 offset:51200
  v_mfma_f32_16x16x32_bf16 v[120:123], v[16:19], v[64:67], v[120:123]
  s_waitcnt lgkmcnt(6)
  v_exp_f32 v11, v11
  v_mfma_f32_16x16x32_bf16 v[120:123], v[32:35], v[68:71], v[120:123]
  v_exp_f32 v248, v248
  v_mfma_f32_16x16x32_bf16 v[136:139], v[32:35], v[76:79], v[136:139]
  v_exp_f32 v249, v249
  v_mfma_f32_16x16x32_bf16 v[136:139], v[16:19], v[72:75], v[136:139]
  v_exp_f32 v250, v250
  v_mfma_f32_16x16x32_bf16 v[140:143], v[20:23], v[72:75], v[140:143]
  v_add_f32 v11, 1.0, v11
  v_add_f32 v248, 1.0, v248
  v_mfma_f32_16x16x32_bf16 v[140:143], v[36:39], v[76:79], v[140:143]
  v_add_f32 v249, 1.0, v249
  v_add_f32 v250, 1.0, v250
  v_mfma_f32_16x16x32_bf16 v[124:127], v[36:39], v[68:71], v[124:127]
  v_rcp_f32 v11, v11
  v_mfma_f32_16x16x32_bf16 v[124:127], v[20:23], v[64:67], v[124:127]
  v_rcp_f32_e64 v248, v248
  v_mfma_f32_16x16x32_bf16 v[128:131], v[24:27], v[64:67], v[128:131]
  v_rcp_f32 v249, v249
  v_mfma_f32_16x16x32_bf16 v[128:131], v[40:43], v[68:71], v[128:131]
  v_rcp_f32 v250, v250
  v_mfma_f32_16x16x32_bf16 v[144:147], v[40:43], v[76:79], v[144:147]
  v_mul_f32 v88, v88, v11
  v_mul_f32 v89, v89, v248
  v_mfma_f32_16x16x32_bf16 v[144:147], v[24:27], v[72:75], v[144:147]
  v_mul_f32 v90, v90, v249
  v_mul_f32 v91, v91, v250
  v_mfma_f32_16x16x32_bf16 v[148:151], v[28:31], v[72:75], v[148:151]
  ds_read_b128 v[72:75], v5 offset:57344
  v_mul_f32 v11, v92, v92
  v_mfma_f32_16x16x32_bf16 v[148:151], v[44:47], v[76:79], v[148:151]
  ds_read_b128 v[76:79], v7 offset:57344
  v_mul_f32 v248, v93, v93
  v_mfma_f32_16x16x32_bf16 v[132:135], v[44:47], v[68:71], v[132:135]
  ds_read_b128 v[68:71], v7 offset:55296
  s_waitcnt lgkmcnt(7)
  v_mul_f32 v249, v94, v94
  v_mfma_f32_16x16x32_bf16 v[132:135], v[28:31], v[64:67], v[132:135]
  ds_read_b128 v[64:67], v5 offset:55296
  v_mul_f32 v250, v95, v95
  v_mfma_f32_16x16x32_bf16 v[152:155], v[16:19], v[80:83], v[152:155]
  s_waitcnt lgkmcnt(4)
  v_fma_f32 v11, v11, v14, v12
  v_fma_f32 v248, v248, v14, v12
  v_mfma_f32_16x16x32_bf16 v[152:155], v[32:35], v[84:87], v[152:155]
  v_fma_f32 v249, v249, v14, v12
  v_fma_f32 v250, v250, v14, v12
  v_mfma_f32_16x16x32_bf16 v[168:171], v[32:35], v[52:55], v[168:171]
  v_mul_f32 v11, v11, v92
  v_mul_f32 v248, v248, v93
  v_mfma_f32_16x16x32_bf16 v[168:171], v[16:19], v[48:51], v[168:171]
  v_mul_f32 v249, v249, v94
  v_mul_f32 v250, v250, v95
  v_mfma_f32_16x16x32_bf16 v[172:175], v[20:23], v[48:51], v[172:175]
  v_exp_f32 v11, v11
  v_mfma_f32_16x16x32_bf16 v[172:175], v[36:39], v[52:55], v[172:175]
  v_exp_f32 v248, v248
  v_mfma_f32_16x16x32_bf16 v[156:159], v[36:39], v[84:87], v[156:159]
  v_exp_f32 v249, v249
  v_mfma_f32_16x16x32_bf16 v[156:159], v[20:23], v[80:83], v[156:159]
  v_exp_f32 v250, v250
  v_mfma_f32_16x16x32_bf16 v[160:163], v[24:27], v[80:83], v[160:163]
  v_add_f32 v11, 1.0, v11
  v_add_f32 v248, 1.0, v248
  v_mfma_f32_16x16x32_bf16 v[160:163], v[40:43], v[84:87], v[160:163]
  v_add_f32 v249, 1.0, v249
  v_add_f32 v250, 1.0, v250
  v_mfma_f32_16x16x32_bf16 v[176:179], v[40:43], v[52:55], v[176:179]
  v_rcp_f32_e64 v11, v11
  v_mfma_f32_16x16x32_bf16 v[176:179], v[24:27], v[48:51], v[176:179]
  v_rcp_f32 v248, v248
  v_mfma_f32_16x16x32_bf16 v[180:183], v[28:31], v[48:51], v[180:183]
  v_rcp_f32 v249, v249
  v_mfma_f32_16x16x32_bf16 v[180:183], v[44:47], v[52:55], v[180:183]
  v_rcp_f32 v250, v250
  v_mfma_f32_16x16x32_bf16 v[164:167], v[44:47], v[84:87], v[164:167]
  ds_read_b128 v[84:87], v7 offset:59392
  v_mul_f32 v92, v92, v11
  v_mfma_f32_16x16x32_bf16 v[164:167], v[28:31], v[80:83], v[164:167]
  ds_read_b128 v[80:83], v5 offset:59392
  v_mul_f32 v93, v93, v248
  v_mfma_f32_16x16x32_bf16 v[184:187], v[16:19], v[56:59], v[184:187]
  s_waitcnt lgkmcnt(2)
  v_mul_f32 v94, v94, v249
  v_mul_f32 v95, v95, v250
  v_mfma_f32_16x16x32_bf16 v[184:187], v[32:35], v[60:63], v[184:187]
  v_mul_f32 v11, v96, v96
  v_mul_f32 v248, v97, v97
  v_mfma_f32_16x16x32_bf16 v[200:203], v[32:35], v[68:71], v[200:203]
  v_mul_f32 v249, v98, v98
  v_mul_f32 v250, v99, v99
  v_mfma_f32_16x16x32_bf16 v[200:203], v[16:19], v[64:67], v[200:203]
  v_fma_f32 v11, v11, v14, v12
  v_fma_f32 v248, v248, v14, v12
  v_mfma_f32_16x16x32_bf16 v[204:207], v[20:23], v[64:67], v[204:207]
  v_fma_f32 v249, v249, v14, v12
  v_fma_f32 v250, v250, v14, v12
  v_mfma_f32_16x16x32_bf16 v[204:207], v[36:39], v[68:71], v[204:207]
  v_mul_f32 v11, v11, v96
  v_mul_f32 v248, v248, v97
  v_mfma_f32_16x16x32_bf16 v[188:191], v[36:39], v[60:63], v[188:191]
  v_mul_f32 v249, v249, v98
  v_mul_f32 v250, v250, v99
  v_mfma_f32_16x16x32_bf16 v[188:191], v[20:23], v[56:59], v[188:191]
  v_exp_f32 v11, v11
  v_mfma_f32_16x16x32_bf16 v[192:195], v[24:27], v[56:59], v[192:195]
  v_exp_f32 v248, v248
  v_mfma_f32_16x16x32_bf16 v[192:195], v[40:43], v[60:63], v[192:195]
  v_exp_f32 v249, v249
  v_mfma_f32_16x16x32_bf16 v[208:211], v[40:43], v[68:71], v[208:211]
  v_exp_f32 v250, v250
  v_mfma_f32_16x16x32_bf16 v[208:211], v[24:27], v[64:67], v[208:211]
  v_add_f32 v11, 1.0, v11
  v_add_f32 v248, 1.0, v248
  v_mfma_f32_16x16x32_bf16 v[212:215], v[28:31], v[64:67], v[212:215]
  v_add_f32 v249, 1.0, v249
  v_add_f32 v250, 1.0, v250
  v_mfma_f32_16x16x32_bf16 v[212:215], v[44:47], v[68:71], v[212:215]
  v_rcp_f32 v11, v11
  v_mfma_f32_16x16x32_bf16 v[196:199], v[44:47], v[60:63], v[196:199]
  v_rcp_f32 v248, v248
  v_mfma_f32_16x16x32_bf16 v[196:199], v[28:31], v[56:59], v[196:199]
  v_rcp_f32 v249, v249
  v_mfma_f32_16x16x32_bf16 v[216:219], v[32:35], v[76:79], v[216:219]
  s_waitcnt lgkmcnt(0)
  v_rcp_f32 v250, v250
  v_mfma_f32_16x16x32_bf16 v[216:219], v[16:19], v[72:75], v[216:219]
  v_mul_f32 v96, v96, v11
  v_mul_f32 v97, v97, v248
  v_mfma_f32_16x16x32_bf16 v[232:235], v[16:19], v[80:83], v[232:235]
  v_mul_f32 v98, v98, v249
  v_mul_f32 v99, v99, v250
  v_mfma_f32_16x16x32_bf16 v[232:235], v[32:35], v[84:87], v[232:235]
  v_mul_f32 v11, v100, v100
  v_mul_f32 v248, v101, v101
  v_mfma_f32_16x16x32_bf16 v[236:239], v[36:39], v[84:87], v[236:239]
  v_mul_f32 v249, v102, v102
  v_mul_f32_e64 v250, v103, v103
  v_mfma_f32_16x16x32_bf16 v[236:239], v[20:23], v[80:83], v[236:239]
  v_fma_f32 v11, v11, v14, v12
  v_fma_f32 v248, v248, v14, v12
  v_mfma_f32_16x16x32_bf16 v[220:223], v[20:23], v[72:75], v[220:223]
  v_fma_f32 v249, v249, v14, v12
  v_fma_f32 v250, v250, v14, v12
  v_mfma_f32_16x16x32_bf16 v[220:223], v[36:39], v[76:79], v[220:223]
  v_mul_f32 v11, v11, v100
  v_mul_f32 v248, v248, v101
  v_mfma_f32_16x16x32_bf16 v[224:227], v[40:43], v[76:79], v[224:227]
  v_mul_f32 v249, v249, v102
  v_mul_f32 v250, v250, v103
  v_mfma_f32_16x16x32_bf16 v[224:227], v[24:27], v[72:75], v[224:227]
  v_exp_f32 v11, v11
  v_mfma_f32_16x16x32_bf16 v[240:243], v[24:27], v[80:83], v[240:243]
  v_exp_f32 v248, v248
  v_mfma_f32_16x16x32_bf16 v[240:243], v[40:43], v[84:87], v[240:243]
  v_exp_f32 v249, v249
  v_mfma_f32_16x16x32_bf16 v[244:247], v[44:47], v[84:87], v[244:247]
  v_exp_f32 v250, v250
  v_mfma_f32_16x16x32_bf16 v[244:247], v[28:31], v[80:83], v[244:247]
  v_add_f32 v11, 1.0, v11
  v_add_f32 v248, 1.0, v248
  v_mfma_f32_16x16x32_bf16 v[228:231], v[28:31], v[72:75], v[228:231]
  v_add_f32 v249, 1.0, v249
  v_add_f32 v250, 1.0, v250
  v_mfma_f32_16x16x32_bf16 v[228:231], v[44:47], v[76:79], v[228:231]
  v_rcp_f32 v11, v11
  v_rcp_f32 v248, v248
  v_rcp_f32 v249, v249
  v_rcp_f32 v250, v250
  v_mul_f32 v100, v100, v11
  v_mul_f32 v101, v101, v248
  v_mul_f32 v102, v102, v249
  v_mul_f32 v103, v103, v250
  ds_read_b64 v[18:19], v9 offset:256
  ds_read_b64 v[22:23], v9 offset:288
  ds_read_b64 v[26:27], v9 offset:320
  ds_read_b64 v[30:31], v9 offset:352
  v_mov_b32 v248, 1.0
  v_mov_b32 v249, 1.0
L_epi:
  v_pk_mul_f32 v[52:53], v[104:105], v[104:105]
  v_pk_mul_f32 v[56:57], v[106:107], v[106:107]
  v_pk_mul_f32 v[60:61], v[108:109], v[108:109]
  v_pk_mul_f32 v[64:65], v[110:111], v[110:111]
  v_pk_fma_f32 v[52:53], v[52:53], v[14:15], v[12:13]
  v_pk_fma_f32 v[56:57], v[56:57], v[14:15], v[12:13]
  v_pk_fma_f32 v[60:61], v[60:61], v[14:15], v[12:13]
  v_pk_fma_f32 v[64:65], v[64:65], v[14:15], v[12:13]
  v_pk_mul_f32 v[52:53], v[52:53], v[104:105]
  v_pk_mul_f32 v[56:57], v[56:57], v[106:107]
  v_pk_mul_f32 v[60:61], v[60:61], v[108:109]
  v_pk_mul_f32 v[64:65], v[64:65], v[110:111]
  v_exp_f32 v52, v52
  v_exp_f32 v53, v53
  v_exp_f32 v56, v56
  v_exp_f32 v57, v57
  v_exp_f32 v60, v60
  v_exp_f32 v61, v61
  v_exp_f32 v64, v64
  v_exp_f32 v65, v65
  s_waitcnt lgkmcnt(3)
  v_lshlrev_b32 v16, 16, v18
  v_and_b32 v17, 0xffff0000, v18
  v_lshlrev_b32 v18, 16, v19
  v_and_b32 v19, 0xffff0000, v19
  s_waitcnt lgkmcnt(2)
  v_lshlrev_b32 v20, 16, v22
  v_and_b32 v21, 0xffff0000, v22
  v_lshlrev_b32 v22, 16, v23
  v_and_b32 v23, 0xffff0000, v23
  s_waitcnt lgkmcnt(1)
  v_lshlrev_b32 v24, 16, v26
  v_and_b32 v25, 0xffff0000, v26
  v_lshlrev_b32 v26, 16, v27
  v_and_b32 v27, 0xffff0000, v27
  s_waitcnt lgkmcnt(0)
  v_lshlrev_b32 v28, 16, v30
  v_and_b32 v29, 0xffff0000, v30
  v_lshlrev_b32 v30, 16, v31
  v_and_b32 v31, 0xffff0000, v31
  v_pk_mul_f32 v[54:55], v[104:105], v[16:17]
  v_pk_mul_f32 v[58:59], v[106:107], v[18:19]
  v_pk_mul_f32 v[62:63], v[108:109], v[20:21]
  v_pk_mul_f32 v[66:67], v[110:111], v[22:23]
  v_pk_add_f32 v[52:53], v[52:53], v[248:249]
  v_pk_add_f32 v[56:57], v[56:57], v[248:249]
  v_pk_add_f32 v[60:61], v[60:61], v[248:249]
  v_pk_add_f32 v[64:65], v[64:65], v[248:249]
  v_rcp_f32 v52, v52
  v_rcp_f32 v53, v53
  v_rcp_f32 v56, v56
  v_rcp_f32 v57, v57
  v_rcp_f32 v60, v60
  v_rcp_f32 v61, v61
  v_rcp_f32 v64, v64
  v_rcp_f32 v65, v65
  v_pk_mul_f32 v[34:35], v[52:53], v[54:55]
  v_pk_fma_f32 v[34:35], v[56:57], v[58:59], v[34:35]
  v_pk_fma_f32 v[34:35], v[60:61], v[62:63], v[34:35]
  v_pk_fma_f32 v[34:35], v[64:65], v[66:67], v[34:35]
  v_pk_mul_f32 v[68:69], v[112:113], v[112:113]
  v_pk_mul_f32 v[72:73], v[114:115], v[114:115]
  v_pk_mul_f32 v[76:77], v[116:117], v[116:117]
  v_pk_mul_f32 v[80:81], v[118:119], v[118:119]
  v_pk_fma_f32 v[68:69], v[68:69], v[14:15], v[12:13]
  v_pk_fma_f32 v[72:73], v[72:73], v[14:15], v[12:13]
  v_pk_fma_f32 v[76:77], v[76:77], v[14:15], v[12:13]
  v_pk_fma_f32 v[80:81], v[80:81], v[14:15], v[12:13]
  v_pk_mul_f32 v[68:69], v[68:69], v[112:113]
  v_pk_mul_f32 v[72:73], v[72:73], v[114:115]
  v_pk_mul_f32 v[76:77], v[76:77], v[116:117]
  v_pk_mul_f32 v[80:81], v[80:81], v[118:119]
  v_exp_f32 v68, v68
  v_exp_f32 v69, v69
  v_exp_f32 v72, v72
  v_exp_f32 v73, v73
  v_exp_f32 v76, v76
  v_exp_f32 v77, v77
  v_exp_f32 v80, v80
  v_exp_f32 v81, v81
  v_pk_mul_f32 v[70:71], v[112:113], v[24:25]
  v_pk_mul_f32 v[74:75], v[114:115], v[26:27]
  v_pk_mul_f32 v[78:79], v[116:117], v[28:29]
  v_pk_mul_f32 v[82:83], v[118:119], v[30:31]
  v_pk_add_f32 v[68:69], v[68:69], v[248:249]
  v_pk_add_f32 v[72:73], v[72:73], v[248:249]
  v_pk_add_f32 v[76:77], v[76:77], v[248:249]
  v_pk_add_f32 v[80:81], v[80:81], v[248:249]
  v_rcp_f32 v68, v68
  v_rcp_f32 v69, v69
  v_rcp_f32 v72, v72
  v_rcp_f32 v73, v73
  v_rcp_f32 v76, v76
  v_rcp_f32 v77, v77
  v_rcp_f32 v80, v80
  v_rcp_f32 v81, v81
  v_pk_fma_f32 v[34:35], v[68:69], v[70:71], v[34:35]
  v_pk_fma_f32 v[34:35], v[72:73], v[74:75], v[34:35]
  v_pk_fma_f32 v[34:35], v[76:77], v[78:79], v[34:35]
  v_pk_fma_f32 v[34:35], v[80:81], v[82:83], v[34:35]
  v_pk_mul_f32 v[52:53], v[120:121], v[120:121]
  v_pk_mul_f32 v[56:57], v[136:137], v[136:137]
  v_pk_mul_f32 v[60:61], v[122:123], v[122:123]
  v_pk_mul_f32 v[64:65], v[138:139], v[138:139]
  v_pk_fma_f32 v[52:53], v[52:53], v[14:15], v[12:13]
  v_pk_fma_f32 v[56:57], v[56:57], v[14:15], v[12:13]
  v_pk_fma_f32 v[60:61], v[60:61], v[14:15], v[12:13]
  v_pk_fma_f32 v[64:65], v[64:65], v[14:15], v[12:13]
  v_pk_mul_f32 v[52:53], v[52:53], v[120:121]
  v_pk_mul_f32 v[56:57], v[56:57], v[136:137]
  v_pk_mul_f32 v[60:61], v[60:61], v[122:123]
  v_pk_mul_f32 v[64:65], v[64:65], v[138:139]
  v_exp_f32 v52, v52
  v_exp_f32 v53, v53
  v_exp_f32 v56, v56
  v_exp_f32 v57, v57
  v_exp_f32 v60, v60
  v_exp_f32 v61, v61
  v_exp_f32 v64, v64
  v_exp_f32 v65, v65
  v_pk_mul_f32 v[54:55], v[120:121], v[16:17]
  v_pk_mul_f32 v[58:59], v[136:137], v[16:17]
  v_pk_mul_f32 v[62:63], v[122:123], v[18:19]
  v_pk_mul_f32 v[66:67], v[138:139], v[18:19]
  v_pk_add_f32 v[52:53], v[52:53], v[248:249]
  v_pk_add_f32 v[56:57], v[56:57], v[248:249]
  v_pk_add_f32 v[60:61], v[60:61], v[248:249]
  v_pk_add_f32 v[64:65], v[64:65], v[248:249]
  v_rcp_f32 v52, v52
  v_rcp_f32 v53, v53
  v_rcp_f32 v56, v56
  v_rcp_f32 v57, v57
  v_rcp_f32 v60, v60
  v_rcp_f32 v61, v61
  v_rcp_f32 v64, v64
  v_rcp_f32 v65, v65
  v_pk_mul_f32 v[36:37], v[52:53], v[54:55]
  v_pk_mul_f32 v[38:39], v[56:57], v[58:59]
  v_pk_fma_f32 v[36:37], v[60:61], v[62:63], v[36:37]
  v_pk_fma_f32 v[38:39], v[64:65], v[66:67], v[38:39]
  v_pk_mul_f32 v[68:69], v[124:125], v[124:125]
  v_pk_mul_f32 v[72:73], v[140:141], v[140:141]
  v_pk_mul_f32 v[76:77], v[126:127], v[126:127]
  v_pk_mul_f32 v[80:81], v[142:143], v[142:143]
  v_pk_fma_f32 v[68:69], v[68:69], v[14:15], v[12:13]
  v_pk_fma_f32 v[72:73], v[72:73], v[14:15], v[12:13]
  v_pk_fma_f32 v[76:77], v[76:77], v[14:15], v[12:13]
  v_pk_fma_f32 v[80:81], v[80:81], v[14:15], v[12:13]
  v_pk_mul_f32 v[68:69], v[68:69], v[124:125]
  v_pk_mul_f32 v[72:73], v[72:73], v[140:141]
  v_pk_mul_f32 v[76:77], v[76:77], v[126:127]
  v_pk_mul_f32 v[80:81], v[80:81], v[142:143]
  v_exp_f32 v68, v68
  v_exp_f32 v69, v69
  v_exp_f32 v72, v72
  v_exp_f32 v73, v73
  v_exp_f32 v76, v76
  v_exp_f32 v77, v77
  v_exp_f32 v80, v80
  v_exp_f32 v81, v81
  v_pk_mul_f32 v[70:71], v[124:125], v[20:21]
  v_pk_mul_f32 v[74:75], v[140:141], v[20:21]
  v_pk_mul_f32 v[78:79], v[126:127], v[22:23]
  v_pk_mul_f32 v[82:83], v[142:143], v[22:23]
  v_pk_add_f32 v[68:69], v[68:69], v[248:249]
  v_pk_add_f32 v[72:73], v[72:73], v[248:249]
  v_pk_add_f32 v[76:77], v[76:77], v[248:249]
  v_pk_add_f32 v[80:81], v[80:81], v[248:249]
  v_rcp_f32 v68, v68
  v_rcp_f32 v69, v69
  v_rcp_f32 v72, v72
  v_rcp_f32 v73, v73
  v_rcp_f32 v76, v76
  v_rcp_f32 v77, v77
  v_rcp_f32 v80, v80
  v_rcp_f32 v81, v81
  v_pk_fma_f32 v[36:37], v[68:69], v[70:71], v[36:37]
  v_pk_fma_f32 v[38:39], v[72:73], v[74:75], v[38:39]
  v_pk_fma_f32 v[36:37], v[76:77], v[78:79], v[36:37]
  v_pk_fma_f32 v[38:39], v[80:81], v[82:83], v[38:39]
  v_pk_mul_f32 v[52:53], v[128:129], v[128:129]
  v_pk_mul_f32 v[56:57], v[144:145], v[144:145]
  v_pk_mul_f32 v[60:61], v[130:131], v[130:131]
  v_pk_mul_f32 v[64:65], v[146:147], v[146:147]
  v_pk_fma_f32 v[52:53], v[52:53], v[14:15], v[12:13]
  v_pk_fma_f32 v[56:57], v[56:57], v[14:15], v[12:13]
  v_pk_fma_f32 v[60:61], v[60:61], v[14:15], v[12:13]
  v_pk_fma_f32 v[64:65], v[64:65], v[14:15], v[12:13]
  v_pk_mul_f32 v[52:53], v[52:53], v[128:129]
  v_pk_mul_f32 v[56:57], v[56:57], v[144:145]
  v_pk_mul_f32 v[60:61], v[60:61], v[130:131]
  v_pk_mul_f32 v[64:65], v[64:65], v[146:147]
  v_exp_f32 v52, v52
  v_exp_f32 v53, v53
  v_exp_f32 v56, v56
  v_exp_f32 v57, v57
  v_exp_f32 v60, v60
  v_exp_f32 v61, v61
  v_exp_f32 v64, v64
  v_exp_f32 v65, v65
  v_pk_mul_f32 v[54:55], v[128:129], v[24:25]
  v_pk_mul_f32 v[58:59], v[144:145], v[24:25]
  v_pk_mul_f32 v[62:63], v[130:131], v[26:27]
  v_pk_mul_f32 v[66:67], v[146:147], v[26:27]
  v_pk_add_f32 v[52:53], v[52:53], v[248:249]
  v_pk_add_f32 v[56:57], v[56:57], v[248:249]
  v_pk_add_f32 v[60:61], v[60:61], v[248:249]
  v_pk_add_f32 v[64:65], v[64:65], v[248:249]
  v_rcp_f32 v52, v52
  v_rcp_f32 v53, v53
  v_rcp_f32 v56, v56
  v_rcp_f32 v57, v57
  v_rcp_f32 v60, v60
  v_rcp_f32 v61, v61
  v_rcp_f32 v64, v64
  v_rcp_f32 v65, v65
  v_pk_fma_f32 v[36:37], v[52:53], v[54:55], v[36:37]
  v_pk_fma_f32 v[38:39], v[56:57], v[58:59], v[38:39]
  v_pk_fma_f32 v[36:37], v[60:61], v[62:63], v[36:37]
  v_pk_fma_f32 v[38:39], v[64:65], v[66:67], v[38:39]
  v_pk_mul_f32 v[68:69], v[132:133], v[132:133]
  v_pk_mul_f32 v[72:73], v[148:149], v[148:149]
  v_pk_mul_f32 v[76:77], v[134:135], v[134:135]
  v_pk_mul_f32 v[80:81], v[150:151], v[150:151]
  v_pk_fma_f32 v[68:69], v[68:69], v[14:15], v[12:13]
  v_pk_fma_f32 v[72:73], v[72:73], v[14:15], v[12:13]
  v_pk_fma_f32 v[76:77], v[76:77], v[14:15], v[12:13]
  v_pk_fma_f32 v[80:81], v[80:81], v[14:15], v[12:13]
  v_pk_mul_f32 v[68:69], v[68:69], v[132:133]
  v_pk_mul_f32 v[72:73], v[72:73], v[148:149]
  v_pk_mul_f32 v[76:77], v[76:77], v[134:135]
  v_pk_mul_f32 v[80:81], v[80:81], v[150:151]
  v_exp_f32 v68, v68
  v_exp_f32 v69, v69
  v_exp_f32 v72, v72
  v_exp_f32 v73, v73
  v_exp_f32 v76, v76
  v_exp_f32 v77, v77
  v_exp_f32 v80, v80
  v_exp_f32 v81, v81
  v_pk_mul_f32 v[70:71], v[132:133], v[28:29]
  v_pk_mul_f32 v[74:75], v[148:149], v[28:29]
  v_pk_mul_f32 v[78:79], v[134:135], v[30:31]
  v_pk_mul_f32 v[82:83], v[150:151], v[30:31]
  v_pk_add_f32 v[68:69], v[68:69], v[248:249]
  v_pk_add_f32 v[72:73], v[72:73], v[248:249]
  v_pk_add_f32 v[76:77], v[76:77], v[248:249]
  v_pk_add_f32 v[80:81], v[80:81], v[248:249]
  v_rcp_f32 v68, v68
  v_rcp_f32 v69, v69
  v_rcp_f32 v72, v72
  v_rcp_f32 v73, v73
  v_rcp_f32 v76, v76
  v_rcp_f32 v77, v77
  v_rcp_f32 v80, v80
  v_rcp_f32 v81, v81
  v_pk_fma_f32 v[36:37], v[68:69], v[70:71], v[36:37]
  v_pk_fma_f32 v[38:39], v[72:73], v[74:75], v[38:39]
  v_pk_fma_f32 v[36:37], v[76:77], v[78:79], v[36:37]
  v_pk_fma_f32 v[38:39], v[80:81], v[82:83], v[38:39]
  v_pk_mul_f32 v[52:53], v[152:153], v[152:153]
  v_pk_mul_f32 v[56:57], v[168:169], v[168:169]
  v_pk_mul_f32 v[60:61], v[154:155], v[154:155]
  v_pk_mul_f32 v[64:65], v[170:171], v[170:171]
  v_pk_fma_f32 v[52:53], v[52:53], v[14:15], v[12:13]
  v_pk_fma_f32 v[56:57], v[56:57], v[14:15], v[12:13]
  v_pk_fma_f32 v[60:61], v[60:61], v[14:15], v[12:13]
  v_pk_fma_f32 v[64:65], v[64:65], v[14:15], v[12:13]
  v_pk_mul_f32 v[52:53], v[52:53], v[152:153]
  v_pk_mul_f32 v[56:57], v[56:57], v[168:169]
  v_pk_mul_f32 v[60:61], v[60:61], v[154:155]
  v_pk_mul_f32 v[64:65], v[64:65], v[170:171]
  v_exp_f32 v52, v52
  v_exp_f32 v53, v53
  v_exp_f32 v56, v56
  v_exp_f32 v57, v57
  v_exp_f32 v60, v60
  v_exp_f32 v61, v61
  v_exp_f32 v64, v64
  v_exp_f32 v65, v65
  v_pk_mul_f32 v[54:55], v[152:153], v[16:17]
  v_pk_mul_f32 v[58:59], v[168:169], v[16:17]
  v_pk_mul_f32 v[62:63], v[154:155], v[18:19]
  v_pk_mul_f32 v[66:67], v[170:171], v[18:19]
  v_pk_add_f32 v[52:53], v[52:53], v[248:249]
  v_pk_add_f32 v[56:57], v[56:57], v[248:249]
  v_pk_add_f32 v[60:61], v[60:61], v[248:249]
  v_pk_add_f32 v[64:65], v[64:65], v[248:249]
  v_rcp_f32 v52, v52
  v_rcp_f32 v53, v53
  v_rcp_f32 v56, v56
  v_rcp_f32 v57, v57
  v_rcp_f32 v60, v60
  v_rcp_f32 v61, v61
  v_rcp_f32 v64, v64
  v_rcp_f32 v65, v65
  v_pk_mul_f32 v[40:41], v[52:53], v[54:55]
  v_pk_mul_f32 v[42:43], v[56:57], v[58:59]
  v_pk_fma_f32 v[40:41], v[60:61], v[62:63], v[40:41]
  v_pk_fma_f32 v[42:43], v[64:65], v[66:67], v[42:43]
  v_pk_mul_f32 v[68:69], v[156:157], v[156:157]
  v_pk_mul_f32 v[72:73], v[172:173], v[172:173]
  v_pk_mul_f32 v[76:77], v[158:159], v[158:159]
  v_pk_mul_f32 v[80:81], v[174:175], v[174:175]
  v_pk_fma_f32 v[68:69], v[68:69], v[14:15], v[12:13]
  v_pk_fma_f32 v[72:73], v[72:73], v[14:15], v[12:13]
  v_pk_fma_f32 v[76:77], v[76:77], v[14:15], v[12:13]
  v_pk_fma_f32 v[80:81], v[80:81], v[14:15], v[12:13]
  v_pk_mul_f32 v[68:69], v[68:69], v[156:157]
  v_pk_mul_f32 v[72:73], v[72:73], v[172:173]
  v_pk_mul_f32 v[76:77], v[76:77], v[158:159]
  v_pk_mul_f32 v[80:81], v[80:81], v[174:175]
  v_exp_f32 v68, v68
  v_exp_f32 v69, v69
  v_exp_f32 v72, v72
  v_exp_f32 v73, v73
  v_exp_f32 v76, v76
  v_exp_f32 v77, v77
  v_exp_f32 v80, v80
  v_exp_f32 v81, v81
  v_pk_mul_f32 v[70:71], v[156:157], v[20:21]
  v_pk_mul_f32 v[74:75], v[172:173], v[20:21]
  v_pk_mul_f32 v[78:79], v[158:159], v[22:23]
  v_pk_mul_f32 v[82:83], v[174:175], v[22:23]
  v_pk_add_f32 v[68:69], v[68:69], v[248:249]
  v_pk_add_f32 v[72:73], v[72:73], v[248:249]
  v_pk_add_f32 v[76:77], v[76:77], v[248:249]
  v_pk_add_f32 v[80:81], v[80:81], v[248:249]
  v_rcp_f32 v68, v68
  v_rcp_f32 v69, v69
  v_rcp_f32 v72, v72
  v_rcp_f32 v73, v73
  v_rcp_f32 v76, v76
  v_rcp_f32 v77, v77
  v_rcp_f32 v80, v80
  v_rcp_f32 v81, v81
  v_pk_fma_f32 v[40:41], v[68:69], v[70:71], v[40:41]
  v_pk_fma_f32 v[42:43], v[72:73], v[74:75], v[42:43]
  v_pk_fma_f32 v[40:41], v[76:77], v[78:79], v[40:41]
  v_pk_fma_f32 v[42:43], v[80:81], v[82:83], v[42:43]
  v_pk_mul_f32 v[52:53], v[160:161], v[160:161]
  v_pk_mul_f32 v[56:57], v[176:177], v[176:177]
  v_pk_mul_f32 v[60:61], v[162:163], v[162:163]
  v_pk_mul_f32 v[64:65], v[178:179], v[178:179]
  v_pk_fma_f32 v[52:53], v[52:53], v[14:15], v[12:13]
  v_pk_fma_f32 v[56:57], v[56:57], v[14:15], v[12:13]
  v_pk_fma_f32 v[60:61], v[60:61], v[14:15], v[12:13]
  v_pk_fma_f32 v[64:65], v[64:65], v[14:15], v[12:13]
  v_pk_mul_f32 v[52:53], v[52:53], v[160:161]
  v_pk_mul_f32 v[56:57], v[56:57], v[176:177]
  v_pk_mul_f32 v[60:61], v[60:61], v[162:163]
  v_pk_mul_f32 v[64:65], v[64:65], v[178:179]
  v_exp_f32 v52, v52
  v_exp_f32 v53, v53
  v_exp_f32 v56, v56
  v_exp_f32 v57, v57
  v_exp_f32 v60, v60
  v_exp_f32 v61, v61
  v_exp_f32 v64, v64
  v_exp_f32 v65, v65
  v_pk_mul_f32 v[54:55], v[160:161], v[24:25]
  v_pk_mul_f32 v[58:59], v[176:177], v[24:25]
  v_pk_mul_f32 v[62:63], v[162:163], v[26:27]
  v_pk_mul_f32 v[66:67], v[178:179], v[26:27]
  v_pk_add_f32 v[52:53], v[52:53], v[248:249]
  v_pk_add_f32 v[56:57], v[56:57], v[248:249]
  v_pk_add_f32 v[60:61], v[60:61], v[248:249]
  v_pk_add_f32 v[64:65], v[64:65], v[248:249]
  v_rcp_f32 v52, v52
  v_rcp_f32 v53, v53
  v_rcp_f32 v56, v56
  v_rcp_f32 v57, v57
  v_rcp_f32 v60, v60
  v_rcp_f32 v61, v61
  v_rcp_f32 v64, v64
  v_rcp_f32 v65, v65
  v_pk_fma_f32 v[40:41], v[52:53], v[54:55], v[40:41]
  v_pk_fma_f32 v[42:43], v[56:57], v[58:59], v[42:43]
  v_pk_fma_f32 v[40:41], v[60:61], v[62:63], v[40:41]
  v_pk_fma_f32 v[42:43], v[64:65], v[66:67], v[42:43]
  v_pk_mul_f32 v[68:69], v[164:165], v[164:165]
  v_pk_mul_f32 v[72:73], v[180:181], v[180:181]
  v_pk_mul_f32 v[76:77], v[166:167], v[166:167]
  v_pk_mul_f32 v[80:81], v[182:183], v[182:183]
  v_pk_fma_f32 v[68:69], v[68:69], v[14:15], v[12:13]
  v_pk_fma_f32 v[72:73], v[72:73], v[14:15], v[12:13]
  v_pk_fma_f32 v[76:77], v[76:77], v[14:15], v[12:13]
  v_pk_fma_f32 v[80:81], v[80:81], v[14:15], v[12:13]
  v_pk_mul_f32 v[68:69], v[68:69], v[164:165]
  v_pk_mul_f32 v[72:73], v[72:73], v[180:181]
  v_pk_mul_f32 v[76:77], v[76:77], v[166:167]
  v_pk_mul_f32 v[80:81], v[80:81], v[182:183]
  v_exp_f32 v68, v68
  v_exp_f32 v69, v69
  v_exp_f32 v72, v72
  v_exp_f32 v73, v73
  v_exp_f32 v76, v76
  v_exp_f32 v77, v77
  v_exp_f32 v80, v80
  v_exp_f32 v81, v81
  v_pk_mul_f32 v[70:71], v[164:165], v[28:29]
  v_pk_mul_f32 v[74:75], v[180:181], v[28:29]
  v_pk_mul_f32 v[78:79], v[166:167], v[30:31]
  v_pk_mul_f32 v[82:83], v[182:183], v[30:31]
  v_pk_add_f32 v[68:69], v[68:69], v[248:249]
  v_pk_add_f32 v[72:73], v[72:73], v[248:249]
  v_pk_add_f32 v[76:77], v[76:77], v[248:249]
  v_pk_add_f32 v[80:81], v[80:81], v[248:249]
  v_rcp_f32 v68, v68
  v_rcp_f32 v69, v69
  v_rcp_f32 v72, v72
  v_rcp_f32 v73, v73
  v_rcp_f32 v76, v76
  v_rcp_f32 v77, v77
  v_rcp_f32 v80, v80
  v_rcp_f32 v81, v81
  v_pk_fma_f32 v[40:41], v[68:69], v[70:71], v[40:41]
  v_pk_fma_f32 v[42:43], v[72:73], v[74:75], v[42:43]
  v_pk_fma_f32 v[40:41], v[76:77], v[78:79], v[40:41]
  v_pk_fma_f32 v[42:43], v[80:81], v[82:83], v[42:43]
  v_pk_mul_f32 v[52:53], v[184:185], v[184:185]
  v_pk_mul_f32 v[56:57], v[200:201], v[200:201]
  v_pk_mul_f32 v[60:61], v[186:187], v[186:187]
  v_pk_mul_f32 v[64:65], v[202:203], v[202:203]
  v_pk_fma_f32 v[52:53], v[52:53], v[14:15], v[12:13]
  v_pk_fma_f32 v[56:57], v[56:57], v[14:15], v[12:13]
  v_pk_fma_f32 v[60:61], v[60:61], v[14:15], v[12:13]
  v_pk_fma_f32 v[64:65], v[64:65], v[14:15], v[12:13]
  v_pk_mul_f32 v[52:53], v[52:53], v[184:185]
  v_pk_mul_f32 v[56:57], v[56:57], v[200:201]
  v_pk_mul_f32 v[60:61], v[60:61], v[186:187]
  v_pk_mul_f32 v[64:65], v[64:65], v[202:203]
  v_exp_f32 v52, v52
  v_exp_f32 v53, v53
  v_exp_f32 v56, v56
  v_exp_f32 v57, v57
  v_exp_f32 v60, v60
  v_exp_f32 v61, v61
  v_exp_f32 v64, v64
  v_exp_f32 v65, v65
  v_pk_mul_f32 v[54:55], v[184:185], v[16:17]
  v_pk_mul_f32 v[58:59], v[200:201], v[16:17]
  v_pk_mul_f32 v[62:63], v[186:187], v[18:19]
  v_pk_mul_f32 v[66:67], v[202:203], v[18:19]
  v_pk_add_f32 v[52:53], v[52:53], v[248:249]
  v_pk_add_f32 v[56:57], v[56:57], v[248:249]
  v_pk_add_f32 v[60:61], v[60:61], v[248:249]
  v_pk_add_f32 v[64:65], v[64:65], v[248:249]
  v_rcp_f32 v52, v52
  v_rcp_f32 v53, v53
  v_rcp_f32 v56, v56
  v_rcp_f32 v57, v57
  v_rcp_f32 v60, v60
  v_rcp_f32 v61, v61
  v_rcp_f32 v64, v64
  v_rcp_f32 v65, v65
  v_pk_mul_f32 v[44:45], v[52:53], v[54:55]
  v_pk_mul_f32 v[46:47], v[56:57], v[58:59]
  v_pk_fma_f32 v[44:45], v[60:61], v[62:63], v[44:45]
  v_pk_fma_f32 v[46:47], v[64:65], v[66:67], v[46:47]
  v_pk_mul_f32 v[68:69], v[188:189], v[188:189]
  v_pk_mul_f32 v[72:73], v[204:205], v[204:205]
  v_pk_mul_f32 v[76:77], v[190:191], v[190:191]
  v_pk_mul_f32 v[80:81], v[206:207], v[206:207]
  v_pk_fma_f32 v[68:69], v[68:69], v[14:15], v[12:13]
  v_pk_fma_f32 v[72:73], v[72:73], v[14:15], v[12:13]
  v_pk_fma_f32 v[76:77], v[76:77], v[14:15], v[12:13]
  v_pk_fma_f32 v[80:81], v[80:81], v[14:15], v[12:13]
  v_pk_mul_f32 v[68:69], v[68:69], v[188:189]
  v_pk_mul_f32 v[72:73], v[72:73], v[204:205]
  v_pk_mul_f32 v[76:77], v[76:77], v[190:191]
  v_pk_mul_f32 v[80:81], v[80:81], v[206:207]
  v_exp_f32 v68, v68
  v_exp_f32 v69, v69
  v_exp_f32 v72, v72
  v_exp_f32 v73, v73
  v_exp_f32 v76, v76
  v_exp_f32 v77, v77
  v_exp_f32 v80, v80
  v_exp_f32 v81, v81
  v_pk_mul_f32 v[70:71], v[188:189], v[20:21]
  v_pk_mul_f32 v[74:75], v[204:205], v[20:21]
  v_pk_mul_f32 v[78:79], v[190:191], v[22:23]
  v_pk_mul_f32 v[82:83], v[206:207], v[22:23]
  v_pk_add_f32 v[68:69], v[68:69], v[248:249]
  v_pk_add_f32 v[72:73], v[72:73], v[248:249]
  v_pk_add_f32 v[76:77], v[76:77], v[248:249]
  v_pk_add_f32 v[80:81], v[80:81], v[248:249]
  v_rcp_f32 v68, v68
  v_rcp_f32 v69, v69
  v_rcp_f32 v72, v72
  v_rcp_f32 v73, v73
  v_rcp_f32 v76, v76
  v_rcp_f32 v77, v77
  v_rcp_f32 v80, v80
  v_rcp_f32 v81, v81
  v_pk_fma_f32 v[44:45], v[68:69], v[70:71], v[44:45]
  v_pk_fma_f32 v[46:47], v[72:73], v[74:75], v[46:47]
  v_pk_fma_f32 v[44:45], v[76:77], v[78:79], v[44:45]
  v_pk_fma_f32 v[46:47], v[80:81], v[82:83], v[46:47]
  v_pk_mul_f32 v[52:53], v[192:193], v[192:193]
  v_pk_mul_f32 v[56:57], v[208:209], v[208:209]
  v_pk_mul_f32 v[60:61], v[194:195], v[194:195]
  v_pk_mul_f32 v[64:65], v[210:211], v[210:211]
  v_pk_fma_f32 v[52:53], v[52:53], v[14:15], v[12:13]
  v_pk_fma_f32 v[56:57], v[56:57], v[14:15], v[12:13]
  v_pk_fma_f32 v[60:61], v[60:61], v[14:15], v[12:13]
  v_pk_fma_f32 v[64:65], v[64:65], v[14:15], v[12:13]
  v_pk_mul_f32 v[52:53], v[52:53], v[192:193]
  v_pk_mul_f32 v[56:57], v[56:57], v[208:209]
  v_pk_mul_f32 v[60:61], v[60:61], v[194:195]
  v_pk_mul_f32 v[64:65], v[64:65], v[210:211]
  v_exp_f32 v52, v52
  v_exp_f32 v53, v53
  v_exp_f32 v56, v56
  v_exp_f32 v57, v57
  v_exp_f32 v60, v60
  v_exp_f32 v61, v61
  v_exp_f32 v64, v64
  v_exp_f32 v65, v65
  v_pk_mul_f32 v[54:55], v[192:193], v[24:25]
  v_pk_mul_f32 v[58:59], v[208:209], v[24:25]
  v_pk_mul_f32 v[62:63], v[194:195], v[26:27]
  v_pk_mul_f32 v[66:67], v[210:211], v[26:27]
  v_pk_add_f32 v[52:53], v[52:53], v[248:249]
  v_pk_add_f32 v[56:57], v[56:57], v[248:249]
  v_pk_add_f32 v[60:61], v[60:61], v[248:249]
  v_pk_add_f32 v[64:65], v[64:65], v[248:249]
  v_rcp_f32 v52, v52
  v_rcp_f32 v53, v53
  v_rcp_f32 v56, v56
  v_rcp_f32 v57, v57
  v_rcp_f32 v60, v60
  v_rcp_f32 v61, v61
  v_rcp_f32 v64, v64
  v_rcp_f32 v65, v65
  v_pk_fma_f32 v[44:45], v[52:53], v[54:55], v[44:45]
  v_pk_fma_f32 v[46:47], v[56:57], v[58:59], v[46:47]
  v_pk_fma_f32 v[44:45], v[60:61], v[62:63], v[44:45]
  v_pk_fma_f32 v[46:47], v[64:65], v[66:67], v[46:47]
  v_pk_mul_f32 v[68:69], v[196:197], v[196:197]
  v_pk_mul_f32 v[72:73], v[212:213], v[212:213]
  v_pk_mul_f32 v[76:77], v[198:199], v[198:199]
  v_pk_mul_f32 v[80:81], v[214:215], v[214:215]
  v_pk_fma_f32 v[68:69], v[68:69], v[14:15], v[12:13]
  v_pk_fma_f32 v[72:73], v[72:73], v[14:15], v[12:13]
  v_pk_fma_f32 v[76:77], v[76:77], v[14:15], v[12:13]
  v_pk_fma_f32 v[80:81], v[80:81], v[14:15], v[12:13]
  v_pk_mul_f32 v[68:69], v[68:69], v[196:197]
  v_pk_mul_f32 v[72:73], v[72:73], v[212:213]
  v_pk_mul_f32 v[76:77], v[76:77], v[198:199]
  v_pk_mul_f32 v[80:81], v[80:81], v[214:215]
  v_exp_f32 v68, v68
  v_exp_f32 v69, v69
  v_exp_f32 v72, v72
  v_exp_f32 v73, v73
  v_exp_f32 v76, v76
  v_exp_f32 v77, v77
  v_exp_f32 v80, v80
  v_exp_f32 v81, v81
  v_pk_mul_f32 v[70:71], v[196:197], v[28:29]
  v_pk_mul_f32 v[74:75], v[212:213], v[28:29]
  v_pk_mul_f32 v[78:79], v[198:199], v[30:31]
  v_pk_mul_f32 v[82:83], v[214:215], v[30:31]
  v_pk_add_f32 v[68:69], v[68:69], v[248:249]
  v_pk_add_f32 v[72:73], v[72:73], v[248:249]
  v_pk_add_f32 v[76:77], v[76:77], v[248:249]
  v_pk_add_f32 v[80:81], v[80:81], v[248:249]
  v_rcp_f32 v68, v68
  v_rcp_f32 v69, v69
  v_rcp_f32 v72, v72
  v_rcp_f32 v73, v73
  v_rcp_f32 v76, v76
  v_rcp_f32 v77, v77
  v_rcp_f32 v80, v80
  v_rcp_f32 v81, v81
  v_pk_fma_f32 v[44:45], v[68:69], v[70:71], v[44:45]
  v_pk_fma_f32 v[46:47], v[72:73], v[74:75], v[46:47]
  v_pk_fma_f32 v[44:45], v[76:77], v[78:79], v[44:45]
  v_pk_fma_f32 v[46:47], v[80:81], v[82:83], v[46:47]
  v_pk_mul_f32 v[52:53], v[216:217], v[216:217]
  v_pk_mul_f32 v[56:57], v[232:233], v[232:233]
  v_pk_mul_f32 v[60:61], v[218:219], v[218:219]
  v_pk_mul_f32 v[64:65], v[234:235], v[234:235]
  v_pk_fma_f32 v[52:53], v[52:53], v[14:15], v[12:13]
  v_pk_fma_f32 v[56:57], v[56:57], v[14:15], v[12:13]
  v_pk_fma_f32 v[60:61], v[60:61], v[14:15], v[12:13]
  v_pk_fma_f32 v[64:65], v[64:65], v[14:15], v[12:13]
  v_pk_mul_f32 v[52:53], v[52:53], v[216:217]
  v_pk_mul_f32 v[56:57], v[56:57], v[232:233]
  v_pk_mul_f32 v[60:61], v[60:61], v[218:219]
  v_pk_mul_f32 v[64:65], v[64:65], v[234:235]
  v_exp_f32 v52, v52
  v_exp_f32 v53, v53
  v_exp_f32 v56, v56
  v_exp_f32 v57, v57
  v_exp_f32 v60, v60
  v_exp_f32 v61, v61
  v_exp_f32 v64, v64
  v_exp_f32 v65, v65
  v_pk_mul_f32 v[54:55], v[216:217], v[16:17]
  v_pk_mul_f32 v[58:59], v[232:233], v[16:17]
  v_pk_mul_f32 v[62:63], v[218:219], v[18:19]
  v_pk_mul_f32 v[66:67], v[234:235], v[18:19]
  v_pk_add_f32 v[52:53], v[52:53], v[248:249]
  v_pk_add_f32 v[56:57], v[56:57], v[248:249]
  v_pk_add_f32 v[60:61], v[60:61], v[248:249]
  v_pk_add_f32 v[64:65], v[64:65], v[248:249]
  v_rcp_f32 v52, v52
  v_rcp_f32 v53, v53
  v_rcp_f32 v56, v56
  v_rcp_f32 v57, v57
  v_rcp_f32 v60, v60
  v_rcp_f32 v61, v61
  v_rcp_f32 v64, v64
  v_rcp_f32 v65, v65
  v_pk_mul_f32 v[48:49], v[52:53], v[54:55]
  v_pk_mul_f32 v[50:51], v[56:57], v[58:59]
  v_pk_fma_f32 v[48:49], v[60:61], v[62:63], v[48:49]
  v_pk_fma_f32 v[50:51], v[64:65], v[66:67], v[50:51]
  v_pk_mul_f32 v[68:69], v[220:221], v[220:221]
  v_pk_mul_f32 v[72:73], v[236:237], v[236:237]
  v_pk_mul_f32 v[76:77], v[222:223], v[222:223]
  v_pk_mul_f32 v[80:81], v[238:239], v[238:239]
  v_pk_fma_f32 v[68:69], v[68:69], v[14:15], v[12:13]
  v_pk_fma_f32 v[72:73], v[72:73], v[14:15], v[12:13]
  v_pk_fma_f32 v[76:77], v[76:77], v[14:15], v[12:13]
  v_pk_fma_f32 v[80:81], v[80:81], v[14:15], v[12:13]
  v_pk_mul_f32 v[68:69], v[68:69], v[220:221]
  v_pk_mul_f32 v[72:73], v[72:73], v[236:237]
  v_pk_mul_f32 v[76:77], v[76:77], v[222:223]
  v_pk_mul_f32 v[80:81], v[80:81], v[238:239]
  v_exp_f32 v68, v68
  v_exp_f32 v69, v69
  v_exp_f32 v72, v72
  v_exp_f32 v73, v73
  v_exp_f32 v76, v76
  v_exp_f32 v77, v77
  v_exp_f32 v80, v80
  v_exp_f32 v81, v81
  v_pk_mul_f32 v[70:71], v[220:221], v[20:21]
  v_pk_mul_f32 v[74:75], v[236:237], v[20:21]
  v_pk_mul_f32 v[78:79], v[222:223], v[22:23]
  v_pk_mul_f32 v[82:83], v[238:239], v[22:23]
  v_pk_add_f32 v[68:69], v[68:69], v[248:249]
  v_pk_add_f32 v[72:73], v[72:73], v[248:249]
  v_pk_add_f32 v[76:77], v[76:77], v[248:249]
  v_pk_add_f32 v[80:81], v[80:81], v[248:249]
  v_rcp_f32 v68, v68
  v_rcp_f32 v69, v69
  v_rcp_f32 v72, v72
  v_rcp_f32 v73, v73
  v_rcp_f32 v76, v76
  v_rcp_f32 v77, v77
  v_rcp_f32 v80, v80
  v_rcp_f32 v81, v81
  v_pk_fma_f32 v[48:49], v[68:69], v[70:71], v[48:49]
  v_pk_fma_f32 v[50:51], v[72:73], v[74:75], v[50:51]
  v_pk_fma_f32 v[48:49], v[76:77], v[78:79], v[48:49]
  v_pk_fma_f32 v[50:51], v[80:81], v[82:83], v[50:51]
  v_pk_mul_f32 v[52:53], v[224:225], v[224:225]
  v_pk_mul_f32 v[56:57], v[240:241], v[240:241]
  v_pk_mul_f32 v[60:61], v[226:227], v[226:227]
  v_pk_mul_f32 v[64:65], v[242:243], v[242:243]
  v_pk_fma_f32 v[52:53], v[52:53], v[14:15], v[12:13]
  v_pk_fma_f32 v[56:57], v[56:57], v[14:15], v[12:13]
  v_pk_fma_f32 v[60:61], v[60:61], v[14:15], v[12:13]
  v_pk_fma_f32 v[64:65], v[64:65], v[14:15], v[12:13]
  v_pk_mul_f32 v[52:53], v[52:53], v[224:225]
  v_pk_mul_f32 v[56:57], v[56:57], v[240:241]
  v_pk_mul_f32 v[60:61], v[60:61], v[226:227]
  v_pk_mul_f32 v[64:65], v[64:65], v[242:243]
  v_exp_f32 v52, v52
  v_exp_f32 v53, v53
  v_exp_f32 v56, v56
  v_exp_f32 v57, v57
  v_exp_f32 v60, v60
  v_exp_f32 v61, v61
  v_exp_f32 v64, v64
  v_exp_f32 v65, v65
  v_pk_mul_f32 v[54:55], v[224:225], v[24:25]
  v_pk_mul_f32 v[58:59], v[240:241], v[24:25]
  v_pk_mul_f32 v[62:63], v[226:227], v[26:27]
  v_pk_mul_f32 v[66:67], v[242:243], v[26:27]
  v_pk_add_f32 v[52:53], v[52:53], v[248:249]
  v_pk_add_f32 v[56:57], v[56:57], v[248:249]
  v_pk_add_f32 v[60:61], v[60:61], v[248:249]
  v_pk_add_f32 v[64:65], v[64:65], v[248:249]
  v_rcp_f32 v52, v52
  v_rcp_f32 v53, v53
  v_rcp_f32 v56, v56
  v_rcp_f32 v57, v57
  v_rcp_f32 v60, v60
  v_rcp_f32 v61, v61
  v_rcp_f32 v64, v64
  v_rcp_f32 v65, v65
  v_pk_fma_f32 v[48:49], v[52:53], v[54:55], v[48:49]
  v_pk_fma_f32 v[50:51], v[56:57], v[58:59], v[50:51]
  v_pk_fma_f32 v[48:49], v[60:61], v[62:63], v[48:49]
  v_pk_fma_f32 v[50:51], v[64:65], v[66:67], v[50:51]
  v_pk_mul_f32 v[68:69], v[228:229], v[228:229]
  v_pk_mul_f32 v[72:73], v[244:245], v[244:245]
  v_pk_mul_f32 v[76:77], v[230:231], v[230:231]
  v_pk_mul_f32 v[80:81], v[246:247], v[246:247]
  v_pk_fma_f32 v[68:69], v[68:69], v[14:15], v[12:13]
  v_pk_fma_f32 v[72:73], v[72:73], v[14:15], v[12:13]
  v_pk_fma_f32 v[76:77], v[76:77], v[14:15], v[12:13]
  v_pk_fma_f32 v[80:81], v[80:81], v[14:15], v[12:13]
  v_pk_mul_f32 v[68:69], v[68:69], v[228:229]
  v_pk_mul_f32 v[72:73], v[72:73], v[244:245]
  v_pk_mul_f32 v[76:77], v[76:77], v[230:231]
  v_pk_mul_f32 v[80:81], v[80:81], v[246:247]
  v_exp_f32 v68, v68
  v_exp_f32 v69, v69
  v_exp_f32 v72, v72
  v_exp_f32 v73, v73
  v_exp_f32 v76, v76
  v_exp_f32 v77, v77
  v_exp_f32 v80, v80
  v_exp_f32 v81, v81
  v_pk_mul_f32 v[70:71], v[228:229], v[28:29]
  v_pk_mul_f32 v[74:75], v[244:245], v[28:29]
  v_pk_mul_f32 v[78:79], v[230:231], v[30:31]
  v_pk_mul_f32 v[82:83], v[246:247], v[30:31]
  v_pk_add_f32 v[68:69], v[68:69], v[248:249]
  v_pk_add_f32 v[72:73], v[72:73], v[248:249]
  v_pk_add_f32 v[76:77], v[76:77], v[248:249]
  v_pk_add_f32 v[80:81], v[80:81], v[248:249]
  v_rcp_f32 v68, v68
  v_rcp_f32 v69, v69
  v_rcp_f32 v72, v72
  v_rcp_f32 v73, v73
  v_rcp_f32 v76, v76
  v_rcp_f32 v77, v77
  v_rcp_f32 v80, v80
  v_rcp_f32 v81, v81
  v_pk_fma_f32 v[48:49], v[68:69], v[70:71], v[48:49]
  v_pk_fma_f32 v[50:51], v[72:73], v[74:75], v[50:51]
  v_pk_fma_f32 v[48:49], v[76:77], v[78:79], v[48:49]
  v_pk_fma_f32 v[50:51], v[80:81], v[82:83], v[50:51]
  v_pk_mul_f32 v[32:33], v[88:89], v[16:17]
  v_pk_fma_f32 v[32:33], v[90:91], v[18:19], v[32:33]
  v_pk_fma_f32 v[32:33], v[92:93], v[20:21], v[32:33]
  v_pk_fma_f32 v[32:33], v[94:95], v[22:23], v[32:33]
  v_pk_fma_f32 v[32:33], v[96:97], v[24:25], v[32:33]
  v_pk_fma_f32 v[32:33], v[98:99], v[26:27], v[32:33]
  v_pk_fma_f32 v[32:33], v[100:101], v[28:29], v[32:33]
  v_pk_fma_f32 v[32:33], v[102:103], v[30:31], v[32:33]
  v_add_f32 v32, v32, v33
  v_add_f32 v34, v34, v35
  v_add_f32 v36, v36, v37
  v_add_f32 v38, v38, v39
  v_add_f32 v40, v40, v41
  v_add_f32 v42, v42, v43
  v_add_f32 v44, v44, v45
  v_add_f32 v46, v46, v47
  v_add_f32 v48, v48, v49
  v_add_f32 v50, v50, v51
  v_permlane32_swap_b32 v32, v34
  v_permlane32_swap_b32 v36, v38
  v_permlane32_swap_b32 v40, v42
  v_permlane32_swap_b32 v44, v46
  v_permlane32_swap_b32 v48, v50
  v_add_f32 v48, v48, v50
  v_add_f32 v32, v32, v34
  v_add_f32 v36, v36, v38
  v_add_f32 v40, v40, v42
  v_add_f32 v44, v44, v46
  v_mov_b32 v50, v48
  v_permlane16_swap_b32 v32, v36
  v_permlane16_swap_b32 v40, v44
  v_permlane16_swap_b32 v48, v50
  v_add_f32 v32, v32, v36
  v_add_f32 v40, v40, v44
  v_add_f32_e64 v48, v48, v50
  ds_write_b32 v10, v32
  ds_write_b32 v10, v40 offset:256
  s_mov_b32 exec_lo, 0xffff
  s_mov_b32 exec_hi, 0xffff
  ds_write_b32 v10, v48 offset:512
  s_mov_b64 exec, -1
  s_waitcnt lgkmcnt(0)
  s_barrier
  s_endpgm
L_ld_tail:
  s_barrier
  s_mov_b32 s60, s24
  s_and_b32 s61, s25, 0xffff
  s_mov_b32 s62, 268435456
  s_mov_b32 s63, 0x20000
  s_mov_b32 s56, s20
  s_and_b32 s57, s21, 0xffff
  s_mov_b32 s58, 8192
  s_mov_b32 s59, 0x20000
  s_mov_b32 s64, s22
  s_and_b32 s65, s23, 0xffff
  s_mov_b32 s66, 256
  s_mov_b32 s67, 0x20000
  s_load_dword s80, s[18:19], 0
  v_mov_b32 v100, 0
  s_mov_b64 exec, 1
  s_mov_b32 s81, 0x80000
  buffer_load_dword v101, v100, s[60:63], s81 offen
  buffer_load_dword v102, v100, s[56:59], 0 offen
  s_mov_b64 exec, -1
  s_mov_b64 exec, 1
  buffer_load_dword v250, v100, s[64:67], 0 offen offset:240 sc1
  s_mov_b64 exec, -1
  s_cmp_lg_u32 s3, 4
  s_cbranch_scc1 L_end
  v_lshlrev_b32 v3, 4, v0
  v_lshlrev_b32 v4, 2, v0
  v_add_u32 v1, 123392, v3
  v_add_u32 v2, 124416, v4
  v_add_u32 v4, 1024, v4
  v_mov_b32 v5, 32
  v_mov_b32 v7, s26
  s_mul_i32 s68, s26, 1280
  s_mul_i32 s69, s27, 16640
  s_add_u32 s69, s69, s68
  s_setprio 3
  v_mov_b32 v64, -1
  v_mov_b32 v65, -1
  v_mov_b32 v66, -1
  v_mov_b32 v67, -1
  buffer_store_dwordx4 v[64:67], v3, s[60:63], s69 offen sc1
  buffer_store_dword v64, v4, s[60:63], s69 offen sc1
  s_waitcnt vmcnt(0)
  s_barrier
  ds_read_b128 v[64:67], v1
  ds_read_b128 v[72:75], v1 offset:1280
  ds_read2st64_b32 v[68:69], v2 offset0:0 offset1:5
  s_waitcnt lgkmcnt(0)
  v_pk_add_f32 v[64:65], v[64:65], v[72:73]
  v_pk_add_f32 v[66:67], v[66:67], v[74:75]
  v_add_f32 v68, v68, v69
  v_min_u32 v64, -2, v64
  v_min_u32 v65, -2, v65
  v_min_u32 v66, -2, v66
  v_min_u32 v67, -2, v67
  v_min_u32 v68, -2, v68
  buffer_store_dwordx4 v[64:67], v3, s[60:63], s69 offen sc1
  buffer_store_dword v68, v4, s[60:63], s69 offen sc1
  s_mov_b64 exec, 1
L_pub:
  v_lshlrev_b32 v6, 4, v7
  v_mov_b32 v13, v5
  buffer_atomic_add v5, v6, s[64:67], 0 offen sc0
  v_cmp_eq_u32 vcc, 12, v7
  v_mov_b32 v8, 436
  v_mov_b32 v9, 434
  v_cndmask_b32 v8, v8, v9, vcc
  v_sub_u32 v8, v8, v13
  s_waitcnt vmcnt(0) lgkmcnt(0)
  v_cmp_eq_u32 s[82:83], v5, v8
  s_mov_b64 exec, -1
  s_lshl_b32 s80, s80, 16
  v_lshrrev_b32 v1, 1, v3
  v_lshrrev_b32 v2, 1, v4
L_fin:
  s_cmp_eq_u32 s82, 0
  s_cbranch_scc1 L_done
  s_ff1_i32_b32 s70, s82
  s_bitset0_b32 s82, s70
  v_readlane_b32 s71, v7, s70
  s_waitcnt vmcnt(0)
L_again:
  s_mul_i32 s68, s71, 1280
  buffer_load_dwordx4 v[64:67], v3, s[60:63], s68 offen sc1
  buffer_load_dword v68, v4, s[60:63], s68 offen sc1
  s_add_u32 s68, s68, 16640
  buffer_load_dwordx4 v[72:75], v3, s[60:63], s68 offen sc1
  buffer_load_dword v76, v4, s[60:63], s68 offen sc1
  s_add_u32 s68, s68, 16640
  buffer_load_dwordx4 v[80:83], v3, s[60:63], s68 offen sc1
  buffer_load_dword v84, v4, s[60:63], s68 offen sc1
  s_add_u32 s68, s68, 16640
  buffer_load_dwordx4 v[88:91], v3, s[60:63], s68 offen sc1
  buffer_load_dword v92, v4, s[60:63], s68 offen sc1
  s_add_u32 s68, s68, 16640
  buffer_load_dwordx4 v[96:99], v3, s[60:63], s68 offen sc1
  buffer_load_dword v100, v4, s[60:63], s68 offen sc1
  s_add_u32 s68, s68, 16640
  buffer_load_dwordx4 v[104:107], v3, s[60:63], s68 offen sc1
  buffer_load_dword v108, v4, s[60:63], s68 offen sc1
  s_add_u32 s68, s68, 16640
  buffer_load_dwordx4 v[112:115], v3, s[60:63], s68 offen sc1
  buffer_load_dword v116, v4, s[60:63], s68 offen sc1
  s_add_u32 s68, s68, 16640
  buffer_load_dwordx4 v[120:123], v3, s[60:63], s68 offen sc1
  buffer_load_dword v124, v4, s[60:63], s68 offen sc1
  s_add_u32 s68, s68, 16640
  buffer_load_dwordx4 v[128:131], v3, s[60:63], s68 offen sc1
  buffer_load_dword v132, v4, s[60:63], s68 offen sc1
  s_add_u32 s68, s68, 16640
  buffer_load_dwordx4 v[136:139], v3, s[60:63], s68 offen sc1
  buffer_load_dword v140, v4, s[60:63], s68 offen sc1
  s_add_u32 s68, s68, 16640
  buffer_load_dwordx4 v[144:147], v3, s[60:63], s68 offen sc1
  buffer_load_dword v148, v4, s[60:63], s68 offen sc1
  s_add_u32 s68, s68, 16640
  buffer_load_dwordx4 v[152:155], v3, s[60:63], s68 offen sc1
  buffer_load_dword v156, v4, s[60:63], s68 offen sc1
  s_add_u32 s68, s68, 16640
  buffer_load_dwordx4 v[160:163], v3, s[60:63], s68 offen sc1
  buffer_load_dword v164, v4, s[60:63], s68 offen sc1
  s_add_u32 s68, s68, 16640
  buffer_load_dwordx4 v[168:171], v3, s[60:63], s68 offen sc1
  buffer_load_dword v172, v4, s[60:63], s68 offen sc1
  s_add_u32 s68, s68, 16640
L_sum:
  s_waitcnt vmcnt(25)
  v_pk_add_f32 v[56:57], v[64:65], v[72:73]
  v_pk_add_f32 v[58:59], v[66:67], v[74:75]
  s_waitcnt vmcnt(24)
  v_add_f32 v60, v68, v76
  s_waitcnt vmcnt(23)
  v_pk_add_f32 v[56:57], v[56:57], v[80:81]
  v_pk_add_f32 v[58:59], v[58:59], v[82:83]
  s_waitcnt vmcnt(22)
  v_add_f32_e64 v60, v60, v84
  s_waitcnt vmcnt(21)
  v_pk_add_f32 v[56:57], v[56:57], v[88:89]
  v_pk_add_f32 v[58:59], v[58:59], v[90:91]
  s_waitcnt vmcnt(20)
  v_add_f32 v60, v60, v92
  s_waitcnt vmcnt(19)
  v_pk_add_f32 v[56:57], v[56:57], v[96:97]
  v_pk_add_f32 v[58:59], v[58:59], v[98:99]
  s_waitcnt vmcnt(18)
  v_add_f32 v60, v60, v100
  s_waitcnt vmcnt(17)
  v_pk_add_f32 v[56:57], v[56:57], v[104:105]
  v_pk_add_f32 v[58:59], v[58:59], v[106:107]
  s_waitcnt vmcnt(16)
  v_add_f32 v60, v60, v108
  s_waitcnt vmcnt(15)
  v_pk_add_f32 v[56:57], v[56:57], v[112:113]
  v_pk_add_f32 v[58:59], v[58:59], v[114:115]
  s_waitcnt vmcnt(14)
  v_add_f32 v60, v60, v116
  s_waitcnt vmcnt(13)
  v_pk_add_f32 v[56:57], v[56:57], v[120:121]
  v_pk_add_f32 v[58:59], v[58:59], v[122:123]
  s_waitcnt vmcnt(12)
  v_add_f32 v60, v60, v124
  s_waitcnt vmcnt(11)
  v_pk_add_f32 v[56:57], v[56:57], v[128:129]
  v_pk_add_f32 v[58:59], v[58:59], v[130:131]
  s_waitcnt vmcnt(10)
  v_add_f32 v60, v60, v132
  s_waitcnt vmcnt(9)
  v_pk_add_f32 v[56:57], v[56:57], v[136:137]
  v_pk_add_f32 v[58:59], v[58:59], v[138:139]
  s_waitcnt vmcnt(8)
  v_add_f32_e64 v60, v60, v140
  s_waitcnt vmcnt(7)
  v_pk_add_f32 v[56:57], v[56:57], v[144:145]
  v_pk_add_f32 v[58:59], v[58:59], v[146:147]
  s_waitcnt vmcnt(6)
  v_add_f32 v60, v60, v148
  s_waitcnt vmcnt(5)
  v_pk_add_f32 v[56:57], v[56:57], v[152:153]
  v_pk_add_f32 v[58:59], v[58:59], v[154:155]
  s_waitcnt vmcnt(4)
  v_add_f32 v60, v60, v156
  s_waitcnt vmcnt(3)
  v_pk_add_f32 v[56:57], v[56:57], v[160:161]
  v_pk_add_f32 v[58:59], v[58:59], v[162:163]
  s_waitcnt vmcnt(2)
  v_add_f32 v60, v60, v164
  s_waitcnt vmcnt(1)
  v_pk_add_f32 v[56:57], v[56:57], v[168:169]
  v_pk_add_f32 v[58:59], v[58:59], v[170:171]
  s_waitcnt vmcnt(0)
  v_add_f32 v60, v60, v172
  v_cmp_u_f32 vcc, v56, v57
  v_cmp_u_f32 s[92:93], v58, v59
  s_nop 0
  s_or_b64 s[92:93], s[92:93], vcc
  v_cmp_u_f32 vcc, v60, v60
  s_nop 0
  s_or_b64 vcc, s[92:93], vcc
  s_cbranch_vccnz L_chk
L_ok:
  s_mul_i32 s71, s71, 640
  v_add_f32 v56, s80, v56
  v_add_f32 v57, s80, v57
  v_add_f32 v58, s80, v58
  v_add_f32 v59, s80, v59
  v_add_f32_e64 v60, s80, v60
  v_cvt_pk_bf16_f32 v10, v56, v57
  v_cvt_pk_bf16_f32 v11, v58, v59
  v_cvt_pk_bf16_f32 v12, v60, v60
  buffer_store_dwordx2 v[10:11], v1, s[56:59], s71 offen
  buffer_store_short v12, v2, s[56:59], s71 offen
  s_branch L_fin
L_chk:
  v_mov_b32 v14, 0
  v_mov_b32 v15, 0
  v_max3_u32 v14, v14, v64, v65
  v_max3_u32 v14, v14, v66, v67
  v_max_u32 v15, v15, v68
  v_max3_u32 v14, v14, v72, v73
  v_max3_u32 v14, v14, v74, v75
  v_max_u32 v15, v15, v76
  v_max3_u32 v14, v14, v80, v81
  v_max3_u32 v14, v14, v82, v83
  v_max_u32 v15, v15, v84
  v_max3_u32 v14, v14, v88, v89
  v_max3_u32 v14, v14, v90, v91
  v_max_u32_e64 v15, v15, v92
  v_max3_u32 v14, v14, v96, v97
  v_max3_u32 v14, v14, v98, v99
  v_max_u32 v15, v15, v100
  v_max3_u32 v14, v14, v104, v105
  v_max3_u32 v14, v14, v106, v107
  v_max_u32 v15, v15, v108
  v_max3_u32 v14, v14, v112, v113
  v_max3_u32 v14, v14, v114, v115
  v_max_u32_e64 v15, v15, v116
  v_max3_u32 v14, v14, v120, v121
  v_max3_u32 v14, v14, v122, v123
  v_max_u32 v15, v15, v124
  v_max3_u32 v14, v14, v128, v129
  v_max3_u32 v14, v14, v130, v131
  v_max_u32 v15, v15, v132
  v_max3_u32 v14, v14, v136, v137
  v_max3_u32 v14, v14, v138, v139
  v_max_u32_e64 v15, v15, v140
  v_max3_u32 v14, v14, v144, v145
  v_max3_u32 v14, v14, v146, v147
  v_max_u32 v15, v15, v148
  v_max3_u32 v14, v14, v152, v153
  v_max3_u32 v14, v14, v154, v155
  v_max_u32 v15, v15, v156
  v_max3_u32 v14, v14, v160, v161
  v_max3_u32 v14, v14, v162, v163
  v_max_u32_e64 v15, v15, v164
  v_max3_u32 v14, v14, v168, v169
  v_max3_u32 v14, v14, v170, v171
  v_max_u32 v15, v15, v172
  s_cmp_eq_u32 s71, 12
  s_cselect_b32 s68, 0, -1
  v_and_b32 v15, s68, v15
  v_max_u32 v14, v14, v15
  v_cmp_eq_u32 vcc, -1, v14
  s_cbranch_vccnz L_again
  s_branch L_ok
L_done:
  s_endpgm
L_cin_done:
  s_mul_i32 s98, s3, 1536
  s_add_u32 s98, s98, 116736
  v_lshlrev_b32 v120, 5, v0
  v_add_u32 v120, s98, v120
  ds_read_b128 v[60:63], v120
  ds_read_b128 v[64:67], v120 offset:16
  v_mul_f32 v116, v184, v192
  v_mul_f32 v117, v185, v193
  v_mul_f32 v118, v186, v194
  v_mul_f32 v119, v187, v195
  v_fmac_f32 v116, v188, v191
  v_fmac_f32 v117, v200, v208
  v_fmac_f32 v118, v201, v209
  v_fmac_f32 v119, v202, v210
  v_fmac_f32 v116, v203, v211
  v_fmac_f32 v117, v204, v207
  v_fmac_f32 v118, v216, v224
  v_fmac_f32 v119, v217, v225
  v_fmac_f32 v116, v218, v226
  v_fmac_f32 v117, v219, v227
  v_fmac_f32 v118, v220, v223
  v_fmac_f32 v119, v232, v240
  v_fmac_f32 v116, v233, v241
  v_fmac_f32 v117, v234, v242
  v_fmac_f32 v118, v235, v243
  v_fmac_f32 v119, v236, v239
  v_fmac_f32 v116, v189, v196
  v_fmac_f32 v117, v189, v197
  v_fmac_f32 v118, v190, v198
  v_fmac_f32 v119, v190, v199
  v_fmac_f32 v116, v205, v212
  v_fmac_f32 v117, v205, v213
  v_fmac_f32 v118, v206, v214
  v_fmac_f32 v119, v206, v215
  v_fmac_f32 v116, v221, v228
  v_fmac_f32 v117, v221, v229
  v_fmac_f32 v118, v222, v230
  v_fmac_f32 v119, v222, v231
  v_fmac_f32 v116, v237, v244
  v_fmac_f32 v117, v237, v245
  v_fmac_f32 v118, v238, v246
  v_fmac_f32 v119, v238, v247
  v_add_f32 v116, v116, v117
  v_add_f32 v118, v118, v119
  v_add_f32 v116, v116, v118
  v_mul_f32 v116, s74, v116
  v_mul_f32_e64 v116, s75, v116
  s_nop 1
  v_add_f32_dpp v116, v116, v116 row_shr:1 row_mask:0xf bank_mask:0xf
  v_subrev_u32 v122, s98, v7
  v_lshrrev_b32 v122, 8, v122
  v_lshrrev_b32 v121, 3, v0
  v_add_f32_dpp v116, v116, v116 row_shr:2 row_mask:0xf bank_mask:0xf
  v_cmp_gt_u32 vcc, v122, v121
  v_min_u32 v121, v121, v122
  v_lshlrev_b32 v121, 4, v121
  v_add_f32_dpp v116, v116, v116 row_shr:4 row_mask:0xf bank_mask:0xf
  v_add_u32 v121, s85, v121
  s_waitcnt lgkmcnt(1)
  v_add_f32 v60, v60, v61
  v_add_f32 v62, v62, v63
  v_add_f32_dpp v116, v116, v116 row_shr:8 row_mask:0xf bank_mask:0xf
  s_waitcnt lgkmcnt(0)
  v_add_f32 v64, v64, v65
  v_add_f32 v66, v66, v67
  v_add_f32 v60, v60, v62
  v_add_f32_dpp v116, v116, v116 row_bcast:15 row_mask:0xa bank_mask:0xf
  v_add_f32 v64, v64, v66
  v_add_f32 v60, v60, v64
  s_nop 1
  v_add_f32_dpp v60, v60, v60 quad_perm:[1,0,3,2] row_mask:0xf bank_mask:0xf
  v_add_f32_dpp v116, v116, v116 row_bcast:31 row_mask:0xc bank_mask:0xf
  s_nop 0
  v_add_f32_dpp v60, v60, v60 quad_perm:[2,3,0,1] row_mask:0xf bank_mask:0xf
  s_nop 1
  v_add_f32_dpp v60, v60, v60 row_half_mirror row_mask:0xf bank_mask:0xf
  v_cndmask_b32 v60, v116, v60, vcc
  s_bitset1_b32 vcc_hi, 31
  s_mov_b64 exec, vcc
  ds_write_b32 v121, v60
  s_mov_b64 exec, -1
  s_cmp_eq_u32 s3, 0
  s_cbranch_scc1 L_cpub
  s_waitcnt lgkmcnt(0)
  s_barrier
  s_endpgm
L_cpub:
  s_load_dword s80, s[18:19], 0
  s_mov_b32 s60, s24
  s_and_b32 s61, s25, 0xffff
  s_mov_b32 s62, 268435456
  s_mov_b32 s63, 0x20000
  s_mov_b32 s56, s20
  s_and_b32 s57, s21, 0xffff
  s_mov_b32 s58, 8192
  s_mov_b32 s59, 0x20000
  s_mov_b32 s64, s22
  s_and_b32 s65, s23, 0xffff
  s_mov_b32 s66, 256
  s_mov_b32 s67, 0x20000
  v_lshlrev_b32 v6, 2, v0
  v_add_u32 v2, 129728, v6
  v_add_u32 v4, 1024, v6
  s_mul_i32 s69, s26, 192
  s_add_u32 s69, s69, 216320
  v_mov_b32 v13, -1
  s_mov_b32 exec_hi, 0xffff
  buffer_store_dword v13, v6, s[60:63], s69 offen sc1
  s_mov_b64 exec, 1
  buffer_load_dword v250, v6, s[56:59], 0 offen
  buffer_load_dword v251, v6, s[64:67], 0 offen offset:240 sc1
  s_mov_b64 exec, -1
  s_mul_i32 s68, s26, 3
  s_mul_i32 s70, s68, 3277
  s_lshr_b32 s70, s70, 16
  v_add_u32 v7, s70, v0
  s_mul_i32 s70, s70, 20
  s_add_u32 s70, s70, 20
  s_sub_u32 s70, s70, s68
  s_min_u32 s70, s70, 3
  s_sub_u32 s68, 3, s70
  v_mov_b32 v5, s68
  v_writelane_b32 v5, s70, 0
  s_cmp_eq_u32 s68, 0
  s_cselect_b32 s68, 1, 3
  v_lshlrev_b32_e64 v3, 4, v0
  s_mov_b32 exec_hi, 0xffff
  s_waitcnt vmcnt(0) lgkmcnt(0)
  s_barrier
  ds_read_b32 v64, v2
  s_waitcnt lgkmcnt(0)
  v_min_u32_e64 v64, -2, v64
  buffer_store_dword v64, v6, s[60:63], s69 offen sc1
  s_mov_b32 exec_lo, s68
  s_mov_b32 exec_hi, 0
  s_branch L_pub
L_dnn_loop1:
  s_barrier
L_ld_in:
  s_add_u32 m0, s75, 131072
  s_nop 0
  buffer_load_dwordx4 v4, s[44:47], s74 offen lds
  s_add_u32 m0, s75, 132096
  s_nop 0
  buffer_load_dwordx4 v5, s[44:47], s74 offen lds
  s_add_u32 s74, s74, 106496
  s_add_u32 m0, s75, 139264
  s_nop 0
  buffer_load_dwordx4 v4, s[44:47], s74 offen lds
  s_add_u32 m0, s75, 140288
  s_nop 0
  buffer_load_dwordx4 v5, s[44:47], s74 offen lds
  s_add_u32 s74, s74, 106496
  s_add_u32 m0, s76, 0
  s_nop 0
  buffer_load_dwordx4 v56, s[32:35], 0 offen lds
  s_add_u32 m0, s76, 2048
  v_add_u32_dpp v56, v16, v2 row_newbcast:1 row_mask:0xf bank_mask:0x3
  buffer_load_dwordx4 v57, s[32:35], 0 offen lds
  s_nop 0
  v_add_u32_dpp v56, v18, v2 row_newbcast:7 row_mask:0xf bank_mask:0xc
  s_add_u32 m0, s76, 4096
  v_add_u32_dpp v57, v20, v2 row_newbcast:1 row_mask:0xf bank_mask:0x3
  buffer_load_dwordx4 v58, s[32:35], 0 offen lds
  s_nop 0
  v_add_u32_dpp v57, v22, v2 row_newbcast:7 row_mask:0xf bank_mask:0xc
  s_add_u32 m0, s76, 6144
  v_add_u32_dpp v58, v24, v2 row_newbcast:1 row_mask:0xf bank_mask:0x3
  buffer_load_dwordx4 v59, s[32:35], 0 offen lds
  s_nop 0
  v_add_u32_dpp v58, v26, v2 row_newbcast:7 row_mask:0xf bank_mask:0xc
  s_add_u32 m0, s76, 8192
  v_add_u32_dpp v59, v28, v2 row_newbcast:1 row_mask:0xf bank_mask:0x3
  buffer_load_dwordx4 v60, s[32:35], 0 offen lds
  s_nop 0
  v_add_u32_dpp v59, v30, v2 row_newbcast:7 row_mask:0xf bank_mask:0xc
  s_add_u32 m0, s76, 10240
  v_add_u32_dpp v60, v32, v2 row_newbcast:1 row_mask:0xf bank_mask:0x3
  buffer_load_dwordx4 v61, s[32:35], 0 offen lds
  s_nop 0
  v_add_u32_dpp v60, v34, v2 row_newbcast:7 row_mask:0xf bank_mask:0xc
  s_add_u32 m0, s76, 12288
  v_add_u32_dpp v61, v36, v2 row_newbcast:1 row_mask:0xf bank_mask:0x3
  buffer_load_dwordx4 v62, s[32:35], 0 offen lds
  s_nop 0
  v_add_u32_dpp v61, v38, v2 row_newbcast:7 row_mask:0xf bank_mask:0xc
  s_add_u32 m0, s76, 14336
  v_add_u32_dpp v62, v40, v2 row_newbcast:1 row_mask:0xf bank_mask:0x3
  buffer_load_dwordx4 v63, s[32:35], 0 offen lds
  s_nop 0
  v_add_u32_dpp v62, v42, v2 row_newbcast:7 row_mask:0xf bank_mask:0xc
  s_add_u32 m0, s76, 16384
  v_add_u32_dpp v63, v44, v2 row_newbcast:1 row_mask:0xf bank_mask:0x3
  buffer_load_dwordx4 v64, s[32:35], 0 offen lds
  s_nop 0
  v_add_u32_dpp v63, v46, v2 row_newbcast:7 row_mask:0xf bank_mask:0xc
  s_add_u32 m0, s76, 18432
  v_add_u32_dpp v64, v48, v2 row_newbcast:1 row_mask:0xf bank_mask:0x3
  buffer_load_dwordx4 v65, s[32:35], 0 offen lds
  s_nop 0
  v_add_u32_dpp v64, v50, v2 row_newbcast:7 row_mask:0xf bank_mask:0xc
  v_add_u32_dpp v65, v52, v2 row_newbcast:1 row_mask:0xf bank_mask:0x3
  s_nop 1
  v_add_u32_dpp v65, v54, v2 row_newbcast:7 row_mask:0xf bank_mask:0xc
  s_waitcnt vmcnt(10)
  s_barrier
  s_add_u32 m0, s75, 147456
  s_nop 0
  buffer_load_dwordx4 v4, s[44:47], s74 offen lds
  s_add_u32 m0, s75, 148480
  s_nop 0
  buffer_load_dwordx4 v5, s[44:47], s74 offen lds
  s_add_u32 s74, s74, 106496
  s_add_u32 m0, s75, 155648
  s_nop 0
  buffer_load_dwordx4 v4, s[44:47], s74 offen lds
  s_add_u32 m0, s75, 156672
  s_nop 0
  buffer_load_dwordx4 v5, s[44:47], s74 offen lds
  s_add_u32 s74, s74, 106496
  s_add_u32 m0, s76, 40960
  s_nop 0
  buffer_load_dwordx4 v56, s[32:35], 0 offen lds
  s_add_u32 m0, s76, 43008
  v_add_u32_dpp v56, v17, v2 row_newbcast:1 row_mask:0xf bank_mask:0x3
  buffer_load_dwordx4 v57, s[32:35], 0 offen lds
  s_nop 0
  v_add_u32_dpp v56, v19, v2 row_newbcast:7 row_mask:0xf bank_mask:0xc
  s_add_u32 m0, s76, 45056
  v_add_u32_dpp v57, v21, v2 row_newbcast:1 row_mask:0xf bank_mask:0x3
  buffer_load_dwordx4 v58, s[32:35], 0 offen lds
  s_nop 0
  v_add_u32_dpp v57, v23, v2 row_newbcast:7 row_mask:0xf bank_mask:0xc
  s_add_u32 m0, s76, 47104
  v_add_u32_dpp v58, v25, v2 row_newbcast:1 row_mask:0xf bank_mask:0x3
  buffer_load_dwordx4 v59, s[32:35], 0 offen lds
  s_nop 0
  v_add_u32_dpp v58, v27, v2 row_newbcast:7 row_mask:0xf bank_mask:0xc
  s_add_u32 m0, s76, 49152
  v_add_u32_dpp v59, v29, v2 row_newbcast:1 row_mask:0xf bank_mask:0x3
  buffer_load_dwordx4 v60, s[32:35], 0 offen lds
  s_nop 0
  v_add_u32_dpp v59, v31, v2 row_newbcast:7 row_mask:0xf bank_mask:0xc
  s_add_u32 m0, s76, 51200
  v_add_u32_dpp v60, v33, v2 row_newbcast:1 row_mask:0xf bank_mask:0x3
  buffer_load_dwordx4 v61, s[32:35], 0 offen lds
  s_nop 0
  v_add_u32_dpp v60, v35, v2 row_newbcast:7 row_mask:0xf bank_mask:0xc
  s_add_u32 m0, s76, 53248
  v_add_u32_dpp v61, v37, v2 row_newbcast:1 row_mask:0xf bank_mask:0x3
  buffer_load_dwordx4 v62, s[32:35], 0 offen lds
  s_nop 0
  v_add_u32_dpp v61, v39, v2 row_newbcast:7 row_mask:0xf bank_mask:0xc
  s_add_u32 m0, s76, 55296
  v_add_u32_dpp v62, v41, v2 row_newbcast:1 row_mask:0xf bank_mask:0x3
  buffer_load_dwordx4 v63, s[32:35], 0 offen lds
  s_nop 0
  v_add_u32_dpp v62, v43, v2 row_newbcast:7 row_mask:0xf bank_mask:0xc
  s_add_u32 m0, s76, 57344
  v_add_u32_dpp v63, v45, v2 row_newbcast:1 row_mask:0xf bank_mask:0x3
  buffer_load_dwordx4 v64, s[32:35], 0 offen lds
  s_nop 0
  v_add_u32_dpp v63, v47, v2 row_newbcast:7 row_mask:0xf bank_mask:0xc
  s_add_u32 m0, s76, 59392
  v_add_u32_dpp v64, v49, v2 row_newbcast:1 row_mask:0xf bank_mask:0x3
  buffer_load_dwordx4 v65, s[32:35], 0 offen lds
  s_nop 0
  v_add_u32_dpp v64, v51, v2 row_newbcast:7 row_mask:0xf bank_mask:0xc
  v_add_u32_dpp v65, v53, v2 row_newbcast:1 row_mask:0xf bank_mask:0x3
  s_nop 1
  v_add_u32_dpp v65, v55, v2 row_newbcast:7 row_mask:0xf bank_mask:0xc
  s_waitcnt vmcnt(10)
  s_barrier
  s_add_u32 m0, s75, 131072
  s_nop 0
  buffer_load_dwordx4 v4, s[44:47], s74 offen lds
  s_add_u32 m0, s75, 132096
  s_nop 0
  buffer_load_dwordx4 v5, s[44:47], s74 offen lds
  s_add_u32 s74, s74, 106496
  s_add_u32 m0, s75, 139264
  s_nop 0
  buffer_load_dwordx4 v4, s[44:47], s74 offen lds
  s_add_u32 m0, s75, 140288
  s_nop 0
  buffer_load_dwordx4 v5, s[44:47], s74 offen lds
  s_add_u32 s74, s74, 106496
  s_add_u32 m0, s76, 81920
  s_nop 0
  buffer_load_dwordx4 v56, s[32:35], 0 offen lds
  s_add_u32 m0, s76, 83968
  v_add_u32_dpp v56, v18, v2 row_newbcast:1 row_mask:0xf bank_mask:0x3
  buffer_load_dwordx4 v57, s[32:35], 0 offen lds
  s_nop 0
  v_add_u32_dpp v56, v16, v2 row_newbcast:8 row_mask:0xf bank_mask:0xc
  s_add_u32 m0, s76, 86016
  v_add_u32_dpp v57, v22, v2 row_newbcast:1 row_mask:0xf bank_mask:0x3
  buffer_load_dwordx4 v58, s[32:35], 0 offen lds
  s_nop 0
  v_add_u32_dpp v57, v20, v2 row_newbcast:8 row_mask:0xf bank_mask:0xc
  s_add_u32 m0, s76, 88064
  v_add_u32_dpp v58, v26, v2 row_newbcast:1 row_mask:0xf bank_mask:0x3
  buffer_load_dwordx4 v59, s[32:35], 0 offen lds
  s_nop 0
  v_add_u32_dpp v58, v24, v2 row_newbcast:8 row_mask:0xf bank_mask:0xc
  s_add_u32 m0, s76, 90112
  v_add_u32_dpp v59, v30, v2 row_newbcast:1 row_mask:0xf bank_mask:0x3
  buffer_load_dwordx4 v60, s[32:35], 0 offen lds
  s_nop 0
  v_add_u32_dpp v59, v28, v2 row_newbcast:8 row_mask:0xf bank_mask:0xc
  s_add_u32 m0, s76, 92160
  v_add_u32_dpp v60, v34, v2 row_newbcast:1 row_mask:0xf bank_mask:0x3
  buffer_load_dwordx4 v61, s[32:35], 0 offen lds
  s_nop 0
  v_add_u32_dpp v60, v32, v2 row_newbcast:8 row_mask:0xf bank_mask:0xc
  s_add_u32 m0, s76, 94208
  v_add_u32_dpp v61, v38, v2 row_newbcast:1 row_mask:0xf bank_mask:0x3
  buffer_load_dwordx4 v62, s[32:35], 0 offen lds
  s_nop 0
  v_add_u32_dpp v61, v36, v2 row_newbcast:8 row_mask:0xf bank_mask:0xc
  s_add_u32 m0, s76, 96256
  v_add_u32_dpp v62, v42, v2 row_newbcast:1 row_mask:0xf bank_mask:0x3
  buffer_load_dwordx4 v63, s[32:35], 0 offen lds
  s_nop 0
  v_add_u32_dpp v62, v40, v2 row_newbcast:8 row_mask:0xf bank_mask:0xc
  s_add_u32 m0, s76, 98304
  v_add_u32_dpp v63, v46, v2 row_newbcast:1 row_mask:0xf bank_mask:0x3
  buffer_load_dwordx4 v64, s[32:35], 0 offen lds
  s_nop 0
  v_add_u32_dpp v63, v44, v2 row_newbcast:8 row_mask:0xf bank_mask:0xc
  s_add_u32 m0, s76, 100352
  v_add_u32_dpp v64, v50, v2 row_newbcast:1 row_mask:0xf bank_mask:0x3
  buffer_load_dwordx4 v65, s[32:35], 0 offen lds
  s_nop 0
  v_add_u32_dpp v64, v48, v2 row_newbcast:8 row_mask:0xf bank_mask:0xc
  v_add_u32_dpp v65, v54, v2 row_newbcast:1 row_mask:0xf bank_mask:0x3
  s_nop 1
  v_add_u32_dpp v65, v52, v2 row_newbcast:8 row_mask:0xf bank_mask:0xc
  s_waitcnt vmcnt(10)
  s_barrier
  s_add_u32 m0, s75, 147456
  s_nop 0
  buffer_load_dwordx4 v4, s[44:47], s74 offen lds
  s_add_u32 m0, s75, 148480
  s_nop 0
  buffer_load_dwordx4 v5, s[44:47], s74 offen lds
  s_add_u32 s74, s74, 106496
  s_add_u32 m0, s75, 155648
  s_nop 0
  buffer_load_dwordx4 v4, s[44:47], s74 offen lds
  s_add_u32 m0, s75, 156672
  s_nop 0
  buffer_load_dwordx4 v5, s[44:47], s74 offen lds
  s_add_u32 s74, s74, 106496
  s_add_u32 m0, s76, 0
  s_nop 0
  buffer_load_dwordx4 v56, s[32:35], 0 offen lds
  s_add_u32 m0, s76, 2048
  v_add_u32_dpp v56, v19, v2 row_newbcast:1 row_mask:0xf bank_mask:0x3
  buffer_load_dwordx4 v57, s[32:35], 0 offen lds
  s_nop 0
  v_add_u32_dpp v56, v17, v2 row_newbcast:8 row_mask:0xf bank_mask:0xc
  s_add_u32 m0, s76, 4096
  v_add_u32_dpp v57, v23, v2 row_newbcast:1 row_mask:0xf bank_mask:0x3
  buffer_load_dwordx4 v58, s[32:35], 0 offen lds
  s_nop 0
  v_add_u32_dpp v57, v21, v2 row_newbcast:8 row_mask:0xf bank_mask:0xc
  s_add_u32 m0, s76, 6144
  v_add_u32_dpp v58, v27, v2 row_newbcast:1 row_mask:0xf bank_mask:0x3
  buffer_load_dwordx4 v59, s[32:35], 0 offen lds
  s_nop 0
  v_add_u32_dpp v58, v25, v2 row_newbcast:8 row_mask:0xf bank_mask:0xc
  s_add_u32 m0, s76, 8192
  v_add_u32_dpp v59, v31, v2 row_newbcast:1 row_mask:0xf bank_mask:0x3
  buffer_load_dwordx4 v60, s[32:35], 0 offen lds
  s_nop 0
  v_add_u32_dpp v59, v29, v2 row_newbcast:8 row_mask:0xf bank_mask:0xc
  s_add_u32 m0, s76, 10240
  v_add_u32_dpp v60, v35, v2 row_newbcast:1 row_mask:0xf bank_mask:0x3
  buffer_load_dwordx4 v61, s[32:35], 0 offen lds
  s_nop 0
  v_add_u32_dpp v60, v33, v2 row_newbcast:8 row_mask:0xf bank_mask:0xc
  s_add_u32 m0, s76, 12288
  v_add_u32_dpp v61, v39, v2 row_newbcast:1 row_mask:0xf bank_mask:0x3
  buffer_load_dwordx4 v62, s[32:35], 0 offen lds
  s_nop 0
  v_add_u32_dpp v61, v37, v2 row_newbcast:8 row_mask:0xf bank_mask:0xc
  s_add_u32 m0, s76, 14336
  v_add_u32_dpp v62, v43, v2 row_newbcast:1 row_mask:0xf bank_mask:0x3
  buffer_load_dwordx4 v63, s[32:35], 0 offen lds
  s_nop 0
  v_add_u32_dpp v62, v41, v2 row_newbcast:8 row_mask:0xf bank_mask:0xc
  s_add_u32 m0, s76, 16384
  v_add_u32_dpp v63, v47, v2 row_newbcast:1 row_mask:0xf bank_mask:0x3
  buffer_load_dwordx4 v64, s[32:35], 0 offen lds
  s_nop 0
  v_add_u32_dpp v63, v45, v2 row_newbcast:8 row_mask:0xf bank_mask:0xc
  s_add_u32 m0, s76, 18432
  v_add_u32_dpp v64, v51, v2 row_newbcast:1 row_mask:0xf bank_mask:0x3
  buffer_load_dwordx4 v65, s[32:35], 0 offen lds
  s_nop 0
  v_add_u32_dpp v64, v49, v2 row_newbcast:8 row_mask:0xf bank_mask:0xc
  v_add_u32_dpp v65, v55, v2 row_newbcast:1 row_mask:0xf bank_mask:0x3
  s_nop 1
  v_add_u32_dpp v65, v53, v2 row_newbcast:8 row_mask:0xf bank_mask:0xc
  s_waitcnt vmcnt(10)
  s_barrier
  s_add_u32 m0, s75, 131072
  s_nop 0
  buffer_load_dwordx4 v4, s[44:47], s74 offen lds
  s_add_u32 m0, s75, 132096
  s_nop 0
  buffer_load_dwordx4 v5, s[44:47], s74 offen lds
  s_add_u32 s74, s74, 106496
  s_add_u32 m0, s75, 139264
  s_nop 0
  buffer_load_dwordx4 v4, s[44:47], s74 offen lds
  s_add_u32 m0, s75, 140288
  s_nop 0
  buffer_load_dwordx4 v5, s[44:47], s74 offen lds
  s_add_u32 s74, s74, 106496
  s_add_u32 m0, s76, 40960
  s_nop 0
  buffer_load_dwordx4 v56, s[32:35], 0 offen lds
  s_add_u32 m0, s76, 43008
  v_add_u32_dpp v56, v16, v2 row_newbcast:2 row_mask:0xf bank_mask:0x3
  buffer_load_dwordx4 v57, s[32:35], 0 offen lds
  s_nop 0
  v_add_u32_dpp v56, v18, v2 row_newbcast:8 row_mask:0xf bank_mask:0xc
  s_add_u32 m0, s76, 45056
  v_add_u32_dpp v57, v20, v2 row_newbcast:2 row_mask:0xf bank_mask:0x3
  buffer_load_dwordx4 v58, s[32:35], 0 offen lds
  s_nop 0
  v_add_u32_dpp v57, v22, v2 row_newbcast:8 row_mask:0xf bank_mask:0xc
  s_add_u32 m0, s76, 47104
  v_add_u32_dpp v58, v24, v2 row_newbcast:2 row_mask:0xf bank_mask:0x3
  buffer_load_dwordx4 v59, s[32:35], 0 offen lds
  s_nop 0
  v_add_u32_dpp v58, v26, v2 row_newbcast:8 row_mask:0xf bank_mask:0xc
  s_add_u32 m0, s76, 49152
  v_add_u32_dpp v59, v28, v2 row_newbcast:2 row_mask:0xf bank_mask:0x3
  buffer_load_dwordx4 v60, s[32:35], 0 offen lds
  s_nop 0
  v_add_u32_dpp v59, v30, v2 row_newbcast:8 row_mask:0xf bank_mask:0xc
  s_add_u32 m0, s76, 51200
  v_add_u32_dpp v60, v32, v2 row_newbcast:2 row_mask:0xf bank_mask:0x3
  buffer_load_dwordx4 v61, s[32:35], 0 offen lds
  s_nop 0
  v_add_u32_dpp v60, v34, v2 row_newbcast:8 row_mask:0xf bank_mask:0xc
  s_add_u32 m0, s76, 53248
  v_add_u32_dpp v61, v36, v2 row_newbcast:2 row_mask:0xf bank_mask:0x3
  buffer_load_dwordx4 v62, s[32:35], 0 offen lds
  s_nop 0
  v_add_u32_dpp v61, v38, v2 row_newbcast:8 row_mask:0xf bank_mask:0xc
  s_add_u32 m0, s76, 55296
  v_add_u32_dpp v62, v40, v2 row_newbcast:2 row_mask:0xf bank_mask:0x3
  buffer_load_dwordx4 v63, s[32:35], 0 offen lds
  s_nop 0
  v_add_u32_dpp v62, v42, v2 row_newbcast:8 row_mask:0xf bank_mask:0xc
  s_add_u32 m0, s76, 57344
  v_add_u32_dpp v63, v44, v2 row_newbcast:2 row_mask:0xf bank_mask:0x3
  buffer_load_dwordx4 v64, s[32:35], 0 offen lds
  s_nop 0
  v_add_u32_dpp v63, v46, v2 row_newbcast:8 row_mask:0xf bank_mask:0xc
  s_add_u32 m0, s76, 59392
  v_add_u32_dpp v64, v48, v2 row_newbcast:2 row_mask:0xf bank_mask:0x3
  buffer_load_dwordx4 v65, s[32:35], 0 offen lds
  s_nop 0
  v_add_u32_dpp v64, v50, v2 row_newbcast:8 row_mask:0xf bank_mask:0xc
  v_add_u32_dpp v65, v52, v2 row_newbcast:2 row_mask:0xf bank_mask:0x3
  s_nop 1
  v_add_u32_dpp v65, v54, v2 row_newbcast:8 row_mask:0xf bank_mask:0xc
  s_waitcnt vmcnt(10)
  s_barrier
  s_add_u32 m0, s75, 147456
  s_nop 0
  buffer_load_dwordx4 v4, s[44:47], s74 offen lds
  s_add_u32 m0, s75, 148480
  s_nop 0
  buffer_load_dwordx4 v5, s[44:47], s74 offen lds
  s_add_u32 s74, s74, 106496
  s_add_u32 m0, s75, 155648
  s_nop 0
  buffer_load_dwordx4 v4, s[44:47], s74 offen lds
  s_add_u32 m0, s75, 156672
  s_nop 0
  buffer_load_dwordx4 v5, s[44:47], s74 offen lds
  s_add_u32 s74, s74, 106496
  s_add_u32 m0, s76, 81920
  s_nop 0
  buffer_load_dwordx4 v56, s[32:35], 0 offen lds
  s_add_u32 m0, s76, 83968
  v_add_u32_dpp v56, v17, v2 row_newbcast:2 row_mask:0xf bank_mask:0x3
  buffer_load_dwordx4 v57, s[32:35], 0 offen lds
  s_nop 0
  v_add_u32_dpp v56, v19, v2 row_newbcast:8 row_mask:0xf bank_mask:0xc
  s_add_u32 m0, s76, 86016
  v_add_u32_dpp v57, v21, v2 row_newbcast:2 row_mask:0xf bank_mask:0x3
  buffer_load_dwordx4 v58, s[32:35], 0 offen lds
  s_nop 0
  v_add_u32_dpp v57, v23, v2 row_newbcast:8 row_mask:0xf bank_mask:0xc
  s_add_u32 m0, s76, 88064
  v_add_u32_dpp v58, v25, v2 row_newbcast:2 row_mask:0xf bank_mask:0x3
  buffer_load_dwordx4 v59, s[32:35], 0 offen lds
  s_nop 0
  v_add_u32_dpp v58, v27, v2 row_newbcast:8 row_mask:0xf bank_mask:0xc
  s_add_u32 m0, s76, 90112
  v_add_u32_dpp v59, v29, v2 row_newbcast:2 row_mask:0xf bank_mask:0x3
  buffer_load_dwordx4 v60, s[32:35], 0 offen lds
  s_nop 0
  v_add_u32_dpp v59, v31, v2 row_newbcast:8 row_mask:0xf bank_mask:0xc
  s_add_u32 m0, s76, 92160
  v_add_u32_dpp v60, v33, v2 row_newbcast:2 row_mask:0xf bank_mask:0x3
  buffer_load_dwordx4 v61, s[32:35], 0 offen lds
  s_nop 0
  v_add_u32_dpp v60, v35, v2 row_newbcast:8 row_mask:0xf bank_mask:0xc
  s_add_u32 m0, s76, 94208
  v_add_u32_dpp v61, v37, v2 row_newbcast:2 row_mask:0xf bank_mask:0x3
  buffer_load_dwordx4 v62, s[32:35], 0 offen lds
  s_nop 0
  v_add_u32_dpp v61, v39, v2 row_newbcast:8 row_mask:0xf bank_mask:0xc
  s_add_u32 m0, s76, 96256
  v_add_u32_dpp v62, v41, v2 row_newbcast:2 row_mask:0xf bank_mask:0x3
  buffer_load_dwordx4 v63, s[32:35], 0 offen lds
  s_nop 0
  v_add_u32_dpp v62, v43, v2 row_newbcast:8 row_mask:0xf bank_mask:0xc
  s_add_u32 m0, s76, 98304
  v_add_u32_dpp v63, v45, v2 row_newbcast:2 row_mask:0xf bank_mask:0x3
  buffer_load_dwordx4 v64, s[32:35], 0 offen lds
  s_nop 0
  v_add_u32_dpp v63, v47, v2 row_newbcast:8 row_mask:0xf bank_mask:0xc
  s_add_u32 m0, s76, 100352
  v_add_u32_dpp v64, v49, v2 row_newbcast:2 row_mask:0xf bank_mask:0x3
  buffer_load_dwordx4 v65, s[32:35], 0 offen lds
  s_nop 0
  v_add_u32_dpp v64, v51, v2 row_newbcast:8 row_mask:0xf bank_mask:0xc
  v_add_u32_dpp v65, v53, v2 row_newbcast:2 row_mask:0xf bank_mask:0x3
  s_nop 1
  v_add_u32_dpp v65, v55, v2 row_newbcast:8 row_mask:0xf bank_mask:0xc
  s_waitcnt vmcnt(10)
  s_barrier
  s_add_u32 m0, s75, 131072
  s_nop 0
  buffer_load_dwordx4 v4, s[44:47], s74 offen lds
  s_add_u32 m0, s75, 132096
  s_nop 0
  buffer_load_dwordx4 v5, s[44:47], s74 offen lds
  s_add_u32 s74, s74, 106496
  s_add_u32 m0, s75, 139264
  s_nop 0
  buffer_load_dwordx4 v4, s[44:47], s74 offen lds
  s_add_u32 m0, s75, 140288
  s_nop 0
  buffer_load_dwordx4 v5, s[44:47], s74 offen lds
  s_add_u32 s74, s74, 106496
  s_add_u32 m0, s76, 0
  s_nop 0
  buffer_load_dwordx4 v56, s[32:35], 0 offen lds
  s_add_u32 m0, s76, 2048
  v_add_u32_dpp v56, v18, v2 row_newbcast:2 row_mask:0xf bank_mask:0x3
  buffer_load_dwordx4 v57, s[32:35], 0 offen lds
  s_nop 0
  v_add_u32_dpp v56, v16, v2 row_newbcast:9 row_mask:0xf bank_mask:0xc
  s_add_u32 m0, s76, 4096
  v_add_u32_dpp v57, v22, v2 row_newbcast:2 row_mask:0xf bank_mask:0x3
  buffer_load_dwordx4 v58, s[32:35], 0 offen lds
  s_nop 0
  v_add_u32_dpp v57, v20, v2 row_newbcast:9 row_mask:0xf bank_mask:0xc
  s_add_u32 m0, s76, 6144
  v_add_u32_dpp v58, v26, v2 row_newbcast:2 row_mask:0xf bank_mask:0x3
  buffer_load_dwordx4 v59, s[32:35], 0 offen lds
  s_nop 0
  v_add_u32_dpp v58, v24, v2 row_newbcast:9 row_mask:0xf bank_mask:0xc
  s_add_u32 m0, s76, 8192
  v_add_u32_dpp v59, v30, v2 row_newbcast:2 row_mask:0xf bank_mask:0x3
  buffer_load_dwordx4 v60, s[32:35], 0 offen lds
  s_nop 0
  v_add_u32_dpp v59, v28, v2 row_newbcast:9 row_mask:0xf bank_mask:0xc
  s_add_u32 m0, s76, 10240
  v_add_u32_dpp v60, v34, v2 row_newbcast:2 row_mask:0xf bank_mask:0x3
  buffer_load_dwordx4 v61, s[32:35], 0 offen lds
  s_nop 0
  v_add_u32_dpp v60, v32, v2 row_newbcast:9 row_mask:0xf bank_mask:0xc
  s_add_u32 m0, s76, 12288
  v_add_u32_dpp v61, v38, v2 row_newbcast:2 row_mask:0xf bank_mask:0x3
  buffer_load_dwordx4 v62, s[32:35], 0 offen lds
  s_nop 0
  v_add_u32_dpp v61, v36, v2 row_newbcast:9 row_mask:0xf bank_mask:0xc
  s_add_u32 m0, s76, 14336
  v_add_u32_dpp v62, v42, v2 row_newbcast:2 row_mask:0xf bank_mask:0x3
  buffer_load_dwordx4 v63, s[32:35], 0 offen lds
  s_nop 0
  v_add_u32_dpp v62, v40, v2 row_newbcast:9 row_mask:0xf bank_mask:0xc
  s_add_u32 m0, s76, 16384
  v_add_u32_dpp v63, v46, v2 row_newbcast:2 row_mask:0xf bank_mask:0x3
  buffer_load_dwordx4 v64, s[32:35], 0 offen lds
  s_nop 0
  v_add_u32_dpp v63, v44, v2 row_newbcast:9 row_mask:0xf bank_mask:0xc
  s_add_u32 m0, s76, 18432
  v_add_u32_dpp v64, v50, v2 row_newbcast:2 row_mask:0xf bank_mask:0x3
  buffer_load_dwordx4 v65, s[32:35], 0 offen lds
  s_nop 0
  v_add_u32_dpp v64, v48, v2 row_newbcast:9 row_mask:0xf bank_mask:0xc
  v_add_u32_dpp v65, v54, v2 row_newbcast:2 row_mask:0xf bank_mask:0x3
  s_nop 1
  v_add_u32_dpp v65, v52, v2 row_newbcast:9 row_mask:0xf bank_mask:0xc
  s_waitcnt vmcnt(10)
  s_barrier
  s_add_u32 m0, s75, 147456
  s_nop 0
  buffer_load_dwordx4 v4, s[44:47], s74 offen lds
  s_add_u32 m0, s75, 148480
  s_nop 0
  buffer_load_dwordx4 v5, s[44:47], s74 offen lds
  s_add_u32 s74, s74, 106496
  s_add_u32 m0, s75, 155648
  s_nop 0
  buffer_load_dwordx4 v4, s[44:47], s74 offen lds
  s_add_u32 m0, s75, 156672
  s_nop 0
  buffer_load_dwordx4 v5, s[44:47], s74 offen lds
  s_add_u32 s74, s74, 106496
  s_add_u32 m0, s76, 40960
  s_nop 0
  buffer_load_dwordx4 v56, s[32:35], 0 offen lds
  s_add_u32 m0, s76, 43008
  v_add_u32_dpp v56, v19, v2 row_newbcast:2 row_mask:0xf bank_mask:0x3
  buffer_load_dwordx4 v57, s[32:35], 0 offen lds
  s_nop 0
  v_add_u32_dpp v56, v17, v2 row_newbcast:9 row_mask:0xf bank_mask:0xc
  s_add_u32 m0, s76, 45056
  v_add_u32_dpp v57, v23, v2 row_newbcast:2 row_mask:0xf bank_mask:0x3
  buffer_load_dwordx4 v58, s[32:35], 0 offen lds
  s_nop 0
  v_add_u32_dpp v57, v21, v2 row_newbcast:9 row_mask:0xf bank_mask:0xc
  s_add_u32 m0, s76, 47104
  v_add_u32_dpp v58, v27, v2 row_newbcast:2 row_mask:0xf bank_mask:0x3
  buffer_load_dwordx4 v59, s[32:35], 0 offen lds
  s_nop 0
  v_add_u32_dpp v58, v25, v2 row_newbcast:9 row_mask:0xf bank_mask:0xc
  s_add_u32 m0, s76, 49152
  v_add_u32_dpp v59, v31, v2 row_newbcast:2 row_mask:0xf bank_mask:0x3
  buffer_load_dwordx4 v60, s[32:35], 0 offen lds
  s_nop 0
  v_add_u32_dpp v59, v29, v2 row_newbcast:9 row_mask:0xf bank_mask:0xc
  s_add_u32 m0, s76, 51200
  v_add_u32_dpp v60, v35, v2 row_newbcast:2 row_mask:0xf bank_mask:0x3
  buffer_load_dwordx4 v61, s[32:35], 0 offen lds
  s_nop 0
  v_add_u32_dpp v60, v33, v2 row_newbcast:9 row_mask:0xf bank_mask:0xc
  s_add_u32 m0, s76, 53248
  v_add_u32_dpp v61, v39, v2 row_newbcast:2 row_mask:0xf bank_mask:0x3
  buffer_load_dwordx4 v62, s[32:35], 0 offen lds
  s_nop 0
  v_add_u32_dpp v61, v37, v2 row_newbcast:9 row_mask:0xf bank_mask:0xc
  s_add_u32 m0, s76, 55296
  v_add_u32_dpp v62, v43, v2 row_newbcast:2 row_mask:0xf bank_mask:0x3
  buffer_load_dwordx4 v63, s[32:35], 0 offen lds
  s_nop 0
  v_add_u32_dpp v62, v41, v2 row_newbcast:9 row_mask:0xf bank_mask:0xc
  s_add_u32 m0, s76, 57344
  v_add_u32_dpp v63, v47, v2 row_newbcast:2 row_mask:0xf bank_mask:0x3
  buffer_load_dwordx4 v64, s[32:35], 0 offen lds
  s_nop 0
  v_add_u32_dpp v63, v45, v2 row_newbcast:9 row_mask:0xf bank_mask:0xc
  s_add_u32 m0, s76, 59392
  v_add_u32_dpp v64, v51, v2 row_newbcast:2 row_mask:0xf bank_mask:0x3
  buffer_load_dwordx4 v65, s[32:35], 0 offen lds
  s_nop 0
  v_add_u32_dpp v64, v49, v2 row_newbcast:9 row_mask:0xf bank_mask:0xc
  v_add_u32_dpp v65, v55, v2 row_newbcast:2 row_mask:0xf bank_mask:0x3
  s_nop 1
  v_add_u32_dpp v65, v53, v2 row_newbcast:9 row_mask:0xf bank_mask:0xc
  s_waitcnt vmcnt(10)
  s_cmp_lg_u32 s72, 1
  s_cbranch_scc1 L_nolpf
  s_mov_b64 exec, 1048575
  global_load_dword v10, v[8:9], off
  s_mov_b64 exec, -1
  s_mov_b32 m0, 123136
  s_mov_b64 exec, 0xffff
  buffer_load_dwordx4 v11, s[52:55], s77 offen lds
  s_mov_b64 exec, -1
L_nolpf:
  s_barrier
  s_add_u32 m0, s75, 131072
  s_nop 0
  buffer_load_dwordx4 v4, s[44:47], s74 offen lds
  s_add_u32 m0, s75, 132096
  s_nop 0
  buffer_load_dwordx4 v5, s[44:47], s74 offen lds
  s_add_u32 s74, s74, 106496
  s_add_u32 m0, s75, 139264
  s_nop 0
  buffer_load_dwordx4 v4, s[44:47], s74 offen lds
  s_add_u32 m0, s75, 140288
  s_nop 0
  buffer_load_dwordx4 v5, s[44:47], s74 offen lds
  s_add_u32 s74, s74, 106496
  s_add_u32 m0, s76, 81920
  s_nop 0
  buffer_load_dwordx4 v56, s[32:35], 0 offen lds
  s_add_u32 m0, s76, 83968
  v_add_u32_dpp v56, v16, v2 row_newbcast:3 row_mask:0xf bank_mask:0x3
  buffer_load_dwordx4 v57, s[32:35], 0 offen lds
  s_nop 0
  v_add_u32_dpp v56, v18, v2 row_newbcast:9 row_mask:0xf bank_mask:0xc
  s_add_u32 m0, s76, 86016
  v_add_u32_dpp v57, v20, v2 row_newbcast:3 row_mask:0xf bank_mask:0x3
  buffer_load_dwordx4 v58, s[32:35], 0 offen lds
  s_nop 0
  v_add_u32_dpp v57, v22, v2 row_newbcast:9 row_mask:0xf bank_mask:0xc
  s_add_u32 m0, s76, 88064
  v_add_u32_dpp v58, v24, v2 row_newbcast:3 row_mask:0xf bank_mask:0x3
  buffer_load_dwordx4 v59, s[32:35], 0 offen lds
  s_nop 0
  v_add_u32_dpp v58, v26, v2 row_newbcast:9 row_mask:0xf bank_mask:0xc
  s_add_u32 m0, s76, 90112
  v_add_u32_dpp v59, v28, v2 row_newbcast:3 row_mask:0xf bank_mask:0x3
  buffer_load_dwordx4 v60, s[32:35], 0 offen lds
  s_nop 0
  v_add_u32_dpp v59, v30, v2 row_newbcast:9 row_mask:0xf bank_mask:0xc
  s_add_u32 m0, s76, 92160
  v_add_u32_dpp v60, v32, v2 row_newbcast:3 row_mask:0xf bank_mask:0x3
  buffer_load_dwordx4 v61, s[32:35], 0 offen lds
  s_nop 0
  v_add_u32_dpp v60, v34, v2 row_newbcast:9 row_mask:0xf bank_mask:0xc
  s_add_u32 m0, s76, 94208
  v_add_u32_dpp v61, v36, v2 row_newbcast:3 row_mask:0xf bank_mask:0x3
  buffer_load_dwordx4 v62, s[32:35], 0 offen lds
  s_nop 0
  v_add_u32_dpp v61, v38, v2 row_newbcast:9 row_mask:0xf bank_mask:0xc
  s_add_u32 m0, s76, 96256
  v_add_u32_dpp v62, v40, v2 row_newbcast:3 row_mask:0xf bank_mask:0x3
  buffer_load_dwordx4 v63, s[32:35], 0 offen lds
  s_nop 0
  v_add_u32_dpp v62, v42, v2 row_newbcast:9 row_mask:0xf bank_mask:0xc
  s_add_u32 m0, s76, 98304
  v_add_u32_dpp v63, v44, v2 row_newbcast:3 row_mask:0xf bank_mask:0x3
  buffer_load_dwordx4 v64, s[32:35], 0 offen lds
  s_nop 0
  v_add_u32_dpp v63, v46, v2 row_newbcast:9 row_mask:0xf bank_mask:0xc
  s_add_u32 m0, s76, 100352
  v_add_u32_dpp v64, v48, v2 row_newbcast:3 row_mask:0xf bank_mask:0x3
  buffer_load_dwordx4 v65, s[32:35], 0 offen lds
  s_nop 0
  v_add_u32_dpp v64, v50, v2 row_newbcast:9 row_mask:0xf bank_mask:0xc
  v_add_u32_dpp v65, v52, v2 row_newbcast:3 row_mask:0xf bank_mask:0x3
  s_nop 1
  v_add_u32_dpp v65, v54, v2 row_newbcast:9 row_mask:0xf bank_mask:0xc
  s_waitcnt vmcnt(10)
  s_barrier
  s_add_u32 m0, s75, 147456
  s_nop 0
  buffer_load_dwordx4 v4, s[44:47], s74 offen lds
  s_add_u32 m0, s75, 148480
  s_nop 0
  buffer_load_dwordx4 v5, s[44:47], s74 offen lds
  s_add_u32 s74, s74, 106496
  s_add_u32 m0, s75, 155648
  s_nop 0
  buffer_load_dwordx4 v4, s[44:47], s74 offen lds
  s_add_u32 m0, s75, 156672
  s_nop 0
  buffer_load_dwordx4 v5, s[44:47], s74 offen lds
  s_add_u32 s74, s74, 106496
  s_add_u32 m0, s76, 0
  s_nop 0
  buffer_load_dwordx4 v56, s[32:35], 0 offen lds
  s_add_u32 m0, s76, 2048
  v_add_u32_dpp v56, v17, v2 row_newbcast:3 row_mask:0xf bank_mask:0x3
  buffer_load_dwordx4 v57, s[32:35], 0 offen lds
  s_nop 0
  v_add_u32_dpp v56, v19, v2 row_newbcast:9 row_mask:0xf bank_mask:0xc
  s_add_u32 m0, s76, 4096
  v_add_u32_dpp v57, v21, v2 row_newbcast:3 row_mask:0xf bank_mask:0x3
  buffer_load_dwordx4 v58, s[32:35], 0 offen lds
  s_nop 0
  v_add_u32_dpp v57, v23, v2 row_newbcast:9 row_mask:0xf bank_mask:0xc
  s_add_u32 m0, s76, 6144
  v_add_u32_dpp v58, v25, v2 row_newbcast:3 row_mask:0xf bank_mask:0x3
  buffer_load_dwordx4 v59, s[32:35], 0 offen lds
  s_nop 0
  v_add_u32_dpp v58, v27, v2 row_newbcast:9 row_mask:0xf bank_mask:0xc
  s_add_u32 m0, s76, 8192
  v_add_u32_dpp v59, v29, v2 row_newbcast:3 row_mask:0xf bank_mask:0x3
  buffer_load_dwordx4 v60, s[32:35], 0 offen lds
  s_nop 0
  v_add_u32_dpp v59, v31, v2 row_newbcast:9 row_mask:0xf bank_mask:0xc
  s_add_u32 m0, s76, 10240
  v_add_u32_dpp v60, v33, v2 row_newbcast:3 row_mask:0xf bank_mask:0x3
  buffer_load_dwordx4 v61, s[32:35], 0 offen lds
  s_nop 0
  v_add_u32_dpp v60, v35, v2 row_newbcast:9 row_mask:0xf bank_mask:0xc
  s_add_u32 m0, s76, 12288
  v_add_u32_dpp v61, v37, v2 row_newbcast:3 row_mask:0xf bank_mask:0x3
  buffer_load_dwordx4 v62, s[32:35], 0 offen lds
  s_nop 0
  v_add_u32_dpp v61, v39, v2 row_newbcast:9 row_mask:0xf bank_mask:0xc
  s_add_u32 m0, s76, 14336
  v_add_u32_dpp v62, v41, v2 row_newbcast:3 row_mask:0xf bank_mask:0x3
  buffer_load_dwordx4 v63, s[32:35], 0 offen lds
  s_nop 0
  v_add_u32_dpp v62, v43, v2 row_newbcast:9 row_mask:0xf bank_mask:0xc
  s_add_u32 m0, s76, 16384
  v_add_u32_dpp v63, v45, v2 row_newbcast:3 row_mask:0xf bank_mask:0x3
  buffer_load_dwordx4 v64, s[32:35], 0 offen lds
  s_nop 0
  v_add_u32_dpp v63, v47, v2 row_newbcast:9 row_mask:0xf bank_mask:0xc
  s_add_u32 m0, s76, 18432
  v_add_u32_dpp v64, v49, v2 row_newbcast:3 row_mask:0xf bank_mask:0x3
  buffer_load_dwordx4 v65, s[32:35], 0 offen lds
  s_nop 0
  v_add_u32_dpp v64, v51, v2 row_newbcast:9 row_mask:0xf bank_mask:0xc
  v_add_u32_dpp v65, v53, v2 row_newbcast:3 row_mask:0xf bank_mask:0x3
  s_nop 1
  v_add_u32_dpp v65, v55, v2 row_newbcast:9 row_mask:0xf bank_mask:0xc
  s_waitcnt vmcnt(10)
  s_barrier
  s_add_u32 m0, s75, 131072
  s_nop 0
  buffer_load_dwordx4 v4, s[44:47], s74 offen lds
  s_add_u32 m0, s75, 132096
  s_nop 0
  buffer_load_dwordx4 v5, s[44:47], s74 offen lds
  s_add_u32 s74, s74, 106496
  s_add_u32 m0, s75, 139264
  s_nop 0
  buffer_load_dwordx4 v4, s[44:47], s74 offen lds
  s_add_u32 m0, s75, 140288
  s_nop 0
  buffer_load_dwordx4 v5, s[44:47], s74 offen lds
  s_add_u32 s74, s74, 106496
  s_add_u32 m0, s76, 40960
  s_nop 0
  buffer_load_dwordx4 v56, s[32:35], 0 offen lds
  s_add_u32 m0, s76, 43008
  v_add_u32_dpp v56, v18, v2 row_newbcast:3 row_mask:0xf bank_mask:0x3
  buffer_load_dwordx4 v57, s[32:35], 0 offen lds
  s_nop 0
  v_add_u32_dpp v56, v16, v2 row_newbcast:10 row_mask:0xf bank_mask:0xc
  s_add_u32 m0, s76, 45056
  v_add_u32_dpp v57, v22, v2 row_newbcast:3 row_mask:0xf bank_mask:0x3
  buffer_load_dwordx4 v58, s[32:35], 0 offen lds
  s_nop 0
  v_add_u32_dpp v57, v20, v2 row_newbcast:10 row_mask:0xf bank_mask:0xc
  s_add_u32 m0, s76, 47104
  v_add_u32_dpp v58, v26, v2 row_newbcast:3 row_mask:0xf bank_mask:0x3
  buffer_load_dwordx4 v59, s[32:35], 0 offen lds
  s_nop 0
  v_add_u32_dpp v58, v24, v2 row_newbcast:10 row_mask:0xf bank_mask:0xc
  s_add_u32 m0, s76, 49152
  v_add_u32_dpp v59, v30, v2 row_newbcast:3 row_mask:0xf bank_mask:0x3
  buffer_load_dwordx4 v60, s[32:35], 0 offen lds
  s_nop 0
  v_add_u32_dpp v59, v28, v2 row_newbcast:10 row_mask:0xf bank_mask:0xc
  s_add_u32 m0, s76, 51200
  v_add_u32_dpp v60, v34, v2 row_newbcast:3 row_mask:0xf bank_mask:0x3
  buffer_load_dwordx4 v61, s[32:35], 0 offen lds
  s_nop 0
  v_add_u32_dpp v60, v32, v2 row_newbcast:10 row_mask:0xf bank_mask:0xc
  s_add_u32 m0, s76, 53248
  v_add_u32_dpp v61, v38, v2 row_newbcast:3 row_mask:0xf bank_mask:0x3
  buffer_load_dwordx4 v62, s[32:35], 0 offen lds
  s_nop 0
  v_add_u32_dpp v61, v36, v2 row_newbcast:10 row_mask:0xf bank_mask:0xc
  s_add_u32 m0, s76, 55296
  v_add_u32_dpp v62, v42, v2 row_newbcast:3 row_mask:0xf bank_mask:0x3
  buffer_load_dwordx4 v63, s[32:35], 0 offen lds
  s_nop 0
  v_add_u32_dpp v62, v40, v2 row_newbcast:10 row_mask:0xf bank_mask:0xc
  s_add_u32 m0, s76, 57344
  v_add_u32_dpp v63, v46, v2 row_newbcast:3 row_mask:0xf bank_mask:0x3
  buffer_load_dwordx4 v64, s[32:35], 0 offen lds
  s_nop 0
  v_add_u32_dpp v63, v44, v2 row_newbcast:10 row_mask:0xf bank_mask:0xc
  s_add_u32 m0, s76, 59392
  v_add_u32_dpp v64, v50, v2 row_newbcast:3 row_mask:0xf bank_mask:0x3
  buffer_load_dwordx4 v65, s[32:35], 0 offen lds
  s_nop 0
  v_add_u32_dpp v64, v48, v2 row_newbcast:10 row_mask:0xf bank_mask:0xc
  v_add_u32_dpp v65, v54, v2 row_newbcast:3 row_mask:0xf bank_mask:0x3
  s_nop 1
  v_add_u32_dpp v65, v52, v2 row_newbcast:10 row_mask:0xf bank_mask:0xc
  v_mov_b32_dpp v16, v16 row_shl:3 row_mask:0xf bank_mask:0xf
  v_mov_b32_dpp v18, v18 row_shl:3 row_mask:0xf bank_mask:0xf
  v_mov_b32_dpp v20, v20 row_shl:3 row_mask:0xf bank_mask:0xf
  v_mov_b32_dpp v22, v22 row_shl:3 row_mask:0xf bank_mask:0xf
  v_mov_b32_dpp v24, v24 row_shl:3 row_mask:0xf bank_mask:0xf
  v_mov_b32_dpp v26, v26 row_shl:3 row_mask:0xf bank_mask:0xf
  v_mov_b32_dpp v28, v28 row_shl:3 row_mask:0xf bank_mask:0xf
  v_mov_b32_dpp v30, v30 row_shl:3 row_mask:0xf bank_mask:0xf
  v_mov_b32_dpp v32, v32 row_shl:3 row_mask:0xf bank_mask:0xf
  v_mov_b32_dpp v34, v34 row_shl:3 row_mask:0xf bank_mask:0xf
  v_mov_b32_dpp v36, v36 row_shl:3 row_mask:0xf bank_mask:0xf
  v_mov_b32_dpp v38, v38 row_shl:3 row_mask:0xf bank_mask:0xf
  v_mov_b32_dpp v40, v40 row_shl:3 row_mask:0xf bank_mask:0xf
  v_mov_b32_dpp v42, v42 row_shl:3 row_mask:0xf bank_mask:0xf
  v_mov_b32_dpp v44, v44 row_shl:3 row_mask:0xf bank_mask:0xf
  v_mov_b32_dpp v46, v46 row_shl:3 row_mask:0xf bank_mask:0xf
  v_mov_b32_dpp v48, v48 row_shl:3 row_mask:0xf bank_mask:0xf
  v_mov_b32_dpp v50, v50 row_shl:3 row_mask:0xf bank_mask:0xf
  v_mov_b32_dpp v52, v52 row_shl:3 row_mask:0xf bank_mask:0xf
  v_mov_b32_dpp v54, v54 row_shl:3 row_mask:0xf bank_mask:0xf
  s_waitcnt vmcnt(10)
  s_barrier
  s_add_u32 m0, s75, 147456
  s_nop 0
  buffer_load_dwordx4 v4, s[44:47], s74 offen lds
  s_add_u32 m0, s75, 148480
  s_nop 0
  buffer_load_dwordx4 v5, s[44:47], s74 offen lds
  s_add_u32 s74, s74, 106496
  s_add_u32 m0, s75, 155648
  s_nop 0
  buffer_load_dwordx4 v4, s[44:47], s74 offen lds
  s_add_u32 m0, s75, 156672
  s_nop 0
  buffer_load_dwordx4 v5, s[44:47], s74 offen lds
  s_add_u32 s74, s74, 106496
  s_add_u32 m0, s76, 81920
  s_nop 0
  buffer_load_dwordx4 v56, s[32:35], 0 offen lds
  s_add_u32 m0, s76, 83968
  v_add_u32_dpp v56, v19, v2 row_newbcast:3 row_mask:0xf bank_mask:0x3
  buffer_load_dwordx4 v57, s[32:35], 0 offen lds
  s_nop 0
  v_add_u32_dpp v56, v17, v2 row_newbcast:10 row_mask:0xf bank_mask:0xc
  s_add_u32 m0, s76, 86016
  v_add_u32_dpp v57, v23, v2 row_newbcast:3 row_mask:0xf bank_mask:0x3
  buffer_load_dwordx4 v58, s[32:35], 0 offen lds
  s_nop 0
  v_add_u32_dpp v57, v21, v2 row_newbcast:10 row_mask:0xf bank_mask:0xc
  s_add_u32 m0, s76, 88064
  v_add_u32_dpp v58, v27, v2 row_newbcast:3 row_mask:0xf bank_mask:0x3
  buffer_load_dwordx4 v59, s[32:35], 0 offen lds
  s_nop 0
  v_add_u32_dpp v58, v25, v2 row_newbcast:10 row_mask:0xf bank_mask:0xc
  s_add_u32 m0, s76, 90112
  v_add_u32_dpp v59, v31, v2 row_newbcast:3 row_mask:0xf bank_mask:0x3
  buffer_load_dwordx4 v60, s[32:35], 0 offen lds
  s_nop 0
  v_add_u32_dpp v59, v29, v2 row_newbcast:10 row_mask:0xf bank_mask:0xc
  s_add_u32 m0, s76, 92160
  v_add_u32_dpp v60, v35, v2 row_newbcast:3 row_mask:0xf bank_mask:0x3
  buffer_load_dwordx4 v61, s[32:35], 0 offen lds
  s_nop 0
  v_add_u32_dpp v60, v33, v2 row_newbcast:10 row_mask:0xf bank_mask:0xc
  s_add_u32 m0, s76, 94208
  v_add_u32_dpp v61, v39, v2 row_newbcast:3 row_mask:0xf bank_mask:0x3
  buffer_load_dwordx4 v62, s[32:35], 0 offen lds
  s_nop 0
  v_add_u32_dpp v61, v37, v2 row_newbcast:10 row_mask:0xf bank_mask:0xc
  s_add_u32 m0, s76, 96256
  v_add_u32_dpp v62, v43, v2 row_newbcast:3 row_mask:0xf bank_mask:0x3
  buffer_load_dwordx4 v63, s[32:35], 0 offen lds
  s_nop 0
  v_add_u32_dpp v62, v41, v2 row_newbcast:10 row_mask:0xf bank_mask:0xc
  s_add_u32 m0, s76, 98304
  v_add_u32_dpp v63, v47, v2 row_newbcast:3 row_mask:0xf bank_mask:0x3
  buffer_load_dwordx4 v64, s[32:35], 0 offen lds
  s_nop 0
  v_add_u32_dpp v63, v45, v2 row_newbcast:10 row_mask:0xf bank_mask:0xc
  s_add_u32 m0, s76, 100352
  v_add_u32_dpp v64, v51, v2 row_newbcast:3 row_mask:0xf bank_mask:0x3
  buffer_load_dwordx4 v65, s[32:35], 0 offen lds
  s_nop 0
  v_add_u32_dpp v64, v49, v2 row_newbcast:10 row_mask:0xf bank_mask:0xc
  v_add_u32_dpp v65, v55, v2 row_newbcast:3 row_mask:0xf bank_mask:0x3
  s_nop 1
  v_add_u32_dpp v65, v53, v2 row_newbcast:10 row_mask:0xf bank_mask:0xc
  v_mov_b32_dpp v17, v17 row_shl:3 row_mask:0xf bank_mask:0xf
  v_mov_b32_dpp v19, v19 row_shl:3 row_mask:0xf bank_mask:0xf
  v_mov_b32_dpp v21, v21 row_shl:3 row_mask:0xf bank_mask:0xf
  v_mov_b32_dpp v23, v23 row_shl:3 row_mask:0xf bank_mask:0xf
  v_mov_b32_dpp v25, v25 row_shl:3 row_mask:0xf bank_mask:0xf
  v_mov_b32_dpp v27, v27 row_shl:3 row_mask:0xf bank_mask:0xf
  v_mov_b32_dpp v29, v29 row_shl:3 row_mask:0xf bank_mask:0xf
  v_mov_b32_dpp v31, v31 row_shl:3 row_mask:0xf bank_mask:0xf
  v_mov_b32_dpp v33, v33 row_shl:3 row_mask:0xf bank_mask:0xf
  v_mov_b32_dpp v35, v35 row_shl:3 row_mask:0xf bank_mask:0xf
  v_mov_b32_dpp v37, v37 row_shl:3 row_mask:0xf bank_mask:0xf
  v_mov_b32_dpp v39, v39 row_shl:3 row_mask:0xf bank_mask:0xf
  v_mov_b32_dpp v41, v41 row_shl:3 row_mask:0xf bank_mask:0xf
  v_mov_b32_dpp v43, v43 row_shl:3 row_mask:0xf bank_mask:0xf
  v_mov_b32_dpp v45, v45 row_shl:3 row_mask:0xf bank_mask:0xf
  v_mov_b32_dpp v47, v47 row_shl:3 row_mask:0xf bank_mask:0xf
  v_mov_b32_dpp v49, v49 row_shl:3 row_mask:0xf bank_mask:0xf
  v_mov_b32_dpp v51, v51 row_shl:3 row_mask:0xf bank_mask:0xf
  v_mov_b32_dpp v53, v53 row_shl:3 row_mask:0xf bank_mask:0xf
  v_mov_b32_dpp v55, v55 row_shl:3 row_mask:0xf bank_mask:0xf
  s_add_u32 s72, s72, 1
  s_cmp_lt_u32 s72, 2
  s_waitcnt vmcnt(10)
  s_cbranch_scc1 L_dnn_loop1
  s_branch L_ld_tail
L_cin:
  v_lshlrev_b32 v1, 4, v0
  s_and_b32 s79, s3, 3
  s_lshr_b32 s84, s3, 2
  s_lshl_b32 s95, s79, 10
  s_mul_i32 s26, s68, 11
  s_add_u32 s26, s26, s69
  s_sub_u32 s26, s26, 22
  s_cmp_eq_u32 s26, 86
  s_cbranch_scc1 L_end
  s_cmp_eq_u32 s84, 0
  s_cbranch_scc1 L_sc
  s_setprio 2
  v_add_u32 v2, L_tables-L_pc+4096, v1
  v_mov_b32 v3, s93
  v_add_co_u32 v2, vcc, s92, v2
  s_nop 1
  v_addc_co_u32 v3, vcc, 0, v3, vcc
  v_add_co_u32 v32, vcc, s95, v2
  s_nop 1
  v_addc_co_u32 v33, vcc, 0, v3, vcc
  global_load_dwordx4 v[224:227], v[2:3], off offset:-4096
  v_add_co_u32 v2, vcc, 0x1800, v2
  s_nop 1
  v_addc_co_u32 v3, vcc, 0, v3, vcc
  global_load_dwordx4 v[240:243], v[2:3], off
  s_cmp_lt_u32 s79, 3
  s_mov_b32 s70, 122176
  s_cselect_b32 s70, 81920, s70
  s_add_u32 m0, s95, 81920
  s_nop 0
  global_load_lds_dwordx4 v[32:33], off offset:-4096
  s_add_u32 m0, s95, s70
  s_nop 0
  global_load_lds_dwordx4 v[32:33], off offset:0
  v_add_co_u32 v32, vcc, 0x2000, v32
  s_nop 1
  v_addc_co_u32 v33, vcc, 0, v33, vcc
  s_add_u32 m0, s95, 2048
  s_nop 0
  global_load_lds_dwordx4 v[32:33], off offset:0
  s_add_u32 m0, s95, 130368
  s_cmp_ge_u32 s79, 2
  s_cbranch_scc1 L_sc
  global_load_lds_dwordx4 v[32:33], off offset:-4096
L_sc:
  s_mul_i32 s85, s84, 20
  s_add_u32 s85, s85, s3
  s_mul_i32 s94, s26, 48
  s_add_u32 s94, s94, s85
  s_mul_i32 s94, s94, 104
  v_lshrrev_b32 v30, 3, v0
  v_lshlrev_b32 v30, 4, v30
  v_and_b32 v29, 0x70, v1
  s_mul_i32 s76, s3, 4064
  s_add_u32 s76, s76, 131136
  s_cmp_eq_u32 s84, 0
  s_cbranch_scc1 L_g0
  s_waitcnt lgkmcnt(0)
  s_mov_b32 s40, s10
  s_and_b32 s41, s11, 0xffff
  s_mov_b32 s42, 156
  s_mov_b32 s43, 0x20000
  s_mov_b32 m0, 129472
  s_mov_b64 exec, 0x7ff
  buffer_load_dwordx4 v1, s[40:43], 0 offen lds
  s_mov_b64 exec, -1
  s_lshl_b32 s85, s85, 2
  s_add_u32 s85, s85, 129728
  s_mul_i32 s72, s84, 3
  s_sub_u32 s72, 4, s72
  s_cmp_eq_u32 s26, 85
  s_cselect_b32 s72, s72, 6
  s_lshl_b32 s44, s3, 7
  s_mul_i32 s45, s3, 5280
  s_lshl_b32 s46, s3, 2
  s_lshl_b32 s47, s3, 1
  s_lshl_b32 s82, s3, 12
  s_and_b32 s98, s3, 1
  s_lshr_b32 s99, s3, 1
  s_mul_i32 s68, s99, 3072
  s_lshl_b32 s83, s98, 3
  s_add_u32 s68, s68, s83
  v_add_u32_e64 v59, s68, v1
  s_lshl_b32 s69, s99, 3
  s_lshr_b32 s69, 0x05030200, s69
  s_and_b32 s69, s69, 0xff
  s_lshl_b32 s69, s69, 9
  s_lshl_b32 s70, s98, 2
  s_add_u32 s101, s69, s70
  s_mov_b32 s99, 0x05040100
  s_mov_b32 s100, 0x07060302
  v_mov_b32 v2, 129664
  v_mov_b32 v109, 0
  v_mov_b32 v108, 0
  v_mov_b64 v[32:33], 0
  v_mov_b64 v[34:35], 0
  v_mov_b64 v[36:37], 0
  v_mov_b64 v[38:39], 0
  v_mov_b64 v[40:41], 0
  v_mov_b64 v[42:43], 0
  v_mov_b64 v[44:45], 0
  v_mov_b64 v[46:47], 0
  v_mov_b64 v[48:49], 0
  v_mov_b64 v[50:51], 0
  v_mov_b64 v[52:53], 0
  v_mov_b64 v[54:55], 0
  v_mov_b64 v[56:57], 0
  v_add_u32 v250, 77824, v1
  s_waitcnt vmcnt(6)
  v_add_u32 v251, 125248, v1
  v_lshrrev_b32 v3, 5, v0
  v_lshl_add_u32 v3, v3, 2, v2
  s_mov_b32 s28, s4
  s_and_b32 s29, s5, 0xffff
  s_mov_b32 s30, 425984
  s_mov_b32 s31, 0x20000
  s_mov_b32 s32, s6
  s_and_b32 s33, s7, 0xffff
  s_mov_b32 s34, 12800000
  s_mov_b32 s35, 0x20000
  ds_write_b128 v2, v[32:35] offset:16
  s_lshl_b32 s68, s79, 6
  v_add_u32 v29, s68, v0
  v_mul_u32_u24 v30, 2521, v29
  v_lshrrev_b32 v30, 16, v30
  v_mul_u32_u24_e64 v30, 12, v30
  v_lshl_add_u32 v28, v29, 1, v30
  v_add_u32 v29, 256, v29
  v_mul_u32_u24 v30, 2521, v29
  v_lshrrev_b32 v30, 16, v30
  v_mul_u32_u24 v30, 12, v30
  v_lshl_add_u32 v58, v29, 1, v30
  v_add_u32 v29, 256, v29
  v_mul_u32_u24 v30, 2521, v29
  v_lshrrev_b32 v30, 16, v30
  v_mul_u32_u24 v30, 12, v30
  v_lshl_add_u32 v111, v29, 1, v30
  v_cmp_gt_u32 vcc, 676, v29
  s_nop 0
  s_mov_b64 s[92:93], vcc
  v_lshlrev_b32_e64 v29, 3, v0
  s_mov_b32 exec_hi, 0xffff
  ds_write_b64 v29, v[32:33] offset:1664
  s_mov_b32 exec_hi, -1
  s_waitcnt vmcnt(4)
  ds_write_b32 v243, v32
  ds_write_b32 v243, v32 offset:43328
  s_waitcnt vmcnt(0)
  ds_read_b64 v[112:113], v240 offset:0
  ds_read_b64 v[114:115], v240 offset:8
  ds_read_b64 v[116:117], v240 offset:32
  ds_read_b64 v[118:119], v240 offset:40
  ds_read_u16 v110, v241
  s_mov_b64 exec, 0x3ffffff
  s_waitcnt lgkmcnt(0)
  ds_write_b16 v242, v110
  v_lshlrev_b32 v109, 17, v110
  v_lshrrev_b32 v109, 1, v109
  s_mov_b64 exec, -1
  v_add_u32 v225, s44, v225
  v_add_u32 v226, s44, v226
  v_add_u32 v227, s44, v227
  s_waitcnt lgkmcnt(0)
  s_barrier
  ds_read_b64_tr_b16 v[60:61], v225 offset:35328
  ds_read_b64_tr_b16 v[62:63], v225 offset:40736
  ds_read_b64_tr_b16 v[64:65], v226 offset:35328
  ds_read_b64_tr_b16 v[66:67], v227 offset:35328
  ds_read_b64_tr_b16 v[68:69], v225 offset:35392
  ds_read_b64_tr_b16 v[70:71], v225 offset:40800
  ds_read_b64_tr_b16 v[72:73], v226 offset:35392
  ds_read_b64_tr_b16 v[74:75], v227 offset:35392
  ds_read_b64_tr_b16 v[76:77], v225 offset:35840
  ds_read_b64_tr_b16 v[78:79], v225 offset:41248
  ds_read_b64_tr_b16 v[80:81], v226 offset:35840
  ds_read_b64_tr_b16 v[82:83], v227 offset:35840
  ds_read_b64_tr_b16 v[84:85], v225 offset:35904
  ds_read_b64_tr_b16 v[86:87], v225 offset:41312
  ds_read_b64_tr_b16 v[88:89], v226 offset:35904
  ds_read_b64_tr_b16 v[90:91], v227 offset:35904
  s_waitcnt lgkmcnt(14)
  v_mfma_f32_32x32x16_bf16 v[120:135], v[112:115], v[60:63], 0
  s_waitcnt lgkmcnt(12)
  v_mfma_f32_32x32x16_bf16 v[120:135], v[116:119], v[64:67], v[120:135]
  ds_read_b64_tr_b16 v[92:93], v225 offset:36352
  ds_read_b64_tr_b16 v[94:95], v225 offset:41760
  ds_read_b64_tr_b16 v[96:97], v226 offset:36352
  ds_read_b64_tr_b16 v[98:99], v227 offset:36352
  s_waitcnt lgkmcnt(14)
  v_mfma_f32_32x32x16_bf16 v[136:151], v[112:115], v[68:71], 0
  s_waitcnt lgkmcnt(12)
  v_mfma_f32_32x32x16_bf16 v[136:151], v[116:119], v[72:75], v[136:151]
  ds_read_b64_tr_b16 v[100:101], v225 offset:36416
  ds_read_b64_tr_b16 v[102:103], v225 offset:41824
  ds_read_b64_tr_b16 v[104:105], v226 offset:36416
  ds_read_b64_tr_b16 v[106:107], v227 offset:36416
  s_waitcnt lgkmcnt(14)
  v_mfma_f32_32x32x16_bf16 v[152:167], v[112:115], v[76:79], 0
  s_waitcnt lgkmcnt(12)
  v_mfma_f32_32x32x16_bf16 v[152:167], v[116:119], v[80:83], v[152:167]
  s_waitcnt lgkmcnt(10)
  v_mfma_f32_32x32x16_bf16 v[168:183], v[112:115], v[84:87], 0
  s_waitcnt lgkmcnt(8)
  v_mfma_f32_32x32x16_bf16 v[168:183], v[116:119], v[88:91], v[168:183]
  ds_read_b128 v[228:231], v250 offset:6144
  ds_read_b128 v[232:235], v251 offset:0
  ds_read_b128 v[4:7], v250 offset:3072
  ds_read_b128 v[8:11], v251 offset:2048
  ds_read_b128 v[20:23], v250 offset:1024
  ds_read_b128 v[24:27], v250 offset:2048
  ds_read_b128 v[216:219], v250 offset:4096
  ds_read_b128 v[220:223], v250 offset:5120
  ds_read_b128 v[236:239], v251 offset:1024
  s_waitcnt lgkmcnt(14)
  v_mfma_f32_32x32x16_bf16 v[184:199], v[112:115], v[92:95], 0
  s_waitcnt lgkmcnt(13)
  v_mfma_f32_32x32x16_bf16 v[184:199], v[116:119], v[96:99], v[184:199]
  s_waitcnt lgkmcnt(11)
  v_mfma_f32_32x32x16_bf16 v[200:215], v[112:115], v[100:103], 0
  s_waitcnt lgkmcnt(9)
  v_mfma_f32_32x32x16_bf16 v[200:215], v[116:119], v[104:107], v[200:215]
  s_waitcnt lgkmcnt(8)
  v_add_u32 v228, s46, v228
  v_add_u32 v229, s46, v229
  v_add_u32 v231, s83, v231
  v_add_u32 v230, s101, v230
  s_waitcnt lgkmcnt(7)
  v_mad_u32_u24 v232, v233, s3, v232
  v_add_u32 v234, s47, v234
  v_mad_u32_u24 v233, v233, 8, v232
  v_add_u32 v246, s82, v235
  v_add_u32 v247, 2048, v246
  v_add_u32 v31, 0, v234
  v_and_b32 v31, 3, v31
  v_lshl_add_u32 v244, v31, 4, v232
  v_add_u32 v31, 1, v234
  v_and_b32 v31, 3, v31
  v_lshl_add_u32 v245, v31, 4, v232
  v_add_u32 v245, 1664, v245
  v_add_u32 v31, 0, v234
  v_and_b32 v31, 3, v31
  v_lshl_add_u32 v248, v31, 4, v233
  v_add_u32 v31, 1, v234
  v_and_b32 v31, 3, v31
  v_lshl_add_u32 v249, v31, 4, v233
  v_add_u32 v249, 1664, v249
  s_waitcnt lgkmcnt(5)
  v_add_u32 v10, s76, v10
  v_add_u32 v4, s76, v4
  v_add_u32 v5, s76, v5
  ds_write_b32 v10, v7 offset:2880
  v_add_u32 v11, s45, v11
  s_waitcnt lgkmcnt(5)
  v_add_u32 v20, s45, v20
  v_add_u32 v21, s45, v21
  v_add_u32 v22, s45, v22
  v_add_u32 v23, s45, v23
  s_waitcnt lgkmcnt(4)
  v_add_u32 v24, s45, v24
  v_add_u32 v25, s45, v25
  v_add_u32 v26, s45, v26
  v_add_u32 v27, s45, v27
  s_mov_b32 exec_lo, 0
  v_mov_b32 v120, v136
  s_mov_b32 exec_lo, -1
  v_cvt_pk_bf16_f32 v60, 0, v120
  ds_write_b16_d16_hi v28, v60
  v_max_f32 v108, |v60|, v108
  s_mov_b32 exec_lo, 0
  v_mov_b32_e64 v152, v168
  s_mov_b32 exec_lo, -1
  v_cvt_pk_bf16_f32 v61, 0, v152
  ds_write_b16_d16_hi v58, v61
  v_max_f32 v108, |v61|, v108
  s_mov_b32 exec_lo, 0
  v_mov_b32 v184, v200
  s_mov_b32 exec_lo, -1
  v_cvt_pk_bf16_f32 v62, 0, v184
  s_mov_b64 exec, s[92:93]
  ds_write_b16_d16_hi v111, v62
  v_max_f32 v108, |v62|, v108
  s_mov_b64 exec, -1
  s_nop 0
  v_permlane32_swap_b32 v108, v109
  v_max_u32 v108, v108, v109
  s_nop 1
  v_max_u32_dpp v108, v108, v108 row_shr:1 row_mask:0xf bank_mask:0xf
  s_nop 1
  v_max_u32_dpp v108, v108, v108 row_shr:2 row_mask:0xf bank_mask:0xf
  s_nop 1
  v_max_u32_dpp v108, v108, v108 row_shr:4 row_mask:0xf bank_mask:0xf
  s_nop 1
  v_max_u32_dpp v108, v108, v108 row_shr:8 row_mask:0xf bank_mask:0xf
  s_nop 1
  v_max_u32_dpp v108, v108, v108 row_bcast:15 row_mask:0xa bank_mask:0xf
  s_mov_b32 exec_lo, 0x80000000
  s_mov_b32 exec_hi, 0x80000000
  ds_max_u32 v3, v108 offset:24
  s_mov_b64 exec, -1
  s_setprio 0
  s_waitcnt lgkmcnt(0)
  s_barrier
  s_branch L_w2
L_g0:
  s_waitcnt lgkmcnt(0)
  s_mov_b32 s36, s8
  s_and_b32 s37, s9, 0xffff
  s_mov_b32 s38, 105456
  s_mov_b32 s39, 0x20000
  s_add_u32 m0, s95, 41984
  s_add_u32 s81, s95, 70304
  buffer_load_dwordx4 v1, s[36:39], s81 offen lds
  s_add_u32 m0, s95, 46080
  s_add_u32 s81, s95, 74400
  buffer_load_dwordx4 v1, s[36:39], s81 offen lds
  s_add_u32 m0, s95, 50176
  s_add_u32 s81, s95, 78496
  buffer_load_dwordx4 v1, s[36:39], s81 offen lds
  s_add_u32 m0, s95, 54272
  s_add_u32 s81, s95, 82592
  buffer_load_dwordx4 v1, s[36:39], s81 offen lds
  s_add_u32 m0, s95, 58368
  s_add_u32 s81, s95, 86688
  buffer_load_dwordx4 v1, s[36:39], s81 offen lds
  s_add_u32 m0, s95, 62464
  s_add_u32 s81, s95, 90784
  buffer_load_dwordx4 v1, s[36:39], s81 offen lds
  s_add_u32 m0, s95, 66560
  s_add_u32 s81, s95, 94880
  buffer_load_dwordx4 v1, s[36:39], s81 offen lds
  s_add_u32 m0, s95, 70656
  s_add_u32 s81, s95, 98976
  buffer_load_dwordx4 v1, s[36:39], s81 offen lds
  s_cmp_eq_u32 s79, 3
  s_cbranch_scc1 L_st3
  s_add_u32 m0, s95, 74752
  s_add_u32 s81, s95, 103072
  buffer_load_dwordx4 v1, s[36:39], s81 offen lds
L_st3:
  s_mov_b32 s28, s4
  s_and_b32 s29, s5, 0xffff
  s_mov_b32 s30, 425984
  s_mov_b32 s31, 0x20000
  buffer_load_dwordx4 v[16:19], v30, s[28:31], s94 offen
  s_add_u32 s94, s94, 416
  buffer_load_dwordx4 v[104:107], v30, s[28:31], s94 offen
  s_add_u32 s94, s94, 416
  s_mov_b32 s32, s6
  s_and_b32 s33, s7, 0xffff
  s_mov_b32 s34, 12800000
  s_mov_b32 s35, 0x20000
  s_mul_i32 s96, s79, 3072
  s_mul_i32 s97, s79, 2704
  v_lshrrev_b32 v31, 5, v0
  v_mul_u32_u24 v31, 184, v31
  v_sub_u32 v31, v1, v31
  s_add_u32 m0, s96, 85312
  s_add_u32 s81, s97, 35152
  buffer_load_dwordx4 v1, s[36:39], s81 offen lds
  s_lshl_b32 s85, s85, 2
  s_add_u32 s85, s85, 129728
  s_mul_i32 s72, s84, 3
  s_sub_u32 s72, 4, s72
  s_cmp_eq_u32 s26, 85
  s_cselect_b32 s72, s72, 6
  s_add_u32 m0, s96, 86336
  s_add_u32 s81, s97, 36176
  buffer_load_dwordx4 v31, s[36:39], s81 offen lds
  s_lshl_b32 s44, s3, 7
  s_mul_i32 s45, s3, 5280
  s_lshl_b32 s46, s3, 2
  s_lshl_b32 s47, s3, 1
  s_lshl_b32 s82, s3, 12
  s_add_u32 m0, s96, 87360
  s_add_u32 s81, s97, 37016
  buffer_load_dwordx4 v1, s[36:39], s81 offen lds
  s_and_b32 s98, s3, 1
  s_lshr_b32 s99, s3, 1
  s_mul_i32 s68, s99, 3072
  s_lshl_b32 s83, s98, 3
  s_add_u32 s68, s68, s83
  s_add_u32 m0, s96, 97600
  s_add_u32 s81, s97, 45968
  buffer_load_dwordx4 v1, s[36:39], s81 offen lds
  v_add_u32_e64 v59, s68, v1
  s_lshl_b32 s69, s99, 3
  s_lshr_b32 s69, 0x05030200, s69
  s_and_b32 s69, s69, 0xff
  s_lshl_b32 s69, s69, 9
  s_add_u32 m0, s96, 98624
  s_add_u32 s81, s97, 46992
  buffer_load_dwordx4 v31, s[36:39], s81 offen lds
  s_lshl_b32 s70, s98, 2
  s_add_u32 s101, s69, s70
  s_mov_b32 s99, 0x05040100
  s_mov_b32 s100, 0x07060302
  v_mov_b32 v2, 129664
  s_add_u32 m0, s96, 99648
  s_add_u32 s81, s97, 47832
  buffer_load_dwordx4 v1, s[36:39], s81 offen lds
  v_mov_b32 v109, 0
  v_mov_b32 v108, 0
  v_mov_b64 v[32:33], 0
  v_mov_b64 v[34:35], 0
  v_mov_b64 v[36:37], 0
  s_add_u32 m0, s96, 109888
  s_add_u32 s81, s97, 56784
  buffer_load_dwordx4 v1, s[36:39], s81 offen lds
  v_mov_b64 v[38:39], 0
  v_mov_b64 v[40:41], 0
  v_mov_b64 v[42:43], 0
  v_mov_b64 v[44:45], 0
  v_mov_b64 v[46:47], 0
  s_add_u32 m0, s96, 110912
  s_add_u32 s81, s97, 57808
  buffer_load_dwordx4 v31, s[36:39], s81 offen lds
  v_mov_b64 v[48:49], 0
  v_mov_b64 v[50:51], 0
  v_mov_b64 v[52:53], 0
  v_mov_b64 v[54:55], 0
  v_mov_b64 v[56:57], 0
  s_add_u32 m0, s96, 111936
  s_add_u32 s81, s97, 58648
  buffer_load_dwordx4 v1, s[36:39], s81 offen lds
  v_add_u32 v250, 77824, v1
  s_waitcnt vmcnt(19)
  v_add_u32 v251, 125248, v1
  v_lshrrev_b32_e64 v3, 5, v0
  v_lshl_add_u32 v3, v3, 2, v2
  s_cmp_lg_u32 s79, 0
  s_cbranch_scc1 L_st2
  s_add_u32 m0, s96, 122176
  s_add_u32 s81, s97, 67600
  buffer_load_dwordx4 v1, s[36:39], s81 offen lds
  s_add_u32 m0, s96, 123200
  s_add_u32 s81, s97, 68624
  buffer_load_dwordx4 v31, s[36:39], s81 offen lds
  s_add_u32 m0, s96, 124224
  s_add_u32 s81, s97, 69464
  buffer_load_dwordx4 v1, s[36:39], s81 offen lds
L_st2:
  s_add_u32 m0, s95, 6144
  s_add_u32 s81, s95, 0
  buffer_load_dwordx4 v1, s[36:39], s81 offen lds
  s_add_u32 m0, s95, 10240
  s_add_u32 s81, s95, 4096
  buffer_load_dwordx4 v1, s[36:39], s81 offen lds
  s_add_u32 m0, s95, 14336
  s_add_u32 s81, s95, 8192
  buffer_load_dwordx4 v1, s[36:39], s81 offen lds
  s_add_u32 m0, s95, 18432
  s_add_u32 s81, s95, 12288
  buffer_load_dwordx4 v1, s[36:39], s81 offen lds
  s_waitcnt vmcnt(15)
  s_barrier
  ds_read_b128 v[224:227], v250 offset:0
  ds_read_b128 v[228:231], v250 offset:6144
  ds_read_b128 v[232:235], v251 offset:0
  ds_read_b128 v[4:7], v250 offset:3072
  ds_read_b128 v[8:11], v251 offset:2048
  ds_read_b128 v[20:23], v250 offset:1024
  ds_read_b128 v[24:27], v250 offset:2048
  ds_read_b128 v[216:219], v250 offset:4096
  ds_read_b128 v[220:223], v250 offset:5120
  ds_read_b128 v[236:239], v251 offset:1024
  s_add_u32 m0, s95, 22528
  s_add_u32 s81, s95, 16384
  buffer_load_dwordx4 v1, s[36:39], s81 offen lds
  s_add_u32 m0, s95, 26624
  s_add_u32 s81, s95, 20480
  buffer_load_dwordx4 v1, s[36:39], s81 offen lds
  s_add_u32 m0, s95, 30720
  s_add_u32 s81, s95, 24576
  buffer_load_dwordx4 v1, s[36:39], s81 offen lds
  s_add_u32 m0, s95, 34816
  s_add_u32 s81, s95, 28672
  buffer_load_dwordx4 v1, s[36:39], s81 offen lds
  s_cmp_eq_u32 s79, 3
  s_cbranch_scc1 L_st1
  s_add_u32 m0, s95, 38912
  s_add_u32 s81, s95, 32768
  buffer_load_dwordx4 v1, s[36:39], s81 offen lds
L_st1:
  s_waitcnt vmcnt(18)
  v_lshl_add_u32 v16, v16, 7, v29
  v_lshl_add_u32 v17, v17, 7, v29
  v_lshl_add_u32 v18, v18, 7, v29
  v_lshl_add_u32 v19, v19, 7, v29
  s_add_u32 m0, s76, 0
  s_mov_b32 exec_hi, 0xffffff
  buffer_load_dwordx4 v16, s[32:35], 0 offen lds
  s_add_u32 m0, s76, 1056
  s_nop 0
  buffer_load_dwordx4 v17, s[32:35], 0 offen lds
  s_add_u32 m0, s76, 2112
  s_mov_b32 exec_hi, 0xffff
  buffer_load_dwordx4 v18, s[32:35], 0 offen lds
  s_add_u32 m0, s76, 3168
  s_nop 0
  buffer_load_dwordx4 v19, s[32:35], 0 offen lds
  s_mov_b32 exec_hi, -1
  s_waitcnt vmcnt(21)
  v_lshl_add_u32 v104, v104, 7, v29
  v_lshl_add_u32 v105, v105, 7, v29
  v_lshl_add_u32 v106, v106, 7, v29
  v_lshl_add_u32 v107, v107, 7, v29
  s_add_u32 m0, s76, 16256
  s_mov_b32 exec_hi, 0xffffff
  buffer_load_dwordx4 v104, s[32:35], 0 offen lds
  s_add_u32 m0, s76, 17312
  s_nop 0
  buffer_load_dwordx4 v105, s[32:35], 0 offen lds
  s_add_u32 m0, s76, 18368
  s_mov_b32 exec_hi, 0xffff
  buffer_load_dwordx4 v106, s[32:35], 0 offen lds
  s_add_u32 m0, s76, 19424
  s_nop 0
  buffer_load_dwordx4 v107, s[32:35], 0 offen lds
  s_mov_b32 exec_hi, -1
  s_waitcnt lgkmcnt(9)
  v_add_u32 v225, s44, v225
  v_add_u32 v226, s44, v226
  v_add_u32 v227, s44, v227
  s_waitcnt lgkmcnt(8)
  v_add_u32 v228, s46, v228
  v_add_u32 v229, s46, v229
  v_add_u32 v231, s83, v231
  v_add_u32 v230, s101, v230
  s_waitcnt lgkmcnt(7)
  v_mad_u32_u24 v232, v233, s3, v232
  v_add_u32 v234, s47, v234
  v_mad_u32_u24 v233, v233, 8, v232
  v_add_u32 v246, s82, v235
  v_add_u32 v247, 2048, v246
  v_add_u32 v31, 0, v234
  v_and_b32 v31, 3, v31
  v_lshl_add_u32 v244, v31, 4, v232
  v_add_u32 v31, 1, v234
  v_and_b32 v31, 3, v31
  v_lshl_add_u32 v245, v31, 4, v232
  v_add_u32 v245, 1664, v245
  v_add_u32 v31, 0, v234
  v_and_b32 v31, 3, v31
  v_lshl_add_u32 v248, v31, 4, v233
  v_add_u32 v31, 1, v234
  v_and_b32 v31, 3, v31
  v_lshl_add_u32 v249, v31, 4, v233
  v_add_u32 v249, 1664, v249
  s_waitcnt lgkmcnt(5)
  v_add_u32 v10, s76, v10
  v_add_u32 v4, s76, v4
  v_add_u32 v5, s76, v5
  ds_write_b32 v10, v7 offset:2880
  v_add_u32 v11, s45, v11
  s_waitcnt lgkmcnt(5)
  v_add_u32 v20, s45, v20
  v_add_u32 v21, s45, v21
  v_add_u32 v22, s45, v22
  v_add_u32 v23, s45, v23
  s_waitcnt lgkmcnt(4)
  v_add_u32 v24, s45, v24
  v_add_u32 v25, s45, v25
  v_add_u32 v26, s45, v26
  v_add_u32_e64 v27, s45, v27
  s_waitcnt vmcnt(8)
  s_barrier
L_w2:
  ds_read2st64_b32 v[60:61], v228 offset0:0 offset1:6
  ds_read2st64_b32 v[62:63], v228 offset0:12 offset1:18
  ds_read2st64_b32 v[64:65], v228 offset0:24 offset1:30
  ds_read2st64_b32 v[66:67], v228 offset0:36 offset1:42
  ds_read2st64_b32 v[68:69], v228 offset0:96 offset1:102
  ds_read2st64_b32 v[70:71], v229 offset0:108 offset1:114
  ds_read2st64_b32 v[72:73], v229 offset0:120 offset1:126
  ds_read2st64_b32 v[74:75], v229 offset0:132 offset1:138
  s_cmp_ge_u32 s3, 5
  s_cbranch_scc1 L_u0
  v_add_u32 v228, 32, v228
  v_add_u32 v229, 32, v229
  ds_read2st64_b32 v[92:93], v228 offset0:0 offset1:6
  ds_read2st64_b32 v[94:95], v228 offset0:12 offset1:18
  ds_read2st64_b32 v[96:97], v228 offset0:24 offset1:30
  ds_read2st64_b32 v[98:99], v228 offset0:36 offset1:42
  ds_read2st64_b32 v[100:101], v228 offset0:96 offset1:102
  ds_read2st64_b32 v[102:103], v229 offset0:108 offset1:114
  ds_read2st64_b32 v[104:105], v229 offset0:120 offset1:126
  ds_read2st64_b32 v[106:107], v229 offset0:132 offset1:138
  ds_read_b64_tr_b16 v[76:77], v225 offset:0
  ds_read_b64_tr_b16 v[78:79], v225 offset:5408
  ds_read_b64_tr_b16 v[80:81], v226 offset:0
  ds_read_b64_tr_b16 v[82:83], v227 offset:0
  ds_read_b64_tr_b16 v[84:85], v225 offset:64
  ds_read_b64_tr_b16 v[86:87], v225 offset:5472
  ds_read_b64_tr_b16 v[88:89], v226 offset:64
  ds_read_b64_tr_b16 v[90:91], v227 offset:64
  ds_read_b64_tr_b16 v[112:113], v224 offset:0
  ds_read_b64_tr_b16 v[114:115], v224 offset:256
  ds_read_b64_tr_b16 v[116:117], v224 offset:1024
  ds_read_b64_tr_b16 v[118:119], v224 offset:1280
  s_waitcnt lgkmcnt(14)
  v_mfma_f32_16x16x32_bf16 v[108:111], v[60:63], v[60:63], 0
  v_mfma_f32_16x16x32_bf16 v[108:111], v[64:67], v[64:67], v[108:111]
  v_mfma_f32_16x16x32_bf16 v[108:111], v[68:71], v[68:71], v[108:111]
  s_nop 0
  v_mfma_f32_16x16x32_bf16 v[108:111], v[72:75], v[72:75], v[108:111]
  v_perm_b32 v184, v61, v60, s99
  v_perm_b32 v185, v63, v62, s99
  v_perm_b32 v186, v65, v64, s99
  v_perm_b32 v187, v67, v66, s99
  v_perm_b32 v188, v69, v68, s99
  v_perm_b32 v189, v71, v70, s99
  v_perm_b32 v190, v73, v72, s99
  v_perm_b32 v191, v75, v74, s99
  v_mfma_f32_16x16x32_bf16 v[108:111], v[92:95], v[92:95], v[108:111]
  v_mfma_f32_16x16x32_bf16 v[108:111], v[96:99], v[96:99], v[108:111]
  v_mfma_f32_16x16x32_bf16 v[108:111], v[100:103], v[100:103], v[108:111]
  s_waitcnt lgkmcnt(12)
  v_mfma_f32_16x16x32_bf16 v[108:111], v[104:107], v[104:107], v[108:111]
  s_waitcnt lgkmcnt(10)
  v_mfma_f32_16x16x32_bf16 v[28:31], v[76:79], v[76:79], 0
  s_waitcnt lgkmcnt(8)
  v_mfma_f32_16x16x32_bf16 v[28:31], v[80:83], v[80:83], v[28:31]
  s_waitcnt lgkmcnt(6)
  v_mfma_f32_16x16x32_bf16 v[28:31], v[84:87], v[84:87], v[28:31]
  s_waitcnt lgkmcnt(4)
  v_mfma_f32_16x16x32_bf16 v[28:31], v[88:91], v[88:91], v[28:31]
  v_perm_b32 v192, v61, v60, s100
  v_perm_b32 v193, v63, v62, s100
  v_perm_b32 v194, v65, v64, s100
  v_perm_b32 v195, v67, v66, s100
  v_perm_b32 v196, v69, v68, s100
  v_perm_b32 v197, v71, v70, s100
  v_perm_b32 v198, v73, v72, s100
  v_perm_b32 v199, v75, v74, s100
  v_max3_f32 v28, v28, v29, 0
  v_perm_b32 v60, v93, v92, s99
  v_perm_b32 v61, v95, v94, s99
  v_max3_f32 v108, v108, v109, 0
  v_perm_b32 v62, v97, v96, s99
  v_max3_f32 v28, v28, v30, v31
  v_perm_b32 v63, v99, v98, s99
  v_max3_f32 v108, v108, v110, v111
  v_perm_b32 v64, v101, v100, s99
  v_perm_b32 v65, v103, v102, s99
  v_permlane32_swap_b32 v28, v108
  v_perm_b32 v66, v105, v104, s99
  v_max_u32 v28, v28, v108
  v_perm_b32 v67, v107, v106, s99
  s_nop 0
  v_max_u32_dpp v28, v28, v28 row_shr:1 row_mask:0xf bank_mask:0xf
  v_perm_b32 v68, v93, v92, s100
  v_perm_b32 v69, v95, v94, s100
  v_max_u32_dpp v28, v28, v28 row_shr:2 row_mask:0xf bank_mask:0xf
  v_perm_b32 v70, v97, v96, s100
  s_nop 0
  v_max_u32_dpp v28, v28, v28 row_shr:4 row_mask:0xf bank_mask:0xf
  v_perm_b32 v71, v99, v98, s100
  s_nop 0
  v_max_u32_dpp v28, v28, v28 row_shr:8 row_mask:0xf bank_mask:0xf
  v_perm_b32 v72, v101, v100, s100
  v_perm_b32 v73, v103, v102, s100
  v_max_u32_dpp v28, v28, v28 row_bcast:15 row_mask:0xa bank_mask:0xf
  v_perm_b32 v74, v105, v104, s100
  s_mov_b32 exec_lo, 0x80000000
  s_mov_b32 exec_hi, 0x80000000
  ds_max_u32 v3, v28 offset:16
  s_mov_b64 exec, -1
  v_perm_b32 v75, v107, v106, s100
  s_branch L_u1
L_u0:
  ds_read_b64_tr_b16 v[76:77], v225 offset:0
  ds_read_b64_tr_b16 v[78:79], v225 offset:5408
  ds_read_b64_tr_b16 v[80:81], v226 offset:0
  ds_read_b64_tr_b16 v[82:83], v227 offset:0
  ds_read_b64_tr_b16 v[84:85], v225 offset:64
  ds_read_b64_tr_b16 v[86:87], v225 offset:5472
  ds_read_b64_tr_b16 v[88:89], v226 offset:64
  ds_read_b64_tr_b16 v[90:91], v227 offset:64
  ds_read_b64_tr_b16 v[92:93], v225 offset:384
  ds_read_b64_tr_b16 v[94:95], v225 offset:5792
  ds_read_b64_tr_b16 v[96:97], v226 offset:384
  ds_read_b64_tr_b16 v[98:99], v227 offset:384
  ds_read_b64_tr_b16 v[100:101], v225 offset:448
  ds_read_b64_tr_b16 v[102:103], v225 offset:5856
  ds_read_b64_tr_b16 v[104:105], v226 offset:448
  ds_read_b64_tr_b16 v[106:107], v227 offset:448
  ds_read_b64_tr_b16 v[112:113], v224 offset:0
  ds_read_b64_tr_b16 v[114:115], v224 offset:256
  ds_read_b64_tr_b16 v[116:117], v224 offset:1024
  ds_read_b64_tr_b16 v[118:119], v224 offset:1280
  s_waitcnt lgkmcnt(14)
  v_mfma_f32_16x16x32_bf16 v[108:111], v[60:63], v[60:63], 0
  v_mfma_f32_16x16x32_bf16 v[108:111], v[64:67], v[64:67], v[108:111]
  s_nop 0
  v_mfma_f32_16x16x32_bf16 v[108:111], v[68:71], v[68:71], v[108:111]
  v_mfma_f32_16x16x32_bf16 v[108:111], v[72:75], v[72:75], v[108:111]
  v_mfma_f32_16x16x32_bf16 v[28:31], v[76:79], v[76:79], 0
  v_mfma_f32_16x16x32_bf16 v[28:31], v[80:83], v[80:83], v[28:31]
  v_mfma_f32_16x16x32_bf16 v[28:31], v[84:87], v[84:87], v[28:31]
  s_waitcnt lgkmcnt(12)
  v_mfma_f32_16x16x32_bf16 v[28:31], v[88:91], v[88:91], v[28:31]
  s_waitcnt lgkmcnt(10)
  v_mfma_f32_16x16x32_bf16 v[28:31], v[92:95], v[92:95], v[28:31]
  s_waitcnt lgkmcnt(8)
  v_mfma_f32_16x16x32_bf16 v[28:31], v[96:99], v[96:99], v[28:31]
  s_waitcnt lgkmcnt(6)
  v_mfma_f32_16x16x32_bf16 v[28:31], v[100:103], v[100:103], v[28:31]
  s_nop 0
  s_waitcnt lgkmcnt(4)
  v_mfma_f32_16x16x32_bf16 v[28:31], v[104:107], v[104:107], v[28:31]
  v_perm_b32 v184, v61, v60, s99
  v_perm_b32 v185, v63, v62, s99
  v_perm_b32 v186, v65, v64, s99
  v_perm_b32 v187, v67, v66, s99
  s_nop 3
  v_max3_f32 v28, v28, v29, 0
  v_perm_b32 v188, v69, v68, s99
  v_max3_f32 v108, v108, v109, 0
  v_perm_b32 v189, v71, v70, s99
  v_max3_f32 v28, v28, v30, v31
  v_perm_b32 v190, v73, v72, s99
  v_max3_f32 v108, v108, v110, v111
  v_perm_b32 v191, v75, v74, s99
  s_nop 0
  v_permlane32_swap_b32 v28, v108
  v_perm_b32 v192, v61, v60, s100
  v_max_u32 v28, v28, v108
  v_perm_b32 v193, v63, v62, s100
  s_nop 0
  v_max_u32_dpp v28, v28, v28 row_shr:1 row_mask:0xf bank_mask:0xf
  v_perm_b32 v194, v65, v64, s100
  s_nop 0
  v_max_u32_dpp v28, v28, v28 row_shr:2 row_mask:0xf bank_mask:0xf
  v_perm_b32 v195, v67, v66, s100
  s_nop 0
  v_max_u32_dpp v28, v28, v28 row_shr:4 row_mask:0xf bank_mask:0xf
  v_perm_b32 v196, v69, v68, s100
  s_nop 0
  v_max_u32_dpp v28, v28, v28 row_shr:8 row_mask:0xf bank_mask:0xf
  v_perm_b32 v197, v71, v70, s100
  s_nop 0
  v_max_u32_dpp v28, v28, v28 row_bcast:15 row_mask:0xa bank_mask:0xf
  v_perm_b32 v198, v73, v72, s100
  s_mov_b32 exec_lo, 0x80000000
  s_mov_b32 exec_hi, 0x80000000
  ds_max_u32 v3, v28 offset:16
  s_mov_b64 exec, -1
  v_perm_b32 v199, v75, v74, s100
  v_add_u32 v248, 12288, v246
  v_add_u32 v249, 12288, v247
  s_cmp_lg_u32 s3, 7
  s_cbranch_scc1 L_u1
  s_mov_b32 exec_lo, 0xfffffff0
  s_mov_b32 exec_hi, 0xfffffff0
  v_mov_b32 v249, 1048576
  s_mov_b64 exec, -1
L_u1:
  s_waitcnt lgkmcnt(0)
  s_barrier
  ds_read_b128 v[108:111], v2 offset:16
  s_mul_i32 s68, s3, 384
  v_lshrrev_b32 v29, 2, v0
  v_mul_u32_u24 v29, 24, v29
  v_add_u32 v29, s68, v29
  v_and_b32 v30, 3, v0
  v_lshlrev_b32 v30, 3, v30
  ds_read_b64 v[224:225], v29 offset:2048
  ds_read_b64 v[226:227], v29 offset:2056
  ds_read_b64 v[228:229], v29 offset:2064
  s_waitcnt lgkmcnt(3)
  v_add_u32 v108, 0x3f800000, v108
  v_add_u32 v109, 0x3f800000, v109
  v_lshrrev_b32 v108, 24, v108
  v_lshrrev_b32_e64 v109, 24, v109
  v_sub_u32 v108, 267, v108
  s_mov_b32 vcc_lo, 0x4000000
  v_min_u32 v108, 167, v108
  s_mov_b32 vcc_hi, 0x4000000
  v_readfirstlane_b32 s74, v108
  v_cndmask_b32 v250, v110, v111, vcc
  v_mul_u32_u24 v108, 0x800080, v108
  v_lshrrev_b32 v250, 23, v250
  v_and_b32 v216, v216, v108
  v_and_b32 v217, v217, v108
  v_and_b32 v218, v218, v108
  v_and_b32 v219, v219, v108
  v_and_b32 v220, v220, v108
  v_and_b32 v221, v221, v108
  v_and_b32 v222, v222, v108
  v_and_b32 v223, v223, v108
  v_mfma_f32_32x32x16_bf16 v[152:167], v[216:219], v[76:79], 0
  v_add_u32_e64 v250, v250, v109
  v_sub_u32 v250, 388, v250
  v_mfma_f32_32x32x16_bf16 v[168:183], v[216:219], v[84:87], 0
  s_movk_i32 s98, 167
  v_med3_i32 v250, v250, 1, s98
  v_mfma_f32_32x32x16_bf16 v[152:167], v[220:223], v[80:83], v[152:167]
  v_subrev_u32 v110, 127, v250
  v_lshlrev_b32 v250, 23, v250
  v_mfma_f32_32x32x16_bf16 v[168:183], v[220:223], v[88:91], v[168:183]
  v_cmp_gt_i32 vcc, 0, v110
  v_mul_u32_u24 v110, 0x800080, v110
  s_cbranch_vccnz L_sdown
  v_add_u32 v112, v112, v110
  v_add_u32 v113, v113, v110
  v_add_u32 v114, v114, v110
  v_add_u32 v115, v115, v110
  v_add_u32 v116, v116, v110
  v_add_u32 v117, v117, v110
  v_add_u32 v118, v118, v110
  v_add_u32 v119, v119, v110
L_scaled:
  v_mfma_f32_32x32x16_bf16 v[120:135], v[184:187], v[112:115], 0
  v_cvt_pk_f16_f32 v152, v152, v153
  v_cvt_pk_f16_f32 v153, v154, v155
  v_cvt_pk_f16_f32 v154, v156, v157
  v_cvt_pk_f16_f32 v155, v158, v159
  ds_write_b128 v246, v[152:155]
  v_xor_b32 v246, 16, v246
  v_mfma_f32_32x32x16_bf16 v[120:135], v[188:191], v[116:119], v[120:135]
  v_cvt_pk_f16_f32 v156, v160, v161
  v_cvt_pk_f16_f32 v157, v162, v163
  v_cvt_pk_f16_f32 v158, v164, v165
  v_cvt_pk_f16_f32 v159, v166, v167
  ds_write_b128 v246, v[156:159]
  v_mfma_f32_32x32x16_bf16 v[136:151], v[192:195], v[112:115], 0
  v_cvt_pk_f16_f32 v168, v168, v169
  v_cvt_pk_f16_f32 v169, v170, v171
  v_cvt_pk_f16_f32 v170, v172, v173
  v_cvt_pk_f16_f32 v171, v174, v175
  ds_write_b128 v247, v[168:171]
  v_xor_b32_e64 v247, 16, v247
  v_mfma_f32_32x32x16_bf16 v[136:151], v[196:199], v[116:119], v[136:151]
  v_cvt_pk_f16_f32 v172, v176, v177
  v_cvt_pk_f16_f32 v173, v178, v179
  v_cvt_pk_f16_f32 v174, v180, v181
  v_cvt_pk_f16_f32 v175, v182, v183
  ds_write_b128 v247, v[172:175]
  s_cmp_ge_u32 s3, 5
  s_cbranch_scc1 L_u2
  v_mfma_f32_32x32x16_bf16 v[184:199], v[60:63], v[112:115], 0
  v_cvt_pk_f16_f32 v120, v120, v121
  v_cvt_pk_f16_f32 v121, v122, v123
  v_cvt_pk_f16_f32 v122, v124, v125
  v_mfma_f32_32x32x16_bf16 v[184:199], v[64:67], v[116:119], v[184:199]
  v_cvt_pk_f16_f32 v123, v126, v127
  ds_write_b128 v244, v[120:123]
  v_xor_b32_e64 v244, 16, v244
  v_mfma_f32_32x32x16_bf16 v[200:215], v[68:71], v[112:115], 0
  v_cvt_pk_f16_f32 v124, v128, v129
  v_cvt_pk_f16_f32 v125, v130, v131
  v_cvt_pk_f16_f32 v126, v132, v133
  v_mfma_f32_32x32x16_bf16 v[200:215], v[72:75], v[116:119], v[200:215]
  v_cvt_pk_f16_f32 v127, v134, v135
  ds_write_b128 v244, v[124:127]
  s_branch L_u3
L_u2:
  v_mfma_f32_32x32x16_bf16 v[184:199], v[216:219], v[92:95], 0
  v_cvt_pk_f16_f32 v120, v120, v121
  v_cvt_pk_f16_f32 v121, v122, v123
  v_cvt_pk_f16_f32 v122, v124, v125
  v_mfma_f32_32x32x16_bf16 v[184:199], v[220:223], v[96:99], v[184:199]
  v_cvt_pk_f16_f32 v123, v126, v127
  ds_write_b128 v244, v[120:123]
  v_xor_b32 v244, 16, v244
  v_mfma_f32_32x32x16_bf16 v[200:215], v[216:219], v[100:103], 0
  v_cvt_pk_f16_f32 v124, v128, v129
  v_cvt_pk_f16_f32 v125, v130, v131
  v_cvt_pk_f16_f32 v126, v132, v133
  v_mfma_f32_32x32x16_bf16 v[200:215], v[220:223], v[104:107], v[200:215]
  v_cvt_pk_f16_f32 v127, v134, v135
  ds_write_b128 v244, v[124:127]
L_u3:
  buffer_load_dwordx4 v[16:19], v6, s[28:31], s94 offen
  s_add_u32 s94, s94, 416
  buffer_load_dwordx4 v[12:15], v6, s[28:31], s94 offen
  s_add_u32 s94, s94, 416
  v_cvt_pk_f16_f32 v136, v136, v137
  s_waitcnt lgkmcnt(8)
  v_xor_b32 v224, v224, v30
  v_cvt_pk_f16_f32 v137, v138, v139
  v_cvt_pk_f16_f32 v138, v140, v141
  v_xor_b32 v232, 32, v224
  v_cvt_pk_f16_f32 v139, v142, v143
  ds_write_b128 v245, v[136:139]
  v_xor_b32 v245, 16, v245
  v_xor_b32 v225, v225, v30
  v_cvt_pk_f16_f32 v140, v144, v145
  v_cvt_pk_f16_f32 v141, v146, v147
  v_cvt_pk_f16_f32 v142, v148, v149
  v_xor_b32 v233, 32, v225
  v_cvt_pk_f16_f32 v143, v150, v151
  ds_write_b128 v245, v[140:143]
  v_cvt_pk_f16_f32 v184, v184, v185
  s_waitcnt lgkmcnt(9)
  v_xor_b32 v226, v226, v30
  v_cvt_pk_f16_f32 v185, v186, v187
  v_cvt_pk_f16_f32 v186, v188, v189
  v_xor_b32_e64 v234, 32, v226
  v_cvt_pk_f16_f32 v187, v190, v191
  ds_write_b128 v248, v[184:187]
  v_xor_b32 v248, 16, v248
  v_xor_b32 v227, v227, v30
  v_cvt_pk_f16_f32 v188, v192, v193
  v_cvt_pk_f16_f32 v189, v194, v195
  v_cvt_pk_f16_f32 v190, v196, v197
  v_xor_b32_e64 v235, 32, v227
  v_cvt_pk_f16_f32 v191, v198, v199
  ds_write_b128 v248, v[188:191]
  v_cvt_pk_f16_f32 v200, v200, v201
  s_waitcnt lgkmcnt(10)
  v_xor_b32 v228, v228, v30
  v_cvt_pk_f16_f32 v201, v202, v203
  v_cvt_pk_f16_f32 v202, v204, v205
  v_xor_b32 v240, 32, v228
  v_cvt_pk_f16_f32 v203, v206, v207
  ds_write_b128 v249, v[200:203]
  v_xor_b32 v249, 16, v249
  v_xor_b32_e64 v229, v229, v30
  v_cvt_pk_f16_f32 v204, v208, v209
  v_cvt_pk_f16_f32 v205, v210, v211
  v_cvt_pk_f16_f32 v206, v212, v213
  v_xor_b32_e64 v241, 32, v229
  v_cvt_pk_f16_f32 v207, v214, v215
  ds_write_b128 v249, v[204:207]
  v_readlane_b32 s0, v250, 0
  v_readlane_b32 s1, v250, 26
  s_sub_u32 s75, 0x7f000000, s0
  s_sub_u32 s1, 0x7f000000, s1
  s_sub_u32 s74, 254, s74
  s_lshl_b32 s74, s74, 23
  s_mov_b32 s92, 0x88888888
  s_mov_b32 s93, 0x88888888
  s_waitcnt lgkmcnt(0)
  s_barrier
  ds_read_b64_tr_b16 v[60:61], v224 offset:0
  ds_read_b64_tr_b16 v[62:63], v225 offset:0
  ds_read_b64_tr_b16 v[64:65], v232 offset:0
  ds_read_b64_tr_b16 v[66:67], v233 offset:0
  ds_read_b64_tr_b16 v[68:69], v224 offset:43328
  ds_read_b64_tr_b16 v[70:71], v225 offset:43328
  ds_read_b64_tr_b16 v[72:73], v232 offset:43328
  ds_read_b64_tr_b16 v[74:75], v233 offset:43328
  ds_read_b64_tr_b16 v[76:77], v226 offset:0
  ds_read_b64_tr_b16 v[78:79], v227 offset:0
  ds_read_b64_tr_b16 v[80:81], v234 offset:0
  ds_read_b64_tr_b16 v[82:83], v235 offset:0
  ds_read_b64_tr_b16 v[84:85], v226 offset:43328
  ds_read_b64_tr_b16 v[86:87], v227 offset:43328
  ds_read_b64_tr_b16 v[88:89], v234 offset:43328
  ds_read_b64_tr_b16 v[90:91], v235 offset:43328
  s_cmp_ge_u32 s3, 6
  s_cbranch_scc1 L_lin
  ds_read_b64_tr_b16 v[92:93], v228 offset:0
  ds_read_b64_tr_b16 v[94:95], v229 offset:0
  ds_read_b64_tr_b16 v[96:97], v240 offset:0
  ds_read_b64_tr_b16 v[98:99], v241 offset:0
  ds_read_b64_tr_b16 v[100:101], v228 offset:43328
  ds_read_b64_tr_b16 v[102:103], v229 offset:43328
  ds_read_b64_tr_b16 v[104:105], v240 offset:43328
  ds_read_b64_tr_b16 v[106:107], v241 offset:43328
  s_waitcnt lgkmcnt(6)
  v_pk_add_f16 v92, v92, v94
  v_pk_add_f16 v93, v93, v95
  ds_write_b64 v59, v[92:93] offset:30720
  s_waitcnt lgkmcnt(5)
  v_pk_add_f16 v96, v96, v98
  v_pk_add_f16 v97, v97, v99
  s_waitcnt lgkmcnt(3)
  v_pk_add_f16 v100, v100, v102
  v_pk_add_f16 v101, v101, v103
  ds_write_b64 v59, v[100:101] offset:32768
  s_waitcnt lgkmcnt(2)
  v_pk_add_f16 v104, v104, v106
  v_pk_add_f16 v105, v105, v107
  v_cndmask_b32 v96, v96, v104, s[92:93]
  v_cndmask_b32 v97, v97, v105, s[92:93]
  ds_write_b64 v59, v[96:97] offset:31744
  ds_write_b32 v230, v104 offset:3072
  ds_write_b32 v230, v105 offset:3088
  s_branch L_p2
L_lin:
  s_and_b32 s98, s3, 1
  s_cselect_b64 vcc, -1, 0
  s_lshl_b32 s99, s98, 5
  v_mov_b32 v31, 0
  v_xor_b32 v236, s99, v236
  v_xor_b32 v237, s99, v237
  v_cndmask_b32 v238, v238, v239, vcc
  ds_read_b64_tr_b16 v[92:93], v236
  ds_read_b64_tr_b16 v[94:95], v237
  ds_read_u16_d16_hi v31, v238
  s_lshl_b32 s98, s98, 10
  v_add_u32 v29, s98, v1
  s_waitcnt lgkmcnt(2)
  v_cvt_f32_f16 v96, v92
  v_cvt_f32_f16_sdwa v97, v92 dst_sel:DWORD dst_unused:UNUSED_PAD src0_sel:WORD_1
  v_mul_f32 v96, s1, v96
  v_mul_f32 v97, s1, v97
  v_mul_f32 v96, s0, v96
  v_mul_f32 v97, s0, v97
  v_cvt_pk_bf16_f32 v92, v96, v97
  v_cvt_f32_f16 v98, v93
  v_cvt_f32_f16_sdwa v99, v93 dst_sel:DWORD dst_unused:UNUSED_PAD src0_sel:WORD_1
  v_mul_f32 v98, s1, v98
  v_mul_f32 v99, s1, v99
  v_mul_f32 v98, s0, v98
  v_mul_f32 v99, s0, v99
  v_cvt_pk_bf16_f32 v93, v98, v99
  s_waitcnt lgkmcnt(1)
  v_cvt_f32_f16 v100, v94
  v_cvt_f32_f16_sdwa v101, v94 dst_sel:DWORD dst_unused:UNUSED_PAD src0_sel:WORD_1
  v_mul_f32 v100, s1, v100
  v_mul_f32 v101, s1, v101
  v_mul_f32 v100, s0, v100
  v_mul_f32 v101, s0, v101
  v_cvt_pk_bf16_f32 v94, v100, v101
  v_cvt_f32_f16_e64 v102, v95
  v_cvt_f32_f16_sdwa v103, v95 dst_sel:DWORD dst_unused:UNUSED_PAD src0_sel:WORD_1
  v_mul_f32 v102, s1, v102
  v_mul_f32 v103, s1, v103
  s_mov_b32 exec_lo, 0
  s_mov_b32 exec_hi, 0xffff
  s_waitcnt lgkmcnt(0)
  v_mov_b32 v102, v31
  s_mov_b64 exec, -1
  v_mul_f32 v102, s0, v102
  v_mul_f32 v103, s0, v103
  v_cvt_pk_bf16_f32 v95, v102, v103
  ds_write_b128 v29, v[92:95] offset:39936
L_p2:
  v_pk_add_f16 v76, v76, v78
  v_pk_add_f16 v77, v77, v79
  ds_write_b64 v59, v[76:77] offset:18432
  v_pk_add_f16 v80, v80, v82
  v_pk_add_f16 v81, v81, v83
  v_pk_add_f16 v84, v84, v86
  v_pk_add_f16 v85, v85, v87
  ds_write_b64 v59, v[84:85] offset:20480
  v_pk_add_f16 v88, v88, v90
  v_pk_add_f16 v89, v89, v91
  v_cndmask_b32 v80, v80, v88, s[92:93]
  v_cndmask_b32 v81, v81, v89, s[92:93]
  ds_write_b64 v59, v[80:81] offset:19456
  ds_write_b32 v230, v88 offset:1024
  ds_write_b32 v230, v89 offset:1040
  v_pk_add_f16 v60, v60, v62
  v_pk_add_f16 v61, v61, v63
  ds_write_b64 v59, v[60:61] offset:6144
  v_pk_add_f16 v64, v64, v66
  v_pk_add_f16 v65, v65, v67
  v_pk_add_f16 v68, v68, v70
  v_pk_add_f16 v69, v69, v71
  ds_write_b64 v59, v[68:69] offset:8192
  v_pk_add_f16 v72, v72, v74
  v_pk_add_f16 v73, v73, v75
  v_cndmask_b32 v64, v64, v72, s[92:93]
  v_cndmask_b32 v65, v65, v73, s[92:93]
  ds_write_b64 v59, v[64:65] offset:7168
  s_cmp_lt_u32 s3, 2
  s_cbranch_scc1 L_p2d
  v_subrev_u32 v230, 1024, v230
  ds_write_b32 v230, v72 offset:0
  ds_write_b32 v230, v73 offset:16
  s_branch L_built
L_p2d:
  ds_write_b64 v231, v[72:73] offset:5120
L_built:
  s_mov_b32 s0, s74
  s_mov_b32 s1, s75
  s_mov_b32 s96, 0x3e000000
  s_mov_b32 s97, 0x43000000
  s_mov_b32 s51, 1
  s_mul_i32 s98, s3, 1536
  s_add_u32 s98, s98, 116736
  s_cmp_lg_u32 s84, 0
  s_cbranch_scc1 L_g1c
  s_sub_u32 s94, s94, 416
  s_waitcnt vmcnt(6)
  ds_read_u16_d16_hi v32, v10 offset:0
  ds_read_u16_d16_hi v33, v10 offset:2
  ds_read_u16_d16_hi v34, v10 offset:2112
  ds_read_u16_d16_hi v35, v10 offset:2114
  ds_read_u16_d16_hi v36, v10 offset:128
  ds_read_u16_d16_hi v37, v10 offset:130
  ds_read_u16_d16_hi v38, v10 offset:2240
  ds_read_u16_d16_hi v39, v10 offset:2242
  ds_read_u16_d16_hi v40, v10 offset:256
  ds_read_u16_d16_hi v41, v10 offset:258
  ds_read_u16_d16_hi v42, v10 offset:2368
  ds_read_u16_d16_hi v43, v10 offset:2370
  ds_read_u16_d16_hi v44, v10 offset:384
  ds_read_u16_d16_hi v45, v10 offset:386
  ds_read_u16_d16_hi v46, v10 offset:2496
  ds_read_u16_d16_hi v47, v10 offset:2498
  ds_read_u16_d16_hi v48, v10 offset:512
  ds_read_u16_d16_hi v49, v10 offset:514
  ds_read_u16_d16_hi v50, v10 offset:2624
  ds_read_u16_d16_hi v51, v10 offset:2626
  ds_read_u16_d16_hi v52, v10 offset:640
  ds_read_u16_d16_hi v53, v10 offset:642
  ds_read_u16_d16_hi v54, v10 offset:2752
  ds_read_u16_d16_hi v55, v10 offset:2754
  ds_read_u16_d16_hi v56, v10 offset:768
  ds_read_u16_d16_hi v57, v10 offset:770
  s_waitcnt lgkmcnt(14)
  v_max3_f32 v58, |v32|, |v33|, 0
  v_cvt_pk_f16_f32 v184, v32, v33
  v_max3_f32 v58, |v34|, |v35|, v58
  v_cvt_pk_f16_f32 v185, v34, v35
  v_max3_f32 v58, |v36|, |v37|, v58
  v_cvt_pk_f16_f32 v186, v36, v37
  v_max3_f32 v58, |v38|, |v39|, v58
  v_cvt_pk_f16_f32 v187, v38, v39
  v_max3_f32 v58, |v40|, |v41|, v58
  v_cvt_pk_f16_f32 v188, v40, v41
  v_max3_f32 v58, |v42|, |v43|, v58
  v_cvt_pk_f16_f32 v189, v42, v43
  s_waitcnt lgkmcnt(12)
  v_max3_f32 v58, |v44|, |v45|, v58
  v_cvt_pk_f16_f32 v190, v44, v45
  s_waitcnt lgkmcnt(10)
  v_max3_f32 v58, |v46|, |v47|, v58
  v_cvt_pk_f16_f32 v191, v46, v47
  s_waitcnt lgkmcnt(8)
  v_max3_f32 v58, |v48|, |v49|, v58
  v_cvt_pk_f16_f32 v192, v48, v49
  s_waitcnt lgkmcnt(6)
  v_max3_f32 v58, |v50|, |v51|, v58
  v_cvt_pk_f16_f32 v193, v50, v51
  s_waitcnt lgkmcnt(4)
  v_max3_f32 v58, |v52|, |v53|, v58
  v_cvt_pk_f16_f32 v194, v52, v53
  s_waitcnt lgkmcnt(2)
  v_max3_f32 v58, |v54|, |v55|, v58
  v_cvt_pk_f16_f32 v195, v54, v55
  s_waitcnt lgkmcnt(0)
  v_max3_f32 v58, |v56|, |v57|, v58
  v_cvt_pk_f16_f32 v196, v56, v57
  s_waitcnt lgkmcnt(0)
  s_barrier
  s_branch L_cin_go
L_g1c:
  s_waitcnt lgkmcnt(0)
  s_barrier
  s_add_u32 s76, s76, -63168
  s_waitcnt vmcnt(1)
  v_lshl_add_u32 v16, v16, 7, v8
  v_lshl_add_u32 v17, v17, 7, v8
  v_lshl_add_u32 v18, v18, 7, v8
  v_lshl_add_u32 v19, v19, 7, v8
  s_add_u32 m0, s76, 0
  s_mov_b32 exec_hi, 0xffffff
  buffer_load_dwordx4 v16, s[32:35], 0 offen lds
  s_add_u32 m0, s76, 1056
  s_nop 0
  buffer_load_dwordx4 v17, s[32:35], 0 offen lds
  s_add_u32 m0, s76, 2112
  s_mov_b32 exec_hi, 0xffff
  buffer_load_dwordx4 v18, s[32:35], 0 offen lds
  s_add_u32 m0, s76, 3168
  s_nop 0
  buffer_load_dwordx4 v19, s[32:35], 0 offen lds
  s_mov_b32 exec_hi, -1
  s_waitcnt vmcnt(4)
  v_lshl_add_u32 v12, v12, 7, v8
  v_lshl_add_u32 v13, v13, 7, v8
  v_lshl_add_u32 v14, v14, 7, v8
  v_lshl_add_u32 v15, v15, 7, v8
  s_add_u32 m0, s76, 16256
  s_mov_b32 exec_hi, 0xffffff
  buffer_load_dwordx4 v12, s[32:35], 0 offen lds
  s_add_u32 m0, s76, 17312
  s_nop 0
  buffer_load_dwordx4 v13, s[32:35], 0 offen lds
  s_add_u32 m0, s76, 18368
  s_mov_b32 exec_hi, 0xffff
  buffer_load_dwordx4 v14, s[32:35], 0 offen lds
  s_add_u32 m0, s76, 19424
  s_nop 0
  buffer_load_dwordx4 v15, s[32:35], 0 offen lds
  s_mov_b32 exec_hi, -1
  buffer_load_dwordx4 v[16:19], v6, s[28:31], s94 offen
  s_add_u32 s94, s94, 416
  v_add_u32 v10, -63168, v10
  v_add_u32 v4, -63168, v4
  v_add_u32 v5, -63168, v5
  ds_write_b32 v10, v7 offset:2880
  ds_write_b32 v10, v7 offset:19136
L_g1d:
  s_waitcnt vmcnt(5)
  ds_read_u16_d16_hi v32, v10 offset:0
  ds_read_u16_d16_hi v33, v10 offset:2
  ds_read_u16_d16_hi v34, v10 offset:2112
  ds_read_u16_d16_hi v35, v10 offset:2114
  ds_read_u16_d16_hi v36, v10 offset:128
  ds_read_u16_d16_hi v37, v10 offset:130
  ds_read_u16_d16_hi v38, v10 offset:2240
  ds_read_u16_d16_hi v39, v10 offset:2242
  ds_read_u16_d16_hi v40, v10 offset:256
  ds_read_u16_d16_hi v41, v10 offset:258
  ds_read_u16_d16_hi v42, v10 offset:2368
  ds_read_u16_d16_hi v43, v10 offset:2370
  ds_read_u16_d16_hi v44, v10 offset:384
  ds_read_u16_d16_hi v45, v10 offset:386
  ds_read_u16_d16_hi v46, v10 offset:2496
  ds_read_u16_d16_hi v47, v10 offset:2498
  ds_read_u16_d16_hi v48, v10 offset:512
  ds_read_u16_d16_hi v49, v10 offset:514
  ds_read_u16_d16_hi v50, v10 offset:2624
  ds_read_u16_d16_hi v51, v10 offset:2626
  ds_read_u16_d16_hi v52, v10 offset:640
  ds_read_u16_d16_hi v53, v10 offset:642
  ds_read_u16_d16_hi v54, v10 offset:2752
  ds_read_u16_d16_hi v55, v10 offset:2754
  ds_read_u16_d16_hi v56, v10 offset:768
  ds_read_u16_d16_hi v57, v10 offset:770
  s_waitcnt lgkmcnt(14)
  v_max3_f32 v58, |v32|, |v33|, 0
  v_cvt_pk_f16_f32 v184, v32, v33
  v_max3_f32 v58, |v34|, |v35|, v58
  v_cvt_pk_f16_f32 v185, v34, v35
  v_max3_f32 v58, |v36|, |v37|, v58
  v_cvt_pk_f16_f32 v186, v36, v37
  v_max3_f32 v58, |v38|, |v39|, v58
  v_cvt_pk_f16_f32 v187, v38, v39
  v_max3_f32 v58, |v40|, |v41|, v58
  v_cvt_pk_f16_f32 v188, v40, v41
  v_max3_f32 v58, |v42|, |v43|, v58
  v_cvt_pk_f16_f32 v189, v42, v43
  s_waitcnt lgkmcnt(12)
  v_max3_f32 v58, |v44|, |v45|, v58
  v_cvt_pk_f16_f32 v190, v44, v45
  s_waitcnt lgkmcnt(10)
  v_max3_f32 v58, |v46|, |v47|, v58
  v_cvt_pk_f16_f32 v191, v46, v47
  s_waitcnt lgkmcnt(8)
  v_max3_f32 v58, |v48|, |v49|, v58
  v_cvt_pk_f16_f32 v192, v48, v49
  s_waitcnt lgkmcnt(6)
  v_max3_f32 v58, |v50|, |v51|, v58
  v_cvt_pk_f16_f32 v193, v50, v51
  s_waitcnt lgkmcnt(4)
  v_max3_f32 v58, |v52|, |v53|, v58
  v_cvt_pk_f16_f32 v194, v52, v53
  s_waitcnt lgkmcnt(2)
  v_max3_f32 v58, |v54|, |v55|, v58
  v_cvt_pk_f16_f32 v195, v54, v55
  s_waitcnt lgkmcnt(0)
  v_max3_f32 v58, |v56|, |v57|, v58
  v_cvt_pk_f16_f32 v196, v56, v57
L_cin_go:
  ds_write_b32 v11, v184 offset:0
  ds_write_b32 v11, v185 offset:160
  ds_write_b32 v11, v186 offset:320
  ds_write_b32 v11, v187 offset:480
  ds_write_b32 v11, v188 offset:640
  ds_write_b32 v11, v189 offset:800
  ds_write_b32 v11, v190 offset:960
  ds_write_b32 v11, v191 offset:1120
  ds_write_b32 v11, v192 offset:1280
  ds_write_b32 v11, v193 offset:1440
  ds_write_b32 v11, v194 offset:1600
  ds_write_b32 v11, v195 offset:1760
  ds_write_b32 v11, v196 offset:1920
  s_mov_b32 s81, 16256
  s_add_u32 s76, s76, 16256
  v_lshlrev_b32 v7, 2, v0
  v_add_u32 v7, s98, v7
L_cin_loop:
  v_cmp_le_f32 s[90:91], s97, v58
  v_cmp_le_f32 vcc, s96, v58
  s_mov_b32 s49, s74
  s_mov_b32 s50, s75
  s_cmp_lg_u64 s[90:91], 0
  s_cbranch_scc1 L_cslow
  s_cbranch_vccz L_cslow
L_cconv:
  s_cmp_lg_u32 s51, 0
  s_cbranch_scc1 L_first
  ds_read_b64_tr_b16 v[60:61], v20 offset:0
  v_mul_f32 v116, v184, v192
  v_mul_f32 v117, v185, v193
  ds_read_b64_tr_b16 v[74:75], v20 offset:32
  v_mul_f32 v118, v186, v194
  ds_read_b64_tr_b16 v[88:89], v20 offset:64
  v_mul_f32 v119, v187, v195
  ds_read_b64_tr_b16 v[102:103], v20 offset:96
  v_fmac_f32_e64 v116, v188, v191
  ds_read_b64_tr_b16 v[66:67], v23 offset:0
  v_fmac_f32 v117, v200, v208
  ds_read_b64_tr_b16 v[80:81], v23 offset:32
  v_fmac_f32 v118, v201, v209
  ds_read_b64_tr_b16 v[94:95], v23 offset:64
  v_fmac_f32 v119, v202, v210
  ds_read_b64_tr_b16 v[108:109], v23 offset:96
  v_fmac_f32 v116, v203, v211
  ds_read_b64_tr_b16 v[68:69], v24 offset:0
  v_fmac_f32_e64 v117, v204, v207
  ds_read_b64_tr_b16 v[82:83], v24 offset:32
  v_fmac_f32 v118, v216, v224
  ds_read_b64_tr_b16 v[96:97], v24 offset:64
  v_fmac_f32 v119, v217, v225
  ds_read_b64_tr_b16 v[110:111], v24 offset:96
  v_fmac_f32 v116, v218, v226
  ds_read_b64_tr_b16 v[124:125], v4 offset:0
  v_fmac_f32 v117, v219, v227
  ds_read_b64_tr_b16 v[126:127], v5 offset:0
  v_fmac_f32 v118, v220, v223
  v_fmac_f32 v119, v232, v240
  ds_read_b64_tr_b16 v[136:137], v4 offset:32
  v_fmac_f32 v116, v233, v241
  ds_read_b64_tr_b16 v[138:139], v5 offset:32
  v_fmac_f32 v117, v234, v242
  ds_read_b64_tr_b16 v[148:149], v4 offset:64
  v_fmac_f32 v118, v235, v243
  ds_read_b64_tr_b16 v[150:151], v5 offset:64
  v_fmac_f32 v119, v236, v239
  ds_read_b64_tr_b16 v[160:161], v4 offset:96
  v_fmac_f32_e64 v116, v189, v196
  ds_read_b64_tr_b16 v[162:163], v5 offset:96
  v_fmac_f32 v117, v189, v197
  ds_read_b128 v[164:167], v1 offset:39936
  v_fmac_f32 v118, v190, v198
  ds_read_b128 v[168:171], v1 offset:40960
  v_fmac_f32 v119, v190, v199
  ds_read_b128 v[172:175], v1 offset:8192
  v_fmac_f32 v116, v205, v212
  ds_read_b128 v[176:179], v1 offset:6144
  v_fmac_f32_e64 v117, v205, v213
  ds_read_b64_tr_b16 v[70:71], v25 offset:0
  v_fmac_f32 v118, v206, v214
  ds_read_b64_tr_b16 v[84:85], v25 offset:32
  v_fmac_f32 v119, v206, v215
  ds_read_b64_tr_b16 v[98:99], v25 offset:64
  v_fmac_f32 v116, v221, v228
  v_fmac_f32 v117, v221, v229
  ds_read_b64_tr_b16 v[112:113], v25 offset:96
  v_fmac_f32 v118, v222, v230
  ds_read_b64_tr_b16 v[72:73], v26 offset:0
  v_fmac_f32 v119, v222, v231
  ds_read_b64_tr_b16 v[86:87], v26 offset:32
  v_fmac_f32 v116, v237, v244
  ds_read_b64_tr_b16 v[100:101], v26 offset:64
  v_fmac_f32 v117, v237, v245
  ds_read_b64_tr_b16 v[114:115], v26 offset:96
  v_fmac_f32 v118, v238, v246
  ds_read_b64_tr_b16 v[62:63], v21 offset:0
  v_fmac_f32 v119, v238, v247
  ds_read_b64_tr_b16 v[76:77], v21 offset:32
  v_add_f32_e64 v116, v116, v117
  ds_read_b64_tr_b16 v[90:91], v21 offset:64
  v_add_f32 v118, v118, v119
  ds_read_b64_tr_b16 v[104:105], v21 offset:96
  v_add_f32 v116, v116, v118
  ds_read_b64_tr_b16 v[64:65], v22 offset:0
  v_mul_f32 v116, s49, v116
  ds_read_b64_tr_b16 v[78:79], v22 offset:32
  v_mul_f32 v116, s50, v116
  ds_read_b64_tr_b16 v[92:93], v22 offset:64
  ds_write_b32 v7, v116
  ds_read_b64_tr_b16 v[106:107], v22 offset:96
  v_add_u32 v7, 256, v7
  s_waitcnt lgkmcnt(14)
  v_pk_mul_f16 v120, v60, v67 op_sel:[0,0] op_sel_hi:[0,1]
  v_pk_mul_f16 v121, v60, v67 op_sel:[1,0] op_sel_hi:[1,1]
  v_pk_mul_f16 v122, v60, v68 op_sel:[0,0] op_sel_hi:[0,1]
  v_pk_mul_f16 v123, v60, v68 op_sel:[1,0] op_sel_hi:[1,1]
  v_pk_mul_f16 v132, v74, v81 op_sel:[0,0] op_sel_hi:[0,1]
  v_pk_mul_f16 v133, v74, v81 op_sel:[1,0] op_sel_hi:[1,1]
  v_pk_mul_f16 v134, v74, v82 op_sel:[0,0] op_sel_hi:[0,1]
  v_pk_mul_f16 v135, v74, v82 op_sel:[1,0] op_sel_hi:[1,1]
  v_pk_mul_f16 v144, v88, v95 op_sel:[0,0] op_sel_hi:[0,1]
  v_pk_mul_f16 v145, v88, v95 op_sel:[1,0] op_sel_hi:[1,1]
  v_pk_mul_f16 v146, v88, v96 op_sel:[0,0] op_sel_hi:[0,1]
  v_pk_mul_f16 v147, v88, v96 op_sel:[1,0] op_sel_hi:[1,1]
  v_pk_mul_f16 v156, v102, v109 op_sel:[0,0] op_sel_hi:[0,1]
  v_pk_mul_f16 v157, v102, v109 op_sel:[1,0] op_sel_hi:[1,1]
  v_pk_mul_f16 v158, v102, v110 op_sel:[0,0] op_sel_hi:[0,1]
  v_pk_mul_f16 v159, v102, v110 op_sel:[1,0] op_sel_hi:[1,1]
  s_waitcnt vmcnt(0)
  v_lshl_add_u32 v16, v16, 7, v8
  v_lshl_add_u32 v17, v17, 7, v8
  v_lshl_add_u32 v18, v18, 7, v8
  v_lshl_add_u32 v19, v19, 7, v8
  s_add_u32 m0, s76, 0
  s_mov_b32 exec_hi, 0xffffff
  buffer_load_dwordx4 v16, s[32:35], 0 offen lds
  s_add_u32 m0, s76, 1056
  s_nop 0
  buffer_load_dwordx4 v17, s[32:35], 0 offen lds
  s_add_u32 m0, s76, 2112
  s_mov_b32 exec_hi, 0xffff
  buffer_load_dwordx4 v18, s[32:35], 0 offen lds
  s_add_u32 m0, s76, 3168
  s_nop 0
  buffer_load_dwordx4 v19, s[32:35], 0 offen lds
  s_mov_b32 exec_hi, -1
  buffer_load_dwordx4 v[16:19], v6, s[28:31], s94 offen
  s_add_u32 s94, s94, 416
L_novm:
  v_add_u32 v10, s81, v10
  v_add_u32 v4, s81, v4
  v_add_u32 v5, s81, v5
  s_sub_u32 s76, s76, s81
  s_sub_u32 s81, 0, s81
  s_mov_b32 s51, 0
  s_waitcnt lgkmcnt(14)
  s_setprio 1
  v_mfma_f32_16x16x32_bf16 v[184:187], v[164:167], v[124:127], 0
  ds_read_b128 v[180:183], v1 offset:7168
  v_pk_mul_f16 v116, v60, v69 op_sel:[0,0] op_sel_hi:[0,1]
  v_mfma_f32_16x16x32_bf16 v[200:203], v[164:167], v[136:139], 0
  v_pk_mul_f16 v117, v60, v69 op_sel:[1,0] op_sel_hi:[1,1]
  v_mfma_f32_16x16x32_bf16 v[216:219], v[164:167], v[148:151], 0
  v_pk_mul_f16 v118, v60, v70 op_sel:[0,0] op_sel_hi:[0,1]
  v_mfma_f32_16x16x32_bf16 v[232:235], v[164:167], v[160:163], 0
  v_pk_mul_f16 v119, v60, v70 op_sel:[1,0] op_sel_hi:[1,1]
  v_mfma_f32_16x16x32_bf16 v[188:191], v[168:171], v[124:127], 0
  ds_read_b128 v[164:167], v1 offset:5120
  v_pk_mul_f16 v128, v74, v83 op_sel:[0,0] op_sel_hi:[0,1]
  v_mfma_f32_16x16x32_bf16 v[204:207], v[168:171], v[136:139], 0
  v_pk_mul_f16 v129, v74, v83 op_sel:[1,0] op_sel_hi:[1,1]
  v_mfma_f32_16x16x32_bf16 v[220:223], v[168:171], v[148:151], 0
  v_pk_mul_f16 v130, v74, v84 op_sel:[0,0] op_sel_hi:[0,1]
  v_mfma_f32_16x16x32_bf16 v[236:239], v[168:171], v[160:163], 0
  v_pk_mul_f16 v131, v74, v84 op_sel:[1,0] op_sel_hi:[1,1]
  v_mfma_f32_16x16x32_f16 v[192:195], v[172:175], v[120:123], 0
  ds_read_b128 v[168:171], v1 offset:11264
  v_pk_mul_f16 v140, v88, v97 op_sel:[0,0] op_sel_hi:[0,1]
  v_mfma_f32_16x16x32_f16 v[208:211], v[172:175], v[132:135], 0
  v_pk_mul_f16 v141, v88, v97 op_sel:[1,0] op_sel_hi:[1,1]
  v_mfma_f32_16x16x32_f16 v[224:227], v[172:175], v[144:147], 0
  s_waitcnt lgkmcnt(14)
  v_pk_mul_f16 v142, v88, v98 op_sel:[0,0] op_sel_hi:[0,1]
  v_mfma_f32_16x16x32_f16 v[240:243], v[172:175], v[156:159], 0
  v_pk_mul_f16 v143, v88, v98 op_sel:[1,0] op_sel_hi:[1,1]
  v_mfma_f32_16x16x32_f16 v[184:187], v[176:179], v[120:123], v[184:187]
  ds_read_b128 v[172:175], v1 offset:9216
  v_pk_mul_f16 v152, v102, v111 op_sel:[0,0] op_sel_hi:[0,1]
  v_mfma_f32_16x16x32_f16 v[200:203], v[176:179], v[132:135], v[200:203]
  s_nop 0
  v_pk_mul_f16 v153, v102, v111 op_sel:[1,0] op_sel_hi:[1,1]
  v_mfma_f32_16x16x32_f16 v[216:219], v[176:179], v[144:147], v[216:219]
  s_setprio 2
  s_waitcnt lgkmcnt(14)
  v_pk_mul_f16 v154, v102, v112 op_sel:[0,0] op_sel_hi:[0,1]
  v_mfma_f32_16x16x32_f16 v[232:235], v[176:179], v[156:159], v[232:235]
  s_nop 0
  s_waitcnt lgkmcnt(3)
  v_pk_mul_f16 v155, v102, v112 op_sel:[1,0] op_sel_hi:[1,1]
  v_mfma_f32_16x16x32_f16 v[188:191], v[180:183], v[120:123], v[188:191]
  ds_read_b128 v[176:179], v1 offset:10240
  v_pk_mul_f16 v124, v61, v68 op_sel:[0,0] op_sel_hi:[0,1]
  v_mfma_f32_16x16x32_f16 v[204:207], v[180:183], v[132:135], v[204:207]
  v_pk_mul_f16 v125, v61, v68 op_sel:[1,0] op_sel_hi:[1,1]
  v_mfma_f32_16x16x32_f16 v[220:223], v[180:183], v[144:147], v[220:223]
  v_pk_mul_f16 v126, v61, v69 op_sel:[0,0] op_sel_hi:[0,1]
  v_mfma_f32_16x16x32_f16 v[236:239], v[180:183], v[156:159], v[236:239]
  s_nop 0
  s_waitcnt lgkmcnt(3)
  v_pk_mul_f16 v127, v61, v69 op_sel:[1,0] op_sel_hi:[1,1]
  v_mfma_f32_16x16x32_f16 v[196:199], v[164:167], v[120:123], 0
  ds_read_b128 v[180:183], v1 offset:14336
  v_pk_mul_f16 v136, v75, v82 op_sel:[0,0] op_sel_hi:[0,1]
  v_mfma_f32_16x16x32_f16 v[212:215], v[164:167], v[132:135], 0
  v_pk_mul_f16 v120, v60, v71 op_sel:[0,0] op_sel_hi:[0,1]
  v_mfma_f32_16x16x32_f16 v[228:231], v[164:167], v[144:147], 0
  v_pk_mul_f16 v121, v60, v71 op_sel:[1,0] op_sel_hi:[1,1]
  v_mfma_f32_16x16x32_f16 v[244:247], v[164:167], v[156:159], 0
  s_waitcnt lgkmcnt(3)
  v_pk_mul_f16 v122, v60, v66 op_sel:[0,1] op_sel_hi:[0,0]
  v_mfma_f32_16x16x32_f16 v[192:195], v[168:171], v[116:119], v[192:195]
  ds_read_b128 v[164:167], v1 offset:12288
  v_pk_mul_f16 v123, v60, v72 op_sel:[0,0] op_sel_hi:[1,0]
  v_mfma_f32_16x16x32_f16 v[208:211], v[168:171], v[128:131], v[208:211]
  s_nop 0
  v_pk_mul_f16 v132, v74, v85 op_sel:[0,0] op_sel_hi:[0,1]
  v_mfma_f32_16x16x32_f16 v[224:227], v[168:171], v[140:143], v[224:227]
  v_pk_mul_f16 v133, v74, v85 op_sel:[1,0] op_sel_hi:[1,1]
  v_mfma_f32_16x16x32_f16 v[240:243], v[168:171], v[152:155], v[240:243]
  s_nop 0
  s_waitcnt lgkmcnt(3)
  v_pk_mul_f16 v134, v74, v80 op_sel:[0,1] op_sel_hi:[0,0]
  v_mfma_f32_16x16x32_f16 v[184:187], v[172:175], v[116:119], v[184:187]
  ds_read_b128 v[168:171], v1 offset:13312
  v_pk_mul_f16 v135, v74, v86 op_sel:[0,0] op_sel_hi:[1,0]
  v_mfma_f32_16x16x32_f16 v[200:203], v[172:175], v[128:131], v[200:203]
  v_pk_mul_f16 v144, v88, v99 op_sel:[0,0] op_sel_hi:[0,1]
  v_mfma_f32_16x16x32_f16 v[216:219], v[172:175], v[140:143], v[216:219]
  v_pk_mul_f16 v145, v88, v99 op_sel:[1,0] op_sel_hi:[1,1]
  v_mfma_f32_16x16x32_f16 v[232:235], v[172:175], v[152:155], v[232:235]
  s_nop 0
  s_waitcnt lgkmcnt(3)
  v_pk_mul_f16 v146, v88, v94 op_sel:[0,1] op_sel_hi:[0,0]
  v_mfma_f32_16x16x32_f16 v[188:191], v[176:179], v[116:119], v[188:191]
  ds_read_b128 v[172:175], v1 offset:0
  v_pk_mul_f16 v147, v88, v100 op_sel:[0,0] op_sel_hi:[1,0]
  v_mfma_f32_16x16x32_f16 v[204:207], v[176:179], v[128:131], v[204:207]
  v_pk_mul_f16 v156, v102, v113 op_sel:[0,0] op_sel_hi:[0,1]
  v_mfma_f32_16x16x32_f16 v[220:223], v[176:179], v[140:143], v[220:223]
  v_pk_mul_f16 v157, v102, v113 op_sel:[1,0] op_sel_hi:[1,1]
  v_mfma_f32_16x16x32_f16 v[236:239], v[176:179], v[152:155], v[236:239]
  s_nop 0
  s_waitcnt lgkmcnt(3)
  v_pk_mul_f16 v158, v102, v108 op_sel:[0,1] op_sel_hi:[0,0]
  v_mfma_f32_16x16x32_f16 v[192:195], v[180:183], v[120:123], v[192:195]
  ds_read_b128 v[176:179], v1 offset:17408
  v_pk_mul_f16 v159, v102, v114 op_sel:[0,0] op_sel_hi:[1,0]
  v_mfma_f32_16x16x32_f16 v[208:211], v[180:183], v[132:135], v[208:211]
  v_pk_mul_f16 v137, v75, v82 op_sel:[1,0] op_sel_hi:[1,1]
  v_mfma_f32_16x16x32_f16 v[224:227], v[180:183], v[144:147], v[224:227]
  v_pk_mul_f16 v138, v75, v83 op_sel:[0,0] op_sel_hi:[0,1]
  v_mfma_f32_16x16x32_f16 v[240:243], v[180:183], v[156:159], v[240:243]
  s_waitcnt lgkmcnt(3)
  v_pk_mul_f16 v139, v75, v83 op_sel:[1,0] op_sel_hi:[1,1]
  v_mfma_f32_16x16x32_f16 v[184:187], v[164:167], v[120:123], v[184:187]
  ds_read_b128 v[180:183], v1 offset:15360
  v_pk_mul_f16 v148, v89, v96 op_sel:[0,0] op_sel_hi:[0,1]
  v_mfma_f32_16x16x32_f16 v[200:203], v[164:167], v[132:135], v[200:203]
  s_nop 0
  v_pk_mul_f16 v149, v89, v96 op_sel:[1,0] op_sel_hi:[1,1]
  v_mfma_f32_16x16x32_f16 v[216:219], v[164:167], v[144:147], v[216:219]
  v_pk_mul_f16 v150, v89, v97 op_sel:[0,0] op_sel_hi:[0,1]
  v_mfma_f32_16x16x32_f16 v[232:235], v[164:167], v[156:159], v[232:235]
  s_nop 0
  s_waitcnt lgkmcnt(3)
  v_pk_mul_f16 v151, v89, v97 op_sel:[1,0] op_sel_hi:[1,1]
  v_mfma_f32_16x16x32_f16 v[188:191], v[168:171], v[120:123], v[188:191]
  ds_read_b128 v[164:167], v1 offset:16384
  v_pk_mul_f16 v160, v103, v110 op_sel:[0,0] op_sel_hi:[0,1]
  v_mfma_f32_16x16x32_f16 v[204:207], v[168:171], v[132:135], v[204:207]
  v_pk_mul_f16 v161, v103, v110 op_sel:[1,0] op_sel_hi:[1,1]
  v_mfma_f32_16x16x32_f16 v[220:223], v[168:171], v[144:147], v[220:223]
  v_pk_mul_f16 v162, v103, v111 op_sel:[0,0] op_sel_hi:[0,1]
  v_mfma_f32_16x16x32_f16 v[236:239], v[168:171], v[156:159], v[236:239]
  s_waitcnt lgkmcnt(3)
  v_pk_mul_f16 v163, v103, v111 op_sel:[1,0] op_sel_hi:[1,1]
  v_smfmac_f32_16x16x64_f16 v[196:199], v[172:175], v[116:123], v9
  s_nop 0
  ds_read_b128 v[168:171], v1 offset:20480
  v_smfmac_f32_16x16x64_f16 v[212:215], v[172:175], v[128:135], v9
  v_pk_mul_f16 v120, v61, v70 op_sel:[0,0] op_sel_hi:[0,1]
  v_smfmac_f32_16x16x64_f16 v[228:231], v[172:175], v[140:147], v9
  v_pk_mul_f16 v121, v61, v70 op_sel:[1,0] op_sel_hi:[1,1]
  v_smfmac_f32_16x16x64_f16 v[244:247], v[172:175], v[152:159], v9
  s_nop 0
  s_waitcnt lgkmcnt(3)
  v_pk_mul_f16 v122, v61, v71 op_sel:[0,0] op_sel_hi:[0,1]
  v_mfma_f32_16x16x32_f16 v[192:195], v[176:179], v[124:127], v[192:195]
  ds_read_b128 v[172:175], v1 offset:18432
  v_pk_mul_f16 v123, v61, v71 op_sel:[1,0] op_sel_hi:[1,1]
  v_mfma_f32_16x16x32_f16 v[208:211], v[176:179], v[136:139], v[208:211]
  v_pk_mul_f16 v132, v75, v84 op_sel:[0,0] op_sel_hi:[0,1]
  v_mfma_f32_16x16x32_f16 v[224:227], v[176:179], v[148:151], v[224:227]
  v_pk_mul_f16 v133, v75, v84 op_sel:[1,0] op_sel_hi:[1,1]
  v_mfma_f32_16x16x32_f16 v[240:243], v[176:179], v[160:163], v[240:243]
  s_waitcnt lgkmcnt(3)
  v_pk_mul_f16 v134, v75, v85 op_sel:[0,0] op_sel_hi:[0,1]
  v_mfma_f32_16x16x32_f16 v[184:187], v[180:183], v[124:127], v[184:187]
  ds_read_b128 v[176:179], v1 offset:19456
  v_pk_mul_f16 v135, v75, v85 op_sel:[1,0] op_sel_hi:[1,1]
  v_mfma_f32_16x16x32_f16 v[200:203], v[180:183], v[136:139], v[200:203]
  v_pk_mul_f16 v144, v89, v98 op_sel:[0,0] op_sel_hi:[0,1]
  v_mfma_f32_16x16x32_f16 v[216:219], v[180:183], v[148:151], v[216:219]
  s_nop 0
  v_pk_mul_f16 v145, v89, v98 op_sel:[1,0] op_sel_hi:[1,1]
  v_mfma_f32_16x16x32_f16 v[232:235], v[180:183], v[160:163], v[232:235]
  s_waitcnt lgkmcnt(3)
  v_pk_mul_f16 v146, v89, v99 op_sel:[0,0] op_sel_hi:[0,1]
  v_mfma_f32_16x16x32_f16 v[188:191], v[164:167], v[124:127], v[188:191]
  ds_read_b128 v[180:183], v1 offset:1024
  v_pk_mul_f16 v147, v89, v99 op_sel:[1,0] op_sel_hi:[1,1]
  v_mfma_f32_16x16x32_f16 v[204:207], v[164:167], v[136:139], v[204:207]
  s_waitcnt vmcnt(1)
  ds_read_u16_d16_hi v32, v10 offset:0
  v_pk_mul_f16 v156, v103, v112 op_sel:[0,0] op_sel_hi:[0,1]
  v_mfma_f32_16x16x32_f16 v[220:223], v[164:167], v[148:151], v[220:223]
  ds_read_u16_d16_hi v33, v10 offset:2
  v_pk_mul_f16 v157, v103, v112 op_sel:[1,0] op_sel_hi:[1,1]
  v_mfma_f32_16x16x32_f16 v[236:239], v[164:167], v[160:163], v[236:239]
  s_nop 0
  s_waitcnt lgkmcnt(5)
  v_pk_mul_f16 v158, v103, v113 op_sel:[0,0] op_sel_hi:[0,1]
  v_mfma_f32_16x16x32_f16 v[192:195], v[168:171], v[120:123], v[192:195]
  ds_read_b128 v[164:167], v1 offset:23552
  v_pk_mul_f16 v159, v103, v113 op_sel:[1,0] op_sel_hi:[1,1]
  v_mfma_f32_16x16x32_f16 v[208:211], v[168:171], v[132:135], v[208:211]
  ds_read_u16_d16_hi v34, v10 offset:2112
  v_pk_mul_f16 v116, v61, v67 op_sel:[0,1] op_sel_hi:[0,0]
  v_mfma_f32_16x16x32_f16 v[224:227], v[168:171], v[144:147], v[224:227]
  ds_read_u16_d16_hi v35, v10 offset:2114
  v_pk_mul_f16 v117, v61, v72 op_sel:[0,0] op_sel_hi:[1,0]
  v_mfma_f32_16x16x32_f16 v[240:243], v[168:171], v[156:159], v[240:243]
  s_nop 0
  s_waitcnt lgkmcnt(7)
  v_pk_mul_f16 v118, v62, v69 op_sel:[0,0] op_sel_hi:[0,1]
  v_mfma_f32_16x16x32_f16 v[184:187], v[172:175], v[120:123], v[184:187]
  ds_read_b128 v[168:171], v1 offset:21504
  v_pk_mul_f16 v119, v62, v69 op_sel:[1,0] op_sel_hi:[1,1]
  v_mfma_f32_16x16x32_f16 v[200:203], v[172:175], v[132:135], v[200:203]
  ds_read_b64_tr_b16 v[60:61], v27 offset:0
  v_pk_mul_f16 v128, v75, v81 op_sel:[0,1] op_sel_hi:[0,0]
  v_mfma_f32_16x16x32_f16 v[216:219], v[172:175], v[144:147], v[216:219]
  ds_read_u16_d16_hi v36, v10 offset:128
  v_pk_mul_f16 v129, v75, v86 op_sel:[0,0] op_sel_hi:[1,0]
  v_mfma_f32_16x16x32_f16 v[232:235], v[172:175], v[156:159], v[232:235]
  s_waitcnt lgkmcnt(9)
  v_pk_mul_f16 v130, v76, v83 op_sel:[0,0] op_sel_hi:[0,1]
  v_pk_mul_f16 v131, v76, v83 op_sel:[1,0] op_sel_hi:[1,1]
  v_mfma_f32_16x16x32_f16 v[188:191], v[176:179], v[120:123], v[188:191]
  ds_read_b128 v[172:175], v1 offset:22528
  v_pk_mul_f16 v140, v89, v95 op_sel:[0,1] op_sel_hi:[0,0]
  v_mfma_f32_16x16x32_f16 v[204:207], v[176:179], v[132:135], v[204:207]
  ds_read_b64_tr_b16 v[74:75], v27 offset:32
  v_pk_mul_f16 v141, v89, v100 op_sel:[0,0] op_sel_hi:[1,0]
  v_mfma_f32_16x16x32_f16 v[220:223], v[176:179], v[144:147], v[220:223]
  ds_read_b64_tr_b16 v[88:89], v27 offset:64
  v_pk_mul_f16 v142, v90, v97 op_sel:[0,0] op_sel_hi:[0,1]
  v_mfma_f32_16x16x32_f16 v[236:239], v[176:179], v[156:159], v[236:239]
  s_waitcnt lgkmcnt(11)
  v_pk_mul_f16 v143, v90, v97 op_sel:[1,0] op_sel_hi:[1,1]
  v_pk_mul_f16 v152, v103, v109 op_sel:[0,1] op_sel_hi:[0,0]
  v_smfmac_f32_16x16x64_f16 v[196:199], v[180:183], v[120:127], v9
  ds_read_b128 v[176:179], v1 offset:26624
  v_pk_mul_f16 v153, v103, v114 op_sel:[0,0] op_sel_hi:[1,0]
  v_smfmac_f32_16x16x64_f16 v[212:215], v[180:183], v[132:139], v9
  ds_read_b64_tr_b16 v[102:103], v27 offset:96
  v_pk_mul_f16 v154, v104, v111 op_sel:[0,0] op_sel_hi:[0,1]
  v_smfmac_f32_16x16x64_f16 v[228:231], v[180:183], v[144:151], v9
  ds_read_u16_d16_hi v37, v10 offset:130
  v_pk_mul_f16 v155, v104, v111 op_sel:[1,0] op_sel_hi:[1,1]
  v_smfmac_f32_16x16x64_f16 v[244:247], v[180:183], v[156:163], v9
  s_nop 0
  s_waitcnt lgkmcnt(11)
  v_pk_mul_f16 v120, v62, v70 op_sel:[0,0] op_sel_hi:[0,1]
  v_mfma_f32_16x16x32_f16 v[192:195], v[164:167], v[116:119], v[192:195]
  ds_read_b128 v[180:183], v1 offset:24576
  v_pk_mul_f16 v121, v62, v70 op_sel:[1,0] op_sel_hi:[1,1]
  v_mfma_f32_16x16x32_f16 v[208:211], v[164:167], v[128:131], v[208:211]
  ds_read_u16_d16_hi v38, v10 offset:2240
  v_pk_mul_f16 v122, v62, v71 op_sel:[0,0] op_sel_hi:[0,1]
  v_mfma_f32_16x16x32_f16 v[224:227], v[164:167], v[140:143], v[224:227]
  ds_read_u16_d16_hi v39, v10 offset:2242
  v_pk_mul_f16 v123, v62, v71 op_sel:[1,0] op_sel_hi:[1,1]
  v_mfma_f32_16x16x32_f16 v[240:243], v[164:167], v[152:155], v[240:243]
  s_waitcnt lgkmcnt(11)
  v_pk_mul_f16 v132, v76, v84 op_sel:[0,0] op_sel_hi:[0,1]
  v_max3_f32 v58, |v32|, |v33|, 0
  v_mfma_f32_16x16x32_f16 v[184:187], v[168:171], v[116:119], v[184:187]
  ds_read_b128 v[164:167], v1 offset:25600
  v_pk_mul_f16 v133, v76, v84 op_sel:[1,0] op_sel_hi:[1,1]
  v_mfma_f32_16x16x32_f16 v[200:203], v[168:171], v[128:131], v[200:203]
  ds_read_u16_d16_hi v40, v10 offset:256
  v_pk_mul_f16 v134, v76, v85 op_sel:[0,0] op_sel_hi:[0,1]
  v_mfma_f32_16x16x32_f16 v[216:219], v[168:171], v[140:143], v[216:219]
  ds_read_u16_d16_hi v41, v10 offset:258
  v_pk_mul_f16 v135, v76, v85 op_sel:[1,0] op_sel_hi:[1,1]
  v_mfma_f32_16x16x32_f16 v[232:235], v[168:171], v[152:155], v[232:235]
  s_waitcnt lgkmcnt(11)
  v_pk_mul_f16 v144, v90, v98 op_sel:[0,0] op_sel_hi:[0,1]
  v_max3_f32 v58, |v34|, |v35|, v58
  v_mfma_f32_16x16x32_f16 v[188:191], v[172:175], v[116:119], v[188:191]
  ds_read_b128 v[168:171], v1 offset:2048
  v_pk_mul_f16 v145, v90, v98 op_sel:[1,0] op_sel_hi:[1,1]
  v_mfma_f32_16x16x32_f16 v[204:207], v[172:175], v[128:131], v[204:207]
  ds_read_u16_d16_hi v42, v10 offset:2368
  v_pk_mul_f16 v146, v90, v99 op_sel:[0,0] op_sel_hi:[0,1]
  v_mfma_f32_16x16x32_f16 v[220:223], v[172:175], v[140:143], v[220:223]
  ds_read_u16_d16_hi v43, v10 offset:2370
  v_pk_mul_f16 v147, v90, v99 op_sel:[1,0] op_sel_hi:[1,1]
  v_mfma_f32_16x16x32_f16 v[236:239], v[172:175], v[152:155], v[236:239]
  s_nop 0
  s_waitcnt lgkmcnt(11)
  v_pk_mul_f16 v156, v104, v112 op_sel:[0,0] op_sel_hi:[0,1]
  v_mfma_f32_16x16x32_f16 v[192:195], v[176:179], v[120:123], v[192:195]
  ds_read_b128 v[172:175], v1 offset:29696
  v_pk_mul_f16 v157, v104, v112 op_sel:[1,0] op_sel_hi:[1,1]
  v_mfma_f32_16x16x32_f16 v[208:211], v[176:179], v[132:135], v[208:211]
  ds_read_u16_d16_hi v44, v10 offset:384
  v_pk_mul_f16 v158, v104, v113 op_sel:[0,0] op_sel_hi:[0,1]
  v_mfma_f32_16x16x32_f16 v[224:227], v[176:179], v[144:147], v[224:227]
  ds_read_u16_d16_hi v45, v10 offset:386
  v_pk_mul_f16 v159, v104, v113 op_sel:[1,0] op_sel_hi:[1,1]
  s_nop 1
  v_mfma_f32_16x16x32_f16 v[240:243], v[176:179], v[156:159], v[240:243]
  s_waitcnt lgkmcnt(11)
  v_pk_mul_f16 v124, v62, v68 op_sel:[0,1] op_sel_hi:[0,0]
  v_mfma_f32_16x16x32_f16 v[184:187], v[180:183], v[120:123], v[184:187]
  ds_read_b128 v[176:179], v1 offset:27648
  v_pk_mul_f16 v125, v62, v72 op_sel:[0,0] op_sel_hi:[1,0]
  v_mfma_f32_16x16x32_f16 v[200:203], v[180:183], v[132:135], v[200:203]
  ds_read_u16_d16_hi v46, v10 offset:2496
  v_pk_mul_f16 v126, v63, v70 op_sel:[0,0] op_sel_hi:[0,1]
  v_mfma_f32_16x16x32_f16 v[216:219], v[180:183], v[144:147], v[216:219]
  ds_read_u16_d16_hi v47, v10 offset:2498
  v_pk_mul_f16 v127, v63, v70 op_sel:[1,0] op_sel_hi:[1,1]
  v_mfma_f32_16x16x32_f16 v[232:235], v[180:183], v[156:159], v[232:235]
  s_waitcnt lgkmcnt(11)
  v_pk_mul_f16 v136, v76, v82 op_sel:[0,1] op_sel_hi:[0,0]
  v_pk_mul_f16 v137, v76, v86 op_sel:[0,0] op_sel_hi:[1,0]
  v_mfma_f32_16x16x32_f16 v[188:191], v[164:167], v[120:123], v[188:191]
  ds_read_b128 v[180:183], v1 offset:28672
  v_pk_mul_f16 v138, v77, v84 op_sel:[0,0] op_sel_hi:[0,1]
  v_mfma_f32_16x16x32_f16 v[204:207], v[164:167], v[132:135], v[204:207]
  ds_read_u16_d16_hi v48, v10 offset:512
  v_pk_mul_f16 v139, v77, v84 op_sel:[1,0] op_sel_hi:[1,1]
  v_mfma_f32_16x16x32_f16 v[220:223], v[164:167], v[144:147], v[220:223]
  ds_read_u16_d16_hi v49, v10 offset:514
  v_pk_mul_f16 v148, v90, v96 op_sel:[0,1] op_sel_hi:[0,0]
  v_mfma_f32_16x16x32_f16 v[236:239], v[164:167], v[156:159], v[236:239]
  s_waitcnt lgkmcnt(11)
  v_pk_mul_f16 v149, v90, v100 op_sel:[0,0] op_sel_hi:[1,0]
  v_pk_mul_f16 v150, v91, v98 op_sel:[0,0] op_sel_hi:[0,1]
  v_smfmac_f32_16x16x64_f16 v[196:199], v[168:171], v[116:123], v9
  ds_read_b128 v[164:167], v1 offset:32768
  v_pk_mul_f16 v151, v91, v98 op_sel:[1,0] op_sel_hi:[1,1]
  v_smfmac_f32_16x16x64_f16 v[212:215], v[168:171], v[128:135], v9
  ds_read_u16_d16_hi v50, v10 offset:2624
  v_pk_mul_f16 v160, v104, v110 op_sel:[0,1] op_sel_hi:[0,0]
  v_smfmac_f32_16x16x64_f16 v[228:231], v[168:171], v[140:147], v9
  ds_read_u16_d16_hi v51, v10 offset:2626
  v_pk_mul_f16 v161, v104, v114 op_sel:[0,0] op_sel_hi:[1,0]
  v_smfmac_f32_16x16x64_f16 v[244:247], v[168:171], v[152:159], v9
  s_nop 0
  s_waitcnt lgkmcnt(11)
  v_pk_mul_f16 v162, v105, v112 op_sel:[0,0] op_sel_hi:[0,1]
  v_mfma_f32_16x16x32_f16 v[192:195], v[172:175], v[124:127], v[192:195]
  ds_read_b128 v[168:171], v1 offset:30720
  v_pk_mul_f16 v163, v105, v112 op_sel:[1,0] op_sel_hi:[1,1]
  v_mfma_f32_16x16x32_f16 v[208:211], v[172:175], v[136:139], v[208:211]
  ds_read_u16_d16_hi v52, v10 offset:640
  v_pk_mul_f16 v120, v63, v71 op_sel:[0,0] op_sel_hi:[0,1]
  v_mfma_f32_16x16x32_f16 v[224:227], v[172:175], v[148:151], v[224:227]
  ds_read_u16_d16_hi v53, v10 offset:642
  v_pk_mul_f16 v121, v63, v71 op_sel:[1,0] op_sel_hi:[1,1]
  v_mfma_f32_16x16x32_f16 v[240:243], v[172:175], v[160:163], v[240:243]
  s_waitcnt lgkmcnt(11)
  v_pk_mul_f16 v122, v63, v69 op_sel:[0,1] op_sel_hi:[1,1]
  v_pk_mul_f16 v123, v63, v72 op_sel:[0,0] op_sel_hi:[1,0]
  v_mfma_f32_16x16x32_f16 v[184:187], v[176:179], v[124:127], v[184:187]
  ds_read_b128 v[172:175], v1 offset:31744
  v_pk_mul_f16 v132, v77, v85 op_sel:[0,0] op_sel_hi:[0,1]
  v_mfma_f32_16x16x32_f16 v[200:203], v[176:179], v[136:139], v[200:203]
  ds_read_u16_d16_hi v54, v10 offset:2752
  v_pk_mul_f16 v133, v77, v85 op_sel:[1,0] op_sel_hi:[1,1]
  v_mfma_f32_16x16x32_f16 v[216:219], v[176:179], v[148:151], v[216:219]
  ds_read_u16_d16_hi v55, v10 offset:2754
  v_pk_mul_f16 v134, v77, v83 op_sel:[0,1] op_sel_hi:[1,1]
  v_mfma_f32_16x16x32_f16 v[232:235], v[176:179], v[160:163], v[232:235]
  s_waitcnt lgkmcnt(11)
  v_pk_mul_f16 v135, v77, v86 op_sel:[0,0] op_sel_hi:[1,0]
  v_pk_mul_f16 v144, v91, v99 op_sel:[0,0] op_sel_hi:[0,1]
  v_mfma_f32_16x16x32_f16 v[188:191], v[180:183], v[124:127], v[188:191]
  ds_read_b128 v[176:179], v1 offset:3072
  v_pk_mul_f16 v145, v91, v99 op_sel:[1,0] op_sel_hi:[1,1]
  v_mfma_f32_16x16x32_f16 v[204:207], v[180:183], v[136:139], v[204:207]
  ds_read_u16_d16_hi v56, v10 offset:768
  v_pk_mul_f16 v146, v91, v97 op_sel:[0,1] op_sel_hi:[1,1]
  v_mfma_f32_16x16x32_f16 v[220:223], v[180:183], v[148:151], v[220:223]
  ds_read_u16_d16_hi v57, v10 offset:770
  v_pk_mul_f16 v147, v91, v100 op_sel:[0,0] op_sel_hi:[1,0]
  v_mfma_f32_16x16x32_f16 v[236:239], v[180:183], v[160:163], v[236:239]
  s_waitcnt lgkmcnt(11)
  v_pk_mul_f16 v156, v105, v113 op_sel:[0,0] op_sel_hi:[0,1]
  v_max3_f32 v58, |v36|, |v37|, v58
  v_mfma_f32_16x16x32_f16 v[192:195], v[164:167], v[120:123], v[192:195]
  ds_read_b128 v[180:183], v1 offset:35840
  v_pk_mul_f16 v157, v105, v113 op_sel:[1,0] op_sel_hi:[1,1]
  v_mfma_f32_16x16x32_f16 v[208:211], v[164:167], v[132:135], v[208:211]
  v_pk_mul_f16 v158, v105, v111 op_sel:[0,1] op_sel_hi:[1,1]
  v_max3_f32 v58, |v38|, |v39|, v58
  v_mfma_f32_16x16x32_f16 v[224:227], v[164:167], v[144:147], v[224:227]
  v_pk_mul_f16 v159, v105, v114 op_sel:[0,0] op_sel_hi:[1,0]
  v_max3_f32 v58, |v40|, |v41|, v58
  s_nop 0
  v_mfma_f32_16x16x32_f16 v[240:243], v[164:167], v[156:159], v[240:243]
  s_nop 0
  s_waitcnt lgkmcnt(9)
  v_pk_mul_f16 v116, v64, v71 op_sel:[0,0] op_sel_hi:[0,1]
  v_mfma_f32_16x16x32_f16 v[184:187], v[168:171], v[120:123], v[184:187]
  ds_read_b128 v[164:167], v1 offset:33792
  v_pk_mul_f16 v117, v64, v71 op_sel:[1,0] op_sel_hi:[1,1]
  v_mfma_f32_16x16x32_f16 v[200:203], v[168:171], v[132:135], v[200:203]
  v_pk_mul_f16 v118, v64, v70 op_sel:[0,1] op_sel_hi:[1,1]
  v_max3_f32 v58, |v42|, |v43|, v58
  v_mfma_f32_16x16x32_f16 v[216:219], v[168:171], v[144:147], v[216:219]
  v_pk_mul_f16 v119, v64, v72 op_sel:[0,0] op_sel_hi:[1,0]
  v_pk_mul_f16 v128, v78, v85 op_sel:[0,0] op_sel_hi:[0,1]
  v_mfma_f32_16x16x32_f16 v[232:235], v[168:171], v[156:159], v[232:235]
  s_waitcnt lgkmcnt(7)
  v_pk_mul_f16 v129, v78, v85 op_sel:[1,0] op_sel_hi:[1,1]
  v_pk_mul_f16 v130, v78, v84 op_sel:[0,1] op_sel_hi:[1,1]
  v_mfma_f32_16x16x32_f16 v[188:191], v[172:175], v[120:123], v[188:191]
  ds_read_b128 v[168:171], v1 offset:34816
  v_pk_mul_f16 v131, v78, v86 op_sel:[0,0] op_sel_hi:[1,0]
  v_mfma_f32_16x16x32_f16 v[204:207], v[172:175], v[132:135], v[204:207]
  v_pk_mul_f16 v140, v92, v99 op_sel:[0,0] op_sel_hi:[0,1]
  v_pk_mul_f16 v141, v92, v99 op_sel:[1,0] op_sel_hi:[1,1]
  v_mfma_f32_16x16x32_f16 v[220:223], v[172:175], v[144:147], v[220:223]
  v_pk_mul_f16 v142, v92, v98 op_sel:[0,1] op_sel_hi:[1,1]
  v_pk_mul_f16 v143, v92, v100 op_sel:[0,0] op_sel_hi:[1,0]
  v_mfma_f32_16x16x32_f16 v[236:239], v[172:175], v[156:159], v[236:239]
  s_waitcnt lgkmcnt(5)
  v_pk_mul_f16 v152, v106, v113 op_sel:[0,0] op_sel_hi:[0,1]
  v_smfmac_f32_16x16x64_f16 v[196:199], v[176:179], v[120:127], v9
  ds_read_b128 v[172:175], v1 offset:38912
  v_pk_mul_f16 v153, v106, v113 op_sel:[1,0] op_sel_hi:[1,1]
  v_smfmac_f32_16x16x64_f16 v[212:215], v[176:179], v[132:139], v9
  v_pk_mul_f16 v154, v106, v112 op_sel:[0,1] op_sel_hi:[1,1]
  v_smfmac_f32_16x16x64_f16 v[228:231], v[176:179], v[144:151], v9
  v_pk_mul_f16 v155, v106, v114 op_sel:[0,0] op_sel_hi:[1,0]
  v_smfmac_f32_16x16x64_f16 v[244:247], v[176:179], v[156:163], v9
  s_waitcnt lgkmcnt(3)
  v_pk_mul_f16 v120, v65, v71 op_sel:[0,1] op_sel_hi:[1,1]
  v_mfma_f32_16x16x32_f16 v[192:195], v[180:183], v[116:119], v[192:195]
  ds_read_b128 v[176:179], v1 offset:36864
  v_pk_mul_f16 v121, v65, v72 op_sel:[0,0] op_sel_hi:[1,0]
  v_mfma_f32_16x16x32_f16 v[208:211], v[180:183], v[128:131], v[208:211]
  s_nop 0
  v_pk_mul_f16 v122, v72, v72 op_sel:[0,0] op_sel_hi:[1,1]
  v_max3_f32 v58, |v44|, |v45|, v58
  v_mfma_f32_16x16x32_f16 v[224:227], v[180:183], v[140:143], v[224:227]
  v_pk_mul_f16 v123, v60, v61 op_sel:[0,0] op_sel_hi:[1,1]
  v_max3_f32 v58, |v46|, |v47|, v58
  v_mfma_f32_16x16x32_f16 v[240:243], v[180:183], v[152:155], v[240:243]
  s_nop 0
  s_waitcnt lgkmcnt(3)
  v_pk_mul_f16 v132, v79, v85 op_sel:[0,1] op_sel_hi:[1,1]
  v_mfma_f32_16x16x32_f16 v[184:187], v[164:167], v[116:119], v[184:187]
  ds_read_b128 v[180:183], v1 offset:37888
  v_pk_mul_f16 v133, v79, v86 op_sel:[0,0] op_sel_hi:[1,0]
  v_mfma_f32_16x16x32_f16 v[200:203], v[164:167], v[128:131], v[200:203]
  v_pk_mul_f16 v134, v86, v86 op_sel:[0,0] op_sel_hi:[1,1]
  v_max3_f32 v58, |v48|, |v49|, v58
  v_mfma_f32_16x16x32_f16 v[216:219], v[164:167], v[140:143], v[216:219]
  v_pk_mul_f16 v135, v74, v75 op_sel:[0,0] op_sel_hi:[1,1]
  v_max3_f32 v58, |v50|, |v51|, v58
  v_mfma_f32_16x16x32_f16 v[232:235], v[164:167], v[152:155], v[232:235]
  s_waitcnt lgkmcnt(3)
  v_pk_mul_f16 v144, v93, v99 op_sel:[0,1] op_sel_hi:[1,1]
  v_mfma_f32_16x16x32_f16 v[188:191], v[168:171], v[116:119], v[188:191]
  ds_read_b128 v[164:167], v1 offset:4096
  v_pk_mul_f16 v145, v93, v100 op_sel:[0,0] op_sel_hi:[1,0]
  v_mfma_f32_16x16x32_f16 v[204:207], v[168:171], v[128:131], v[204:207]
  s_nop 0
  v_pk_mul_f16 v146, v100, v100 op_sel:[0,0] op_sel_hi:[1,1]
  v_max3_f32 v58, |v52|, |v53|, v58
  v_mfma_f32_16x16x32_f16 v[220:223], v[168:171], v[140:143], v[220:223]
  v_pk_mul_f16 v147, v88, v89 op_sel:[0,0] op_sel_hi:[1,1]
  v_max3_f32 v58, |v54|, |v55|, v58
  v_mfma_f32_16x16x32_f16 v[236:239], v[168:171], v[152:155], v[236:239]
  s_waitcnt lgkmcnt(3)
  v_pk_mul_f16 v156, v107, v113 op_sel:[0,1] op_sel_hi:[1,1]
  v_mfma_f32_16x16x32_f16 v[192:195], v[172:175], v[120:123], v[192:195]
  s_nop 0
  v_pk_mul_f16 v157, v107, v114 op_sel:[0,0] op_sel_hi:[1,0]
  v_max3_f32 v58, |v56|, |v57|, v58
  v_mfma_f32_16x16x32_f16 v[208:211], v[172:175], v[132:135], v[208:211]
  v_pk_mul_f16 v158, v114, v114 op_sel:[0,0] op_sel_hi:[1,1]
  v_cvt_pk_f16_f32 v62, v32, v33
  v_mfma_f32_16x16x32_f16 v[224:227], v[172:175], v[144:147], v[224:227]
  s_nop 0
  v_pk_mul_f16 v159, v102, v103 op_sel:[0,0] op_sel_hi:[1,1]
  s_nop 1
  v_mfma_f32_16x16x32_f16 v[240:243], v[172:175], v[156:159], v[240:243]
  s_waitcnt lgkmcnt(2)
  v_cvt_pk_f16_f32 v76, v34, v35
  v_cvt_pk_f16_f32 v90, v36, v37
  v_mfma_f32_16x16x32_f16 v[184:187], v[176:179], v[120:123], v[184:187]
  ds_write_b32 v11, v62 offset:0
  v_mfma_f32_16x16x32_f16 v[200:203], v[176:179], v[132:135], v[200:203]
  ds_write_b32 v11, v76 offset:160
  v_mfma_f32_16x16x32_f16 v[216:219], v[176:179], v[144:147], v[216:219]
  ds_write_b32 v11, v90 offset:320
  v_mfma_f32_16x16x32_f16 v[232:235], v[176:179], v[156:159], v[232:235]
  s_waitcnt lgkmcnt(4)
  v_cvt_pk_f16_f32 v104, v38, v39
  v_cvt_pk_f16_f32 v63, v40, v41
  v_mfma_f32_16x16x32_f16 v[188:191], v[180:183], v[120:123], v[188:191]
  ds_write_b32 v11, v104 offset:480
  v_mfma_f32_16x16x32_f16 v[204:207], v[180:183], v[132:135], v[204:207]
  ds_write_b32 v11, v63 offset:640
  v_mfma_f32_16x16x32_f16 v[220:223], v[180:183], v[144:147], v[220:223]
  s_nop 0
  v_cvt_pk_f16_f32 v77, v42, v43
  v_cvt_pk_f16_f32 v91, v44, v45
  v_mfma_f32_16x16x32_f16 v[236:239], v[180:183], v[156:159], v[236:239]
  s_waitcnt lgkmcnt(5)
  v_cvt_pk_f16_f32 v105, v46, v47
  v_cvt_pk_f16_f32 v66, v48, v49
  v_smfmac_f32_16x16x64_f16 v[196:199], v[164:167], v[116:123], v9
  ds_write_b32 v11, v77 offset:800
  v_smfmac_f32_16x16x64_f16 v[212:215], v[164:167], v[128:135], v9
  ds_write_b32 v11, v91 offset:960
  v_smfmac_f32_16x16x64_f16 v[228:231], v[164:167], v[140:147], v9
  ds_write_b32 v11, v105 offset:1120
  v_smfmac_f32_16x16x64_f16 v[244:247], v[164:167], v[152:159], v9
  ds_write_b32 v11, v66 offset:1280
  s_setprio 0
  s_sub_u32 s72, s72, 1
  s_cmp_eq_u32 s72, 0
  s_cbranch_scc1 L_cin_done
  v_cvt_pk_f16_f32 v80, v50, v51
  v_cvt_pk_f16_f32 v94, v52, v53
  v_cvt_pk_f16_f32 v108, v54, v55
  v_cvt_pk_f16_f32 v67, v56, v57
  ds_write_b32 v11, v80 offset:1440
  ds_write_b32 v11, v94 offset:1600
  ds_write_b32 v11, v108 offset:1760
  ds_write_b32 v11, v67 offset:1920
  s_branch L_cin_loop
L_cslow:
  v_max_f32_dpp v58, v58, v58 row_shr:1 row_mask:0xf bank_mask:0xf
  s_nop 1
  v_max_f32_dpp v58, v58, v58 row_shr:2 row_mask:0xf bank_mask:0xf
  s_nop 1
  v_max_f32_dpp v58, v58, v58 row_shr:4 row_mask:0xf bank_mask:0xf
  s_nop 1
  v_max_f32_dpp v58, v58, v58 row_shr:8 row_mask:0xf bank_mask:0xf
  s_nop 1
  v_max_f32_dpp v58, v58, v58 row_bcast:15 row_mask:0xa bank_mask:0xf
  s_nop 1
  v_max_f32_dpp v58, v58, v58 row_bcast:31 row_mask:0xc bank_mask:0xf
  s_nop 0
  v_readlane_b32 s98, v58, 63
  s_mov_b32 s97, 0
  s_lshr_b32 s98, s98, 23
  s_min_u32 s98, s98, 182
  s_lshr_b32 s99, s1, 23
  s_sub_u32 s99, s99, 47
  s_lshr_b32 s99, s99, 1
  s_min_u32 s99, s99, 59
  s_sub_u32 s99, 131, s99
  s_max_u32 s98, s98, s99
  s_sub_u32 s99, 258, s98
  s_lshl_b32 s100, s99, 1
  s_sub_u32 s100, s100, 127
  s_sub_u32 s95, 254, s100
  s_lshl_b32 s95, s95, 23
  v_mov_b32 v60, s95
  v_mul_f32 v61, s0, v60
  v_mul_f32 v60, s1, v60
  v_readfirstlane_b32 s74, v61
  v_readfirstlane_b32 s75, v60
  s_lshl_b32 s99, s99, 23
  s_lshl_b32 s100, s100, 23
  v_mul_f32 v60, s99, v32
  v_mul_f32 v61, s99, v33
  v_mul_f32 v62, s100, v32
  v_mul_f32 v63, s100, v33
  v_cvt_pk_f16_f32 v80, v60, v61
  v_cvt_pk_bf16_f32 v64, v62, v63
  ds_write_b32 v11, v80 offset:0
  ds_write_b32 v10, v64 offset:0
  v_mul_f32 v60, s99, v34
  v_mul_f32 v61, s99, v35
  v_mul_f32 v62, s100, v34
  v_mul_f32 v63, s100, v35
  v_cvt_pk_f16_f32 v81, v60, v61
  v_cvt_pk_bf16_f32 v65, v62, v63
  ds_write_b32 v11, v81 offset:160
  ds_write_b32 v10, v65 offset:2112
  v_mul_f32 v60, s99, v36
  v_mul_f32 v61, s99, v37
  v_mul_f32 v62, s100, v36
  v_mul_f32_e64 v63, s100, v37
  v_cvt_pk_f16_f32 v82, v60, v61
  v_cvt_pk_bf16_f32 v66, v62, v63
  ds_write_b32 v11, v82 offset:320
  ds_write_b32 v10, v66 offset:128
  v_mul_f32 v60, s99, v38
  v_mul_f32 v61, s99, v39
  v_mul_f32 v62, s100, v38
  v_mul_f32 v63, s100, v39
  v_cvt_pk_f16_f32 v83, v60, v61
  v_cvt_pk_bf16_f32 v67, v62, v63
  ds_write_b32 v11, v83 offset:480
  ds_write_b32 v10, v67 offset:2240
  v_mul_f32 v60, s99, v40
  v_mul_f32 v61, s99, v41
  v_mul_f32 v62, s100, v40
  v_mul_f32 v63, s100, v41
  v_cvt_pk_f16_f32 v84, v60, v61
  v_cvt_pk_bf16_f32 v68, v62, v63
  ds_write_b32 v11, v84 offset:640
  ds_write_b32 v10, v68 offset:256
  v_mul_f32 v60, s99, v42
  v_mul_f32 v61, s99, v43
  v_mul_f32 v62, s100, v42
  v_mul_f32 v63, s100, v43
  v_cvt_pk_f16_f32 v85, v60, v61
  v_cvt_pk_bf16_f32 v69, v62, v63
  ds_write_b32 v11, v85 offset:800
  ds_write_b32 v10, v69 offset:2368
  v_mul_f32 v60, s99, v44
  v_mul_f32 v61, s99, v45
  v_mul_f32 v62, s100, v44
  v_mul_f32 v63, s100, v45
  v_cvt_pk_f16_f32 v86, v60, v61
  v_cvt_pk_bf16_f32 v70, v62, v63
  ds_write_b32 v11, v86 offset:960
  ds_write_b32 v10, v70 offset:384
  v_mul_f32 v60, s99, v46
  v_mul_f32 v61, s99, v47
  v_mul_f32 v62, s100, v46
  v_mul_f32 v63, s100, v47
  v_cvt_pk_f16_f32 v87, v60, v61
  v_cvt_pk_bf16_f32 v71, v62, v63
  ds_write_b32 v11, v87 offset:1120
  ds_write_b32 v10, v71 offset:2496
  v_mul_f32 v60, s99, v48
  v_mul_f32 v61, s99, v49
  v_mul_f32 v62, s100, v48
  v_mul_f32 v63, s100, v49
  v_cvt_pk_f16_f32 v88, v60, v61
  v_cvt_pk_bf16_f32 v72, v62, v63
  ds_write_b32 v11, v88 offset:1280
  ds_write_b32 v10, v72 offset:512
  v_mul_f32 v60, s99, v50
  v_mul_f32 v61, s99, v51
  v_mul_f32 v62, s100, v50
  v_mul_f32 v63, s100, v51
  v_cvt_pk_f16_f32 v89, v60, v61
  v_cvt_pk_bf16_f32 v73, v62, v63
  ds_write_b32 v11, v89 offset:1440
  ds_write_b32 v10, v73 offset:2624
  v_mul_f32 v60, s99, v52
  v_mul_f32 v61, s99, v53
  v_mul_f32 v62, s100, v52
  v_mul_f32 v63, s100, v53
  v_cvt_pk_f16_f32 v90, v60, v61
  v_cvt_pk_bf16_f32 v74, v62, v63
  ds_write_b32 v11, v90 offset:1600
  ds_write_b32 v10, v74 offset:640
  v_mul_f32 v60, s99, v54
  v_mul_f32 v61, s99, v55
  v_mul_f32 v62, s100, v54
  v_mul_f32 v63, s100, v55
  v_cvt_pk_f16_f32 v91, v60, v61
  v_cvt_pk_bf16_f32 v75, v62, v63
  ds_write_b32 v11, v91 offset:1760
  ds_write_b32 v10, v75 offset:2752
  v_mul_f32 v60, s99, v56
  v_mul_f32 v61, s99, v57
  v_mul_f32 v62, s100, v56
  v_mul_f32 v63, s100, v57
  v_cvt_pk_f16_f32 v92, v60, v61
  v_cvt_pk_bf16_f32 v76, v62, v63
  ds_write_b32 v11, v92 offset:1920
  ds_write_b32 v10, v76 offset:768
  v_mov_b32 v60, s100
  v_cvt_pk_bf16_f32 v60, v60, v60
  s_mov_b32 exec_hi, 0
  ds_write_b32 v10, v60 offset:2880
  s_mov_b32 exec_hi, -1
  s_waitcnt lgkmcnt(0)
  s_branch L_cconv
L_sdown:
  v_lshlrev_b32 v108, 16, v112
  v_and_b32 v109, 0xffff0000, v112
  v_mul_f32 v108, v108, v250
  v_mul_f32 v109, v109, v250
  v_cvt_pk_bf16_f32 v112, v108, v109
  v_lshlrev_b32 v108, 16, v113
  v_and_b32 v109, 0xffff0000, v113
  v_mul_f32 v108, v108, v250
  v_mul_f32 v109, v109, v250
  v_cvt_pk_bf16_f32 v113, v108, v109
  v_lshlrev_b32 v108, 16, v114
  v_and_b32 v109, 0xffff0000, v114
  v_mul_f32 v108, v108, v250
  v_mul_f32 v109, v109, v250
  v_cvt_pk_bf16_f32 v114, v108, v109
  v_lshlrev_b32_e64 v108, 16, v115
  v_and_b32 v109, 0xffff0000, v115
  v_mul_f32 v108, v108, v250
  v_mul_f32 v109, v109, v250
  v_cvt_pk_bf16_f32 v115, v108, v109
  v_lshlrev_b32 v108, 16, v116
  v_and_b32 v109, 0xffff0000, v116
  v_mul_f32 v108, v108, v250
  v_mul_f32 v109, v109, v250
  v_cvt_pk_bf16_f32 v116, v108, v109
  v_lshlrev_b32 v108, 16, v117
  v_and_b32 v109, 0xffff0000, v117
  v_mul_f32 v108, v108, v250
  v_mul_f32 v109, v109, v250
  v_cvt_pk_bf16_f32 v117, v108, v109
  v_lshlrev_b32 v108, 16, v118
  v_and_b32 v109, 0xffff0000, v118
  v_mul_f32 v108, v108, v250
  v_mul_f32 v109, v109, v250
  v_cvt_pk_bf16_f32 v118, v108, v109
  v_lshlrev_b32 v108, 16, v119
  v_and_b32 v109, 0xffff0000, v119
  v_mul_f32 v108, v108, v250
  v_mul_f32 v109, v109, v250
  v_cvt_pk_bf16_f32 v119, v108, v109
  s_branch L_scaled
L_first:
  ds_read_b64_tr_b16 v[60:61], v20 offset:0
  ds_read_b64_tr_b16 v[74:75], v20 offset:32
  ds_read_b64_tr_b16 v[88:89], v20 offset:64
  ds_read_b64_tr_b16 v[102:103], v20 offset:96
  ds_read_b64_tr_b16 v[66:67], v23 offset:0
  ds_read_b64_tr_b16 v[80:81], v23 offset:32
  ds_read_b64_tr_b16 v[94:95], v23 offset:64
  ds_read_b64_tr_b16 v[108:109], v23 offset:96
  ds_read_b64_tr_b16 v[68:69], v24 offset:0
  ds_read_b64_tr_b16 v[82:83], v24 offset:32
  ds_read_b64_tr_b16 v[96:97], v24 offset:64
  ds_read_b64_tr_b16 v[110:111], v24 offset:96
  ds_read_b64_tr_b16 v[124:125], v4 offset:0
  ds_read_b64_tr_b16 v[126:127], v5 offset:0
  ds_read_b64_tr_b16 v[136:137], v4 offset:32
  ds_read_b64_tr_b16 v[138:139], v5 offset:32
  ds_read_b64_tr_b16 v[148:149], v4 offset:64
  ds_read_b64_tr_b16 v[150:151], v5 offset:64
  ds_read_b64_tr_b16 v[160:161], v4 offset:96
  ds_read_b64_tr_b16 v[162:163], v5 offset:96
  ds_read_b128 v[164:167], v1 offset:39936
  ds_read_b128 v[168:171], v1 offset:40960
  ds_read_b128 v[172:175], v1 offset:8192
  ds_read_b128 v[176:179], v1 offset:6144
  ds_read_b64_tr_b16 v[70:71], v25 offset:0
  ds_read_b64_tr_b16 v[84:85], v25 offset:32
  ds_read_b64_tr_b16 v[98:99], v25 offset:64
  ds_read_b64_tr_b16 v[112:113], v25 offset:96
  ds_read_b64_tr_b16 v[72:73], v26 offset:0
  s_waitcnt lgkmcnt(14)
  v_pk_mul_f16 v120, v60, v67 op_sel:[0,0] op_sel_hi:[0,1]
  v_pk_mul_f16 v121, v60, v67 op_sel:[1,0] op_sel_hi:[1,1]
  ds_read_b64_tr_b16 v[86:87], v26 offset:32
  v_pk_mul_f16 v122, v60, v68 op_sel:[0,0] op_sel_hi:[0,1]
  ds_read_b64_tr_b16 v[100:101], v26 offset:64
  v_pk_mul_f16 v123, v60, v68 op_sel:[1,0] op_sel_hi:[1,1]
  ds_read_b64_tr_b16 v[114:115], v26 offset:96
  v_pk_mul_f16 v132, v74, v81 op_sel:[0,0] op_sel_hi:[0,1]
  v_pk_mul_f16 v133, v74, v81 op_sel:[1,0] op_sel_hi:[1,1]
  ds_read_b64_tr_b16 v[62:63], v21 offset:0
  v_pk_mul_f16 v134, v74, v82 op_sel:[0,0] op_sel_hi:[0,1]
  ds_read_b64_tr_b16 v[76:77], v21 offset:32
  v_pk_mul_f16 v135, v74, v82 op_sel:[1,0] op_sel_hi:[1,1]
  ds_read_b64_tr_b16 v[90:91], v21 offset:64
  v_pk_mul_f16 v144, v88, v95 op_sel:[0,0] op_sel_hi:[0,1]
  v_pk_mul_f16 v145, v88, v95 op_sel:[1,0] op_sel_hi:[1,1]
  ds_read_b64_tr_b16 v[104:105], v21 offset:96
  v_pk_mul_f16 v146, v88, v96 op_sel:[0,0] op_sel_hi:[0,1]
  ds_read_b64_tr_b16 v[64:65], v22 offset:0
  v_pk_mul_f16 v147, v88, v96 op_sel:[1,0] op_sel_hi:[1,1]
  ds_read_b64_tr_b16 v[78:79], v22 offset:32
  v_pk_mul_f16 v156, v102, v109 op_sel:[0,0] op_sel_hi:[0,1]
  v_pk_mul_f16 v157, v102, v109 op_sel:[1,0] op_sel_hi:[1,1]
  ds_read_b64_tr_b16 v[92:93], v22 offset:64
  v_pk_mul_f16 v158, v102, v110 op_sel:[0,0] op_sel_hi:[0,1]
  ds_read_b64_tr_b16 v[106:107], v22 offset:96
  v_pk_mul_f16 v159, v102, v110 op_sel:[1,0] op_sel_hi:[1,1]
  s_branch L_novm
L_end:
  s_endpgm
.p2align 8
L_tables:
.long 0x0, 0x1800, 0x6c80, 0x81a0, 0x8, 0x1808, 0x6c88, 0x81a8
.long 0x10, 0x1810, 0x6c90, 0x81b0, 0x18, 0x1818, 0x6c98, 0x81b8
.long 0x40, 0x1d48, 0x71c8, 0x86e8, 0x48, 0x1d50, 0x71d0, 0x86f0
.long 0x50, 0x1d58, 0x71d8, 0x86f8, 0x58, 0x1d60, 0x71e0, 0x8700
.long 0x80, 0x2290, 0x7710, 0x8c30, 0x88, 0x2298, 0x7718, 0x8c38
.long 0x90, 0x22a0, 0x7720, 0x8c40, 0x98, 0x22a8, 0x7728, 0x8c48
.long 0xc0, 0x27d8, 0x7c58, 0x9178, 0xc8, 0x27e0, 0x7c60, 0x9180
.long 0xd0, 0x27e8, 0x7c68, 0x9188, 0xd8, 0x27f0, 0x7c70, 0x9190
.long 0x20, 0x1820, 0x6ca0, 0x81c0, 0x28, 0x1828, 0x6ca8, 0x81c8
.long 0x30, 0x1830, 0x6cb0, 0x81d0, 0x38, 0x1838, 0x6cb8, 0x81d8
.long 0x60, 0x1d68, 0x71e8, 0x8708, 0x68, 0x1d70, 0x71f0, 0x8710
.long 0x70, 0x1d78, 0x71f8, 0x8718, 0x78, 0x1d80, 0x7200, 0x8720
.long 0xa0, 0x22b0, 0x7730, 0x8c50, 0xa8, 0x22b8, 0x7738, 0x8c58
.long 0xb0, 0x22c0, 0x7740, 0x8c60, 0xb8, 0x22c8, 0x7748, 0x8c68
.long 0xe0, 0x27f8, 0x7c78, 0x9198, 0xe8, 0x2800, 0x7c80, 0x91a0
.long 0xf0, 0x2808, 0x7c88, 0x91a8, 0xf8, 0x2810, 0x7c90, 0x91b0
.long 0x200, 0x4240, 0x96c0, 0x9c08, 0x208, 0x4248, 0x96c8, 0x9c10
.long 0x210, 0x4250, 0x96d0, 0x9c18, 0x218, 0x4258, 0x96d8, 0x9c20
.long 0x240, 0x4788, 0x9c08, 0x9c08, 0x248, 0x4790, 0x9c10, 0x9c10
.long 0x250, 0x4798, 0x9c18, 0x9c18, 0x258, 0x47a0, 0x9c20, 0x9c20
.long 0x280, 0x4cd0, 0x9c08, 0x9c08, 0x288, 0x4cd8, 0x9c10, 0x9c10
.long 0x290, 0x4ce0, 0x9c18, 0x9c18, 0x298, 0x4ce8, 0x9c20, 0x9c20
.long 0x2c0, 0x5218, 0x9c08, 0x9c08, 0x2c8, 0x5220, 0x9c10, 0x9c10
.long 0x2d0, 0x5228, 0x9c18, 0x9c18, 0x2d8, 0x5230, 0x9c20, 0x9c20
.long 0x220, 0x4260, 0x96e0, 0x9c28, 0x228, 0x4268, 0x96e8, 0x9c30
.long 0x230, 0x4270, 0x96f0, 0x9c38, 0x238, 0x4278, 0x96f8, 0x9c40
.long 0x260, 0x47a8, 0x9c28, 0x9c28, 0x268, 0x47b0, 0x9c30, 0x9c30
.long 0x270, 0x47b8, 0x9c38, 0x9c38, 0x278, 0x47c0, 0x9c40, 0x9c40
.long 0x2a0, 0x4cf0, 0x9c28, 0x9c28, 0x2a8, 0x4cf8, 0x9c30, 0x9c30
.long 0x2b0, 0x4d00, 0x9c38, 0x9c38, 0x2b8, 0x4d08, 0x9c40, 0x9c40
.long 0x2e0, 0x5238, 0x9c28, 0x9c28, 0x2e8, 0x5240, 0x9c30, 0x9c30
.long 0x2f0, 0x5248, 0x9c38, 0x9c38, 0x2f8, 0x5250, 0x9c40, 0x9c40
.long 0xaae0, 0xa680, 0xa900, 0xaae0, 0xaae8, 0xa688, 0xa908, 0xaae8
.long 0xaaf0, 0xa690, 0xa910, 0xaaf0, 0xaaf8, 0xa698, 0xa918, 0xaaf8
.long 0xaa40, 0xa860, 0xa9a0, 0xaa40, 0xaa48, 0xa868, 0xa9a8, 0xaa48
.long 0xaa50, 0xa870, 0xa9b0, 0xaa50, 0xaa58, 0xa878, 0xa9b8, 0xaa58
.long 0xa400, 0xa7c0, 0xa540, 0xa400, 0xa408, 0xa7c8, 0xa548, 0xa408
.long 0xa410, 0xa7d0, 0xa550, 0xa410, 0xa418, 0xa7d8, 0xa558, 0xa418
.long 0xa4a0, 0xa720, 0xa5e0, 0xa4a0, 0xa4a8, 0xa728, 0xa5e8, 0xa4a8
.long 0xa4b0, 0xa730, 0xa5f0, 0xa4b0, 0xa4b8, 0xa738, 0xa5f8, 0xa4b8
.long 0xb260, 0xb4e0, 0xb6c0, 0xb260, 0xb268, 0xb4e8, 0xb6c8, 0xb268
.long 0xb270, 0xb4f0, 0xb6d0, 0xb270, 0xb278, 0xb4f8, 0xb6d8, 0xb278
.long 0xb1c0, 0xb300, 0xb760, 0xb1c0, 0xb1c8, 0xb308, 0xb768, 0xb1c8
.long 0xb1d0, 0xb310, 0xb770, 0xb1d0, 0xb1d8, 0xb318, 0xb778, 0xb1d8
.long 0xb580, 0xb440, 0xb080, 0xb580, 0xb588, 0xb448, 0xb088, 0xb588
.long 0xb590, 0xb450, 0xb090, 0xb590, 0xb598, 0xb458, 0xb098, 0xb598
.long 0xb620, 0xb3a0, 0xb120, 0xb620, 0xb628, 0xb3a8, 0xb128, 0xb628
.long 0xb630, 0xb3b0, 0xb130, 0xb630, 0xb638, 0xb3b8, 0xb138, 0xb638
.long 0xa900, 0xa400, 0xaae0, 0xb620, 0xa908, 0xa408, 0xaae8, 0xb628
.long 0xa910, 0xa410, 0xaaf0, 0xb630, 0xa918, 0xa418, 0xaaf8, 0xb638
.long 0xa9a0, 0xa4a0, 0xab80, 0xb800, 0xa9a8, 0xa4a8, 0xab88, 0xb808
.long 0xa9b0, 0xa4b0, 0xab90, 0xb810, 0xa9b8, 0xa4b8, 0xab98, 0xb818
.long 0xaa40, 0xa680, 0xa860, 0xb3a0, 0xaa48, 0xa688, 0xa868, 0xb3a8
.long 0xaa50, 0xa690, 0xa870, 0xb3b0, 0xaa58, 0xa698, 0xa878, 0xb3b8
.long 0xa720, 0xa540, 0xa7c0, 0xb1c0, 0xa728, 0xa548, 0xa7c8, 0xb1c8
.long 0xa730, 0xa550, 0xa7d0, 0xb1d0, 0xa738, 0xa558, 0xa7d8, 0xb1d8
.long 0xa5e0, 0xaae0, 0xa400, 0xb080, 0xa5e8, 0xaae8, 0xa408, 0xb088
.long 0xa5f0, 0xaaf0, 0xa410, 0xb090, 0xa5f8, 0xaaf8, 0xa418, 0xb098
.long 0xa7c0, 0xa540, 0xa720, 0xb760, 0xa7c8, 0xa548, 0xa728, 0xb768
.long 0xa7d0, 0xa550, 0xa730, 0xb770, 0xa7d8, 0xa558, 0xa738, 0xb778
.long 0xa860, 0xa680, 0xaa40, 0xb440, 0xa868, 0xa688, 0xaa48, 0xb448
.long 0xa870, 0xa690, 0xaa50, 0xb450, 0xa878, 0xa698, 0xaa58, 0xb458
.long 0xab80, 0xa4a0, 0xa9a0, 0xb4e0, 0xab88, 0xa4a8, 0xa9a8, 0xb4e8
.long 0xab90, 0xa4b0, 0xa9b0, 0xb4f0, 0xab98, 0xa4b8, 0xa9b8, 0xb4f8
.long 0xa680, 0xa900, 0xab80, 0xa4a0, 0xa688, 0xa908, 0xab88, 0xa4a8
.long 0xa690, 0xa910, 0xab90, 0xa4b0, 0xa698, 0xa918, 0xab98, 0xa4b8
.long 0xa860, 0xa9a0, 0xb1c0, 0xb440, 0xa868, 0xa9a8, 0xb1c8, 0xb448
.long 0xa870, 0xa9b0, 0xb1d0, 0xb450, 0xa878, 0xa9b8, 0xb1d8, 0xb458
.long 0xa7c0, 0xa540, 0xab80, 0xa4a0, 0xa7c8, 0xa548, 0xab88, 0xa4a8
.long 0xa7d0, 0xa550, 0xab90, 0xa4b0, 0xa7d8, 0xa558, 0xab98, 0xa4b8
.long 0xa720, 0xa5e0, 0xb1c0, 0xb440, 0xa728, 0xa5e8, 0xb1c8, 0xb448
.long 0xa730, 0xa5f0, 0xb1d0, 0xb450, 0xa738, 0xa5f8, 0xb1d8, 0xb458
.long 0xb4e0, 0xb6c0, 0xb800, 0xa860, 0xb4e8, 0xb6c8, 0xb808, 0xa868
.long 0xb4f0, 0xb6d0, 0xb810, 0xa870, 0xb4f8, 0xb6d8, 0xb818, 0xa878
.long 0xb300, 0xb760, 0xa540, 0xa900, 0xb308, 0xb768, 0xa548, 0xa908
.long 0xb310, 0xb770, 0xa550, 0xa910, 0xb318, 0xb778, 0xa558, 0xa918
.long 0xb440, 0xb080, 0xb800, 0xa860, 0xb448, 0xb088, 0xb808, 0xa868
.long 0xb450, 0xb090, 0xb810, 0xa870, 0xb458, 0xb098, 0xb818, 0xa878
.long 0xb3a0, 0xb120, 0xa540, 0xa900, 0xb3a8, 0xb128, 0xa548, 0xa908
.long 0xb3b0, 0xb130, 0xa550, 0xa910, 0xb3b8, 0xb138, 0xa558, 0xa918
.long 0xb120, 0xb580, 0xb080, 0xb300, 0xb128, 0xb588, 0xb088, 0xb308
.long 0xb130, 0xb590, 0xb090, 0xb310, 0xb138, 0xb598, 0xb098, 0xb318
.long 0xb6c0, 0xb4e0, 0xaa40, 0xb6c0, 0xb6c8, 0xb4e8, 0xaa48, 0xb6c8
.long 0xb6d0, 0xb4f0, 0xaa50, 0xb6d0, 0xb6d8, 0xb4f8, 0xaa58, 0xb6d8
.long 0xb300, 0xb440, 0xb080, 0xb300, 0xb308, 0xb448, 0xb088, 0xb308
.long 0xb310, 0xb450, 0xb090, 0xb310, 0xb318, 0xb458, 0xb098, 0xb318
.long 0xb260, 0xb760, 0xaa40, 0xb6c0, 0xb268, 0xb768, 0xaa48, 0xb6c8
.long 0xb270, 0xb770, 0xaa50, 0xb6d0, 0xb278, 0xb778, 0xaa58, 0xb6d8
.long 0xb580, 0xb120, 0xb620, 0xa680, 0xb588, 0xb128, 0xb628, 0xa688
.long 0xb590, 0xb130, 0xb630, 0xa690, 0xb598, 0xb138, 0xb638, 0xa698
.long 0xb260, 0xb1c0, 0xa7c0, 0xa680, 0xb268, 0xb1c8, 0xa7c8, 0xa688
.long 0xb270, 0xb1d0, 0xa7d0, 0xa690, 0xb278, 0xb1d8, 0xa7d8, 0xa698
.long 0xb300, 0xb3a0, 0xb620, 0xb300, 0xb308, 0xb3a8, 0xb628, 0xb308
.long 0xb310, 0xb3b0, 0xb630, 0xb310, 0xb318, 0xb3b8, 0xb638, 0xb318
.long 0xb6c0, 0xb800, 0xa7c0, 0xb300, 0xb6c8, 0xb808, 0xa7c8, 0xb308
.long 0xb6d0, 0xb810, 0xa7d0, 0xb310, 0xb6d8, 0xb818, 0xa7d8, 0xb318
.long 0x0, 0x200, 0x0, 0x3f803f80, 0x8, 0x208, 0x0, 0x3f803f80
.long 0x10, 0x210, 0x0, 0x3f803f80, 0x18, 0x218, 0x0, 0x3f803f80
.long 0x420, 0x620, 0x0, 0x3f803f80, 0x428, 0x628, 0x0, 0x3f803f80
.long 0x430, 0x630, 0x0, 0x3f803f80, 0x438, 0x638, 0x0, 0x3f803f80
.long 0x840, 0xa40, 0x10, 0x3f803f80, 0x848, 0xa48, 0x10, 0x3f803f80
.long 0x850, 0xa50, 0x10, 0x3f803f80, 0x858, 0xa58, 0x10, 0x3f803f80
.long 0xc60, 0xe60, 0x10, 0x3f803f80, 0xc68, 0xe68, 0x10, 0x3f803f80
.long 0xc70, 0xe70, 0x10, 0x3f803f80, 0xc78, 0xe78, 0x10, 0x3f803f80
.long 0x80, 0x280, 0x20, 0x3f803f80, 0x88, 0x288, 0x20, 0x3f803f80
.long 0x90, 0x290, 0x20, 0x3f803f80, 0x98, 0x298, 0x20, 0x3f803f80
.long 0x4a0, 0x6a0, 0x20, 0x3f803f80, 0x4a8, 0x6a8, 0x20, 0x3f803f80
.long 0x4b0, 0x6b0, 0x20, 0x3f803f80, 0x4b8, 0x6b8, 0x20, 0x3f803f80
.long 0x8c0, 0xac0, 0x30, 0x3f803f80, 0x8c8, 0xac8, 0x30, 0x3f803f80
.long 0x8d0, 0xad0, 0x30, 0x3f803f80, 0x8d8, 0xad8, 0x30, 0x3f803f80
.long 0xce0, 0xee0, 0x30, 0x3f803f80, 0xce8, 0xee8, 0x30, 0x3f803f80
.long 0xcf0, 0xef0, 0x30, 0x3f803f80, 0xcf8, 0xef8, 0x30, 0x3f803f80
.long 0x100, 0x300, 0x40, 0x0, 0x108, 0x308, 0x40, 0x0
.long 0x110, 0x310, 0x40, 0x0, 0x118, 0x318, 0x40, 0x0
.long 0x520, 0x720, 0x40, 0x0, 0x528, 0x728, 0x40, 0x0
.long 0x530, 0x730, 0x40, 0x0, 0x538, 0x738, 0x40, 0x0
.long 0x940, 0xb40, 0x50, 0x0, 0x948, 0xb48, 0x50, 0x0
.long 0x950, 0xb50, 0x50, 0x0, 0x958, 0xb58, 0x50, 0x0
.long 0xd60, 0xf60, 0x50, 0x0, 0xd68, 0xf68, 0x50, 0x0
.long 0xd70, 0xf70, 0x50, 0x0, 0xd78, 0xf78, 0x50, 0x0
.long 0x180, 0xf60, 0x60, 0x0, 0x188, 0xf68, 0x60, 0x0
.long 0x190, 0xf70, 0x60, 0x0, 0x198, 0xf78, 0x60, 0x0
.long 0x5a0, 0xf60, 0x60, 0x0, 0x5a8, 0xf68, 0x60, 0x0
.long 0x5b0, 0xf70, 0x60, 0x0, 0x5b8, 0xf78, 0x60, 0x0
.long 0x9c0, 0xf60, 0x70, 0x0, 0x9c8, 0xf68, 0x70, 0x0
.long 0x9d0, 0xf70, 0x70, 0x0, 0x9d8, 0xf78, 0x70, 0x0
.long 0xde0, 0xf60, 0x70, 0x0, 0xde8, 0xf68, 0x70, 0x0
.long 0xdf0, 0xf70, 0x70, 0x0, 0xdf8, 0xf78, 0x70, 0x0
.long 0xffff, 0x0, 0x0, 0x0, 0x0, 0x0, 0xffff, 0x0
.long 0x0, 0x0, 0x0, 0x0, 0x0, 0x0, 0x0, 0x0
.long 0x0, 0x0, 0x0, 0x0, 0x0, 0x0, 0x0, 0x0
.long 0x0, 0x0, 0x0, 0x0, 0x0, 0x0, 0x0, 0x0
.long 0xffff0000, 0x0, 0x0, 0x0, 0x0, 0x0, 0xffff0000, 0x0
.long 0x0, 0x0, 0x0, 0x0, 0x0, 0x0, 0x0, 0x0
.long 0x0, 0x0, 0x0, 0x0, 0x0, 0x0, 0x0, 0x0
.long 0x0, 0x0, 0x0, 0x0, 0x0, 0x0, 0x0, 0x0
.long 0x0, 0xffff, 0x0, 0x0, 0x0, 0x0, 0x0, 0xffff
.long 0x0, 0x0, 0x0, 0x0, 0x0, 0x0, 0x0, 0x0
.long 0x0, 0x0, 0x0, 0x0, 0x0, 0x0, 0x0, 0x0
.long 0x0, 0x0, 0x0, 0x0, 0x0, 0x0, 0x0, 0x0
.long 0x0, 0xffff0000, 0x0, 0x0, 0x0, 0x0, 0x0, 0xffff0000
.long 0x0, 0x0, 0x0, 0x0, 0x0, 0x0, 0x0, 0x0
.long 0x0, 0x0, 0x0, 0x0, 0x0, 0x0, 0x0, 0x0
.long 0x0, 0x0, 0x0, 0x0, 0x0, 0x0, 0x0, 0x0
.long 0x0, 0x0, 0x0, 0x0, 0x0, 0x0, 0x0, 0x0
.long 0xffff, 0x0, 0x0, 0x0, 0x0, 0x0, 0xffff, 0x0
.long 0x0, 0x0, 0x0, 0x0, 0x0, 0x0, 0x0, 0x0
.long 0x0, 0x0, 0x0, 0x0, 0x0, 0x0, 0x0, 0x0
.long 0x0, 0x0, 0x0, 0x0, 0x0, 0x0, 0x0, 0x0
.long 0xffff0000, 0x0, 0x0, 0x0, 0x0, 0x0, 0xffff0000, 0x0
.long 0x0, 0x0, 0x0, 0x0, 0x0, 0x0, 0x0, 0x0
.long 0x0, 0x0, 0x0, 0x0, 0x0, 0x0, 0x0, 0x0
.long 0x0, 0x0, 0x0, 0x0, 0x0, 0x0, 0x0, 0x0
.long 0x0, 0xffff, 0x0, 0x0, 0x0, 0x0, 0x0, 0xffff
.long 0x0, 0x0, 0x0, 0x0, 0x0, 0x0, 0x0, 0x0
.long 0x0, 0x0, 0x0, 0x0, 0x0, 0x0, 0x0, 0x0
.long 0x0, 0x0, 0x0, 0x0, 0x0, 0x0, 0x0, 0x0
.long 0x0, 0xffff0000, 0x0, 0x0, 0x0, 0x0, 0x0, 0xffff0000
.long 0x0, 0x0, 0x0, 0x0, 0x0, 0x0, 0x0, 0x0
.long 0x0, 0x0, 0x0, 0x0, 0x0, 0x0, 0x0, 0x0
.long 0x0, 0x0, 0x0, 0x0, 0x0, 0x0, 0x0, 0x0
.long 0x0, 0x0, 0x0, 0x0, 0x0, 0x0, 0x0, 0x0
.long 0x0, 0x0, 0xffff, 0x0, 0x0, 0x0, 0x0, 0x0
.long 0x0, 0x0, 0x0, 0x0, 0xffff, 0x0, 0x0, 0x0
.long 0x0, 0x0, 0x0, 0x0, 0x0, 0x0, 0x0, 0x0
.long 0x0, 0x0, 0x0, 0x0, 0x0, 0x0, 0x0, 0x0
.long 0x0, 0x0, 0xffff0000, 0x0, 0x0, 0x0, 0x0, 0x0
.long 0x0, 0x0, 0x0, 0x0, 0xffff0000, 0x0, 0x0, 0x0
.long 0x0, 0x0, 0x0, 0x0, 0x0, 0x0, 0x0, 0x0
.long 0x0, 0x0, 0x0, 0x0, 0x0, 0x0, 0x0, 0x0
.long 0x0, 0x0, 0x0, 0xffff, 0x0, 0x0, 0x0, 0x0
.long 0x0, 0x0, 0x0, 0x0, 0x0, 0xffff, 0x0, 0x0
.long 0x0, 0x0, 0x0, 0x0, 0x0, 0x0, 0x0, 0x0
.long 0x0, 0x0, 0x0, 0x0, 0x0, 0x0, 0x0, 0x0
.long 0x0, 0x0, 0x0, 0xffff0000, 0x0, 0x0, 0x0, 0x0
.long 0x0, 0x0, 0x0, 0x0, 0x0, 0xffff0000, 0x0, 0x0
.long 0x0, 0x0, 0x0, 0x0, 0x0, 0x0, 0x0, 0x0
.long 0x0, 0x0, 0x0, 0x0, 0x0, 0x0, 0x0, 0x0
.long 0x0, 0x0, 0x0, 0x0, 0xffff, 0x0, 0x0, 0x0
.long 0x0, 0x0, 0x0, 0x0, 0x0, 0x0, 0x0, 0x0
.long 0x0, 0x0, 0x0, 0x0, 0x0, 0x0, 0x0, 0x0
.long 0x0, 0x0, 0x0, 0x0, 0x0, 0x0, 0x0, 0x0
.long 0x0, 0x0, 0x0, 0x0, 0xffff0000, 0x0, 0x0, 0x0
.long 0x0, 0x0, 0x0, 0x0, 0x0, 0x0, 0x0, 0x0
.long 0x0, 0x0, 0x0, 0x0, 0x0, 0x0, 0x0, 0x0
.long 0x0, 0x0, 0x0, 0x0, 0x0, 0x0, 0x0, 0x0
.long 0x0, 0x0, 0x0, 0x0, 0x0, 0x0, 0x0, 0x0
.long 0x0, 0x0, 0x0, 0x0, 0x0, 0x0, 0x0, 0x0
.long 0x0, 0x0, 0x0, 0x0, 0x0, 0x0, 0x0, 0x0
.long 0x0, 0x0, 0x0, 0x0, 0x0, 0x0, 0x0, 0x0
.long 0x0, 0x0, 0x0, 0x0, 0x0, 0x0, 0x0, 0x0
.long 0x0, 0x0, 0x0, 0x0, 0x0, 0x0, 0x0, 0x0
.long 0x14d40, 0x14d40, 0x0, 0x0, 0x14e10, 0x14e10, 0x20, 0x20
.long 0x14ee0, 0x14ee0, 0x100000, 0x100000, 0x14fb0, 0x14fb0, 0x100020, 0x100020
.long 0x15080, 0x15080, 0x40, 0x40, 0x15150, 0x15150, 0x60, 0x60
.long 0x15220, 0x15220, 0x100040, 0x100040, 0x100000, 0x100000, 0x100060, 0x100060
.long 0x14d74, 0x14d74, 0x80, 0x80, 0x14e44, 0x14e44, 0xa0, 0xa0
.long 0x14f14, 0x14f14, 0x100080, 0x100080, 0x14fe4, 0x14fe4, 0x1000a0, 0x1000a0
.long 0x150b4, 0x150b4, 0xc0, 0xc0, 0x15184, 0x15184, 0xe0, 0xe0
.long 0x15254, 0x15254, 0x1000c0, 0x1000c0, 0x100000, 0x100000, 0x1000e0, 0x1000e0
.long 0x14da8, 0x14da8, 0x8, 0x100, 0x14e78, 0x14e78, 0x28, 0x120
.long 0x14f48, 0x14f48, 0x100008, 0x100100, 0x15018, 0x15018, 0x100028, 0x100120
.long 0x150e8, 0x150e8, 0x48, 0x140, 0x151b8, 0x151b8, 0x68, 0x160
.long 0x100000, 0x100000, 0x100048, 0x100140, 0x100000, 0x100000, 0x100068, 0x100160
.long 0x14ddc, 0x14ddc, 0x88, 0x180, 0x14eac, 0x14eac, 0xa8, 0x1a0
.long 0x14f7c, 0x14f7c, 0x100088, 0x100180, 0x1504c, 0x1504c, 0x1000a8, 0x1001a0
.long 0x1511c, 0x1511c, 0xc8, 0x1c0, 0x151ec, 0x151ec, 0xe8, 0x1e0
.long 0x100000, 0x100000, 0x1000c8, 0x1001c0, 0x100000, 0x100000, 0x1000e8, 0x1001e0
.long 0x17d40, 0x114d40, 0x100, 0x200, 0x17e10, 0x114e10, 0x120, 0x220
.long 0x17ee0, 0x114ee0, 0x100100, 0x100200, 0x17fb0, 0x114fb0, 0x100120, 0x100220
.long 0x18080, 0x115080, 0x140, 0x240, 0x18150, 0x115150, 0x160, 0x260
.long 0x18220, 0x115220, 0x100140, 0x100240, 0x103000, 0x200000, 0x100160, 0x100260
.long 0x17d74, 0x114d74, 0x180, 0x280, 0x17e44, 0x114e44, 0x1a0, 0x2a0
.long 0x17f14, 0x114f14, 0x100180, 0x100280, 0x17fe4, 0x114fe4, 0x1001a0, 0x1002a0
.long 0x180b4, 0x1150b4, 0x1c0, 0x2c0, 0x18184, 0x115184, 0x1e0, 0x2e0
.long 0x18254, 0x115254, 0x1001c0, 0x1002c0, 0x103000, 0x200000, 0x1001e0, 0x1002e0
.long 0x17da8, 0x114da8, 0x108, 0x300, 0x17e78, 0x114e78, 0x128, 0x320
.long 0x17f48, 0x114f48, 0x100108, 0x100300, 0x18018, 0x115018, 0x100128, 0x100320
.long 0x180e8, 0x1150e8, 0x148, 0x340, 0x181b8, 0x1151b8, 0x168, 0x360
.long 0x103000, 0x200000, 0x100148, 0x100340, 0x103000, 0x200000, 0x100168, 0x100360
.long 0x17ddc, 0x114ddc, 0x188, 0x380, 0x17eac, 0x114eac, 0x1a8, 0x3a0
.long 0x17f7c, 0x114f7c, 0x100188, 0x100380, 0x1804c, 0x11504c, 0x1001a8, 0x1003a0
.long 0x1811c, 0x11511c, 0x1c8, 0x3c0, 0x181ec, 0x1151ec, 0x1e8, 0x3e0
.long 0x103000, 0x200000, 0x1001c8, 0x1003c0, 0x103000, 0x200000, 0x1001e8, 0x1003e0
.long 0xa400, 0xd00, 0x0, 0x14d40, 0xa440, 0xd00, 0x0, 0x14d80
.long 0xa480, 0xd00, 0x1, 0x14dd0, 0xa4c0, 0xd00, 0x1, 0x14e10
.long 0xa500, 0xd00, 0x2, 0x14e60, 0xa540, 0xd00, 0x2, 0x14ea0
.long 0xa580, 0xd00, 0x3, 0x14ef0, 0xa5c0, 0xd00, 0x3, 0x14f30
.long 0xa600, 0xd00, 0x4, 0x14f40, 0xa640, 0xd00, 0x4, 0x14f80
.long 0xa680, 0xd00, 0x5, 0x14fd0, 0xa6c0, 0xd00, 0x5, 0x15010
.long 0xa700, 0xd00, 0x6, 0x15060, 0xa740, 0xd00, 0x6, 0x150a0
.long 0xa780, 0xd00, 0x7, 0x150f0, 0xa7c0, 0xd00, 0x7, 0x15130
.long 0xa800, 0xd00, 0x8, 0x15140, 0xa840, 0xd00, 0x8, 0x15180
.long 0xa880, 0xd00, 0x9, 0x151d0, 0xa8c0, 0xd00, 0x9, 0x15210
.long 0xa900, 0xd00, 0xa, 0x15260, 0xa940, 0xd00, 0xa, 0x152a0
.long 0xa980, 0xd00, 0xb, 0x152f0, 0xa9c0, 0xd00, 0xb, 0x15330
.long 0xaa00, 0xd00, 0xc, 0x15340, 0xaa40, 0xd00, 0xc, 0x15380
.long 0x1f680, 0x40, 0xd, 0x153d0, 0x100000, 0xd00, 0xd, 0x15410
.long 0x100000, 0xd00, 0xe, 0x15460, 0x100000, 0xd00, 0xe, 0x154a0
.long 0x100000, 0xd00, 0xf, 0x154f0, 0x100000, 0xd00, 0xf, 0x15530
.long 0xa400, 0xd00, 0x2, 0x14d60, 0xa440, 0xd00, 0x2, 0x14da0
.long 0xa480, 0xd00, 0x3, 0x14df0, 0xa4c0, 0xd00, 0x3, 0x14e30
.long 0xa500, 0xd00, 0x4, 0x14e40, 0xa540, 0xd00, 0x4, 0x14e80
.long 0xa580, 0xd00, 0x5, 0x14ed0, 0xa5c0, 0xd00, 0x5, 0x14f10
.long 0xa600, 0xd00, 0x6, 0x14f60, 0xa640, 0xd00, 0x6, 0x14fa0
.long 0xa680, 0xd00, 0x7, 0x14ff0, 0xa6c0, 0xd00, 0x7, 0x15030
.long 0xa700, 0xd00, 0x8, 0x15040, 0xa740, 0xd00, 0x8, 0x15080
.long 0xa780, 0xd00, 0x9, 0x150d0, 0xa7c0, 0xd00, 0x9, 0x15110
.long 0xa800, 0xd00, 0xa, 0x15160, 0xa840, 0xd00, 0xa, 0x151a0
.long 0xa880, 0xd00, 0xb, 0x151f0, 0xa8c0, 0xd00, 0xb, 0x15230
.long 0xa900, 0xd00, 0xc, 0x15240, 0xa940, 0xd00, 0xc, 0x15280
.long 0xa980, 0xd00, 0xd, 0x152d0, 0xa9c0, 0xd00, 0xd, 0x15310
.long 0xaa00, 0xd00, 0xe, 0x15360, 0xaa40, 0xd00, 0xe, 0x153a0
.long 0x1f680, 0x40, 0xf, 0x153f0, 0x100000, 0xd00, 0xf, 0x15430
.long 0x100000, 0xd00, 0x10, 0x15440, 0x100000, 0xd00, 0x10, 0x15480
.long 0x100000, 0xd00, 0x11, 0x154d0, 0x100000, 0xd00, 0x11, 0x15510
.long 0x1f690, 0x1f890, 0x1f9c0, 0x1f9e0, 0x1f698, 0x1f898, 0x1f9c8, 0x1f9e8
.long 0x1f680, 0x1f880, 0x1f9d0, 0x1f9f0, 0x1f688, 0x1f888, 0x1f9d8, 0x100000
.long 0x1fd20, 0x1ff20, 0x1f9c2, 0x1f9e2, 0x1fd28, 0x1ff28, 0x1f9ca, 0x1f9ea
.long 0x1fd30, 0x1ff30, 0x1f9d2, 0x1f9f2, 0x1fd38, 0x1ff38, 0x1f9da, 0x100000
.long 0x1f6f0, 0x1f8f0, 0x1f9c4, 0x1f9e4, 0x1f6f8, 0x1f8f8, 0x1f9cc, 0x1f9ec
.long 0x1f6e0, 0x1f8e0, 0x1f9d4, 0x100000, 0x1f6e8, 0x1f8e8, 0x1f9dc, 0x100000
.long 0x1fd40, 0x1ff40, 0x1f9c6, 0x1f9e6, 0x1fd48, 0x1ff48, 0x1f9ce, 0x1f9ee
.long 0x1fd50, 0x1ff50, 0x1f9d6, 0x100000, 0x1fd58, 0x1ff58, 0x1f9de, 0x100000
.long 0x1f710, 0x1f910, 0x1f9c0, 0x1f9e0, 0x1f718, 0x1f918, 0x1f9c8, 0x1f9e8
.long 0x1f700, 0x1f900, 0x1f9d0, 0x1f9f0, 0x1f708, 0x1f908, 0x1f9d8, 0x100000
.long 0x1fda0, 0x1ffa0, 0x1f9c2, 0x1f9e2, 0x1fda8, 0x1ffa8, 0x1f9ca, 0x1f9ea
.long 0x1fdb0, 0x1ffb0, 0x1f9d2, 0x1f9f2, 0x1fdb8, 0x1ffb8, 0x1f9da, 0x100000
.long 0x1f770, 0x1f970, 0x1f9c4, 0x1f9e4, 0x1f778, 0x1f978, 0x1f9cc, 0x1f9ec
.long 0x1f760, 0x1f960, 0x1f9d4, 0x100000, 0x1f768, 0x1f968, 0x1f9dc, 0x100000
.long 0x1fdc0, 0x1ffc0, 0x1f9c6, 0x1f9e6, 0x1fdc8, 0x1ffc8, 0x1f9ce, 0x1f9ee
.long 0x1fdd0, 0x1ffd0, 0x1f9d6, 0x100000, 0x1fdd8, 0x1ffd8, 0x1f9de, 0x100000
.long 0x1f790, 0x1f990, 0x1f9c0, 0x1f9e0, 0x1f798, 0x1f998, 0x1f9c8, 0x1f9e8
.long 0x1f780, 0x1f980, 0x1f9d0, 0x1f9f0, 0x1f788, 0x1f988, 0x1f9d8, 0x100000
.long 0x1fe20, 0x20020, 0x1f9c2, 0x1f9e2, 0x1fe28, 0x20028, 0x1f9ca, 0x1f9ea
.long 0x1fe30, 0x20030, 0x1f9d2, 0x1f9f2, 0x1fe38, 0x20038, 0x1f9da, 0x100000
.long 0x1f7f0, 0x14d00, 0x1f9c4, 0x1f9e4, 0x1f7f8, 0x14d08, 0x1f9cc, 0x1f9ec
.long 0x1f7e0, 0x14d10, 0x1f9d4, 0x100000, 0x1f7e8, 0x14d18, 0x1f9dc, 0x100000
.long 0x1fe40, 0x14d00, 0x1f9c6, 0x1f9e6, 0x1fe48, 0x14d08, 0x1f9ce, 0x1f9ee
.long 0x1fe50, 0x14d10, 0x1f9d6, 0x100000, 0x1fe58, 0x14d18, 0x1f9de, 0x100000
.long 0x1f810, 0x14d00, 0x1f9c0, 0x1f9e0, 0x1f818, 0x14d08, 0x1f9c8, 0x1f9e8
.long 0x1f800, 0x14d10, 0x1f9d0, 0x1f9f0, 0x1f808, 0x14d18, 0x1f9d8, 0x100000
.long 0x1fea0, 0x14d00, 0x1f9c2, 0x1f9e2, 0x1fea8, 0x14d08, 0x1f9ca, 0x1f9ea
.long 0x1feb0, 0x14d10, 0x1f9d2, 0x1f9f2, 0x1feb8, 0x14d18, 0x1f9da, 0x100000
.long 0x1f870, 0x14d00, 0x1f9c4, 0x1f9e4, 0x1f878, 0x14d08, 0x1f9cc, 0x1f9ec
.long 0x1f860, 0x14d10, 0x1f9d4, 0x100000, 0x1f868, 0x14d18, 0x1f9dc, 0x100000
.long 0x1fec0, 0x14d00, 0x1f9c6, 0x1f9e6, 0x1fec8, 0x14d08, 0x1f9ce, 0x1f9ee
.long 0x1fed0, 0x14d10, 0x1f9d6, 0x100000, 0x1fed8, 0x14d18, 0x1f9de, 0x100000
.long 0x0, 0x4444, 0x0, 0xa400, 0x10, 0xeeee, 0x4, 0xa404
.long 0x20, 0x4444, 0x8, 0xa408, 0x30, 0xeeee, 0xc, 0xa40c
.long 0x40, 0x4444, 0x10, 0xa410, 0x50, 0xeeee, 0x14, 0xa414
.long 0x60, 0x4444, 0x18, 0xa418, 0x70, 0xeeee, 0x1c, 0xa41c
.long 0x0, 0x4444, 0x20, 0xa420, 0x10, 0xeeee, 0x24, 0xa424
.long 0x20, 0x4444, 0x28, 0xa428, 0x30, 0xeeee, 0x2c, 0xa42c
.long 0x40, 0x4444, 0x30, 0xa430, 0x50, 0xeeee, 0x34, 0xa434
.long 0x60, 0x4444, 0x38, 0xa438, 0x70, 0xeeee, 0x3c, 0xa43c
.long 0x0, 0x4444, 0x40, 0xa440, 0x10, 0xeeee, 0x44, 0xa444
.long 0x20, 0x4444, 0x48, 0xa448, 0x30, 0xeeee, 0x4c, 0xa44c
.long 0x40, 0x4444, 0x50, 0xa450, 0x50, 0xeeee, 0x54, 0xa454
.long 0x60, 0x4444, 0x58, 0xa458, 0x70, 0xeeee, 0x5c, 0xa45c
.long 0x0, 0x4444, 0x60, 0xa460, 0x10, 0xeeee, 0x64, 0xa464
.long 0x20, 0x4444, 0x68, 0xa468, 0x30, 0xeeee, 0x6c, 0xa46c
.long 0x40, 0x4444, 0x70, 0xa470, 0x50, 0xeeee, 0x74, 0xa474
.long 0x60, 0x4444, 0x78, 0xa478, 0x70, 0xeeee, 0x7c, 0xa47c
.long 0x0, 0x4444, 0x420, 0xb080, 0x10, 0xeeee, 0x424, 0xb084
.long 0x20, 0x4444, 0x428, 0xb088, 0x30, 0xeeee, 0x42c, 0xb08c
.long 0x40, 0x4444, 0x430, 0xb090, 0x50, 0xeeee, 0x434, 0xb094
.long 0x60, 0x4444, 0x438, 0xb098, 0x70, 0xeeee, 0x43c, 0xb09c
.long 0x0, 0x4444, 0x440, 0xb0a0, 0x10, 0xeeee, 0x444, 0xb0a4
.long 0x20, 0x4444, 0x448, 0xb0a8, 0x30, 0xeeee, 0x44c, 0xb0ac
.long 0x40, 0x4444, 0x450, 0xb0b0, 0x50, 0xeeee, 0x454, 0xb0b4
.long 0x60, 0x4444, 0x458, 0xb0b8, 0x70, 0xeeee, 0x45c, 0xb0bc
.long 0x0, 0x4444, 0x460, 0xb0c0, 0x10, 0xeeee, 0x464, 0xb0c4
.long 0x20, 0x4444, 0x468, 0xb0c8, 0x30, 0xeeee, 0x46c, 0xb0cc
.long 0x40, 0x4444, 0x470, 0xb0d0, 0x50, 0xeeee, 0x474, 0xb0d4
.long 0x60, 0x4444, 0x478, 0xb0d8, 0x70, 0xeeee, 0x47c, 0xb0dc
.long 0x0, 0x4444, 0x480, 0xb0e0, 0x10, 0xeeee, 0x484, 0xb0e4
.long 0x20, 0x4444, 0x488, 0xb0e8, 0x30, 0xeeee, 0x48c, 0xb0ec
.long 0x40, 0x4444, 0x490, 0xb0f0, 0x50, 0xeeee, 0x494, 0xb0f4
.long 0x60, 0x4444, 0x498, 0xb0f8, 0x70, 0xeeee, 0x49c, 0xb0fc
.long 0x1fa28, 0x1f9f4, 0x34, 0x14d00, 0x1fa28, 0x1f9f6, 0x74, 0x14d04
.long 0x1fa28, 0x1f9f8, 0xb4, 0x14d08, 0x1fa28, 0x1f9fa, 0xf4, 0x14d0c
.long 0x1fa28, 0x1f9fc, 0x134, 0x14d10, 0x1fa28, 0x1f9fe, 0x174, 0x14d14
.long 0x1fa28, 0x1fa00, 0x1b4, 0x14d18, 0x1fa28, 0x1fa02, 0x1f4, 0x14d1c
.long 0x1fa28, 0x1fa04, 0x234, 0x14d20, 0x1fa28, 0x1fa06, 0x274, 0x14d24
.long 0x1fa28, 0x1fa08, 0x2b4, 0x14d28, 0x1fa28, 0x1fa0a, 0x2f4, 0x14d2c
.long 0x1fa28, 0x1fa0c, 0x334, 0x14d30, 0x1fa28, 0x1fa0e, 0x374, 0x14d34
.long 0x1fa28, 0x1fa10, 0x3b4, 0x14d38, 0x1fa28, 0x1fa12, 0x3f4, 0x14d3c
.long 0x1fa28, 0x1fa14, 0x434, 0x14d00, 0x1fa28, 0x1fa16, 0x474, 0x14d04
.long 0x1fa28, 0x1fa18, 0x4b4, 0x14d08, 0x1fa28, 0x1fa1a, 0x4f4, 0x14d0c
.long 0x1fa28, 0x1fa1c, 0x534, 0x14d10, 0x1fa28, 0x1fa1e, 0x574, 0x14d14
.long 0x1fa28, 0x1fa20, 0x5b4, 0x14d18, 0x1fa28, 0x1fa22, 0x5f4, 0x14d1c
.long 0x1fa28, 0x1fa24, 0x634, 0x14d20, 0x1fa28, 0x1fa26, 0x674, 0x14d24
.long 0x1fa28, 0x1fa28, 0x6b4, 0x14d28, 0x1fa28, 0x1fa2a, 0x6f4, 0x14d2c
.long 0x1fa28, 0x1fa2c, 0x734, 0x14d30, 0x1fa28, 0x1fa2e, 0x774, 0x14d34
.long 0x1fa28, 0x1fa30, 0x7b4, 0x14d38, 0x1fa28, 0x1fa32, 0x7f4, 0x14d3c
.long 0x1fa38, 0x1fa34, 0x834, 0x14d00, 0x1fa38, 0x1fa36, 0x874, 0x14d04
.long 0x1fa38, 0x1fa38, 0x8b4, 0x14d08, 0x1fa38, 0x1fa3a, 0x8f4, 0x14d0c
.long 0x1fa38, 0x1fa3c, 0x934, 0x14d10, 0x1fa38, 0x1fa3e, 0x974, 0x14d14
.long 0x1fa38, 0x1fa40, 0x9b4, 0x14d18, 0x1fa38, 0x1fa42, 0x9f4, 0x14d1c
.long 0x1fa38, 0x1fa44, 0xa34, 0x14d20, 0x1fa38, 0x1fa46, 0xa74, 0x14d24
.long 0x1fa38, 0x1fa48, 0xab4, 0x14d28, 0x1fa38, 0x1fa4a, 0xaf4, 0x14d2c
.long 0x1fa38, 0x1fa4c, 0xb34, 0x14d30, 0x1fa38, 0x1fa4e, 0xb74, 0x14d34
.long 0x1fa38, 0x1fa50, 0xbb4, 0x14d38, 0x1fa38, 0x1fa52, 0xbf4, 0x14d3c
.long 0x1fa38, 0x1fa54, 0xc34, 0x14d00, 0x1fa38, 0x1fa56, 0xc74, 0x14d04
.long 0x1fa38, 0x1fa58, 0xcb4, 0x14d08, 0x1fa38, 0x1fa5a, 0xcf4, 0x14d0c
.long 0x1fa38, 0x1fa5c, 0xd34, 0x14d10, 0x1fa38, 0x1fa5e, 0xd74, 0x14d14
.long 0x1fa38, 0x1fa60, 0xdb4, 0x14d18, 0x1fa38, 0x1fa62, 0xdf4, 0x14d1c
.long 0x1fa38, 0x1fa64, 0xe34, 0x14d20, 0x1fa38, 0x1fa66, 0xe74, 0x14d24
.long 0x1fa38, 0x1fa68, 0xeb4, 0x14d28, 0x1fa38, 0x1fa6a, 0xef4, 0x14d2c
.long 0x1fa38, 0x1fa6c, 0xf34, 0x14d30, 0x1fa38, 0x1fa6e, 0xf74, 0x14d34
.long 0x1fa38, 0x1fa70, 0xfb4, 0x14d38, 0x1fa38, 0x1fa72, 0xff4, 0x14d3c
.long 0x0, 0x0, 0x0, 0x0, 0x0, 0x0, 0x0, 0x0
.long 0x0, 0x0, 0x0, 0x0, 0x0, 0x0, 0x0, 0x0
.long 0x0, 0x0, 0x0, 0x0, 0x0, 0x0, 0x0, 0x0
.long 0x0, 0x0, 0x0, 0x0, 0x0, 0x0, 0x0, 0x0
.long 0x0, 0x0, 0x0, 0x0, 0x0, 0x0, 0x0, 0x0
.long 0x0, 0x0, 0x0, 0x0, 0x0, 0x0, 0x0, 0x0
.long 0x0, 0x0, 0x0, 0x0, 0x0, 0x0, 0x0, 0x0
.long 0x0, 0x0, 0x0, 0x0, 0x0, 0x0, 0x0, 0x0
.long 0x0, 0x0, 0x0, 0x0, 0x0, 0x0, 0x0, 0x0
.long 0x0, 0x0, 0x0, 0x0, 0x0, 0x0, 0x0, 0x0
.long 0x0, 0x0, 0x0, 0x0, 0x0, 0x0, 0x0, 0x0
.long 0x0, 0x0, 0x0, 0x0, 0x0, 0x0, 0x0, 0x0
.long 0x0, 0x0, 0x0, 0x0, 0x0, 0x0, 0x0, 0x0
.long 0x0, 0x0, 0x0, 0x0, 0x0, 0x0, 0x0, 0x0
.long 0x0, 0x0, 0x0, 0x0, 0x0, 0x0, 0x0, 0x0
.long 0x0, 0x0, 0x0, 0x0, 0x0, 0x0, 0x0, 0x0
.long 0x0, 0x0, 0x0, 0x0, 0x0, 0x0, 0x0, 0x0
.long 0x0, 0x0, 0x0, 0x0, 0x0, 0x0, 0x0, 0x0
.long 0x0, 0x0, 0x0, 0x0, 0x0, 0x0, 0x0, 0x0
.long 0x0, 0x0, 0x0, 0x0, 0x0, 0x0, 0x0, 0x0
.long 0x0, 0x0, 0x0, 0x0, 0x0, 0x0, 0x0, 0x0
.long 0x0, 0x0, 0x0, 0x0, 0x0, 0x0, 0x0, 0x0
.long 0x0, 0x0, 0x0, 0x0, 0x0, 0x0, 0x0, 0x0
.long 0x0, 0x0, 0x0, 0x0, 0x0, 0x0, 0x0, 0x0
.long 0x0, 0x0, 0x0, 0x0, 0x0, 0x0, 0x0, 0x0
.long 0x0, 0x0, 0x0, 0x0, 0x0, 0x0, 0x0, 0x0
.long 0x0, 0x0, 0x0, 0x0, 0x0, 0x0, 0x0, 0x0
.long 0x0, 0x0, 0x0, 0x0, 0x0, 0x0, 0x0, 0x0
.long 0x0, 0x0, 0x0, 0x0, 0x0, 0x0, 0x0, 0x0
.long 0x0, 0x0, 0x0, 0x0, 0x0, 0x0, 0x0, 0x0
.long 0x0, 0x0, 0x0, 0x0, 0x0, 0x0, 0x0, 0x0
.long 0x0, 0x0, 0x0, 0x0, 0x0, 0x0, 0x0, 0x0
.long 0x13320, 0xa9b0, 0xa800, 0x10c00, 0xf320, 0xc120, 0x133b0, 0xb690
.long 0xa890, 0x11920, 0xf3b0, 0xce00, 0x12600, 0xa920, 0xb520, 0x10c90
.long 0xe600, 0xc090, 0x12690, 0xb600, 0xb5b0, 0x119b0, 0xe690, 0xcdb0
.long 0xd5f0, 0x11440, 0x117f0, 0x130d0, 0xf8d0, 0xadf0, 0xd640, 0x12160
.long 0x11840, 0x13df0, 0xf960, 0xbad0, 0xc8d0, 0x113f0, 0x124d0, 0x13160
.long 0xebf0, 0xad60, 0xc960, 0x120d0, 0x12560, 0x13e40, 0xec40, 0xba40
.long 0xefb0, 0x10ed0, 0x117b0, 0x12a40, 0xfa90, 0xdb60, 0xc890, 0x10d60
.long 0x10a90, 0x129f0, 0x13bb0, 0xddf0, 0xf000, 0x11bf0, 0x11520, 0xe960
.long 0xc160, 0xf9b0, 0xc920, 0x11a40, 0x10800, 0xe8d0, 0xc3f0, 0x13a90
.long 0xce40, 0xfa00, 0xfff0, 0xbb20, 0xedb0, 0xdad0, 0xced0, 0x10720
.long 0x10040, 0xc800, 0x14890, 0xde40, 0xf560, 0xfbb0, 0x140d0, 0xbdb0
.long 0xb3f0, 0xec00, 0xf5f0, 0x10890, 0x14160, 0xca90, 0xb760, 0x14720
.long 0x13520, 0xddb0, 0xa520, 0xbe00, 0xf490, 0xe800, 0x13690, 0x10490
.long 0xa5b0, 0xcb20, 0xe7b0, 0x14d00, 0x12800, 0xdd20, 0xb200, 0xbe90
.long 0xf800, 0x14320, 0x129b0, 0x10400, 0xb290, 0xcbb0, 0xeb20, 0x14290
.long 0xd560, 0x10760, 0x112d0, 0xaed0, 0xfb60, 0xeed0, 0xd3f0, 0xe040
.long 0x11360, 0xbbf0, 0xee40, 0x14d00, 0xc840, 0x106d0, 0x11ff0, 0xaf60
.long 0xfed0, 0x149f0, 0xc6d0, 0xdff0, 0x12040, 0xbc40, 0xf1f0, 0x14960
.long 0xbbb0, 0x10cd0, 0xfdb0, 0x12960, 0xd3b0, 0xd9f0, 0x13090, 0x11160
.long 0x13e90, 0x12bf0, 0xbff0, 0xd290, 0xbc00, 0x119f0, 0xfb20, 0xe840
.long 0xac90, 0xd840, 0x13120, 0x11e40, 0x13c00, 0xead0, 0xbe40, 0xabb0
.long 0xcf60, 0x11400, 0x101f0, 0xef20, 0x12e90, 0xdd60, 0xccd0, 0xd320
.long 0x10560, 0x14a00, 0xb640, 0x12d20, 0xf640, 0x115b0, 0x142d0, 0xf1b0
.long 0x121b0, 0xdcd0, 0xf3f0, 0xd490, 0x14640, 0x14c90, 0xb5f0, 0x12000
.long 0x13600, 0xf7b0, 0xa490, 0xb120, 0x10d20, 0xc200, 0x135b0, 0xea90
.long 0xa400, 0x14d00, 0x10db0, 0xcf20, 0x12920, 0xf720, 0xaa00, 0x14000
.long 0x11a00, 0xc290, 0x12890, 0xea00, 0xb720, 0x14090, 0x11a90, 0xcfb0
.long 0xd4d0, 0xfa40, 0x11760, 0x123f0, 0x12cd0, 0xaff0, 0xd440, 0xed60
.long 0x116d0, 0x14d00, 0x12d60, 0xbcd0, 0xc7f0, 0xf9f0, 0x118d0, 0x14ad0
.long 0x139f0, 0xb040, 0xc760, 0xecd0, 0x125f0, 0x14b60, 0x13a40, 0xbd60
.long 0xe290, 0x10e40, 0xc9b0, 0x12760, 0xfe00, 0x13640, 0x10df0, 0xd5b0
.long 0xf090, 0x128d0, 0x13f20, 0x138d0, 0xe320, 0x11b60, 0x12640, 0xafb0
.long 0xfe90, 0x14360, 0x11ad0, 0xd600, 0xe560, 0xad20, 0x13fb0, 0x145f0
.long 0xe000, 0xcd60, 0x10920, 0x102d0, 0xa6d0, 0xebb0, 0xd040, 0x12e00
.long 0xfc00, 0x10240, 0xaa40, 0x14690, 0xe1b0, 0xf440, 0x103f0, 0x12320
.long 0xe7f0, 0xee00, 0xf760, 0x12fb0, 0x144d0, 0x125b0, 0xeb60, 0x14920
.long 0x13720, 0x111b0, 0xdb20, 0xf400, 0x11090, 0x11d20, 0x137b0, 0x11e90
.long 0xda90, 0xe720, 0x11db0, 0x14d00, 0x12a00, 0x11120, 0x10200, 0xf5b0
.long 0x11200, 0x14400, 0x12a90, 0x11e00, 0x101b0, 0xe890, 0x11f20, 0x14490
.long 0xd6d0, 0x12e40, 0x108d0, 0xfc40, 0x13240, 0x13ed0, 0xd760, 0x13b60
.long 0x10840, 0xef60, 0x13f60, 0x14d00, 0xc9f0, 0x12df0, 0xe1f0, 0xfad0
.long 0x132d0, 0x14bf0, 0xca40, 0x13ad0, 0xe160, 0xedf0, 0x13ff0, 0x14c40
.long 0x11690, 0x11040, 0xde90, 0xa640, 0x10b20, 0x136d0, 0x109b0, 0x10ff0
.long 0xa5f0, 0xd1b0, 0x10bb0, 0x143f0, 0x11720, 0x11d60, 0xdf20, 0xb360
.long 0xb000, 0x13360, 0x10a00, 0x11cd0, 0xb2d0, 0xd200, 0xb090, 0x14040
.long 0xcbf0, 0xb920, 0xe400, 0x13560, 0xa560, 0xc490, 0xcc40, 0xc600
.long 0x13840, 0x13200, 0xe640, 0xc720, 0xf2d0, 0xba90, 0xdfb0, 0xc040
.long 0xa8d0, 0x11fb0, 0xf360, 0xc7b0, 0xc360, 0x12db0, 0xe9f0, 0x12200
.long 0x13400, 0xc3b0, 0xdc00, 0x10e00, 0xbfb0, 0xcc00, 0x13490, 0xd090
.long 0xdc90, 0x11b20, 0xcc90, 0x14d00, 0x12720, 0xc320, 0x10320, 0x10fb0
.long 0xc400, 0x14120, 0x127b0, 0xd000, 0x103b0, 0x11c90, 0xd120, 0x141b0
.long 0xd1f0, 0xac40, 0x10ad0, 0x13040, 0xab60, 0xb7f0, 0xd240, 0xb960
.long 0x10b60, 0x13d60, 0xb840, 0x14d00, 0xc4d0, 0xabf0, 0xe3f0, 0x12ed0
.long 0xb0d0, 0x146d0, 0xc560, 0xb8d0, 0xe440, 0x13bf0, 0xbdf0, 0x14760
.long 0xfc90, 0x10f60, 0x11290, 0xa840, 0x13d20, 0x104d0, 0x13db0, 0x111f0
.long 0x105b0, 0xa7f0, 0x13c90, 0xf7f0, 0xfd20, 0x11c40, 0x11320, 0xb560
.long 0xae00, 0xff60, 0x13e00, 0x11ed0, 0x10600, 0xb4d0, 0xadb0, 0xf240
.long 0xcdf0, 0xed20, 0x133f0, 0xbd20, 0x12c40, 0x14bb0, 0xd160, 0x14800
.long 0x13440, 0xca00, 0x11f60, 0x14b20, 0xf4d0, 0xee90, 0xbed0, 0xb890
.long 0x12ad0, 0x12490, 0xf840, 0x149b0, 0xbf60, 0xc5b0, 0x11df0, 0x12400
.long 0x12bb0, 0x13800, 0xd920, 0xc000, 0x14600, 0x14d00, 0x13890, 0x14d00
.long 0xd9b0, 0xcd20, 0xc5f0, 0x14d00, 0x13920, 0x145b0, 0x10000, 0xc1b0
.long 0xb1b0, 0x14d00, 0x12c00, 0x14520, 0x10090, 0xce90, 0xfbf0, 0x14d00
.long 0xc640, 0xd2d0, 0x105f0, 0xae40, 0x14cd0, 0x14d00, 0xd360, 0x14d00
.long 0x10640, 0xbb60, 0xbf20, 0x14d00, 0xd7f0, 0x14840, 0xded0, 0xacd0
.long 0x10290, 0x14d00, 0xcad0, 0x147f0, 0xdf60, 0xb9f0, 0x11000, 0x14d00
.long 0x14a90, 0x11240, 0xf890, 0xa760, 0x14d00, 0xaad0, 0x123b0, 0x110d0
.long 0x139b0, 0xa9f0, 0x14d00, 0x12b20, 0x10c40, 0xae90, 0xf920, 0xb440
.long 0xe0d0, 0x14d00, 0x11960, 0xaf20, 0x13a00, 0xb6d0, 0x131f0, 0x14d00
.long 0x13b20, 0xd0d0, 0x135f0, 0xf120, 0x14d00, 0x12440, 0xac00, 0xcb60
.long 0x13960, 0x14c00, 0xf520, 0x14d00, 0xcff0, 0x12120, 0xc0d0, 0xec90
.long 0xda40, 0xe090, 0xf6d0, 0x12290, 0xc440, 0x147b0, 0x14d00, 0x14d00
.long 0xa600, 0xd800, 0xdbb0, 0x10120, 0x0, 0x0, 0xa7b0, 0xff20
.long 0xda00, 0x14d00, 0x0, 0x0, 0xb320, 0xd890, 0xde00, 0x14200
.long 0x0, 0x0, 0xb490, 0xffb0, 0x10520, 0x143b0, 0x0, 0x0
.long 0x11640, 0x109f0, 0x107f0, 0xe240, 0x0, 0x0, 0x114d0, 0xe2d0
.long 0x10960, 0x14d00, 0x0, 0x0, 0x12360, 0x10a40, 0x10bf0, 0x14a40
.long 0x0, 0x0, 0x121f0, 0xe360, 0xe4d0, 0x148d0, 0x0, 0x0
.long 0xbc90, 0x126d0, 0x12c90, 0xa960, 0x0, 0x0, 0x131b0, 0x12b60
.long 0xb7b0, 0xa4d0, 0x0, 0x0, 0xba00, 0xe5f0, 0xa440, 0xaa90
.long 0x0, 0x0, 0x12f20, 0xea40, 0xb160, 0xab20, 0x0, 0x0
.long 0x10360, 0x11600, 0xd720, 0x134d0, 0x0, 0x0, 0x100d0, 0xd520
.long 0x11800, 0x13760, 0x0, 0x0, 0x14440, 0x11890, 0x137f0, 0x12520
.long 0x0, 0x0, 0x141f0, 0xd7b0, 0xc2d0, 0x12090, 0x0, 0x0
.long 0xa720, 0xf200, 0xf600, 0x10f20, 0x0, 0x0, 0xa690, 0xe520
.long 0xf690, 0x11c00, 0x0, 0x0, 0xb400, 0xf290, 0xe920, 0x10e90
.long 0x0, 0x0, 0xb3b0, 0xe5b0, 0xe9b0, 0x11bb0, 0x0, 0x0
.long 0x115f0, 0xfcd0, 0xfdf0, 0x12ff0, 0x0, 0x0, 0x11560, 0xeff0
.long 0xfe40, 0x13cd0, 0x0, 0x0, 0x122d0, 0xfd60, 0xf0d0, 0x12f60
.long 0x0, 0x0, 0x12240, 0xf040, 0xf160, 0x13c40, 0x0, 0x0
.long 0xe3b0, 0x12840, 0x11490, 0xdc40, 0x0, 0x0, 0x127f0, 0xd690
.long 0x107b0, 0xdbf0, 0x0, 0x0, 0xe120, 0xe760, 0xc240, 0x113b0
.long 0x0, 0x0, 0xe6d0, 0xd400, 0xc1f0, 0x10690, 0x0, 0x0
.long 0xe200, 0x10160, 0xb9b0, 0xd8d0, 0x0, 0x0, 0x10440, 0x13000
.long 0xc690, 0xd960, 0x0, 0x0, 0xe490, 0x14240, 0xb1f0, 0xb800
.long 0x0, 0x0, 0x14560, 0x13290, 0xb240, 0xc520, 0x0, 0x0
.long 0x0, 0x0, 0x0, 0x0, 0x0, 0x0, 0x0, 0x0
.long 0x0, 0x0, 0x0, 0x0, 0x0, 0x0, 0x0, 0x0
.long 0x0, 0x0, 0x0, 0x0, 0x0, 0x0, 0x0, 0x0
.long 0x0, 0x0, 0x0, 0x0, 0x0, 0x0, 0x0, 0x0
.long 0x0, 0x0, 0x0, 0x0, 0x0, 0x0, 0x0, 0x0
.long 0x0, 0x0, 0x0, 0x0, 0x0, 0x0, 0x0, 0x0
.long 0x0, 0x0, 0x0, 0x0, 0x0, 0x0, 0x0, 0x0
.long 0x0, 0x0, 0x0, 0x0, 0x0, 0x0, 0x0, 0x0
.long 0x0, 0x0, 0x0, 0x0, 0x0, 0x0, 0x0, 0x0
.long 0x0, 0x0, 0x0, 0x0, 0x0, 0x0, 0x0, 0x0
.long 0x0, 0x0, 0x0, 0x0, 0x0, 0x0, 0x0, 0x0
.long 0x0, 0x0, 0x0, 0x0, 0x0, 0x0, 0x0, 0x0
.long 0x0, 0x0, 0x0, 0x0, 0x0, 0x0, 0x0, 0x0
.long 0x0, 0x0, 0x0, 0x0, 0x0, 0x0, 0x0, 0x0
.long 0x0, 0x0, 0x0, 0x0, 0x0, 0x0, 0x0, 0x0
.long 0x0, 0x0, 0x0, 0x0, 0x0, 0x0, 0x0, 0x0
.long 0x0, 0x0, 0x0, 0x0, 0x0, 0x0, 0x0, 0x0
.long 0x0, 0x0, 0x0, 0x0, 0x0, 0x0, 0x0, 0x0
.long 0x0, 0x0, 0x0, 0x0, 0x0, 0x0, 0x0, 0x0
.long 0x0, 0x0, 0x0, 0x0, 0x0, 0x0, 0x0, 0x0
.long 0x0, 0x0, 0x0, 0x0, 0x0, 0x0, 0x0, 0x0
.long 0x0, 0x0, 0x0, 0x0, 0x0, 0x0, 0x0, 0x0
.long 0x0, 0x0, 0x0, 0x0, 0x0, 0x0, 0x0, 0x0
.long 0x0, 0x0, 0x0, 0x0, 0x0, 0x0, 0x0, 0x0
.long 0x0, 0x0, 0x0, 0x0, 0x0, 0x0, 0x0, 0x0
.long 0x0, 0x0, 0x0, 0x0, 0x0, 0x0, 0x0, 0x0
.long 0x0, 0x0, 0x0, 0x0, 0x0, 0x0, 0x0, 0x0
.long 0x0, 0x0, 0x0, 0x0, 0x0, 0x0, 0x0, 0x0
.long 0x0, 0x0, 0x0, 0x0, 0x0, 0x0, 0x0, 0x0
.long 0x0, 0x0, 0x0, 0x0, 0x0, 0x0, 0x0, 0x0
.long 0x0, 0x0, 0x0, 0x0, 0x0, 0x0, 0x0, 0x0
.long 0x0, 0x0, 0x0, 0x0, 0x0, 0x0, 0x0, 0x0
.section .rodata,"a"
.p2align 6
.amdhsa_kernel standalone__deep_cross_xdeepfm__recsys_kernel
  .amdhsa_next_free_vgpr 256
  .amdhsa_next_free_sgpr 102
  .amdhsa_accum_offset 256
  .amdhsa_group_segment_fixed_size 0
  .amdhsa_kernarg_size 88
  .amdhsa_user_sgpr_count 2
  .amdhsa_user_sgpr_kernarg_segment_ptr 1
  .amdhsa_system_sgpr_workgroup_id_x 1
  .amdhsa_float_denorm_mode_32 3
.end_amdhsa_kernel
```

```asm
; @launch grid=(256,1,1) block=(512,1,1) lds=163840
.amdgcn_target "amdgcn-amd-amdhsa--gfx950"
.text
.globl standalone__deep_cross_xdeepfm__recsys_kernel
.p2align 8
.type standalone__deep_cross_xdeepfm__recsys_kernel,@function
standalone__deep_cross_xdeepfm__recsys_kernel:
  s_cmp_ge_u32 s2, 256
  s_cbranch_scc1 L_end
  s_load_dwordx16 s[4:19], s[0:1], 0
  s_load_dwordx4 s[20:23], s[0:1], 64
  s_load_dwordx2 s[24:25], s[0:1], 80
  v_lshrrev_b32 v1, 6, v0
  s_getpc_b64 s[92:93]
L_pc:
  s_and_b32 s68, s2, 0xf8
  v_add_u32 v2, s68, v1
  v_and_b32_e64 v3, 32, v0
  v_lshl_add_u32 v2, v3, 3, v2
  v_lshlrev_b32 v2, 7, v2
  v_min_u32 v2, L_end-L_pc, v2
  v_mov_b32 v3, s93
  v_add_co_u32 v2, vcc, s92, v2
  s_nop 1
  v_addc_co_u32 v3, vcc, 0, v3, vcc
  global_load_dword v251, v[2:3], off
  v_and_b32 v0, 63, v0
  v_readfirstlane_b32 s3, v1
  s_and_b32 s68, s2, 7
  s_lshr_b32 s69, s2, 3
  s_xor_b32 s69, s69, 31
  s_and_b32 s80, s2, 0xf8
  s_add_u32 s80, s80, s3
  s_lshl_b32 s80, s80, 0
  s_min_u32 s70, s68, 1
  s_add_u32 s71, s69, s70
  s_cmp_ge_u32 s71, 22
  s_cbranch_scc1 L_cin
  s_mul_i32 s68, s68, 21
  s_add_u32 s68, s68, s71
  s_mul_i32 s26, s68, 5042
  s_lshr_b32 s26, s26, 16
  s_mul_i32 s69, s26, 13
  s_sub_u32 s27, s68, s69
  s_lshl_b32 s77, s27, 8
  s_mul_i32 s71, s26, 320
  v_lshrrev_b32 v116, 4, v0
  v_lshlrev_b32 v11, 4, v0
  s_and_b32 s79, s3, 3
  s_cmp_lt_u32 s3, 4
  s_cbranch_scc1 L_cmp
  s_lshr_b32 s68, s79, 1
  s_mul_i32 s68, s68, 20
  s_and_b32 s69, s79, 1
  s_add_u32 s68, s68, s69
  s_lshl_b32 s76, s68, 10
  s_mul_i32 s78, s71, 104
  s_mul_i32 s68, s68, 832
  s_add_u32 s94, s78, s68
  v_mul_u32_u24 v118, 48, v116
  v_sub_u32 v12, v11, v118
  s_add_u32 s95, s94, 3328
  s_add_u32 s96, s94, 6656
  s_add_u32 s97, s94, 9984
  s_add_u32 s98, s94, 13312
  s_and_b32 s70, s79, 1
  s_lshl_b32 s70, s70, 3
  v_lshlrev_b32 v117, 1, v116
  v_or_b32 v117, s70, v117
  v_xor_b32 v117, v117, v0
  v_and_b32_e64 v117, 15, v117
  v_mul_u32_u24 v4, 3328, v116
  v_lshl_add_u32 v4, v117, 4, v4
  v_add_u32 v5, 13312, v4
  s_mul_i32 s74, s79, 26624
  s_add_u32 s74, s74, s77
  s_lshl_b32 s75, s79, 11
  s_waitcnt lgkmcnt(0)
  s_mov_b32 s28, s4
  s_and_b32 s29, s5, 0xffff
  s_mov_b32 s30, 425984
  s_mov_b32 s31, 0x20000
  buffer_load_dwordx4 v[16:19], v12, s[28:31], s94 offen offset:0
  s_mov_b32 s32, s6
  s_and_b32 s33, s7, 0xffff
  s_mov_b32 s34, 12800000
  s_mov_b32 s35, 0x20000
  s_mov_b32 s44, s12
  s_and_b32 s45, s13, 0xffff
  s_mov_b32 s46, 5537792
  s_mov_b32 s47, 0x20000
  s_add_u32 m0, s75, 131072
  s_nop 0
  buffer_load_dwordx4 v4, s[44:47], s74 offen lds
  s_add_u32 m0, s75, 132096
  s_nop 0
  buffer_load_dwordx4 v5, s[44:47], s74 offen lds
  s_add_u32 s74, s74, 106496
  s_add_u32 m0, s75, 139264
  s_nop 0
  buffer_load_dwordx4 v4, s[44:47], s74 offen lds
  s_add_u32 m0, s75, 140288
  s_nop 0
  buffer_load_dwordx4 v5, s[44:47], s74 offen lds
  s_add_u32 s74, s74, 106496
  buffer_load_dwordx4 v[20:23], v12, s[28:31], s94 offen offset:1664
  buffer_load_dwordx4 v[24:27], v12, s[28:31], s95 offen offset:0
  buffer_load_dwordx4 v[28:31], v12, s[28:31], s95 offen offset:1664
  buffer_load_dwordx4 v[32:35], v12, s[28:31], s96 offen offset:0
  buffer_load_dwordx4 v[36:39], v12, s[28:31], s96 offen offset:1664
  buffer_load_dwordx4 v[40:43], v12, s[28:31], s97 offen offset:0
  buffer_load_dwordx4 v[44:47], v12, s[28:31], s97 offen offset:1664
  buffer_load_dwordx4 v[48:51], v12, s[28:31], s98 offen offset:0
  buffer_load_dwordx4 v[52:55], v12, s[28:31], s98 offen offset:1664
  s_lshl_b32 s70, s69, 6
  v_and_b32 v118, 7, v0
  v_xor_b32 v118, v118, v116
  v_lshlrev_b32 v118, 4, v118
  v_xor_b32 v2, s70, v118
  v_xor_b32 v3, 64, v2
  s_mov_b32 s72, 0
  s_mul_i32 s70, s79, 13
  s_add_u32 s70, s70, s27
  s_min_u32 s70, s70, 39
  s_lshl_b32 s70, s70, 3
  s_add_u32 s70, s70, s71
  s_mul_i32 s84, s70, 104
  v_lshrrev_b32 v118, 2, v0
  v_min_u32 v118, 7, v118
  v_mul_u32_u24 v118, 104, v118
  v_and_b32 v117, 3, v0
  v_lshl_add_u32 v7, v117, 2, v118
  s_lshl_b32 s70, s26, 2
  s_add_u32 s70, s70, s79
  s_add_u32 s70, s70, 384
  s_mul_i32 s85, s70, 3328
  s_add_u32 s85, s85, s77
  s_mov_b32 s70, 173056
  v_lshrrev_b32 v118, 1, v0
  v_mul_lo_u32 v118, s70, v118
  v_and_b32 v117, 1, v0
  v_lshl_add_u32 v76, v117, 7, v118
  s_mov_b32 s52, s16
  s_and_b32 s53, s17, 0xffff
  s_mov_b32 s54, 3328
  s_mov_b32 s55, 0x20000
  s_mul_i32 s70, s79, 2560
  s_add_u32 s70, s70, L_tail-L_pc
  v_lshlrev_b32 v8, 7, v0
  v_add_u32 v8, s70, v8
  v_mov_b32 v9, s93
  v_add_co_u32 v8, vcc, s92, v8
  s_nop 1
  v_addc_co_u32 v9, vcc, 0, v9, vcc
  s_waitcnt vmcnt(13)
  v_lshlrev_b32 v16, 7, v16
  v_lshlrev_b32 v18, 7, v18
  v_lshlrev_b32 v17, 7, v17
  v_lshlrev_b32_e64 v19, 7, v19
  v_add_u32_dpp v56, v16, v2 row_newbcast:0 row_mask:0xf bank_mask:0x3
  s_nop 1
  v_add_u32_dpp v56, v18, v2 row_newbcast:6 row_mask:0xf bank_mask:0xc
  s_add_u32 m0, s76, 0
  s_nop 0
  buffer_load_dwordx4 v56, s[32:35], 0 offen lds
  s_waitcnt vmcnt(10)
  s_barrier
  s_waitcnt vmcnt(9)
  v_lshlrev_b32 v20, 7, v20
  v_lshlrev_b32 v22, 7, v22
  v_lshlrev_b32 v21, 7, v21
  v_lshlrev_b32 v23, 7, v23
  v_add_u32_dpp v57, v20, v2 row_newbcast:0 row_mask:0xf bank_mask:0x3
  s_nop 1
  v_add_u32_dpp v57, v22, v2 row_newbcast:6 row_mask:0xf bank_mask:0xc
  s_add_u32 m0, s76, 2048
  s_nop 0
  buffer_load_dwordx4 v57, s[32:35], 0 offen lds
  s_waitcnt vmcnt(9)
  v_lshlrev_b32 v24, 7, v24
  v_lshlrev_b32 v26, 7, v26
  v_lshlrev_b32 v25, 7, v25
  v_lshlrev_b32 v27, 7, v27
  v_add_u32_dpp v58, v24, v2 row_newbcast:0 row_mask:0xf bank_mask:0x3
  s_nop 1
  v_add_u32_dpp v58, v26, v2 row_newbcast:6 row_mask:0xf bank_mask:0xc
  s_add_u32 m0, s76, 4096
  s_nop 0
  buffer_load_dwordx4 v58, s[32:35], 0 offen lds
  s_waitcnt vmcnt(9)
  v_lshlrev_b32 v28, 7, v28
  v_lshlrev_b32 v30, 7, v30
  v_lshlrev_b32 v29, 7, v29
  v_lshlrev_b32_e64 v31, 7, v31
  v_add_u32_dpp v59, v28, v2 row_newbcast:0 row_mask:0xf bank_mask:0x3
  s_nop 1
  v_add_u32_dpp v59, v30, v2 row_newbcast:6 row_mask:0xf bank_mask:0xc
  s_add_u32 m0, s76, 6144
  s_nop 0
  buffer_load_dwordx4 v59, s[32:35], 0 offen lds
  s_waitcnt vmcnt(9)
  v_lshlrev_b32 v32, 7, v32
  v_lshlrev_b32 v34, 7, v34
  v_lshlrev_b32 v33, 7, v33
  v_lshlrev_b32_e64 v35, 7, v35
  v_add_u32_dpp v60, v32, v2 row_newbcast:0 row_mask:0xf bank_mask:0x3
  s_nop 1
  v_add_u32_dpp v60, v34, v2 row_newbcast:6 row_mask:0xf bank_mask:0xc
  s_add_u32 m0, s76, 8192
  s_nop 0
  buffer_load_dwordx4 v60, s[32:35], 0 offen lds
  s_waitcnt vmcnt(9)
  v_lshlrev_b32 v36, 7, v36
  v_lshlrev_b32 v38, 7, v38
  v_lshlrev_b32 v37, 7, v37
  v_lshlrev_b32_e64 v39, 7, v39
  v_add_u32_dpp v61, v36, v2 row_newbcast:0 row_mask:0xf bank_mask:0x3
  s_nop 1
  v_add_u32_dpp v61, v38, v2 row_newbcast:6 row_mask:0xf bank_mask:0xc
  s_add_u32 m0, s76, 10240
  s_nop 0
  buffer_load_dwordx4 v61, s[32:35], 0 offen lds
  s_waitcnt vmcnt(9)
  v_lshlrev_b32 v40, 7, v40
  v_lshlrev_b32 v42, 7, v42
  v_lshlrev_b32 v41, 7, v41
  v_lshlrev_b32_e64 v43, 7, v43
  v_add_u32_dpp v62, v40, v2 row_newbcast:0 row_mask:0xf bank_mask:0x3
  s_nop 1
  v_add_u32_dpp v62, v42, v2 row_newbcast:6 row_mask:0xf bank_mask:0xc
  s_add_u32 m0, s76, 12288
  s_nop 0
  buffer_load_dwordx4 v62, s[32:35], 0 offen lds
  s_waitcnt vmcnt(9)
  v_lshlrev_b32 v44, 7, v44
  v_lshlrev_b32 v46, 7, v46
  v_lshlrev_b32 v45, 7, v45
  v_lshlrev_b32_e64 v47, 7, v47
  v_add_u32_dpp v63, v44, v2 row_newbcast:0 row_mask:0xf bank_mask:0x3
  s_nop 1
  v_add_u32_dpp v63, v46, v2 row_newbcast:6 row_mask:0xf bank_mask:0xc
  s_add_u32 m0, s76, 14336
  s_nop 0
  buffer_load_dwordx4 v63, s[32:35], 0 offen lds
  s_waitcnt vmcnt(9)
  v_lshlrev_b32 v48, 7, v48
  v_lshlrev_b32 v50, 7, v50
  v_lshlrev_b32 v49, 7, v49
  v_lshlrev_b32_e64 v51, 7, v51
  v_add_u32_dpp v64, v48, v2 row_newbcast:0 row_mask:0xf bank_mask:0x3
  s_nop 1
  v_add_u32_dpp v64, v50, v2 row_newbcast:6 row_mask:0xf bank_mask:0xc
  s_add_u32 m0, s76, 16384
  s_nop 0
  buffer_load_dwordx4 v64, s[32:35], 0 offen lds
  s_waitcnt vmcnt(9)
  v_lshlrev_b32 v52, 7, v52
  v_lshlrev_b32 v54, 7, v54
  v_lshlrev_b32 v53, 7, v53
  v_lshlrev_b32_e64 v55, 7, v55
  v_add_u32_dpp v65, v52, v2 row_newbcast:0 row_mask:0xf bank_mask:0x3
  s_nop 1
  v_add_u32_dpp v65, v54, v2 row_newbcast:6 row_mask:0xf bank_mask:0xc
  s_add_u32 m0, s76, 18432
  s_nop 0
  buffer_load_dwordx4 v65, s[32:35], 0 offen lds
  v_add_u32_dpp v56, v17, v2 row_newbcast:0 row_mask:0xf bank_mask:0x3
  s_nop 1
  v_add_u32_dpp v56, v19, v2 row_newbcast:6 row_mask:0xf bank_mask:0xc
  s_add_u32 m0, s76, 40960
  s_nop 0
  buffer_load_dwordx4 v56, s[32:35], 0 offen lds
  v_add_u32_dpp v57, v21, v2 row_newbcast:0 row_mask:0xf bank_mask:0x3
  s_nop 1
  v_add_u32_dpp v57, v23, v2 row_newbcast:6 row_mask:0xf bank_mask:0xc
  s_add_u32 m0, s76, 43008
  s_nop 0
  buffer_load_dwordx4 v57, s[32:35], 0 offen lds
  v_add_u32_dpp v58, v25, v2 row_newbcast:0 row_mask:0xf bank_mask:0x3
  s_nop 1
  v_add_u32_dpp v58, v27, v2 row_newbcast:6 row_mask:0xf bank_mask:0xc
  s_add_u32 m0, s76, 45056
  s_nop 0
  buffer_load_dwordx4 v58, s[32:35], 0 offen lds
  v_add_u32_dpp v59, v29, v2 row_newbcast:0 row_mask:0xf bank_mask:0x3
  s_nop 1
  v_add_u32_dpp v59, v31, v2 row_newbcast:6 row_mask:0xf bank_mask:0xc
  s_add_u32 m0, s76, 47104
  s_nop 0
  buffer_load_dwordx4 v59, s[32:35], 0 offen lds
  v_add_u32_dpp v60, v33, v2 row_newbcast:0 row_mask:0xf bank_mask:0x3
  s_nop 1
  v_add_u32_dpp v60, v35, v2 row_newbcast:6 row_mask:0xf bank_mask:0xc
  s_add_u32 m0, s76, 49152
  s_nop 0
  buffer_load_dwordx4 v60, s[32:35], 0 offen lds
  s_waitcnt vmcnt(11)
  s_barrier
  v_add_u32_dpp v61, v37, v2 row_newbcast:0 row_mask:0xf bank_mask:0x3
  s_nop 1
  v_add_u32_dpp v61, v39, v2 row_newbcast:6 row_mask:0xf bank_mask:0xc
  s_add_u32 m0, s76, 51200
  s_nop 0
  buffer_load_dwordx4 v61, s[32:35], 0 offen lds
  v_add_u32_dpp v62, v41, v2 row_newbcast:0 row_mask:0xf bank_mask:0x3
  s_nop 1
  v_add_u32_dpp v62, v43, v2 row_newbcast:6 row_mask:0xf bank_mask:0xc
  s_add_u32 m0, s76, 53248
  s_nop 0
  buffer_load_dwordx4 v62, s[32:35], 0 offen lds
  v_add_u32_dpp v63, v45, v2 row_newbcast:0 row_mask:0xf bank_mask:0x3
  s_nop 1
  v_add_u32_dpp v63, v47, v2 row_newbcast:6 row_mask:0xf bank_mask:0xc
  s_add_u32 m0, s76, 55296
  s_nop 0
  buffer_load_dwordx4 v63, s[32:35], 0 offen lds
  v_add_u32_dpp v64, v49, v2 row_newbcast:0 row_mask:0xf bank_mask:0x3
  s_nop 1
  v_add_u32_dpp v64, v51, v2 row_newbcast:6 row_mask:0xf bank_mask:0xc
  s_add_u32 m0, s76, 57344
  s_nop 0
  buffer_load_dwordx4 v64, s[32:35], 0 offen lds
  v_add_u32_dpp v65, v53, v2 row_newbcast:0 row_mask:0xf bank_mask:0x3
  s_nop 1
  v_add_u32_dpp v65, v55, v2 row_newbcast:6 row_mask:0xf bank_mask:0xc
  s_add_u32 m0, s76, 59392
  s_nop 0
  buffer_load_dwordx4 v65, s[32:35], 0 offen lds
  s_waitcnt vmcnt(10)
  s_barrier
  s_add_u32 m0, s75, 147456
  s_nop 0
  buffer_load_dwordx4 v4, s[44:47], s74 offen lds
  s_add_u32 m0, s75, 148480
  s_nop 0
  buffer_load_dwordx4 v5, s[44:47], s74 offen lds
  s_add_u32 s74, s74, 106496
  s_add_u32 m0, s75, 155648
  s_nop 0
  buffer_load_dwordx4 v4, s[44:47], s74 offen lds
  s_add_u32 m0, s75, 156672
  s_nop 0
  buffer_load_dwordx4 v5, s[44:47], s74 offen lds
  s_add_u32 s74, s74, 106496
  v_add_u32_dpp v56, v18, v2 row_newbcast:0 row_mask:0xf bank_mask:0x3
  v_add_u32_dpp v57, v22, v2 row_newbcast:0 row_mask:0xf bank_mask:0x3
  v_add_u32_dpp v58, v26, v2 row_newbcast:0 row_mask:0xf bank_mask:0x3
  v_add_u32_dpp v59, v30, v2 row_newbcast:0 row_mask:0xf bank_mask:0x3
  v_add_u32_dpp v60, v34, v2 row_newbcast:0 row_mask:0xf bank_mask:0x3
  v_add_u32_dpp v61, v38, v2 row_newbcast:0 row_mask:0xf bank_mask:0x3
  v_add_u32_dpp v62, v42, v2 row_newbcast:0 row_mask:0xf bank_mask:0x3
  v_add_u32_dpp v63, v46, v2 row_newbcast:0 row_mask:0xf bank_mask:0x3
  v_add_u32_dpp v64, v50, v2 row_newbcast:0 row_mask:0xf bank_mask:0x3
  v_add_u32_dpp v65, v54, v2 row_newbcast:0 row_mask:0xf bank_mask:0x3
  v_add_u32_dpp v56, v16, v2 row_newbcast:7 row_mask:0xf bank_mask:0xc
  v_add_u32_dpp v57, v20, v2 row_newbcast:7 row_mask:0xf bank_mask:0xc
  v_add_u32_dpp v58, v24, v2 row_newbcast:7 row_mask:0xf bank_mask:0xc
  v_add_u32_dpp v59, v28, v2 row_newbcast:7 row_mask:0xf bank_mask:0xc
  v_add_u32_dpp v60, v32, v2 row_newbcast:7 row_mask:0xf bank_mask:0xc
  v_add_u32_dpp v61, v36, v2 row_newbcast:7 row_mask:0xf bank_mask:0xc
  v_add_u32_dpp v62, v40, v2 row_newbcast:7 row_mask:0xf bank_mask:0xc
  v_add_u32_dpp v63, v44, v2 row_newbcast:7 row_mask:0xf bank_mask:0xc
  v_add_u32_dpp v64, v48, v2 row_newbcast:7 row_mask:0xf bank_mask:0xc
  v_add_u32_dpp v65, v52, v2 row_newbcast:7 row_mask:0xf bank_mask:0xc
  s_add_u32 m0, s76, 81920
  s_nop 0
  buffer_load_dwordx4 v56, s[32:35], 0 offen lds
  s_add_u32 m0, s76, 83968
  s_nop 0
  buffer_load_dwordx4 v57, s[32:35], 0 offen lds
  s_add_u32 m0, s76, 86016
  s_nop 0
  buffer_load_dwordx4 v58, s[32:35], 0 offen lds
  s_add_u32 m0, s76, 88064
  s_nop 0
  buffer_load_dwordx4 v59, s[32:35], 0 offen lds
  s_add_u32 m0, s76, 90112
  s_nop 0
  buffer_load_dwordx4 v60, s[32:35], 0 offen lds
  s_add_u32 m0, s76, 92160
  s_nop 0
  buffer_load_dwordx4 v61, s[32:35], 0 offen lds
  s_add_u32 m0, s76, 94208
  s_nop 0
  buffer_load_dwordx4 v62, s[32:35], 0 offen lds
  s_add_u32 m0, s76, 96256
  s_nop 0
  buffer_load_dwordx4 v63, s[32:35], 0 offen lds
  s_waitcnt vmcnt(8)
  s_barrier
  s_add_u32 m0, s76, 98304
  s_nop 0
  buffer_load_dwordx4 v64, s[32:35], 0 offen lds
  s_add_u32 m0, s76, 100352
  s_nop 0
  buffer_load_dwordx4 v65, s[32:35], 0 offen lds
  v_add_u32_dpp v56, v19, v2 row_newbcast:0 row_mask:0xf bank_mask:0x3
  v_add_u32_dpp v57, v23, v2 row_newbcast:0 row_mask:0xf bank_mask:0x3
  v_add_u32_dpp v58, v27, v2 row_newbcast:0 row_mask:0xf bank_mask:0x3
  v_add_u32_dpp v59, v31, v2 row_newbcast:0 row_mask:0xf bank_mask:0x3
  v_add_u32_dpp v60, v35, v2 row_newbcast:0 row_mask:0xf bank_mask:0x3
  v_add_u32_dpp v61, v39, v2 row_newbcast:0 row_mask:0xf bank_mask:0x3
  v_add_u32_dpp v62, v43, v2 row_newbcast:0 row_mask:0xf bank_mask:0x3
  v_add_u32_dpp v63, v47, v2 row_newbcast:0 row_mask:0xf bank_mask:0x3
  v_add_u32_dpp v64, v51, v2 row_newbcast:0 row_mask:0xf bank_mask:0x3
  v_add_u32_dpp v65, v55, v2 row_newbcast:0 row_mask:0xf bank_mask:0x3
  v_add_u32_dpp v56, v17, v2 row_newbcast:7 row_mask:0xf bank_mask:0xc
  v_add_u32_dpp v57, v21, v2 row_newbcast:7 row_mask:0xf bank_mask:0xc
  v_add_u32_dpp v58, v25, v2 row_newbcast:7 row_mask:0xf bank_mask:0xc
  v_add_u32_dpp v59, v29, v2 row_newbcast:7 row_mask:0xf bank_mask:0xc
  v_add_u32_dpp v60, v33, v2 row_newbcast:7 row_mask:0xf bank_mask:0xc
  v_add_u32_dpp v61, v37, v2 row_newbcast:7 row_mask:0xf bank_mask:0xc
  v_add_u32_dpp v62, v41, v2 row_newbcast:7 row_mask:0xf bank_mask:0xc
  v_add_u32_dpp v63, v45, v2 row_newbcast:7 row_mask:0xf bank_mask:0xc
  v_add_u32_dpp v64, v49, v2 row_newbcast:7 row_mask:0xf bank_mask:0xc
  v_add_u32_dpp v65, v53, v2 row_newbcast:7 row_mask:0xf bank_mask:0xc
  s_setprio 0
  s_branch L_ld_in
L_cmp:
  s_mul_i32 s70, s3, 13
  v_min_u32 v118, 12, v0
  v_add_u32 v118, s70, v118
  v_lshrrev_b32 v117, 1, v118
  v_mul_u32_u24 v117, 96, v117
  v_lshl_add_u32 v118, v118, 2, v117
  s_mul_i32 s78, s27, 25
  s_min_u32 s78, s78, 294
  s_add_u32 s78, s78, s71
  s_mul_i32 s78, s78, 104
  s_waitcnt lgkmcnt(0)
  s_mov_b32 s28, s4
  s_and_b32 s29, s5, 0xffff
  s_mov_b32 s30, 425984
  s_mov_b32 s31, 0x20000
  s_mov_b32 s32, s6
  s_and_b32 s33, s7, 0xffff
  s_mov_b32 s34, 12800000
  s_mov_b32 s35, 0x20000
  s_mov_b32 s48, s14
  s_and_b32 s49, s15, 0xffff
  s_mov_b32 s50, 3328
  s_mov_b32 s51, 0x20000
  s_mov_b32 m0, 122880
  s_mov_b64 exec, 0xffff
  buffer_load_dwordx4 v11, s[48:51], s77 offen lds
  s_mov_b64 exec, -1
  s_and_b32 s68, s3, 1
  s_lshr_b32 s69, s3, 1
  v_bfe_u32 v117, v0, 2, 2
  v_lshl_add_u32 v118, v116, 3, v117
  v_lshlrev_b32 v118, 8, v118
  v_bfe_u32 v117, v0, 2, 3
  s_lshl_b32 s70, s69, 2
  v_xor_b32 v117, s70, v117
  v_lshl_add_u32 v118, v117, 5, v118
  v_and_b32 v117, 3, v0
  v_lshl_add_u32 v118, v117, 3, v118
  v_add_u32 v1, 131072, v118
  v_xor_b32 v2, 32, v1
  v_xor_b32 v3, 64, v1
  v_xor_b32 v4, 96, v1
  s_lshl_b32 s70, s69, 7
  s_add_u32 s70, s70, 122880
  v_lshlrev_b32 v118, 3, v116
  v_add_u32 v9, s70, v118
  v_and_b32 v118, 15, v0
  v_lshlrev_b32 v118, 7, v118
  v_bfe_u32 v117, v0, 1, 3
  v_xor_b32 v117, v117, v116
  v_lshl_add_u32 v118, v117, 4, v118
  s_mul_i32 s70, s68, 20480
  v_add_u32 v5, s70, v118
  v_xor_b32_e64 v7, 64, v5
  v_add_u32 v6, 81920, v5
  v_add_u32 v8, 81920, v7
  s_mul_i32 s70, s3, 640
  s_add_u32 s70, s70, 123392
  v_and_b32 v118, 15, v0
  v_lshlrev_b32 v118, 2, v118
  v_add_u32 v118, s70, v118
  v_lshrrev_b32_e64 v117, 5, v0
  v_lshl_add_u32 v118, v117, 6, v118
  v_bfe_u32 v117, v0, 4, 1
  v_lshl_add_u32 v10, v117, 7, v118
  s_mov_b32 s72, 0
  v_mov_b32 v12, 0xc0135761
  v_mov_b32 v13, 0xc0135761
  v_mov_b32 v14, 0xbdd2d3e8
  v_mov_b32 v15, 0xbdd2d3e8
  s_barrier
  ds_read_b64_tr_b16 v[16:17], v1 offset:0
  ds_read_b64_tr_b16 v[18:19], v1 offset:1024
  ds_read_b64_tr_b16 v[32:33], v1 offset:8192
  ds_read_b64_tr_b16 v[34:35], v1 offset:9216
  ds_read_b64_tr_b16 v[20:21], v2 offset:0
  ds_read_b64_tr_b16 v[22:23], v2 offset:1024
  ds_read_b64_tr_b16 v[36:37], v2 offset:8192
  ds_read_b64_tr_b16 v[38:39], v2 offset:9216
  ds_read_b64_tr_b16 v[24:25], v3 offset:0
  ds_read_b64_tr_b16 v[26:27], v3 offset:1024
  ds_read_b64_tr_b16 v[40:41], v3 offset:8192
  ds_read_b64_tr_b16 v[42:43], v3 offset:9216
  ds_read_b64_tr_b16 v[28:29], v4 offset:0
  ds_read_b64_tr_b16 v[30:31], v4 offset:1024
  ds_read_b64_tr_b16 v[44:45], v4 offset:8192
  ds_read_b64_tr_b16 v[46:47], v4 offset:9216
  s_waitcnt vmcnt(0)
  ds_read_b64 v[234:235], v9 offset:0
  ds_read_b64 v[238:239], v9 offset:32
  ds_read_b64 v[242:243], v9 offset:64
  ds_read_b64 v[246:247], v9 offset:96
  s_waitcnt lgkmcnt(3)
  v_lshlrev_b32 v232, 16, v234
  v_and_b32 v233, 0xffff0000, v234
  v_lshlrev_b32 v234, 16, v235
  v_and_b32 v235, 0xffff0000, v235
  s_waitcnt lgkmcnt(2)
  v_lshlrev_b32 v236, 16, v238
  v_and_b32 v237, 0xffff0000, v238
  v_lshlrev_b32 v238, 16, v239
  v_and_b32 v239, 0xffff0000, v239
  s_waitcnt lgkmcnt(1)
  v_lshlrev_b32 v240, 16, v242
  v_and_b32 v241, 0xffff0000, v242
  v_lshlrev_b32 v242, 16, v243
  v_and_b32 v243, 0xffff0000, v243
  s_waitcnt lgkmcnt(0)
  v_lshlrev_b32 v244, 16, v246
  v_and_b32 v245, 0xffff0000, v246
  v_lshlrev_b32 v246, 16, v247
  v_and_b32 v247, 0xffff0000, v247
  v_mov_b64 v[216:217], v[232:233]
  v_mov_b64 v[218:219], v[234:235]
  v_mov_b64 v[220:221], v[236:237]
  v_mov_b64 v[222:223], v[238:239]
  v_mov_b64 v[224:225], v[240:241]
  v_mov_b64 v[226:227], v[242:243]
  v_mov_b64 v[228:229], v[244:245]
  v_mov_b64 v[230:231], v[246:247]
  s_waitcnt lgkmcnt(0)
  s_setprio 1
  s_barrier
  ds_read_b128 v[48:51], v5 offset:0
  ds_read_b128 v[52:55], v7 offset:0
  ds_read_b128 v[56:59], v5 offset:2048
  ds_read_b128 v[60:63], v7 offset:2048
  ds_read_b128 v[64:67], v5 offset:4096
  ds_read_b128 v[68:71], v7 offset:4096
  ds_read_b128 v[72:75], v5 offset:6144
  ds_read_b128 v[76:79], v7 offset:6144
  s_waitcnt lgkmcnt(7)
  v_mfma_f32_16x16x32_bf16 v[88:91], v[16:19], v[48:51], v[232:235]
  s_waitcnt lgkmcnt(4)
  v_mfma_f32_16x16x32_bf16 v[88:91], v[32:35], v[52:55], v[88:91]
  v_mfma_f32_16x16x32_bf16 v[104:107], v[32:35], v[60:63], v[232:235]
  s_nop 0
  v_mfma_f32_16x16x32_bf16 v[104:107], v[16:19], v[56:59], v[104:107]
  v_mfma_f32_16x16x32_bf16 v[108:111], v[20:23], v[56:59], v[236:239]
  v_mfma_f32_16x16x32_bf16 v[108:111], v[36:39], v[60:63], v[108:111]
  v_mfma_f32_16x16x32_bf16 v[92:95], v[36:39], v[52:55], v[236:239]
  v_mfma_f32_16x16x32_bf16 v[92:95], v[20:23], v[48:51], v[92:95]
  v_mfma_f32_16x16x32_bf16 v[96:99], v[24:27], v[48:51], v[240:243]
  v_xor_b32 v1, 16384, v1
  v_mfma_f32_16x16x32_bf16 v[96:99], v[40:43], v[52:55], v[96:99]
  v_xor_b32 v2, 16384, v2
  v_mfma_f32_16x16x32_bf16 v[112:115], v[40:43], v[60:63], v[240:243]
  v_xor_b32 v3, 16384, v3
  v_mfma_f32_16x16x32_bf16 v[112:115], v[24:27], v[56:59], v[112:115]
  v_xor_b32 v4, 16384, v4
  v_mfma_f32_16x16x32_bf16 v[116:119], v[28:31], v[56:59], v[244:247]
  v_mfma_f32_16x16x32_bf16 v[116:119], v[44:47], v[60:63], v[116:119]
  v_mfma_f32_16x16x32_bf16 v[100:103], v[44:47], v[52:55], v[244:247]
  s_waitcnt lgkmcnt(2)
  v_mfma_f32_16x16x32_bf16 v[100:103], v[28:31], v[48:51], v[100:103]
  v_mfma_f32_16x16x32_bf16 v[120:123], v[16:19], v[64:67], v[232:235]
  s_barrier
  s_waitcnt lgkmcnt(0)
  v_mfma_f32_16x16x32_bf16 v[120:123], v[32:35], v[68:71], v[120:123]
  ds_read_b128 v[80:83], v5 offset:8192
  v_mfma_f32_16x16x32_bf16 v[136:139], v[32:35], v[76:79], v[232:235]
  s_nop 0
  ds_read_b128 v[84:87], v7 offset:8192
  v_mfma_f32_16x16x32_bf16 v[136:139], v[16:19], v[72:75], v[136:139]
  ds_read_b128 v[48:51], v5 offset:10240
  v_mfma_f32_16x16x32_bf16 v[140:143], v[20:23], v[72:75], v[236:239]
  ds_read_b128 v[52:55], v7 offset:10240
  v_mfma_f32_16x16x32_bf16 v[140:143], v[36:39], v[76:79], v[140:143]
  ds_read_b128 v[56:59], v5 offset:12288
  v_mfma_f32_16x16x32_bf16 v[124:127], v[36:39], v[68:71], v[236:239]
  ds_read_b128 v[60:63], v7 offset:12288
  v_mfma_f32_16x16x32_bf16 v[124:127], v[20:23], v[64:67], v[124:127]
  v_mfma_f32_16x16x32_bf16 v[128:131], v[24:27], v[64:67], v[240:243]
  v_mfma_f32_16x16x32_bf16 v[128:131], v[40:43], v[68:71], v[128:131]
  v_mfma_f32_16x16x32_bf16 v[144:147], v[40:43], v[76:79], v[240:243]
  v_mfma_f32_16x16x32_bf16 v[144:147], v[24:27], v[72:75], v[144:147]
  v_mfma_f32_16x16x32_bf16 v[148:151], v[28:31], v[72:75], v[244:247]
  ds_read_b128 v[72:75], v5 offset:16384
  v_mfma_f32_16x16x32_bf16 v[148:151], v[44:47], v[76:79], v[148:151]
  ds_read_b128 v[76:79], v7 offset:16384
  v_mfma_f32_16x16x32_bf16 v[132:135], v[44:47], v[68:71], v[244:247]
  ds_read_b128 v[68:71], v7 offset:14336
  s_waitcnt lgkmcnt(7)
  v_mfma_f32_16x16x32_bf16 v[132:135], v[28:31], v[64:67], v[132:135]
  ds_read_b128 v[64:67], v5 offset:14336
  v_mfma_f32_16x16x32_bf16 v[152:155], v[16:19], v[80:83], v[232:235]
  s_waitcnt lgkmcnt(6)
  v_mfma_f32_16x16x32_bf16 v[152:155], v[32:35], v[84:87], v[152:155]
  v_mfma_f32_16x16x32_bf16 v[168:171], v[32:35], v[52:55], v[232:235]
  v_mfma_f32_16x16x32_bf16 v[168:171], v[16:19], v[48:51], v[168:171]
  v_mfma_f32_16x16x32_bf16 v[172:175], v[20:23], v[48:51], v[236:239]
  v_mfma_f32_16x16x32_bf16 v[172:175], v[36:39], v[52:55], v[172:175]
  v_mfma_f32_16x16x32_bf16 v[156:159], v[36:39], v[84:87], v[236:239]
  v_mfma_f32_16x16x32_bf16 v[156:159], v[20:23], v[80:83], v[156:159]
  v_mfma_f32_16x16x32_bf16 v[160:163], v[24:27], v[80:83], v[240:243]
  v_mfma_f32_16x16x32_bf16 v[160:163], v[40:43], v[84:87], v[160:163]
  v_mfma_f32_16x16x32_bf16 v[176:179], v[40:43], v[52:55], v[240:243]
  v_mfma_f32_16x16x32_bf16 v[176:179], v[24:27], v[48:51], v[176:179]
  v_mfma_f32_16x16x32_bf16 v[180:183], v[28:31], v[48:51], v[244:247]
  v_mfma_f32_16x16x32_bf16 v[180:183], v[44:47], v[52:55], v[180:183]
  v_mfma_f32_16x16x32_bf16 v[164:167], v[44:47], v[84:87], v[244:247]
  ds_read_b128 v[84:87], v7 offset:18432
  s_waitcnt lgkmcnt(5)
  v_mfma_f32_16x16x32_bf16 v[164:167], v[28:31], v[80:83], v[164:167]
  s_nop 0
  ds_read_b128 v[80:83], v5 offset:18432
  v_mfma_f32_16x16x32_bf16 v[184:187], v[16:19], v[56:59], v[232:235]
  s_waitcnt lgkmcnt(2)
  v_mfma_f32_16x16x32_bf16 v[184:187], v[32:35], v[60:63], v[184:187]
  v_mfma_f32_16x16x32_bf16 v[200:203], v[32:35], v[68:71], v[232:235]
  v_mfma_f32_16x16x32_bf16 v[200:203], v[16:19], v[64:67], v[200:203]
  v_mfma_f32_16x16x32_bf16 v[204:207], v[20:23], v[64:67], v[236:239]
  v_mfma_f32_16x16x32_bf16 v[204:207], v[36:39], v[68:71], v[204:207]
  s_waitcnt lgkmcnt(0)
  s_barrier
  v_mfma_f32_16x16x32_bf16 v[188:191], v[36:39], v[60:63], v[236:239]
  ds_read_b128 v[48:51], v5 offset:40960
  v_mfma_f32_16x16x32_bf16 v[188:191], v[20:23], v[56:59], v[188:191]
  ds_read_b128 v[52:55], v7 offset:40960
  v_mfma_f32_16x16x32_bf16 v[192:195], v[24:27], v[56:59], v[240:243]
  v_mfma_f32_16x16x32_bf16 v[192:195], v[40:43], v[60:63], v[192:195]
  v_mfma_f32_16x16x32_bf16 v[208:211], v[40:43], v[68:71], v[240:243]
  s_nop 0
  v_mfma_f32_16x16x32_bf16 v[208:211], v[24:27], v[64:67], v[208:211]
  v_mfma_f32_16x16x32_bf16 v[212:215], v[28:31], v[64:67], v[244:247]
  ds_read_b128 v[64:67], v5 offset:45056
  v_mfma_f32_16x16x32_bf16 v[212:215], v[44:47], v[68:71], v[212:215]
  ds_read_b128 v[68:71], v7 offset:45056
  v_mfma_f32_16x16x32_bf16 v[196:199], v[44:47], v[60:63], v[244:247]
  ds_read_b128 v[60:63], v7 offset:43008
  v_mfma_f32_16x16x32_bf16 v[196:199], v[28:31], v[56:59], v[196:199]
  ds_read_b128 v[56:59], v5 offset:43008
  v_mfma_f32_16x16x32_bf16 v[216:219], v[32:35], v[76:79], v[216:219]
  v_mfma_f32_16x16x32_bf16 v[216:219], v[16:19], v[72:75], v[216:219]
  v_mfma_f32_16x16x32_bf16 v[232:235], v[16:19], v[80:83], v[232:235]
  ds_read_b64_tr_b16 v[16:17], v1 offset:0
  v_mfma_f32_16x16x32_bf16 v[232:235], v[32:35], v[84:87], v[232:235]
  ds_read_b64_tr_b16 v[18:19], v1 offset:1024
  v_mfma_f32_16x16x32_bf16 v[236:239], v[36:39], v[84:87], v[236:239]
  ds_read_b64_tr_b16 v[32:33], v1 offset:8192
  v_mfma_f32_16x16x32_bf16 v[236:239], v[20:23], v[80:83], v[236:239]
  ds_read_b64_tr_b16 v[34:35], v1 offset:9216
  v_mfma_f32_16x16x32_bf16 v[220:223], v[20:23], v[72:75], v[220:223]
  ds_read_b64_tr_b16 v[20:21], v2 offset:0
  v_mfma_f32_16x16x32_bf16 v[220:223], v[36:39], v[76:79], v[220:223]
  ds_read_b64_tr_b16 v[22:23], v2 offset:1024
  v_mfma_f32_16x16x32_bf16 v[224:227], v[40:43], v[76:79], v[224:227]
  ds_read_b64_tr_b16 v[36:37], v2 offset:8192
  v_mfma_f32_16x16x32_bf16 v[224:227], v[24:27], v[72:75], v[224:227]
  ds_read_b64_tr_b16 v[38:39], v2 offset:9216
  v_mfma_f32_16x16x32_bf16 v[240:243], v[24:27], v[80:83], v[240:243]
  ds_read_b64_tr_b16 v[24:25], v3 offset:0
  v_mfma_f32_16x16x32_bf16 v[240:243], v[40:43], v[84:87], v[240:243]
  ds_read_b64_tr_b16 v[26:27], v3 offset:1024
  v_mfma_f32_16x16x32_bf16 v[244:247], v[44:47], v[84:87], v[244:247]
  ds_read_b64_tr_b16 v[40:41], v3 offset:8192
  v_mfma_f32_16x16x32_bf16 v[244:247], v[28:31], v[80:83], v[244:247]
  s_nop 0
  ds_read_b64_tr_b16 v[42:43], v3 offset:9216
  v_mfma_f32_16x16x32_bf16 v[228:231], v[28:31], v[72:75], v[228:231]
  ds_read_b64_tr_b16 v[28:29], v4 offset:0
  s_waitcnt lgkmcnt(9)
  v_mfma_f32_16x16x32_bf16 v[228:231], v[44:47], v[76:79], v[228:231]
  ds_read_b64_tr_b16 v[30:31], v4 offset:1024
L_dnn_loop0:
  v_mfma_f32_16x16x32_bf16 v[88:91], v[16:19], v[48:51], v[88:91]
  ds_read_b64_tr_b16 v[44:45], v4 offset:8192
  v_mfma_f32_16x16x32_bf16 v[88:91], v[32:35], v[52:55], v[88:91]
  ds_read_b64_tr_b16 v[46:47], v4 offset:9216
  v_mfma_f32_16x16x32_bf16 v[104:107], v[32:35], v[60:63], v[104:107]
  ds_read_b128 v[72:75], v5 offset:47104
  s_waitcnt lgkmcnt(9)
  v_mfma_f32_16x16x32_bf16 v[104:107], v[16:19], v[56:59], v[104:107]
  s_nop 0
  ds_read_b128 v[76:79], v7 offset:47104
  v_mfma_f32_16x16x32_bf16 v[108:111], v[20:23], v[56:59], v[108:111]
  ds_read_b128 v[80:83], v5 offset:49152
  v_mfma_f32_16x16x32_bf16 v[108:111], v[36:39], v[60:63], v[108:111]
  ds_read_b128 v[84:87], v7 offset:49152
  v_mfma_f32_16x16x32_bf16 v[92:95], v[36:39], v[52:55], v[92:95]
  s_waitcnt lgkmcnt(8)
  v_mfma_f32_16x16x32_bf16 v[92:95], v[20:23], v[48:51], v[92:95]
  s_nop 0
  v_mfma_f32_16x16x32_bf16 v[96:99], v[24:27], v[48:51], v[96:99]
  v_xor_b32 v1, 16384, v1
  v_mfma_f32_16x16x32_bf16 v[96:99], v[40:43], v[52:55], v[96:99]
  v_xor_b32 v2, 16384, v2
  v_mfma_f32_16x16x32_bf16 v[112:115], v[40:43], v[60:63], v[112:115]
  v_xor_b32 v3, 16384, v3
  s_waitcnt lgkmcnt(4)
  v_mfma_f32_16x16x32_bf16 v[112:115], v[24:27], v[56:59], v[112:115]
  s_nop 0
  v_xor_b32 v4, 16384, v4
  v_mfma_f32_16x16x32_bf16 v[116:119], v[28:31], v[56:59], v[116:119]
  ds_read_b128 v[56:59], v5 offset:53248
  v_mfma_f32_16x16x32_bf16 v[116:119], v[44:47], v[60:63], v[116:119]
  ds_read_b128 v[60:63], v7 offset:53248
  v_mfma_f32_16x16x32_bf16 v[100:103], v[44:47], v[52:55], v[100:103]
  ds_read_b128 v[52:55], v7 offset:51200
  v_mfma_f32_16x16x32_bf16 v[100:103], v[28:31], v[48:51], v[100:103]
  ds_read_b128 v[48:51], v5 offset:51200
  v_mfma_f32_16x16x32_bf16 v[120:123], v[16:19], v[64:67], v[120:123]
  s_waitcnt lgkmcnt(6)
  v_mfma_f32_16x16x32_bf16 v[120:123], v[32:35], v[68:71], v[120:123]
  v_mfma_f32_16x16x32_bf16 v[136:139], v[32:35], v[76:79], v[136:139]
  v_mfma_f32_16x16x32_bf16 v[136:139], v[16:19], v[72:75], v[136:139]
  v_mfma_f32_16x16x32_bf16 v[140:143], v[20:23], v[72:75], v[140:143]
  v_mfma_f32_16x16x32_bf16 v[140:143], v[36:39], v[76:79], v[140:143]
  s_nop 0
  v_mfma_f32_16x16x32_bf16 v[124:127], v[36:39], v[68:71], v[124:127]
  v_mfma_f32_16x16x32_bf16 v[124:127], v[20:23], v[64:67], v[124:127]
  v_mfma_f32_16x16x32_bf16 v[128:131], v[24:27], v[64:67], v[128:131]
  v_mfma_f32_16x16x32_bf16 v[128:131], v[40:43], v[68:71], v[128:131]
  v_mfma_f32_16x16x32_bf16 v[144:147], v[40:43], v[76:79], v[144:147]
  v_mfma_f32_16x16x32_bf16 v[144:147], v[24:27], v[72:75], v[144:147]
  v_mfma_f32_16x16x32_bf16 v[148:151], v[28:31], v[72:75], v[148:151]
  ds_read_b128 v[72:75], v5 offset:57344
  v_mfma_f32_16x16x32_bf16 v[148:151], v[44:47], v[76:79], v[148:151]
  ds_read_b128 v[76:79], v7 offset:57344
  v_mfma_f32_16x16x32_bf16 v[132:135], v[44:47], v[68:71], v[132:135]
  ds_read_b128 v[68:71], v7 offset:55296
  s_waitcnt lgkmcnt(7)
  v_mfma_f32_16x16x32_bf16 v[132:135], v[28:31], v[64:67], v[132:135]
  ds_read_b128 v[64:67], v5 offset:55296
  v_mfma_f32_16x16x32_bf16 v[152:155], v[16:19], v[80:83], v[152:155]
  s_waitcnt lgkmcnt(4)
  v_mfma_f32_16x16x32_bf16 v[152:155], v[32:35], v[84:87], v[152:155]
  v_mfma_f32_16x16x32_bf16 v[168:171], v[32:35], v[52:55], v[168:171]
  v_mfma_f32_16x16x32_bf16 v[168:171], v[16:19], v[48:51], v[168:171]
  v_mfma_f32_16x16x32_bf16 v[172:175], v[20:23], v[48:51], v[172:175]
  v_mfma_f32_16x16x32_bf16 v[172:175], v[36:39], v[52:55], v[172:175]
  v_mfma_f32_16x16x32_bf16 v[156:159], v[36:39], v[84:87], v[156:159]
  v_mfma_f32_16x16x32_bf16 v[156:159], v[20:23], v[80:83], v[156:159]
  v_mfma_f32_16x16x32_bf16 v[160:163], v[24:27], v[80:83], v[160:163]
  v_mfma_f32_16x16x32_bf16 v[160:163], v[40:43], v[84:87], v[160:163]
  v_mfma_f32_16x16x32_bf16 v[176:179], v[40:43], v[52:55], v[176:179]
  v_mfma_f32_16x16x32_bf16 v[176:179], v[24:27], v[48:51], v[176:179]
  v_mfma_f32_16x16x32_bf16 v[180:183], v[28:31], v[48:51], v[180:183]
  v_mfma_f32_16x16x32_bf16 v[180:183], v[44:47], v[52:55], v[180:183]
  v_mfma_f32_16x16x32_bf16 v[164:167], v[44:47], v[84:87], v[164:167]
  ds_read_b128 v[84:87], v7 offset:59392
  v_mfma_f32_16x16x32_bf16 v[164:167], v[28:31], v[80:83], v[164:167]
  ds_read_b128 v[80:83], v5 offset:59392
  v_mfma_f32_16x16x32_bf16 v[184:187], v[16:19], v[56:59], v[184:187]
  s_waitcnt lgkmcnt(2)
  v_mfma_f32_16x16x32_bf16 v[184:187], v[32:35], v[60:63], v[184:187]
  v_mfma_f32_16x16x32_bf16 v[200:203], v[32:35], v[68:71], v[200:203]
  v_mfma_f32_16x16x32_bf16 v[200:203], v[16:19], v[64:67], v[200:203]
  v_mfma_f32_16x16x32_bf16 v[204:207], v[20:23], v[64:67], v[204:207]
  v_mfma_f32_16x16x32_bf16 v[204:207], v[36:39], v[68:71], v[204:207]
  s_waitcnt lgkmcnt(0)
  s_barrier
  v_mfma_f32_16x16x32_bf16 v[188:191], v[36:39], v[60:63], v[188:191]
  ds_read_b128 v[48:51], v6 offset:0
  v_mfma_f32_16x16x32_bf16 v[188:191], v[20:23], v[56:59], v[188:191]
  ds_read_b128 v[52:55], v8 offset:0
  v_mfma_f32_16x16x32_bf16 v[192:195], v[24:27], v[56:59], v[192:195]
  v_mfma_f32_16x16x32_bf16 v[192:195], v[40:43], v[60:63], v[192:195]
  v_mfma_f32_16x16x32_bf16 v[208:211], v[40:43], v[68:71], v[208:211]
  s_nop 0
  v_mfma_f32_16x16x32_bf16 v[208:211], v[24:27], v[64:67], v[208:211]
  v_mfma_f32_16x16x32_bf16 v[212:215], v[28:31], v[64:67], v[212:215]
  ds_read_b128 v[64:67], v6 offset:4096
  v_mfma_f32_16x16x32_bf16 v[212:215], v[44:47], v[68:71], v[212:215]
  ds_read_b128 v[68:71], v8 offset:4096
  v_mfma_f32_16x16x32_bf16 v[196:199], v[44:47], v[60:63], v[196:199]
  ds_read_b128 v[60:63], v8 offset:2048
  v_mfma_f32_16x16x32_bf16 v[196:199], v[28:31], v[56:59], v[196:199]
  ds_read_b128 v[56:59], v6 offset:2048
  v_mfma_f32_16x16x32_bf16 v[216:219], v[32:35], v[76:79], v[216:219]
  v_mfma_f32_16x16x32_bf16 v[216:219], v[16:19], v[72:75], v[216:219]
  v_mfma_f32_16x16x32_bf16 v[232:235], v[16:19], v[80:83], v[232:235]
  ds_read_b64_tr_b16 v[16:17], v1 offset:0
  v_mfma_f32_16x16x32_bf16 v[232:235], v[32:35], v[84:87], v[232:235]
  ds_read_b64_tr_b16 v[18:19], v1 offset:1024
  v_mfma_f32_16x16x32_bf16 v[236:239], v[36:39], v[84:87], v[236:239]
  ds_read_b64_tr_b16 v[32:33], v1 offset:8192
  v_mfma_f32_16x16x32_bf16 v[236:239], v[20:23], v[80:83], v[236:239]
  ds_read_b64_tr_b16 v[34:35], v1 offset:9216
  v_mfma_f32_16x16x32_bf16 v[220:223], v[20:23], v[72:75], v[220:223]
  ds_read_b64_tr_b16 v[20:21], v2 offset:0
  v_mfma_f32_16x16x32_bf16 v[220:223], v[36:39], v[76:79], v[220:223]
  ds_read_b64_tr_b16 v[22:23], v2 offset:1024
  v_mfma_f32_16x16x32_bf16 v[224:227], v[40:43], v[76:79], v[224:227]
  ds_read_b64_tr_b16 v[36:37], v2 offset:8192
  v_mfma_f32_16x16x32_bf16 v[224:227], v[24:27], v[72:75], v[224:227]
  ds_read_b64_tr_b16 v[38:39], v2 offset:9216
  v_mfma_f32_16x16x32_bf16 v[240:243], v[24:27], v[80:83], v[240:243]
  ds_read_b64_tr_b16 v[24:25], v3 offset:0
  v_mfma_f32_16x16x32_bf16 v[240:243], v[40:43], v[84:87], v[240:243]
  ds_read_b64_tr_b16 v[26:27], v3 offset:1024
  v_mfma_f32_16x16x32_bf16 v[244:247], v[44:47], v[84:87], v[244:247]
  ds_read_b64_tr_b16 v[40:41], v3 offset:8192
  v_mfma_f32_16x16x32_bf16 v[244:247], v[28:31], v[80:83], v[244:247]
  ds_read_b64_tr_b16 v[42:43], v3 offset:9216
  v_mfma_f32_16x16x32_bf16 v[228:231], v[28:31], v[72:75], v[228:231]
  ds_read_b64_tr_b16 v[28:29], v4 offset:0
  s_waitcnt lgkmcnt(9)
  v_mfma_f32_16x16x32_bf16 v[228:231], v[44:47], v[76:79], v[228:231]
  s_nop 0
  ds_read_b64_tr_b16 v[30:31], v4 offset:1024
  v_mfma_f32_16x16x32_bf16 v[88:91], v[16:19], v[48:51], v[88:91]
  ds_read_b64_tr_b16 v[44:45], v4 offset:8192
  v_mfma_f32_16x16x32_bf16 v[88:91], v[32:35], v[52:55], v[88:91]
  ds_read_b64_tr_b16 v[46:47], v4 offset:9216
  v_mfma_f32_16x16x32_bf16 v[104:107], v[32:35], v[60:63], v[104:107]
  ds_read_b128 v[72:75], v6 offset:6144
  s_waitcnt lgkmcnt(9)
  v_mfma_f32_16x16x32_bf16 v[104:107], v[16:19], v[56:59], v[104:107]
  s_nop 0
  ds_read_b128 v[76:79], v8 offset:6144
  v_mfma_f32_16x16x32_bf16 v[108:111], v[20:23], v[56:59], v[108:111]
  ds_read_b128 v[80:83], v6 offset:8192
  v_mfma_f32_16x16x32_bf16 v[108:111], v[36:39], v[60:63], v[108:111]
  ds_read_b128 v[84:87], v8 offset:8192
  v_mfma_f32_16x16x32_bf16 v[92:95], v[36:39], v[52:55], v[92:95]
  s_waitcnt lgkmcnt(8)
  v_mfma_f32_16x16x32_bf16 v[92:95], v[20:23], v[48:51], v[92:95]
  s_nop 0
  v_mfma_f32_16x16x32_bf16 v[96:99], v[24:27], v[48:51], v[96:99]
  v_xor_b32 v1, 16384, v1
  v_mfma_f32_16x16x32_bf16 v[96:99], v[40:43], v[52:55], v[96:99]
  v_xor_b32 v2, 16384, v2
  v_mfma_f32_16x16x32_bf16 v[112:115], v[40:43], v[60:63], v[112:115]
  v_xor_b32 v3, 16384, v3
  s_waitcnt lgkmcnt(4)
  v_mfma_f32_16x16x32_bf16 v[112:115], v[24:27], v[56:59], v[112:115]
  s_nop 0
  v_xor_b32 v4, 16384, v4
  v_mfma_f32_16x16x32_bf16 v[116:119], v[28:31], v[56:59], v[116:119]
  ds_read_b128 v[56:59], v6 offset:12288
  v_mfma_f32_16x16x32_bf16 v[116:119], v[44:47], v[60:63], v[116:119]
  ds_read_b128 v[60:63], v8 offset:12288
  v_mfma_f32_16x16x32_bf16 v[100:103], v[44:47], v[52:55], v[100:103]
  ds_read_b128 v[52:55], v8 offset:10240
  v_mfma_f32_16x16x32_bf16 v[100:103], v[28:31], v[48:51], v[100:103]
  ds_read_b128 v[48:51], v6 offset:10240
  v_mfma_f32_16x16x32_bf16 v[120:123], v[16:19], v[64:67], v[120:123]
  s_waitcnt lgkmcnt(6)
  v_mfma_f32_16x16x32_bf16 v[120:123], v[32:35], v[68:71], v[120:123]
  v_mfma_f32_16x16x32_bf16 v[136:139], v[32:35], v[76:79], v[136:139]
  v_mfma_f32_16x16x32_bf16 v[136:139], v[16:19], v[72:75], v[136:139]
  v_mfma_f32_16x16x32_bf16 v[140:143], v[20:23], v[72:75], v[140:143]
  v_mfma_f32_16x16x32_bf16 v[140:143], v[36:39], v[76:79], v[140:143]
  s_nop 0
  v_mfma_f32_16x16x32_bf16 v[124:127], v[36:39], v[68:71], v[124:127]
  v_mfma_f32_16x16x32_bf16 v[124:127], v[20:23], v[64:67], v[124:127]
  v_mfma_f32_16x16x32_bf16 v[128:131], v[24:27], v[64:67], v[128:131]
  v_mfma_f32_16x16x32_bf16 v[128:131], v[40:43], v[68:71], v[128:131]
  v_mfma_f32_16x16x32_bf16 v[144:147], v[40:43], v[76:79], v[144:147]
  v_mfma_f32_16x16x32_bf16 v[144:147], v[24:27], v[72:75], v[144:147]
  v_mfma_f32_16x16x32_bf16 v[148:151], v[28:31], v[72:75], v[148:151]
  ds_read_b128 v[72:75], v6 offset:16384
  v_mfma_f32_16x16x32_bf16 v[148:151], v[44:47], v[76:79], v[148:151]
  ds_read_b128 v[76:79], v8 offset:16384
  v_mfma_f32_16x16x32_bf16 v[132:135], v[44:47], v[68:71], v[132:135]
  ds_read_b128 v[68:71], v8 offset:14336
  s_waitcnt lgkmcnt(7)
  v_mfma_f32_16x16x32_bf16 v[132:135], v[28:31], v[64:67], v[132:135]
  ds_read_b128 v[64:67], v6 offset:14336
  v_mfma_f32_16x16x32_bf16 v[152:155], v[16:19], v[80:83], v[152:155]
  s_waitcnt lgkmcnt(4)
  v_mfma_f32_16x16x32_bf16 v[152:155], v[32:35], v[84:87], v[152:155]
  v_mfma_f32_16x16x32_bf16 v[168:171], v[32:35], v[52:55], v[168:171]
  v_mfma_f32_16x16x32_bf16 v[168:171], v[16:19], v[48:51], v[168:171]
  v_mfma_f32_16x16x32_bf16 v[172:175], v[20:23], v[48:51], v[172:175]
  v_mfma_f32_16x16x32_bf16 v[172:175], v[36:39], v[52:55], v[172:175]
  v_mfma_f32_16x16x32_bf16 v[156:159], v[36:39], v[84:87], v[156:159]
  v_mfma_f32_16x16x32_bf16 v[156:159], v[20:23], v[80:83], v[156:159]
  v_mfma_f32_16x16x32_bf16 v[160:163], v[24:27], v[80:83], v[160:163]
  v_mfma_f32_16x16x32_bf16 v[160:163], v[40:43], v[84:87], v[160:163]
  v_mfma_f32_16x16x32_bf16 v[176:179], v[40:43], v[52:55], v[176:179]
  v_mfma_f32_16x16x32_bf16 v[176:179], v[24:27], v[48:51], v[176:179]
  v_mfma_f32_16x16x32_bf16 v[180:183], v[28:31], v[48:51], v[180:183]
  v_mfma_f32_16x16x32_bf16 v[180:183], v[44:47], v[52:55], v[180:183]
  v_mfma_f32_16x16x32_bf16 v[164:167], v[44:47], v[84:87], v[164:167]
  ds_read_b128 v[84:87], v8 offset:18432
  v_mfma_f32_16x16x32_bf16 v[164:167], v[28:31], v[80:83], v[164:167]
  ds_read_b128 v[80:83], v6 offset:18432
  v_mfma_f32_16x16x32_bf16 v[184:187], v[16:19], v[56:59], v[184:187]
  s_waitcnt lgkmcnt(2)
  v_mfma_f32_16x16x32_bf16 v[184:187], v[32:35], v[60:63], v[184:187]
  v_mfma_f32_16x16x32_bf16 v[200:203], v[32:35], v[68:71], v[200:203]
  v_mfma_f32_16x16x32_bf16 v[200:203], v[16:19], v[64:67], v[200:203]
  v_mfma_f32_16x16x32_bf16 v[204:207], v[20:23], v[64:67], v[204:207]
  v_mfma_f32_16x16x32_bf16 v[204:207], v[36:39], v[68:71], v[204:207]
  s_waitcnt lgkmcnt(0)
  s_barrier
  v_mfma_f32_16x16x32_bf16 v[188:191], v[36:39], v[60:63], v[188:191]
  ds_read_b128 v[48:51], v5 offset:0
  v_mfma_f32_16x16x32_bf16 v[188:191], v[20:23], v[56:59], v[188:191]
  ds_read_b128 v[52:55], v7 offset:0
  v_mfma_f32_16x16x32_bf16 v[192:195], v[24:27], v[56:59], v[192:195]
  v_mfma_f32_16x16x32_bf16 v[192:195], v[40:43], v[60:63], v[192:195]
  v_mfma_f32_16x16x32_bf16 v[208:211], v[40:43], v[68:71], v[208:211]
  s_nop 0
  v_mfma_f32_16x16x32_bf16 v[208:211], v[24:27], v[64:67], v[208:211]
  v_mfma_f32_16x16x32_bf16 v[212:215], v[28:31], v[64:67], v[212:215]
  ds_read_b128 v[64:67], v5 offset:4096
  v_mfma_f32_16x16x32_bf16 v[212:215], v[44:47], v[68:71], v[212:215]
  ds_read_b128 v[68:71], v7 offset:4096
  v_mfma_f32_16x16x32_bf16 v[196:199], v[44:47], v[60:63], v[196:199]
  ds_read_b128 v[60:63], v7 offset:2048
  v_mfma_f32_16x16x32_bf16 v[196:199], v[28:31], v[56:59], v[196:199]
  ds_read_b128 v[56:59], v5 offset:2048
  v_mfma_f32_16x16x32_bf16 v[216:219], v[32:35], v[76:79], v[216:219]
  v_mfma_f32_16x16x32_bf16 v[216:219], v[16:19], v[72:75], v[216:219]
  v_mfma_f32_16x16x32_bf16 v[232:235], v[16:19], v[80:83], v[232:235]
  ds_read_b64_tr_b16 v[16:17], v1 offset:0
  v_mfma_f32_16x16x32_bf16 v[232:235], v[32:35], v[84:87], v[232:235]
  ds_read_b64_tr_b16 v[18:19], v1 offset:1024
  v_mfma_f32_16x16x32_bf16 v[236:239], v[36:39], v[84:87], v[236:239]
  ds_read_b64_tr_b16 v[32:33], v1 offset:8192
  v_mfma_f32_16x16x32_bf16 v[236:239], v[20:23], v[80:83], v[236:239]
  ds_read_b64_tr_b16 v[34:35], v1 offset:9216
  v_mfma_f32_16x16x32_bf16 v[220:223], v[20:23], v[72:75], v[220:223]
  ds_read_b64_tr_b16 v[20:21], v2 offset:0
  v_mfma_f32_16x16x32_bf16 v[220:223], v[36:39], v[76:79], v[220:223]
  ds_read_b64_tr_b16 v[22:23], v2 offset:1024
  v_mfma_f32_16x16x32_bf16 v[224:227], v[40:43], v[76:79], v[224:227]
  ds_read_b64_tr_b16 v[36:37], v2 offset:8192
  v_mfma_f32_16x16x32_bf16 v[224:227], v[24:27], v[72:75], v[224:227]
  ds_read_b64_tr_b16 v[38:39], v2 offset:9216
  v_mfma_f32_16x16x32_bf16 v[240:243], v[24:27], v[80:83], v[240:243]
  ds_read_b64_tr_b16 v[24:25], v3 offset:0
  v_mfma_f32_16x16x32_bf16 v[240:243], v[40:43], v[84:87], v[240:243]
  ds_read_b64_tr_b16 v[26:27], v3 offset:1024
  v_mfma_f32_16x16x32_bf16 v[244:247], v[44:47], v[84:87], v[244:247]
  ds_read_b64_tr_b16 v[40:41], v3 offset:8192
  v_mfma_f32_16x16x32_bf16 v[244:247], v[28:31], v[80:83], v[244:247]
  ds_read_b64_tr_b16 v[42:43], v3 offset:9216
  v_mfma_f32_16x16x32_bf16 v[228:231], v[28:31], v[72:75], v[228:231]
  ds_read_b64_tr_b16 v[28:29], v4 offset:0
  s_waitcnt lgkmcnt(9)
  v_mfma_f32_16x16x32_bf16 v[228:231], v[44:47], v[76:79], v[228:231]
  s_nop 0
  ds_read_b64_tr_b16 v[30:31], v4 offset:1024
  v_mfma_f32_16x16x32_bf16 v[88:91], v[16:19], v[48:51], v[88:91]
  ds_read_b64_tr_b16 v[44:45], v4 offset:8192
  v_mfma_f32_16x16x32_bf16 v[88:91], v[32:35], v[52:55], v[88:91]
  ds_read_b64_tr_b16 v[46:47], v4 offset:9216
  v_mfma_f32_16x16x32_bf16 v[104:107], v[32:35], v[60:63], v[104:107]
  ds_read_b128 v[72:75], v5 offset:6144
  s_waitcnt lgkmcnt(9)
  v_mfma_f32_16x16x32_bf16 v[104:107], v[16:19], v[56:59], v[104:107]
  s_nop 0
  ds_read_b128 v[76:79], v7 offset:6144
  v_mfma_f32_16x16x32_bf16 v[108:111], v[20:23], v[56:59], v[108:111]
  ds_read_b128 v[80:83], v5 offset:8192
  v_mfma_f32_16x16x32_bf16 v[108:111], v[36:39], v[60:63], v[108:111]
  ds_read_b128 v[84:87], v7 offset:8192
  v_mfma_f32_16x16x32_bf16 v[92:95], v[36:39], v[52:55], v[92:95]
  s_waitcnt lgkmcnt(8)
  v_mfma_f32_16x16x32_bf16 v[92:95], v[20:23], v[48:51], v[92:95]
  s_nop 0
  v_mfma_f32_16x16x32_bf16 v[96:99], v[24:27], v[48:51], v[96:99]
  v_xor_b32 v1, 16384, v1
  v_mfma_f32_16x16x32_bf16 v[96:99], v[40:43], v[52:55], v[96:99]
  v_xor_b32 v2, 16384, v2
  v_mfma_f32_16x16x32_bf16 v[112:115], v[40:43], v[60:63], v[112:115]
  v_xor_b32 v3, 16384, v3
  s_waitcnt lgkmcnt(4)
  v_mfma_f32_16x16x32_bf16 v[112:115], v[24:27], v[56:59], v[112:115]
  s_nop 0
  v_xor_b32 v4, 16384, v4
  v_mfma_f32_16x16x32_bf16 v[116:119], v[28:31], v[56:59], v[116:119]
  ds_read_b128 v[56:59], v5 offset:12288
  v_mfma_f32_16x16x32_bf16 v[116:119], v[44:47], v[60:63], v[116:119]
  ds_read_b128 v[60:63], v7 offset:12288
  v_mfma_f32_16x16x32_bf16 v[100:103], v[44:47], v[52:55], v[100:103]
  ds_read_b128 v[52:55], v7 offset:10240
  v_mfma_f32_16x16x32_bf16 v[100:103], v[28:31], v[48:51], v[100:103]
  ds_read_b128 v[48:51], v5 offset:10240
  v_mfma_f32_16x16x32_bf16 v[120:123], v[16:19], v[64:67], v[120:123]
  s_waitcnt lgkmcnt(6)
  v_mfma_f32_16x16x32_bf16 v[120:123], v[32:35], v[68:71], v[120:123]
  v_mfma_f32_16x16x32_bf16 v[136:139], v[32:35], v[76:79], v[136:139]
  v_mfma_f32_16x16x32_bf16 v[136:139], v[16:19], v[72:75], v[136:139]
  v_mfma_f32_16x16x32_bf16 v[140:143], v[20:23], v[72:75], v[140:143]
  v_mfma_f32_16x16x32_bf16 v[140:143], v[36:39], v[76:79], v[140:143]
  s_nop 0
  v_mfma_f32_16x16x32_bf16 v[124:127], v[36:39], v[68:71], v[124:127]
  v_mfma_f32_16x16x32_bf16 v[124:127], v[20:23], v[64:67], v[124:127]
  v_mfma_f32_16x16x32_bf16 v[128:131], v[24:27], v[64:67], v[128:131]
  v_mfma_f32_16x16x32_bf16 v[128:131], v[40:43], v[68:71], v[128:131]
  v_mfma_f32_16x16x32_bf16 v[144:147], v[40:43], v[76:79], v[144:147]
  v_mfma_f32_16x16x32_bf16 v[144:147], v[24:27], v[72:75], v[144:147]
  v_mfma_f32_16x16x32_bf16 v[148:151], v[28:31], v[72:75], v[148:151]
  ds_read_b128 v[72:75], v5 offset:16384
  v_mfma_f32_16x16x32_bf16 v[148:151], v[44:47], v[76:79], v[148:151]
  ds_read_b128 v[76:79], v7 offset:16384
  v_mfma_f32_16x16x32_bf16 v[132:135], v[44:47], v[68:71], v[132:135]
  ds_read_b128 v[68:71], v7 offset:14336
  s_waitcnt lgkmcnt(7)
  v_mfma_f32_16x16x32_bf16 v[132:135], v[28:31], v[64:67], v[132:135]
  ds_read_b128 v[64:67], v5 offset:14336
  v_mfma_f32_16x16x32_bf16 v[152:155], v[16:19], v[80:83], v[152:155]
  s_waitcnt lgkmcnt(4)
  v_mfma_f32_16x16x32_bf16 v[152:155], v[32:35], v[84:87], v[152:155]
  v_mfma_f32_16x16x32_bf16 v[168:171], v[32:35], v[52:55], v[168:171]
  v_mfma_f32_16x16x32_bf16 v[168:171], v[16:19], v[48:51], v[168:171]
  v_mfma_f32_16x16x32_bf16 v[172:175], v[20:23], v[48:51], v[172:175]
  v_mfma_f32_16x16x32_bf16 v[172:175], v[36:39], v[52:55], v[172:175]
  v_mfma_f32_16x16x32_bf16 v[156:159], v[36:39], v[84:87], v[156:159]
  v_mfma_f32_16x16x32_bf16 v[156:159], v[20:23], v[80:83], v[156:159]
  v_mfma_f32_16x16x32_bf16 v[160:163], v[24:27], v[80:83], v[160:163]
  v_mfma_f32_16x16x32_bf16 v[160:163], v[40:43], v[84:87], v[160:163]
  v_mfma_f32_16x16x32_bf16 v[176:179], v[40:43], v[52:55], v[176:179]
  v_mfma_f32_16x16x32_bf16 v[176:179], v[24:27], v[48:51], v[176:179]
  v_mfma_f32_16x16x32_bf16 v[180:183], v[28:31], v[48:51], v[180:183]
  v_mfma_f32_16x16x32_bf16 v[180:183], v[44:47], v[52:55], v[180:183]
  v_mfma_f32_16x16x32_bf16 v[164:167], v[44:47], v[84:87], v[164:167]
  ds_read_b128 v[84:87], v7 offset:18432
  v_mfma_f32_16x16x32_bf16 v[164:167], v[28:31], v[80:83], v[164:167]
  ds_read_b128 v[80:83], v5 offset:18432
  v_mfma_f32_16x16x32_bf16 v[184:187], v[16:19], v[56:59], v[184:187]
  s_waitcnt lgkmcnt(2)
  s_add_u32 s72, s72, 1
  s_cmp_lt_u32 s72, 8
  v_mfma_f32_16x16x32_bf16 v[184:187], v[32:35], v[60:63], v[184:187]
  v_mfma_f32_16x16x32_bf16 v[200:203], v[32:35], v[68:71], v[200:203]
  v_mfma_f32_16x16x32_bf16 v[200:203], v[16:19], v[64:67], v[200:203]
  v_mfma_f32_16x16x32_bf16 v[204:207], v[20:23], v[64:67], v[204:207]
  s_nop 0
  v_mfma_f32_16x16x32_bf16 v[204:207], v[36:39], v[68:71], v[204:207]
  s_waitcnt lgkmcnt(0)
  s_barrier
  v_mfma_f32_16x16x32_bf16 v[188:191], v[36:39], v[60:63], v[188:191]
  ds_read_b128 v[48:51], v5 offset:40960
  v_mfma_f32_16x16x32_bf16 v[188:191], v[20:23], v[56:59], v[188:191]
  ds_read_b128 v[52:55], v7 offset:40960
  v_mfma_f32_16x16x32_bf16 v[192:195], v[24:27], v[56:59], v[192:195]
  v_mfma_f32_16x16x32_bf16 v[192:195], v[40:43], v[60:63], v[192:195]
  v_mfma_f32_16x16x32_bf16 v[208:211], v[40:43], v[68:71], v[208:211]
  v_mfma_f32_16x16x32_bf16 v[208:211], v[24:27], v[64:67], v[208:211]
  v_mfma_f32_16x16x32_bf16 v[212:215], v[28:31], v[64:67], v[212:215]
  ds_read_b128 v[64:67], v5 offset:45056
  v_mfma_f32_16x16x32_bf16 v[212:215], v[44:47], v[68:71], v[212:215]
  ds_read_b128 v[68:71], v7 offset:45056
  v_mfma_f32_16x16x32_bf16 v[196:199], v[44:47], v[60:63], v[196:199]
  ds_read_b128 v[60:63], v7 offset:43008
  v_mfma_f32_16x16x32_bf16 v[196:199], v[28:31], v[56:59], v[196:199]
  ds_read_b128 v[56:59], v5 offset:43008
  v_mfma_f32_16x16x32_bf16 v[216:219], v[32:35], v[76:79], v[216:219]
  v_mfma_f32_16x16x32_bf16 v[216:219], v[16:19], v[72:75], v[216:219]
  v_mfma_f32_16x16x32_bf16 v[232:235], v[16:19], v[80:83], v[232:235]
  ds_read_b64_tr_b16 v[16:17], v1 offset:0
  v_mfma_f32_16x16x32_bf16 v[232:235], v[32:35], v[84:87], v[232:235]
  ds_read_b64_tr_b16 v[18:19], v1 offset:1024
  v_mfma_f32_16x16x32_bf16 v[236:239], v[36:39], v[84:87], v[236:239]
  ds_read_b64_tr_b16 v[32:33], v1 offset:8192
  v_mfma_f32_16x16x32_bf16 v[236:239], v[20:23], v[80:83], v[236:239]
  ds_read_b64_tr_b16 v[34:35], v1 offset:9216
  v_mfma_f32_16x16x32_bf16 v[220:223], v[20:23], v[72:75], v[220:223]
  ds_read_b64_tr_b16 v[20:21], v2 offset:0
  v_mfma_f32_16x16x32_bf16 v[220:223], v[36:39], v[76:79], v[220:223]
  ds_read_b64_tr_b16 v[22:23], v2 offset:1024
  v_mfma_f32_16x16x32_bf16 v[224:227], v[40:43], v[76:79], v[224:227]
  ds_read_b64_tr_b16 v[36:37], v2 offset:8192
  v_mfma_f32_16x16x32_bf16 v[224:227], v[24:27], v[72:75], v[224:227]
  ds_read_b64_tr_b16 v[38:39], v2 offset:9216
  v_mfma_f32_16x16x32_bf16 v[240:243], v[24:27], v[80:83], v[240:243]
  ds_read_b64_tr_b16 v[24:25], v3 offset:0
  v_mfma_f32_16x16x32_bf16 v[240:243], v[40:43], v[84:87], v[240:243]
  ds_read_b64_tr_b16 v[26:27], v3 offset:1024
  v_mfma_f32_16x16x32_bf16 v[244:247], v[44:47], v[84:87], v[244:247]
  ds_read_b64_tr_b16 v[40:41], v3 offset:8192
  v_mfma_f32_16x16x32_bf16 v[244:247], v[28:31], v[80:83], v[244:247]
  s_nop 0
  ds_read_b64_tr_b16 v[42:43], v3 offset:9216
  v_mfma_f32_16x16x32_bf16 v[228:231], v[28:31], v[72:75], v[228:231]
  ds_read_b64_tr_b16 v[28:29], v4 offset:0
  s_waitcnt lgkmcnt(9)
  v_mfma_f32_16x16x32_bf16 v[228:231], v[44:47], v[76:79], v[228:231]
  ds_read_b64_tr_b16 v[30:31], v4 offset:1024
  s_cbranch_scc1 L_dnn_loop0
L_tail:
  v_mfma_f32_16x16x32_bf16 v[88:91], v[16:19], v[48:51], v[88:91]
  ds_read_b64_tr_b16 v[44:45], v4 offset:8192
  v_mfma_f32_16x16x32_bf16 v[88:91], v[32:35], v[52:55], v[88:91]
  ds_read_b64_tr_b16 v[46:47], v4 offset:9216
  v_mfma_f32_16x16x32_bf16 v[104:107], v[32:35], v[60:63], v[104:107]
  ds_read_b128 v[72:75], v5 offset:47104
  s_waitcnt lgkmcnt(9)
  v_mfma_f32_16x16x32_bf16 v[104:107], v[16:19], v[56:59], v[104:107]
  ds_read_b128 v[76:79], v7 offset:47104
  v_mfma_f32_16x16x32_bf16 v[108:111], v[20:23], v[56:59], v[108:111]
  ds_read_b128 v[80:83], v5 offset:49152
  v_mfma_f32_16x16x32_bf16 v[108:111], v[36:39], v[60:63], v[108:111]
  ds_read_b128 v[84:87], v7 offset:49152
  v_mul_f32 v11, v88, v88
  v_mfma_f32_16x16x32_bf16 v[92:95], v[36:39], v[52:55], v[92:95]
  s_waitcnt lgkmcnt(8)
  v_mul_f32 v248, v89, v89
  v_mul_f32 v249, v90, v90
  v_mfma_f32_16x16x32_bf16 v[92:95], v[20:23], v[48:51], v[92:95]
  v_mul_f32_e64 v250, v91, v91
  v_fma_f32 v11, v11, v14, v12
  v_mfma_f32_16x16x32_bf16 v[96:99], v[24:27], v[48:51], v[96:99]
  v_fma_f32 v248, v248, v14, v12
  v_fma_f32 v249, v249, v14, v12
  v_mfma_f32_16x16x32_bf16 v[96:99], v[40:43], v[52:55], v[96:99]
  v_fma_f32 v250, v250, v14, v12
  v_mul_f32 v11, v11, v88
  v_mfma_f32_16x16x32_bf16 v[112:115], v[40:43], v[60:63], v[112:115]
  s_waitcnt lgkmcnt(4)
  v_mul_f32 v248, v248, v89
  v_mul_f32 v249, v249, v90
  v_mfma_f32_16x16x32_bf16 v[112:115], v[24:27], v[56:59], v[112:115]
  v_mul_f32_e64 v250, v250, v91
  v_mfma_f32_16x16x32_bf16 v[116:119], v[28:31], v[56:59], v[116:119]
  ds_read_b128 v[56:59], v5 offset:53248
  v_mfma_f32_16x16x32_bf16 v[116:119], v[44:47], v[60:63], v[116:119]
  ds_read_b128 v[60:63], v7 offset:53248
  v_mfma_f32_16x16x32_bf16 v[100:103], v[44:47], v[52:55], v[100:103]
  ds_read_b128 v[52:55], v7 offset:51200
  v_mfma_f32_16x16x32_bf16 v[100:103], v[28:31], v[48:51], v[100:103]
  ds_read_b128 v[48:51], v5 offset:51200
  v_mfma_f32_16x16x32_bf16 v[120:123], v[16:19], v[64:67], v[120:123]
  s_waitcnt lgkmcnt(6)
  v_exp_f32 v11, v11
  v_mfma_f32_16x16x32_bf16 v[120:123], v[32:35], v[68:71], v[120:123]
  v_exp_f32 v248, v248
  v_mfma_f32_16x16x32_bf16 v[136:139], v[32:35], v[76:79], v[136:139]
  v_exp_f32 v249, v249
  v_mfma_f32_16x16x32_bf16 v[136:139], v[16:19], v[72:75], v[136:139]
  v_exp_f32 v250, v250
  v_mfma_f32_16x16x32_bf16 v[140:143], v[20:23], v[72:75], v[140:143]
  v_add_f32 v11, 1.0, v11
  v_add_f32 v248, 1.0, v248
  v_mfma_f32_16x16x32_bf16 v[140:143], v[36:39], v[76:79], v[140:143]
  v_add_f32 v249, 1.0, v249
  v_add_f32 v250, 1.0, v250
  v_mfma_f32_16x16x32_bf16 v[124:127], v[36:39], v[68:71], v[124:127]
  v_rcp_f32 v11, v11
  v_mfma_f32_16x16x32_bf16 v[124:127], v[20:23], v[64:67], v[124:127]
  v_rcp_f32 v248, v248
  v_mfma_f32_16x16x32_bf16 v[128:131], v[24:27], v[64:67], v[128:131]
  v_rcp_f32 v249, v249
  v_mfma_f32_16x16x32_bf16 v[128:131], v[40:43], v[68:71], v[128:131]
  v_rcp_f32 v250, v250
  v_mfma_f32_16x16x32_bf16 v[144:147], v[40:43], v[76:79], v[144:147]
  v_mul_f32 v88, v88, v11
  v_mul_f32 v89, v89, v248
  v_mfma_f32_16x16x32_bf16 v[144:147], v[24:27], v[72:75], v[144:147]
  v_mul_f32 v90, v90, v249
  v_mul_f32 v91, v91, v250
  v_mfma_f32_16x16x32_bf16 v[148:151], v[28:31], v[72:75], v[148:151]
  ds_read_b128 v[72:75], v5 offset:57344
  v_mul_f32 v11, v92, v92
  v_mfma_f32_16x16x32_bf16 v[148:151], v[44:47], v[76:79], v[148:151]
  ds_read_b128 v[76:79], v7 offset:57344
  v_mul_f32_e64 v248, v93, v93
  v_mfma_f32_16x16x32_bf16 v[132:135], v[44:47], v[68:71], v[132:135]
  ds_read_b128 v[68:71], v7 offset:55296
  s_waitcnt lgkmcnt(7)
  v_mul_f32 v249, v94, v94
  v_mfma_f32_16x16x32_bf16 v[132:135], v[28:31], v[64:67], v[132:135]
  ds_read_b128 v[64:67], v5 offset:55296
  v_mul_f32 v250, v95, v95
  v_mfma_f32_16x16x32_bf16 v[152:155], v[16:19], v[80:83], v[152:155]
  s_waitcnt lgkmcnt(4)
  v_fma_f32 v11, v11, v14, v12
  v_fma_f32 v248, v248, v14, v12
  v_mfma_f32_16x16x32_bf16 v[152:155], v[32:35], v[84:87], v[152:155]
  v_fma_f32 v249, v249, v14, v12
  v_fma_f32 v250, v250, v14, v12
  v_mfma_f32_16x16x32_bf16 v[168:171], v[32:35], v[52:55], v[168:171]
  v_mul_f32 v11, v11, v92
  v_mul_f32 v248, v248, v93
  v_mfma_f32_16x16x32_bf16 v[168:171], v[16:19], v[48:51], v[168:171]
  v_mul_f32 v249, v249, v94
  v_mul_f32 v250, v250, v95
  v_mfma_f32_16x16x32_bf16 v[172:175], v[20:23], v[48:51], v[172:175]
  v_exp_f32 v11, v11
  v_mfma_f32_16x16x32_bf16 v[172:175], v[36:39], v[52:55], v[172:175]
  v_exp_f32 v248, v248
  v_mfma_f32_16x16x32_bf16 v[156:159], v[36:39], v[84:87], v[156:159]
  v_exp_f32 v249, v249
  v_mfma_f32_16x16x32_bf16 v[156:159], v[20:23], v[80:83], v[156:159]
  v_exp_f32 v250, v250
  v_mfma_f32_16x16x32_bf16 v[160:163], v[24:27], v[80:83], v[160:163]
  v_add_f32 v11, 1.0, v11
  v_add_f32 v248, 1.0, v248
  v_mfma_f32_16x16x32_bf16 v[160:163], v[40:43], v[84:87], v[160:163]
  v_add_f32 v249, 1.0, v249
  v_add_f32 v250, 1.0, v250
  v_mfma_f32_16x16x32_bf16 v[176:179], v[40:43], v[52:55], v[176:179]
  v_rcp_f32 v11, v11
  v_mfma_f32_16x16x32_bf16 v[176:179], v[24:27], v[48:51], v[176:179]
  v_rcp_f32 v248, v248
  v_mfma_f32_16x16x32_bf16 v[180:183], v[28:31], v[48:51], v[180:183]
  v_rcp_f32 v249, v249
  v_mfma_f32_16x16x32_bf16 v[180:183], v[44:47], v[52:55], v[180:183]
  v_rcp_f32 v250, v250
  v_mfma_f32_16x16x32_bf16 v[164:167], v[44:47], v[84:87], v[164:167]
  ds_read_b128 v[84:87], v7 offset:59392
  v_mul_f32 v92, v92, v11
  v_mfma_f32_16x16x32_bf16 v[164:167], v[28:31], v[80:83], v[164:167]
  ds_read_b128 v[80:83], v5 offset:59392
  v_mul_f32 v93, v93, v248
  v_mfma_f32_16x16x32_bf16 v[184:187], v[16:19], v[56:59], v[184:187]
  s_waitcnt lgkmcnt(2)
  v_mul_f32 v94, v94, v249
  v_mul_f32_e64 v95, v95, v250
  v_mfma_f32_16x16x32_bf16 v[184:187], v[32:35], v[60:63], v[184:187]
  v_mul_f32 v11, v96, v96
  v_mul_f32 v248, v97, v97
  v_mfma_f32_16x16x32_bf16 v[200:203], v[32:35], v[68:71], v[200:203]
  v_mul_f32 v249, v98, v98
  v_mul_f32 v250, v99, v99
  v_mfma_f32_16x16x32_bf16 v[200:203], v[16:19], v[64:67], v[200:203]
  v_fma_f32 v11, v11, v14, v12
  v_fma_f32 v248, v248, v14, v12
  v_mfma_f32_16x16x32_bf16 v[204:207], v[20:23], v[64:67], v[204:207]
  v_fma_f32 v249, v249, v14, v12
  v_fma_f32 v250, v250, v14, v12
  v_mfma_f32_16x16x32_bf16 v[204:207], v[36:39], v[68:71], v[204:207]
  v_mul_f32 v11, v11, v96
  v_mul_f32 v248, v248, v97
  v_mfma_f32_16x16x32_bf16 v[188:191], v[36:39], v[60:63], v[188:191]
  v_mul_f32 v249, v249, v98
  v_mul_f32 v250, v250, v99
  v_mfma_f32_16x16x32_bf16 v[188:191], v[20:23], v[56:59], v[188:191]
  v_exp_f32_e64 v11, v11
  v_mfma_f32_16x16x32_bf16 v[192:195], v[24:27], v[56:59], v[192:195]
  v_exp_f32 v248, v248
  v_mfma_f32_16x16x32_bf16 v[192:195], v[40:43], v[60:63], v[192:195]
  v_exp_f32 v249, v249
  v_mfma_f32_16x16x32_bf16 v[208:211], v[40:43], v[68:71], v[208:211]
  v_exp_f32 v250, v250
  v_mfma_f32_16x16x32_bf16 v[208:211], v[24:27], v[64:67], v[208:211]
  v_add_f32 v11, 1.0, v11
  v_add_f32 v248, 1.0, v248
  v_mfma_f32_16x16x32_bf16 v[212:215], v[28:31], v[64:67], v[212:215]
  v_add_f32 v249, 1.0, v249
  v_add_f32 v250, 1.0, v250
  v_mfma_f32_16x16x32_bf16 v[212:215], v[44:47], v[68:71], v[212:215]
  v_rcp_f32 v11, v11
  v_mfma_f32_16x16x32_bf16 v[196:199], v[44:47], v[60:63], v[196:199]
  v_rcp_f32 v248, v248
  v_mfma_f32_16x16x32_bf16 v[196:199], v[28:31], v[56:59], v[196:199]
  v_rcp_f32 v249, v249
  v_mfma_f32_16x16x32_bf16 v[216:219], v[32:35], v[76:79], v[216:219]
  s_waitcnt lgkmcnt(0)
  v_rcp_f32 v250, v250
  v_mfma_f32_16x16x32_bf16 v[216:219], v[16:19], v[72:75], v[216:219]
  v_mul_f32 v96, v96, v11
  v_mul_f32 v97, v97, v248
  v_mfma_f32_16x16x32_bf16 v[232:235], v[16:19], v[80:83], v[232:235]
  v_mul_f32 v98, v98, v249
  v_mul_f32 v99, v99, v250
  v_mfma_f32_16x16x32_bf16 v[232:235], v[32:35], v[84:87], v[232:235]
  v_mul_f32 v11, v100, v100
  v_mul_f32 v248, v101, v101
  v_mfma_f32_16x16x32_bf16 v[236:239], v[36:39], v[84:87], v[236:239]
  v_mul_f32 v249, v102, v102
  v_mul_f32 v250, v103, v103
  v_mfma_f32_16x16x32_bf16 v[236:239], v[20:23], v[80:83], v[236:239]
  v_fma_f32 v11, v11, v14, v12
  v_fma_f32 v248, v248, v14, v12
  v_mfma_f32_16x16x32_bf16 v[220:223], v[20:23], v[72:75], v[220:223]
  v_fma_f32 v249, v249, v14, v12
  v_fma_f32 v250, v250, v14, v12
  v_mfma_f32_16x16x32_bf16 v[220:223], v[36:39], v[76:79], v[220:223]
  v_mul_f32 v11, v11, v100
  v_mul_f32 v248, v248, v101
  v_mfma_f32_16x16x32_bf16 v[224:227], v[40:43], v[76:79], v[224:227]
  v_mul_f32 v249, v249, v102
  v_mul_f32 v250, v250, v103
  v_mfma_f32_16x16x32_bf16 v[224:227], v[24:27], v[72:75], v[224:227]
  v_exp_f32 v11, v11
  v_mfma_f32_16x16x32_bf16 v[240:243], v[24:27], v[80:83], v[240:243]
  v_exp_f32 v248, v248
  v_mfma_f32_16x16x32_bf16 v[240:243], v[40:43], v[84:87], v[240:243]
  v_exp_f32 v249, v249
  v_mfma_f32_16x16x32_bf16 v[244:247], v[44:47], v[84:87], v[244:247]
  v_exp_f32 v250, v250
  v_mfma_f32_16x16x32_bf16 v[244:247], v[28:31], v[80:83], v[244:247]
  v_add_f32 v11, 1.0, v11
  v_add_f32 v248, 1.0, v248
  v_mfma_f32_16x16x32_bf16 v[228:231], v[28:31], v[72:75], v[228:231]
  v_add_f32 v249, 1.0, v249
  v_add_f32 v250, 1.0, v250
  v_mfma_f32_16x16x32_bf16 v[228:231], v[44:47], v[76:79], v[228:231]
  v_rcp_f32 v11, v11
  v_rcp_f32 v248, v248
  v_rcp_f32 v249, v249
  v_rcp_f32 v250, v250
  v_mul_f32 v100, v100, v11
  v_mul_f32 v101, v101, v248
  v_mul_f32 v102, v102, v249
  v_mul_f32 v103, v103, v250
  ds_read_b64 v[18:19], v9 offset:256
  ds_read_b64 v[22:23], v9 offset:288
  ds_read_b64 v[26:27], v9 offset:320
  ds_read_b64 v[30:31], v9 offset:352
  v_mov_b32 v248, 1.0
  v_mov_b32 v249, 1.0
L_epi:
  v_mov_b32 v84, 0xc1c00000
  v_mov_b32 v85, 0xc1c00000
  v_mov_b32 v86, 0x4b800000
  v_mov_b32 v87, 0x4b800000
  v_pk_mul_f32 v[52:53], v[104:105], v[104:105]
  v_pk_mul_f32 v[56:57], v[106:107], v[106:107]
  v_pk_mul_f32 v[60:61], v[108:109], v[108:109]
  v_pk_mul_f32 v[64:65], v[110:111], v[110:111]
  v_pk_mul_f32 v[68:69], v[120:121], v[120:121]
  v_pk_mul_f32 v[72:73], v[122:123], v[122:123]
  v_pk_mul_f32 v[76:77], v[124:125], v[124:125]
  v_pk_mul_f32 v[80:81], v[126:127], v[126:127]
  v_pk_fma_f32 v[52:53], v[52:53], v[14:15], v[12:13]
  v_pk_fma_f32 v[56:57], v[56:57], v[14:15], v[12:13]
  v_pk_fma_f32 v[60:61], v[60:61], v[14:15], v[12:13]
  v_pk_fma_f32 v[64:65], v[64:65], v[14:15], v[12:13]
  v_pk_fma_f32 v[68:69], v[68:69], v[14:15], v[12:13]
  v_pk_fma_f32 v[72:73], v[72:73], v[14:15], v[12:13]
  v_pk_fma_f32 v[76:77], v[76:77], v[14:15], v[12:13]
  v_pk_fma_f32 v[80:81], v[80:81], v[14:15], v[12:13]
  v_pk_fma_f32 v[52:53], v[52:53], v[104:105], v[84:85]
  v_pk_fma_f32 v[56:57], v[56:57], v[106:107], v[84:85]
  v_pk_fma_f32 v[60:61], v[60:61], v[108:109], v[84:85]
  v_pk_fma_f32 v[64:65], v[64:65], v[110:111], v[84:85]
  v_pk_fma_f32 v[68:69], v[68:69], v[120:121], v[84:85]
  v_pk_fma_f32 v[72:73], v[72:73], v[122:123], v[84:85]
  v_pk_fma_f32 v[76:77], v[76:77], v[124:125], v[84:85]
  v_pk_fma_f32 v[80:81], v[80:81], v[126:127], v[84:85]
  v_exp_f32 v52, v52 clamp
  v_exp_f32 v53, v53 clamp
  v_exp_f32 v56, v56 clamp
  v_exp_f32 v57, v57 clamp
  v_exp_f32 v60, v60 clamp
  v_exp_f32 v61, v61 clamp
  v_exp_f32 v64, v64 clamp
  v_exp_f32 v65, v65 clamp
  v_exp_f32 v68, v68 clamp
  v_exp_f32 v69, v69 clamp
  v_exp_f32 v72, v72 clamp
  v_exp_f32 v73, v73 clamp
  v_exp_f32 v76, v76 clamp
  v_exp_f32 v77, v77 clamp
  v_exp_f32 v80, v80 clamp
  v_exp_f32 v81, v81 clamp
  s_waitcnt lgkmcnt(3)
  v_lshlrev_b32 v16, 16, v18
  v_and_b32 v17, 0xffff0000, v18
  v_lshlrev_b32 v18, 16, v19
  v_and_b32 v19, 0xffff0000, v19
  s_waitcnt lgkmcnt(2)
  v_lshlrev_b32 v20, 16, v22
  v_and_b32 v21, 0xffff0000, v22
  v_lshlrev_b32 v22, 16, v23
  v_and_b32 v23, 0xffff0000, v23
  s_waitcnt lgkmcnt(1)
  v_lshlrev_b32 v24, 16, v26
  v_and_b32 v25, 0xffff0000, v26
  v_lshlrev_b32 v26, 16, v27
  v_and_b32 v27, 0xffff0000, v27
  s_waitcnt lgkmcnt(0)
  v_lshlrev_b32 v28, 16, v30
  v_and_b32 v29, 0xffff0000, v30
  v_lshlrev_b32 v30, 16, v31
  v_and_b32 v31, 0xffff0000, v31
  v_pk_mul_f32 v[54:55], v[104:105], v[16:17]
  v_pk_mul_f32 v[58:59], v[106:107], v[18:19]
  v_pk_mul_f32 v[62:63], v[108:109], v[20:21]
  v_pk_mul_f32 v[66:67], v[110:111], v[22:23]
  v_pk_mul_f32 v[70:71], v[120:121], v[16:17]
  v_pk_mul_f32 v[74:75], v[122:123], v[18:19]
  v_pk_mul_f32 v[78:79], v[124:125], v[20:21]
  v_pk_mul_f32 v[82:83], v[126:127], v[22:23]
  v_pk_fma_f32 v[52:53], v[52:53], v[86:87], v[248:249]
  v_pk_fma_f32 v[56:57], v[56:57], v[86:87], v[248:249]
  v_pk_fma_f32 v[60:61], v[60:61], v[86:87], v[248:249]
  v_pk_fma_f32 v[64:65], v[64:65], v[86:87], v[248:249]
  v_pk_fma_f32 v[68:69], v[68:69], v[86:87], v[248:249]
  v_pk_fma_f32 v[72:73], v[72:73], v[86:87], v[248:249]
  v_pk_fma_f32 v[76:77], v[76:77], v[86:87], v[248:249]
  v_pk_fma_f32 v[80:81], v[80:81], v[86:87], v[248:249]
  v_pk_mul_f32 v[54:55], v[54:55], v[56:57]
  v_pk_mul_f32 v[62:63], v[62:63], v[64:65]
  v_pk_mul_f32 v[70:71], v[70:71], v[72:73]
  v_pk_mul_f32 v[78:79], v[78:79], v[80:81]
  v_pk_fma_f32 v[54:55], v[58:59], v[52:53], v[54:55]
  v_pk_fma_f32 v[62:63], v[66:67], v[60:61], v[62:63]
  v_pk_fma_f32 v[70:71], v[74:75], v[68:69], v[70:71]
  v_pk_fma_f32 v[78:79], v[82:83], v[76:77], v[78:79]
  v_pk_mul_f32 v[52:53], v[52:53], v[56:57]
  v_pk_mul_f32 v[60:61], v[60:61], v[64:65]
  v_pk_mul_f32 v[68:69], v[68:69], v[72:73]
  v_pk_mul_f32 v[76:77], v[76:77], v[80:81]
  v_pk_mul_f32 v[54:55], v[54:55], v[60:61]
  v_pk_mul_f32 v[70:71], v[70:71], v[76:77]
  v_pk_fma_f32 v[54:55], v[62:63], v[52:53], v[54:55]
  v_pk_fma_f32 v[70:71], v[78:79], v[68:69], v[70:71]
  v_pk_mul_f32 v[52:53], v[52:53], v[60:61]
  v_pk_mul_f32 v[68:69], v[68:69], v[76:77]
  v_rcp_f32 v52, v52
  v_rcp_f32 v53, v53
  v_rcp_f32 v68, v68
  v_rcp_f32 v69, v69
  v_pk_mul_f32 v[34:35], v[52:53], v[54:55]
  v_pk_mul_f32 v[36:37], v[68:69], v[70:71]
  v_pk_mul_f32 v[52:53], v[112:113], v[112:113]
  v_pk_mul_f32 v[56:57], v[114:115], v[114:115]
  v_pk_mul_f32 v[60:61], v[116:117], v[116:117]
  v_pk_mul_f32 v[64:65], v[118:119], v[118:119]
  v_pk_mul_f32 v[68:69], v[128:129], v[128:129]
  v_pk_mul_f32 v[72:73], v[130:131], v[130:131]
  v_pk_mul_f32 v[76:77], v[132:133], v[132:133]
  v_pk_mul_f32 v[80:81], v[134:135], v[134:135]
  v_pk_fma_f32 v[52:53], v[52:53], v[14:15], v[12:13]
  v_pk_fma_f32 v[56:57], v[56:57], v[14:15], v[12:13]
  v_pk_fma_f32 v[60:61], v[60:61], v[14:15], v[12:13]
  v_pk_fma_f32 v[64:65], v[64:65], v[14:15], v[12:13]
  v_pk_fma_f32 v[68:69], v[68:69], v[14:15], v[12:13]
  v_pk_fma_f32 v[72:73], v[72:73], v[14:15], v[12:13]
  v_pk_fma_f32 v[76:77], v[76:77], v[14:15], v[12:13]
  v_pk_fma_f32 v[80:81], v[80:81], v[14:15], v[12:13]
  v_pk_fma_f32 v[52:53], v[52:53], v[112:113], v[84:85]
  v_pk_fma_f32 v[56:57], v[56:57], v[114:115], v[84:85]
  v_pk_fma_f32 v[60:61], v[60:61], v[116:117], v[84:85]
  v_pk_fma_f32 v[64:65], v[64:65], v[118:119], v[84:85]
  v_pk_fma_f32 v[68:69], v[68:69], v[128:129], v[84:85]
  v_pk_fma_f32 v[72:73], v[72:73], v[130:131], v[84:85]
  v_pk_fma_f32 v[76:77], v[76:77], v[132:133], v[84:85]
  v_pk_fma_f32 v[80:81], v[80:81], v[134:135], v[84:85]
  v_exp_f32 v52, v52 clamp
  v_exp_f32 v53, v53 clamp
  v_exp_f32 v56, v56 clamp
  v_exp_f32 v57, v57 clamp
  v_exp_f32 v60, v60 clamp
  v_exp_f32 v61, v61 clamp
  v_exp_f32 v64, v64 clamp
  v_exp_f32 v65, v65 clamp
  v_exp_f32 v68, v68 clamp
  v_exp_f32 v69, v69 clamp
  v_exp_f32 v72, v72 clamp
  v_exp_f32 v73, v73 clamp
  v_exp_f32 v76, v76 clamp
  v_exp_f32 v77, v77 clamp
  v_exp_f32 v80, v80 clamp
  v_exp_f32 v81, v81 clamp
  v_pk_mul_f32 v[54:55], v[112:113], v[24:25]
  v_pk_mul_f32 v[58:59], v[114:115], v[26:27]
  v_pk_mul_f32 v[62:63], v[116:117], v[28:29]
  v_pk_mul_f32 v[66:67], v[118:119], v[30:31]
  v_pk_mul_f32 v[70:71], v[128:129], v[24:25]
  v_pk_mul_f32 v[74:75], v[130:131], v[26:27]
  v_pk_mul_f32 v[78:79], v[132:133], v[28:29]
  v_pk_mul_f32 v[82:83], v[134:135], v[30:31]
  v_pk_fma_f32 v[52:53], v[52:53], v[86:87], v[248:249]
  v_pk_fma_f32 v[56:57], v[56:57], v[86:87], v[248:249]
  v_pk_fma_f32 v[60:61], v[60:61], v[86:87], v[248:249]
  v_pk_fma_f32 v[64:65], v[64:65], v[86:87], v[248:249]
  v_pk_fma_f32 v[68:69], v[68:69], v[86:87], v[248:249]
  v_pk_fma_f32 v[72:73], v[72:73], v[86:87], v[248:249]
  v_pk_fma_f32 v[76:77], v[76:77], v[86:87], v[248:249]
  v_pk_fma_f32 v[80:81], v[80:81], v[86:87], v[248:249]
  v_pk_mul_f32 v[54:55], v[54:55], v[56:57]
  v_pk_mul_f32 v[62:63], v[62:63], v[64:65]
  v_pk_mul_f32 v[70:71], v[70:71], v[72:73]
  v_pk_mul_f32 v[78:79], v[78:79], v[80:81]
  v_pk_fma_f32 v[54:55], v[58:59], v[52:53], v[54:55]
  v_pk_fma_f32 v[62:63], v[66:67], v[60:61], v[62:63]
  v_pk_fma_f32 v[70:71], v[74:75], v[68:69], v[70:71]
  v_pk_fma_f32 v[78:79], v[82:83], v[76:77], v[78:79]
  v_pk_mul_f32 v[52:53], v[52:53], v[56:57]
  v_pk_mul_f32 v[60:61], v[60:61], v[64:65]
  v_pk_mul_f32 v[68:69], v[68:69], v[72:73]
  v_pk_mul_f32 v[76:77], v[76:77], v[80:81]
  v_pk_mul_f32 v[54:55], v[54:55], v[60:61]
  v_pk_mul_f32 v[70:71], v[70:71], v[76:77]
  v_pk_fma_f32 v[54:55], v[62:63], v[52:53], v[54:55]
  v_pk_fma_f32 v[70:71], v[78:79], v[68:69], v[70:71]
  v_pk_mul_f32 v[52:53], v[52:53], v[60:61]
  v_pk_mul_f32 v[68:69], v[68:69], v[76:77]
  v_rcp_f32 v52, v52
  v_rcp_f32 v53, v53
  v_rcp_f32 v68, v68
  v_rcp_f32 v69, v69
  v_pk_fma_f32 v[34:35], v[52:53], v[54:55], v[34:35]
  v_pk_fma_f32 v[36:37], v[68:69], v[70:71], v[36:37]
  v_pk_mul_f32 v[52:53], v[136:137], v[136:137]
  v_pk_mul_f32 v[56:57], v[138:139], v[138:139]
  v_pk_mul_f32 v[60:61], v[140:141], v[140:141]
  v_pk_mul_f32 v[64:65], v[142:143], v[142:143]
  v_pk_mul_f32 v[68:69], v[152:153], v[152:153]
  v_pk_mul_f32 v[72:73], v[154:155], v[154:155]
  v_pk_mul_f32 v[76:77], v[156:157], v[156:157]
  v_pk_mul_f32 v[80:81], v[158:159], v[158:159]
  v_pk_fma_f32 v[52:53], v[52:53], v[14:15], v[12:13]
  v_pk_fma_f32 v[56:57], v[56:57], v[14:15], v[12:13]
  v_pk_fma_f32 v[60:61], v[60:61], v[14:15], v[12:13]
  v_pk_fma_f32 v[64:65], v[64:65], v[14:15], v[12:13]
  v_pk_fma_f32 v[68:69], v[68:69], v[14:15], v[12:13]
  v_pk_fma_f32 v[72:73], v[72:73], v[14:15], v[12:13]
  v_pk_fma_f32 v[76:77], v[76:77], v[14:15], v[12:13]
  v_pk_fma_f32 v[80:81], v[80:81], v[14:15], v[12:13]
  v_pk_fma_f32 v[52:53], v[52:53], v[136:137], v[84:85]
  v_pk_fma_f32 v[56:57], v[56:57], v[138:139], v[84:85]
  v_pk_fma_f32 v[60:61], v[60:61], v[140:141], v[84:85]
  v_pk_fma_f32 v[64:65], v[64:65], v[142:143], v[84:85]
  v_pk_fma_f32 v[68:69], v[68:69], v[152:153], v[84:85]
  v_pk_fma_f32 v[72:73], v[72:73], v[154:155], v[84:85]
  v_pk_fma_f32 v[76:77], v[76:77], v[156:157], v[84:85]
  v_pk_fma_f32 v[80:81], v[80:81], v[158:159], v[84:85]
  v_exp_f32 v52, v52 clamp
  v_exp_f32 v53, v53 clamp
  v_exp_f32 v56, v56 clamp
  v_exp_f32 v57, v57 clamp
  v_exp_f32 v60, v60 clamp
  v_exp_f32 v61, v61 clamp
  v_exp_f32 v64, v64 clamp
  v_exp_f32 v65, v65 clamp
  v_exp_f32 v68, v68 clamp
  v_exp_f32 v69, v69 clamp
  v_exp_f32 v72, v72 clamp
  v_exp_f32 v73, v73 clamp
  v_exp_f32 v76, v76 clamp
  v_exp_f32 v77, v77 clamp
  v_exp_f32 v80, v80 clamp
  v_exp_f32 v81, v81 clamp
  v_pk_mul_f32 v[54:55], v[136:137], v[16:17]
  v_pk_mul_f32 v[58:59], v[138:139], v[18:19]
  v_pk_mul_f32 v[62:63], v[140:141], v[20:21]
  v_pk_mul_f32 v[66:67], v[142:143], v[22:23]
  v_pk_mul_f32 v[70:71], v[152:153], v[16:17]
  v_pk_mul_f32 v[74:75], v[154:155], v[18:19]
  v_pk_mul_f32 v[78:79], v[156:157], v[20:21]
  v_pk_mul_f32 v[82:83], v[158:159], v[22:23]
  v_pk_fma_f32 v[52:53], v[52:53], v[86:87], v[248:249]
  v_pk_fma_f32 v[56:57], v[56:57], v[86:87], v[248:249]
  v_pk_fma_f32 v[60:61], v[60:61], v[86:87], v[248:249]
  v_pk_fma_f32 v[64:65], v[64:65], v[86:87], v[248:249]
  v_pk_fma_f32 v[68:69], v[68:69], v[86:87], v[248:249]
  v_pk_fma_f32 v[72:73], v[72:73], v[86:87], v[248:249]
  v_pk_fma_f32 v[76:77], v[76:77], v[86:87], v[248:249]
  v_pk_fma_f32 v[80:81], v[80:81], v[86:87], v[248:249]
  v_pk_mul_f32 v[54:55], v[54:55], v[56:57]
  v_pk_mul_f32 v[62:63], v[62:63], v[64:65]
  v_pk_mul_f32 v[70:71], v[70:71], v[72:73]
  v_pk_mul_f32 v[78:79], v[78:79], v[80:81]
  v_pk_fma_f32 v[54:55], v[58:59], v[52:53], v[54:55]
  v_pk_fma_f32 v[62:63], v[66:67], v[60:61], v[62:63]
  v_pk_fma_f32 v[70:71], v[74:75], v[68:69], v[70:71]
  v_pk_fma_f32 v[78:79], v[82:83], v[76:77], v[78:79]
  v_pk_mul_f32 v[52:53], v[52:53], v[56:57]
  v_pk_mul_f32 v[60:61], v[60:61], v[64:65]
  v_pk_mul_f32 v[68:69], v[68:69], v[72:73]
  v_pk_mul_f32 v[76:77], v[76:77], v[80:81]
  v_pk_mul_f32 v[54:55], v[54:55], v[60:61]
  v_pk_mul_f32 v[70:71], v[70:71], v[76:77]
  v_pk_fma_f32 v[54:55], v[62:63], v[52:53], v[54:55]
  v_pk_fma_f32 v[70:71], v[78:79], v[68:69], v[70:71]
  v_pk_mul_f32 v[52:53], v[52:53], v[60:61]
  v_pk_mul_f32 v[68:69], v[68:69], v[76:77]
  v_rcp_f32 v52, v52
  v_rcp_f32 v53, v53
  v_rcp_f32 v68, v68
  v_rcp_f32 v69, v69
  v_pk_mul_f32 v[38:39], v[52:53], v[54:55]
  v_pk_mul_f32 v[40:41], v[68:69], v[70:71]
  v_pk_mul_f32 v[52:53], v[144:145], v[144:145]
  v_pk_mul_f32 v[56:57], v[146:147], v[146:147]
  v_pk_mul_f32 v[60:61], v[148:149], v[148:149]
  v_pk_mul_f32 v[64:65], v[150:151], v[150:151]
  v_pk_mul_f32 v[68:69], v[160:161], v[160:161]
  v_pk_mul_f32 v[72:73], v[162:163], v[162:163]
  v_pk_mul_f32 v[76:77], v[164:165], v[164:165]
  v_pk_mul_f32 v[80:81], v[166:167], v[166:167]
  v_pk_fma_f32 v[52:53], v[52:53], v[14:15], v[12:13]
  v_pk_fma_f32 v[56:57], v[56:57], v[14:15], v[12:13]
  v_pk_fma_f32 v[60:61], v[60:61], v[14:15], v[12:13]
  v_pk_fma_f32 v[64:65], v[64:65], v[14:15], v[12:13]
  v_pk_fma_f32 v[68:69], v[68:69], v[14:15], v[12:13]
  v_pk_fma_f32 v[72:73], v[72:73], v[14:15], v[12:13]
  v_pk_fma_f32 v[76:77], v[76:77], v[14:15], v[12:13]
  v_pk_fma_f32 v[80:81], v[80:81], v[14:15], v[12:13]
  v_pk_fma_f32 v[52:53], v[52:53], v[144:145], v[84:85]
  v_pk_fma_f32 v[56:57], v[56:57], v[146:147], v[84:85]
  v_pk_fma_f32 v[60:61], v[60:61], v[148:149], v[84:85]
  v_pk_fma_f32 v[64:65], v[64:65], v[150:151], v[84:85]
  v_pk_fma_f32 v[68:69], v[68:69], v[160:161], v[84:85]
  v_pk_fma_f32 v[72:73], v[72:73], v[162:163], v[84:85]
  v_pk_fma_f32 v[76:77], v[76:77], v[164:165], v[84:85]
  v_pk_fma_f32 v[80:81], v[80:81], v[166:167], v[84:85]
  v_exp_f32 v52, v52 clamp
  v_exp_f32 v53, v53 clamp
  v_exp_f32 v56, v56 clamp
  v_exp_f32 v57, v57 clamp
  v_exp_f32 v60, v60 clamp
  v_exp_f32 v61, v61 clamp
  v_exp_f32 v64, v64 clamp
  v_exp_f32 v65, v65 clamp
  v_exp_f32 v68, v68 clamp
  v_exp_f32 v69, v69 clamp
  v_exp_f32 v72, v72 clamp
  v_exp_f32 v73, v73 clamp
  v_exp_f32 v76, v76 clamp
  v_exp_f32 v77, v77 clamp
  v_exp_f32 v80, v80 clamp
  v_exp_f32 v81, v81 clamp
  v_pk_mul_f32 v[54:55], v[144:145], v[24:25]
  v_pk_mul_f32 v[58:59], v[146:147], v[26:27]
  v_pk_mul_f32 v[62:63], v[148:149], v[28:29]
  v_pk_mul_f32 v[66:67], v[150:151], v[30:31]
  v_pk_mul_f32 v[70:71], v[160:161], v[24:25]
  v_pk_mul_f32 v[74:75], v[162:163], v[26:27]
  v_pk_mul_f32 v[78:79], v[164:165], v[28:29]
  v_pk_mul_f32 v[82:83], v[166:167], v[30:31]
  v_pk_fma_f32 v[52:53], v[52:53], v[86:87], v[248:249]
  v_pk_fma_f32 v[56:57], v[56:57], v[86:87], v[248:249]
  v_pk_fma_f32 v[60:61], v[60:61], v[86:87], v[248:249]
  v_pk_fma_f32 v[64:65], v[64:65], v[86:87], v[248:249]
  v_pk_fma_f32 v[68:69], v[68:69], v[86:87], v[248:249]
  v_pk_fma_f32 v[72:73], v[72:73], v[86:87], v[248:249]
  v_pk_fma_f32 v[76:77], v[76:77], v[86:87], v[248:249]
  v_pk_fma_f32 v[80:81], v[80:81], v[86:87], v[248:249]
  v_pk_mul_f32 v[54:55], v[54:55], v[56:57]
  v_pk_mul_f32 v[62:63], v[62:63], v[64:65]
  v_pk_mul_f32 v[70:71], v[70:71], v[72:73]
  v_pk_mul_f32 v[78:79], v[78:79], v[80:81]
  v_pk_fma_f32 v[54:55], v[58:59], v[52:53], v[54:55]
  v_pk_fma_f32 v[62:63], v[66:67], v[60:61], v[62:63]
  v_pk_fma_f32 v[70:71], v[74:75], v[68:69], v[70:71]
  v_pk_fma_f32 v[78:79], v[82:83], v[76:77], v[78:79]
  v_pk_mul_f32 v[52:53], v[52:53], v[56:57]
  v_pk_mul_f32 v[60:61], v[60:61], v[64:65]
  v_pk_mul_f32 v[68:69], v[68:69], v[72:73]
  v_pk_mul_f32 v[76:77], v[76:77], v[80:81]
  v_pk_mul_f32 v[54:55], v[54:55], v[60:61]
  v_pk_mul_f32 v[70:71], v[70:71], v[76:77]
  v_pk_fma_f32 v[54:55], v[62:63], v[52:53], v[54:55]
  v_pk_fma_f32 v[70:71], v[78:79], v[68:69], v[70:71]
  v_pk_mul_f32 v[52:53], v[52:53], v[60:61]
  v_pk_mul_f32 v[68:69], v[68:69], v[76:77]
  v_rcp_f32 v52, v52
  v_rcp_f32 v53, v53
  v_rcp_f32 v68, v68
  v_rcp_f32 v69, v69
  v_pk_fma_f32 v[38:39], v[52:53], v[54:55], v[38:39]
  v_pk_fma_f32 v[40:41], v[68:69], v[70:71], v[40:41]
  v_pk_mul_f32 v[52:53], v[168:169], v[168:169]
  v_pk_mul_f32 v[56:57], v[170:171], v[170:171]
  v_pk_mul_f32 v[60:61], v[172:173], v[172:173]
  v_pk_mul_f32 v[64:65], v[174:175], v[174:175]
  v_pk_mul_f32 v[68:69], v[184:185], v[184:185]
  v_pk_mul_f32 v[72:73], v[186:187], v[186:187]
  v_pk_mul_f32 v[76:77], v[188:189], v[188:189]
  v_pk_mul_f32 v[80:81], v[190:191], v[190:191]
  v_pk_fma_f32 v[52:53], v[52:53], v[14:15], v[12:13]
  v_pk_fma_f32 v[56:57], v[56:57], v[14:15], v[12:13]
  v_pk_fma_f32 v[60:61], v[60:61], v[14:15], v[12:13]
  v_pk_fma_f32 v[64:65], v[64:65], v[14:15], v[12:13]
  v_pk_fma_f32 v[68:69], v[68:69], v[14:15], v[12:13]
  v_pk_fma_f32 v[72:73], v[72:73], v[14:15], v[12:13]
  v_pk_fma_f32 v[76:77], v[76:77], v[14:15], v[12:13]
  v_pk_fma_f32 v[80:81], v[80:81], v[14:15], v[12:13]
  v_pk_fma_f32 v[52:53], v[52:53], v[168:169], v[84:85]
  v_pk_fma_f32 v[56:57], v[56:57], v[170:171], v[84:85]
  v_pk_fma_f32 v[60:61], v[60:61], v[172:173], v[84:85]
  v_pk_fma_f32 v[64:65], v[64:65], v[174:175], v[84:85]
  v_pk_fma_f32 v[68:69], v[68:69], v[184:185], v[84:85]
  v_pk_fma_f32 v[72:73], v[72:73], v[186:187], v[84:85]
  v_pk_fma_f32 v[76:77], v[76:77], v[188:189], v[84:85]
  v_pk_fma_f32 v[80:81], v[80:81], v[190:191], v[84:85]
  v_exp_f32 v52, v52 clamp
  v_exp_f32 v53, v53 clamp
  v_exp_f32 v56, v56 clamp
  v_exp_f32 v57, v57 clamp
  v_exp_f32 v60, v60 clamp
  v_exp_f32 v61, v61 clamp
  v_exp_f32 v64, v64 clamp
  v_exp_f32 v65, v65 clamp
  v_exp_f32 v68, v68 clamp
  v_exp_f32 v69, v69 clamp
  v_exp_f32 v72, v72 clamp
  v_exp_f32 v73, v73 clamp
  v_exp_f32 v76, v76 clamp
  v_exp_f32 v77, v77 clamp
  v_exp_f32 v80, v80 clamp
  v_exp_f32 v81, v81 clamp
  v_pk_mul_f32 v[54:55], v[168:169], v[16:17]
  v_pk_mul_f32 v[58:59], v[170:171], v[18:19]
  v_pk_mul_f32 v[62:63], v[172:173], v[20:21]
  v_pk_mul_f32 v[66:67], v[174:175], v[22:23]
  v_pk_mul_f32 v[70:71], v[184:185], v[16:17]
  v_pk_mul_f32 v[74:75], v[186:187], v[18:19]
  v_pk_mul_f32 v[78:79], v[188:189], v[20:21]
  v_pk_mul_f32 v[82:83], v[190:191], v[22:23]
  v_pk_fma_f32 v[52:53], v[52:53], v[86:87], v[248:249]
  v_pk_fma_f32 v[56:57], v[56:57], v[86:87], v[248:249]
  v_pk_fma_f32 v[60:61], v[60:61], v[86:87], v[248:249]
  v_pk_fma_f32 v[64:65], v[64:65], v[86:87], v[248:249]
  v_pk_fma_f32 v[68:69], v[68:69], v[86:87], v[248:249]
  v_pk_fma_f32 v[72:73], v[72:73], v[86:87], v[248:249]
  v_pk_fma_f32 v[76:77], v[76:77], v[86:87], v[248:249]
  v_pk_fma_f32 v[80:81], v[80:81], v[86:87], v[248:249]
  v_pk_mul_f32 v[54:55], v[54:55], v[56:57]
  v_pk_mul_f32 v[62:63], v[62:63], v[64:65]
  v_pk_mul_f32 v[70:71], v[70:71], v[72:73]
  v_pk_mul_f32 v[78:79], v[78:79], v[80:81]
  v_pk_fma_f32 v[54:55], v[58:59], v[52:53], v[54:55]
  v_pk_fma_f32 v[62:63], v[66:67], v[60:61], v[62:63]
  v_pk_fma_f32 v[70:71], v[74:75], v[68:69], v[70:71]
  v_pk_fma_f32 v[78:79], v[82:83], v[76:77], v[78:79]
  v_pk_mul_f32 v[52:53], v[52:53], v[56:57]
  v_pk_mul_f32 v[60:61], v[60:61], v[64:65]
  v_pk_mul_f32 v[68:69], v[68:69], v[72:73]
  v_pk_mul_f32 v[76:77], v[76:77], v[80:81]
  v_pk_mul_f32 v[54:55], v[54:55], v[60:61]
  v_pk_mul_f32 v[70:71], v[70:71], v[76:77]
  v_pk_fma_f32 v[54:55], v[62:63], v[52:53], v[54:55]
  v_pk_fma_f32 v[70:71], v[78:79], v[68:69], v[70:71]
  v_pk_mul_f32 v[52:53], v[52:53], v[60:61]
  v_pk_mul_f32 v[68:69], v[68:69], v[76:77]
  v_rcp_f32 v52, v52
  v_rcp_f32 v53, v53
  v_rcp_f32 v68, v68
  v_rcp_f32 v69, v69
  v_pk_mul_f32 v[42:43], v[52:53], v[54:55]
  v_pk_mul_f32 v[44:45], v[68:69], v[70:71]
  v_pk_mul_f32 v[52:53], v[176:177], v[176:177]
  v_pk_mul_f32 v[56:57], v[178:179], v[178:179]
  v_pk_mul_f32 v[60:61], v[180:181], v[180:181]
  v_pk_mul_f32 v[64:65], v[182:183], v[182:183]
  v_pk_mul_f32 v[68:69], v[192:193], v[192:193]
  v_pk_mul_f32 v[72:73], v[194:195], v[194:195]
  v_pk_mul_f32 v[76:77], v[196:197], v[196:197]
  v_pk_mul_f32 v[80:81], v[198:199], v[198:199]
  v_pk_fma_f32 v[52:53], v[52:53], v[14:15], v[12:13]
  v_pk_fma_f32 v[56:57], v[56:57], v[14:15], v[12:13]
  v_pk_fma_f32 v[60:61], v[60:61], v[14:15], v[12:13]
  v_pk_fma_f32 v[64:65], v[64:65], v[14:15], v[12:13]
  v_pk_fma_f32 v[68:69], v[68:69], v[14:15], v[12:13]
  v_pk_fma_f32 v[72:73], v[72:73], v[14:15], v[12:13]
  v_pk_fma_f32 v[76:77], v[76:77], v[14:15], v[12:13]
  v_pk_fma_f32 v[80:81], v[80:81], v[14:15], v[12:13]
  v_pk_fma_f32 v[52:53], v[52:53], v[176:177], v[84:85]
  v_pk_fma_f32 v[56:57], v[56:57], v[178:179], v[84:85]
  v_pk_fma_f32 v[60:61], v[60:61], v[180:181], v[84:85]
  v_pk_fma_f32 v[64:65], v[64:65], v[182:183], v[84:85]
  v_pk_fma_f32 v[68:69], v[68:69], v[192:193], v[84:85]
  v_pk_fma_f32 v[72:73], v[72:73], v[194:195], v[84:85]
  v_pk_fma_f32 v[76:77], v[76:77], v[196:197], v[84:85]
  v_pk_fma_f32 v[80:81], v[80:81], v[198:199], v[84:85]
  v_exp_f32 v52, v52 clamp
  v_exp_f32 v53, v53 clamp
  v_exp_f32 v56, v56 clamp
  v_exp_f32 v57, v57 clamp
  v_exp_f32 v60, v60 clamp
  v_exp_f32 v61, v61 clamp
  v_exp_f32 v64, v64 clamp
  v_exp_f32 v65, v65 clamp
  v_exp_f32 v68, v68 clamp
  v_exp_f32 v69, v69 clamp
  v_exp_f32 v72, v72 clamp
  v_exp_f32 v73, v73 clamp
  v_exp_f32 v76, v76 clamp
  v_exp_f32 v77, v77 clamp
  v_exp_f32 v80, v80 clamp
  v_exp_f32 v81, v81 clamp
  v_pk_mul_f32 v[54:55], v[176:177], v[24:25]
  v_pk_mul_f32 v[58:59], v[178:179], v[26:27]
  v_pk_mul_f32 v[62:63], v[180:181], v[28:29]
  v_pk_mul_f32 v[66:67], v[182:183], v[30:31]
  v_pk_mul_f32 v[70:71], v[192:193], v[24:25]
  v_pk_mul_f32 v[74:75], v[194:195], v[26:27]
  v_pk_mul_f32 v[78:79], v[196:197], v[28:29]
  v_pk_mul_f32 v[82:83], v[198:199], v[30:31]
  v_pk_fma_f32 v[52:53], v[52:53], v[86:87], v[248:249]
  v_pk_fma_f32 v[56:57], v[56:57], v[86:87], v[248:249]
  v_pk_fma_f32 v[60:61], v[60:61], v[86:87], v[248:249]
  v_pk_fma_f32 v[64:65], v[64:65], v[86:87], v[248:249]
  v_pk_fma_f32 v[68:69], v[68:69], v[86:87], v[248:249]
  v_pk_fma_f32 v[72:73], v[72:73], v[86:87], v[248:249]
  v_pk_fma_f32 v[76:77], v[76:77], v[86:87], v[248:249]
  v_pk_fma_f32 v[80:81], v[80:81], v[86:87], v[248:249]
  v_pk_mul_f32 v[54:55], v[54:55], v[56:57]
  v_pk_mul_f32 v[62:63], v[62:63], v[64:65]
  v_pk_mul_f32 v[70:71], v[70:71], v[72:73]
  v_pk_mul_f32 v[78:79], v[78:79], v[80:81]
  v_pk_fma_f32 v[54:55], v[58:59], v[52:53], v[54:55]
  v_pk_fma_f32 v[62:63], v[66:67], v[60:61], v[62:63]
  v_pk_fma_f32 v[70:71], v[74:75], v[68:69], v[70:71]
  v_pk_fma_f32 v[78:79], v[82:83], v[76:77], v[78:79]
  v_pk_mul_f32 v[52:53], v[52:53], v[56:57]
  v_pk_mul_f32 v[60:61], v[60:61], v[64:65]
  v_pk_mul_f32 v[68:69], v[68:69], v[72:73]
  v_pk_mul_f32 v[76:77], v[76:77], v[80:81]
  v_pk_mul_f32 v[54:55], v[54:55], v[60:61]
  v_pk_mul_f32 v[70:71], v[70:71], v[76:77]
  v_pk_fma_f32 v[54:55], v[62:63], v[52:53], v[54:55]
  v_pk_fma_f32 v[70:71], v[78:79], v[68:69], v[70:71]
  v_pk_mul_f32 v[52:53], v[52:53], v[60:61]
  v_pk_mul_f32 v[68:69], v[68:69], v[76:77]
  v_rcp_f32 v52, v52
  v_rcp_f32 v53, v53
  v_rcp_f32 v68, v68
  v_rcp_f32 v69, v69
  v_pk_fma_f32 v[42:43], v[52:53], v[54:55], v[42:43]
  v_pk_fma_f32 v[44:45], v[68:69], v[70:71], v[44:45]
  v_pk_mul_f32 v[52:53], v[200:201], v[200:201]
  v_pk_mul_f32 v[56:57], v[202:203], v[202:203]
  v_pk_mul_f32 v[60:61], v[204:205], v[204:205]
  v_pk_mul_f32 v[64:65], v[206:207], v[206:207]
  v_pk_mul_f32 v[68:69], v[216:217], v[216:217]
  v_pk_mul_f32 v[72:73], v[218:219], v[218:219]
  v_pk_mul_f32 v[76:77], v[220:221], v[220:221]
  v_pk_mul_f32 v[80:81], v[222:223], v[222:223]
  v_pk_fma_f32 v[52:53], v[52:53], v[14:15], v[12:13]
  v_pk_fma_f32 v[56:57], v[56:57], v[14:15], v[12:13]
  v_pk_fma_f32 v[60:61], v[60:61], v[14:15], v[12:13]
  v_pk_fma_f32 v[64:65], v[64:65], v[14:15], v[12:13]
  v_pk_fma_f32 v[68:69], v[68:69], v[14:15], v[12:13]
  v_pk_fma_f32 v[72:73], v[72:73], v[14:15], v[12:13]
  v_pk_fma_f32 v[76:77], v[76:77], v[14:15], v[12:13]
  v_pk_fma_f32 v[80:81], v[80:81], v[14:15], v[12:13]
  v_pk_fma_f32 v[52:53], v[52:53], v[200:201], v[84:85]
  v_pk_fma_f32 v[56:57], v[56:57], v[202:203], v[84:85]
  v_pk_fma_f32 v[60:61], v[60:61], v[204:205], v[84:85]
  v_pk_fma_f32 v[64:65], v[64:65], v[206:207], v[84:85]
  v_pk_fma_f32 v[68:69], v[68:69], v[216:217], v[84:85]
  v_pk_fma_f32 v[72:73], v[72:73], v[218:219], v[84:85]
  v_pk_fma_f32 v[76:77], v[76:77], v[220:221], v[84:85]
  v_pk_fma_f32 v[80:81], v[80:81], v[222:223], v[84:85]
  v_exp_f32 v52, v52 clamp
  v_exp_f32 v53, v53 clamp
  v_exp_f32 v56, v56 clamp
  v_exp_f32 v57, v57 clamp
  v_exp_f32 v60, v60 clamp
  v_exp_f32 v61, v61 clamp
  v_exp_f32 v64, v64 clamp
  v_exp_f32 v65, v65 clamp
  v_exp_f32 v68, v68 clamp
  v_exp_f32 v69, v69 clamp
  v_exp_f32 v72, v72 clamp
  v_exp_f32 v73, v73 clamp
  v_exp_f32 v76, v76 clamp
  v_exp_f32 v77, v77 clamp
  v_exp_f32 v80, v80 clamp
  v_exp_f32 v81, v81 clamp
  v_pk_mul_f32 v[54:55], v[200:201], v[16:17]
  v_pk_mul_f32 v[58:59], v[202:203], v[18:19]
  v_pk_mul_f32 v[62:63], v[204:205], v[20:21]
  v_pk_mul_f32 v[66:67], v[206:207], v[22:23]
  v_pk_mul_f32 v[70:71], v[216:217], v[16:17]
  v_pk_mul_f32 v[74:75], v[218:219], v[18:19]
  v_pk_mul_f32 v[78:79], v[220:221], v[20:21]
  v_pk_mul_f32 v[82:83], v[222:223], v[22:23]
  v_pk_fma_f32 v[52:53], v[52:53], v[86:87], v[248:249]
  v_pk_fma_f32 v[56:57], v[56:57], v[86:87], v[248:249]
  v_pk_fma_f32 v[60:61], v[60:61], v[86:87], v[248:249]
  v_pk_fma_f32 v[64:65], v[64:65], v[86:87], v[248:249]
  v_pk_fma_f32 v[68:69], v[68:69], v[86:87], v[248:249]
  v_pk_fma_f32 v[72:73], v[72:73], v[86:87], v[248:249]
  v_pk_fma_f32 v[76:77], v[76:77], v[86:87], v[248:249]
  v_pk_fma_f32 v[80:81], v[80:81], v[86:87], v[248:249]
  v_pk_mul_f32 v[54:55], v[54:55], v[56:57]
  v_pk_mul_f32 v[62:63], v[62:63], v[64:65]
  v_pk_mul_f32 v[70:71], v[70:71], v[72:73]
  v_pk_mul_f32 v[78:79], v[78:79], v[80:81]
  v_pk_fma_f32 v[54:55], v[58:59], v[52:53], v[54:55]
  v_pk_fma_f32 v[62:63], v[66:67], v[60:61], v[62:63]
  v_pk_fma_f32 v[70:71], v[74:75], v[68:69], v[70:71]
  v_pk_fma_f32 v[78:79], v[82:83], v[76:77], v[78:79]
  v_pk_mul_f32 v[52:53], v[52:53], v[56:57]
  v_pk_mul_f32 v[60:61], v[60:61], v[64:65]
  v_pk_mul_f32 v[68:69], v[68:69], v[72:73]
  v_pk_mul_f32 v[76:77], v[76:77], v[80:81]
  v_pk_mul_f32 v[54:55], v[54:55], v[60:61]
  v_pk_mul_f32 v[70:71], v[70:71], v[76:77]
  v_pk_fma_f32 v[54:55], v[62:63], v[52:53], v[54:55]
  v_pk_fma_f32 v[70:71], v[78:79], v[68:69], v[70:71]
  v_pk_mul_f32 v[52:53], v[52:53], v[60:61]
  v_pk_mul_f32 v[68:69], v[68:69], v[76:77]
  v_rcp_f32 v52, v52
  v_rcp_f32 v53, v53
  v_rcp_f32 v68, v68
  v_rcp_f32 v69, v69
  v_pk_mul_f32 v[46:47], v[52:53], v[54:55]
  v_pk_mul_f32 v[48:49], v[68:69], v[70:71]
  v_pk_mul_f32 v[52:53], v[208:209], v[208:209]
  v_pk_mul_f32 v[56:57], v[210:211], v[210:211]
  v_pk_mul_f32 v[60:61], v[212:213], v[212:213]
  v_pk_mul_f32 v[64:65], v[214:215], v[214:215]
  v_pk_mul_f32 v[68:69], v[224:225], v[224:225]
  v_pk_mul_f32 v[72:73], v[226:227], v[226:227]
  v_pk_mul_f32 v[76:77], v[228:229], v[228:229]
  v_pk_mul_f32 v[80:81], v[230:231], v[230:231]
  v_pk_fma_f32 v[52:53], v[52:53], v[14:15], v[12:13]
  v_pk_fma_f32 v[56:57], v[56:57], v[14:15], v[12:13]
  v_pk_fma_f32 v[60:61], v[60:61], v[14:15], v[12:13]
  v_pk_fma_f32 v[64:65], v[64:65], v[14:15], v[12:13]
  v_pk_fma_f32 v[68:69], v[68:69], v[14:15], v[12:13]
  v_pk_fma_f32 v[72:73], v[72:73], v[14:15], v[12:13]
  v_pk_fma_f32 v[76:77], v[76:77], v[14:15], v[12:13]
  v_pk_fma_f32 v[80:81], v[80:81], v[14:15], v[12:13]
  v_pk_fma_f32 v[52:53], v[52:53], v[208:209], v[84:85]
  v_pk_fma_f32 v[56:57], v[56:57], v[210:211], v[84:85]
  v_pk_fma_f32 v[60:61], v[60:61], v[212:213], v[84:85]
  v_pk_fma_f32 v[64:65], v[64:65], v[214:215], v[84:85]
  v_pk_fma_f32 v[68:69], v[68:69], v[224:225], v[84:85]
  v_pk_fma_f32 v[72:73], v[72:73], v[226:227], v[84:85]
  v_pk_fma_f32 v[76:77], v[76:77], v[228:229], v[84:85]
  v_pk_fma_f32 v[80:81], v[80:81], v[230:231], v[84:85]
  v_exp_f32 v52, v52 clamp
  v_exp_f32 v53, v53 clamp
  v_exp_f32 v56, v56 clamp
  v_exp_f32 v57, v57 clamp
  v_exp_f32 v60, v60 clamp
  v_exp_f32 v61, v61 clamp
  v_exp_f32 v64, v64 clamp
  v_exp_f32 v65, v65 clamp
  v_exp_f32 v68, v68 clamp
  v_exp_f32 v69, v69 clamp
  v_exp_f32 v72, v72 clamp
  v_exp_f32 v73, v73 clamp
  v_exp_f32 v76, v76 clamp
  v_exp_f32 v77, v77 clamp
  v_exp_f32 v80, v80 clamp
  v_exp_f32 v81, v81 clamp
  v_pk_mul_f32 v[54:55], v[208:209], v[24:25]
  v_pk_mul_f32 v[58:59], v[210:211], v[26:27]
  v_pk_mul_f32 v[62:63], v[212:213], v[28:29]
  v_pk_mul_f32 v[66:67], v[214:215], v[30:31]
  v_pk_mul_f32 v[70:71], v[224:225], v[24:25]
  v_pk_mul_f32 v[74:75], v[226:227], v[26:27]
  v_pk_mul_f32 v[78:79], v[228:229], v[28:29]
  v_pk_mul_f32 v[82:83], v[230:231], v[30:31]
  v_pk_fma_f32 v[52:53], v[52:53], v[86:87], v[248:249]
  v_pk_fma_f32 v[56:57], v[56:57], v[86:87], v[248:249]
  v_pk_fma_f32 v[60:61], v[60:61], v[86:87], v[248:249]
  v_pk_fma_f32 v[64:65], v[64:65], v[86:87], v[248:249]
  v_pk_fma_f32 v[68:69], v[68:69], v[86:87], v[248:249]
  v_pk_fma_f32 v[72:73], v[72:73], v[86:87], v[248:249]
  v_pk_fma_f32 v[76:77], v[76:77], v[86:87], v[248:249]
  v_pk_fma_f32 v[80:81], v[80:81], v[86:87], v[248:249]
  v_pk_mul_f32 v[54:55], v[54:55], v[56:57]
  v_pk_mul_f32 v[62:63], v[62:63], v[64:65]
  v_pk_mul_f32 v[70:71], v[70:71], v[72:73]
  v_pk_mul_f32 v[78:79], v[78:79], v[80:81]
  v_pk_fma_f32 v[54:55], v[58:59], v[52:53], v[54:55]
  v_pk_fma_f32 v[62:63], v[66:67], v[60:61], v[62:63]
  v_pk_fma_f32 v[70:71], v[74:75], v[68:69], v[70:71]
  v_pk_fma_f32 v[78:79], v[82:83], v[76:77], v[78:79]
  v_pk_mul_f32 v[52:53], v[52:53], v[56:57]
  v_pk_mul_f32 v[60:61], v[60:61], v[64:65]
  v_pk_mul_f32 v[68:69], v[68:69], v[72:73]
  v_pk_mul_f32 v[76:77], v[76:77], v[80:81]
  v_pk_mul_f32 v[54:55], v[54:55], v[60:61]
  v_pk_mul_f32 v[70:71], v[70:71], v[76:77]
  v_pk_fma_f32 v[54:55], v[62:63], v[52:53], v[54:55]
  v_pk_fma_f32 v[70:71], v[78:79], v[68:69], v[70:71]
  v_pk_mul_f32 v[52:53], v[52:53], v[60:61]
  v_pk_mul_f32 v[68:69], v[68:69], v[76:77]
  v_rcp_f32 v52, v52
  v_rcp_f32 v53, v53
  v_rcp_f32 v68, v68
  v_rcp_f32 v69, v69
  v_pk_fma_f32 v[46:47], v[52:53], v[54:55], v[46:47]
  v_pk_fma_f32 v[48:49], v[68:69], v[70:71], v[48:49]
  v_pk_mul_f32 v[52:53], v[232:233], v[232:233]
  v_pk_mul_f32 v[56:57], v[234:235], v[234:235]
  v_pk_mul_f32 v[60:61], v[236:237], v[236:237]
  v_pk_mul_f32 v[64:65], v[238:239], v[238:239]
  v_pk_mul_f32 v[68:69], v[240:241], v[240:241]
  v_pk_mul_f32 v[72:73], v[242:243], v[242:243]
  v_pk_mul_f32 v[76:77], v[244:245], v[244:245]
  v_pk_mul_f32 v[80:81], v[246:247], v[246:247]
  v_pk_fma_f32 v[52:53], v[52:53], v[14:15], v[12:13]
  v_pk_fma_f32 v[56:57], v[56:57], v[14:15], v[12:13]
  v_pk_fma_f32 v[60:61], v[60:61], v[14:15], v[12:13]
  v_pk_fma_f32 v[64:65], v[64:65], v[14:15], v[12:13]
  v_pk_fma_f32 v[68:69], v[68:69], v[14:15], v[12:13]
  v_pk_fma_f32 v[72:73], v[72:73], v[14:15], v[12:13]
  v_pk_fma_f32 v[76:77], v[76:77], v[14:15], v[12:13]
  v_pk_fma_f32 v[80:81], v[80:81], v[14:15], v[12:13]
  v_pk_fma_f32 v[52:53], v[52:53], v[232:233], v[84:85]
  v_pk_fma_f32 v[56:57], v[56:57], v[234:235], v[84:85]
  v_pk_fma_f32 v[60:61], v[60:61], v[236:237], v[84:85]
  v_pk_fma_f32 v[64:65], v[64:65], v[238:239], v[84:85]
  v_pk_fma_f32 v[68:69], v[68:69], v[240:241], v[84:85]
  v_pk_fma_f32 v[72:73], v[72:73], v[242:243], v[84:85]
  v_pk_fma_f32 v[76:77], v[76:77], v[244:245], v[84:85]
  v_pk_fma_f32 v[80:81], v[80:81], v[246:247], v[84:85]
  v_exp_f32 v52, v52 clamp
  v_exp_f32 v53, v53 clamp
  v_exp_f32 v56, v56 clamp
  v_exp_f32 v57, v57 clamp
  v_exp_f32 v60, v60 clamp
  v_exp_f32 v61, v61 clamp
  v_exp_f32 v64, v64 clamp
  v_exp_f32 v65, v65 clamp
  v_exp_f32 v68, v68 clamp
  v_exp_f32 v69, v69 clamp
  v_exp_f32 v72, v72 clamp
  v_exp_f32 v73, v73 clamp
  v_exp_f32 v76, v76 clamp
  v_exp_f32 v77, v77 clamp
  v_exp_f32 v80, v80 clamp
  v_exp_f32 v81, v81 clamp
  v_pk_mul_f32 v[54:55], v[232:233], v[16:17]
  v_pk_mul_f32 v[58:59], v[234:235], v[18:19]
  v_pk_mul_f32 v[62:63], v[236:237], v[20:21]
  v_pk_mul_f32 v[66:67], v[238:239], v[22:23]
  v_pk_mul_f32 v[70:71], v[240:241], v[24:25]
  v_pk_mul_f32 v[74:75], v[242:243], v[26:27]
  v_pk_mul_f32 v[78:79], v[244:245], v[28:29]
  v_pk_mul_f32 v[82:83], v[246:247], v[30:31]
  v_pk_fma_f32 v[52:53], v[52:53], v[86:87], v[248:249]
  v_pk_fma_f32 v[56:57], v[56:57], v[86:87], v[248:249]
  v_pk_fma_f32 v[60:61], v[60:61], v[86:87], v[248:249]
  v_pk_fma_f32 v[64:65], v[64:65], v[86:87], v[248:249]
  v_pk_fma_f32 v[68:69], v[68:69], v[86:87], v[248:249]
  v_pk_fma_f32 v[72:73], v[72:73], v[86:87], v[248:249]
  v_pk_fma_f32 v[76:77], v[76:77], v[86:87], v[248:249]
  v_pk_fma_f32 v[80:81], v[80:81], v[86:87], v[248:249]
  v_pk_mul_f32 v[54:55], v[54:55], v[56:57]
  v_pk_mul_f32 v[62:63], v[62:63], v[64:65]
  v_pk_mul_f32 v[70:71], v[70:71], v[72:73]
  v_pk_mul_f32 v[78:79], v[78:79], v[80:81]
  v_pk_fma_f32 v[54:55], v[58:59], v[52:53], v[54:55]
  v_pk_fma_f32 v[62:63], v[66:67], v[60:61], v[62:63]
  v_pk_fma_f32 v[70:71], v[74:75], v[68:69], v[70:71]
  v_pk_fma_f32 v[78:79], v[82:83], v[76:77], v[78:79]
  v_pk_mul_f32 v[52:53], v[52:53], v[56:57]
  v_pk_mul_f32 v[60:61], v[60:61], v[64:65]
  v_pk_mul_f32 v[68:69], v[68:69], v[72:73]
  v_pk_mul_f32 v[76:77], v[76:77], v[80:81]
  v_pk_mul_f32 v[54:55], v[54:55], v[60:61]
  v_pk_mul_f32 v[70:71], v[70:71], v[76:77]
  v_pk_fma_f32 v[54:55], v[62:63], v[52:53], v[54:55]
  v_pk_fma_f32 v[70:71], v[78:79], v[68:69], v[70:71]
  v_pk_mul_f32 v[52:53], v[52:53], v[60:61]
  v_pk_mul_f32 v[68:69], v[68:69], v[76:77]
  v_rcp_f32 v52, v52
  v_rcp_f32 v53, v53
  v_rcp_f32 v68, v68
  v_rcp_f32 v69, v69
  v_pk_mul_f32 v[50:51], v[52:53], v[54:55]
  v_pk_fma_f32 v[50:51], v[68:69], v[70:71], v[50:51]
  v_pk_mul_f32 v[32:33], v[88:89], v[16:17]
  v_pk_fma_f32 v[32:33], v[90:91], v[18:19], v[32:33]
  v_pk_fma_f32 v[32:33], v[92:93], v[20:21], v[32:33]
  v_pk_fma_f32 v[32:33], v[94:95], v[22:23], v[32:33]
  v_pk_fma_f32 v[32:33], v[96:97], v[24:25], v[32:33]
  v_pk_fma_f32 v[32:33], v[98:99], v[26:27], v[32:33]
  v_pk_fma_f32 v[32:33], v[100:101], v[28:29], v[32:33]
  v_pk_fma_f32 v[32:33], v[102:103], v[30:31], v[32:33]
  v_add_f32 v32, v32, v33
  v_add_f32 v34, v34, v35
  v_add_f32 v36, v36, v37
  v_add_f32 v38, v38, v39
  v_add_f32 v40, v40, v41
  v_add_f32 v42, v42, v43
  v_add_f32 v44, v44, v45
  v_add_f32 v46, v46, v47
  v_add_f32 v48, v48, v49
  v_add_f32 v50, v50, v51
  v_permlane32_swap_b32 v32, v34
  v_permlane32_swap_b32 v36, v38
  v_permlane32_swap_b32 v40, v42
  v_permlane32_swap_b32 v44, v46
  v_permlane32_swap_b32 v48, v50
  v_add_f32 v48, v48, v50
  v_add_f32 v32, v32, v34
  v_add_f32 v36, v36, v38
  v_add_f32 v40, v40, v42
  v_add_f32 v44, v44, v46
  v_mov_b32 v50, v48
  v_permlane16_swap_b32 v32, v36
  v_permlane16_swap_b32 v40, v44
  v_permlane16_swap_b32 v48, v50
  v_add_f32 v32, v32, v36
  v_add_f32 v40, v40, v44
  v_add_f32 v48, v48, v50
  ds_write_b32 v10, v32
  ds_write_b32 v10, v40 offset:256
  s_mov_b32 exec_lo, 0xffff
  s_mov_b32 exec_hi, 0xffff
  ds_write_b32 v10, v48 offset:512
  s_mov_b64 exec, -1
  s_waitcnt lgkmcnt(0)
  s_barrier
  s_endpgm
L_ld_tail:
  s_barrier
  s_mov_b32 s60, s24
  s_and_b32 s61, s25, 0xffff
  s_mov_b32 s62, 268435456
  s_mov_b32 s63, 0x20000
  s_mov_b32 s56, s20
  s_and_b32 s57, s21, 0xffff
  s_mov_b32 s58, 8192
  s_mov_b32 s59, 0x20000
  s_mov_b32 s64, s22
  s_and_b32 s65, s23, 0xffff
  s_mov_b32 s66, 256
  s_mov_b32 s67, 0x20000
  s_load_dword s80, s[18:19], 0
  v_mov_b32_e64 v100, 0
  s_mov_b64 exec, 1
  s_mov_b32 s81, 0x80000
  buffer_load_dword v101, v100, s[60:63], s81 offen
  buffer_load_dword v102, v100, s[56:59], 0 offen
  s_mov_b64 exec, -1
  s_mov_b64 exec, 1
  buffer_load_dword v250, v100, s[64:67], 0 offen offset:240 sc1
  s_mov_b64 exec, -1
  s_cmp_lg_u32 s3, 4
  s_cbranch_scc1 L_end
  v_lshlrev_b32 v3, 4, v0
  v_lshlrev_b32_e64 v4, 2, v0
  v_add_u32 v1, 123392, v3
  v_add_u32 v2, 124416, v4
  v_add_u32 v4, 1024, v4
  v_mov_b32 v5, 32
  v_mov_b32 v7, s26
  s_mul_i32 s68, s26, 1280
  s_mul_i32 s69, s27, 16640
  s_add_u32 s69, s69, s68
  s_setprio 3
  v_mov_b32 v64, -1
  v_mov_b32 v65, -1
  v_mov_b32 v66, -1
  v_mov_b32 v67, -1
  buffer_store_dwordx4 v[64:67], v3, s[60:63], s69 offen sc1
  buffer_store_dword v64, v4, s[60:63], s69 offen sc1
  s_waitcnt vmcnt(0)
  s_barrier
  ds_read_b128 v[64:67], v1
  ds_read_b128 v[72:75], v1 offset:1280
  ds_read2st64_b32 v[68:69], v2 offset0:0 offset1:5
  s_waitcnt lgkmcnt(0)
  v_pk_add_f32 v[64:65], v[64:65], v[72:73]
  v_pk_add_f32 v[66:67], v[66:67], v[74:75]
  v_add_f32 v68, v68, v69
  v_min_u32 v64, -2, v64
  v_min_u32 v65, -2, v65
  v_min_u32 v66, -2, v66
  v_min_u32 v67, -2, v67
  v_min_u32 v68, -2, v68
  buffer_store_dwordx4 v[64:67], v3, s[60:63], s69 offen sc1
  buffer_store_dword v68, v4, s[60:63], s69 offen sc1
  s_mov_b64 exec, 1
L_pub:
  v_lshlrev_b32 v6, 4, v7
  v_mov_b32 v13, v5
  buffer_atomic_add v5, v6, s[64:67], 0 offen sc0
  v_cmp_eq_u32 vcc, 12, v7
  v_mov_b32 v8, 436
  v_mov_b32 v9, 434
  v_cndmask_b32 v8, v8, v9, vcc
  v_sub_u32 v8, v8, v13
  s_waitcnt vmcnt(0) lgkmcnt(0)
  v_cmp_eq_u32 s[82:83], v5, v8
  s_mov_b64 exec, -1
  s_lshl_b32 s80, s80, 16
  v_lshrrev_b32 v1, 1, v3
  v_lshrrev_b32 v2, 1, v4
L_fin:
  s_cmp_eq_u32 s82, 0
  s_cbranch_scc1 L_done
  s_ff1_i32_b32 s70, s82
  s_bitset0_b32 s82, s70
  v_readlane_b32 s71, v7, s70
  s_waitcnt vmcnt(0)
L_again:
  s_mul_i32 s68, s71, 1280
  buffer_load_dwordx4 v[64:67], v3, s[60:63], s68 offen sc1
  buffer_load_dword v68, v4, s[60:63], s68 offen sc1
  s_add_u32 s68, s68, 16640
  buffer_load_dwordx4 v[72:75], v3, s[60:63], s68 offen sc1
  buffer_load_dword v76, v4, s[60:63], s68 offen sc1
  s_add_u32 s68, s68, 16640
  buffer_load_dwordx4 v[80:83], v3, s[60:63], s68 offen sc1
  buffer_load_dword v84, v4, s[60:63], s68 offen sc1
  s_add_u32 s68, s68, 16640
  buffer_load_dwordx4 v[88:91], v3, s[60:63], s68 offen sc1
  buffer_load_dword v92, v4, s[60:63], s68 offen sc1
  s_add_u32 s68, s68, 16640
  buffer_load_dwordx4 v[96:99], v3, s[60:63], s68 offen sc1
  buffer_load_dword v100, v4, s[60:63], s68 offen sc1
  s_add_u32 s68, s68, 16640
  buffer_load_dwordx4 v[104:107], v3, s[60:63], s68 offen sc1
  buffer_load_dword v108, v4, s[60:63], s68 offen sc1
  s_add_u32 s68, s68, 16640
  buffer_load_dwordx4 v[112:115], v3, s[60:63], s68 offen sc1
  buffer_load_dword v116, v4, s[60:63], s68 offen sc1
  s_add_u32 s68, s68, 16640
  buffer_load_dwordx4 v[120:123], v3, s[60:63], s68 offen sc1
  buffer_load_dword v124, v4, s[60:63], s68 offen sc1
  s_add_u32 s68, s68, 16640
  buffer_load_dwordx4 v[128:131], v3, s[60:63], s68 offen sc1
  buffer_load_dword v132, v4, s[60:63], s68 offen sc1
  s_add_u32 s68, s68, 16640
  buffer_load_dwordx4 v[136:139], v3, s[60:63], s68 offen sc1
  buffer_load_dword v140, v4, s[60:63], s68 offen sc1
  s_add_u32 s68, s68, 16640
  buffer_load_dwordx4 v[144:147], v3, s[60:63], s68 offen sc1
  buffer_load_dword v148, v4, s[60:63], s68 offen sc1
  s_add_u32 s68, s68, 16640
  buffer_load_dwordx4 v[152:155], v3, s[60:63], s68 offen sc1
  buffer_load_dword v156, v4, s[60:63], s68 offen sc1
  s_add_u32 s68, s68, 16640
  buffer_load_dwordx4 v[160:163], v3, s[60:63], s68 offen sc1
  buffer_load_dword v164, v4, s[60:63], s68 offen sc1
  s_add_u32 s68, s68, 16640
  buffer_load_dwordx4 v[168:171], v3, s[60:63], s68 offen sc1
  buffer_load_dword v172, v4, s[60:63], s68 offen sc1
  s_add_u32 s68, s68, 16640
L_sum:
  s_waitcnt vmcnt(25)
  v_pk_add_f32 v[56:57], v[64:65], v[72:73]
  v_pk_add_f32 v[58:59], v[66:67], v[74:75]
  s_waitcnt vmcnt(24)
  v_add_f32 v60, v68, v76
  s_waitcnt vmcnt(23)
  v_pk_add_f32 v[56:57], v[56:57], v[80:81]
  v_pk_add_f32 v[58:59], v[58:59], v[82:83]
  s_waitcnt vmcnt(22)
  v_add_f32 v60, v60, v84
  s_waitcnt vmcnt(21)
  v_pk_add_f32 v[56:57], v[56:57], v[88:89]
  v_pk_add_f32 v[58:59], v[58:59], v[90:91]
  s_waitcnt vmcnt(20)
  v_add_f32 v60, v60, v92
  s_waitcnt vmcnt(19)
  v_pk_add_f32 v[56:57], v[56:57], v[96:97]
  v_pk_add_f32 v[58:59], v[58:59], v[98:99]
  s_waitcnt vmcnt(18)
  v_add_f32 v60, v60, v100
  s_waitcnt vmcnt(17)
  v_pk_add_f32 v[56:57], v[56:57], v[104:105]
  v_pk_add_f32 v[58:59], v[58:59], v[106:107]
  s_waitcnt vmcnt(16)
  v_add_f32_e64 v60, v60, v108
  s_waitcnt vmcnt(15)
  v_pk_add_f32 v[56:57], v[56:57], v[112:113]
  v_pk_add_f32 v[58:59], v[58:59], v[114:115]
  s_waitcnt vmcnt(14)
  v_add_f32 v60, v60, v116
  s_waitcnt vmcnt(13)
  v_pk_add_f32 v[56:57], v[56:57], v[120:121]
  v_pk_add_f32 v[58:59], v[58:59], v[122:123]
  s_waitcnt vmcnt(12)
  v_add_f32 v60, v60, v124
  s_waitcnt vmcnt(11)
  v_pk_add_f32 v[56:57], v[56:57], v[128:129]
  v_pk_add_f32 v[58:59], v[58:59], v[130:131]
  s_waitcnt vmcnt(10)
  v_add_f32 v60, v60, v132
  s_waitcnt vmcnt(9)
  v_pk_add_f32 v[56:57], v[56:57], v[136:137]
  v_pk_add_f32 v[58:59], v[58:59], v[138:139]
  s_waitcnt vmcnt(8)
  v_add_f32 v60, v60, v140
  s_waitcnt vmcnt(7)
  v_pk_add_f32 v[56:57], v[56:57], v[144:145]
  v_pk_add_f32 v[58:59], v[58:59], v[146:147]
  s_waitcnt vmcnt(6)
  v_add_f32 v60, v60, v148
  s_waitcnt vmcnt(5)
  v_pk_add_f32 v[56:57], v[56:57], v[152:153]
  v_pk_add_f32 v[58:59], v[58:59], v[154:155]
  s_waitcnt vmcnt(4)
  v_add_f32 v60, v60, v156
  s_waitcnt vmcnt(3)
  v_pk_add_f32 v[56:57], v[56:57], v[160:161]
  v_pk_add_f32 v[58:59], v[58:59], v[162:163]
  s_waitcnt vmcnt(2)
  v_add_f32 v60, v60, v164
  s_waitcnt vmcnt(1)
  v_pk_add_f32 v[56:57], v[56:57], v[168:169]
  v_pk_add_f32 v[58:59], v[58:59], v[170:171]
  s_waitcnt vmcnt(0)
  v_add_f32 v60, v60, v172
  v_cmp_u_f32 vcc, v56, v57
  v_cmp_u_f32 s[92:93], v58, v59
  s_nop 0
  s_or_b64 s[92:93], s[92:93], vcc
  v_cmp_u_f32 vcc, v60, v60
  s_nop 0
  s_or_b64 vcc, s[92:93], vcc
  s_cbranch_vccnz L_chk
L_ok:
  s_mul_i32 s71, s71, 640
  v_add_f32 v56, s80, v56
  v_add_f32 v57, s80, v57
  v_add_f32 v58, s80, v58
  v_add_f32 v59, s80, v59
  v_add_f32_e64 v60, s80, v60
  v_cvt_pk_bf16_f32 v10, v56, v57
  v_cvt_pk_bf16_f32 v11, v58, v59
  v_cvt_pk_bf16_f32 v12, v60, v60
  buffer_store_dwordx2 v[10:11], v1, s[56:59], s71 offen
  buffer_store_short v12, v2, s[56:59], s71 offen
  s_branch L_fin
L_chk:
  v_mov_b32 v14, 0
  v_mov_b32 v15, 0
  v_max3_u32 v14, v14, v64, v65
  v_max3_u32 v14, v14, v66, v67
  v_max_u32 v15, v15, v68
  v_max3_u32 v14, v14, v72, v73
  v_max3_u32 v14, v14, v74, v75
  v_max_u32_e64 v15, v15, v76
  v_max3_u32 v14, v14, v80, v81
  v_max3_u32 v14, v14, v82, v83
  v_max_u32 v15, v15, v84
  v_max3_u32 v14, v14, v88, v89
  v_max3_u32 v14, v14, v90, v91
  v_max_u32 v15, v15, v92
  v_max3_u32 v14, v14, v96, v97
  v_max3_u32 v14, v14, v98, v99
  v_max_u32_e64 v15, v15, v100
  v_max3_u32 v14, v14, v104, v105
  v_max3_u32 v14, v14, v106, v107
  v_max_u32 v15, v15, v108
  v_max3_u32 v14, v14, v112, v113
  v_max3_u32 v14, v14, v114, v115
  v_max_u32 v15, v15, v116
  v_max3_u32 v14, v14, v120, v121
  v_max3_u32 v14, v14, v122, v123
  v_max_u32_e64 v15, v15, v124
  v_max3_u32 v14, v14, v128, v129
  v_max3_u32 v14, v14, v130, v131
  v_max_u32 v15, v15, v132
  v_max3_u32 v14, v14, v136, v137
  v_max3_u32 v14, v14, v138, v139
  v_max_u32 v15, v15, v140
  v_max3_u32 v14, v14, v144, v145
  v_max3_u32 v14, v14, v146, v147
  v_max_u32_e64 v15, v15, v148
  v_max3_u32 v14, v14, v152, v153
  v_max3_u32 v14, v14, v154, v155
  v_max_u32 v15, v15, v156
  v_max3_u32 v14, v14, v160, v161
  v_max3_u32 v14, v14, v162, v163
  v_max_u32 v15, v15, v164
  v_max3_u32 v14, v14, v168, v169
  v_max3_u32 v14, v14, v170, v171
  v_max_u32 v15, v15, v172
  s_cmp_eq_u32 s71, 12
  s_cselect_b32 s68, 0, -1
  v_and_b32 v15, s68, v15
  v_max_u32 v14, v14, v15
  v_cmp_eq_u32 vcc, -1, v14
  s_cbranch_vccnz L_again
  s_branch L_ok
L_done:
  s_endpgm
L_cin_done:
  s_mul_i32 s98, s3, 1536
  s_add_u32 s98, s98, 116736
  v_lshlrev_b32 v120, 5, v0
  v_add_u32_e64 v120, s98, v120
  ds_read_b128 v[60:63], v120
  ds_read_b128 v[64:67], v120 offset:16
  v_mul_f32 v116, v184, v192
  v_mul_f32 v117, v185, v193
  v_mul_f32 v118, v186, v194
  v_mul_f32 v119, v187, v195
  v_fmac_f32 v116, v188, v191
  v_fmac_f32 v117, v200, v208
  v_fmac_f32 v118, v201, v209
  v_fmac_f32 v119, v202, v210
  v_fmac_f32 v116, v203, v211
  v_fmac_f32 v117, v204, v207
  v_fmac_f32 v118, v216, v224
  v_fmac_f32 v119, v217, v225
  v_fmac_f32 v116, v218, v226
  v_fmac_f32 v117, v219, v227
  v_fmac_f32 v118, v220, v223
  v_fmac_f32 v119, v232, v240
  v_fmac_f32 v116, v233, v241
  v_fmac_f32 v117, v234, v242
  v_fmac_f32 v118, v235, v243
  v_fmac_f32 v119, v236, v239
  v_fmac_f32 v116, v189, v196
  v_fmac_f32 v117, v189, v197
  v_fmac_f32 v118, v190, v198
  v_fmac_f32 v119, v190, v199
  v_fmac_f32 v116, v205, v212
  v_fmac_f32 v117, v205, v213
  v_fmac_f32 v118, v206, v214
  v_fmac_f32 v119, v206, v215
  v_fmac_f32 v116, v221, v228
  v_fmac_f32 v117, v221, v229
  v_fmac_f32 v118, v222, v230
  v_fmac_f32 v119, v222, v231
  v_fmac_f32 v116, v237, v244
  v_fmac_f32 v117, v237, v245
  v_fmac_f32 v118, v238, v246
  v_fmac_f32 v119, v238, v247
  v_add_f32 v116, v116, v117
  v_add_f32 v118, v118, v119
  v_add_f32 v116, v116, v118
  v_mul_f32 v116, s74, v116
  v_mul_f32 v116, s75, v116
  s_nop 1
  v_add_f32_dpp v116, v116, v116 row_shr:1 row_mask:0xf bank_mask:0xf
  v_subrev_u32 v122, s98, v7
  v_lshrrev_b32 v122, 8, v122
  v_lshrrev_b32 v121, 3, v0
  v_add_f32_dpp v116, v116, v116 row_shr:2 row_mask:0xf bank_mask:0xf
  v_cmp_gt_u32 vcc, v122, v121
  v_min_u32 v121, v121, v122
  v_lshlrev_b32 v121, 4, v121
  v_add_f32_dpp v116, v116, v116 row_shr:4 row_mask:0xf bank_mask:0xf
  v_add_u32 v121, s85, v121
  s_waitcnt lgkmcnt(1)
  v_add_f32 v60, v60, v61
  v_add_f32 v62, v62, v63
  v_add_f32_dpp v116, v116, v116 row_shr:8 row_mask:0xf bank_mask:0xf
  s_waitcnt lgkmcnt(0)
  v_add_f32 v64, v64, v65
  v_add_f32 v66, v66, v67
  v_add_f32 v60, v60, v62
  v_add_f32_dpp v116, v116, v116 row_bcast:15 row_mask:0xa bank_mask:0xf
  v_add_f32 v64, v64, v66
  v_add_f32_e64 v60, v60, v64
  s_nop 1
  v_add_f32_dpp v60, v60, v60 quad_perm:[1,0,3,2] row_mask:0xf bank_mask:0xf
  v_add_f32_dpp v116, v116, v116 row_bcast:31 row_mask:0xc bank_mask:0xf
  s_nop 0
  v_add_f32_dpp v60, v60, v60 quad_perm:[2,3,0,1] row_mask:0xf bank_mask:0xf
  s_nop 1
  v_add_f32_dpp v60, v60, v60 row_half_mirror row_mask:0xf bank_mask:0xf
  v_cndmask_b32 v60, v116, v60, vcc
  s_bitset1_b32 vcc_hi, 31
  s_mov_b64 exec, vcc
  ds_write_b32 v121, v60
  s_mov_b64 exec, -1
  s_cmp_eq_u32 s3, 0
  s_cbranch_scc1 L_cpub
  s_waitcnt lgkmcnt(0)
  s_barrier
  s_endpgm
L_cpub:
  s_load_dword s80, s[18:19], 0
  s_mov_b32 s60, s24
  s_and_b32 s61, s25, 0xffff
  s_mov_b32 s62, 268435456
  s_mov_b32 s63, 0x20000
  s_mov_b32 s56, s20
  s_and_b32 s57, s21, 0xffff
  s_mov_b32 s58, 8192
  s_mov_b32 s59, 0x20000
  s_mov_b32 s64, s22
  s_and_b32 s65, s23, 0xffff
  s_mov_b32 s66, 256
  s_mov_b32 s67, 0x20000
  v_lshlrev_b32 v6, 2, v0
  v_add_u32 v2, 129728, v6
  v_add_u32 v4, 1024, v6
  s_mul_i32 s69, s26, 192
  s_add_u32 s69, s69, 216320
  v_mov_b32 v13, -1
  s_mov_b32 exec_hi, 0xffff
  buffer_store_dword v13, v6, s[60:63], s69 offen sc1
  s_mov_b64 exec, 1
  buffer_load_dword v250, v6, s[56:59], 0 offen
  buffer_load_dword v251, v6, s[64:67], 0 offen offset:240 sc1
  s_mov_b64 exec, -1
  s_mul_i32 s68, s26, 3
  s_mul_i32 s70, s68, 3277
  s_lshr_b32 s70, s70, 16
  v_add_u32 v7, s70, v0
  s_mul_i32 s70, s70, 20
  s_add_u32 s70, s70, 20
  s_sub_u32 s70, s70, s68
  s_min_u32 s70, s70, 3
  s_sub_u32 s68, 3, s70
  v_mov_b32 v5, s68
  v_writelane_b32 v5, s70, 0
  s_cmp_eq_u32 s68, 0
  s_cselect_b32 s68, 1, 3
  v_lshlrev_b32 v3, 4, v0
  s_mov_b32 exec_hi, 0xffff
  s_waitcnt vmcnt(0) lgkmcnt(0)
  s_barrier
  ds_read_b32 v64, v2
  s_waitcnt lgkmcnt(0)
  v_min_u32 v64, -2, v64
  buffer_store_dword v64, v6, s[60:63], s69 offen sc1
  s_mov_b32 exec_lo, s68
  s_mov_b32 exec_hi, 0
  s_branch L_pub
L_dnn_loop1:
  s_barrier
L_ld_in:
  s_add_u32 m0, s75, 131072
  s_nop 0
  buffer_load_dwordx4 v4, s[44:47], s74 offen lds
  s_add_u32 m0, s75, 132096
  s_nop 0
  buffer_load_dwordx4 v5, s[44:47], s74 offen lds
  s_add_u32 s74, s74, 106496
  s_add_u32 m0, s75, 139264
  s_nop 0
  buffer_load_dwordx4 v4, s[44:47], s74 offen lds
  s_add_u32 m0, s75, 140288
  s_nop 0
  buffer_load_dwordx4 v5, s[44:47], s74 offen lds
  s_add_u32 s74, s74, 106496
  s_add_u32 m0, s76, 0
  s_nop 0
  buffer_load_dwordx4 v56, s[32:35], 0 offen lds
  s_add_u32 m0, s76, 2048
  v_add_u32_dpp v56, v16, v2 row_newbcast:1 row_mask:0xf bank_mask:0x3
  buffer_load_dwordx4 v57, s[32:35], 0 offen lds
  s_nop 0
  v_add_u32_dpp v56, v18, v2 row_newbcast:7 row_mask:0xf bank_mask:0xc
  s_add_u32 m0, s76, 4096
  v_add_u32_dpp v57, v20, v2 row_newbcast:1 row_mask:0xf bank_mask:0x3
  buffer_load_dwordx4 v58, s[32:35], 0 offen lds
  s_nop 0
  v_add_u32_dpp v57, v22, v2 row_newbcast:7 row_mask:0xf bank_mask:0xc
  s_add_u32 m0, s76, 6144
  v_add_u32_dpp v58, v24, v2 row_newbcast:1 row_mask:0xf bank_mask:0x3
  buffer_load_dwordx4 v59, s[32:35], 0 offen lds
  s_nop 0
  v_add_u32_dpp v58, v26, v2 row_newbcast:7 row_mask:0xf bank_mask:0xc
  s_add_u32 m0, s76, 8192
  v_add_u32_dpp v59, v28, v2 row_newbcast:1 row_mask:0xf bank_mask:0x3
  buffer_load_dwordx4 v60, s[32:35], 0 offen lds
  s_nop 0
  v_add_u32_dpp v59, v30, v2 row_newbcast:7 row_mask:0xf bank_mask:0xc
  s_add_u32 m0, s76, 10240
  v_add_u32_dpp v60, v32, v2 row_newbcast:1 row_mask:0xf bank_mask:0x3
  buffer_load_dwordx4 v61, s[32:35], 0 offen lds
  s_nop 0
  v_add_u32_dpp v60, v34, v2 row_newbcast:7 row_mask:0xf bank_mask:0xc
  s_add_u32 m0, s76, 12288
  v_add_u32_dpp v61, v36, v2 row_newbcast:1 row_mask:0xf bank_mask:0x3
  buffer_load_dwordx4 v62, s[32:35], 0 offen lds
  s_nop 0
  v_add_u32_dpp v61, v38, v2 row_newbcast:7 row_mask:0xf bank_mask:0xc
  s_add_u32 m0, s76, 14336
  v_add_u32_dpp v62, v40, v2 row_newbcast:1 row_mask:0xf bank_mask:0x3
  buffer_load_dwordx4 v63, s[32:35], 0 offen lds
  s_nop 0
  v_add_u32_dpp v62, v42, v2 row_newbcast:7 row_mask:0xf bank_mask:0xc
  s_add_u32 m0, s76, 16384
  v_add_u32_dpp v63, v44, v2 row_newbcast:1 row_mask:0xf bank_mask:0x3
  buffer_load_dwordx4 v64, s[32:35], 0 offen lds
  s_nop 0
  v_add_u32_dpp v63, v46, v2 row_newbcast:7 row_mask:0xf bank_mask:0xc
  s_add_u32 m0, s76, 18432
  v_add_u32_dpp v64, v48, v2 row_newbcast:1 row_mask:0xf bank_mask:0x3
  buffer_load_dwordx4 v65, s[32:35], 0 offen lds
  s_nop 0
  v_add_u32_dpp v64, v50, v2 row_newbcast:7 row_mask:0xf bank_mask:0xc
  v_add_u32_dpp v65, v52, v2 row_newbcast:1 row_mask:0xf bank_mask:0x3
  s_nop 1
  v_add_u32_dpp v65, v54, v2 row_newbcast:7 row_mask:0xf bank_mask:0xc
  s_waitcnt vmcnt(10)
  s_barrier
  s_add_u32 m0, s75, 147456
  s_nop 0
  buffer_load_dwordx4 v4, s[44:47], s74 offen lds
  s_add_u32 m0, s75, 148480
  s_nop 0
  buffer_load_dwordx4 v5, s[44:47], s74 offen lds
  s_add_u32 s74, s74, 106496
  s_add_u32 m0, s75, 155648
  s_nop 0
  buffer_load_dwordx4 v4, s[44:47], s74 offen lds
  s_add_u32 m0, s75, 156672
  s_nop 0
  buffer_load_dwordx4 v5, s[44:47], s74 offen lds
  s_add_u32 s74, s74, 106496
  s_add_u32 m0, s76, 40960
  s_nop 0
  buffer_load_dwordx4 v56, s[32:35], 0 offen lds
  s_add_u32 m0, s76, 43008
  v_add_u32_dpp v56, v17, v2 row_newbcast:1 row_mask:0xf bank_mask:0x3
  buffer_load_dwordx4 v57, s[32:35], 0 offen lds
  s_nop 0
  v_add_u32_dpp v56, v19, v2 row_newbcast:7 row_mask:0xf bank_mask:0xc
  s_add_u32 m0, s76, 45056
  v_add_u32_dpp v57, v21, v2 row_newbcast:1 row_mask:0xf bank_mask:0x3
  buffer_load_dwordx4 v58, s[32:35], 0 offen lds
  s_nop 0
  v_add_u32_dpp v57, v23, v2 row_newbcast:7 row_mask:0xf bank_mask:0xc
  s_add_u32 m0, s76, 47104
  v_add_u32_dpp v58, v25, v2 row_newbcast:1 row_mask:0xf bank_mask:0x3
  buffer_load_dwordx4 v59, s[32:35], 0 offen lds
  s_nop 0
  v_add_u32_dpp v58, v27, v2 row_newbcast:7 row_mask:0xf bank_mask:0xc
  s_add_u32 m0, s76, 49152
  v_add_u32_dpp v59, v29, v2 row_newbcast:1 row_mask:0xf bank_mask:0x3
  buffer_load_dwordx4 v60, s[32:35], 0 offen lds
  s_nop 0
  v_add_u32_dpp v59, v31, v2 row_newbcast:7 row_mask:0xf bank_mask:0xc
  s_add_u32 m0, s76, 51200
  v_add_u32_dpp v60, v33, v2 row_newbcast:1 row_mask:0xf bank_mask:0x3
  buffer_load_dwordx4 v61, s[32:35], 0 offen lds
  s_nop 0
  v_add_u32_dpp v60, v35, v2 row_newbcast:7 row_mask:0xf bank_mask:0xc
  s_add_u32 m0, s76, 53248
  v_add_u32_dpp v61, v37, v2 row_newbcast:1 row_mask:0xf bank_mask:0x3
  buffer_load_dwordx4 v62, s[32:35], 0 offen lds
  s_nop 0
  v_add_u32_dpp v61, v39, v2 row_newbcast:7 row_mask:0xf bank_mask:0xc
  s_add_u32 m0, s76, 55296
  v_add_u32_dpp v62, v41, v2 row_newbcast:1 row_mask:0xf bank_mask:0x3
  buffer_load_dwordx4 v63, s[32:35], 0 offen lds
  s_nop 0
  v_add_u32_dpp v62, v43, v2 row_newbcast:7 row_mask:0xf bank_mask:0xc
  s_add_u32 m0, s76, 57344
  v_add_u32_dpp v63, v45, v2 row_newbcast:1 row_mask:0xf bank_mask:0x3
  buffer_load_dwordx4 v64, s[32:35], 0 offen lds
  s_nop 0
  v_add_u32_dpp v63, v47, v2 row_newbcast:7 row_mask:0xf bank_mask:0xc
  s_add_u32 m0, s76, 59392
  v_add_u32_dpp v64, v49, v2 row_newbcast:1 row_mask:0xf bank_mask:0x3
  buffer_load_dwordx4 v65, s[32:35], 0 offen lds
  s_nop 0
  v_add_u32_dpp v64, v51, v2 row_newbcast:7 row_mask:0xf bank_mask:0xc
  v_add_u32_dpp v65, v53, v2 row_newbcast:1 row_mask:0xf bank_mask:0x3
  s_nop 1
  v_add_u32_dpp v65, v55, v2 row_newbcast:7 row_mask:0xf bank_mask:0xc
  s_waitcnt vmcnt(10)
  s_barrier
  s_add_u32 m0, s75, 131072
  s_nop 0
  buffer_load_dwordx4 v4, s[44:47], s74 offen lds
  s_add_u32 m0, s75, 132096
  s_nop 0
  buffer_load_dwordx4 v5, s[44:47], s74 offen lds
  s_add_u32 s74, s74, 106496
  s_add_u32 m0, s75, 139264
  s_nop 0
  buffer_load_dwordx4 v4, s[44:47], s74 offen lds
  s_add_u32 m0, s75, 140288
  s_nop 0
  buffer_load_dwordx4 v5, s[44:47], s74 offen lds
  s_add_u32 s74, s74, 106496
  s_add_u32 m0, s76, 81920
  s_nop 0
  buffer_load_dwordx4 v56, s[32:35], 0 offen lds
  s_add_u32 m0, s76, 83968
  v_add_u32_dpp v56, v18, v2 row_newbcast:1 row_mask:0xf bank_mask:0x3
  buffer_load_dwordx4 v57, s[32:35], 0 offen lds
  s_nop 0
  v_add_u32_dpp v56, v16, v2 row_newbcast:8 row_mask:0xf bank_mask:0xc
  s_add_u32 m0, s76, 86016
  v_add_u32_dpp v57, v22, v2 row_newbcast:1 row_mask:0xf bank_mask:0x3
  buffer_load_dwordx4 v58, s[32:35], 0 offen lds
  s_nop 0
  v_add_u32_dpp v57, v20, v2 row_newbcast:8 row_mask:0xf bank_mask:0xc
  s_add_u32 m0, s76, 88064
  v_add_u32_dpp v58, v26, v2 row_newbcast:1 row_mask:0xf bank_mask:0x3
  buffer_load_dwordx4 v59, s[32:35], 0 offen lds
  s_nop 0
  v_add_u32_dpp v58, v24, v2 row_newbcast:8 row_mask:0xf bank_mask:0xc
  s_add_u32 m0, s76, 90112
  v_add_u32_dpp v59, v30, v2 row_newbcast:1 row_mask:0xf bank_mask:0x3
  buffer_load_dwordx4 v60, s[32:35], 0 offen lds
  s_nop 0
  v_add_u32_dpp v59, v28, v2 row_newbcast:8 row_mask:0xf bank_mask:0xc
  s_add_u32 m0, s76, 92160
  v_add_u32_dpp v60, v34, v2 row_newbcast:1 row_mask:0xf bank_mask:0x3
  buffer_load_dwordx4 v61, s[32:35], 0 offen lds
  s_nop 0
  v_add_u32_dpp v60, v32, v2 row_newbcast:8 row_mask:0xf bank_mask:0xc
  s_add_u32 m0, s76, 94208
  v_add_u32_dpp v61, v38, v2 row_newbcast:1 row_mask:0xf bank_mask:0x3
  buffer_load_dwordx4 v62, s[32:35], 0 offen lds
  s_nop 0
  v_add_u32_dpp v61, v36, v2 row_newbcast:8 row_mask:0xf bank_mask:0xc
  s_add_u32 m0, s76, 96256
  v_add_u32_dpp v62, v42, v2 row_newbcast:1 row_mask:0xf bank_mask:0x3
  buffer_load_dwordx4 v63, s[32:35], 0 offen lds
  s_nop 0
  v_add_u32_dpp v62, v40, v2 row_newbcast:8 row_mask:0xf bank_mask:0xc
  s_add_u32 m0, s76, 98304
  v_add_u32_dpp v63, v46, v2 row_newbcast:1 row_mask:0xf bank_mask:0x3
  buffer_load_dwordx4 v64, s[32:35], 0 offen lds
  s_nop 0
  v_add_u32_dpp v63, v44, v2 row_newbcast:8 row_mask:0xf bank_mask:0xc
  s_add_u32 m0, s76, 100352
  v_add_u32_dpp v64, v50, v2 row_newbcast:1 row_mask:0xf bank_mask:0x3
  buffer_load_dwordx4 v65, s[32:35], 0 offen lds
  s_nop 0
  v_add_u32_dpp v64, v48, v2 row_newbcast:8 row_mask:0xf bank_mask:0xc
  v_add_u32_dpp v65, v54, v2 row_newbcast:1 row_mask:0xf bank_mask:0x3
  s_nop 1
  v_add_u32_dpp v65, v52, v2 row_newbcast:8 row_mask:0xf bank_mask:0xc
  s_waitcnt vmcnt(10)
  s_barrier
  s_add_u32 m0, s75, 147456
  s_nop 0
  buffer_load_dwordx4 v4, s[44:47], s74 offen lds
  s_add_u32 m0, s75, 148480
  s_nop 0
  buffer_load_dwordx4 v5, s[44:47], s74 offen lds
  s_add_u32 s74, s74, 106496
  s_add_u32 m0, s75, 155648
  s_nop 0
  buffer_load_dwordx4 v4, s[44:47], s74 offen lds
  s_add_u32 m0, s75, 156672
  s_nop 0
  buffer_load_dwordx4 v5, s[44:47], s74 offen lds
  s_add_u32 s74, s74, 106496
  s_add_u32 m0, s76, 0
  s_nop 0
  buffer_load_dwordx4 v56, s[32:35], 0 offen lds
  s_add_u32 m0, s76, 2048
  v_add_u32_dpp v56, v19, v2 row_newbcast:1 row_mask:0xf bank_mask:0x3
  buffer_load_dwordx4 v57, s[32:35], 0 offen lds
  s_nop 0
  v_add_u32_dpp v56, v17, v2 row_newbcast:8 row_mask:0xf bank_mask:0xc
  s_add_u32 m0, s76, 4096
  v_add_u32_dpp v57, v23, v2 row_newbcast:1 row_mask:0xf bank_mask:0x3
  buffer_load_dwordx4 v58, s[32:35], 0 offen lds
  s_nop 0
  v_add_u32_dpp v57, v21, v2 row_newbcast:8 row_mask:0xf bank_mask:0xc
  s_add_u32 m0, s76, 6144
  v_add_u32_dpp v58, v27, v2 row_newbcast:1 row_mask:0xf bank_mask:0x3
  buffer_load_dwordx4 v59, s[32:35], 0 offen lds
  s_nop 0
  v_add_u32_dpp v58, v25, v2 row_newbcast:8 row_mask:0xf bank_mask:0xc
  s_add_u32 m0, s76, 8192
  v_add_u32_dpp v59, v31, v2 row_newbcast:1 row_mask:0xf bank_mask:0x3
  buffer_load_dwordx4 v60, s[32:35], 0 offen lds
  s_nop 0
  v_add_u32_dpp v59, v29, v2 row_newbcast:8 row_mask:0xf bank_mask:0xc
  s_add_u32 m0, s76, 10240
  v_add_u32_dpp v60, v35, v2 row_newbcast:1 row_mask:0xf bank_mask:0x3
  buffer_load_dwordx4 v61, s[32:35], 0 offen lds
  s_nop 0
  v_add_u32_dpp v60, v33, v2 row_newbcast:8 row_mask:0xf bank_mask:0xc
  s_add_u32 m0, s76, 12288
  v_add_u32_dpp v61, v39, v2 row_newbcast:1 row_mask:0xf bank_mask:0x3
  buffer_load_dwordx4 v62, s[32:35], 0 offen lds
  s_nop 0
  v_add_u32_dpp v61, v37, v2 row_newbcast:8 row_mask:0xf bank_mask:0xc
  s_add_u32 m0, s76, 14336
  v_add_u32_dpp v62, v43, v2 row_newbcast:1 row_mask:0xf bank_mask:0x3
  buffer_load_dwordx4 v63, s[32:35], 0 offen lds
  s_nop 0
  v_add_u32_dpp v62, v41, v2 row_newbcast:8 row_mask:0xf bank_mask:0xc
  s_add_u32 m0, s76, 16384
  v_add_u32_dpp v63, v47, v2 row_newbcast:1 row_mask:0xf bank_mask:0x3
  buffer_load_dwordx4 v64, s[32:35], 0 offen lds
  s_nop 0
  v_add_u32_dpp v63, v45, v2 row_newbcast:8 row_mask:0xf bank_mask:0xc
  s_add_u32 m0, s76, 18432
  v_add_u32_dpp v64, v51, v2 row_newbcast:1 row_mask:0xf bank_mask:0x3
  buffer_load_dwordx4 v65, s[32:35], 0 offen lds
  s_nop 0
  v_add_u32_dpp v64, v49, v2 row_newbcast:8 row_mask:0xf bank_mask:0xc
  v_add_u32_dpp v65, v55, v2 row_newbcast:1 row_mask:0xf bank_mask:0x3
  s_nop 1
  v_add_u32_dpp v65, v53, v2 row_newbcast:8 row_mask:0xf bank_mask:0xc
  s_waitcnt vmcnt(10)
  s_barrier
  s_add_u32 m0, s75, 131072
  s_nop 0
  buffer_load_dwordx4 v4, s[44:47], s74 offen lds
  s_add_u32 m0, s75, 132096
  s_nop 0
  buffer_load_dwordx4 v5, s[44:47], s74 offen lds
  s_add_u32 s74, s74, 106496
  s_add_u32 m0, s75, 139264
  s_nop 0
  buffer_load_dwordx4 v4, s[44:47], s74 offen lds
  s_add_u32 m0, s75, 140288
  s_nop 0
  buffer_load_dwordx4 v5, s[44:47], s74 offen lds
  s_add_u32 s74, s74, 106496
  s_add_u32 m0, s76, 40960
  s_nop 0
  buffer_load_dwordx4 v56, s[32:35], 0 offen lds
  s_add_u32 m0, s76, 43008
  v_add_u32_dpp v56, v16, v2 row_newbcast:2 row_mask:0xf bank_mask:0x3
  buffer_load_dwordx4 v57, s[32:35], 0 offen lds
  s_nop 0
  v_add_u32_dpp v56, v18, v2 row_newbcast:8 row_mask:0xf bank_mask:0xc
  s_add_u32 m0, s76, 45056
  v_add_u32_dpp v57, v20, v2 row_newbcast:2 row_mask:0xf bank_mask:0x3
  buffer_load_dwordx4 v58, s[32:35], 0 offen lds
  s_nop 0
  v_add_u32_dpp v57, v22, v2 row_newbcast:8 row_mask:0xf bank_mask:0xc
  s_add_u32 m0, s76, 47104
  v_add_u32_dpp v58, v24, v2 row_newbcast:2 row_mask:0xf bank_mask:0x3
  buffer_load_dwordx4 v59, s[32:35], 0 offen lds
  s_nop 0
  v_add_u32_dpp v58, v26, v2 row_newbcast:8 row_mask:0xf bank_mask:0xc
  s_add_u32 m0, s76, 49152
  v_add_u32_dpp v59, v28, v2 row_newbcast:2 row_mask:0xf bank_mask:0x3
  buffer_load_dwordx4 v60, s[32:35], 0 offen lds
  s_nop 0
  v_add_u32_dpp v59, v30, v2 row_newbcast:8 row_mask:0xf bank_mask:0xc
  s_add_u32 m0, s76, 51200
  v_add_u32_dpp v60, v32, v2 row_newbcast:2 row_mask:0xf bank_mask:0x3
  buffer_load_dwordx4 v61, s[32:35], 0 offen lds
  s_nop 0
  v_add_u32_dpp v60, v34, v2 row_newbcast:8 row_mask:0xf bank_mask:0xc
  s_add_u32 m0, s76, 53248
  v_add_u32_dpp v61, v36, v2 row_newbcast:2 row_mask:0xf bank_mask:0x3
  buffer_load_dwordx4 v62, s[32:35], 0 offen lds
  s_nop 0
  v_add_u32_dpp v61, v38, v2 row_newbcast:8 row_mask:0xf bank_mask:0xc
  s_add_u32 m0, s76, 55296
  v_add_u32_dpp v62, v40, v2 row_newbcast:2 row_mask:0xf bank_mask:0x3
  buffer_load_dwordx4 v63, s[32:35], 0 offen lds
  s_nop 0
  v_add_u32_dpp v62, v42, v2 row_newbcast:8 row_mask:0xf bank_mask:0xc
  s_add_u32 m0, s76, 57344
  v_add_u32_dpp v63, v44, v2 row_newbcast:2 row_mask:0xf bank_mask:0x3
  buffer_load_dwordx4 v64, s[32:35], 0 offen lds
  s_nop 0
  v_add_u32_dpp v63, v46, v2 row_newbcast:8 row_mask:0xf bank_mask:0xc
  s_add_u32 m0, s76, 59392
  v_add_u32_dpp v64, v48, v2 row_newbcast:2 row_mask:0xf bank_mask:0x3
  buffer_load_dwordx4 v65, s[32:35], 0 offen lds
  s_nop 0
  v_add_u32_dpp v64, v50, v2 row_newbcast:8 row_mask:0xf bank_mask:0xc
  v_add_u32_dpp v65, v52, v2 row_newbcast:2 row_mask:0xf bank_mask:0x3
  s_nop 1
  v_add_u32_dpp v65, v54, v2 row_newbcast:8 row_mask:0xf bank_mask:0xc
  s_waitcnt vmcnt(10)
  s_barrier
  s_add_u32 m0, s75, 147456
  s_nop 0
  buffer_load_dwordx4 v4, s[44:47], s74 offen lds
  s_add_u32 m0, s75, 148480
  s_nop 0
  buffer_load_dwordx4 v5, s[44:47], s74 offen lds
  s_add_u32 s74, s74, 106496
  s_add_u32 m0, s75, 155648
  s_nop 0
  buffer_load_dwordx4 v4, s[44:47], s74 offen lds
  s_add_u32 m0, s75, 156672
  s_nop 0
  buffer_load_dwordx4 v5, s[44:47], s74 offen lds
  s_add_u32 s74, s74, 106496
  s_add_u32 m0, s76, 81920
  s_nop 0
  buffer_load_dwordx4 v56, s[32:35], 0 offen lds
  s_add_u32 m0, s76, 83968
  v_add_u32_dpp v56, v17, v2 row_newbcast:2 row_mask:0xf bank_mask:0x3
  buffer_load_dwordx4 v57, s[32:35], 0 offen lds
  s_nop 0
  v_add_u32_dpp v56, v19, v2 row_newbcast:8 row_mask:0xf bank_mask:0xc
  s_add_u32 m0, s76, 86016
  v_add_u32_dpp v57, v21, v2 row_newbcast:2 row_mask:0xf bank_mask:0x3
  buffer_load_dwordx4 v58, s[32:35], 0 offen lds
  s_nop 0
  v_add_u32_dpp v57, v23, v2 row_newbcast:8 row_mask:0xf bank_mask:0xc
  s_add_u32 m0, s76, 88064
  v_add_u32_dpp v58, v25, v2 row_newbcast:2 row_mask:0xf bank_mask:0x3
  buffer_load_dwordx4 v59, s[32:35], 0 offen lds
  s_nop 0
  v_add_u32_dpp v58, v27, v2 row_newbcast:8 row_mask:0xf bank_mask:0xc
  s_add_u32 m0, s76, 90112
  v_add_u32_dpp v59, v29, v2 row_newbcast:2 row_mask:0xf bank_mask:0x3
  buffer_load_dwordx4 v60, s[32:35], 0 offen lds
  s_nop 0
  v_add_u32_dpp v59, v31, v2 row_newbcast:8 row_mask:0xf bank_mask:0xc
  s_add_u32 m0, s76, 92160
  v_add_u32_dpp v60, v33, v2 row_newbcast:2 row_mask:0xf bank_mask:0x3
  buffer_load_dwordx4 v61, s[32:35], 0 offen lds
  s_nop 0
  v_add_u32_dpp v60, v35, v2 row_newbcast:8 row_mask:0xf bank_mask:0xc
  s_add_u32 m0, s76, 94208
  v_add_u32_dpp v61, v37, v2 row_newbcast:2 row_mask:0xf bank_mask:0x3
  buffer_load_dwordx4 v62, s[32:35], 0 offen lds
  s_nop 0
  v_add_u32_dpp v61, v39, v2 row_newbcast:8 row_mask:0xf bank_mask:0xc
  s_add_u32 m0, s76, 96256
  v_add_u32_dpp v62, v41, v2 row_newbcast:2 row_mask:0xf bank_mask:0x3
  buffer_load_dwordx4 v63, s[32:35], 0 offen lds
  s_nop 0
  v_add_u32_dpp v62, v43, v2 row_newbcast:8 row_mask:0xf bank_mask:0xc
  s_add_u32 m0, s76, 98304
  v_add_u32_dpp v63, v45, v2 row_newbcast:2 row_mask:0xf bank_mask:0x3
  buffer_load_dwordx4 v64, s[32:35], 0 offen lds
  s_nop 0
  v_add_u32_dpp v63, v47, v2 row_newbcast:8 row_mask:0xf bank_mask:0xc
  s_add_u32 m0, s76, 100352
  v_add_u32_dpp v64, v49, v2 row_newbcast:2 row_mask:0xf bank_mask:0x3
  buffer_load_dwordx4 v65, s[32:35], 0 offen lds
  s_nop 0
  v_add_u32_dpp v64, v51, v2 row_newbcast:8 row_mask:0xf bank_mask:0xc
  v_add_u32_dpp v65, v53, v2 row_newbcast:2 row_mask:0xf bank_mask:0x3
  s_nop 1
  v_add_u32_dpp v65, v55, v2 row_newbcast:8 row_mask:0xf bank_mask:0xc
  s_waitcnt vmcnt(10)
  s_barrier
  s_add_u32 m0, s75, 131072
  s_nop 0
  buffer_load_dwordx4 v4, s[44:47], s74 offen lds
  s_add_u32 m0, s75, 132096
  s_nop 0
  buffer_load_dwordx4 v5, s[44:47], s74 offen lds
  s_add_u32 s74, s74, 106496
  s_add_u32 m0, s75, 139264
  s_nop 0
  buffer_load_dwordx4 v4, s[44:47], s74 offen lds
  s_add_u32 m0, s75, 140288
  s_nop 0
  buffer_load_dwordx4 v5, s[44:47], s74 offen lds
  s_add_u32 s74, s74, 106496
  s_add_u32 m0, s76, 0
  s_nop 0
  buffer_load_dwordx4 v56, s[32:35], 0 offen lds
  s_add_u32 m0, s76, 2048
  v_add_u32_dpp v56, v18, v2 row_newbcast:2 row_mask:0xf bank_mask:0x3
  buffer_load_dwordx4 v57, s[32:35], 0 offen lds
  s_nop 0
  v_add_u32_dpp v56, v16, v2 row_newbcast:9 row_mask:0xf bank_mask:0xc
  s_add_u32 m0, s76, 4096
  v_add_u32_dpp v57, v22, v2 row_newbcast:2 row_mask:0xf bank_mask:0x3
  buffer_load_dwordx4 v58, s[32:35], 0 offen lds
  s_nop 0
  v_add_u32_dpp v57, v20, v2 row_newbcast:9 row_mask:0xf bank_mask:0xc
  s_add_u32 m0, s76, 6144
  v_add_u32_dpp v58, v26, v2 row_newbcast:2 row_mask:0xf bank_mask:0x3
  buffer_load_dwordx4 v59, s[32:35], 0 offen lds
  s_nop 0
  v_add_u32_dpp v58, v24, v2 row_newbcast:9 row_mask:0xf bank_mask:0xc
  s_add_u32 m0, s76, 8192
  v_add_u32_dpp v59, v30, v2 row_newbcast:2 row_mask:0xf bank_mask:0x3
  buffer_load_dwordx4 v60, s[32:35], 0 offen lds
  s_nop 0
  v_add_u32_dpp v59, v28, v2 row_newbcast:9 row_mask:0xf bank_mask:0xc
  s_add_u32 m0, s76, 10240
  v_add_u32_dpp v60, v34, v2 row_newbcast:2 row_mask:0xf bank_mask:0x3
  buffer_load_dwordx4 v61, s[32:35], 0 offen lds
  s_nop 0
  v_add_u32_dpp v60, v32, v2 row_newbcast:9 row_mask:0xf bank_mask:0xc
  s_add_u32 m0, s76, 12288
  v_add_u32_dpp v61, v38, v2 row_newbcast:2 row_mask:0xf bank_mask:0x3
  buffer_load_dwordx4 v62, s[32:35], 0 offen lds
  s_nop 0
  v_add_u32_dpp v61, v36, v2 row_newbcast:9 row_mask:0xf bank_mask:0xc
  s_add_u32 m0, s76, 14336
  v_add_u32_dpp v62, v42, v2 row_newbcast:2 row_mask:0xf bank_mask:0x3
  buffer_load_dwordx4 v63, s[32:35], 0 offen lds
  s_nop 0
  v_add_u32_dpp v62, v40, v2 row_newbcast:9 row_mask:0xf bank_mask:0xc
  s_add_u32 m0, s76, 16384
  v_add_u32_dpp v63, v46, v2 row_newbcast:2 row_mask:0xf bank_mask:0x3
  buffer_load_dwordx4 v64, s[32:35], 0 offen lds
  s_nop 0
  v_add_u32_dpp v63, v44, v2 row_newbcast:9 row_mask:0xf bank_mask:0xc
  s_add_u32 m0, s76, 18432
  v_add_u32_dpp v64, v50, v2 row_newbcast:2 row_mask:0xf bank_mask:0x3
  buffer_load_dwordx4 v65, s[32:35], 0 offen lds
  s_nop 0
  v_add_u32_dpp v64, v48, v2 row_newbcast:9 row_mask:0xf bank_mask:0xc
  v_add_u32_dpp v65, v54, v2 row_newbcast:2 row_mask:0xf bank_mask:0x3
  s_nop 1
  v_add_u32_dpp v65, v52, v2 row_newbcast:9 row_mask:0xf bank_mask:0xc
  s_waitcnt vmcnt(10)
  s_barrier
  s_add_u32 m0, s75, 147456
  s_nop 0
  buffer_load_dwordx4 v4, s[44:47], s74 offen lds
  s_add_u32 m0, s75, 148480
  s_nop 0
  buffer_load_dwordx4 v5, s[44:47], s74 offen lds
  s_add_u32 s74, s74, 106496
  s_add_u32 m0, s75, 155648
  s_nop 0
  buffer_load_dwordx4 v4, s[44:47], s74 offen lds
  s_add_u32 m0, s75, 156672
  s_nop 0
  buffer_load_dwordx4 v5, s[44:47], s74 offen lds
  s_add_u32 s74, s74, 106496
  s_add_u32 m0, s76, 40960
  s_nop 0
  buffer_load_dwordx4 v56, s[32:35], 0 offen lds
  s_add_u32 m0, s76, 43008
  v_add_u32_dpp v56, v19, v2 row_newbcast:2 row_mask:0xf bank_mask:0x3
  buffer_load_dwordx4 v57, s[32:35], 0 offen lds
  s_nop 0
  v_add_u32_dpp v56, v17, v2 row_newbcast:9 row_mask:0xf bank_mask:0xc
  s_add_u32 m0, s76, 45056
  v_add_u32_dpp v57, v23, v2 row_newbcast:2 row_mask:0xf bank_mask:0x3
  buffer_load_dwordx4 v58, s[32:35], 0 offen lds
  s_nop 0
  v_add_u32_dpp v57, v21, v2 row_newbcast:9 row_mask:0xf bank_mask:0xc
  s_add_u32 m0, s76, 47104
  v_add_u32_dpp v58, v27, v2 row_newbcast:2 row_mask:0xf bank_mask:0x3
  buffer_load_dwordx4 v59, s[32:35], 0 offen lds
  s_nop 0
  v_add_u32_dpp v58, v25, v2 row_newbcast:9 row_mask:0xf bank_mask:0xc
  s_add_u32 m0, s76, 49152
  v_add_u32_dpp v59, v31, v2 row_newbcast:2 row_mask:0xf bank_mask:0x3
  buffer_load_dwordx4 v60, s[32:35], 0 offen lds
  s_nop 0
  v_add_u32_dpp v59, v29, v2 row_newbcast:9 row_mask:0xf bank_mask:0xc
  s_add_u32 m0, s76, 51200
  v_add_u32_dpp v60, v35, v2 row_newbcast:2 row_mask:0xf bank_mask:0x3
  buffer_load_dwordx4 v61, s[32:35], 0 offen lds
  s_nop 0
  v_add_u32_dpp v60, v33, v2 row_newbcast:9 row_mask:0xf bank_mask:0xc
  s_add_u32 m0, s76, 53248
  v_add_u32_dpp v61, v39, v2 row_newbcast:2 row_mask:0xf bank_mask:0x3
  buffer_load_dwordx4 v62, s[32:35], 0 offen lds
  s_nop 0
  v_add_u32_dpp v61, v37, v2 row_newbcast:9 row_mask:0xf bank_mask:0xc
  s_add_u32 m0, s76, 55296
  v_add_u32_dpp v62, v43, v2 row_newbcast:2 row_mask:0xf bank_mask:0x3
  buffer_load_dwordx4 v63, s[32:35], 0 offen lds
  s_nop 0
  v_add_u32_dpp v62, v41, v2 row_newbcast:9 row_mask:0xf bank_mask:0xc
  s_add_u32 m0, s76, 57344
  v_add_u32_dpp v63, v47, v2 row_newbcast:2 row_mask:0xf bank_mask:0x3
  buffer_load_dwordx4 v64, s[32:35], 0 offen lds
  s_nop 0
  v_add_u32_dpp v63, v45, v2 row_newbcast:9 row_mask:0xf bank_mask:0xc
  s_add_u32 m0, s76, 59392
  v_add_u32_dpp v64, v51, v2 row_newbcast:2 row_mask:0xf bank_mask:0x3
  buffer_load_dwordx4 v65, s[32:35], 0 offen lds
  s_nop 0
  v_add_u32_dpp v64, v49, v2 row_newbcast:9 row_mask:0xf bank_mask:0xc
  v_add_u32_dpp v65, v55, v2 row_newbcast:2 row_mask:0xf bank_mask:0x3
  s_nop 1
  v_add_u32_dpp v65, v53, v2 row_newbcast:9 row_mask:0xf bank_mask:0xc
  s_waitcnt vmcnt(10)
  s_cmp_lg_u32 s72, 1
  s_cbranch_scc1 L_nolpf
  s_mov_b64 exec, 1048575
  global_load_dword v10, v[8:9], off
  s_mov_b64 exec, -1
  s_mov_b32 m0, 123136
  s_mov_b64 exec, 0xffff
  buffer_load_dwordx4 v11, s[52:55], s77 offen lds
  s_mov_b64 exec, -1
L_nolpf:
  s_barrier
  s_add_u32 m0, s75, 131072
  s_nop 0
  buffer_load_dwordx4 v4, s[44:47], s74 offen lds
  s_add_u32 m0, s75, 132096
  s_nop 0
  buffer_load_dwordx4 v5, s[44:47], s74 offen lds
  s_add_u32 s74, s74, 106496
  s_add_u32 m0, s75, 139264
  s_nop 0
  buffer_load_dwordx4 v4, s[44:47], s74 offen lds
  s_add_u32 m0, s75, 140288
  s_nop 0
  buffer_load_dwordx4 v5, s[44:47], s74 offen lds
  s_add_u32 s74, s74, 106496
  s_add_u32 m0, s76, 81920
  s_nop 0
  buffer_load_dwordx4 v56, s[32:35], 0 offen lds
  s_add_u32 m0, s76, 83968
  v_add_u32_dpp v56, v16, v2 row_newbcast:3 row_mask:0xf bank_mask:0x3
  buffer_load_dwordx4 v57, s[32:35], 0 offen lds
  s_nop 0
  v_add_u32_dpp v56, v18, v2 row_newbcast:9 row_mask:0xf bank_mask:0xc
  s_add_u32 m0, s76, 86016
  v_add_u32_dpp v57, v20, v2 row_newbcast:3 row_mask:0xf bank_mask:0x3
  buffer_load_dwordx4 v58, s[32:35], 0 offen lds
  s_nop 0
  v_add_u32_dpp v57, v22, v2 row_newbcast:9 row_mask:0xf bank_mask:0xc
  s_add_u32 m0, s76, 88064
  v_add_u32_dpp v58, v24, v2 row_newbcast:3 row_mask:0xf bank_mask:0x3
  buffer_load_dwordx4 v59, s[32:35], 0 offen lds
  s_nop 0
  v_add_u32_dpp v58, v26, v2 row_newbcast:9 row_mask:0xf bank_mask:0xc
  s_add_u32 m0, s76, 90112
  v_add_u32_dpp v59, v28, v2 row_newbcast:3 row_mask:0xf bank_mask:0x3
  buffer_load_dwordx4 v60, s[32:35], 0 offen lds
  s_nop 0
  v_add_u32_dpp v59, v30, v2 row_newbcast:9 row_mask:0xf bank_mask:0xc
  s_add_u32 m0, s76, 92160
  v_add_u32_dpp v60, v32, v2 row_newbcast:3 row_mask:0xf bank_mask:0x3
  buffer_load_dwordx4 v61, s[32:35], 0 offen lds
  s_nop 0
  v_add_u32_dpp v60, v34, v2 row_newbcast:9 row_mask:0xf bank_mask:0xc
  s_add_u32 m0, s76, 94208
  v_add_u32_dpp v61, v36, v2 row_newbcast:3 row_mask:0xf bank_mask:0x3
  buffer_load_dwordx4 v62, s[32:35], 0 offen lds
  s_nop 0
  v_add_u32_dpp v61, v38, v2 row_newbcast:9 row_mask:0xf bank_mask:0xc
  s_add_u32 m0, s76, 96256
  v_add_u32_dpp v62, v40, v2 row_newbcast:3 row_mask:0xf bank_mask:0x3
  buffer_load_dwordx4 v63, s[32:35], 0 offen lds
  s_nop 0
  v_add_u32_dpp v62, v42, v2 row_newbcast:9 row_mask:0xf bank_mask:0xc
  s_add_u32 m0, s76, 98304
  v_add_u32_dpp v63, v44, v2 row_newbcast:3 row_mask:0xf bank_mask:0x3
  buffer_load_dwordx4 v64, s[32:35], 0 offen lds
  s_nop 0
  v_add_u32_dpp v63, v46, v2 row_newbcast:9 row_mask:0xf bank_mask:0xc
  s_add_u32 m0, s76, 100352
  v_add_u32_dpp v64, v48, v2 row_newbcast:3 row_mask:0xf bank_mask:0x3
  buffer_load_dwordx4 v65, s[32:35], 0 offen lds
  s_nop 0
  v_add_u32_dpp v64, v50, v2 row_newbcast:9 row_mask:0xf bank_mask:0xc
  v_add_u32_dpp v65, v52, v2 row_newbcast:3 row_mask:0xf bank_mask:0x3
  s_nop 1
  v_add_u32_dpp v65, v54, v2 row_newbcast:9 row_mask:0xf bank_mask:0xc
  s_waitcnt vmcnt(10)
  s_barrier
  s_add_u32 m0, s75, 147456
  s_nop 0
  buffer_load_dwordx4 v4, s[44:47], s74 offen lds
  s_add_u32 m0, s75, 148480
  s_nop 0
  buffer_load_dwordx4 v5, s[44:47], s74 offen lds
  s_add_u32 s74, s74, 106496
  s_add_u32 m0, s75, 155648
  s_nop 0
  buffer_load_dwordx4 v4, s[44:47], s74 offen lds
  s_add_u32 m0, s75, 156672
  s_nop 0
  buffer_load_dwordx4 v5, s[44:47], s74 offen lds
  s_add_u32 s74, s74, 106496
  s_add_u32 m0, s76, 0
  s_nop 0
  buffer_load_dwordx4 v56, s[32:35], 0 offen lds
  s_add_u32 m0, s76, 2048
  v_add_u32_dpp v56, v17, v2 row_newbcast:3 row_mask:0xf bank_mask:0x3
  buffer_load_dwordx4 v57, s[32:35], 0 offen lds
  s_nop 0
  v_add_u32_dpp v56, v19, v2 row_newbcast:9 row_mask:0xf bank_mask:0xc
  s_add_u32 m0, s76, 4096
  v_add_u32_dpp v57, v21, v2 row_newbcast:3 row_mask:0xf bank_mask:0x3
  buffer_load_dwordx4 v58, s[32:35], 0 offen lds
  s_nop 0
  v_add_u32_dpp v57, v23, v2 row_newbcast:9 row_mask:0xf bank_mask:0xc
  s_add_u32 m0, s76, 6144
  v_add_u32_dpp v58, v25, v2 row_newbcast:3 row_mask:0xf bank_mask:0x3
  buffer_load_dwordx4 v59, s[32:35], 0 offen lds
  s_nop 0
  v_add_u32_dpp v58, v27, v2 row_newbcast:9 row_mask:0xf bank_mask:0xc
  s_add_u32 m0, s76, 8192
  v_add_u32_dpp v59, v29, v2 row_newbcast:3 row_mask:0xf bank_mask:0x3
  buffer_load_dwordx4 v60, s[32:35], 0 offen lds
  s_nop 0
  v_add_u32_dpp v59, v31, v2 row_newbcast:9 row_mask:0xf bank_mask:0xc
  s_add_u32 m0, s76, 10240
  v_add_u32_dpp v60, v33, v2 row_newbcast:3 row_mask:0xf bank_mask:0x3
  buffer_load_dwordx4 v61, s[32:35], 0 offen lds
  s_nop 0
  v_add_u32_dpp v60, v35, v2 row_newbcast:9 row_mask:0xf bank_mask:0xc
  s_add_u32 m0, s76, 12288
  v_add_u32_dpp v61, v37, v2 row_newbcast:3 row_mask:0xf bank_mask:0x3
  buffer_load_dwordx4 v62, s[32:35], 0 offen lds
  s_nop 0
  v_add_u32_dpp v61, v39, v2 row_newbcast:9 row_mask:0xf bank_mask:0xc
  s_add_u32 m0, s76, 14336
  v_add_u32_dpp v62, v41, v2 row_newbcast:3 row_mask:0xf bank_mask:0x3
  buffer_load_dwordx4 v63, s[32:35], 0 offen lds
  s_nop 0
  v_add_u32_dpp v62, v43, v2 row_newbcast:9 row_mask:0xf bank_mask:0xc
  s_add_u32 m0, s76, 16384
  v_add_u32_dpp v63, v45, v2 row_newbcast:3 row_mask:0xf bank_mask:0x3
  buffer_load_dwordx4 v64, s[32:35], 0 offen lds
  s_nop 0
  v_add_u32_dpp v63, v47, v2 row_newbcast:9 row_mask:0xf bank_mask:0xc
  s_add_u32 m0, s76, 18432
  v_add_u32_dpp v64, v49, v2 row_newbcast:3 row_mask:0xf bank_mask:0x3
  buffer_load_dwordx4 v65, s[32:35], 0 offen lds
  s_nop 0
  v_add_u32_dpp v64, v51, v2 row_newbcast:9 row_mask:0xf bank_mask:0xc
  v_add_u32_dpp v65, v53, v2 row_newbcast:3 row_mask:0xf bank_mask:0x3
  s_nop 1
  v_add_u32_dpp v65, v55, v2 row_newbcast:9 row_mask:0xf bank_mask:0xc
  s_waitcnt vmcnt(10)
  s_barrier
  s_add_u32 m0, s75, 131072
  s_nop 0
  buffer_load_dwordx4 v4, s[44:47], s74 offen lds
  s_add_u32 m0, s75, 132096
  s_nop 0
  buffer_load_dwordx4 v5, s[44:47], s74 offen lds
  s_add_u32 s74, s74, 106496
  s_add_u32 m0, s75, 139264
  s_nop 0
  buffer_load_dwordx4 v4, s[44:47], s74 offen lds
  s_add_u32 m0, s75, 140288
  s_nop 0
  buffer_load_dwordx4 v5, s[44:47], s74 offen lds
  s_add_u32 s74, s74, 106496
  s_add_u32 m0, s76, 40960
  s_nop 0
  buffer_load_dwordx4 v56, s[32:35], 0 offen lds
  s_add_u32 m0, s76, 43008
  v_add_u32_dpp v56, v18, v2 row_newbcast:3 row_mask:0xf bank_mask:0x3
  buffer_load_dwordx4 v57, s[32:35], 0 offen lds
  s_nop 0
  v_add_u32_dpp v56, v16, v2 row_newbcast:10 row_mask:0xf bank_mask:0xc
  s_add_u32 m0, s76, 45056
  v_add_u32_dpp v57, v22, v2 row_newbcast:3 row_mask:0xf bank_mask:0x3
  buffer_load_dwordx4 v58, s[32:35], 0 offen lds
  s_nop 0
  v_add_u32_dpp v57, v20, v2 row_newbcast:10 row_mask:0xf bank_mask:0xc
  s_add_u32 m0, s76, 47104
  v_add_u32_dpp v58, v26, v2 row_newbcast:3 row_mask:0xf bank_mask:0x3
  buffer_load_dwordx4 v59, s[32:35], 0 offen lds
  s_nop 0
  v_add_u32_dpp v58, v24, v2 row_newbcast:10 row_mask:0xf bank_mask:0xc
  s_add_u32 m0, s76, 49152
  v_add_u32_dpp v59, v30, v2 row_newbcast:3 row_mask:0xf bank_mask:0x3
  buffer_load_dwordx4 v60, s[32:35], 0 offen lds
  s_nop 0
  v_add_u32_dpp v59, v28, v2 row_newbcast:10 row_mask:0xf bank_mask:0xc
  s_add_u32 m0, s76, 51200
  v_add_u32_dpp v60, v34, v2 row_newbcast:3 row_mask:0xf bank_mask:0x3
  buffer_load_dwordx4 v61, s[32:35], 0 offen lds
  s_nop 0
  v_add_u32_dpp v60, v32, v2 row_newbcast:10 row_mask:0xf bank_mask:0xc
  s_add_u32 m0, s76, 53248
  v_add_u32_dpp v61, v38, v2 row_newbcast:3 row_mask:0xf bank_mask:0x3
  buffer_load_dwordx4 v62, s[32:35], 0 offen lds
  s_nop 0
  v_add_u32_dpp v61, v36, v2 row_newbcast:10 row_mask:0xf bank_mask:0xc
  s_add_u32 m0, s76, 55296
  v_add_u32_dpp v62, v42, v2 row_newbcast:3 row_mask:0xf bank_mask:0x3
  buffer_load_dwordx4 v63, s[32:35], 0 offen lds
  s_nop 0
  v_add_u32_dpp v62, v40, v2 row_newbcast:10 row_mask:0xf bank_mask:0xc
  s_add_u32 m0, s76, 57344
  v_add_u32_dpp v63, v46, v2 row_newbcast:3 row_mask:0xf bank_mask:0x3
  buffer_load_dwordx4 v64, s[32:35], 0 offen lds
  s_nop 0
  v_add_u32_dpp v63, v44, v2 row_newbcast:10 row_mask:0xf bank_mask:0xc
  s_add_u32 m0, s76, 59392
  v_add_u32_dpp v64, v50, v2 row_newbcast:3 row_mask:0xf bank_mask:0x3
  buffer_load_dwordx4 v65, s[32:35], 0 offen lds
  s_nop 0
  v_add_u32_dpp v64, v48, v2 row_newbcast:10 row_mask:0xf bank_mask:0xc
  v_add_u32_dpp v65, v54, v2 row_newbcast:3 row_mask:0xf bank_mask:0x3
  s_nop 1
  v_add_u32_dpp v65, v52, v2 row_newbcast:10 row_mask:0xf bank_mask:0xc
  v_mov_b32_dpp v16, v16 row_shl:3 row_mask:0xf bank_mask:0xf
  v_mov_b32_dpp v18, v18 row_shl:3 row_mask:0xf bank_mask:0xf
  v_mov_b32_dpp v20, v20 row_shl:3 row_mask:0xf bank_mask:0xf
  v_mov_b32_dpp v22, v22 row_shl:3 row_mask:0xf bank_mask:0xf
  v_mov_b32_dpp v24, v24 row_shl:3 row_mask:0xf bank_mask:0xf
  v_mov_b32_dpp v26, v26 row_shl:3 row_mask:0xf bank_mask:0xf
  v_mov_b32_dpp v28, v28 row_shl:3 row_mask:0xf bank_mask:0xf
  v_mov_b32_dpp v30, v30 row_shl:3 row_mask:0xf bank_mask:0xf
  v_mov_b32_dpp v32, v32 row_shl:3 row_mask:0xf bank_mask:0xf
  v_mov_b32_dpp v34, v34 row_shl:3 row_mask:0xf bank_mask:0xf
  v_mov_b32_dpp v36, v36 row_shl:3 row_mask:0xf bank_mask:0xf
  v_mov_b32_dpp v38, v38 row_shl:3 row_mask:0xf bank_mask:0xf
  v_mov_b32_dpp v40, v40 row_shl:3 row_mask:0xf bank_mask:0xf
  v_mov_b32_dpp v42, v42 row_shl:3 row_mask:0xf bank_mask:0xf
  v_mov_b32_dpp v44, v44 row_shl:3 row_mask:0xf bank_mask:0xf
  v_mov_b32_dpp v46, v46 row_shl:3 row_mask:0xf bank_mask:0xf
  v_mov_b32_dpp v48, v48 row_shl:3 row_mask:0xf bank_mask:0xf
  v_mov_b32_dpp v50, v50 row_shl:3 row_mask:0xf bank_mask:0xf
  v_mov_b32_dpp v52, v52 row_shl:3 row_mask:0xf bank_mask:0xf
  v_mov_b32_dpp v54, v54 row_shl:3 row_mask:0xf bank_mask:0xf
  s_waitcnt vmcnt(10)
  s_barrier
  s_add_u32 m0, s75, 147456
  s_nop 0
  buffer_load_dwordx4 v4, s[44:47], s74 offen lds
  s_add_u32 m0, s75, 148480
  s_nop 0
  buffer_load_dwordx4 v5, s[44:47], s74 offen lds
  s_add_u32 s74, s74, 106496
  s_add_u32 m0, s75, 155648
  s_nop 0
  buffer_load_dwordx4 v4, s[44:47], s74 offen lds
  s_add_u32 m0, s75, 156672
  s_nop 0
  buffer_load_dwordx4 v5, s[44:47], s74 offen lds
  s_add_u32 s74, s74, 106496
  s_add_u32 m0, s76, 81920
  s_nop 0
  buffer_load_dwordx4 v56, s[32:35], 0 offen lds
  s_add_u32 m0, s76, 83968
  v_add_u32_dpp v56, v19, v2 row_newbcast:3 row_mask:0xf bank_mask:0x3
  buffer_load_dwordx4 v57, s[32:35], 0 offen lds
  s_nop 0
  v_add_u32_dpp v56, v17, v2 row_newbcast:10 row_mask:0xf bank_mask:0xc
  s_add_u32 m0, s76, 86016
  v_add_u32_dpp v57, v23, v2 row_newbcast:3 row_mask:0xf bank_mask:0x3
  buffer_load_dwordx4 v58, s[32:35], 0 offen lds
  s_nop 0
  v_add_u32_dpp v57, v21, v2 row_newbcast:10 row_mask:0xf bank_mask:0xc
  s_add_u32 m0, s76, 88064
  v_add_u32_dpp v58, v27, v2 row_newbcast:3 row_mask:0xf bank_mask:0x3
  buffer_load_dwordx4 v59, s[32:35], 0 offen lds
  s_nop 0
  v_add_u32_dpp v58, v25, v2 row_newbcast:10 row_mask:0xf bank_mask:0xc
  s_add_u32 m0, s76, 90112
  v_add_u32_dpp v59, v31, v2 row_newbcast:3 row_mask:0xf bank_mask:0x3
  buffer_load_dwordx4 v60, s[32:35], 0 offen lds
  s_nop 0
  v_add_u32_dpp v59, v29, v2 row_newbcast:10 row_mask:0xf bank_mask:0xc
  s_add_u32 m0, s76, 92160
  v_add_u32_dpp v60, v35, v2 row_newbcast:3 row_mask:0xf bank_mask:0x3
  buffer_load_dwordx4 v61, s[32:35], 0 offen lds
  s_nop 0
  v_add_u32_dpp v60, v33, v2 row_newbcast:10 row_mask:0xf bank_mask:0xc
  s_add_u32 m0, s76, 94208
  v_add_u32_dpp v61, v39, v2 row_newbcast:3 row_mask:0xf bank_mask:0x3
  buffer_load_dwordx4 v62, s[32:35], 0 offen lds
  s_nop 0
  v_add_u32_dpp v61, v37, v2 row_newbcast:10 row_mask:0xf bank_mask:0xc
  s_add_u32 m0, s76, 96256
  v_add_u32_dpp v62, v43, v2 row_newbcast:3 row_mask:0xf bank_mask:0x3
  buffer_load_dwordx4 v63, s[32:35], 0 offen lds
  s_nop 0
  v_add_u32_dpp v62, v41, v2 row_newbcast:10 row_mask:0xf bank_mask:0xc
  s_add_u32 m0, s76, 98304
  v_add_u32_dpp v63, v47, v2 row_newbcast:3 row_mask:0xf bank_mask:0x3
  buffer_load_dwordx4 v64, s[32:35], 0 offen lds
  s_nop 0
  v_add_u32_dpp v63, v45, v2 row_newbcast:10 row_mask:0xf bank_mask:0xc
  s_add_u32 m0, s76, 100352
  v_add_u32_dpp v64, v51, v2 row_newbcast:3 row_mask:0xf bank_mask:0x3
  buffer_load_dwordx4 v65, s[32:35], 0 offen lds
  s_nop 0
  v_add_u32_dpp v64, v49, v2 row_newbcast:10 row_mask:0xf bank_mask:0xc
  v_add_u32_dpp v65, v55, v2 row_newbcast:3 row_mask:0xf bank_mask:0x3
  s_nop 1
  v_add_u32_dpp v65, v53, v2 row_newbcast:10 row_mask:0xf bank_mask:0xc
  v_mov_b32_dpp v17, v17 row_shl:3 row_mask:0xf bank_mask:0xf
  v_mov_b32_dpp v19, v19 row_shl:3 row_mask:0xf bank_mask:0xf
  v_mov_b32_dpp v21, v21 row_shl:3 row_mask:0xf bank_mask:0xf
  v_mov_b32_dpp v23, v23 row_shl:3 row_mask:0xf bank_mask:0xf
  v_mov_b32_dpp v25, v25 row_shl:3 row_mask:0xf bank_mask:0xf
  v_mov_b32_dpp v27, v27 row_shl:3 row_mask:0xf bank_mask:0xf
  v_mov_b32_dpp v29, v29 row_shl:3 row_mask:0xf bank_mask:0xf
  v_mov_b32_dpp v31, v31 row_shl:3 row_mask:0xf bank_mask:0xf
  v_mov_b32_dpp v33, v33 row_shl:3 row_mask:0xf bank_mask:0xf
  v_mov_b32_dpp v35, v35 row_shl:3 row_mask:0xf bank_mask:0xf
  v_mov_b32_dpp v37, v37 row_shl:3 row_mask:0xf bank_mask:0xf
  v_mov_b32_dpp v39, v39 row_shl:3 row_mask:0xf bank_mask:0xf
  v_mov_b32_dpp v41, v41 row_shl:3 row_mask:0xf bank_mask:0xf
  v_mov_b32_dpp v43, v43 row_shl:3 row_mask:0xf bank_mask:0xf
  v_mov_b32_dpp v45, v45 row_shl:3 row_mask:0xf bank_mask:0xf
  v_mov_b32_dpp v47, v47 row_shl:3 row_mask:0xf bank_mask:0xf
  v_mov_b32_dpp v49, v49 row_shl:3 row_mask:0xf bank_mask:0xf
  v_mov_b32_dpp v51, v51 row_shl:3 row_mask:0xf bank_mask:0xf
  v_mov_b32_dpp v53, v53 row_shl:3 row_mask:0xf bank_mask:0xf
  v_mov_b32_dpp v55, v55 row_shl:3 row_mask:0xf bank_mask:0xf
  s_add_u32 s72, s72, 1
  s_cmp_lt_u32 s72, 2
  s_waitcnt vmcnt(10)
  s_cbranch_scc1 L_dnn_loop1
  s_branch L_ld_tail
L_cin:
  v_lshlrev_b32 v1, 4, v0
  s_and_b32 s79, s3, 3
  s_lshr_b32 s84, s3, 2
  s_lshl_b32 s95, s79, 10
  s_mul_i32 s26, s68, 11
  s_add_u32 s26, s26, s69
  s_sub_u32 s26, s26, 22
  s_cmp_eq_u32 s26, 86
  s_cbranch_scc1 L_end
  s_cmp_eq_u32 s84, 0
  s_cbranch_scc1 L_sc
  s_setprio 2
  v_add_u32 v2, L_tables-L_pc+4096, v1
  v_mov_b32 v3, s93
  v_add_co_u32 v2, vcc, s92, v2
  s_nop 1
  v_addc_co_u32 v3, vcc, 0, v3, vcc
  v_add_co_u32 v32, vcc, s95, v2
  s_nop 1
  v_addc_co_u32 v33, vcc, 0, v3, vcc
  global_load_dwordx4 v[224:227], v[2:3], off offset:-4096
  v_add_co_u32 v2, vcc, 0x1800, v2
  s_nop 1
  v_addc_co_u32 v3, vcc, 0, v3, vcc
  global_load_dwordx4 v[240:243], v[2:3], off
  s_cmp_lt_u32 s79, 3
  s_mov_b32 s70, 122176
  s_cselect_b32 s70, 81920, s70
  s_add_u32 m0, s95, 81920
  s_nop 0
  global_load_lds_dwordx4 v[32:33], off offset:-4096
  s_add_u32 m0, s95, s70
  s_nop 0
  global_load_lds_dwordx4 v[32:33], off offset:0
  v_add_co_u32 v32, vcc, 0x2000, v32
  s_nop 1
  v_addc_co_u32 v33, vcc, 0, v33, vcc
  s_add_u32 m0, s95, 2048
  s_nop 0
  global_load_lds_dwordx4 v[32:33], off offset:0
  s_add_u32 m0, s95, 130368
  s_cmp_ge_u32 s79, 2
  s_cbranch_scc1 L_sc
  global_load_lds_dwordx4 v[32:33], off offset:-4096
L_sc:
  s_mul_i32 s85, s84, 20
  s_add_u32 s85, s85, s3
  s_mul_i32 s94, s26, 48
  s_add_u32 s94, s94, s85
  s_mul_i32 s94, s94, 104
  v_lshrrev_b32 v30, 3, v0
  v_lshlrev_b32 v30, 4, v30
  v_and_b32 v29, 0x70, v1
  s_mul_i32 s76, s3, 4064
  s_add_u32 s76, s76, 131136
  s_cmp_eq_u32 s84, 0
  s_cbranch_scc1 L_g0
  s_waitcnt lgkmcnt(0)
  s_mov_b32 s40, s10
  s_and_b32 s41, s11, 0xffff
  s_mov_b32 s42, 156
  s_mov_b32 s43, 0x20000
  s_mov_b32 m0, 129472
  s_mov_b64 exec, 0x7ff
  buffer_load_dwordx4 v1, s[40:43], 0 offen lds
  s_mov_b64 exec, -1
  s_lshl_b32 s85, s85, 2
  s_add_u32 s85, s85, 129728
  s_mul_i32 s72, s84, 3
  s_sub_u32 s72, 4, s72
  s_cmp_eq_u32 s26, 85
  s_cselect_b32 s72, s72, 6
  s_lshl_b32 s44, s3, 7
  s_mul_i32 s45, s3, 5280
  s_lshl_b32 s46, s3, 2
  s_lshl_b32 s47, s3, 1
  s_lshl_b32 s82, s3, 12
  s_and_b32 s98, s3, 1
  s_lshr_b32 s99, s3, 1
  s_mul_i32 s68, s99, 3072
  s_lshl_b32 s83, s98, 3
  s_add_u32 s68, s68, s83
  v_add_u32_e64 v59, s68, v1
  s_lshl_b32 s69, s99, 3
  s_lshr_b32 s69, 0x05030200, s69
  s_and_b32 s69, s69, 0xff
  s_lshl_b32 s69, s69, 9
  s_lshl_b32 s70, s98, 2
  s_add_u32 s101, s69, s70
  s_mov_b32 s99, 0x05040100
  s_mov_b32 s100, 0x07060302
  v_mov_b32 v2, 129664
  v_mov_b32 v109, 0
  v_mov_b32 v108, 0
  v_mov_b64 v[32:33], 0
  v_mov_b64 v[34:35], 0
  v_mov_b64 v[36:37], 0
  v_mov_b64 v[38:39], 0
  v_mov_b64 v[40:41], 0
  v_mov_b64 v[42:43], 0
  v_mov_b64 v[44:45], 0
  v_mov_b64 v[46:47], 0
  v_mov_b64 v[48:49], 0
  v_mov_b64 v[50:51], 0
  v_mov_b64 v[52:53], 0
  v_mov_b64 v[54:55], 0
  v_mov_b64 v[56:57], 0
  v_add_u32 v250, 77824, v1
  s_waitcnt vmcnt(6)
  v_add_u32 v251, 125248, v1
  v_lshrrev_b32 v3, 5, v0
  v_lshl_add_u32 v3, v3, 2, v2
  s_mov_b32 s28, s4
  s_and_b32 s29, s5, 0xffff
  s_mov_b32 s30, 425984
  s_mov_b32 s31, 0x20000
  s_mov_b32 s32, s6
  s_and_b32 s33, s7, 0xffff
  s_mov_b32 s34, 12800000
  s_mov_b32 s35, 0x20000
  ds_write_b128 v2, v[32:35] offset:16
  s_lshl_b32 s68, s79, 6
  v_add_u32 v29, s68, v0
  v_mul_u32_u24 v30, 2521, v29
  v_lshrrev_b32 v30, 16, v30
  v_mul_u32_u24 v30, 12, v30
  v_lshl_add_u32 v28, v29, 1, v30
  v_add_u32 v29, 256, v29
  v_mul_u32_u24 v30, 2521, v29
  v_lshrrev_b32 v30, 16, v30
  v_mul_u32_u24 v30, 12, v30
  v_lshl_add_u32 v58, v29, 1, v30
  v_add_u32 v29, 256, v29
  v_mul_u32_u24 v30, 2521, v29
  v_lshrrev_b32 v30, 16, v30
  v_mul_u32_u24 v30, 12, v30
  v_lshl_add_u32 v111, v29, 1, v30
  v_cmp_gt_u32 vcc, 676, v29
  s_nop 0
  s_mov_b64 s[92:93], vcc
  v_lshlrev_b32 v29, 3, v0
  s_mov_b32 exec_hi, 0xffff
  ds_write_b64 v29, v[32:33] offset:1664
  s_mov_b32 exec_hi, -1
  s_waitcnt vmcnt(4)
  ds_write_b32 v243, v32
  ds_write_b32 v243, v32 offset:43328
  s_waitcnt vmcnt(0)
  ds_read_b64 v[112:113], v240 offset:0
  ds_read_b64 v[114:115], v240 offset:8
  ds_read_b64 v[116:117], v240 offset:32
  ds_read_b64 v[118:119], v240 offset:40
  ds_read_u16 v110, v241
  s_mov_b64 exec, 0x3ffffff
  s_waitcnt lgkmcnt(0)
  ds_write_b16 v242, v110
  v_lshlrev_b32 v109, 17, v110
  v_lshrrev_b32 v109, 1, v109
  s_mov_b64 exec, -1
  v_add_u32 v225, s44, v225
  v_add_u32 v226, s44, v226
  v_add_u32_e64 v227, s44, v227
  s_waitcnt lgkmcnt(0)
  s_barrier
  ds_read_b64_tr_b16 v[60:61], v225 offset:35328
  ds_read_b64_tr_b16 v[62:63], v225 offset:40736
  ds_read_b64_tr_b16 v[64:65], v226 offset:35328
  ds_read_b64_tr_b16 v[66:67], v227 offset:35328
  ds_read_b64_tr_b16 v[68:69], v225 offset:35392
  ds_read_b64_tr_b16 v[70:71], v225 offset:40800
  ds_read_b64_tr_b16 v[72:73], v226 offset:35392
  ds_read_b64_tr_b16 v[74:75], v227 offset:35392
  ds_read_b64_tr_b16 v[76:77], v225 offset:35840
  ds_read_b64_tr_b16 v[78:79], v225 offset:41248
  ds_read_b64_tr_b16 v[80:81], v226 offset:35840
  ds_read_b64_tr_b16 v[82:83], v227 offset:35840
  ds_read_b64_tr_b16 v[84:85], v225 offset:35904
  ds_read_b64_tr_b16 v[86:87], v225 offset:41312
  ds_read_b64_tr_b16 v[88:89], v226 offset:35904
  ds_read_b64_tr_b16 v[90:91], v227 offset:35904
  s_waitcnt lgkmcnt(14)
  v_mfma_f32_32x32x16_bf16 v[120:135], v[112:115], v[60:63], 0
  s_waitcnt lgkmcnt(12)
  v_mfma_f32_32x32x16_bf16 v[120:135], v[116:119], v[64:67], v[120:135]
  ds_read_b64_tr_b16 v[92:93], v225 offset:36352
  ds_read_b64_tr_b16 v[94:95], v225 offset:41760
  ds_read_b64_tr_b16 v[96:97], v226 offset:36352
  ds_read_b64_tr_b16 v[98:99], v227 offset:36352
  s_waitcnt lgkmcnt(14)
  v_mfma_f32_32x32x16_bf16 v[136:151], v[112:115], v[68:71], 0
  s_waitcnt lgkmcnt(12)
  v_mfma_f32_32x32x16_bf16 v[136:151], v[116:119], v[72:75], v[136:151]
  ds_read_b64_tr_b16 v[100:101], v225 offset:36416
  ds_read_b64_tr_b16 v[102:103], v225 offset:41824
  ds_read_b64_tr_b16 v[104:105], v226 offset:36416
  ds_read_b64_tr_b16 v[106:107], v227 offset:36416
  s_waitcnt lgkmcnt(14)
  v_mfma_f32_32x32x16_bf16 v[152:167], v[112:115], v[76:79], 0
  s_waitcnt lgkmcnt(12)
  v_mfma_f32_32x32x16_bf16 v[152:167], v[116:119], v[80:83], v[152:167]
  s_waitcnt lgkmcnt(10)
  v_mfma_f32_32x32x16_bf16 v[168:183], v[112:115], v[84:87], 0
  s_waitcnt lgkmcnt(8)
  v_mfma_f32_32x32x16_bf16 v[168:183], v[116:119], v[88:91], v[168:183]
  ds_read_b128 v[228:231], v250 offset:6144
  ds_read_b128 v[232:235], v251 offset:0
  ds_read_b128 v[4:7], v250 offset:3072
  ds_read_b128 v[8:11], v251 offset:2048
  ds_read_b128 v[20:23], v250 offset:1024
  ds_read_b128 v[24:27], v250 offset:2048
  ds_read_b128 v[216:219], v250 offset:4096
  ds_read_b128 v[220:223], v250 offset:5120
  ds_read_b128 v[236:239], v251 offset:1024
  s_waitcnt lgkmcnt(14)
  v_mfma_f32_32x32x16_bf16 v[184:199], v[112:115], v[92:95], 0
  s_waitcnt lgkmcnt(13)
  v_mfma_f32_32x32x16_bf16 v[184:199], v[116:119], v[96:99], v[184:199]
  s_waitcnt lgkmcnt(11)
  v_mfma_f32_32x32x16_bf16 v[200:215], v[112:115], v[100:103], 0
  s_waitcnt lgkmcnt(9)
  v_mfma_f32_32x32x16_bf16 v[200:215], v[116:119], v[104:107], v[200:215]
  s_waitcnt lgkmcnt(8)
  v_add_u32 v228, s46, v228
  v_add_u32 v229, s46, v229
  v_add_u32 v231, s83, v231
  v_add_u32 v230, s101, v230
  s_waitcnt lgkmcnt(7)
  v_mad_u32_u24 v232, v233, s3, v232
  v_add_u32 v234, s47, v234
  v_mad_u32_u24 v233, v233, 8, v232
  v_add_u32 v246, s82, v235
  v_add_u32 v247, 2048, v246
  v_add_u32 v31, 0, v234
  v_and_b32 v31, 3, v31
  v_lshl_add_u32 v244, v31, 4, v232
  v_add_u32 v31, 1, v234
  v_and_b32 v31, 3, v31
  v_lshl_add_u32 v245, v31, 4, v232
  v_add_u32 v245, 1664, v245
  v_add_u32 v31, 0, v234
  v_and_b32 v31, 3, v31
  v_lshl_add_u32 v248, v31, 4, v233
  v_add_u32 v31, 1, v234
  v_and_b32 v31, 3, v31
  v_lshl_add_u32 v249, v31, 4, v233
  v_add_u32 v249, 1664, v249
  s_waitcnt lgkmcnt(5)
  v_add_u32 v10, s76, v10
  v_add_u32 v4, s76, v4
  v_add_u32 v5, s76, v5
  ds_write_b32 v10, v7 offset:2880
  v_add_u32 v11, s45, v11
  s_waitcnt lgkmcnt(5)
  v_add_u32 v20, s45, v20
  v_add_u32 v21, s45, v21
  v_add_u32 v22, s45, v22
  v_add_u32 v23, s45, v23
  s_waitcnt lgkmcnt(4)
  v_add_u32 v24, s45, v24
  v_add_u32 v25, s45, v25
  v_add_u32 v26, s45, v26
  v_add_u32 v27, s45, v27
  s_mov_b32 exec_lo, 0
  v_mov_b32 v120, v136
  s_mov_b32 exec_lo, -1
  v_cvt_pk_bf16_f32 v60, 0, v120
  ds_write_b16_d16_hi v28, v60
  v_max_f32 v108, |v60|, v108
  s_mov_b32 exec_lo, 0
  v_mov_b32 v152, v168
  s_mov_b32 exec_lo, -1
  v_cvt_pk_bf16_f32 v61, 0, v152
  ds_write_b16_d16_hi v58, v61
  v_max_f32 v108, |v61|, v108
  s_mov_b32 exec_lo, 0
  v_mov_b32 v184, v200
  s_mov_b32 exec_lo, -1
  v_cvt_pk_bf16_f32 v62, 0, v184
  s_mov_b64 exec, s[92:93]
  ds_write_b16_d16_hi v111, v62
  v_max_f32 v108, |v62|, v108
  s_mov_b64 exec, -1
  s_nop 0
  v_permlane32_swap_b32 v108, v109
  v_max_u32 v108, v108, v109
  s_nop 1
  v_max_u32_dpp v108, v108, v108 row_shr:1 row_mask:0xf bank_mask:0xf
  s_nop 1
  v_max_u32_dpp v108, v108, v108 row_shr:2 row_mask:0xf bank_mask:0xf
  s_nop 1
  v_max_u32_dpp v108, v108, v108 row_shr:4 row_mask:0xf bank_mask:0xf
  s_nop 1
  v_max_u32_dpp v108, v108, v108 row_shr:8 row_mask:0xf bank_mask:0xf
  s_nop 1
  v_max_u32_dpp v108, v108, v108 row_bcast:15 row_mask:0xa bank_mask:0xf
  s_mov_b32 exec_lo, 0x80000000
  s_mov_b32 exec_hi, 0x80000000
  ds_max_u32 v3, v108 offset:24
  s_mov_b64 exec, -1
  s_setprio 0
  s_waitcnt lgkmcnt(0)
  s_barrier
  s_branch L_w2
L_g0:
  s_waitcnt lgkmcnt(0)
  s_mov_b32 s36, s8
  s_and_b32 s37, s9, 0xffff
  s_mov_b32 s38, 105456
  s_mov_b32 s39, 0x20000
  s_add_u32 m0, s95, 41984
  s_add_u32 s81, s95, 70304
  buffer_load_dwordx4 v1, s[36:39], s81 offen lds
  s_add_u32 m0, s95, 46080
  s_add_u32 s81, s95, 74400
  buffer_load_dwordx4 v1, s[36:39], s81 offen lds
  s_add_u32 m0, s95, 50176
  s_add_u32 s81, s95, 78496
  buffer_load_dwordx4 v1, s[36:39], s81 offen lds
  s_add_u32 m0, s95, 54272
  s_add_u32 s81, s95, 82592
  buffer_load_dwordx4 v1, s[36:39], s81 offen lds
  s_add_u32 m0, s95, 58368
  s_add_u32 s81, s95, 86688
  buffer_load_dwordx4 v1, s[36:39], s81 offen lds
  s_add_u32 m0, s95, 62464
  s_add_u32 s81, s95, 90784
  buffer_load_dwordx4 v1, s[36:39], s81 offen lds
  s_add_u32 m0, s95, 66560
  s_add_u32 s81, s95, 94880
  buffer_load_dwordx4 v1, s[36:39], s81 offen lds
  s_add_u32 m0, s95, 70656
  s_add_u32 s81, s95, 98976
  buffer_load_dwordx4 v1, s[36:39], s81 offen lds
  s_cmp_eq_u32 s79, 3
  s_cbranch_scc1 L_st3
  s_add_u32 m0, s95, 74752
  s_add_u32 s81, s95, 103072
  buffer_load_dwordx4 v1, s[36:39], s81 offen lds
L_st3:
  s_mov_b32 s28, s4
  s_and_b32 s29, s5, 0xffff
  s_mov_b32 s30, 425984
  s_mov_b32 s31, 0x20000
  buffer_load_dwordx4 v[16:19], v30, s[28:31], s94 offen
  s_add_u32 s94, s94, 416
  buffer_load_dwordx4 v[104:107], v30, s[28:31], s94 offen
  s_add_u32 s94, s94, 416
  s_mov_b32 s32, s6
  s_and_b32 s33, s7, 0xffff
  s_mov_b32 s34, 12800000
  s_mov_b32 s35, 0x20000
  s_mul_i32 s96, s79, 3072
  s_mul_i32 s97, s79, 2704
  v_lshrrev_b32 v31, 5, v0
  v_mul_u32_u24 v31, 184, v31
  v_sub_u32 v31, v1, v31
  s_add_u32 m0, s96, 85312
  s_add_u32 s81, s97, 35152
  buffer_load_dwordx4 v1, s[36:39], s81 offen lds
  s_lshl_b32 s85, s85, 2
  s_add_u32 s85, s85, 129728
  s_mul_i32 s72, s84, 3
  s_sub_u32 s72, 4, s72
  s_cmp_eq_u32 s26, 85
  s_cselect_b32 s72, s72, 6
  s_add_u32 m0, s96, 86336
  s_add_u32 s81, s97, 36176
  buffer_load_dwordx4 v31, s[36:39], s81 offen lds
  s_lshl_b32 s44, s3, 7
  s_mul_i32 s45, s3, 5280
  s_lshl_b32 s46, s3, 2
  s_lshl_b32 s47, s3, 1
  s_lshl_b32 s82, s3, 12
  s_add_u32 m0, s96, 87360
  s_add_u32 s81, s97, 37016
  buffer_load_dwordx4 v1, s[36:39], s81 offen lds
  s_and_b32 s98, s3, 1
  s_lshr_b32 s99, s3, 1
  s_mul_i32 s68, s99, 3072
  s_lshl_b32 s83, s98, 3
  s_add_u32 s68, s68, s83
  s_add_u32 m0, s96, 97600
  s_add_u32 s81, s97, 45968
  buffer_load_dwordx4 v1, s[36:39], s81 offen lds
  v_add_u32 v59, s68, v1
  s_lshl_b32 s69, s99, 3
  s_lshr_b32 s69, 0x05030200, s69
  s_and_b32 s69, s69, 0xff
  s_lshl_b32 s69, s69, 9
  s_add_u32 m0, s96, 98624
  s_add_u32 s81, s97, 46992
  buffer_load_dwordx4 v31, s[36:39], s81 offen lds
  s_lshl_b32 s70, s98, 2
  s_add_u32 s101, s69, s70
  s_mov_b32 s99, 0x05040100
  s_mov_b32 s100, 0x07060302
  v_mov_b32 v2, 129664
  s_add_u32 m0, s96, 99648
  s_add_u32 s81, s97, 47832
  buffer_load_dwordx4 v1, s[36:39], s81 offen lds
  v_mov_b32 v109, 0
  v_mov_b32 v108, 0
  v_mov_b64 v[32:33], 0
  v_mov_b64 v[34:35], 0
  v_mov_b64 v[36:37], 0
  s_add_u32 m0, s96, 109888
  s_add_u32 s81, s97, 56784
  buffer_load_dwordx4 v1, s[36:39], s81 offen lds
  v_mov_b64 v[38:39], 0
  v_mov_b64 v[40:41], 0
  v_mov_b64 v[42:43], 0
  v_mov_b64 v[44:45], 0
  v_mov_b64 v[46:47], 0
  s_add_u32 m0, s96, 110912
  s_add_u32 s81, s97, 57808
  buffer_load_dwordx4 v31, s[36:39], s81 offen lds
  v_mov_b64 v[48:49], 0
  v_mov_b64 v[50:51], 0
  v_mov_b64 v[52:53], 0
  v_mov_b64 v[54:55], 0
  v_mov_b64 v[56:57], 0
  s_add_u32 m0, s96, 111936
  s_add_u32 s81, s97, 58648
  buffer_load_dwordx4 v1, s[36:39], s81 offen lds
  v_add_u32 v250, 77824, v1
  s_waitcnt vmcnt(19)
  v_add_u32 v251, 125248, v1
  v_lshrrev_b32_e64 v3, 5, v0
  v_lshl_add_u32 v3, v3, 2, v2
  s_cmp_lg_u32 s79, 0
  s_cbranch_scc1 L_st2
  s_add_u32 m0, s96, 122176
  s_add_u32 s81, s97, 67600
  buffer_load_dwordx4 v1, s[36:39], s81 offen lds
  s_add_u32 m0, s96, 123200
  s_add_u32 s81, s97, 68624
  buffer_load_dwordx4 v31, s[36:39], s81 offen lds
  s_add_u32 m0, s96, 124224
  s_add_u32 s81, s97, 69464
  buffer_load_dwordx4 v1, s[36:39], s81 offen lds
L_st2:
  s_add_u32 m0, s95, 6144
  s_add_u32 s81, s95, 0
  buffer_load_dwordx4 v1, s[36:39], s81 offen lds
  s_add_u32 m0, s95, 10240
  s_add_u32 s81, s95, 4096
  buffer_load_dwordx4 v1, s[36:39], s81 offen lds
  s_add_u32 m0, s95, 14336
  s_add_u32 s81, s95, 8192
  buffer_load_dwordx4 v1, s[36:39], s81 offen lds
  s_add_u32 m0, s95, 18432
  s_add_u32 s81, s95, 12288
  buffer_load_dwordx4 v1, s[36:39], s81 offen lds
  s_waitcnt vmcnt(15)
  s_barrier
  ds_read_b128 v[224:227], v250 offset:0
  ds_read_b128 v[228:231], v250 offset:6144
  ds_read_b128 v[232:235], v251 offset:0
  ds_read_b128 v[4:7], v250 offset:3072
  ds_read_b128 v[8:11], v251 offset:2048
  ds_read_b128 v[20:23], v250 offset:1024
  ds_read_b128 v[24:27], v250 offset:2048
  ds_read_b128 v[216:219], v250 offset:4096
  ds_read_b128 v[220:223], v250 offset:5120
  ds_read_b128 v[236:239], v251 offset:1024
  s_add_u32 m0, s95, 22528
  s_add_u32 s81, s95, 16384
  buffer_load_dwordx4 v1, s[36:39], s81 offen lds
  s_add_u32 m0, s95, 26624
  s_add_u32 s81, s95, 20480
  buffer_load_dwordx4 v1, s[36:39], s81 offen lds
  s_add_u32 m0, s95, 30720
  s_add_u32 s81, s95, 24576
  buffer_load_dwordx4 v1, s[36:39], s81 offen lds
  s_add_u32 m0, s95, 34816
  s_add_u32 s81, s95, 28672
  buffer_load_dwordx4 v1, s[36:39], s81 offen lds
  s_cmp_eq_u32 s79, 3
  s_cbranch_scc1 L_st1
  s_add_u32 m0, s95, 38912
  s_add_u32 s81, s95, 32768
  buffer_load_dwordx4 v1, s[36:39], s81 offen lds
L_st1:
  s_waitcnt vmcnt(18)
  v_lshl_add_u32 v16, v16, 7, v29
  v_lshl_add_u32 v17, v17, 7, v29
  v_lshl_add_u32 v18, v18, 7, v29
  v_lshl_add_u32 v19, v19, 7, v29
  s_add_u32 m0, s76, 0
  s_mov_b32 exec_hi, 0xffffff
  buffer_load_dwordx4 v16, s[32:35], 0 offen lds
  s_add_u32 m0, s76, 1056
  s_nop 0
  buffer_load_dwordx4 v17, s[32:35], 0 offen lds
  s_add_u32 m0, s76, 2112
  s_mov_b32 exec_hi, 0xffff
  buffer_load_dwordx4 v18, s[32:35], 0 offen lds
  s_add_u32 m0, s76, 3168
  s_nop 0
  buffer_load_dwordx4 v19, s[32:35], 0 offen lds
  s_mov_b32 exec_hi, -1
  s_waitcnt vmcnt(21)
  v_lshl_add_u32 v104, v104, 7, v29
  v_lshl_add_u32 v105, v105, 7, v29
  v_lshl_add_u32 v106, v106, 7, v29
  v_lshl_add_u32 v107, v107, 7, v29
  s_add_u32 m0, s76, 16256
  s_mov_b32 exec_hi, 0xffffff
  buffer_load_dwordx4 v104, s[32:35], 0 offen lds
  s_add_u32 m0, s76, 17312
  s_nop 0
  buffer_load_dwordx4 v105, s[32:35], 0 offen lds
  s_add_u32 m0, s76, 18368
  s_mov_b32 exec_hi, 0xffff
  buffer_load_dwordx4 v106, s[32:35], 0 offen lds
  s_add_u32 m0, s76, 19424
  s_nop 0
  buffer_load_dwordx4 v107, s[32:35], 0 offen lds
  s_mov_b32 exec_hi, -1
  s_waitcnt lgkmcnt(9)
  v_add_u32 v225, s44, v225
  v_add_u32 v226, s44, v226
  v_add_u32 v227, s44, v227
  s_waitcnt lgkmcnt(8)
  v_add_u32 v228, s46, v228
  v_add_u32 v229, s46, v229
  v_add_u32 v231, s83, v231
  v_add_u32 v230, s101, v230
  s_waitcnt lgkmcnt(7)
  v_mad_u32_u24 v232, v233, s3, v232
  v_add_u32 v234, s47, v234
  v_mad_u32_u24 v233, v233, 8, v232
  v_add_u32 v246, s82, v235
  v_add_u32 v247, 2048, v246
  v_add_u32 v31, 0, v234
  v_and_b32 v31, 3, v31
  v_lshl_add_u32 v244, v31, 4, v232
  v_add_u32 v31, 1, v234
  v_and_b32 v31, 3, v31
  v_lshl_add_u32 v245, v31, 4, v232
  v_add_u32 v245, 1664, v245
  v_add_u32 v31, 0, v234
  v_and_b32 v31, 3, v31
  v_lshl_add_u32 v248, v31, 4, v233
  v_add_u32 v31, 1, v234
  v_and_b32 v31, 3, v31
  v_lshl_add_u32 v249, v31, 4, v233
  v_add_u32 v249, 1664, v249
  s_waitcnt lgkmcnt(5)
  v_add_u32 v10, s76, v10
  v_add_u32 v4, s76, v4
  v_add_u32 v5, s76, v5
  ds_write_b32 v10, v7 offset:2880
  v_add_u32 v11, s45, v11
  s_waitcnt lgkmcnt(5)
  v_add_u32 v20, s45, v20
  v_add_u32 v21, s45, v21
  v_add_u32 v22, s45, v22
  v_add_u32 v23, s45, v23
  s_waitcnt lgkmcnt(4)
  v_add_u32 v24, s45, v24
  v_add_u32 v25, s45, v25
  v_add_u32 v26, s45, v26
  v_add_u32_e64 v27, s45, v27
  s_waitcnt vmcnt(8)
  s_barrier
L_w2:
  ds_read2st64_b32 v[60:61], v228 offset0:0 offset1:6
  ds_read2st64_b32 v[62:63], v228 offset0:12 offset1:18
  ds_read2st64_b32 v[64:65], v228 offset0:24 offset1:30
  ds_read2st64_b32 v[66:67], v228 offset0:36 offset1:42
  ds_read2st64_b32 v[68:69], v228 offset0:96 offset1:102
  ds_read2st64_b32 v[70:71], v229 offset0:108 offset1:114
  ds_read2st64_b32 v[72:73], v229 offset0:120 offset1:126
  ds_read2st64_b32 v[74:75], v229 offset0:132 offset1:138
  s_cmp_ge_u32 s3, 5
  s_cbranch_scc1 L_u0
  v_add_u32 v228, 32, v228
  v_add_u32 v229, 32, v229
  ds_read2st64_b32 v[92:93], v228 offset0:0 offset1:6
  ds_read2st64_b32 v[94:95], v228 offset0:12 offset1:18
  ds_read2st64_b32 v[96:97], v228 offset0:24 offset1:30
  ds_read2st64_b32 v[98:99], v228 offset0:36 offset1:42
  ds_read2st64_b32 v[100:101], v228 offset0:96 offset1:102
  ds_read2st64_b32 v[102:103], v229 offset0:108 offset1:114
  ds_read2st64_b32 v[104:105], v229 offset0:120 offset1:126
  ds_read2st64_b32 v[106:107], v229 offset0:132 offset1:138
  ds_read_b64_tr_b16 v[76:77], v225 offset:0
  ds_read_b64_tr_b16 v[78:79], v225 offset:5408
  ds_read_b64_tr_b16 v[80:81], v226 offset:0
  ds_read_b64_tr_b16 v[82:83], v227 offset:0
  ds_read_b64_tr_b16 v[84:85], v225 offset:64
  ds_read_b64_tr_b16 v[86:87], v225 offset:5472
  ds_read_b64_tr_b16 v[88:89], v226 offset:64
  ds_read_b64_tr_b16 v[90:91], v227 offset:64
  ds_read_b64_tr_b16 v[112:113], v224 offset:0
  ds_read_b64_tr_b16 v[114:115], v224 offset:256
  ds_read_b64_tr_b16 v[116:117], v224 offset:1024
  ds_read_b64_tr_b16 v[118:119], v224 offset:1280
  s_waitcnt lgkmcnt(14)
  v_mfma_f32_16x16x32_bf16 v[108:111], v[60:63], v[60:63], 0
  s_nop 0
  v_mfma_f32_16x16x32_bf16 v[108:111], v[64:67], v[64:67], v[108:111]
  v_mfma_f32_16x16x32_bf16 v[108:111], v[68:71], v[68:71], v[108:111]
  v_mfma_f32_16x16x32_bf16 v[108:111], v[72:75], v[72:75], v[108:111]
  v_perm_b32 v184, v61, v60, s99
  v_perm_b32 v185, v63, v62, s99
  v_perm_b32 v186, v65, v64, s99
  v_perm_b32 v187, v67, v66, s99
  v_perm_b32 v188, v69, v68, s99
  v_perm_b32 v189, v71, v70, s99
  v_perm_b32 v190, v73, v72, s99
  v_perm_b32 v191, v75, v74, s99
  v_mfma_f32_16x16x32_bf16 v[108:111], v[92:95], v[92:95], v[108:111]
  v_mfma_f32_16x16x32_bf16 v[108:111], v[96:99], v[96:99], v[108:111]
  v_mfma_f32_16x16x32_bf16 v[108:111], v[100:103], v[100:103], v[108:111]
  s_waitcnt lgkmcnt(12)
  v_mfma_f32_16x16x32_bf16 v[108:111], v[104:107], v[104:107], v[108:111]
  s_waitcnt lgkmcnt(10)
  v_mfma_f32_16x16x32_bf16 v[28:31], v[76:79], v[76:79], 0
  s_waitcnt lgkmcnt(8)
  v_mfma_f32_16x16x32_bf16 v[28:31], v[80:83], v[80:83], v[28:31]
  s_waitcnt lgkmcnt(6)
  v_mfma_f32_16x16x32_bf16 v[28:31], v[84:87], v[84:87], v[28:31]
  s_nop 0
  s_waitcnt lgkmcnt(4)
  v_mfma_f32_16x16x32_bf16 v[28:31], v[88:91], v[88:91], v[28:31]
  v_perm_b32 v192, v61, v60, s100
  v_perm_b32 v193, v63, v62, s100
  v_perm_b32 v194, v65, v64, s100
  v_perm_b32 v195, v67, v66, s100
  v_perm_b32 v196, v69, v68, s100
  v_perm_b32 v197, v71, v70, s100
  v_perm_b32 v198, v73, v72, s100
  v_perm_b32 v199, v75, v74, s100
  v_max3_f32 v28, v28, v29, 0
  v_perm_b32 v60, v93, v92, s99
  v_perm_b32 v61, v95, v94, s99
  v_max3_f32 v108, v108, v109, 0
  v_perm_b32 v62, v97, v96, s99
  v_max3_f32 v28, v28, v30, v31
  v_perm_b32 v63, v99, v98, s99
  v_max3_f32 v108, v108, v110, v111
  v_perm_b32 v64, v101, v100, s99
  v_perm_b32 v65, v103, v102, s99
  v_permlane32_swap_b32 v28, v108
  v_perm_b32 v66, v105, v104, s99
  v_max_u32_e64 v28, v28, v108
  v_perm_b32 v67, v107, v106, s99
  s_nop 0
  v_max_u32_dpp v28, v28, v28 row_shr:1 row_mask:0xf bank_mask:0xf
  v_perm_b32 v68, v93, v92, s100
  v_perm_b32 v69, v95, v94, s100
  v_max_u32_dpp v28, v28, v28 row_shr:2 row_mask:0xf bank_mask:0xf
  v_perm_b32 v70, v97, v96, s100
  s_nop 0
  v_max_u32_dpp v28, v28, v28 row_shr:4 row_mask:0xf bank_mask:0xf
  v_perm_b32 v71, v99, v98, s100
  s_nop 0
  v_max_u32_dpp v28, v28, v28 row_shr:8 row_mask:0xf bank_mask:0xf
  v_perm_b32 v72, v101, v100, s100
  v_perm_b32 v73, v103, v102, s100
  v_max_u32_dpp v28, v28, v28 row_bcast:15 row_mask:0xa bank_mask:0xf
  v_perm_b32 v74, v105, v104, s100
  s_mov_b32 exec_lo, 0x80000000
  s_mov_b32 exec_hi, 0x80000000
  ds_max_u32 v3, v28 offset:16
  s_mov_b64 exec, -1
  v_perm_b32 v75, v107, v106, s100
  s_branch L_u1
L_u0:
  ds_read_b64_tr_b16 v[76:77], v225 offset:0
  ds_read_b64_tr_b16 v[78:79], v225 offset:5408
  ds_read_b64_tr_b16 v[80:81], v226 offset:0
  ds_read_b64_tr_b16 v[82:83], v227 offset:0
  ds_read_b64_tr_b16 v[84:85], v225 offset:64
  ds_read_b64_tr_b16 v[86:87], v225 offset:5472
  ds_read_b64_tr_b16 v[88:89], v226 offset:64
  ds_read_b64_tr_b16 v[90:91], v227 offset:64
  ds_read_b64_tr_b16 v[92:93], v225 offset:384
  ds_read_b64_tr_b16 v[94:95], v225 offset:5792
  ds_read_b64_tr_b16 v[96:97], v226 offset:384
  ds_read_b64_tr_b16 v[98:99], v227 offset:384
  ds_read_b64_tr_b16 v[100:101], v225 offset:448
  ds_read_b64_tr_b16 v[102:103], v225 offset:5856
  ds_read_b64_tr_b16 v[104:105], v226 offset:448
  ds_read_b64_tr_b16 v[106:107], v227 offset:448
  ds_read_b64_tr_b16 v[112:113], v224 offset:0
  ds_read_b64_tr_b16 v[114:115], v224 offset:256
  ds_read_b64_tr_b16 v[116:117], v224 offset:1024
  ds_read_b64_tr_b16 v[118:119], v224 offset:1280
  s_waitcnt lgkmcnt(14)
  v_mfma_f32_16x16x32_bf16 v[108:111], v[60:63], v[60:63], 0
  v_mfma_f32_16x16x32_bf16 v[108:111], v[64:67], v[64:67], v[108:111]
  v_mfma_f32_16x16x32_bf16 v[108:111], v[68:71], v[68:71], v[108:111]
  v_mfma_f32_16x16x32_bf16 v[108:111], v[72:75], v[72:75], v[108:111]
  v_mfma_f32_16x16x32_bf16 v[28:31], v[76:79], v[76:79], 0
  s_nop 0
  v_mfma_f32_16x16x32_bf16 v[28:31], v[80:83], v[80:83], v[28:31]
  v_mfma_f32_16x16x32_bf16 v[28:31], v[84:87], v[84:87], v[28:31]
  s_waitcnt lgkmcnt(12)
  v_mfma_f32_16x16x32_bf16 v[28:31], v[88:91], v[88:91], v[28:31]
  s_waitcnt lgkmcnt(10)
  v_mfma_f32_16x16x32_bf16 v[28:31], v[92:95], v[92:95], v[28:31]
  s_waitcnt lgkmcnt(8)
  v_mfma_f32_16x16x32_bf16 v[28:31], v[96:99], v[96:99], v[28:31]
  s_waitcnt lgkmcnt(6)
  v_mfma_f32_16x16x32_bf16 v[28:31], v[100:103], v[100:103], v[28:31]
  s_waitcnt lgkmcnt(4)
  v_mfma_f32_16x16x32_bf16 v[28:31], v[104:107], v[104:107], v[28:31]
  v_perm_b32 v184, v61, v60, s99
  v_perm_b32 v185, v63, v62, s99
  v_perm_b32 v186, v65, v64, s99
  v_perm_b32 v187, v67, v66, s99
  s_nop 3
  v_max3_f32 v28, v28, v29, 0
  v_perm_b32 v188, v69, v68, s99
  v_max3_f32 v108, v108, v109, 0
  v_perm_b32 v189, v71, v70, s99
  v_max3_f32 v28, v28, v30, v31
  v_perm_b32 v190, v73, v72, s99
  v_max3_f32 v108, v108, v110, v111
  v_perm_b32 v191, v75, v74, s99
  s_nop 0
  v_permlane32_swap_b32 v28, v108
  v_perm_b32 v192, v61, v60, s100
  v_max_u32 v28, v28, v108
  v_perm_b32 v193, v63, v62, s100
  s_nop 0
  v_max_u32_dpp v28, v28, v28 row_shr:1 row_mask:0xf bank_mask:0xf
  v_perm_b32 v194, v65, v64, s100
  s_nop 0
  v_max_u32_dpp v28, v28, v28 row_shr:2 row_mask:0xf bank_mask:0xf
  v_perm_b32 v195, v67, v66, s100
  s_nop 0
  v_max_u32_dpp v28, v28, v28 row_shr:4 row_mask:0xf bank_mask:0xf
  v_perm_b32 v196, v69, v68, s100
  s_nop 0
  v_max_u32_dpp v28, v28, v28 row_shr:8 row_mask:0xf bank_mask:0xf
  v_perm_b32 v197, v71, v70, s100
  s_nop 0
  v_max_u32_dpp v28, v28, v28 row_bcast:15 row_mask:0xa bank_mask:0xf
  v_perm_b32 v198, v73, v72, s100
  s_mov_b32 exec_lo, 0x80000000
  s_mov_b32 exec_hi, 0x80000000
  ds_max_u32 v3, v28 offset:16
  s_mov_b64 exec, -1
  v_perm_b32 v199, v75, v74, s100
  v_add_u32 v248, 12288, v246
  v_add_u32 v249, 12288, v247
  s_cmp_lg_u32 s3, 7
  s_cbranch_scc1 L_u1
  s_mov_b32 exec_lo, 0xfffffff0
  s_mov_b32 exec_hi, 0xfffffff0
  v_mov_b32 v249, 1048576
  s_mov_b64 exec, -1
L_u1:
  s_waitcnt lgkmcnt(0)
  s_barrier
  ds_read_b128 v[108:111], v2 offset:16
  s_mul_i32 s68, s3, 384
  v_lshrrev_b32 v29, 2, v0
  v_mul_u32_u24 v29, 24, v29
  v_add_u32 v29, s68, v29
  v_and_b32 v30, 3, v0
  v_lshlrev_b32_e64 v30, 3, v30
  ds_read_b64 v[224:225], v29 offset:2048
  ds_read_b64 v[226:227], v29 offset:2056
  ds_read_b64 v[228:229], v29 offset:2064
  s_waitcnt lgkmcnt(3)
  v_add_u32 v108, 0x3f800000, v108
  v_add_u32 v109, 0x3f800000, v109
  v_lshrrev_b32 v108, 24, v108
  v_lshrrev_b32 v109, 24, v109
  v_sub_u32 v108, 267, v108
  s_mov_b32 vcc_lo, 0x4000000
  v_min_u32 v108, 167, v108
  s_mov_b32 vcc_hi, 0x4000000
  v_readfirstlane_b32 s74, v108
  v_cndmask_b32 v250, v110, v111, vcc
  v_mul_u32_u24 v108, 0x800080, v108
  v_lshrrev_b32 v250, 23, v250
  v_and_b32 v216, v216, v108
  v_and_b32 v217, v217, v108
  v_and_b32 v218, v218, v108
  v_and_b32 v219, v219, v108
  v_and_b32 v220, v220, v108
  v_and_b32 v221, v221, v108
  v_and_b32 v222, v222, v108
  v_and_b32 v223, v223, v108
  v_mfma_f32_32x32x16_bf16 v[152:167], v[216:219], v[76:79], 0
  v_add_u32_e64 v250, v250, v109
  v_sub_u32 v250, 388, v250
  v_mfma_f32_32x32x16_bf16 v[168:183], v[216:219], v[84:87], 0
  s_movk_i32 s98, 167
  v_med3_i32 v250, v250, 1, s98
  v_mfma_f32_32x32x16_bf16 v[152:167], v[220:223], v[80:83], v[152:167]
  v_subrev_u32 v110, 127, v250
  v_lshlrev_b32_e64 v250, 23, v250
  v_mfma_f32_32x32x16_bf16 v[168:183], v[220:223], v[88:91], v[168:183]
  v_cmp_gt_i32 vcc, 0, v110
  v_mul_u32_u24 v110, 0x800080, v110
  s_cbranch_vccnz L_sdown
  v_add_u32 v112, v112, v110
  v_add_u32 v113, v113, v110
  v_add_u32 v114, v114, v110
  v_add_u32 v115, v115, v110
  v_add_u32 v116, v116, v110
  v_add_u32 v117, v117, v110
  v_add_u32 v118, v118, v110
  v_add_u32_e64 v119, v119, v110
L_scaled:
  v_mfma_f32_32x32x16_bf16 v[120:135], v[184:187], v[112:115], 0
  v_cvt_pk_f16_f32 v152, v152, v153
  v_cvt_pk_f16_f32 v153, v154, v155
  v_cvt_pk_f16_f32 v154, v156, v157
  v_cvt_pk_f16_f32 v155, v158, v159
  ds_write_b128 v246, v[152:155]
  v_xor_b32_e64 v246, 16, v246
  v_mfma_f32_32x32x16_bf16 v[120:135], v[188:191], v[116:119], v[120:135]
  v_cvt_pk_f16_f32 v156, v160, v161
  v_cvt_pk_f16_f32 v157, v162, v163
  v_cvt_pk_f16_f32 v158, v164, v165
  v_cvt_pk_f16_f32 v159, v166, v167
  ds_write_b128 v246, v[156:159]
  v_mfma_f32_32x32x16_bf16 v[136:151], v[192:195], v[112:115], 0
  v_cvt_pk_f16_f32 v168, v168, v169
  v_cvt_pk_f16_f32 v169, v170, v171
  v_cvt_pk_f16_f32 v170, v172, v173
  v_cvt_pk_f16_f32 v171, v174, v175
  ds_write_b128 v247, v[168:171]
  v_xor_b32 v247, 16, v247
  v_mfma_f32_32x32x16_bf16 v[136:151], v[196:199], v[116:119], v[136:151]
  v_cvt_pk_f16_f32 v172, v176, v177
  v_cvt_pk_f16_f32 v173, v178, v179
  v_cvt_pk_f16_f32 v174, v180, v181
  v_cvt_pk_f16_f32 v175, v182, v183
  ds_write_b128 v247, v[172:175]
  s_cmp_ge_u32 s3, 5
  s_cbranch_scc1 L_u2
  v_mfma_f32_32x32x16_bf16 v[184:199], v[60:63], v[112:115], 0
  v_cvt_pk_f16_f32 v120, v120, v121
  v_cvt_pk_f16_f32 v121, v122, v123
  v_cvt_pk_f16_f32 v122, v124, v125
  v_mfma_f32_32x32x16_bf16 v[184:199], v[64:67], v[116:119], v[184:199]
  v_cvt_pk_f16_f32 v123, v126, v127
  ds_write_b128 v244, v[120:123]
  v_xor_b32 v244, 16, v244
  v_mfma_f32_32x32x16_bf16 v[200:215], v[68:71], v[112:115], 0
  v_cvt_pk_f16_f32 v124, v128, v129
  v_cvt_pk_f16_f32 v125, v130, v131
  v_cvt_pk_f16_f32 v126, v132, v133
  v_mfma_f32_32x32x16_bf16 v[200:215], v[72:75], v[116:119], v[200:215]
  v_cvt_pk_f16_f32 v127, v134, v135
  ds_write_b128 v244, v[124:127]
  s_branch L_u3
L_u2:
  v_mfma_f32_32x32x16_bf16 v[184:199], v[216:219], v[92:95], 0
  v_cvt_pk_f16_f32 v120, v120, v121
  v_cvt_pk_f16_f32 v121, v122, v123
  v_cvt_pk_f16_f32 v122, v124, v125
  v_mfma_f32_32x32x16_bf16 v[184:199], v[220:223], v[96:99], v[184:199]
  v_cvt_pk_f16_f32 v123, v126, v127
  ds_write_b128 v244, v[120:123]
  v_xor_b32 v244, 16, v244
  v_mfma_f32_32x32x16_bf16 v[200:215], v[216:219], v[100:103], 0
  v_cvt_pk_f16_f32 v124, v128, v129
  v_cvt_pk_f16_f32 v125, v130, v131
  v_cvt_pk_f16_f32 v126, v132, v133
  v_mfma_f32_32x32x16_bf16 v[200:215], v[220:223], v[104:107], v[200:215]
  v_cvt_pk_f16_f32 v127, v134, v135
  ds_write_b128 v244, v[124:127]
L_u3:
  buffer_load_dwordx4 v[16:19], v6, s[28:31], s94 offen
  s_add_u32 s94, s94, 416
  buffer_load_dwordx4 v[12:15], v6, s[28:31], s94 offen
  s_add_u32 s94, s94, 416
  v_cvt_pk_f16_f32 v136, v136, v137
  s_waitcnt lgkmcnt(8)
  v_xor_b32 v224, v224, v30
  v_cvt_pk_f16_f32 v137, v138, v139
  v_cvt_pk_f16_f32 v138, v140, v141
  v_xor_b32_e64 v232, 32, v224
  v_cvt_pk_f16_f32 v139, v142, v143
  ds_write_b128 v245, v[136:139]
  v_xor_b32 v245, 16, v245
  v_xor_b32 v225, v225, v30
  v_cvt_pk_f16_f32 v140, v144, v145
  v_cvt_pk_f16_f32 v141, v146, v147
  v_cvt_pk_f16_f32 v142, v148, v149
  v_xor_b32_e64 v233, 32, v225
  v_cvt_pk_f16_f32 v143, v150, v151
  ds_write_b128 v245, v[140:143]
  v_cvt_pk_f16_f32 v184, v184, v185
  s_waitcnt lgkmcnt(9)
  v_xor_b32 v226, v226, v30
  v_cvt_pk_f16_f32 v185, v186, v187
  v_cvt_pk_f16_f32 v186, v188, v189
  v_xor_b32 v234, 32, v226
  v_cvt_pk_f16_f32 v187, v190, v191
  ds_write_b128 v248, v[184:187]
  v_xor_b32 v248, 16, v248
  v_xor_b32_e64 v227, v227, v30
  v_cvt_pk_f16_f32 v188, v192, v193
  v_cvt_pk_f16_f32 v189, v194, v195
  v_cvt_pk_f16_f32 v190, v196, v197
  v_xor_b32 v235, 32, v227
  v_cvt_pk_f16_f32 v191, v198, v199
  ds_write_b128 v248, v[188:191]
  v_cvt_pk_f16_f32 v200, v200, v201
  s_waitcnt lgkmcnt(10)
  v_xor_b32_e64 v228, v228, v30
  v_cvt_pk_f16_f32 v201, v202, v203
  v_cvt_pk_f16_f32 v202, v204, v205
  v_xor_b32 v240, 32, v228
  v_cvt_pk_f16_f32 v203, v206, v207
  ds_write_b128 v249, v[200:203]
  v_xor_b32 v249, 16, v249
  v_xor_b32_e64 v229, v229, v30
  v_cvt_pk_f16_f32 v204, v208, v209
  v_cvt_pk_f16_f32 v205, v210, v211
  v_cvt_pk_f16_f32 v206, v212, v213
  v_xor_b32_e64 v241, 32, v229
  v_cvt_pk_f16_f32 v207, v214, v215
  ds_write_b128 v249, v[204:207]
  v_readlane_b32 s0, v250, 0
  v_readlane_b32 s1, v250, 26
  s_sub_u32 s75, 0x7f000000, s0
  s_sub_u32 s1, 0x7f000000, s1
  s_sub_u32 s74, 254, s74
  s_lshl_b32 s74, s74, 23
  s_mov_b32 s92, 0x88888888
  s_mov_b32 s93, 0x88888888
  s_waitcnt lgkmcnt(0)
  s_barrier
  ds_read_b64_tr_b16 v[60:61], v224 offset:0
  ds_read_b64_tr_b16 v[62:63], v225 offset:0
  ds_read_b64_tr_b16 v[64:65], v232 offset:0
  ds_read_b64_tr_b16 v[66:67], v233 offset:0
  ds_read_b64_tr_b16 v[68:69], v224 offset:43328
  ds_read_b64_tr_b16 v[70:71], v225 offset:43328
  ds_read_b64_tr_b16 v[72:73], v232 offset:43328
  ds_read_b64_tr_b16 v[74:75], v233 offset:43328
  ds_read_b64_tr_b16 v[76:77], v226 offset:0
  ds_read_b64_tr_b16 v[78:79], v227 offset:0
  ds_read_b64_tr_b16 v[80:81], v234 offset:0
  ds_read_b64_tr_b16 v[82:83], v235 offset:0
  ds_read_b64_tr_b16 v[84:85], v226 offset:43328
  ds_read_b64_tr_b16 v[86:87], v227 offset:43328
  ds_read_b64_tr_b16 v[88:89], v234 offset:43328
  ds_read_b64_tr_b16 v[90:91], v235 offset:43328
  s_cmp_ge_u32 s3, 6
  s_cbranch_scc1 L_lin
  ds_read_b64_tr_b16 v[92:93], v228 offset:0
  ds_read_b64_tr_b16 v[94:95], v229 offset:0
  ds_read_b64_tr_b16 v[96:97], v240 offset:0
  ds_read_b64_tr_b16 v[98:99], v241 offset:0
  ds_read_b64_tr_b16 v[100:101], v228 offset:43328
  ds_read_b64_tr_b16 v[102:103], v229 offset:43328
  ds_read_b64_tr_b16 v[104:105], v240 offset:43328
  ds_read_b64_tr_b16 v[106:107], v241 offset:43328
  s_waitcnt lgkmcnt(6)
  v_pk_add_f16 v92, v92, v94
  v_pk_add_f16 v93, v93, v95
  ds_write_b64 v59, v[92:93] offset:30720
  s_waitcnt lgkmcnt(5)
  v_pk_add_f16 v96, v96, v98
  v_pk_add_f16 v97, v97, v99
  s_waitcnt lgkmcnt(3)
  v_pk_add_f16 v100, v100, v102
  v_pk_add_f16 v101, v101, v103
  ds_write_b64 v59, v[100:101] offset:32768
  s_waitcnt lgkmcnt(2)
  v_pk_add_f16 v104, v104, v106
  v_pk_add_f16 v105, v105, v107
  v_cndmask_b32 v96, v96, v104, s[92:93]
  v_cndmask_b32 v97, v97, v105, s[92:93]
  ds_write_b64 v59, v[96:97] offset:31744
  ds_write_b32 v230, v104 offset:3072
  ds_write_b32 v230, v105 offset:3088
  s_branch L_p2
L_lin:
  s_and_b32 s98, s3, 1
  s_cselect_b64 vcc, -1, 0
  s_lshl_b32 s99, s98, 5
  v_mov_b32 v31, 0
  v_xor_b32 v236, s99, v236
  v_xor_b32 v237, s99, v237
  v_cndmask_b32 v238, v238, v239, vcc
  ds_read_b64_tr_b16 v[92:93], v236
  ds_read_b64_tr_b16 v[94:95], v237
  ds_read_u16_d16_hi v31, v238
  s_lshl_b32 s98, s98, 10
  v_add_u32 v29, s98, v1
  s_waitcnt lgkmcnt(2)
  v_cvt_f32_f16_e64 v96, v92
  v_cvt_f32_f16_sdwa v97, v92 dst_sel:DWORD dst_unused:UNUSED_PAD src0_sel:WORD_1
  v_mul_f32 v96, s1, v96
  v_mul_f32 v97, s1, v97
  v_mul_f32 v96, s0, v96
  v_mul_f32 v97, s0, v97
  v_cvt_pk_bf16_f32 v92, v96, v97
  v_cvt_f32_f16 v98, v93
  v_cvt_f32_f16_sdwa v99, v93 dst_sel:DWORD dst_unused:UNUSED_PAD src0_sel:WORD_1
  v_mul_f32 v98, s1, v98
  v_mul_f32 v99, s1, v99
  v_mul_f32 v98, s0, v98
  v_mul_f32_e64 v99, s0, v99
  v_cvt_pk_bf16_f32 v93, v98, v99
  s_waitcnt lgkmcnt(1)
  v_cvt_f32_f16 v100, v94
  v_cvt_f32_f16_sdwa v101, v94 dst_sel:DWORD dst_unused:UNUSED_PAD src0_sel:WORD_1
  v_mul_f32 v100, s1, v100
  v_mul_f32 v101, s1, v101
  v_mul_f32 v100, s0, v100
  v_mul_f32 v101, s0, v101
  v_cvt_pk_bf16_f32 v94, v100, v101
  v_cvt_f32_f16 v102, v95
  v_cvt_f32_f16_sdwa v103, v95 dst_sel:DWORD dst_unused:UNUSED_PAD src0_sel:WORD_1
  v_mul_f32 v102, s1, v102
  v_mul_f32 v103, s1, v103
  s_mov_b32 exec_lo, 0
  s_mov_b32 exec_hi, 0xffff
  s_waitcnt lgkmcnt(0)
  v_mov_b32 v102, v31
  s_mov_b64 exec, -1
  v_mul_f32 v102, s0, v102
  v_mul_f32_e64 v103, s0, v103
  v_cvt_pk_bf16_f32 v95, v102, v103
  ds_write_b128 v29, v[92:95] offset:39936
L_p2:
  v_pk_add_f16 v76, v76, v78
  v_pk_add_f16 v77, v77, v79
  ds_write_b64 v59, v[76:77] offset:18432
  v_pk_add_f16 v80, v80, v82
  v_pk_add_f16 v81, v81, v83
  v_pk_add_f16 v84, v84, v86
  v_pk_add_f16 v85, v85, v87
  ds_write_b64 v59, v[84:85] offset:20480
  v_pk_add_f16 v88, v88, v90
  v_pk_add_f16 v89, v89, v91
  v_cndmask_b32 v80, v80, v88, s[92:93]
  v_cndmask_b32 v81, v81, v89, s[92:93]
  ds_write_b64 v59, v[80:81] offset:19456
  ds_write_b32 v230, v88 offset:1024
  ds_write_b32 v230, v89 offset:1040
  v_pk_add_f16 v60, v60, v62
  v_pk_add_f16 v61, v61, v63
  ds_write_b64 v59, v[60:61] offset:6144
  v_pk_add_f16 v64, v64, v66
  v_pk_add_f16 v65, v65, v67
  v_pk_add_f16 v68, v68, v70
  v_pk_add_f16 v69, v69, v71
  ds_write_b64 v59, v[68:69] offset:8192
  v_pk_add_f16 v72, v72, v74
  v_pk_add_f16 v73, v73, v75
  v_cndmask_b32 v64, v64, v72, s[92:93]
  v_cndmask_b32 v65, v65, v73, s[92:93]
  ds_write_b64 v59, v[64:65] offset:7168
  s_cmp_lt_u32 s3, 2
  s_cbranch_scc1 L_p2d
  v_subrev_u32 v230, 1024, v230
  ds_write_b32 v230, v72 offset:0
  ds_write_b32 v230, v73 offset:16
  s_branch L_built
L_p2d:
  ds_write_b64 v231, v[72:73] offset:5120
L_built:
  s_mov_b32 s0, s74
  s_mov_b32 s1, s75
  s_mov_b32 s96, 0x3e000000
  s_mov_b32 s97, 0x43000000
  s_mov_b32 s51, 1
  s_mul_i32 s98, s3, 1536
  s_add_u32 s98, s98, 116736
  s_cmp_lg_u32 s84, 0
  s_cbranch_scc1 L_g1c
  s_sub_u32 s94, s94, 416
  s_waitcnt vmcnt(6)
  ds_read_u16_d16_hi v32, v10 offset:0
  ds_read_u16_d16_hi v33, v10 offset:2
  ds_read_u16_d16_hi v34, v10 offset:2112
  ds_read_u16_d16_hi v35, v10 offset:2114
  ds_read_u16_d16_hi v36, v10 offset:128
  ds_read_u16_d16_hi v37, v10 offset:130
  ds_read_u16_d16_hi v38, v10 offset:2240
  ds_read_u16_d16_hi v39, v10 offset:2242
  ds_read_u16_d16_hi v40, v10 offset:256
  ds_read_u16_d16_hi v41, v10 offset:258
  ds_read_u16_d16_hi v42, v10 offset:2368
  ds_read_u16_d16_hi v43, v10 offset:2370
  ds_read_u16_d16_hi v44, v10 offset:384
  ds_read_u16_d16_hi v45, v10 offset:386
  ds_read_u16_d16_hi v46, v10 offset:2496
  ds_read_u16_d16_hi v47, v10 offset:2498
  ds_read_u16_d16_hi v48, v10 offset:512
  ds_read_u16_d16_hi v49, v10 offset:514
  ds_read_u16_d16_hi v50, v10 offset:2624
  ds_read_u16_d16_hi v51, v10 offset:2626
  ds_read_u16_d16_hi v52, v10 offset:640
  ds_read_u16_d16_hi v53, v10 offset:642
  ds_read_u16_d16_hi v54, v10 offset:2752
  ds_read_u16_d16_hi v55, v10 offset:2754
  ds_read_u16_d16_hi v56, v10 offset:768
  ds_read_u16_d16_hi v57, v10 offset:770
  s_waitcnt lgkmcnt(14)
  v_max3_f32 v58, |v32|, |v33|, 0
  v_cvt_pk_f16_f32 v184, v32, v33
  v_max3_f32 v58, |v34|, |v35|, v58
  v_cvt_pk_f16_f32 v185, v34, v35
  v_max3_f32 v58, |v36|, |v37|, v58
  v_cvt_pk_f16_f32 v186, v36, v37
  v_max3_f32 v58, |v38|, |v39|, v58
  v_cvt_pk_f16_f32 v187, v38, v39
  v_max3_f32 v58, |v40|, |v41|, v58
  v_cvt_pk_f16_f32 v188, v40, v41
  v_max3_f32 v58, |v42|, |v43|, v58
  v_cvt_pk_f16_f32 v189, v42, v43
  s_waitcnt lgkmcnt(12)
  v_max3_f32 v58, |v44|, |v45|, v58
  v_cvt_pk_f16_f32 v190, v44, v45
  s_waitcnt lgkmcnt(10)
  v_max3_f32 v58, |v46|, |v47|, v58
  v_cvt_pk_f16_f32 v191, v46, v47
  s_waitcnt lgkmcnt(8)
  v_max3_f32 v58, |v48|, |v49|, v58
  v_cvt_pk_f16_f32 v192, v48, v49
  s_waitcnt lgkmcnt(6)
  v_max3_f32 v58, |v50|, |v51|, v58
  v_cvt_pk_f16_f32 v193, v50, v51
  s_waitcnt lgkmcnt(4)
  v_max3_f32 v58, |v52|, |v53|, v58
  v_cvt_pk_f16_f32 v194, v52, v53
  s_waitcnt lgkmcnt(2)
  v_max3_f32 v58, |v54|, |v55|, v58
  v_cvt_pk_f16_f32 v195, v54, v55
  s_waitcnt lgkmcnt(0)
  v_max3_f32 v58, |v56|, |v57|, v58
  v_cvt_pk_f16_f32 v196, v56, v57
  s_waitcnt lgkmcnt(0)
  s_barrier
  s_branch L_cin_go
L_g1c:
  s_waitcnt lgkmcnt(0)
  s_barrier
  s_add_u32 s76, s76, -63168
  s_waitcnt vmcnt(1)
  v_lshl_add_u32 v16, v16, 7, v8
  v_lshl_add_u32 v17, v17, 7, v8
  v_lshl_add_u32 v18, v18, 7, v8
  v_lshl_add_u32 v19, v19, 7, v8
  s_add_u32 m0, s76, 0
  s_mov_b32 exec_hi, 0xffffff
  buffer_load_dwordx4 v16, s[32:35], 0 offen lds
  s_add_u32 m0, s76, 1056
  s_nop 0
  buffer_load_dwordx4 v17, s[32:35], 0 offen lds
  s_add_u32 m0, s76, 2112
  s_mov_b32 exec_hi, 0xffff
  buffer_load_dwordx4 v18, s[32:35], 0 offen lds
  s_add_u32 m0, s76, 3168
  s_nop 0
  buffer_load_dwordx4 v19, s[32:35], 0 offen lds
  s_mov_b32 exec_hi, -1
  s_waitcnt vmcnt(4)
  v_lshl_add_u32 v12, v12, 7, v8
  v_lshl_add_u32 v13, v13, 7, v8
  v_lshl_add_u32 v14, v14, 7, v8
  v_lshl_add_u32 v15, v15, 7, v8
  s_add_u32 m0, s76, 16256
  s_mov_b32 exec_hi, 0xffffff
  buffer_load_dwordx4 v12, s[32:35], 0 offen lds
  s_add_u32 m0, s76, 17312
  s_nop 0
  buffer_load_dwordx4 v13, s[32:35], 0 offen lds
  s_add_u32 m0, s76, 18368
  s_mov_b32 exec_hi, 0xffff
  buffer_load_dwordx4 v14, s[32:35], 0 offen lds
  s_add_u32 m0, s76, 19424
  s_nop 0
  buffer_load_dwordx4 v15, s[32:35], 0 offen lds
  s_mov_b32 exec_hi, -1
  buffer_load_dwordx4 v[16:19], v6, s[28:31], s94 offen
  s_add_u32 s94, s94, 416
  v_add_u32 v10, -63168, v10
  v_add_u32 v4, -63168, v4
  v_add_u32 v5, -63168, v5
  ds_write_b32 v10, v7 offset:2880
  ds_write_b32 v10, v7 offset:19136
L_g1d:
  s_waitcnt vmcnt(5)
  ds_read_u16_d16_hi v32, v10 offset:0
  ds_read_u16_d16_hi v33, v10 offset:2
  ds_read_u16_d16_hi v34, v10 offset:2112
  ds_read_u16_d16_hi v35, v10 offset:2114
  ds_read_u16_d16_hi v36, v10 offset:128
  ds_read_u16_d16_hi v37, v10 offset:130
  ds_read_u16_d16_hi v38, v10 offset:2240
  ds_read_u16_d16_hi v39, v10 offset:2242
  ds_read_u16_d16_hi v40, v10 offset:256
  ds_read_u16_d16_hi v41, v10 offset:258
  ds_read_u16_d16_hi v42, v10 offset:2368
  ds_read_u16_d16_hi v43, v10 offset:2370
  ds_read_u16_d16_hi v44, v10 offset:384
  ds_read_u16_d16_hi v45, v10 offset:386
  ds_read_u16_d16_hi v46, v10 offset:2496
  ds_read_u16_d16_hi v47, v10 offset:2498
  ds_read_u16_d16_hi v48, v10 offset:512
  ds_read_u16_d16_hi v49, v10 offset:514
  ds_read_u16_d16_hi v50, v10 offset:2624
  ds_read_u16_d16_hi v51, v10 offset:2626
  ds_read_u16_d16_hi v52, v10 offset:640
  ds_read_u16_d16_hi v53, v10 offset:642
  ds_read_u16_d16_hi v54, v10 offset:2752
  ds_read_u16_d16_hi v55, v10 offset:2754
  ds_read_u16_d16_hi v56, v10 offset:768
  ds_read_u16_d16_hi v57, v10 offset:770
  s_waitcnt lgkmcnt(14)
  v_max3_f32 v58, |v32|, |v33|, 0
  v_cvt_pk_f16_f32 v184, v32, v33
  v_max3_f32 v58, |v34|, |v35|, v58
  v_cvt_pk_f16_f32 v185, v34, v35
  v_max3_f32 v58, |v36|, |v37|, v58
  v_cvt_pk_f16_f32 v186, v36, v37
  v_max3_f32 v58, |v38|, |v39|, v58
  v_cvt_pk_f16_f32 v187, v38, v39
  v_max3_f32 v58, |v40|, |v41|, v58
  v_cvt_pk_f16_f32 v188, v40, v41
  v_max3_f32 v58, |v42|, |v43|, v58
  v_cvt_pk_f16_f32 v189, v42, v43
  s_waitcnt lgkmcnt(12)
  v_max3_f32 v58, |v44|, |v45|, v58
  v_cvt_pk_f16_f32 v190, v44, v45
  s_waitcnt lgkmcnt(10)
  v_max3_f32 v58, |v46|, |v47|, v58
  v_cvt_pk_f16_f32 v191, v46, v47
  s_waitcnt lgkmcnt(8)
  v_max3_f32 v58, |v48|, |v49|, v58
  v_cvt_pk_f16_f32 v192, v48, v49
  s_waitcnt lgkmcnt(6)
  v_max3_f32 v58, |v50|, |v51|, v58
  v_cvt_pk_f16_f32 v193, v50, v51
  s_waitcnt lgkmcnt(4)
  v_max3_f32 v58, |v52|, |v53|, v58
  v_cvt_pk_f16_f32 v194, v52, v53
  s_waitcnt lgkmcnt(2)
  v_max3_f32 v58, |v54|, |v55|, v58
  v_cvt_pk_f16_f32 v195, v54, v55
  s_waitcnt lgkmcnt(0)
  v_max3_f32 v58, |v56|, |v57|, v58
  v_cvt_pk_f16_f32 v196, v56, v57
L_cin_go:
  ds_write_b32 v11, v184 offset:0
  ds_write_b32 v11, v185 offset:160
  ds_write_b32 v11, v186 offset:320
  ds_write_b32 v11, v187 offset:480
  ds_write_b32 v11, v188 offset:640
  ds_write_b32 v11, v189 offset:800
  ds_write_b32 v11, v190 offset:960
  ds_write_b32 v11, v191 offset:1120
  ds_write_b32 v11, v192 offset:1280
  ds_write_b32 v11, v193 offset:1440
  ds_write_b32 v11, v194 offset:1600
  ds_write_b32 v11, v195 offset:1760
  ds_write_b32 v11, v196 offset:1920
  s_mov_b32 s81, 16256
  s_add_u32 s76, s76, 16256
  v_lshlrev_b32 v7, 2, v0
  v_add_u32 v7, s98, v7
L_cin_loop:
  v_cmp_le_f32 s[90:91], s97, v58
  v_cmp_le_f32 vcc, s96, v58
  s_mov_b32 s49, s74
  s_mov_b32 s50, s75
  s_cmp_lg_u64 s[90:91], 0
  s_cbranch_scc1 L_cslow
  s_cbranch_vccz L_cslow
L_cconv:
  s_cmp_lg_u32 s51, 0
  s_cbranch_scc1 L_first
  ds_read_b64_tr_b16 v[60:61], v20 offset:0
  v_mul_f32 v116, v184, v192
  v_mul_f32 v117, v185, v193
  ds_read_b64_tr_b16 v[74:75], v20 offset:32
  v_mul_f32 v118, v186, v194
  ds_read_b64_tr_b16 v[88:89], v20 offset:64
  v_mul_f32 v119, v187, v195
  ds_read_b64_tr_b16 v[102:103], v20 offset:96
  v_fmac_f32 v116, v188, v191
  ds_read_b64_tr_b16 v[66:67], v23 offset:0
  v_fmac_f32 v117, v200, v208
  ds_read_b64_tr_b16 v[80:81], v23 offset:32
  v_fmac_f32 v118, v201, v209
  ds_read_b64_tr_b16 v[94:95], v23 offset:64
  v_fmac_f32 v119, v202, v210
  ds_read_b64_tr_b16 v[108:109], v23 offset:96
  v_fmac_f32 v116, v203, v211
  ds_read_b64_tr_b16 v[68:69], v24 offset:0
  v_fmac_f32 v117, v204, v207
  ds_read_b64_tr_b16 v[82:83], v24 offset:32
  v_fmac_f32_e64 v118, v216, v224
  ds_read_b64_tr_b16 v[96:97], v24 offset:64
  v_fmac_f32 v119, v217, v225
  ds_read_b64_tr_b16 v[110:111], v24 offset:96
  v_fmac_f32 v116, v218, v226
  ds_read_b64_tr_b16 v[124:125], v4 offset:0
  v_fmac_f32 v117, v219, v227
  ds_read_b64_tr_b16 v[126:127], v5 offset:0
  v_fmac_f32 v118, v220, v223
  v_fmac_f32 v119, v232, v240
  ds_read_b64_tr_b16 v[136:137], v4 offset:32
  v_fmac_f32 v116, v233, v241
  ds_read_b64_tr_b16 v[138:139], v5 offset:32
  v_fmac_f32 v117, v234, v242
  ds_read_b64_tr_b16 v[148:149], v4 offset:64
  v_fmac_f32 v118, v235, v243
  ds_read_b64_tr_b16 v[150:151], v5 offset:64
  v_fmac_f32 v119, v236, v239
  ds_read_b64_tr_b16 v[160:161], v4 offset:96
  v_fmac_f32 v116, v189, v196
  ds_read_b64_tr_b16 v[162:163], v5 offset:96
  v_fmac_f32_e64 v117, v189, v197
  ds_read_b128 v[164:167], v1 offset:39936
  v_fmac_f32 v118, v190, v198
  ds_read_b128 v[168:171], v1 offset:40960
  v_fmac_f32 v119, v190, v199
  ds_read_b128 v[172:175], v1 offset:8192
  v_fmac_f32 v116, v205, v212
  ds_read_b128 v[176:179], v1 offset:6144
  v_fmac_f32 v117, v205, v213
  ds_read_b64_tr_b16 v[70:71], v25 offset:0
  v_fmac_f32_e64 v118, v206, v214
  ds_read_b64_tr_b16 v[84:85], v25 offset:32
  v_fmac_f32 v119, v206, v215
  ds_read_b64_tr_b16 v[98:99], v25 offset:64
  v_fmac_f32 v116, v221, v228
  v_fmac_f32 v117, v221, v229
  ds_read_b64_tr_b16 v[112:113], v25 offset:96
  v_fmac_f32 v118, v222, v230
  ds_read_b64_tr_b16 v[72:73], v26 offset:0
  v_fmac_f32 v119, v222, v231
  ds_read_b64_tr_b16 v[86:87], v26 offset:32
  v_fmac_f32 v116, v237, v244
  ds_read_b64_tr_b16 v[100:101], v26 offset:64
  v_fmac_f32 v117, v237, v245
  ds_read_b64_tr_b16 v[114:115], v26 offset:96
  v_fmac_f32 v118, v238, v246
  ds_read_b64_tr_b16 v[62:63], v21 offset:0
  v_fmac_f32 v119, v238, v247
  ds_read_b64_tr_b16 v[76:77], v21 offset:32
  v_add_f32 v116, v116, v117
  ds_read_b64_tr_b16 v[90:91], v21 offset:64
  v_add_f32_e64 v118, v118, v119
  ds_read_b64_tr_b16 v[104:105], v21 offset:96
  v_add_f32 v116, v116, v118
  ds_read_b64_tr_b16 v[64:65], v22 offset:0
  v_mul_f32 v116, s49, v116
  ds_read_b64_tr_b16 v[78:79], v22 offset:32
  v_mul_f32_e64 v116, s50, v116
  ds_read_b64_tr_b16 v[92:93], v22 offset:64
  ds_write_b32 v7, v116
  ds_read_b64_tr_b16 v[106:107], v22 offset:96
  v_add_u32 v7, 256, v7
  s_waitcnt lgkmcnt(14)
  v_pk_mul_f16 v120, v60, v67 op_sel:[0,0] op_sel_hi:[0,1]
  v_pk_mul_f16 v121, v60, v67 op_sel:[1,0] op_sel_hi:[1,1]
  v_pk_mul_f16 v122, v60, v68 op_sel:[0,0] op_sel_hi:[0,1]
  v_pk_mul_f16 v123, v60, v68 op_sel:[1,0] op_sel_hi:[1,1]
  v_pk_mul_f16 v132, v74, v81 op_sel:[0,0] op_sel_hi:[0,1]
  v_pk_mul_f16 v133, v74, v81 op_sel:[1,0] op_sel_hi:[1,1]
  v_pk_mul_f16 v134, v74, v82 op_sel:[0,0] op_sel_hi:[0,1]
  v_pk_mul_f16 v135, v74, v82 op_sel:[1,0] op_sel_hi:[1,1]
  v_pk_mul_f16 v144, v88, v95 op_sel:[0,0] op_sel_hi:[0,1]
  v_pk_mul_f16 v145, v88, v95 op_sel:[1,0] op_sel_hi:[1,1]
  v_pk_mul_f16 v146, v88, v96 op_sel:[0,0] op_sel_hi:[0,1]
  v_pk_mul_f16 v147, v88, v96 op_sel:[1,0] op_sel_hi:[1,1]
  v_pk_mul_f16 v156, v102, v109 op_sel:[0,0] op_sel_hi:[0,1]
  v_pk_mul_f16 v157, v102, v109 op_sel:[1,0] op_sel_hi:[1,1]
  v_pk_mul_f16 v158, v102, v110 op_sel:[0,0] op_sel_hi:[0,1]
  v_pk_mul_f16 v159, v102, v110 op_sel:[1,0] op_sel_hi:[1,1]
  s_waitcnt vmcnt(0)
  v_lshl_add_u32 v16, v16, 7, v8
  v_lshl_add_u32 v17, v17, 7, v8
  v_lshl_add_u32 v18, v18, 7, v8
  v_lshl_add_u32 v19, v19, 7, v8
  s_add_u32 m0, s76, 0
  s_mov_b32 exec_hi, 0xffffff
  buffer_load_dwordx4 v16, s[32:35], 0 offen lds
  s_add_u32 m0, s76, 1056
  s_nop 0
  buffer_load_dwordx4 v17, s[32:35], 0 offen lds
  s_add_u32 m0, s76, 2112
  s_mov_b32 exec_hi, 0xffff
  buffer_load_dwordx4 v18, s[32:35], 0 offen lds
  s_add_u32 m0, s76, 3168
  s_nop 0
  buffer_load_dwordx4 v19, s[32:35], 0 offen lds
  s_mov_b32 exec_hi, -1
  buffer_load_dwordx4 v[16:19], v6, s[28:31], s94 offen
  s_add_u32 s94, s94, 416
L_novm:
  v_add_u32 v10, s81, v10
  v_add_u32 v4, s81, v4
  v_add_u32 v5, s81, v5
  s_sub_u32 s76, s76, s81
  s_sub_u32 s81, 0, s81
  s_mov_b32 s51, 0
  s_waitcnt lgkmcnt(14)
  s_setprio 1
  v_mfma_f32_16x16x32_bf16 v[184:187], v[164:167], v[124:127], 0
  ds_read_b128 v[180:183], v1 offset:7168
  v_pk_mul_f16 v116, v60, v69 op_sel:[0,0] op_sel_hi:[0,1]
  v_mfma_f32_16x16x32_bf16 v[200:203], v[164:167], v[136:139], 0
  v_pk_mul_f16 v117, v60, v69 op_sel:[1,0] op_sel_hi:[1,1]
  v_mfma_f32_16x16x32_bf16 v[216:219], v[164:167], v[148:151], 0
  v_pk_mul_f16 v118, v60, v70 op_sel:[0,0] op_sel_hi:[0,1]
  v_mfma_f32_16x16x32_bf16 v[232:235], v[164:167], v[160:163], 0
  v_pk_mul_f16 v119, v60, v70 op_sel:[1,0] op_sel_hi:[1,1]
  v_mfma_f32_16x16x32_bf16 v[188:191], v[168:171], v[124:127], 0
  ds_read_b128 v[164:167], v1 offset:5120
  v_pk_mul_f16 v128, v74, v83 op_sel:[0,0] op_sel_hi:[0,1]
  v_mfma_f32_16x16x32_bf16 v[204:207], v[168:171], v[136:139], 0
  v_pk_mul_f16 v129, v74, v83 op_sel:[1,0] op_sel_hi:[1,1]
  v_mfma_f32_16x16x32_bf16 v[220:223], v[168:171], v[148:151], 0
  v_pk_mul_f16 v130, v74, v84 op_sel:[0,0] op_sel_hi:[0,1]
  v_mfma_f32_16x16x32_bf16 v[236:239], v[168:171], v[160:163], 0
  v_pk_mul_f16 v131, v74, v84 op_sel:[1,0] op_sel_hi:[1,1]
  v_mfma_f32_16x16x32_f16 v[192:195], v[172:175], v[120:123], 0
  ds_read_b128 v[168:171], v1 offset:11264
  v_pk_mul_f16 v140, v88, v97 op_sel:[0,0] op_sel_hi:[0,1]
  v_mfma_f32_16x16x32_f16 v[208:211], v[172:175], v[132:135], 0
  v_pk_mul_f16 v141, v88, v97 op_sel:[1,0] op_sel_hi:[1,1]
  v_mfma_f32_16x16x32_f16 v[224:227], v[172:175], v[144:147], 0
  s_nop 0
  s_waitcnt lgkmcnt(14)
  v_pk_mul_f16 v142, v88, v98 op_sel:[0,0] op_sel_hi:[0,1]
  v_mfma_f32_16x16x32_f16 v[240:243], v[172:175], v[156:159], 0
  v_pk_mul_f16 v143, v88, v98 op_sel:[1,0] op_sel_hi:[1,1]
  v_mfma_f32_16x16x32_f16 v[184:187], v[176:179], v[120:123], v[184:187]
  ds_read_b128 v[172:175], v1 offset:9216
  v_pk_mul_f16 v152, v102, v111 op_sel:[0,0] op_sel_hi:[0,1]
  v_mfma_f32_16x16x32_f16 v[200:203], v[176:179], v[132:135], v[200:203]
  v_pk_mul_f16 v153, v102, v111 op_sel:[1,0] op_sel_hi:[1,1]
  v_mfma_f32_16x16x32_f16 v[216:219], v[176:179], v[144:147], v[216:219]
  s_setprio 2
  s_waitcnt lgkmcnt(14)
  v_pk_mul_f16 v154, v102, v112 op_sel:[0,0] op_sel_hi:[0,1]
  v_mfma_f32_16x16x32_f16 v[232:235], v[176:179], v[156:159], v[232:235]
  s_nop 0
  s_waitcnt lgkmcnt(3)
  v_pk_mul_f16 v155, v102, v112 op_sel:[1,0] op_sel_hi:[1,1]
  v_mfma_f32_16x16x32_f16 v[188:191], v[180:183], v[120:123], v[188:191]
  ds_read_b128 v[176:179], v1 offset:10240
  v_pk_mul_f16 v124, v61, v68 op_sel:[0,0] op_sel_hi:[0,1]
  v_mfma_f32_16x16x32_f16 v[204:207], v[180:183], v[132:135], v[204:207]
  v_pk_mul_f16 v125, v61, v68 op_sel:[1,0] op_sel_hi:[1,1]
  v_mfma_f32_16x16x32_f16 v[220:223], v[180:183], v[144:147], v[220:223]
  v_pk_mul_f16 v126, v61, v69 op_sel:[0,0] op_sel_hi:[0,1]
  v_mfma_f32_16x16x32_f16 v[236:239], v[180:183], v[156:159], v[236:239]
  s_nop 0
  s_waitcnt lgkmcnt(3)
  v_pk_mul_f16 v127, v61, v69 op_sel:[1,0] op_sel_hi:[1,1]
  v_mfma_f32_16x16x32_f16 v[196:199], v[164:167], v[120:123], 0
  ds_read_b128 v[180:183], v1 offset:14336
  v_pk_mul_f16 v136, v75, v82 op_sel:[0,0] op_sel_hi:[0,1]
  v_mfma_f32_16x16x32_f16 v[212:215], v[164:167], v[132:135], 0
  v_pk_mul_f16 v120, v60, v71 op_sel:[0,0] op_sel_hi:[0,1]
  v_mfma_f32_16x16x32_f16 v[228:231], v[164:167], v[144:147], 0
  v_pk_mul_f16 v121, v60, v71 op_sel:[1,0] op_sel_hi:[1,1]
  v_mfma_f32_16x16x32_f16 v[244:247], v[164:167], v[156:159], 0
  s_waitcnt lgkmcnt(3)
  v_pk_mul_f16 v122, v60, v66 op_sel:[0,1] op_sel_hi:[0,0]
  v_mfma_f32_16x16x32_f16 v[192:195], v[168:171], v[116:119], v[192:195]
  ds_read_b128 v[164:167], v1 offset:12288
  v_pk_mul_f16 v123, v60, v72 op_sel:[0,0] op_sel_hi:[1,0]
  v_mfma_f32_16x16x32_f16 v[208:211], v[168:171], v[128:131], v[208:211]
  v_pk_mul_f16 v132, v74, v85 op_sel:[0,0] op_sel_hi:[0,1]
  v_mfma_f32_16x16x32_f16 v[224:227], v[168:171], v[140:143], v[224:227]
  s_nop 0
  v_pk_mul_f16 v133, v74, v85 op_sel:[1,0] op_sel_hi:[1,1]
  v_mfma_f32_16x16x32_f16 v[240:243], v[168:171], v[152:155], v[240:243]
  s_waitcnt lgkmcnt(3)
  v_pk_mul_f16 v134, v74, v80 op_sel:[0,1] op_sel_hi:[0,0]
  v_mfma_f32_16x16x32_f16 v[184:187], v[172:175], v[116:119], v[184:187]
  ds_read_b128 v[168:171], v1 offset:13312
  v_pk_mul_f16 v135, v74, v86 op_sel:[0,0] op_sel_hi:[1,0]
  v_mfma_f32_16x16x32_f16 v[200:203], v[172:175], v[128:131], v[200:203]
  s_nop 0
  v_pk_mul_f16 v144, v88, v99 op_sel:[0,0] op_sel_hi:[0,1]
  v_mfma_f32_16x16x32_f16 v[216:219], v[172:175], v[140:143], v[216:219]
  v_pk_mul_f16 v145, v88, v99 op_sel:[1,0] op_sel_hi:[1,1]
  v_mfma_f32_16x16x32_f16 v[232:235], v[172:175], v[152:155], v[232:235]
  s_nop 0
  s_waitcnt lgkmcnt(3)
  v_pk_mul_f16 v146, v88, v94 op_sel:[0,1] op_sel_hi:[0,0]
  v_mfma_f32_16x16x32_f16 v[188:191], v[176:179], v[116:119], v[188:191]
  ds_read_b128 v[172:175], v1 offset:0
  v_pk_mul_f16 v147, v88, v100 op_sel:[0,0] op_sel_hi:[1,0]
  v_mfma_f32_16x16x32_f16 v[204:207], v[176:179], v[128:131], v[204:207]
  v_pk_mul_f16 v156, v102, v113 op_sel:[0,0] op_sel_hi:[0,1]
  v_mfma_f32_16x16x32_f16 v[220:223], v[176:179], v[140:143], v[220:223]
  v_pk_mul_f16 v157, v102, v113 op_sel:[1,0] op_sel_hi:[1,1]
  v_mfma_f32_16x16x32_f16 v[236:239], v[176:179], v[152:155], v[236:239]
  s_nop 0
  s_waitcnt lgkmcnt(3)
  v_pk_mul_f16 v158, v102, v108 op_sel:[0,1] op_sel_hi:[0,0]
  v_mfma_f32_16x16x32_f16 v[192:195], v[180:183], v[120:123], v[192:195]
  ds_read_b128 v[176:179], v1 offset:17408
  v_pk_mul_f16 v159, v102, v114 op_sel:[0,0] op_sel_hi:[1,0]
  v_mfma_f32_16x16x32_f16 v[208:211], v[180:183], v[132:135], v[208:211]
  v_pk_mul_f16 v137, v75, v82 op_sel:[1,0] op_sel_hi:[1,1]
  v_mfma_f32_16x16x32_f16 v[224:227], v[180:183], v[144:147], v[224:227]
  v_pk_mul_f16 v138, v75, v83 op_sel:[0,0] op_sel_hi:[0,1]
  v_mfma_f32_16x16x32_f16 v[240:243], v[180:183], v[156:159], v[240:243]
  s_waitcnt lgkmcnt(3)
  v_pk_mul_f16 v139, v75, v83 op_sel:[1,0] op_sel_hi:[1,1]
  v_mfma_f32_16x16x32_f16 v[184:187], v[164:167], v[120:123], v[184:187]
  ds_read_b128 v[180:183], v1 offset:15360
  v_pk_mul_f16 v148, v89, v96 op_sel:[0,0] op_sel_hi:[0,1]
  v_mfma_f32_16x16x32_f16 v[200:203], v[164:167], v[132:135], v[200:203]
  v_pk_mul_f16 v149, v89, v96 op_sel:[1,0] op_sel_hi:[1,1]
  v_mfma_f32_16x16x32_f16 v[216:219], v[164:167], v[144:147], v[216:219]
  s_nop 0
  v_pk_mul_f16 v150, v89, v97 op_sel:[0,0] op_sel_hi:[0,1]
  v_mfma_f32_16x16x32_f16 v[232:235], v[164:167], v[156:159], v[232:235]
  s_waitcnt lgkmcnt(3)
  v_pk_mul_f16 v151, v89, v97 op_sel:[1,0] op_sel_hi:[1,1]
  v_mfma_f32_16x16x32_f16 v[188:191], v[168:171], v[120:123], v[188:191]
  ds_read_b128 v[164:167], v1 offset:16384
  v_pk_mul_f16 v160, v103, v110 op_sel:[0,0] op_sel_hi:[0,1]
  v_mfma_f32_16x16x32_f16 v[204:207], v[168:171], v[132:135], v[204:207]
  s_nop 0
  v_pk_mul_f16 v161, v103, v110 op_sel:[1,0] op_sel_hi:[1,1]
  v_mfma_f32_16x16x32_f16 v[220:223], v[168:171], v[144:147], v[220:223]
  v_pk_mul_f16 v162, v103, v111 op_sel:[0,0] op_sel_hi:[0,1]
  v_mfma_f32_16x16x32_f16 v[236:239], v[168:171], v[156:159], v[236:239]
  s_waitcnt lgkmcnt(3)
  v_pk_mul_f16 v163, v103, v111 op_sel:[1,0] op_sel_hi:[1,1]
  v_smfmac_f32_16x16x64_f16 v[196:199], v[172:175], v[116:123], v9
  s_nop 0
  ds_read_b128 v[168:171], v1 offset:20480
  v_smfmac_f32_16x16x64_f16 v[212:215], v[172:175], v[128:135], v9
  v_pk_mul_f16 v120, v61, v70 op_sel:[0,0] op_sel_hi:[0,1]
  v_smfmac_f32_16x16x64_f16 v[228:231], v[172:175], v[140:147], v9
  v_pk_mul_f16 v121, v61, v70 op_sel:[1,0] op_sel_hi:[1,1]
  v_smfmac_f32_16x16x64_f16 v[244:247], v[172:175], v[152:159], v9
  s_nop 0
  s_waitcnt lgkmcnt(3)
  v_pk_mul_f16 v122, v61, v71 op_sel:[0,0] op_sel_hi:[0,1]
  v_mfma_f32_16x16x32_f16 v[192:195], v[176:179], v[124:127], v[192:195]
  ds_read_b128 v[172:175], v1 offset:18432
  v_pk_mul_f16 v123, v61, v71 op_sel:[1,0] op_sel_hi:[1,1]
  v_mfma_f32_16x16x32_f16 v[208:211], v[176:179], v[136:139], v[208:211]
  v_pk_mul_f16 v132, v75, v84 op_sel:[0,0] op_sel_hi:[0,1]
  v_mfma_f32_16x16x32_f16 v[224:227], v[176:179], v[148:151], v[224:227]
  v_pk_mul_f16 v133, v75, v84 op_sel:[1,0] op_sel_hi:[1,1]
  v_mfma_f32_16x16x32_f16 v[240:243], v[176:179], v[160:163], v[240:243]
  s_nop 0
  s_waitcnt lgkmcnt(3)
  v_pk_mul_f16 v134, v75, v85 op_sel:[0,0] op_sel_hi:[0,1]
  v_mfma_f32_16x16x32_f16 v[184:187], v[180:183], v[124:127], v[184:187]
  ds_read_b128 v[176:179], v1 offset:19456
  v_pk_mul_f16 v135, v75, v85 op_sel:[1,0] op_sel_hi:[1,1]
  v_mfma_f32_16x16x32_f16 v[200:203], v[180:183], v[136:139], v[200:203]
  v_pk_mul_f16 v144, v89, v98 op_sel:[0,0] op_sel_hi:[0,1]
  v_mfma_f32_16x16x32_f16 v[216:219], v[180:183], v[148:151], v[216:219]
  v_pk_mul_f16 v145, v89, v98 op_sel:[1,0] op_sel_hi:[1,1]
  v_mfma_f32_16x16x32_f16 v[232:235], v[180:183], v[160:163], v[232:235]
  s_waitcnt lgkmcnt(3)
  v_pk_mul_f16 v146, v89, v99 op_sel:[0,0] op_sel_hi:[0,1]
  v_mfma_f32_16x16x32_f16 v[188:191], v[164:167], v[124:127], v[188:191]
  ds_read_b128 v[180:183], v1 offset:1024
  v_pk_mul_f16 v147, v89, v99 op_sel:[1,0] op_sel_hi:[1,1]
  v_mfma_f32_16x16x32_f16 v[204:207], v[164:167], v[136:139], v[204:207]
  s_waitcnt vmcnt(1)
  ds_read_u16_d16_hi v32, v10 offset:0
  v_pk_mul_f16 v156, v103, v112 op_sel:[0,0] op_sel_hi:[0,1]
  v_mfma_f32_16x16x32_f16 v[220:223], v[164:167], v[148:151], v[220:223]
  ds_read_u16_d16_hi v33, v10 offset:2
  v_pk_mul_f16 v157, v103, v112 op_sel:[1,0] op_sel_hi:[1,1]
  v_mfma_f32_16x16x32_f16 v[236:239], v[164:167], v[160:163], v[236:239]
  s_nop 0
  s_waitcnt lgkmcnt(5)
  v_pk_mul_f16 v158, v103, v113 op_sel:[0,0] op_sel_hi:[0,1]
  v_mfma_f32_16x16x32_f16 v[192:195], v[168:171], v[120:123], v[192:195]
  ds_read_b128 v[164:167], v1 offset:23552
  v_pk_mul_f16 v159, v103, v113 op_sel:[1,0] op_sel_hi:[1,1]
  v_mfma_f32_16x16x32_f16 v[208:211], v[168:171], v[132:135], v[208:211]
  ds_read_u16_d16_hi v34, v10 offset:2112
  v_pk_mul_f16 v116, v61, v67 op_sel:[0,1] op_sel_hi:[0,0]
  v_mfma_f32_16x16x32_f16 v[224:227], v[168:171], v[144:147], v[224:227]
  ds_read_u16_d16_hi v35, v10 offset:2114
  v_pk_mul_f16 v117, v61, v72 op_sel:[0,0] op_sel_hi:[1,0]
  v_mfma_f32_16x16x32_f16 v[240:243], v[168:171], v[156:159], v[240:243]
  s_nop 0
  s_waitcnt lgkmcnt(7)
  v_pk_mul_f16 v118, v62, v69 op_sel:[0,0] op_sel_hi:[0,1]
  v_mfma_f32_16x16x32_f16 v[184:187], v[172:175], v[120:123], v[184:187]
  ds_read_b128 v[168:171], v1 offset:21504
  v_pk_mul_f16 v119, v62, v69 op_sel:[1,0] op_sel_hi:[1,1]
  v_mfma_f32_16x16x32_f16 v[200:203], v[172:175], v[132:135], v[200:203]
  ds_read_b64_tr_b16 v[60:61], v27 offset:0
  v_pk_mul_f16 v128, v75, v81 op_sel:[0,1] op_sel_hi:[0,0]
  v_mfma_f32_16x16x32_f16 v[216:219], v[172:175], v[144:147], v[216:219]
  ds_read_u16_d16_hi v36, v10 offset:128
  v_pk_mul_f16 v129, v75, v86 op_sel:[0,0] op_sel_hi:[1,0]
  v_mfma_f32_16x16x32_f16 v[232:235], v[172:175], v[156:159], v[232:235]
  s_waitcnt lgkmcnt(9)
  v_pk_mul_f16 v130, v76, v83 op_sel:[0,0] op_sel_hi:[0,1]
  v_pk_mul_f16 v131, v76, v83 op_sel:[1,0] op_sel_hi:[1,1]
  v_mfma_f32_16x16x32_f16 v[188:191], v[176:179], v[120:123], v[188:191]
  ds_read_b128 v[172:175], v1 offset:22528
  v_pk_mul_f16 v140, v89, v95 op_sel:[0,1] op_sel_hi:[0,0]
  v_mfma_f32_16x16x32_f16 v[204:207], v[176:179], v[132:135], v[204:207]
  ds_read_b64_tr_b16 v[74:75], v27 offset:32
  v_pk_mul_f16 v141, v89, v100 op_sel:[0,0] op_sel_hi:[1,0]
  v_mfma_f32_16x16x32_f16 v[220:223], v[176:179], v[144:147], v[220:223]
  ds_read_b64_tr_b16 v[88:89], v27 offset:64
  v_pk_mul_f16 v142, v90, v97 op_sel:[0,0] op_sel_hi:[0,1]
  v_mfma_f32_16x16x32_f16 v[236:239], v[176:179], v[156:159], v[236:239]
  s_waitcnt lgkmcnt(11)
  v_pk_mul_f16 v143, v90, v97 op_sel:[1,0] op_sel_hi:[1,1]
  v_pk_mul_f16 v152, v103, v109 op_sel:[0,1] op_sel_hi:[0,0]
  v_smfmac_f32_16x16x64_f16 v[196:199], v[180:183], v[120:127], v9
  ds_read_b128 v[176:179], v1 offset:26624
  v_pk_mul_f16 v153, v103, v114 op_sel:[0,0] op_sel_hi:[1,0]
  v_smfmac_f32_16x16x64_f16 v[212:215], v[180:183], v[132:139], v9
  ds_read_b64_tr_b16 v[102:103], v27 offset:96
  v_pk_mul_f16 v154, v104, v111 op_sel:[0,0] op_sel_hi:[0,1]
  v_smfmac_f32_16x16x64_f16 v[228:231], v[180:183], v[144:151], v9
  ds_read_u16_d16_hi v37, v10 offset:130
  v_pk_mul_f16 v155, v104, v111 op_sel:[1,0] op_sel_hi:[1,1]
  v_smfmac_f32_16x16x64_f16 v[244:247], v[180:183], v[156:163], v9
  s_nop 0
  s_waitcnt lgkmcnt(11)
  v_pk_mul_f16 v120, v62, v70 op_sel:[0,0] op_sel_hi:[0,1]
  v_mfma_f32_16x16x32_f16 v[192:195], v[164:167], v[116:119], v[192:195]
  ds_read_b128 v[180:183], v1 offset:24576
  v_pk_mul_f16 v121, v62, v70 op_sel:[1,0] op_sel_hi:[1,1]
  v_mfma_f32_16x16x32_f16 v[208:211], v[164:167], v[128:131], v[208:211]
  ds_read_u16_d16_hi v38, v10 offset:2240
  v_pk_mul_f16 v122, v62, v71 op_sel:[0,0] op_sel_hi:[0,1]
  v_mfma_f32_16x16x32_f16 v[224:227], v[164:167], v[140:143], v[224:227]
  ds_read_u16_d16_hi v39, v10 offset:2242
  v_pk_mul_f16 v123, v62, v71 op_sel:[1,0] op_sel_hi:[1,1]
  v_mfma_f32_16x16x32_f16 v[240:243], v[164:167], v[152:155], v[240:243]
  s_waitcnt lgkmcnt(11)
  v_pk_mul_f16 v132, v76, v84 op_sel:[0,0] op_sel_hi:[0,1]
  v_max3_f32 v58, |v32|, |v33|, 0
  v_mfma_f32_16x16x32_f16 v[184:187], v[168:171], v[116:119], v[184:187]
  ds_read_b128 v[164:167], v1 offset:25600
  v_pk_mul_f16 v133, v76, v84 op_sel:[1,0] op_sel_hi:[1,1]
  v_mfma_f32_16x16x32_f16 v[200:203], v[168:171], v[128:131], v[200:203]
  ds_read_u16_d16_hi v40, v10 offset:256
  v_pk_mul_f16 v134, v76, v85 op_sel:[0,0] op_sel_hi:[0,1]
  v_mfma_f32_16x16x32_f16 v[216:219], v[168:171], v[140:143], v[216:219]
  ds_read_u16_d16_hi v41, v10 offset:258
  v_pk_mul_f16 v135, v76, v85 op_sel:[1,0] op_sel_hi:[1,1]
  v_mfma_f32_16x16x32_f16 v[232:235], v[168:171], v[152:155], v[232:235]
  s_waitcnt lgkmcnt(11)
  v_pk_mul_f16 v144, v90, v98 op_sel:[0,0] op_sel_hi:[0,1]
  v_max3_f32 v58, |v34|, |v35|, v58
  v_mfma_f32_16x16x32_f16 v[188:191], v[172:175], v[116:119], v[188:191]
  ds_read_b128 v[168:171], v1 offset:2048
  v_pk_mul_f16 v145, v90, v98 op_sel:[1,0] op_sel_hi:[1,1]
  v_mfma_f32_16x16x32_f16 v[204:207], v[172:175], v[128:131], v[204:207]
  ds_read_u16_d16_hi v42, v10 offset:2368
  v_pk_mul_f16 v146, v90, v99 op_sel:[0,0] op_sel_hi:[0,1]
  v_mfma_f32_16x16x32_f16 v[220:223], v[172:175], v[140:143], v[220:223]
  ds_read_u16_d16_hi v43, v10 offset:2370
  v_pk_mul_f16 v147, v90, v99 op_sel:[1,0] op_sel_hi:[1,1]
  v_mfma_f32_16x16x32_f16 v[236:239], v[172:175], v[152:155], v[236:239]
  s_nop 0
  s_waitcnt lgkmcnt(11)
  v_pk_mul_f16 v156, v104, v112 op_sel:[0,0] op_sel_hi:[0,1]
  v_mfma_f32_16x16x32_f16 v[192:195], v[176:179], v[120:123], v[192:195]
  ds_read_b128 v[172:175], v1 offset:29696
  v_pk_mul_f16 v157, v104, v112 op_sel:[1,0] op_sel_hi:[1,1]
  v_mfma_f32_16x16x32_f16 v[208:211], v[176:179], v[132:135], v[208:211]
  ds_read_u16_d16_hi v44, v10 offset:384
  v_pk_mul_f16 v158, v104, v113 op_sel:[0,0] op_sel_hi:[0,1]
  v_mfma_f32_16x16x32_f16 v[224:227], v[176:179], v[144:147], v[224:227]
  ds_read_u16_d16_hi v45, v10 offset:386
  v_pk_mul_f16 v159, v104, v113 op_sel:[1,0] op_sel_hi:[1,1]
  s_nop 1
  v_mfma_f32_16x16x32_f16 v[240:243], v[176:179], v[156:159], v[240:243]
  s_waitcnt lgkmcnt(11)
  v_pk_mul_f16 v124, v62, v68 op_sel:[0,1] op_sel_hi:[0,0]
  v_mfma_f32_16x16x32_f16 v[184:187], v[180:183], v[120:123], v[184:187]
  ds_read_b128 v[176:179], v1 offset:27648
  v_pk_mul_f16 v125, v62, v72 op_sel:[0,0] op_sel_hi:[1,0]
  v_mfma_f32_16x16x32_f16 v[200:203], v[180:183], v[132:135], v[200:203]
  ds_read_u16_d16_hi v46, v10 offset:2496
  v_pk_mul_f16 v126, v63, v70 op_sel:[0,0] op_sel_hi:[0,1]
  v_mfma_f32_16x16x32_f16 v[216:219], v[180:183], v[144:147], v[216:219]
  ds_read_u16_d16_hi v47, v10 offset:2498
  v_pk_mul_f16 v127, v63, v70 op_sel:[1,0] op_sel_hi:[1,1]
  v_mfma_f32_16x16x32_f16 v[232:235], v[180:183], v[156:159], v[232:235]
  s_waitcnt lgkmcnt(11)
  v_pk_mul_f16 v136, v76, v82 op_sel:[0,1] op_sel_hi:[0,0]
  v_pk_mul_f16 v137, v76, v86 op_sel:[0,0] op_sel_hi:[1,0]
  v_mfma_f32_16x16x32_f16 v[188:191], v[164:167], v[120:123], v[188:191]
  ds_read_b128 v[180:183], v1 offset:28672
  v_pk_mul_f16 v138, v77, v84 op_sel:[0,0] op_sel_hi:[0,1]
  v_mfma_f32_16x16x32_f16 v[204:207], v[164:167], v[132:135], v[204:207]
  ds_read_u16_d16_hi v48, v10 offset:512
  v_pk_mul_f16 v139, v77, v84 op_sel:[1,0] op_sel_hi:[1,1]
  v_mfma_f32_16x16x32_f16 v[220:223], v[164:167], v[144:147], v[220:223]
  ds_read_u16_d16_hi v49, v10 offset:514
  v_pk_mul_f16 v148, v90, v96 op_sel:[0,1] op_sel_hi:[0,0]
  v_mfma_f32_16x16x32_f16 v[236:239], v[164:167], v[156:159], v[236:239]
  s_waitcnt lgkmcnt(11)
  v_pk_mul_f16 v149, v90, v100 op_sel:[0,0] op_sel_hi:[1,0]
  v_pk_mul_f16 v150, v91, v98 op_sel:[0,0] op_sel_hi:[0,1]
  v_smfmac_f32_16x16x64_f16 v[196:199], v[168:171], v[116:123], v9
  ds_read_b128 v[164:167], v1 offset:32768
  v_pk_mul_f16 v151, v91, v98 op_sel:[1,0] op_sel_hi:[1,1]
  v_smfmac_f32_16x16x64_f16 v[212:215], v[168:171], v[128:135], v9
  ds_read_u16_d16_hi v50, v10 offset:2624
  v_pk_mul_f16 v160, v104, v110 op_sel:[0,1] op_sel_hi:[0,0]
  v_smfmac_f32_16x16x64_f16 v[228:231], v[168:171], v[140:147], v9
  ds_read_u16_d16_hi v51, v10 offset:2626
  v_pk_mul_f16 v161, v104, v114 op_sel:[0,0] op_sel_hi:[1,0]
  v_smfmac_f32_16x16x64_f16 v[244:247], v[168:171], v[152:159], v9
  s_nop 0
  s_waitcnt lgkmcnt(11)
  v_pk_mul_f16 v162, v105, v112 op_sel:[0,0] op_sel_hi:[0,1]
  v_mfma_f32_16x16x32_f16 v[192:195], v[172:175], v[124:127], v[192:195]
  ds_read_b128 v[168:171], v1 offset:30720
  v_pk_mul_f16 v163, v105, v112 op_sel:[1,0] op_sel_hi:[1,1]
  v_mfma_f32_16x16x32_f16 v[208:211], v[172:175], v[136:139], v[208:211]
  ds_read_u16_d16_hi v52, v10 offset:640
  v_pk_mul_f16 v120, v63, v71 op_sel:[0,0] op_sel_hi:[0,1]
  v_mfma_f32_16x16x32_f16 v[224:227], v[172:175], v[148:151], v[224:227]
  ds_read_u16_d16_hi v53, v10 offset:642
  v_pk_mul_f16 v121, v63, v71 op_sel:[1,0] op_sel_hi:[1,1]
  v_mfma_f32_16x16x32_f16 v[240:243], v[172:175], v[160:163], v[240:243]
  s_waitcnt lgkmcnt(11)
  v_pk_mul_f16 v122, v63, v69 op_sel:[0,1] op_sel_hi:[1,1]
  v_pk_mul_f16 v123, v63, v72 op_sel:[0,0] op_sel_hi:[1,0]
  v_mfma_f32_16x16x32_f16 v[184:187], v[176:179], v[124:127], v[184:187]
  ds_read_b128 v[172:175], v1 offset:31744
  v_pk_mul_f16 v132, v77, v85 op_sel:[0,0] op_sel_hi:[0,1]
  v_mfma_f32_16x16x32_f16 v[200:203], v[176:179], v[136:139], v[200:203]
  ds_read_u16_d16_hi v54, v10 offset:2752
  v_pk_mul_f16 v133, v77, v85 op_sel:[1,0] op_sel_hi:[1,1]
  v_mfma_f32_16x16x32_f16 v[216:219], v[176:179], v[148:151], v[216:219]
  ds_read_u16_d16_hi v55, v10 offset:2754
  v_pk_mul_f16 v134, v77, v83 op_sel:[0,1] op_sel_hi:[1,1]
  v_mfma_f32_16x16x32_f16 v[232:235], v[176:179], v[160:163], v[232:235]
  s_waitcnt lgkmcnt(11)
  v_pk_mul_f16 v135, v77, v86 op_sel:[0,0] op_sel_hi:[1,0]
  v_pk_mul_f16 v144, v91, v99 op_sel:[0,0] op_sel_hi:[0,1]
  v_mfma_f32_16x16x32_f16 v[188:191], v[180:183], v[124:127], v[188:191]
  ds_read_b128 v[176:179], v1 offset:3072
  v_pk_mul_f16 v145, v91, v99 op_sel:[1,0] op_sel_hi:[1,1]
  v_mfma_f32_16x16x32_f16 v[204:207], v[180:183], v[136:139], v[204:207]
  ds_read_u16_d16_hi v56, v10 offset:768
  v_pk_mul_f16 v146, v91, v97 op_sel:[0,1] op_sel_hi:[1,1]
  v_mfma_f32_16x16x32_f16 v[220:223], v[180:183], v[148:151], v[220:223]
  ds_read_u16_d16_hi v57, v10 offset:770
  v_pk_mul_f16 v147, v91, v100 op_sel:[0,0] op_sel_hi:[1,0]
  v_mfma_f32_16x16x32_f16 v[236:239], v[180:183], v[160:163], v[236:239]
  s_waitcnt lgkmcnt(11)
  v_pk_mul_f16 v156, v105, v113 op_sel:[0,0] op_sel_hi:[0,1]
  v_max3_f32 v58, |v36|, |v37|, v58
  v_mfma_f32_16x16x32_f16 v[192:195], v[164:167], v[120:123], v[192:195]
  ds_read_b128 v[180:183], v1 offset:35840
  v_pk_mul_f16 v157, v105, v113 op_sel:[1,0] op_sel_hi:[1,1]
  v_mfma_f32_16x16x32_f16 v[208:211], v[164:167], v[132:135], v[208:211]
  s_nop 0
  v_pk_mul_f16 v158, v105, v111 op_sel:[0,1] op_sel_hi:[1,1]
  v_max3_f32 v58, |v38|, |v39|, v58
  v_mfma_f32_16x16x32_f16 v[224:227], v[164:167], v[144:147], v[224:227]
  v_pk_mul_f16 v159, v105, v114 op_sel:[0,0] op_sel_hi:[1,0]
  v_max3_f32 v58, |v40|, |v41|, v58
  s_nop 0
  v_mfma_f32_16x16x32_f16 v[240:243], v[164:167], v[156:159], v[240:243]
  s_waitcnt lgkmcnt(9)
  v_pk_mul_f16 v116, v64, v71 op_sel:[0,0] op_sel_hi:[0,1]
  v_mfma_f32_16x16x32_f16 v[184:187], v[168:171], v[120:123], v[184:187]
  ds_read_b128 v[164:167], v1 offset:33792
  v_pk_mul_f16 v117, v64, v71 op_sel:[1,0] op_sel_hi:[1,1]
  v_mfma_f32_16x16x32_f16 v[200:203], v[168:171], v[132:135], v[200:203]
  v_pk_mul_f16 v118, v64, v70 op_sel:[0,1] op_sel_hi:[1,1]
  v_max3_f32 v58, |v42|, |v43|, v58
  v_mfma_f32_16x16x32_f16 v[216:219], v[168:171], v[144:147], v[216:219]
  v_pk_mul_f16 v119, v64, v72 op_sel:[0,0] op_sel_hi:[1,0]
  v_pk_mul_f16 v128, v78, v85 op_sel:[0,0] op_sel_hi:[0,1]
  v_mfma_f32_16x16x32_f16 v[232:235], v[168:171], v[156:159], v[232:235]
  s_waitcnt lgkmcnt(7)
  v_pk_mul_f16 v129, v78, v85 op_sel:[1,0] op_sel_hi:[1,1]
  v_pk_mul_f16 v130, v78, v84 op_sel:[0,1] op_sel_hi:[1,1]
  v_mfma_f32_16x16x32_f16 v[188:191], v[172:175], v[120:123], v[188:191]
  ds_read_b128 v[168:171], v1 offset:34816
  v_pk_mul_f16 v131, v78, v86 op_sel:[0,0] op_sel_hi:[1,0]
  v_mfma_f32_16x16x32_f16 v[204:207], v[172:175], v[132:135], v[204:207]
  v_pk_mul_f16 v140, v92, v99 op_sel:[0,0] op_sel_hi:[0,1]
  v_pk_mul_f16 v141, v92, v99 op_sel:[1,0] op_sel_hi:[1,1]
  v_mfma_f32_16x16x32_f16 v[220:223], v[172:175], v[144:147], v[220:223]
  v_pk_mul_f16 v142, v92, v98 op_sel:[0,1] op_sel_hi:[1,1]
  v_pk_mul_f16 v143, v92, v100 op_sel:[0,0] op_sel_hi:[1,0]
  v_mfma_f32_16x16x32_f16 v[236:239], v[172:175], v[156:159], v[236:239]
  s_waitcnt lgkmcnt(5)
  v_pk_mul_f16 v152, v106, v113 op_sel:[0,0] op_sel_hi:[0,1]
  v_smfmac_f32_16x16x64_f16 v[196:199], v[176:179], v[120:127], v9
  ds_read_b128 v[172:175], v1 offset:38912
  v_pk_mul_f16 v153, v106, v113 op_sel:[1,0] op_sel_hi:[1,1]
  v_smfmac_f32_16x16x64_f16 v[212:215], v[176:179], v[132:139], v9
  v_pk_mul_f16 v154, v106, v112 op_sel:[0,1] op_sel_hi:[1,1]
  v_smfmac_f32_16x16x64_f16 v[228:231], v[176:179], v[144:151], v9
  v_pk_mul_f16 v155, v106, v114 op_sel:[0,0] op_sel_hi:[1,0]
  v_smfmac_f32_16x16x64_f16 v[244:247], v[176:179], v[156:163], v9
  s_waitcnt lgkmcnt(3)
  v_pk_mul_f16 v120, v65, v71 op_sel:[0,1] op_sel_hi:[1,1]
  v_mfma_f32_16x16x32_f16 v[192:195], v[180:183], v[116:119], v[192:195]
  ds_read_b128 v[176:179], v1 offset:36864
  v_pk_mul_f16 v121, v65, v72 op_sel:[0,0] op_sel_hi:[1,0]
  v_mfma_f32_16x16x32_f16 v[208:211], v[180:183], v[128:131], v[208:211]
  s_nop 0
  v_pk_mul_f16 v122, v72, v72 op_sel:[0,0] op_sel_hi:[1,1]
  v_max3_f32 v58, |v44|, |v45|, v58
  v_mfma_f32_16x16x32_f16 v[224:227], v[180:183], v[140:143], v[224:227]
  v_pk_mul_f16 v123, v60, v61 op_sel:[0,0] op_sel_hi:[1,1]
  v_max3_f32 v58, |v46|, |v47|, v58
  v_mfma_f32_16x16x32_f16 v[240:243], v[180:183], v[152:155], v[240:243]
  s_nop 0
  s_waitcnt lgkmcnt(3)
  v_pk_mul_f16 v132, v79, v85 op_sel:[0,1] op_sel_hi:[1,1]
  v_mfma_f32_16x16x32_f16 v[184:187], v[164:167], v[116:119], v[184:187]
  ds_read_b128 v[180:183], v1 offset:37888
  v_pk_mul_f16 v133, v79, v86 op_sel:[0,0] op_sel_hi:[1,0]
  v_mfma_f32_16x16x32_f16 v[200:203], v[164:167], v[128:131], v[200:203]
  v_pk_mul_f16 v134, v86, v86 op_sel:[0,0] op_sel_hi:[1,1]
  v_max3_f32 v58, |v48|, |v49|, v58
  v_mfma_f32_16x16x32_f16 v[216:219], v[164:167], v[140:143], v[216:219]
  v_pk_mul_f16 v135, v74, v75 op_sel:[0,0] op_sel_hi:[1,1]
  v_max3_f32 v58, |v50|, |v51|, v58
  v_mfma_f32_16x16x32_f16 v[232:235], v[164:167], v[152:155], v[232:235]
  s_waitcnt lgkmcnt(3)
  v_pk_mul_f16 v144, v93, v99 op_sel:[0,1] op_sel_hi:[1,1]
  v_mfma_f32_16x16x32_f16 v[188:191], v[168:171], v[116:119], v[188:191]
  ds_read_b128 v[164:167], v1 offset:4096
  v_pk_mul_f16 v145, v93, v100 op_sel:[0,0] op_sel_hi:[1,0]
  v_mfma_f32_16x16x32_f16 v[204:207], v[168:171], v[128:131], v[204:207]
  s_nop 0
  v_pk_mul_f16 v146, v100, v100 op_sel:[0,0] op_sel_hi:[1,1]
  v_max3_f32 v58, |v52|, |v53|, v58
  v_mfma_f32_16x16x32_f16 v[220:223], v[168:171], v[140:143], v[220:223]
  v_pk_mul_f16 v147, v88, v89 op_sel:[0,0] op_sel_hi:[1,1]
  v_max3_f32 v58, |v54|, |v55|, v58
  v_mfma_f32_16x16x32_f16 v[236:239], v[168:171], v[152:155], v[236:239]
  s_waitcnt lgkmcnt(3)
  v_pk_mul_f16 v156, v107, v113 op_sel:[0,1] op_sel_hi:[1,1]
  v_mfma_f32_16x16x32_f16 v[192:195], v[172:175], v[120:123], v[192:195]
  s_nop 0
  v_pk_mul_f16 v157, v107, v114 op_sel:[0,0] op_sel_hi:[1,0]
  v_max3_f32 v58, |v56|, |v57|, v58
  v_mfma_f32_16x16x32_f16 v[208:211], v[172:175], v[132:135], v[208:211]
  v_pk_mul_f16 v158, v114, v114 op_sel:[0,0] op_sel_hi:[1,1]
  v_cvt_pk_f16_f32 v62, v32, v33
  v_mfma_f32_16x16x32_f16 v[224:227], v[172:175], v[144:147], v[224:227]
  v_pk_mul_f16 v159, v102, v103 op_sel:[0,0] op_sel_hi:[1,1]
  s_nop 1
  v_mfma_f32_16x16x32_f16 v[240:243], v[172:175], v[156:159], v[240:243]
  s_waitcnt lgkmcnt(2)
  v_cvt_pk_f16_f32 v76, v34, v35
  v_cvt_pk_f16_f32 v90, v36, v37
  v_mfma_f32_16x16x32_f16 v[184:187], v[176:179], v[120:123], v[184:187]
  ds_write_b32 v11, v62 offset:0
  v_mfma_f32_16x16x32_f16 v[200:203], v[176:179], v[132:135], v[200:203]
  ds_write_b32 v11, v76 offset:160
  v_mfma_f32_16x16x32_f16 v[216:219], v[176:179], v[144:147], v[216:219]
  ds_write_b32 v11, v90 offset:320
  v_mfma_f32_16x16x32_f16 v[232:235], v[176:179], v[156:159], v[232:235]
  s_waitcnt lgkmcnt(4)
  v_cvt_pk_f16_f32 v104, v38, v39
  v_cvt_pk_f16_f32 v63, v40, v41
  v_mfma_f32_16x16x32_f16 v[188:191], v[180:183], v[120:123], v[188:191]
  ds_write_b32 v11, v104 offset:480
  v_mfma_f32_16x16x32_f16 v[204:207], v[180:183], v[132:135], v[204:207]
  ds_write_b32 v11, v63 offset:640
  v_mfma_f32_16x16x32_f16 v[220:223], v[180:183], v[144:147], v[220:223]
  v_cvt_pk_f16_f32 v77, v42, v43
  v_cvt_pk_f16_f32 v91, v44, v45
  v_mfma_f32_16x16x32_f16 v[236:239], v[180:183], v[156:159], v[236:239]
  s_waitcnt lgkmcnt(5)
  v_cvt_pk_f16_f32 v105, v46, v47
  v_cvt_pk_f16_f32 v66, v48, v49
  v_smfmac_f32_16x16x64_f16 v[196:199], v[164:167], v[116:123], v9
  ds_write_b32 v11, v77 offset:800
  v_smfmac_f32_16x16x64_f16 v[212:215], v[164:167], v[128:135], v9
  ds_write_b32 v11, v91 offset:960
  v_smfmac_f32_16x16x64_f16 v[228:231], v[164:167], v[140:147], v9
  ds_write_b32 v11, v105 offset:1120
  v_smfmac_f32_16x16x64_f16 v[244:247], v[164:167], v[152:159], v9
  ds_write_b32 v11, v66 offset:1280
  s_setprio 0
  s_sub_u32 s72, s72, 1
  s_cmp_eq_u32 s72, 0
  s_cbranch_scc1 L_cin_done
  v_cvt_pk_f16_f32 v80, v50, v51
  v_cvt_pk_f16_f32 v94, v52, v53
  v_cvt_pk_f16_f32 v108, v54, v55
  v_cvt_pk_f16_f32 v67, v56, v57
  ds_write_b32 v11, v80 offset:1440
  ds_write_b32 v11, v94 offset:1600
  ds_write_b32 v11, v108 offset:1760
  ds_write_b32 v11, v67 offset:1920
  s_branch L_cin_loop
L_cslow:
  v_max_f32_dpp v58, v58, v58 row_shr:1 row_mask:0xf bank_mask:0xf
  s_nop 1
  v_max_f32_dpp v58, v58, v58 row_shr:2 row_mask:0xf bank_mask:0xf
  s_nop 1
  v_max_f32_dpp v58, v58, v58 row_shr:4 row_mask:0xf bank_mask:0xf
  s_nop 1
  v_max_f32_dpp v58, v58, v58 row_shr:8 row_mask:0xf bank_mask:0xf
  s_nop 1
  v_max_f32_dpp v58, v58, v58 row_bcast:15 row_mask:0xa bank_mask:0xf
  s_nop 1
  v_max_f32_dpp v58, v58, v58 row_bcast:31 row_mask:0xc bank_mask:0xf
  s_nop 0
  v_readlane_b32 s98, v58, 63
  s_mov_b32 s97, 0
  s_lshr_b32 s98, s98, 23
  s_min_u32 s98, s98, 182
  s_lshr_b32 s99, s1, 23
  s_sub_u32 s99, s99, 47
  s_lshr_b32 s99, s99, 1
  s_min_u32 s99, s99, 59
  s_sub_u32 s99, 131, s99
  s_max_u32 s98, s98, s99
  s_sub_u32 s99, 258, s98
  s_lshl_b32 s100, s99, 1
  s_sub_u32 s100, s100, 127
  s_sub_u32 s95, 254, s100
  s_lshl_b32 s95, s95, 23
  v_mov_b32 v60, s95
  v_mul_f32 v61, s0, v60
  v_mul_f32 v60, s1, v60
  v_readfirstlane_b32 s74, v61
  v_readfirstlane_b32 s75, v60
  s_lshl_b32 s99, s99, 23
  s_lshl_b32 s100, s100, 23
  v_mul_f32 v60, s99, v32
  v_mul_f32 v61, s99, v33
  v_mul_f32 v62, s100, v32
  v_mul_f32 v63, s100, v33
  v_cvt_pk_f16_f32 v80, v60, v61
  v_cvt_pk_bf16_f32 v64, v62, v63
  ds_write_b32 v11, v80 offset:0
  ds_write_b32 v10, v64 offset:0
  v_mul_f32 v60, s99, v34
  v_mul_f32 v61, s99, v35
  v_mul_f32 v62, s100, v34
  v_mul_f32_e64 v63, s100, v35
  v_cvt_pk_f16_f32 v81, v60, v61
  v_cvt_pk_bf16_f32 v65, v62, v63
  ds_write_b32 v11, v81 offset:160
  ds_write_b32 v10, v65 offset:2112
  v_mul_f32 v60, s99, v36
  v_mul_f32 v61, s99, v37
  v_mul_f32 v62, s100, v36
  v_mul_f32 v63, s100, v37
  v_cvt_pk_f16_f32 v82, v60, v61
  v_cvt_pk_bf16_f32 v66, v62, v63
  ds_write_b32 v11, v82 offset:320
  ds_write_b32 v10, v66 offset:128
  v_mul_f32 v60, s99, v38
  v_mul_f32 v61, s99, v39
  v_mul_f32 v62, s100, v38
  v_mul_f32 v63, s100, v39
  v_cvt_pk_f16_f32 v83, v60, v61
  v_cvt_pk_bf16_f32 v67, v62, v63
  ds_write_b32 v11, v83 offset:480
  ds_write_b32 v10, v67 offset:2240
  v_mul_f32 v60, s99, v40
  v_mul_f32 v61, s99, v41
  v_mul_f32 v62, s100, v40
  v_mul_f32 v63, s100, v41
  v_cvt_pk_f16_f32 v84, v60, v61
  v_cvt_pk_bf16_f32 v68, v62, v63
  ds_write_b32 v11, v84 offset:640
  ds_write_b32 v10, v68 offset:256
  v_mul_f32 v60, s99, v42
  v_mul_f32 v61, s99, v43
  v_mul_f32 v62, s100, v42
  v_mul_f32 v63, s100, v43
  v_cvt_pk_f16_f32 v85, v60, v61
  v_cvt_pk_bf16_f32 v69, v62, v63
  ds_write_b32 v11, v85 offset:800
  ds_write_b32 v10, v69 offset:2368
  v_mul_f32 v60, s99, v44
  v_mul_f32 v61, s99, v45
  v_mul_f32 v62, s100, v44
  v_mul_f32 v63, s100, v45
  v_cvt_pk_f16_f32 v86, v60, v61
  v_cvt_pk_bf16_f32 v70, v62, v63
  ds_write_b32 v11, v86 offset:960
  ds_write_b32 v10, v70 offset:384
  v_mul_f32 v60, s99, v46
  v_mul_f32 v61, s99, v47
  v_mul_f32 v62, s100, v46
  v_mul_f32 v63, s100, v47
  v_cvt_pk_f16_f32 v87, v60, v61
  v_cvt_pk_bf16_f32 v71, v62, v63
  ds_write_b32 v11, v87 offset:1120
  ds_write_b32 v10, v71 offset:2496
  v_mul_f32 v60, s99, v48
  v_mul_f32 v61, s99, v49
  v_mul_f32 v62, s100, v48
  v_mul_f32 v63, s100, v49
  v_cvt_pk_f16_f32 v88, v60, v61
  v_cvt_pk_bf16_f32 v72, v62, v63
  ds_write_b32 v11, v88 offset:1280
  ds_write_b32 v10, v72 offset:512
  v_mul_f32 v60, s99, v50
  v_mul_f32 v61, s99, v51
  v_mul_f32 v62, s100, v50
  v_mul_f32 v63, s100, v51
  v_cvt_pk_f16_f32 v89, v60, v61
  v_cvt_pk_bf16_f32 v73, v62, v63
  ds_write_b32 v11, v89 offset:1440
  ds_write_b32 v10, v73 offset:2624
  v_mul_f32 v60, s99, v52
  v_mul_f32 v61, s99, v53
  v_mul_f32 v62, s100, v52
  v_mul_f32 v63, s100, v53
  v_cvt_pk_f16_f32 v90, v60, v61
  v_cvt_pk_bf16_f32 v74, v62, v63
  ds_write_b32 v11, v90 offset:1600
  ds_write_b32 v10, v74 offset:640
  v_mul_f32 v60, s99, v54
  v_mul_f32 v61, s99, v55
  v_mul_f32 v62, s100, v54
  v_mul_f32 v63, s100, v55
  v_cvt_pk_f16_f32 v91, v60, v61
  v_cvt_pk_bf16_f32 v75, v62, v63
  ds_write_b32 v11, v91 offset:1760
  ds_write_b32 v10, v75 offset:2752
  v_mul_f32 v60, s99, v56
  v_mul_f32 v61, s99, v57
  v_mul_f32 v62, s100, v56
  v_mul_f32 v63, s100, v57
  v_cvt_pk_f16_f32 v92, v60, v61
  v_cvt_pk_bf16_f32 v76, v62, v63
  ds_write_b32 v11, v92 offset:1920
  ds_write_b32 v10, v76 offset:768
  v_mov_b32 v60, s100
  v_cvt_pk_bf16_f32 v60, v60, v60
  s_mov_b32 exec_hi, 0
  ds_write_b32 v10, v60 offset:2880
  s_mov_b32 exec_hi, -1
  s_waitcnt lgkmcnt(0)
  s_branch L_cconv
L_sdown:
  v_lshlrev_b32 v108, 16, v112
  v_and_b32 v109, 0xffff0000, v112
  v_mul_f32 v108, v108, v250
  v_mul_f32 v109, v109, v250
  v_cvt_pk_bf16_f32 v112, v108, v109
  v_lshlrev_b32 v108, 16, v113
  v_and_b32 v109, 0xffff0000, v113
  v_mul_f32 v108, v108, v250
  v_mul_f32 v109, v109, v250
  v_cvt_pk_bf16_f32 v113, v108, v109
  v_lshlrev_b32 v108, 16, v114
  v_and_b32 v109, 0xffff0000, v114
  v_mul_f32 v108, v108, v250
  v_mul_f32 v109, v109, v250
  v_cvt_pk_bf16_f32 v114, v108, v109
  v_lshlrev_b32 v108, 16, v115
  v_and_b32 v109, 0xffff0000, v115
  v_mul_f32 v108, v108, v250
  v_mul_f32_e64 v109, v109, v250
  v_cvt_pk_bf16_f32 v115, v108, v109
  v_lshlrev_b32 v108, 16, v116
  v_and_b32 v109, 0xffff0000, v116
  v_mul_f32 v108, v108, v250
  v_mul_f32 v109, v109, v250
  v_cvt_pk_bf16_f32 v116, v108, v109
  v_lshlrev_b32 v108, 16, v117
  v_and_b32 v109, 0xffff0000, v117
  v_mul_f32 v108, v108, v250
  v_mul_f32 v109, v109, v250
  v_cvt_pk_bf16_f32 v117, v108, v109
  v_lshlrev_b32 v108, 16, v118
  v_and_b32 v109, 0xffff0000, v118
  v_mul_f32 v108, v108, v250
  v_mul_f32 v109, v109, v250
  v_cvt_pk_bf16_f32 v118, v108, v109
  v_lshlrev_b32 v108, 16, v119
  v_and_b32 v109, 0xffff0000, v119
  v_mul_f32 v108, v108, v250
  v_mul_f32_e64 v109, v109, v250
  v_cvt_pk_bf16_f32 v119, v108, v109
  s_branch L_scaled
L_first:
  ds_read_b64_tr_b16 v[60:61], v20 offset:0
  ds_read_b64_tr_b16 v[74:75], v20 offset:32
  ds_read_b64_tr_b16 v[88:89], v20 offset:64
  ds_read_b64_tr_b16 v[102:103], v20 offset:96
  ds_read_b64_tr_b16 v[66:67], v23 offset:0
  ds_read_b64_tr_b16 v[80:81], v23 offset:32
  ds_read_b64_tr_b16 v[94:95], v23 offset:64
  ds_read_b64_tr_b16 v[108:109], v23 offset:96
  ds_read_b64_tr_b16 v[68:69], v24 offset:0
  ds_read_b64_tr_b16 v[82:83], v24 offset:32
  ds_read_b64_tr_b16 v[96:97], v24 offset:64
  ds_read_b64_tr_b16 v[110:111], v24 offset:96
  ds_read_b64_tr_b16 v[124:125], v4 offset:0
  ds_read_b64_tr_b16 v[126:127], v5 offset:0
  ds_read_b64_tr_b16 v[136:137], v4 offset:32
  ds_read_b64_tr_b16 v[138:139], v5 offset:32
  ds_read_b64_tr_b16 v[148:149], v4 offset:64
  ds_read_b64_tr_b16 v[150:151], v5 offset:64
  ds_read_b64_tr_b16 v[160:161], v4 offset:96
  ds_read_b64_tr_b16 v[162:163], v5 offset:96
  ds_read_b128 v[164:167], v1 offset:39936
  ds_read_b128 v[168:171], v1 offset:40960
  ds_read_b128 v[172:175], v1 offset:8192
  ds_read_b128 v[176:179], v1 offset:6144
  ds_read_b64_tr_b16 v[70:71], v25 offset:0
  ds_read_b64_tr_b16 v[84:85], v25 offset:32
  ds_read_b64_tr_b16 v[98:99], v25 offset:64
  ds_read_b64_tr_b16 v[112:113], v25 offset:96
  ds_read_b64_tr_b16 v[72:73], v26 offset:0
  s_waitcnt lgkmcnt(14)
  v_pk_mul_f16 v120, v60, v67 op_sel:[0,0] op_sel_hi:[0,1]
  v_pk_mul_f16 v121, v60, v67 op_sel:[1,0] op_sel_hi:[1,1]
  ds_read_b64_tr_b16 v[86:87], v26 offset:32
  v_pk_mul_f16 v122, v60, v68 op_sel:[0,0] op_sel_hi:[0,1]
  ds_read_b64_tr_b16 v[100:101], v26 offset:64
  v_pk_mul_f16 v123, v60, v68 op_sel:[1,0] op_sel_hi:[1,1]
  ds_read_b64_tr_b16 v[114:115], v26 offset:96
  v_pk_mul_f16 v132, v74, v81 op_sel:[0,0] op_sel_hi:[0,1]
  v_pk_mul_f16 v133, v74, v81 op_sel:[1,0] op_sel_hi:[1,1]
  ds_read_b64_tr_b16 v[62:63], v21 offset:0
  v_pk_mul_f16 v134, v74, v82 op_sel:[0,0] op_sel_hi:[0,1]
  ds_read_b64_tr_b16 v[76:77], v21 offset:32
  v_pk_mul_f16 v135, v74, v82 op_sel:[1,0] op_sel_hi:[1,1]
  ds_read_b64_tr_b16 v[90:91], v21 offset:64
  v_pk_mul_f16 v144, v88, v95 op_sel:[0,0] op_sel_hi:[0,1]
  v_pk_mul_f16 v145, v88, v95 op_sel:[1,0] op_sel_hi:[1,1]
  ds_read_b64_tr_b16 v[104:105], v21 offset:96
  v_pk_mul_f16 v146, v88, v96 op_sel:[0,0] op_sel_hi:[0,1]
  ds_read_b64_tr_b16 v[64:65], v22 offset:0
  v_pk_mul_f16 v147, v88, v96 op_sel:[1,0] op_sel_hi:[1,1]
  ds_read_b64_tr_b16 v[78:79], v22 offset:32
  v_pk_mul_f16 v156, v102, v109 op_sel:[0,0] op_sel_hi:[0,1]
  v_pk_mul_f16 v157, v102, v109 op_sel:[1,0] op_sel_hi:[1,1]
  ds_read_b64_tr_b16 v[92:93], v22 offset:64
  v_pk_mul_f16 v158, v102, v110 op_sel:[0,0] op_sel_hi:[0,1]
  ds_read_b64_tr_b16 v[106:107], v22 offset:96
  v_pk_mul_f16 v159, v102, v110 op_sel:[1,0] op_sel_hi:[1,1]
  s_branch L_novm
L_end:
  s_endpgm
.p2align 8
L_tables:
.long 0x0, 0x1800, 0x6c80, 0x81a0, 0x8, 0x1808, 0x6c88, 0x81a8
.long 0x10, 0x1810, 0x6c90, 0x81b0, 0x18, 0x1818, 0x6c98, 0x81b8
.long 0x40, 0x1d48, 0x71c8, 0x86e8, 0x48, 0x1d50, 0x71d0, 0x86f0
.long 0x50, 0x1d58, 0x71d8, 0x86f8, 0x58, 0x1d60, 0x71e0, 0x8700
.long 0x80, 0x2290, 0x7710, 0x8c30, 0x88, 0x2298, 0x7718, 0x8c38
.long 0x90, 0x22a0, 0x7720, 0x8c40, 0x98, 0x22a8, 0x7728, 0x8c48
.long 0xc0, 0x27d8, 0x7c58, 0x9178, 0xc8, 0x27e0, 0x7c60, 0x9180
.long 0xd0, 0x27e8, 0x7c68, 0x9188, 0xd8, 0x27f0, 0x7c70, 0x9190
.long 0x20, 0x1820, 0x6ca0, 0x81c0, 0x28, 0x1828, 0x6ca8, 0x81c8
.long 0x30, 0x1830, 0x6cb0, 0x81d0, 0x38, 0x1838, 0x6cb8, 0x81d8
.long 0x60, 0x1d68, 0x71e8, 0x8708, 0x68, 0x1d70, 0x71f0, 0x8710
.long 0x70, 0x1d78, 0x71f8, 0x8718, 0x78, 0x1d80, 0x7200, 0x8720
.long 0xa0, 0x22b0, 0x7730, 0x8c50, 0xa8, 0x22b8, 0x7738, 0x8c58
.long 0xb0, 0x22c0, 0x7740, 0x8c60, 0xb8, 0x22c8, 0x7748, 0x8c68
.long 0xe0, 0x27f8, 0x7c78, 0x9198, 0xe8, 0x2800, 0x7c80, 0x91a0
.long 0xf0, 0x2808, 0x7c88, 0x91a8, 0xf8, 0x2810, 0x7c90, 0x91b0
.long 0x200, 0x4240, 0x96c0, 0x9c08, 0x208, 0x4248, 0x96c8, 0x9c10
.long 0x210, 0x4250, 0x96d0, 0x9c18, 0x218, 0x4258, 0x96d8, 0x9c20
.long 0x240, 0x4788, 0x9c08, 0x9c08, 0x248, 0x4790, 0x9c10, 0x9c10
.long 0x250, 0x4798, 0x9c18, 0x9c18, 0x258, 0x47a0, 0x9c20, 0x9c20
.long 0x280, 0x4cd0, 0x9c08, 0x9c08, 0x288, 0x4cd8, 0x9c10, 0x9c10
.long 0x290, 0x4ce0, 0x9c18, 0x9c18, 0x298, 0x4ce8, 0x9c20, 0x9c20
.long 0x2c0, 0x5218, 0x9c08, 0x9c08, 0x2c8, 0x5220, 0x9c10, 0x9c10
.long 0x2d0, 0x5228, 0x9c18, 0x9c18, 0x2d8, 0x5230, 0x9c20, 0x9c20
.long 0x220, 0x4260, 0x96e0, 0x9c28, 0x228, 0x4268, 0x96e8, 0x9c30
.long 0x230, 0x4270, 0x96f0, 0x9c38, 0x238, 0x4278, 0x96f8, 0x9c40
.long 0x260, 0x47a8, 0x9c28, 0x9c28, 0x268, 0x47b0, 0x9c30, 0x9c30
.long 0x270, 0x47b8, 0x9c38, 0x9c38, 0x278, 0x47c0, 0x9c40, 0x9c40
.long 0x2a0, 0x4cf0, 0x9c28, 0x9c28, 0x2a8, 0x4cf8, 0x9c30, 0x9c30
.long 0x2b0, 0x4d00, 0x9c38, 0x9c38, 0x2b8, 0x4d08, 0x9c40, 0x9c40
.long 0x2e0, 0x5238, 0x9c28, 0x9c28, 0x2e8, 0x5240, 0x9c30, 0x9c30
.long 0x2f0, 0x5248, 0x9c38, 0x9c38, 0x2f8, 0x5250, 0x9c40, 0x9c40
.long 0xaae0, 0xa680, 0xa900, 0xaae0, 0xaae8, 0xa688, 0xa908, 0xaae8
.long 0xaaf0, 0xa690, 0xa910, 0xaaf0, 0xaaf8, 0xa698, 0xa918, 0xaaf8
.long 0xaa40, 0xa860, 0xa9a0, 0xaa40, 0xaa48, 0xa868, 0xa9a8, 0xaa48
.long 0xaa50, 0xa870, 0xa9b0, 0xaa50, 0xaa58, 0xa878, 0xa9b8, 0xaa58
.long 0xa400, 0xa7c0, 0xa540, 0xa400, 0xa408, 0xa7c8, 0xa548, 0xa408
.long 0xa410, 0xa7d0, 0xa550, 0xa410, 0xa418, 0xa7d8, 0xa558, 0xa418
.long 0xa4a0, 0xa720, 0xa5e0, 0xa4a0, 0xa4a8, 0xa728, 0xa5e8, 0xa4a8
.long 0xa4b0, 0xa730, 0xa5f0, 0xa4b0, 0xa4b8, 0xa738, 0xa5f8, 0xa4b8
.long 0xb260, 0xb4e0, 0xb6c0, 0xb260, 0xb268, 0xb4e8, 0xb6c8, 0xb268
.long 0xb270, 0xb4f0, 0xb6d0, 0xb270, 0xb278, 0xb4f8, 0xb6d8, 0xb278
.long 0xb1c0, 0xb300, 0xb760, 0xb1c0, 0xb1c8, 0xb308, 0xb768, 0xb1c8
.long 0xb1d0, 0xb310, 0xb770, 0xb1d0, 0xb1d8, 0xb318, 0xb778, 0xb1d8
.long 0xb580, 0xb440, 0xb080, 0xb580, 0xb588, 0xb448, 0xb088, 0xb588
.long 0xb590, 0xb450, 0xb090, 0xb590, 0xb598, 0xb458, 0xb098, 0xb598
.long 0xb620, 0xb3a0, 0xb120, 0xb620, 0xb628, 0xb3a8, 0xb128, 0xb628
.long 0xb630, 0xb3b0, 0xb130, 0xb630, 0xb638, 0xb3b8, 0xb138, 0xb638
.long 0xa900, 0xa400, 0xaae0, 0xb620, 0xa908, 0xa408, 0xaae8, 0xb628
.long 0xa910, 0xa410, 0xaaf0, 0xb630, 0xa918, 0xa418, 0xaaf8, 0xb638
.long 0xa9a0, 0xa4a0, 0xab80, 0xb800, 0xa9a8, 0xa4a8, 0xab88, 0xb808
.long 0xa9b0, 0xa4b0, 0xab90, 0xb810, 0xa9b8, 0xa4b8, 0xab98, 0xb818
.long 0xaa40, 0xa680, 0xa860, 0xb3a0, 0xaa48, 0xa688, 0xa868, 0xb3a8
.long 0xaa50, 0xa690, 0xa870, 0xb3b0, 0xaa58, 0xa698, 0xa878, 0xb3b8
.long 0xa720, 0xa540, 0xa7c0, 0xb1c0, 0xa728, 0xa548, 0xa7c8, 0xb1c8
.long 0xa730, 0xa550, 0xa7d0, 0xb1d0, 0xa738, 0xa558, 0xa7d8, 0xb1d8
.long 0xa5e0, 0xaae0, 0xa400, 0xb080, 0xa5e8, 0xaae8, 0xa408, 0xb088
.long 0xa5f0, 0xaaf0, 0xa410, 0xb090, 0xa5f8, 0xaaf8, 0xa418, 0xb098
.long 0xa7c0, 0xa540, 0xa720, 0xb760, 0xa7c8, 0xa548, 0xa728, 0xb768
.long 0xa7d0, 0xa550, 0xa730, 0xb770, 0xa7d8, 0xa558, 0xa738, 0xb778
.long 0xa860, 0xa680, 0xaa40, 0xb440, 0xa868, 0xa688, 0xaa48, 0xb448
.long 0xa870, 0xa690, 0xaa50, 0xb450, 0xa878, 0xa698, 0xaa58, 0xb458
.long 0xab80, 0xa4a0, 0xa9a0, 0xb4e0, 0xab88, 0xa4a8, 0xa9a8, 0xb4e8
.long 0xab90, 0xa4b0, 0xa9b0, 0xb4f0, 0xab98, 0xa4b8, 0xa9b8, 0xb4f8
.long 0xa680, 0xa900, 0xab80, 0xa4a0, 0xa688, 0xa908, 0xab88, 0xa4a8
.long 0xa690, 0xa910, 0xab90, 0xa4b0, 0xa698, 0xa918, 0xab98, 0xa4b8
.long 0xa860, 0xa9a0, 0xb1c0, 0xb440, 0xa868, 0xa9a8, 0xb1c8, 0xb448
.long 0xa870, 0xa9b0, 0xb1d0, 0xb450, 0xa878, 0xa9b8, 0xb1d8, 0xb458
.long 0xa7c0, 0xa540, 0xab80, 0xa4a0, 0xa7c8, 0xa548, 0xab88, 0xa4a8
.long 0xa7d0, 0xa550, 0xab90, 0xa4b0, 0xa7d8, 0xa558, 0xab98, 0xa4b8
.long 0xa720, 0xa5e0, 0xb1c0, 0xb440, 0xa728, 0xa5e8, 0xb1c8, 0xb448
.long 0xa730, 0xa5f0, 0xb1d0, 0xb450, 0xa738, 0xa5f8, 0xb1d8, 0xb458
.long 0xb4e0, 0xb6c0, 0xb800, 0xa860, 0xb4e8, 0xb6c8, 0xb808, 0xa868
.long 0xb4f0, 0xb6d0, 0xb810, 0xa870, 0xb4f8, 0xb6d8, 0xb818, 0xa878
.long 0xb300, 0xb760, 0xa540, 0xa900, 0xb308, 0xb768, 0xa548, 0xa908
.long 0xb310, 0xb770, 0xa550, 0xa910, 0xb318, 0xb778, 0xa558, 0xa918
.long 0xb440, 0xb080, 0xb800, 0xa860, 0xb448, 0xb088, 0xb808, 0xa868
.long 0xb450, 0xb090, 0xb810, 0xa870, 0xb458, 0xb098, 0xb818, 0xa878
.long 0xb3a0, 0xb120, 0xa540, 0xa900, 0xb3a8, 0xb128, 0xa548, 0xa908
.long 0xb3b0, 0xb130, 0xa550, 0xa910, 0xb3b8, 0xb138, 0xa558, 0xa918
.long 0xb120, 0xb580, 0xb080, 0xb300, 0xb128, 0xb588, 0xb088, 0xb308
.long 0xb130, 0xb590, 0xb090, 0xb310, 0xb138, 0xb598, 0xb098, 0xb318
.long 0xb6c0, 0xb4e0, 0xaa40, 0xb6c0, 0xb6c8, 0xb4e8, 0xaa48, 0xb6c8
.long 0xb6d0, 0xb4f0, 0xaa50, 0xb6d0, 0xb6d8, 0xb4f8, 0xaa58, 0xb6d8
.long 0xb300, 0xb440, 0xb080, 0xb300, 0xb308, 0xb448, 0xb088, 0xb308
.long 0xb310, 0xb450, 0xb090, 0xb310, 0xb318, 0xb458, 0xb098, 0xb318
.long 0xb260, 0xb760, 0xaa40, 0xb6c0, 0xb268, 0xb768, 0xaa48, 0xb6c8
.long 0xb270, 0xb770, 0xaa50, 0xb6d0, 0xb278, 0xb778, 0xaa58, 0xb6d8
.long 0xb580, 0xb120, 0xb620, 0xa680, 0xb588, 0xb128, 0xb628, 0xa688
.long 0xb590, 0xb130, 0xb630, 0xa690, 0xb598, 0xb138, 0xb638, 0xa698
.long 0xb260, 0xb1c0, 0xa7c0, 0xa680, 0xb268, 0xb1c8, 0xa7c8, 0xa688
.long 0xb270, 0xb1d0, 0xa7d0, 0xa690, 0xb278, 0xb1d8, 0xa7d8, 0xa698
.long 0xb300, 0xb3a0, 0xb620, 0xb300, 0xb308, 0xb3a8, 0xb628, 0xb308
.long 0xb310, 0xb3b0, 0xb630, 0xb310, 0xb318, 0xb3b8, 0xb638, 0xb318
.long 0xb6c0, 0xb800, 0xa7c0, 0xb300, 0xb6c8, 0xb808, 0xa7c8, 0xb308
.long 0xb6d0, 0xb810, 0xa7d0, 0xb310, 0xb6d8, 0xb818, 0xa7d8, 0xb318
.long 0x0, 0x200, 0x0, 0x3f803f80, 0x8, 0x208, 0x0, 0x3f803f80
.long 0x10, 0x210, 0x0, 0x3f803f80, 0x18, 0x218, 0x0, 0x3f803f80
.long 0x420, 0x620, 0x0, 0x3f803f80, 0x428, 0x628, 0x0, 0x3f803f80
.long 0x430, 0x630, 0x0, 0x3f803f80, 0x438, 0x638, 0x0, 0x3f803f80
.long 0x840, 0xa40, 0x10, 0x3f803f80, 0x848, 0xa48, 0x10, 0x3f803f80
.long 0x850, 0xa50, 0x10, 0x3f803f80, 0x858, 0xa58, 0x10, 0x3f803f80
.long 0xc60, 0xe60, 0x10, 0x3f803f80, 0xc68, 0xe68, 0x10, 0x3f803f80
.long 0xc70, 0xe70, 0x10, 0x3f803f80, 0xc78, 0xe78, 0x10, 0x3f803f80
.long 0x80, 0x280, 0x20, 0x3f803f80, 0x88, 0x288, 0x20, 0x3f803f80
.long 0x90, 0x290, 0x20, 0x3f803f80, 0x98, 0x298, 0x20, 0x3f803f80
.long 0x4a0, 0x6a0, 0x20, 0x3f803f80, 0x4a8, 0x6a8, 0x20, 0x3f803f80
.long 0x4b0, 0x6b0, 0x20, 0x3f803f80, 0x4b8, 0x6b8, 0x20, 0x3f803f80
.long 0x8c0, 0xac0, 0x30, 0x3f803f80, 0x8c8, 0xac8, 0x30, 0x3f803f80
.long 0x8d0, 0xad0, 0x30, 0x3f803f80, 0x8d8, 0xad8, 0x30, 0x3f803f80
.long 0xce0, 0xee0, 0x30, 0x3f803f80, 0xce8, 0xee8, 0x30, 0x3f803f80
.long 0xcf0, 0xef0, 0x30, 0x3f803f80, 0xcf8, 0xef8, 0x30, 0x3f803f80
.long 0x100, 0x300, 0x40, 0x0, 0x108, 0x308, 0x40, 0x0
.long 0x110, 0x310, 0x40, 0x0, 0x118, 0x318, 0x40, 0x0
.long 0x520, 0x720, 0x40, 0x0, 0x528, 0x728, 0x40, 0x0
.long 0x530, 0x730, 0x40, 0x0, 0x538, 0x738, 0x40, 0x0
.long 0x940, 0xb40, 0x50, 0x0, 0x948, 0xb48, 0x50, 0x0
.long 0x950, 0xb50, 0x50, 0x0, 0x958, 0xb58, 0x50, 0x0
.long 0xd60, 0xf60, 0x50, 0x0, 0xd68, 0xf68, 0x50, 0x0
.long 0xd70, 0xf70, 0x50, 0x0, 0xd78, 0xf78, 0x50, 0x0
.long 0x180, 0xf60, 0x60, 0x0, 0x188, 0xf68, 0x60, 0x0
.long 0x190, 0xf70, 0x60, 0x0, 0x198, 0xf78, 0x60, 0x0
.long 0x5a0, 0xf60, 0x60, 0x0, 0x5a8, 0xf68, 0x60, 0x0
.long 0x5b0, 0xf70, 0x60, 0x0, 0x5b8, 0xf78, 0x60, 0x0
.long 0x9c0, 0xf60, 0x70, 0x0, 0x9c8, 0xf68, 0x70, 0x0
.long 0x9d0, 0xf70, 0x70, 0x0, 0x9d8, 0xf78, 0x70, 0x0
.long 0xde0, 0xf60, 0x70, 0x0, 0xde8, 0xf68, 0x70, 0x0
.long 0xdf0, 0xf70, 0x70, 0x0, 0xdf8, 0xf78, 0x70, 0x0
.long 0xffff, 0x0, 0x0, 0x0, 0x0, 0x0, 0xffff, 0x0
.long 0x0, 0x0, 0x0, 0x0, 0x0, 0x0, 0x0, 0x0
.long 0x0, 0x0, 0x0, 0x0, 0x0, 0x0, 0x0, 0x0
.long 0x0, 0x0, 0x0, 0x0, 0x0, 0x0, 0x0, 0x0
.long 0xffff0000, 0x0, 0x0, 0x0, 0x0, 0x0, 0xffff0000, 0x0
.long 0x0, 0x0, 0x0, 0x0, 0x0, 0x0, 0x0, 0x0
.long 0x0, 0x0, 0x0, 0x0, 0x0, 0x0, 0x0, 0x0
.long 0x0, 0x0, 0x0, 0x0, 0x0, 0x0, 0x0, 0x0
.long 0x0, 0xffff, 0x0, 0x0, 0x0, 0x0, 0x0, 0xffff
.long 0x0, 0x0, 0x0, 0x0, 0x0, 0x0, 0x0, 0x0
.long 0x0, 0x0, 0x0, 0x0, 0x0, 0x0, 0x0, 0x0
.long 0x0, 0x0, 0x0, 0x0, 0x0, 0x0, 0x0, 0x0
.long 0x0, 0xffff0000, 0x0, 0x0, 0x0, 0x0, 0x0, 0xffff0000
.long 0x0, 0x0, 0x0, 0x0, 0x0, 0x0, 0x0, 0x0
.long 0x0, 0x0, 0x0, 0x0, 0x0, 0x0, 0x0, 0x0
.long 0x0, 0x0, 0x0, 0x0, 0x0, 0x0, 0x0, 0x0
.long 0x0, 0x0, 0x0, 0x0, 0x0, 0x0, 0x0, 0x0
.long 0xffff, 0x0, 0x0, 0x0, 0x0, 0x0, 0xffff, 0x0
.long 0x0, 0x0, 0x0, 0x0, 0x0, 0x0, 0x0, 0x0
.long 0x0, 0x0, 0x0, 0x0, 0x0, 0x0, 0x0, 0x0
.long 0x0, 0x0, 0x0, 0x0, 0x0, 0x0, 0x0, 0x0
.long 0xffff0000, 0x0, 0x0, 0x0, 0x0, 0x0, 0xffff0000, 0x0
.long 0x0, 0x0, 0x0, 0x0, 0x0, 0x0, 0x0, 0x0
.long 0x0, 0x0, 0x0, 0x0, 0x0, 0x0, 0x0, 0x0
.long 0x0, 0x0, 0x0, 0x0, 0x0, 0x0, 0x0, 0x0
.long 0x0, 0xffff, 0x0, 0x0, 0x0, 0x0, 0x0, 0xffff
.long 0x0, 0x0, 0x0, 0x0, 0x0, 0x0, 0x0, 0x0
.long 0x0, 0x0, 0x0, 0x0, 0x0, 0x0, 0x0, 0x0
.long 0x0, 0x0, 0x0, 0x0, 0x0, 0x0, 0x0, 0x0
.long 0x0, 0xffff0000, 0x0, 0x0, 0x0, 0x0, 0x0, 0xffff0000
.long 0x0, 0x0, 0x0, 0x0, 0x0, 0x0, 0x0, 0x0
.long 0x0, 0x0, 0x0, 0x0, 0x0, 0x0, 0x0, 0x0
.long 0x0, 0x0, 0x0, 0x0, 0x0, 0x0, 0x0, 0x0
.long 0x0, 0x0, 0x0, 0x0, 0x0, 0x0, 0x0, 0x0
.long 0x0, 0x0, 0xffff, 0x0, 0x0, 0x0, 0x0, 0x0
.long 0x0, 0x0, 0x0, 0x0, 0xffff, 0x0, 0x0, 0x0
.long 0x0, 0x0, 0x0, 0x0, 0x0, 0x0, 0x0, 0x0
.long 0x0, 0x0, 0x0, 0x0, 0x0, 0x0, 0x0, 0x0
.long 0x0, 0x0, 0xffff0000, 0x0, 0x0, 0x0, 0x0, 0x0
.long 0x0, 0x0, 0x0, 0x0, 0xffff0000, 0x0, 0x0, 0x0
.long 0x0, 0x0, 0x0, 0x0, 0x0, 0x0, 0x0, 0x0
.long 0x0, 0x0, 0x0, 0x0, 0x0, 0x0, 0x0, 0x0
.long 0x0, 0x0, 0x0, 0xffff, 0x0, 0x0, 0x0, 0x0
.long 0x0, 0x0, 0x0, 0x0, 0x0, 0xffff, 0x0, 0x0
.long 0x0, 0x0, 0x0, 0x0, 0x0, 0x0, 0x0, 0x0
.long 0x0, 0x0, 0x0, 0x0, 0x0, 0x0, 0x0, 0x0
.long 0x0, 0x0, 0x0, 0xffff0000, 0x0, 0x0, 0x0, 0x0
.long 0x0, 0x0, 0x0, 0x0, 0x0, 0xffff0000, 0x0, 0x0
.long 0x0, 0x0, 0x0, 0x0, 0x0, 0x0, 0x0, 0x0
.long 0x0, 0x0, 0x0, 0x0, 0x0, 0x0, 0x0, 0x0
.long 0x0, 0x0, 0x0, 0x0, 0xffff, 0x0, 0x0, 0x0
.long 0x0, 0x0, 0x0, 0x0, 0x0, 0x0, 0x0, 0x0
.long 0x0, 0x0, 0x0, 0x0, 0x0, 0x0, 0x0, 0x0
.long 0x0, 0x0, 0x0, 0x0, 0x0, 0x0, 0x0, 0x0
.long 0x0, 0x0, 0x0, 0x0, 0xffff0000, 0x0, 0x0, 0x0
.long 0x0, 0x0, 0x0, 0x0, 0x0, 0x0, 0x0, 0x0
.long 0x0, 0x0, 0x0, 0x0, 0x0, 0x0, 0x0, 0x0
.long 0x0, 0x0, 0x0, 0x0, 0x0, 0x0, 0x0, 0x0
.long 0x0, 0x0, 0x0, 0x0, 0x0, 0x0, 0x0, 0x0
.long 0x0, 0x0, 0x0, 0x0, 0x0, 0x0, 0x0, 0x0
.long 0x0, 0x0, 0x0, 0x0, 0x0, 0x0, 0x0, 0x0
.long 0x0, 0x0, 0x0, 0x0, 0x0, 0x0, 0x0, 0x0
.long 0x0, 0x0, 0x0, 0x0, 0x0, 0x0, 0x0, 0x0
.long 0x0, 0x0, 0x0, 0x0, 0x0, 0x0, 0x0, 0x0
.long 0x14d40, 0x14d40, 0x0, 0x0, 0x14e10, 0x14e10, 0x20, 0x20
.long 0x14ee0, 0x14ee0, 0x100000, 0x100000, 0x14fb0, 0x14fb0, 0x100020, 0x100020
.long 0x15080, 0x15080, 0x40, 0x40, 0x15150, 0x15150, 0x60, 0x60
.long 0x15220, 0x15220, 0x100040, 0x100040, 0x100000, 0x100000, 0x100060, 0x100060
.long 0x14d74, 0x14d74, 0x80, 0x80, 0x14e44, 0x14e44, 0xa0, 0xa0
.long 0x14f14, 0x14f14, 0x100080, 0x100080, 0x14fe4, 0x14fe4, 0x1000a0, 0x1000a0
.long 0x150b4, 0x150b4, 0xc0, 0xc0, 0x15184, 0x15184, 0xe0, 0xe0
.long 0x15254, 0x15254, 0x1000c0, 0x1000c0, 0x100000, 0x100000, 0x1000e0, 0x1000e0
.long 0x14da8, 0x14da8, 0x8, 0x100, 0x14e78, 0x14e78, 0x28, 0x120
.long 0x14f48, 0x14f48, 0x100008, 0x100100, 0x15018, 0x15018, 0x100028, 0x100120
.long 0x150e8, 0x150e8, 0x48, 0x140, 0x151b8, 0x151b8, 0x68, 0x160
.long 0x100000, 0x100000, 0x100048, 0x100140, 0x100000, 0x100000, 0x100068, 0x100160
.long 0x14ddc, 0x14ddc, 0x88, 0x180, 0x14eac, 0x14eac, 0xa8, 0x1a0
.long 0x14f7c, 0x14f7c, 0x100088, 0x100180, 0x1504c, 0x1504c, 0x1000a8, 0x1001a0
.long 0x1511c, 0x1511c, 0xc8, 0x1c0, 0x151ec, 0x151ec, 0xe8, 0x1e0
.long 0x100000, 0x100000, 0x1000c8, 0x1001c0, 0x100000, 0x100000, 0x1000e8, 0x1001e0
.long 0x17d40, 0x114d40, 0x100, 0x200, 0x17e10, 0x114e10, 0x120, 0x220
.long 0x17ee0, 0x114ee0, 0x100100, 0x100200, 0x17fb0, 0x114fb0, 0x100120, 0x100220
.long 0x18080, 0x115080, 0x140, 0x240, 0x18150, 0x115150, 0x160, 0x260
.long 0x18220, 0x115220, 0x100140, 0x100240, 0x103000, 0x200000, 0x100160, 0x100260
.long 0x17d74, 0x114d74, 0x180, 0x280, 0x17e44, 0x114e44, 0x1a0, 0x2a0
.long 0x17f14, 0x114f14, 0x100180, 0x100280, 0x17fe4, 0x114fe4, 0x1001a0, 0x1002a0
.long 0x180b4, 0x1150b4, 0x1c0, 0x2c0, 0x18184, 0x115184, 0x1e0, 0x2e0
.long 0x18254, 0x115254, 0x1001c0, 0x1002c0, 0x103000, 0x200000, 0x1001e0, 0x1002e0
.long 0x17da8, 0x114da8, 0x108, 0x300, 0x17e78, 0x114e78, 0x128, 0x320
.long 0x17f48, 0x114f48, 0x100108, 0x100300, 0x18018, 0x115018, 0x100128, 0x100320
.long 0x180e8, 0x1150e8, 0x148, 0x340, 0x181b8, 0x1151b8, 0x168, 0x360
.long 0x103000, 0x200000, 0x100148, 0x100340, 0x103000, 0x200000, 0x100168, 0x100360
.long 0x17ddc, 0x114ddc, 0x188, 0x380, 0x17eac, 0x114eac, 0x1a8, 0x3a0
.long 0x17f7c, 0x114f7c, 0x100188, 0x100380, 0x1804c, 0x11504c, 0x1001a8, 0x1003a0
.long 0x1811c, 0x11511c, 0x1c8, 0x3c0, 0x181ec, 0x1151ec, 0x1e8, 0x3e0
.long 0x103000, 0x200000, 0x1001c8, 0x1003c0, 0x103000, 0x200000, 0x1001e8, 0x1003e0
.long 0xa400, 0xd00, 0x0, 0x14d40, 0xa440, 0xd00, 0x0, 0x14d80
.long 0xa480, 0xd00, 0x1, 0x14dd0, 0xa4c0, 0xd00, 0x1, 0x14e10
.long 0xa500, 0xd00, 0x2, 0x14e60, 0xa540, 0xd00, 0x2, 0x14ea0
.long 0xa580, 0xd00, 0x3, 0x14ef0, 0xa5c0, 0xd00, 0x3, 0x14f30
.long 0xa600, 0xd00, 0x4, 0x14f40, 0xa640, 0xd00, 0x4, 0x14f80
.long 0xa680, 0xd00, 0x5, 0x14fd0, 0xa6c0, 0xd00, 0x5, 0x15010
.long 0xa700, 0xd00, 0x6, 0x15060, 0xa740, 0xd00, 0x6, 0x150a0
.long 0xa780, 0xd00, 0x7, 0x150f0, 0xa7c0, 0xd00, 0x7, 0x15130
.long 0xa800, 0xd00, 0x8, 0x15140, 0xa840, 0xd00, 0x8, 0x15180
.long 0xa880, 0xd00, 0x9, 0x151d0, 0xa8c0, 0xd00, 0x9, 0x15210
.long 0xa900, 0xd00, 0xa, 0x15260, 0xa940, 0xd00, 0xa, 0x152a0
.long 0xa980, 0xd00, 0xb, 0x152f0, 0xa9c0, 0xd00, 0xb, 0x15330
.long 0xaa00, 0xd00, 0xc, 0x15340, 0xaa40, 0xd00, 0xc, 0x15380
.long 0x1f680, 0x40, 0xd, 0x153d0, 0x100000, 0xd00, 0xd, 0x15410
.long 0x100000, 0xd00, 0xe, 0x15460, 0x100000, 0xd00, 0xe, 0x154a0
.long 0x100000, 0xd00, 0xf, 0x154f0, 0x100000, 0xd00, 0xf, 0x15530
.long 0xa400, 0xd00, 0x2, 0x14d60, 0xa440, 0xd00, 0x2, 0x14da0
.long 0xa480, 0xd00, 0x3, 0x14df0, 0xa4c0, 0xd00, 0x3, 0x14e30
.long 0xa500, 0xd00, 0x4, 0x14e40, 0xa540, 0xd00, 0x4, 0x14e80
.long 0xa580, 0xd00, 0x5, 0x14ed0, 0xa5c0, 0xd00, 0x5, 0x14f10
.long 0xa600, 0xd00, 0x6, 0x14f60, 0xa640, 0xd00, 0x6, 0x14fa0
.long 0xa680, 0xd00, 0x7, 0x14ff0, 0xa6c0, 0xd00, 0x7, 0x15030
.long 0xa700, 0xd00, 0x8, 0x15040, 0xa740, 0xd00, 0x8, 0x15080
.long 0xa780, 0xd00, 0x9, 0x150d0, 0xa7c0, 0xd00, 0x9, 0x15110
.long 0xa800, 0xd00, 0xa, 0x15160, 0xa840, 0xd00, 0xa, 0x151a0
.long 0xa880, 0xd00, 0xb, 0x151f0, 0xa8c0, 0xd00, 0xb, 0x15230
.long 0xa900, 0xd00, 0xc, 0x15240, 0xa940, 0xd00, 0xc, 0x15280
.long 0xa980, 0xd00, 0xd, 0x152d0, 0xa9c0, 0xd00, 0xd, 0x15310
.long 0xaa00, 0xd00, 0xe, 0x15360, 0xaa40, 0xd00, 0xe, 0x153a0
.long 0x1f680, 0x40, 0xf, 0x153f0, 0x100000, 0xd00, 0xf, 0x15430
.long 0x100000, 0xd00, 0x10, 0x15440, 0x100000, 0xd00, 0x10, 0x15480
.long 0x100000, 0xd00, 0x11, 0x154d0, 0x100000, 0xd00, 0x11, 0x15510
.long 0x1f690, 0x1f890, 0x1f9c0, 0x1f9e0, 0x1f698, 0x1f898, 0x1f9c8, 0x1f9e8
.long 0x1f680, 0x1f880, 0x1f9d0, 0x1f9f0, 0x1f688, 0x1f888, 0x1f9d8, 0x100000
.long 0x1fd20, 0x1ff20, 0x1f9c2, 0x1f9e2, 0x1fd28, 0x1ff28, 0x1f9ca, 0x1f9ea
.long 0x1fd30, 0x1ff30, 0x1f9d2, 0x1f9f2, 0x1fd38, 0x1ff38, 0x1f9da, 0x100000
.long 0x1f6f0, 0x1f8f0, 0x1f9c4, 0x1f9e4, 0x1f6f8, 0x1f8f8, 0x1f9cc, 0x1f9ec
.long 0x1f6e0, 0x1f8e0, 0x1f9d4, 0x100000, 0x1f6e8, 0x1f8e8, 0x1f9dc, 0x100000
.long 0x1fd40, 0x1ff40, 0x1f9c6, 0x1f9e6, 0x1fd48, 0x1ff48, 0x1f9ce, 0x1f9ee
.long 0x1fd50, 0x1ff50, 0x1f9d6, 0x100000, 0x1fd58, 0x1ff58, 0x1f9de, 0x100000
.long 0x1f710, 0x1f910, 0x1f9c0, 0x1f9e0, 0x1f718, 0x1f918, 0x1f9c8, 0x1f9e8
.long 0x1f700, 0x1f900, 0x1f9d0, 0x1f9f0, 0x1f708, 0x1f908, 0x1f9d8, 0x100000
.long 0x1fda0, 0x1ffa0, 0x1f9c2, 0x1f9e2, 0x1fda8, 0x1ffa8, 0x1f9ca, 0x1f9ea
.long 0x1fdb0, 0x1ffb0, 0x1f9d2, 0x1f9f2, 0x1fdb8, 0x1ffb8, 0x1f9da, 0x100000
.long 0x1f770, 0x1f970, 0x1f9c4, 0x1f9e4, 0x1f778, 0x1f978, 0x1f9cc, 0x1f9ec
.long 0x1f760, 0x1f960, 0x1f9d4, 0x100000, 0x1f768, 0x1f968, 0x1f9dc, 0x100000
.long 0x1fdc0, 0x1ffc0, 0x1f9c6, 0x1f9e6, 0x1fdc8, 0x1ffc8, 0x1f9ce, 0x1f9ee
.long 0x1fdd0, 0x1ffd0, 0x1f9d6, 0x100000, 0x1fdd8, 0x1ffd8, 0x1f9de, 0x100000
.long 0x1f790, 0x1f990, 0x1f9c0, 0x1f9e0, 0x1f798, 0x1f998, 0x1f9c8, 0x1f9e8
.long 0x1f780, 0x1f980, 0x1f9d0, 0x1f9f0, 0x1f788, 0x1f988, 0x1f9d8, 0x100000
.long 0x1fe20, 0x20020, 0x1f9c2, 0x1f9e2, 0x1fe28, 0x20028, 0x1f9ca, 0x1f9ea
.long 0x1fe30, 0x20030, 0x1f9d2, 0x1f9f2, 0x1fe38, 0x20038, 0x1f9da, 0x100000
.long 0x1f7f0, 0x14d00, 0x1f9c4, 0x1f9e4, 0x1f7f8, 0x14d08, 0x1f9cc, 0x1f9ec
.long 0x1f7e0, 0x14d10, 0x1f9d4, 0x100000, 0x1f7e8, 0x14d18, 0x1f9dc, 0x100000
.long 0x1fe40, 0x14d00, 0x1f9c6, 0x1f9e6, 0x1fe48, 0x14d08, 0x1f9ce, 0x1f9ee
.long 0x1fe50, 0x14d10, 0x1f9d6, 0x100000, 0x1fe58, 0x14d18, 0x1f9de, 0x100000
.long 0x1f810, 0x14d00, 0x1f9c0, 0x1f9e0, 0x1f818, 0x14d08, 0x1f9c8, 0x1f9e8
.long 0x1f800, 0x14d10, 0x1f9d0, 0x1f9f0, 0x1f808, 0x14d18, 0x1f9d8, 0x100000
.long 0x1fea0, 0x14d00, 0x1f9c2, 0x1f9e2, 0x1fea8, 0x14d08, 0x1f9ca, 0x1f9ea
.long 0x1feb0, 0x14d10, 0x1f9d2, 0x1f9f2, 0x1feb8, 0x14d18, 0x1f9da, 0x100000
.long 0x1f870, 0x14d00, 0x1f9c4, 0x1f9e4, 0x1f878, 0x14d08, 0x1f9cc, 0x1f9ec
.long 0x1f860, 0x14d10, 0x1f9d4, 0x100000, 0x1f868, 0x14d18, 0x1f9dc, 0x100000
.long 0x1fec0, 0x14d00, 0x1f9c6, 0x1f9e6, 0x1fec8, 0x14d08, 0x1f9ce, 0x1f9ee
.long 0x1fed0, 0x14d10, 0x1f9d6, 0x100000, 0x1fed8, 0x14d18, 0x1f9de, 0x100000
.long 0x0, 0x4444, 0x0, 0xa400, 0x10, 0xeeee, 0x4, 0xa404
.long 0x20, 0x4444, 0x8, 0xa408, 0x30, 0xeeee, 0xc, 0xa40c
.long 0x40, 0x4444, 0x10, 0xa410, 0x50, 0xeeee, 0x14, 0xa414
.long 0x60, 0x4444, 0x18, 0xa418, 0x70, 0xeeee, 0x1c, 0xa41c
.long 0x0, 0x4444, 0x20, 0xa420, 0x10, 0xeeee, 0x24, 0xa424
.long 0x20, 0x4444, 0x28, 0xa428, 0x30, 0xeeee, 0x2c, 0xa42c
.long 0x40, 0x4444, 0x30, 0xa430, 0x50, 0xeeee, 0x34, 0xa434
.long 0x60, 0x4444, 0x38, 0xa438, 0x70, 0xeeee, 0x3c, 0xa43c
.long 0x0, 0x4444, 0x40, 0xa440, 0x10, 0xeeee, 0x44, 0xa444
.long 0x20, 0x4444, 0x48, 0xa448, 0x30, 0xeeee, 0x4c, 0xa44c
.long 0x40, 0x4444, 0x50, 0xa450, 0x50, 0xeeee, 0x54, 0xa454
.long 0x60, 0x4444, 0x58, 0xa458, 0x70, 0xeeee, 0x5c, 0xa45c
.long 0x0, 0x4444, 0x60, 0xa460, 0x10, 0xeeee, 0x64, 0xa464
.long 0x20, 0x4444, 0x68, 0xa468, 0x30, 0xeeee, 0x6c, 0xa46c
.long 0x40, 0x4444, 0x70, 0xa470, 0x50, 0xeeee, 0x74, 0xa474
.long 0x60, 0x4444, 0x78, 0xa478, 0x70, 0xeeee, 0x7c, 0xa47c
.long 0x0, 0x4444, 0x420, 0xb080, 0x10, 0xeeee, 0x424, 0xb084
.long 0x20, 0x4444, 0x428, 0xb088, 0x30, 0xeeee, 0x42c, 0xb08c
.long 0x40, 0x4444, 0x430, 0xb090, 0x50, 0xeeee, 0x434, 0xb094
.long 0x60, 0x4444, 0x438, 0xb098, 0x70, 0xeeee, 0x43c, 0xb09c
.long 0x0, 0x4444, 0x440, 0xb0a0, 0x10, 0xeeee, 0x444, 0xb0a4
.long 0x20, 0x4444, 0x448, 0xb0a8, 0x30, 0xeeee, 0x44c, 0xb0ac
.long 0x40, 0x4444, 0x450, 0xb0b0, 0x50, 0xeeee, 0x454, 0xb0b4
.long 0x60, 0x4444, 0x458, 0xb0b8, 0x70, 0xeeee, 0x45c, 0xb0bc
.long 0x0, 0x4444, 0x460, 0xb0c0, 0x10, 0xeeee, 0x464, 0xb0c4
.long 0x20, 0x4444, 0x468, 0xb0c8, 0x30, 0xeeee, 0x46c, 0xb0cc
.long 0x40, 0x4444, 0x470, 0xb0d0, 0x50, 0xeeee, 0x474, 0xb0d4
.long 0x60, 0x4444, 0x478, 0xb0d8, 0x70, 0xeeee, 0x47c, 0xb0dc
.long 0x0, 0x4444, 0x480, 0xb0e0, 0x10, 0xeeee, 0x484, 0xb0e4
.long 0x20, 0x4444, 0x488, 0xb0e8, 0x30, 0xeeee, 0x48c, 0xb0ec
.long 0x40, 0x4444, 0x490, 0xb0f0, 0x50, 0xeeee, 0x494, 0xb0f4
.long 0x60, 0x4444, 0x498, 0xb0f8, 0x70, 0xeeee, 0x49c, 0xb0fc
.long 0x1fa28, 0x1f9f4, 0x34, 0x14d00, 0x1fa28, 0x1f9f6, 0x74, 0x14d04
.long 0x1fa28, 0x1f9f8, 0xb4, 0x14d08, 0x1fa28, 0x1f9fa, 0xf4, 0x14d0c
.long 0x1fa28, 0x1f9fc, 0x134, 0x14d10, 0x1fa28, 0x1f9fe, 0x174, 0x14d14
.long 0x1fa28, 0x1fa00, 0x1b4, 0x14d18, 0x1fa28, 0x1fa02, 0x1f4, 0x14d1c
.long 0x1fa28, 0x1fa04, 0x234, 0x14d20, 0x1fa28, 0x1fa06, 0x274, 0x14d24
.long 0x1fa28, 0x1fa08, 0x2b4, 0x14d28, 0x1fa28, 0x1fa0a, 0x2f4, 0x14d2c
.long 0x1fa28, 0x1fa0c, 0x334, 0x14d30, 0x1fa28, 0x1fa0e, 0x374, 0x14d34
.long 0x1fa28, 0x1fa10, 0x3b4, 0x14d38, 0x1fa28, 0x1fa12, 0x3f4, 0x14d3c
.long 0x1fa28, 0x1fa14, 0x434, 0x14d00, 0x1fa28, 0x1fa16, 0x474, 0x14d04
.long 0x1fa28, 0x1fa18, 0x4b4, 0x14d08, 0x1fa28, 0x1fa1a, 0x4f4, 0x14d0c
.long 0x1fa28, 0x1fa1c, 0x534, 0x14d10, 0x1fa28, 0x1fa1e, 0x574, 0x14d14
.long 0x1fa28, 0x1fa20, 0x5b4, 0x14d18, 0x1fa28, 0x1fa22, 0x5f4, 0x14d1c
.long 0x1fa28, 0x1fa24, 0x634, 0x14d20, 0x1fa28, 0x1fa26, 0x674, 0x14d24
.long 0x1fa28, 0x1fa28, 0x6b4, 0x14d28, 0x1fa28, 0x1fa2a, 0x6f4, 0x14d2c
.long 0x1fa28, 0x1fa2c, 0x734, 0x14d30, 0x1fa28, 0x1fa2e, 0x774, 0x14d34
.long 0x1fa28, 0x1fa30, 0x7b4, 0x14d38, 0x1fa28, 0x1fa32, 0x7f4, 0x14d3c
.long 0x1fa38, 0x1fa34, 0x834, 0x14d00, 0x1fa38, 0x1fa36, 0x874, 0x14d04
.long 0x1fa38, 0x1fa38, 0x8b4, 0x14d08, 0x1fa38, 0x1fa3a, 0x8f4, 0x14d0c
.long 0x1fa38, 0x1fa3c, 0x934, 0x14d10, 0x1fa38, 0x1fa3e, 0x974, 0x14d14
.long 0x1fa38, 0x1fa40, 0x9b4, 0x14d18, 0x1fa38, 0x1fa42, 0x9f4, 0x14d1c
.long 0x1fa38, 0x1fa44, 0xa34, 0x14d20, 0x1fa38, 0x1fa46, 0xa74, 0x14d24
.long 0x1fa38, 0x1fa48, 0xab4, 0x14d28, 0x1fa38, 0x1fa4a, 0xaf4, 0x14d2c
.long 0x1fa38, 0x1fa4c, 0xb34, 0x14d30, 0x1fa38, 0x1fa4e, 0xb74, 0x14d34
.long 0x1fa38, 0x1fa50, 0xbb4, 0x14d38, 0x1fa38, 0x1fa52, 0xbf4, 0x14d3c
.long 0x1fa38, 0x1fa54, 0xc34, 0x14d00, 0x1fa38, 0x1fa56, 0xc74, 0x14d04
.long 0x1fa38, 0x1fa58, 0xcb4, 0x14d08, 0x1fa38, 0x1fa5a, 0xcf4, 0x14d0c
.long 0x1fa38, 0x1fa5c, 0xd34, 0x14d10, 0x1fa38, 0x1fa5e, 0xd74, 0x14d14
.long 0x1fa38, 0x1fa60, 0xdb4, 0x14d18, 0x1fa38, 0x1fa62, 0xdf4, 0x14d1c
.long 0x1fa38, 0x1fa64, 0xe34, 0x14d20, 0x1fa38, 0x1fa66, 0xe74, 0x14d24
.long 0x1fa38, 0x1fa68, 0xeb4, 0x14d28, 0x1fa38, 0x1fa6a, 0xef4, 0x14d2c
.long 0x1fa38, 0x1fa6c, 0xf34, 0x14d30, 0x1fa38, 0x1fa6e, 0xf74, 0x14d34
.long 0x1fa38, 0x1fa70, 0xfb4, 0x14d38, 0x1fa38, 0x1fa72, 0xff4, 0x14d3c
.long 0x0, 0x0, 0x0, 0x0, 0x0, 0x0, 0x0, 0x0
.long 0x0, 0x0, 0x0, 0x0, 0x0, 0x0, 0x0, 0x0
.long 0x0, 0x0, 0x0, 0x0, 0x0, 0x0, 0x0, 0x0
.long 0x0, 0x0, 0x0, 0x0, 0x0, 0x0, 0x0, 0x0
.long 0x0, 0x0, 0x0, 0x0, 0x0, 0x0, 0x0, 0x0
.long 0x0, 0x0, 0x0, 0x0, 0x0, 0x0, 0x0, 0x0
.long 0x0, 0x0, 0x0, 0x0, 0x0, 0x0, 0x0, 0x0
.long 0x0, 0x0, 0x0, 0x0, 0x0, 0x0, 0x0, 0x0
.long 0x0, 0x0, 0x0, 0x0, 0x0, 0x0, 0x0, 0x0
.long 0x0, 0x0, 0x0, 0x0, 0x0, 0x0, 0x0, 0x0
.long 0x0, 0x0, 0x0, 0x0, 0x0, 0x0, 0x0, 0x0
.long 0x0, 0x0, 0x0, 0x0, 0x0, 0x0, 0x0, 0x0
.long 0x0, 0x0, 0x0, 0x0, 0x0, 0x0, 0x0, 0x0
.long 0x0, 0x0, 0x0, 0x0, 0x0, 0x0, 0x0, 0x0
.long 0x0, 0x0, 0x0, 0x0, 0x0, 0x0, 0x0, 0x0
.long 0x0, 0x0, 0x0, 0x0, 0x0, 0x0, 0x0, 0x0
.long 0x0, 0x0, 0x0, 0x0, 0x0, 0x0, 0x0, 0x0
.long 0x0, 0x0, 0x0, 0x0, 0x0, 0x0, 0x0, 0x0
.long 0x0, 0x0, 0x0, 0x0, 0x0, 0x0, 0x0, 0x0
.long 0x0, 0x0, 0x0, 0x0, 0x0, 0x0, 0x0, 0x0
.long 0x0, 0x0, 0x0, 0x0, 0x0, 0x0, 0x0, 0x0
.long 0x0, 0x0, 0x0, 0x0, 0x0, 0x0, 0x0, 0x0
.long 0x0, 0x0, 0x0, 0x0, 0x0, 0x0, 0x0, 0x0
.long 0x0, 0x0, 0x0, 0x0, 0x0, 0x0, 0x0, 0x0
.long 0x0, 0x0, 0x0, 0x0, 0x0, 0x0, 0x0, 0x0
.long 0x0, 0x0, 0x0, 0x0, 0x0, 0x0, 0x0, 0x0
.long 0x0, 0x0, 0x0, 0x0, 0x0, 0x0, 0x0, 0x0
.long 0x0, 0x0, 0x0, 0x0, 0x0, 0x0, 0x0, 0x0
.long 0x0, 0x0, 0x0, 0x0, 0x0, 0x0, 0x0, 0x0
.long 0x0, 0x0, 0x0, 0x0, 0x0, 0x0, 0x0, 0x0
.long 0x0, 0x0, 0x0, 0x0, 0x0, 0x0, 0x0, 0x0
.long 0x0, 0x0, 0x0, 0x0, 0x0, 0x0, 0x0, 0x0
.long 0x13320, 0xa9b0, 0xa800, 0x10c00, 0xf320, 0xc120, 0x133b0, 0xb690
.long 0xa890, 0x11920, 0xf3b0, 0xce00, 0x12600, 0xa920, 0xb520, 0x10c90
.long 0xe600, 0xc090, 0x12690, 0xb600, 0xb5b0, 0x119b0, 0xe690, 0xcdb0
.long 0xd5f0, 0x11440, 0x117f0, 0x130d0, 0xf8d0, 0xadf0, 0xd640, 0x12160
.long 0x11840, 0x13df0, 0xf960, 0xbad0, 0xc8d0, 0x113f0, 0x124d0, 0x13160
.long 0xebf0, 0xad60, 0xc960, 0x120d0, 0x12560, 0x13e40, 0xec40, 0xba40
.long 0xefb0, 0x10ed0, 0x117b0, 0x12a40, 0xfa90, 0xdb60, 0xc890, 0x10d60
.long 0x10a90, 0x129f0, 0x13bb0, 0xddf0, 0xf000, 0x11bf0, 0x11520, 0xe960
.long 0xc160, 0xf9b0, 0xc920, 0x11a40, 0x10800, 0xe8d0, 0xc3f0, 0x13a90
.long 0xce40, 0xfa00, 0xfff0, 0xbb20, 0xedb0, 0xdad0, 0xced0, 0x10720
.long 0x10040, 0xc800, 0x14890, 0xde40, 0xf560, 0xfbb0, 0x140d0, 0xbdb0
.long 0xb3f0, 0xec00, 0xf5f0, 0x10890, 0x14160, 0xca90, 0xb760, 0x14720
.long 0x13520, 0xddb0, 0xa520, 0xbe00, 0xf490, 0xe800, 0x13690, 0x10490
.long 0xa5b0, 0xcb20, 0xe7b0, 0x14d00, 0x12800, 0xdd20, 0xb200, 0xbe90
.long 0xf800, 0x14320, 0x129b0, 0x10400, 0xb290, 0xcbb0, 0xeb20, 0x14290
.long 0xd560, 0x10760, 0x112d0, 0xaed0, 0xfb60, 0xeed0, 0xd3f0, 0xe040
.long 0x11360, 0xbbf0, 0xee40, 0x14d00, 0xc840, 0x106d0, 0x11ff0, 0xaf60
.long 0xfed0, 0x149f0, 0xc6d0, 0xdff0, 0x12040, 0xbc40, 0xf1f0, 0x14960
.long 0xbbb0, 0x10cd0, 0xfdb0, 0x12960, 0xd3b0, 0xd9f0, 0x13090, 0x11160
.long 0x13e90, 0x12bf0, 0xbff0, 0xd290, 0xbc00, 0x119f0, 0xfb20, 0xe840
.long 0xac90, 0xd840, 0x13120, 0x11e40, 0x13c00, 0xead0, 0xbe40, 0xabb0
.long 0xcf60, 0x11400, 0x101f0, 0xef20, 0x12e90, 0xdd60, 0xccd0, 0xd320
.long 0x10560, 0x14a00, 0xb640, 0x12d20, 0xf640, 0x115b0, 0x142d0, 0xf1b0
.long 0x121b0, 0xdcd0, 0xf3f0, 0xd490, 0x14640, 0x14c90, 0xb5f0, 0x12000
.long 0x13600, 0xf7b0, 0xa490, 0xb120, 0x10d20, 0xc200, 0x135b0, 0xea90
.long 0xa400, 0x14d00, 0x10db0, 0xcf20, 0x12920, 0xf720, 0xaa00, 0x14000
.long 0x11a00, 0xc290, 0x12890, 0xea00, 0xb720, 0x14090, 0x11a90, 0xcfb0
.long 0xd4d0, 0xfa40, 0x11760, 0x123f0, 0x12cd0, 0xaff0, 0xd440, 0xed60
.long 0x116d0, 0x14d00, 0x12d60, 0xbcd0, 0xc7f0, 0xf9f0, 0x118d0, 0x14ad0
.long 0x139f0, 0xb040, 0xc760, 0xecd0, 0x125f0, 0x14b60, 0x13a40, 0xbd60
.long 0xe290, 0x10e40, 0xc9b0, 0x12760, 0xfe00, 0x13640, 0x10df0, 0xd5b0
.long 0xf090, 0x128d0, 0x13f20, 0x138d0, 0xe320, 0x11b60, 0x12640, 0xafb0
.long 0xfe90, 0x14360, 0x11ad0, 0xd600, 0xe560, 0xad20, 0x13fb0, 0x145f0
.long 0xe000, 0xcd60, 0x10920, 0x102d0, 0xa6d0, 0xebb0, 0xd040, 0x12e00
.long 0xfc00, 0x10240, 0xaa40, 0x14690, 0xe1b0, 0xf440, 0x103f0, 0x12320
.long 0xe7f0, 0xee00, 0xf760, 0x12fb0, 0x144d0, 0x125b0, 0xeb60, 0x14920
.long 0x13720, 0x111b0, 0xdb20, 0xf400, 0x11090, 0x11d20, 0x137b0, 0x11e90
.long 0xda90, 0xe720, 0x11db0, 0x14d00, 0x12a00, 0x11120, 0x10200, 0xf5b0
.long 0x11200, 0x14400, 0x12a90, 0x11e00, 0x101b0, 0xe890, 0x11f20, 0x14490
.long 0xd6d0, 0x12e40, 0x108d0, 0xfc40, 0x13240, 0x13ed0, 0xd760, 0x13b60
.long 0x10840, 0xef60, 0x13f60, 0x14d00, 0xc9f0, 0x12df0, 0xe1f0, 0xfad0
.long 0x132d0, 0x14bf0, 0xca40, 0x13ad0, 0xe160, 0xedf0, 0x13ff0, 0x14c40
.long 0x11690, 0x11040, 0xde90, 0xa640, 0x10b20, 0x136d0, 0x109b0, 0x10ff0
.long 0xa5f0, 0xd1b0, 0x10bb0, 0x143f0, 0x11720, 0x11d60, 0xdf20, 0xb360
.long 0xb000, 0x13360, 0x10a00, 0x11cd0, 0xb2d0, 0xd200, 0xb090, 0x14040
.long 0xcbf0, 0xb920, 0xe400, 0x13560, 0xa560, 0xc490, 0xcc40, 0xc600
.long 0x13840, 0x13200, 0xe640, 0xc720, 0xf2d0, 0xba90, 0xdfb0, 0xc040
.long 0xa8d0, 0x11fb0, 0xf360, 0xc7b0, 0xc360, 0x12db0, 0xe9f0, 0x12200
.long 0x13400, 0xc3b0, 0xdc00, 0x10e00, 0xbfb0, 0xcc00, 0x13490, 0xd090
.long 0xdc90, 0x11b20, 0xcc90, 0x14d00, 0x12720, 0xc320, 0x10320, 0x10fb0
.long 0xc400, 0x14120, 0x127b0, 0xd000, 0x103b0, 0x11c90, 0xd120, 0x141b0
.long 0xd1f0, 0xac40, 0x10ad0, 0x13040, 0xab60, 0xb7f0, 0xd240, 0xb960
.long 0x10b60, 0x13d60, 0xb840, 0x14d00, 0xc4d0, 0xabf0, 0xe3f0, 0x12ed0
.long 0xb0d0, 0x146d0, 0xc560, 0xb8d0, 0xe440, 0x13bf0, 0xbdf0, 0x14760
.long 0xfc90, 0x10f60, 0x11290, 0xa840, 0x13d20, 0x104d0, 0x13db0, 0x111f0
.long 0x105b0, 0xa7f0, 0x13c90, 0xf7f0, 0xfd20, 0x11c40, 0x11320, 0xb560
.long 0xae00, 0xff60, 0x13e00, 0x11ed0, 0x10600, 0xb4d0, 0xadb0, 0xf240
.long 0xcdf0, 0xed20, 0x133f0, 0xbd20, 0x12c40, 0x14bb0, 0xd160, 0x14800
.long 0x13440, 0xca00, 0x11f60, 0x14b20, 0xf4d0, 0xee90, 0xbed0, 0xb890
.long 0x12ad0, 0x12490, 0xf840, 0x149b0, 0xbf60, 0xc5b0, 0x11df0, 0x12400
.long 0x12bb0, 0x13800, 0xd920, 0xc000, 0x14600, 0x14d00, 0x13890, 0x14d00
.long 0xd9b0, 0xcd20, 0xc5f0, 0x14d00, 0x13920, 0x145b0, 0x10000, 0xc1b0
.long 0xb1b0, 0x14d00, 0x12c00, 0x14520, 0x10090, 0xce90, 0xfbf0, 0x14d00
.long 0xc640, 0xd2d0, 0x105f0, 0xae40, 0x14cd0, 0x14d00, 0xd360, 0x14d00
.long 0x10640, 0xbb60, 0xbf20, 0x14d00, 0xd7f0, 0x14840, 0xded0, 0xacd0
.long 0x10290, 0x14d00, 0xcad0, 0x147f0, 0xdf60, 0xb9f0, 0x11000, 0x14d00
.long 0x14a90, 0x11240, 0xf890, 0xa760, 0x14d00, 0xaad0, 0x123b0, 0x110d0
.long 0x139b0, 0xa9f0, 0x14d00, 0x12b20, 0x10c40, 0xae90, 0xf920, 0xb440
.long 0xe0d0, 0x14d00, 0x11960, 0xaf20, 0x13a00, 0xb6d0, 0x131f0, 0x14d00
.long 0x13b20, 0xd0d0, 0x135f0, 0xf120, 0x14d00, 0x12440, 0xac00, 0xcb60
.long 0x13960, 0x14c00, 0xf520, 0x14d00, 0xcff0, 0x12120, 0xc0d0, 0xec90
.long 0xda40, 0xe090, 0xf6d0, 0x12290, 0xc440, 0x147b0, 0x14d00, 0x14d00
.long 0xa600, 0xd800, 0xdbb0, 0x10120, 0x0, 0x0, 0xa7b0, 0xff20
.long 0xda00, 0x14d00, 0x0, 0x0, 0xb320, 0xd890, 0xde00, 0x14200
.long 0x0, 0x0, 0xb490, 0xffb0, 0x10520, 0x143b0, 0x0, 0x0
.long 0x11640, 0x109f0, 0x107f0, 0xe240, 0x0, 0x0, 0x114d0, 0xe2d0
.long 0x10960, 0x14d00, 0x0, 0x0, 0x12360, 0x10a40, 0x10bf0, 0x14a40
.long 0x0, 0x0, 0x121f0, 0xe360, 0xe4d0, 0x148d0, 0x0, 0x0
.long 0xbc90, 0x126d0, 0x12c90, 0xa960, 0x0, 0x0, 0x131b0, 0x12b60
.long 0xb7b0, 0xa4d0, 0x0, 0x0, 0xba00, 0xe5f0, 0xa440, 0xaa90
.long 0x0, 0x0, 0x12f20, 0xea40, 0xb160, 0xab20, 0x0, 0x0
.long 0x10360, 0x11600, 0xd720, 0x134d0, 0x0, 0x0, 0x100d0, 0xd520
.long 0x11800, 0x13760, 0x0, 0x0, 0x14440, 0x11890, 0x137f0, 0x12520
.long 0x0, 0x0, 0x141f0, 0xd7b0, 0xc2d0, 0x12090, 0x0, 0x0
.long 0xa720, 0xf200, 0xf600, 0x10f20, 0x0, 0x0, 0xa690, 0xe520
.long 0xf690, 0x11c00, 0x0, 0x0, 0xb400, 0xf290, 0xe920, 0x10e90
.long 0x0, 0x0, 0xb3b0, 0xe5b0, 0xe9b0, 0x11bb0, 0x0, 0x0
.long 0x115f0, 0xfcd0, 0xfdf0, 0x12ff0, 0x0, 0x0, 0x11560, 0xeff0
.long 0xfe40, 0x13cd0, 0x0, 0x0, 0x122d0, 0xfd60, 0xf0d0, 0x12f60
.long 0x0, 0x0, 0x12240, 0xf040, 0xf160, 0x13c40, 0x0, 0x0
.long 0xe3b0, 0x12840, 0x11490, 0xdc40, 0x0, 0x0, 0x127f0, 0xd690
.long 0x107b0, 0xdbf0, 0x0, 0x0, 0xe120, 0xe760, 0xc240, 0x113b0
.long 0x0, 0x0, 0xe6d0, 0xd400, 0xc1f0, 0x10690, 0x0, 0x0
.long 0xe200, 0x10160, 0xb9b0, 0xd8d0, 0x0, 0x0, 0x10440, 0x13000
.long 0xc690, 0xd960, 0x0, 0x0, 0xe490, 0x14240, 0xb1f0, 0xb800
.long 0x0, 0x0, 0x14560, 0x13290, 0xb240, 0xc520, 0x0, 0x0
.long 0x0, 0x0, 0x0, 0x0, 0x0, 0x0, 0x0, 0x0
.long 0x0, 0x0, 0x0, 0x0, 0x0, 0x0, 0x0, 0x0
.long 0x0, 0x0, 0x0, 0x0, 0x0, 0x0, 0x0, 0x0
.long 0x0, 0x0, 0x0, 0x0, 0x0, 0x0, 0x0, 0x0
.long 0x0, 0x0, 0x0, 0x0, 0x0, 0x0, 0x0, 0x0
.long 0x0, 0x0, 0x0, 0x0, 0x0, 0x0, 0x0, 0x0
.long 0x0, 0x0, 0x0, 0x0, 0x0, 0x0, 0x0, 0x0
.long 0x0, 0x0, 0x0, 0x0, 0x0, 0x0, 0x0, 0x0
.long 0x0, 0x0, 0x0, 0x0, 0x0, 0x0, 0x0, 0x0
.long 0x0, 0x0, 0x0, 0x0, 0x0, 0x0, 0x0, 0x0
.long 0x0, 0x0, 0x0, 0x0, 0x0, 0x0, 0x0, 0x0
.long 0x0, 0x0, 0x0, 0x0, 0x0, 0x0, 0x0, 0x0
.long 0x0, 0x0, 0x0, 0x0, 0x0, 0x0, 0x0, 0x0
.long 0x0, 0x0, 0x0, 0x0, 0x0, 0x0, 0x0, 0x0
.long 0x0, 0x0, 0x0, 0x0, 0x0, 0x0, 0x0, 0x0
.long 0x0, 0x0, 0x0, 0x0, 0x0, 0x0, 0x0, 0x0
.long 0x0, 0x0, 0x0, 0x0, 0x0, 0x0, 0x0, 0x0
.long 0x0, 0x0, 0x0, 0x0, 0x0, 0x0, 0x0, 0x0
.long 0x0, 0x0, 0x0, 0x0, 0x0, 0x0, 0x0, 0x0
.long 0x0, 0x0, 0x0, 0x0, 0x0, 0x0, 0x0, 0x0
.long 0x0, 0x0, 0x0, 0x0, 0x0, 0x0, 0x0, 0x0
.long 0x0, 0x0, 0x0, 0x0, 0x0, 0x0, 0x0, 0x0
.long 0x0, 0x0, 0x0, 0x0, 0x0, 0x0, 0x0, 0x0
.long 0x0, 0x0, 0x0, 0x0, 0x0, 0x0, 0x0, 0x0
.long 0x0, 0x0, 0x0, 0x0, 0x0, 0x0, 0x0, 0x0
.long 0x0, 0x0, 0x0, 0x0, 0x0, 0x0, 0x0, 0x0
.long 0x0, 0x0, 0x0, 0x0, 0x0, 0x0, 0x0, 0x0
.long 0x0, 0x0, 0x0, 0x0, 0x0, 0x0, 0x0, 0x0
.long 0x0, 0x0, 0x0, 0x0, 0x0, 0x0, 0x0, 0x0
.long 0x0, 0x0, 0x0, 0x0, 0x0, 0x0, 0x0, 0x0
.long 0x0, 0x0, 0x0, 0x0, 0x0, 0x0, 0x0, 0x0
.long 0x0, 0x0, 0x0, 0x0, 0x0, 0x0, 0x0, 0x0
.section .rodata,"a"
.p2align 6
.amdhsa_kernel standalone__deep_cross_xdeepfm__recsys_kernel
  .amdhsa_next_free_vgpr 256
  .amdhsa_next_free_sgpr 102
  .amdhsa_accum_offset 256
  .amdhsa_group_segment_fixed_size 0
  .amdhsa_kernarg_size 88
  .amdhsa_user_sgpr_count 2
  .amdhsa_user_sgpr_kernarg_segment_ptr 1
  .amdhsa_system_sgpr_workgroup_id_x 1
  .amdhsa_float_denorm_mode_32 3
.end_amdhsa_kernel
```

```asm
; @launch grid=(256,1,1) block=(512,1,1) lds=163840
.amdgcn_target "amdgcn-amd-amdhsa--gfx950"
.text
.globl standalone__deep_cross_xdeepfm__recsys_kernel
.p2align 8
.type standalone__deep_cross_xdeepfm__recsys_kernel,@function
standalone__deep_cross_xdeepfm__recsys_kernel:
  s_cmp_ge_u32 s2, 256
  s_cbranch_scc1 L_end
  s_load_dwordx16 s[4:19], s[0:1], 0
  s_load_dwordx4 s[20:23], s[0:1], 64
  s_load_dwordx2 s[24:25], s[0:1], 80
  v_lshrrev_b32 v1, 6, v0
  s_getpc_b64 s[92:93]
L_pc:
  s_and_b32 s68, s2, 0xf8
  v_add_u32 v2, s68, v1
  v_and_b32_e64 v3, 32, v0
  v_lshl_add_u32 v2, v3, 3, v2
  v_lshlrev_b32 v2, 7, v2
  v_min_u32 v2, L_end-L_pc, v2
  v_mov_b32 v3, s93
  v_add_co_u32 v2, vcc, s92, v2
  s_nop 1
  v_addc_co_u32 v3, vcc, 0, v3, vcc
  global_load_dword v251, v[2:3], off
  v_and_b32 v0, 63, v0
  v_readfirstlane_b32 s3, v1
  s_and_b32 s68, s2, 7
  s_lshr_b32 s69, s2, 3
  s_xor_b32 s69, s69, 31
  s_and_b32 s80, s2, 0xf8
  s_add_u32 s80, s80, s3
  s_lshl_b32 s80, s80, 0
  s_min_u32 s70, s68, 1
  s_add_u32 s71, s69, s70
  s_cmp_ge_u32 s71, 22
  s_cbranch_scc1 L_cin
  s_mul_i32 s68, s68, 21
  s_add_u32 s68, s68, s71
  s_mul_i32 s26, s68, 5042
  s_lshr_b32 s26, s26, 16
  s_mul_i32 s69, s26, 13
  s_sub_u32 s27, s68, s69
  s_lshl_b32 s77, s27, 8
  s_mul_i32 s71, s26, 320
  v_lshrrev_b32 v116, 4, v0
  v_lshlrev_b32 v11, 4, v0
  s_and_b32 s79, s3, 3
  s_cmp_lt_u32 s3, 4
  s_cbranch_scc1 L_cmp
  s_lshr_b32 s68, s79, 1
  s_mul_i32 s68, s68, 20
  s_and_b32 s69, s79, 1
  s_add_u32 s68, s68, s69
  s_lshl_b32 s76, s68, 10
  s_mul_i32 s78, s71, 104
  s_mul_i32 s68, s68, 832
  s_add_u32 s94, s78, s68
  v_mul_u32_u24 v118, 48, v116
  v_sub_u32 v12, v11, v118
  s_add_u32 s95, s94, 3328
  s_add_u32 s96, s94, 6656
  s_add_u32 s97, s94, 9984
  s_add_u32 s98, s94, 13312
  s_and_b32 s70, s79, 1
  s_lshl_b32 s70, s70, 3
  v_lshlrev_b32 v117, 1, v116
  v_or_b32 v117, s70, v117
  v_xor_b32 v117, v117, v0
  v_and_b32_e64 v117, 15, v117
  v_mul_u32_u24 v4, 3328, v116
  v_lshl_add_u32 v4, v117, 4, v4
  v_add_u32 v5, 13312, v4
  s_mul_i32 s74, s79, 26624
  s_add_u32 s74, s74, s77
  s_lshl_b32 s75, s79, 11
  s_waitcnt lgkmcnt(0)
  s_mov_b32 s28, s4
  s_and_b32 s29, s5, 0xffff
  s_mov_b32 s30, 425984
  s_mov_b32 s31, 0x20000
  buffer_load_dwordx4 v[16:19], v12, s[28:31], s94 offen offset:0
  s_mov_b32 s32, s6
  s_and_b32 s33, s7, 0xffff
  s_mov_b32 s34, 12800000
  s_mov_b32 s35, 0x20000
  s_mov_b32 s44, s12
  s_and_b32 s45, s13, 0xffff
  s_mov_b32 s46, 5537792
  s_mov_b32 s47, 0x20000
  s_add_u32 m0, s75, 131072
  s_nop 0
  buffer_load_dwordx4 v4, s[44:47], s74 offen lds
  s_add_u32 m0, s75, 132096
  s_nop 0
  buffer_load_dwordx4 v5, s[44:47], s74 offen lds
  s_add_u32 s74, s74, 106496
  s_add_u32 m0, s75, 139264
  s_nop 0
  buffer_load_dwordx4 v4, s[44:47], s74 offen lds
  s_add_u32 m0, s75, 140288
  s_nop 0
  buffer_load_dwordx4 v5, s[44:47], s74 offen lds
  s_add_u32 s74, s74, 106496
  buffer_load_dwordx4 v[20:23], v12, s[28:31], s94 offen offset:1664
  buffer_load_dwordx4 v[24:27], v12, s[28:31], s95 offen offset:0
  buffer_load_dwordx4 v[28:31], v12, s[28:31], s95 offen offset:1664
  buffer_load_dwordx4 v[32:35], v12, s[28:31], s96 offen offset:0
  buffer_load_dwordx4 v[36:39], v12, s[28:31], s96 offen offset:1664
  buffer_load_dwordx4 v[40:43], v12, s[28:31], s97 offen offset:0
  buffer_load_dwordx4 v[44:47], v12, s[28:31], s97 offen offset:1664
  buffer_load_dwordx4 v[48:51], v12, s[28:31], s98 offen offset:0
  buffer_load_dwordx4 v[52:55], v12, s[28:31], s98 offen offset:1664
  s_lshl_b32 s70, s69, 6
  v_and_b32 v118, 7, v0
  v_xor_b32 v118, v118, v116
  v_lshlrev_b32 v118, 4, v118
  v_xor_b32 v2, s70, v118
  v_xor_b32 v3, 64, v2
  s_mov_b32 s72, 0
  s_mul_i32 s70, s79, 13
  s_add_u32 s70, s70, s27
  s_min_u32 s70, s70, 39
  s_lshl_b32 s70, s70, 3
  s_add_u32 s70, s70, s71
  s_mul_i32 s84, s70, 104
  v_lshrrev_b32 v118, 2, v0
  v_min_u32 v118, 7, v118
  v_mul_u32_u24 v118, 104, v118
  v_and_b32 v117, 3, v0
  v_lshl_add_u32 v7, v117, 2, v118
  s_lshl_b32 s70, s26, 2
  s_add_u32 s70, s70, s79
  s_add_u32 s70, s70, 384
  s_mul_i32 s85, s70, 3328
  s_add_u32 s85, s85, s77
  s_mov_b32 s70, 173056
  v_lshrrev_b32 v118, 1, v0
  v_mul_lo_u32 v118, s70, v118
  v_and_b32 v117, 1, v0
  v_lshl_add_u32 v76, v117, 7, v118
  s_mov_b32 s52, s16
  s_and_b32 s53, s17, 0xffff
  s_mov_b32 s54, 3328
  s_mov_b32 s55, 0x20000
  s_mul_i32 s70, s79, 2560
  s_add_u32 s70, s70, L_tail-L_pc
  v_lshlrev_b32 v8, 7, v0
  v_add_u32 v8, s70, v8
  v_mov_b32 v9, s93
  v_add_co_u32 v8, vcc, s92, v8
  s_nop 1
  v_addc_co_u32 v9, vcc, 0, v9, vcc
  s_waitcnt vmcnt(13)
  v_lshlrev_b32 v16, 7, v16
  v_lshlrev_b32 v18, 7, v18
  v_lshlrev_b32 v17, 7, v17
  v_lshlrev_b32_e64 v19, 7, v19
  v_add_u32_dpp v56, v16, v2 row_newbcast:0 row_mask:0xf bank_mask:0x3
  s_nop 1
  v_add_u32_dpp v56, v18, v2 row_newbcast:6 row_mask:0xf bank_mask:0xc
  s_add_u32 m0, s76, 0
  s_nop 0
  buffer_load_dwordx4 v56, s[32:35], 0 offen lds
  s_waitcnt vmcnt(10)
  s_barrier
  s_waitcnt vmcnt(9)
  v_lshlrev_b32 v20, 7, v20
  v_lshlrev_b32 v22, 7, v22
  v_lshlrev_b32 v21, 7, v21
  v_lshlrev_b32 v23, 7, v23
  v_add_u32_dpp v57, v20, v2 row_newbcast:0 row_mask:0xf bank_mask:0x3
  s_nop 1
  v_add_u32_dpp v57, v22, v2 row_newbcast:6 row_mask:0xf bank_mask:0xc
  s_add_u32 m0, s76, 2048
  s_nop 0
  buffer_load_dwordx4 v57, s[32:35], 0 offen lds
  s_waitcnt vmcnt(9)
  v_lshlrev_b32 v24, 7, v24
  v_lshlrev_b32 v26, 7, v26
  v_lshlrev_b32 v25, 7, v25
  v_lshlrev_b32 v27, 7, v27
  v_add_u32_dpp v58, v24, v2 row_newbcast:0 row_mask:0xf bank_mask:0x3
  s_nop 1
  v_add_u32_dpp v58, v26, v2 row_newbcast:6 row_mask:0xf bank_mask:0xc
  s_add_u32 m0, s76, 4096
  s_nop 0
  buffer_load_dwordx4 v58, s[32:35], 0 offen lds
  s_waitcnt vmcnt(9)
  v_lshlrev_b32 v28, 7, v28
  v_lshlrev_b32 v30, 7, v30
  v_lshlrev_b32 v29, 7, v29
  v_lshlrev_b32_e64 v31, 7, v31
  v_add_u32_dpp v59, v28, v2 row_newbcast:0 row_mask:0xf bank_mask:0x3
  s_nop 1
  v_add_u32_dpp v59, v30, v2 row_newbcast:6 row_mask:0xf bank_mask:0xc
  s_add_u32 m0, s76, 6144
  s_nop 0
  buffer_load_dwordx4 v59, s[32:35], 0 offen lds
  s_waitcnt vmcnt(9)
  v_lshlrev_b32 v32, 7, v32
  v_lshlrev_b32 v34, 7, v34
  v_lshlrev_b32 v33, 7, v33
  v_lshlrev_b32_e64 v35, 7, v35
  v_add_u32_dpp v60, v32, v2 row_newbcast:0 row_mask:0xf bank_mask:0x3
  s_nop 1
  v_add_u32_dpp v60, v34, v2 row_newbcast:6 row_mask:0xf bank_mask:0xc
  s_add_u32 m0, s76, 8192
  s_nop 0
  buffer_load_dwordx4 v60, s[32:35], 0 offen lds
  s_waitcnt vmcnt(9)
  v_lshlrev_b32 v36, 7, v36
  v_lshlrev_b32 v38, 7, v38
  v_lshlrev_b32 v37, 7, v37
  v_lshlrev_b32_e64 v39, 7, v39
  v_add_u32_dpp v61, v36, v2 row_newbcast:0 row_mask:0xf bank_mask:0x3
  s_nop 1
  v_add_u32_dpp v61, v38, v2 row_newbcast:6 row_mask:0xf bank_mask:0xc
  s_add_u32 m0, s76, 10240
  s_nop 0
  buffer_load_dwordx4 v61, s[32:35], 0 offen lds
  s_waitcnt vmcnt(9)
  v_lshlrev_b32 v40, 7, v40
  v_lshlrev_b32 v42, 7, v42
  v_lshlrev_b32 v41, 7, v41
  v_lshlrev_b32_e64 v43, 7, v43
  v_add_u32_dpp v62, v40, v2 row_newbcast:0 row_mask:0xf bank_mask:0x3
  s_nop 1
  v_add_u32_dpp v62, v42, v2 row_newbcast:6 row_mask:0xf bank_mask:0xc
  s_add_u32 m0, s76, 12288
  s_nop 0
  buffer_load_dwordx4 v62, s[32:35], 0 offen lds
  s_waitcnt vmcnt(9)
  v_lshlrev_b32 v44, 7, v44
  v_lshlrev_b32 v46, 7, v46
  v_lshlrev_b32 v45, 7, v45
  v_lshlrev_b32_e64 v47, 7, v47
  v_add_u32_dpp v63, v44, v2 row_newbcast:0 row_mask:0xf bank_mask:0x3
  s_nop 1
  v_add_u32_dpp v63, v46, v2 row_newbcast:6 row_mask:0xf bank_mask:0xc
  s_add_u32 m0, s76, 14336
  s_nop 0
  buffer_load_dwordx4 v63, s[32:35], 0 offen lds
  s_waitcnt vmcnt(9)
  v_lshlrev_b32 v48, 7, v48
  v_lshlrev_b32 v50, 7, v50
  v_lshlrev_b32 v49, 7, v49
  v_lshlrev_b32_e64 v51, 7, v51
  v_add_u32_dpp v64, v48, v2 row_newbcast:0 row_mask:0xf bank_mask:0x3
  s_nop 1
  v_add_u32_dpp v64, v50, v2 row_newbcast:6 row_mask:0xf bank_mask:0xc
  s_add_u32 m0, s76, 16384
  s_nop 0
  buffer_load_dwordx4 v64, s[32:35], 0 offen lds
  s_waitcnt vmcnt(9)
  v_lshlrev_b32 v52, 7, v52
  v_lshlrev_b32 v54, 7, v54
  v_lshlrev_b32 v53, 7, v53
  v_lshlrev_b32_e64 v55, 7, v55
  v_add_u32_dpp v65, v52, v2 row_newbcast:0 row_mask:0xf bank_mask:0x3
  s_nop 1
  v_add_u32_dpp v65, v54, v2 row_newbcast:6 row_mask:0xf bank_mask:0xc
  s_add_u32 m0, s76, 18432
  s_nop 0
  buffer_load_dwordx4 v65, s[32:35], 0 offen lds
  v_add_u32_dpp v56, v17, v2 row_newbcast:0 row_mask:0xf bank_mask:0x3
  s_nop 1
  v_add_u32_dpp v56, v19, v2 row_newbcast:6 row_mask:0xf bank_mask:0xc
  s_add_u32 m0, s76, 40960
  s_nop 0
  buffer_load_dwordx4 v56, s[32:35], 0 offen lds
  v_add_u32_dpp v57, v21, v2 row_newbcast:0 row_mask:0xf bank_mask:0x3
  s_nop 1
  v_add_u32_dpp v57, v23, v2 row_newbcast:6 row_mask:0xf bank_mask:0xc
  s_add_u32 m0, s76, 43008
  s_nop 0
  buffer_load_dwordx4 v57, s[32:35], 0 offen lds
  v_add_u32_dpp v58, v25, v2 row_newbcast:0 row_mask:0xf bank_mask:0x3
  s_nop 1
  v_add_u32_dpp v58, v27, v2 row_newbcast:6 row_mask:0xf bank_mask:0xc
  s_add_u32 m0, s76, 45056
  s_nop 0
  buffer_load_dwordx4 v58, s[32:35], 0 offen lds
  v_add_u32_dpp v59, v29, v2 row_newbcast:0 row_mask:0xf bank_mask:0x3
  s_nop 1
  v_add_u32_dpp v59, v31, v2 row_newbcast:6 row_mask:0xf bank_mask:0xc
  s_add_u32 m0, s76, 47104
  s_nop 0
  buffer_load_dwordx4 v59, s[32:35], 0 offen lds
  v_add_u32_dpp v60, v33, v2 row_newbcast:0 row_mask:0xf bank_mask:0x3
  s_nop 1
  v_add_u32_dpp v60, v35, v2 row_newbcast:6 row_mask:0xf bank_mask:0xc
  s_add_u32 m0, s76, 49152
  s_nop 0
  buffer_load_dwordx4 v60, s[32:35], 0 offen lds
  s_waitcnt vmcnt(11)
  s_barrier
  v_add_u32_dpp v61, v37, v2 row_newbcast:0 row_mask:0xf bank_mask:0x3
  s_nop 1
  v_add_u32_dpp v61, v39, v2 row_newbcast:6 row_mask:0xf bank_mask:0xc
  s_add_u32 m0, s76, 51200
  s_nop 0
  buffer_load_dwordx4 v61, s[32:35], 0 offen lds
  v_add_u32_dpp v62, v41, v2 row_newbcast:0 row_mask:0xf bank_mask:0x3
  s_nop 1
  v_add_u32_dpp v62, v43, v2 row_newbcast:6 row_mask:0xf bank_mask:0xc
  s_add_u32 m0, s76, 53248
  s_nop 0
  buffer_load_dwordx4 v62, s[32:35], 0 offen lds
  v_add_u32_dpp v63, v45, v2 row_newbcast:0 row_mask:0xf bank_mask:0x3
  s_nop 1
  v_add_u32_dpp v63, v47, v2 row_newbcast:6 row_mask:0xf bank_mask:0xc
  s_add_u32 m0, s76, 55296
  s_nop 0
  buffer_load_dwordx4 v63, s[32:35], 0 offen lds
  v_add_u32_dpp v64, v49, v2 row_newbcast:0 row_mask:0xf bank_mask:0x3
  s_nop 1
  v_add_u32_dpp v64, v51, v2 row_newbcast:6 row_mask:0xf bank_mask:0xc
  s_add_u32 m0, s76, 57344
  s_nop 0
  buffer_load_dwordx4 v64, s[32:35], 0 offen lds
  v_add_u32_dpp v65, v53, v2 row_newbcast:0 row_mask:0xf bank_mask:0x3
  s_nop 1
  v_add_u32_dpp v65, v55, v2 row_newbcast:6 row_mask:0xf bank_mask:0xc
  s_add_u32 m0, s76, 59392
  s_nop 0
  buffer_load_dwordx4 v65, s[32:35], 0 offen lds
  s_waitcnt vmcnt(10)
  s_barrier
  s_add_u32 m0, s75, 147456
  s_nop 0
  buffer_load_dwordx4 v4, s[44:47], s74 offen lds
  s_add_u32 m0, s75, 148480
  s_nop 0
  buffer_load_dwordx4 v5, s[44:47], s74 offen lds
  s_add_u32 s74, s74, 106496
  s_add_u32 m0, s75, 155648
  s_nop 0
  buffer_load_dwordx4 v4, s[44:47], s74 offen lds
  s_add_u32 m0, s75, 156672
  s_nop 0
  buffer_load_dwordx4 v5, s[44:47], s74 offen lds
  s_add_u32 s74, s74, 106496
  v_add_u32_dpp v56, v18, v2 row_newbcast:0 row_mask:0xf bank_mask:0x3
  v_add_u32_dpp v57, v22, v2 row_newbcast:0 row_mask:0xf bank_mask:0x3
  v_add_u32_dpp v58, v26, v2 row_newbcast:0 row_mask:0xf bank_mask:0x3
  v_add_u32_dpp v59, v30, v2 row_newbcast:0 row_mask:0xf bank_mask:0x3
  v_add_u32_dpp v60, v34, v2 row_newbcast:0 row_mask:0xf bank_mask:0x3
  v_add_u32_dpp v61, v38, v2 row_newbcast:0 row_mask:0xf bank_mask:0x3
  v_add_u32_dpp v62, v42, v2 row_newbcast:0 row_mask:0xf bank_mask:0x3
  v_add_u32_dpp v63, v46, v2 row_newbcast:0 row_mask:0xf bank_mask:0x3
  v_add_u32_dpp v64, v50, v2 row_newbcast:0 row_mask:0xf bank_mask:0x3
  v_add_u32_dpp v65, v54, v2 row_newbcast:0 row_mask:0xf bank_mask:0x3
  v_add_u32_dpp v56, v16, v2 row_newbcast:7 row_mask:0xf bank_mask:0xc
  v_add_u32_dpp v57, v20, v2 row_newbcast:7 row_mask:0xf bank_mask:0xc
  v_add_u32_dpp v58, v24, v2 row_newbcast:7 row_mask:0xf bank_mask:0xc
  v_add_u32_dpp v59, v28, v2 row_newbcast:7 row_mask:0xf bank_mask:0xc
  v_add_u32_dpp v60, v32, v2 row_newbcast:7 row_mask:0xf bank_mask:0xc
  v_add_u32_dpp v61, v36, v2 row_newbcast:7 row_mask:0xf bank_mask:0xc
  v_add_u32_dpp v62, v40, v2 row_newbcast:7 row_mask:0xf bank_mask:0xc
  v_add_u32_dpp v63, v44, v2 row_newbcast:7 row_mask:0xf bank_mask:0xc
  v_add_u32_dpp v64, v48, v2 row_newbcast:7 row_mask:0xf bank_mask:0xc
  v_add_u32_dpp v65, v52, v2 row_newbcast:7 row_mask:0xf bank_mask:0xc
  s_add_u32 m0, s76, 81920
  s_nop 0
  buffer_load_dwordx4 v56, s[32:35], 0 offen lds
  s_add_u32 m0, s76, 83968
  s_nop 0
  buffer_load_dwordx4 v57, s[32:35], 0 offen lds
  s_add_u32 m0, s76, 86016
  s_nop 0
  buffer_load_dwordx4 v58, s[32:35], 0 offen lds
  s_add_u32 m0, s76, 88064
  s_nop 0
  buffer_load_dwordx4 v59, s[32:35], 0 offen lds
  s_add_u32 m0, s76, 90112
  s_nop 0
  buffer_load_dwordx4 v60, s[32:35], 0 offen lds
  s_add_u32 m0, s76, 92160
  s_nop 0
  buffer_load_dwordx4 v61, s[32:35], 0 offen lds
  s_add_u32 m0, s76, 94208
  s_nop 0
  buffer_load_dwordx4 v62, s[32:35], 0 offen lds
  s_add_u32 m0, s76, 96256
  s_nop 0
  buffer_load_dwordx4 v63, s[32:35], 0 offen lds
  s_waitcnt vmcnt(8)
  s_barrier
  s_add_u32 m0, s76, 98304
  s_nop 0
  buffer_load_dwordx4 v64, s[32:35], 0 offen lds
  s_add_u32 m0, s76, 100352
  s_nop 0
  buffer_load_dwordx4 v65, s[32:35], 0 offen lds
  v_add_u32_dpp v56, v19, v2 row_newbcast:0 row_mask:0xf bank_mask:0x3
  v_add_u32_dpp v57, v23, v2 row_newbcast:0 row_mask:0xf bank_mask:0x3
  v_add_u32_dpp v58, v27, v2 row_newbcast:0 row_mask:0xf bank_mask:0x3
  v_add_u32_dpp v59, v31, v2 row_newbcast:0 row_mask:0xf bank_mask:0x3
  v_add_u32_dpp v60, v35, v2 row_newbcast:0 row_mask:0xf bank_mask:0x3
  v_add_u32_dpp v61, v39, v2 row_newbcast:0 row_mask:0xf bank_mask:0x3
  v_add_u32_dpp v62, v43, v2 row_newbcast:0 row_mask:0xf bank_mask:0x3
  v_add_u32_dpp v63, v47, v2 row_newbcast:0 row_mask:0xf bank_mask:0x3
  v_add_u32_dpp v64, v51, v2 row_newbcast:0 row_mask:0xf bank_mask:0x3
  v_add_u32_dpp v65, v55, v2 row_newbcast:0 row_mask:0xf bank_mask:0x3
  v_add_u32_dpp v56, v17, v2 row_newbcast:7 row_mask:0xf bank_mask:0xc
  v_add_u32_dpp v57, v21, v2 row_newbcast:7 row_mask:0xf bank_mask:0xc
  v_add_u32_dpp v58, v25, v2 row_newbcast:7 row_mask:0xf bank_mask:0xc
  v_add_u32_dpp v59, v29, v2 row_newbcast:7 row_mask:0xf bank_mask:0xc
  v_add_u32_dpp v60, v33, v2 row_newbcast:7 row_mask:0xf bank_mask:0xc
  v_add_u32_dpp v61, v37, v2 row_newbcast:7 row_mask:0xf bank_mask:0xc
  v_add_u32_dpp v62, v41, v2 row_newbcast:7 row_mask:0xf bank_mask:0xc
  v_add_u32_dpp v63, v45, v2 row_newbcast:7 row_mask:0xf bank_mask:0xc
  v_add_u32_dpp v64, v49, v2 row_newbcast:7 row_mask:0xf bank_mask:0xc
  v_add_u32_dpp v65, v53, v2 row_newbcast:7 row_mask:0xf bank_mask:0xc
  s_setprio 0
  s_branch L_ld_in
L_cmp:
  s_mul_i32 s70, s3, 13
  v_min_u32 v118, 12, v0
  v_add_u32 v118, s70, v118
  v_lshrrev_b32 v117, 1, v118
  v_mul_u32_u24 v117, 96, v117
  v_lshl_add_u32 v118, v118, 2, v117
  s_mul_i32 s78, s27, 25
  s_min_u32 s78, s78, 294
  s_add_u32 s78, s78, s71
  s_mul_i32 s78, s78, 104
  s_waitcnt lgkmcnt(0)
  s_mov_b32 s28, s4
  s_and_b32 s29, s5, 0xffff
  s_mov_b32 s30, 425984
  s_mov_b32 s31, 0x20000
  s_mov_b32 s32, s6
  s_and_b32 s33, s7, 0xffff
  s_mov_b32 s34, 12800000
  s_mov_b32 s35, 0x20000
  s_mov_b32 s48, s14
  s_and_b32 s49, s15, 0xffff
  s_mov_b32 s50, 3328
  s_mov_b32 s51, 0x20000
  s_mov_b32 m0, 122880
  s_mov_b64 exec, 0xffff
  buffer_load_dwordx4 v11, s[48:51], s77 offen lds
  s_mov_b64 exec, -1
  s_and_b32 s68, s3, 1
  s_lshr_b32 s69, s3, 1
  v_bfe_u32 v117, v0, 2, 2
  v_lshl_add_u32 v118, v116, 3, v117
  v_lshlrev_b32 v118, 8, v118
  v_bfe_u32 v117, v0, 2, 3
  s_lshl_b32 s70, s69, 2
  v_xor_b32 v117, s70, v117
  v_lshl_add_u32 v118, v117, 5, v118
  v_and_b32 v117, 3, v0
  v_lshl_add_u32 v118, v117, 3, v118
  v_add_u32 v1, 131072, v118
  v_xor_b32 v2, 32, v1
  v_xor_b32 v3, 64, v1
  v_xor_b32 v4, 96, v1
  s_lshl_b32 s70, s69, 7
  s_add_u32 s70, s70, 122880
  v_lshlrev_b32 v118, 3, v116
  v_add_u32 v9, s70, v118
  v_and_b32 v118, 15, v0
  v_lshlrev_b32 v118, 7, v118
  v_bfe_u32 v117, v0, 1, 3
  v_xor_b32 v117, v117, v116
  v_lshl_add_u32 v118, v117, 4, v118
  s_mul_i32 s70, s68, 20480
  v_add_u32 v5, s70, v118
  v_xor_b32_e64 v7, 64, v5
  v_add_u32 v6, 81920, v5
  v_add_u32 v8, 81920, v7
  s_mul_i32 s70, s3, 640
  s_add_u32 s70, s70, 123392
  v_and_b32 v118, 15, v0
  v_lshlrev_b32 v118, 2, v118
  v_add_u32 v118, s70, v118
  v_lshrrev_b32_e64 v117, 5, v0
  v_lshl_add_u32 v118, v117, 6, v118
  v_bfe_u32 v117, v0, 4, 1
  v_lshl_add_u32 v10, v117, 7, v118
  s_mov_b32 s72, 0
  v_mov_b32 v12, 0xc0135761
  v_mov_b32 v13, 0xc0135761
  v_mov_b32 v14, 0xbdd2d3e8
  v_mov_b32 v15, 0xbdd2d3e8
  s_barrier
  ds_read_b64_tr_b16 v[16:17], v1 offset:0
  ds_read_b64_tr_b16 v[18:19], v1 offset:1024
  ds_read_b64_tr_b16 v[32:33], v1 offset:8192
  ds_read_b64_tr_b16 v[34:35], v1 offset:9216
  ds_read_b64_tr_b16 v[20:21], v2 offset:0
  ds_read_b64_tr_b16 v[22:23], v2 offset:1024
  ds_read_b64_tr_b16 v[36:37], v2 offset:8192
  ds_read_b64_tr_b16 v[38:39], v2 offset:9216
  ds_read_b64_tr_b16 v[24:25], v3 offset:0
  ds_read_b64_tr_b16 v[26:27], v3 offset:1024
  ds_read_b64_tr_b16 v[40:41], v3 offset:8192
  ds_read_b64_tr_b16 v[42:43], v3 offset:9216
  ds_read_b64_tr_b16 v[28:29], v4 offset:0
  ds_read_b64_tr_b16 v[30:31], v4 offset:1024
  ds_read_b64_tr_b16 v[44:45], v4 offset:8192
  ds_read_b64_tr_b16 v[46:47], v4 offset:9216
  s_waitcnt vmcnt(0)
  ds_read_b64 v[234:235], v9 offset:0
  ds_read_b64 v[238:239], v9 offset:32
  ds_read_b64 v[242:243], v9 offset:64
  ds_read_b64 v[246:247], v9 offset:96
  s_waitcnt lgkmcnt(3)
  v_lshlrev_b32 v232, 16, v234
  v_and_b32 v233, 0xffff0000, v234
  v_lshlrev_b32 v234, 16, v235
  v_and_b32 v235, 0xffff0000, v235
  s_waitcnt lgkmcnt(2)
  v_lshlrev_b32 v236, 16, v238
  v_and_b32 v237, 0xffff0000, v238
  v_lshlrev_b32 v238, 16, v239
  v_and_b32 v239, 0xffff0000, v239
  s_waitcnt lgkmcnt(1)
  v_lshlrev_b32 v240, 16, v242
  v_and_b32 v241, 0xffff0000, v242
  v_lshlrev_b32 v242, 16, v243
  v_and_b32 v243, 0xffff0000, v243
  s_waitcnt lgkmcnt(0)
  v_lshlrev_b32 v244, 16, v246
  v_and_b32 v245, 0xffff0000, v246
  v_lshlrev_b32 v246, 16, v247
  v_and_b32 v247, 0xffff0000, v247
  v_mov_b64 v[216:217], v[232:233]
  v_mov_b64 v[218:219], v[234:235]
  v_mov_b64 v[220:221], v[236:237]
  v_mov_b64 v[222:223], v[238:239]
  v_mov_b64 v[224:225], v[240:241]
  v_mov_b64 v[226:227], v[242:243]
  v_mov_b64 v[228:229], v[244:245]
  v_mov_b64 v[230:231], v[246:247]
  s_waitcnt lgkmcnt(0)
  s_setprio 1
  s_barrier
  ds_read_b128 v[48:51], v5 offset:0
  ds_read_b128 v[52:55], v7 offset:0
  ds_read_b128 v[56:59], v5 offset:2048
  ds_read_b128 v[60:63], v7 offset:2048
  ds_read_b128 v[64:67], v5 offset:4096
  ds_read_b128 v[68:71], v7 offset:4096
  ds_read_b128 v[72:75], v5 offset:6144
  ds_read_b128 v[76:79], v7 offset:6144
  s_waitcnt lgkmcnt(7)
  v_mfma_f32_16x16x32_bf16 v[88:91], v[16:19], v[48:51], v[232:235]
  s_waitcnt lgkmcnt(4)
  v_mfma_f32_16x16x32_bf16 v[88:91], v[32:35], v[52:55], v[88:91]
  v_mfma_f32_16x16x32_bf16 v[104:107], v[32:35], v[60:63], v[232:235]
  s_nop 0
  v_mfma_f32_16x16x32_bf16 v[104:107], v[16:19], v[56:59], v[104:107]
  v_mfma_f32_16x16x32_bf16 v[108:111], v[20:23], v[56:59], v[236:239]
  v_mfma_f32_16x16x32_bf16 v[108:111], v[36:39], v[60:63], v[108:111]
  v_mfma_f32_16x16x32_bf16 v[92:95], v[36:39], v[52:55], v[236:239]
  v_mfma_f32_16x16x32_bf16 v[92:95], v[20:23], v[48:51], v[92:95]
  v_mfma_f32_16x16x32_bf16 v[96:99], v[24:27], v[48:51], v[240:243]
  v_xor_b32 v1, 16384, v1
  v_mfma_f32_16x16x32_bf16 v[96:99], v[40:43], v[52:55], v[96:99]
  v_xor_b32 v2, 16384, v2
  v_mfma_f32_16x16x32_bf16 v[112:115], v[40:43], v[60:63], v[240:243]
  v_xor_b32 v3, 16384, v3
  v_mfma_f32_16x16x32_bf16 v[112:115], v[24:27], v[56:59], v[112:115]
  v_xor_b32 v4, 16384, v4
  v_mfma_f32_16x16x32_bf16 v[116:119], v[28:31], v[56:59], v[244:247]
  v_mfma_f32_16x16x32_bf16 v[116:119], v[44:47], v[60:63], v[116:119]
  v_mfma_f32_16x16x32_bf16 v[100:103], v[44:47], v[52:55], v[244:247]
  s_waitcnt lgkmcnt(2)
  v_mfma_f32_16x16x32_bf16 v[100:103], v[28:31], v[48:51], v[100:103]
  v_mfma_f32_16x16x32_bf16 v[120:123], v[16:19], v[64:67], v[232:235]
  s_barrier
  s_waitcnt lgkmcnt(0)
  v_mfma_f32_16x16x32_bf16 v[120:123], v[32:35], v[68:71], v[120:123]
  ds_read_b128 v[80:83], v5 offset:8192
  v_mfma_f32_16x16x32_bf16 v[136:139], v[32:35], v[76:79], v[232:235]
  s_nop 0
  ds_read_b128 v[84:87], v7 offset:8192
  v_mfma_f32_16x16x32_bf16 v[136:139], v[16:19], v[72:75], v[136:139]
  ds_read_b128 v[48:51], v5 offset:10240
  v_mfma_f32_16x16x32_bf16 v[140:143], v[20:23], v[72:75], v[236:239]
  ds_read_b128 v[52:55], v7 offset:10240
  v_mfma_f32_16x16x32_bf16 v[140:143], v[36:39], v[76:79], v[140:143]
  ds_read_b128 v[56:59], v5 offset:12288
  v_mfma_f32_16x16x32_bf16 v[124:127], v[36:39], v[68:71], v[236:239]
  ds_read_b128 v[60:63], v7 offset:12288
  v_mfma_f32_16x16x32_bf16 v[124:127], v[20:23], v[64:67], v[124:127]
  v_mfma_f32_16x16x32_bf16 v[128:131], v[24:27], v[64:67], v[240:243]
  v_mfma_f32_16x16x32_bf16 v[128:131], v[40:43], v[68:71], v[128:131]
  v_mfma_f32_16x16x32_bf16 v[144:147], v[40:43], v[76:79], v[240:243]
  v_mfma_f32_16x16x32_bf16 v[144:147], v[24:27], v[72:75], v[144:147]
  v_mfma_f32_16x16x32_bf16 v[148:151], v[28:31], v[72:75], v[244:247]
  ds_read_b128 v[72:75], v5 offset:16384
  v_mfma_f32_16x16x32_bf16 v[148:151], v[44:47], v[76:79], v[148:151]
  ds_read_b128 v[76:79], v7 offset:16384
  v_mfma_f32_16x16x32_bf16 v[132:135], v[44:47], v[68:71], v[244:247]
  ds_read_b128 v[68:71], v7 offset:14336
  s_waitcnt lgkmcnt(7)
  v_mfma_f32_16x16x32_bf16 v[132:135], v[28:31], v[64:67], v[132:135]
  ds_read_b128 v[64:67], v5 offset:14336
  v_mfma_f32_16x16x32_bf16 v[152:155], v[16:19], v[80:83], v[232:235]
  s_waitcnt lgkmcnt(6)
  v_mfma_f32_16x16x32_bf16 v[152:155], v[32:35], v[84:87], v[152:155]
  v_mfma_f32_16x16x32_bf16 v[168:171], v[32:35], v[52:55], v[232:235]
  v_mfma_f32_16x16x32_bf16 v[168:171], v[16:19], v[48:51], v[168:171]
  v_mfma_f32_16x16x32_bf16 v[172:175], v[20:23], v[48:51], v[236:239]
  v_mfma_f32_16x16x32_bf16 v[172:175], v[36:39], v[52:55], v[172:175]
  v_mfma_f32_16x16x32_bf16 v[156:159], v[36:39], v[84:87], v[236:239]
  v_mfma_f32_16x16x32_bf16 v[156:159], v[20:23], v[80:83], v[156:159]
  v_mfma_f32_16x16x32_bf16 v[160:163], v[24:27], v[80:83], v[240:243]
  v_mfma_f32_16x16x32_bf16 v[160:163], v[40:43], v[84:87], v[160:163]
  v_mfma_f32_16x16x32_bf16 v[176:179], v[40:43], v[52:55], v[240:243]
  v_mfma_f32_16x16x32_bf16 v[176:179], v[24:27], v[48:51], v[176:179]
  v_mfma_f32_16x16x32_bf16 v[180:183], v[28:31], v[48:51], v[244:247]
  v_mfma_f32_16x16x32_bf16 v[180:183], v[44:47], v[52:55], v[180:183]
  v_mfma_f32_16x16x32_bf16 v[164:167], v[44:47], v[84:87], v[244:247]
  ds_read_b128 v[84:87], v7 offset:18432
  s_waitcnt lgkmcnt(5)
  v_mfma_f32_16x16x32_bf16 v[164:167], v[28:31], v[80:83], v[164:167]
  s_nop 0
  ds_read_b128 v[80:83], v5 offset:18432
  v_mfma_f32_16x16x32_bf16 v[184:187], v[16:19], v[56:59], v[232:235]
  s_waitcnt lgkmcnt(2)
  v_mfma_f32_16x16x32_bf16 v[184:187], v[32:35], v[60:63], v[184:187]
  v_mfma_f32_16x16x32_bf16 v[200:203], v[32:35], v[68:71], v[232:235]
  v_mfma_f32_16x16x32_bf16 v[200:203], v[16:19], v[64:67], v[200:203]
  v_mfma_f32_16x16x32_bf16 v[204:207], v[20:23], v[64:67], v[236:239]
  v_mfma_f32_16x16x32_bf16 v[204:207], v[36:39], v[68:71], v[204:207]
  s_waitcnt lgkmcnt(0)
  s_barrier
  v_mfma_f32_16x16x32_bf16 v[188:191], v[36:39], v[60:63], v[236:239]
  ds_read_b128 v[48:51], v5 offset:40960
  v_mfma_f32_16x16x32_bf16 v[188:191], v[20:23], v[56:59], v[188:191]
  ds_read_b128 v[52:55], v7 offset:40960
  v_mfma_f32_16x16x32_bf16 v[192:195], v[24:27], v[56:59], v[240:243]
  v_mfma_f32_16x16x32_bf16 v[192:195], v[40:43], v[60:63], v[192:195]
  v_mfma_f32_16x16x32_bf16 v[208:211], v[40:43], v[68:71], v[240:243]
  s_nop 0
  v_mfma_f32_16x16x32_bf16 v[208:211], v[24:27], v[64:67], v[208:211]
  v_mfma_f32_16x16x32_bf16 v[212:215], v[28:31], v[64:67], v[244:247]
  ds_read_b128 v[64:67], v5 offset:45056
  v_mfma_f32_16x16x32_bf16 v[212:215], v[44:47], v[68:71], v[212:215]
  ds_read_b128 v[68:71], v7 offset:45056
  v_mfma_f32_16x16x32_bf16 v[196:199], v[44:47], v[60:63], v[244:247]
  ds_read_b128 v[60:63], v7 offset:43008
  v_mfma_f32_16x16x32_bf16 v[196:199], v[28:31], v[56:59], v[196:199]
  ds_read_b128 v[56:59], v5 offset:43008
  v_mfma_f32_16x16x32_bf16 v[216:219], v[32:35], v[76:79], v[216:219]
  v_mfma_f32_16x16x32_bf16 v[216:219], v[16:19], v[72:75], v[216:219]
  v_mfma_f32_16x16x32_bf16 v[232:235], v[16:19], v[80:83], v[232:235]
  ds_read_b64_tr_b16 v[16:17], v1 offset:0
  v_mfma_f32_16x16x32_bf16 v[232:235], v[32:35], v[84:87], v[232:235]
  ds_read_b64_tr_b16 v[18:19], v1 offset:1024
  v_mfma_f32_16x16x32_bf16 v[236:239], v[36:39], v[84:87], v[236:239]
  ds_read_b64_tr_b16 v[32:33], v1 offset:8192
  v_mfma_f32_16x16x32_bf16 v[236:239], v[20:23], v[80:83], v[236:239]
  ds_read_b64_tr_b16 v[34:35], v1 offset:9216
  v_mfma_f32_16x16x32_bf16 v[220:223], v[20:23], v[72:75], v[220:223]
  ds_read_b64_tr_b16 v[20:21], v2 offset:0
  v_mfma_f32_16x16x32_bf16 v[220:223], v[36:39], v[76:79], v[220:223]
  ds_read_b64_tr_b16 v[22:23], v2 offset:1024
  v_mfma_f32_16x16x32_bf16 v[224:227], v[40:43], v[76:79], v[224:227]
  ds_read_b64_tr_b16 v[36:37], v2 offset:8192
  v_mfma_f32_16x16x32_bf16 v[224:227], v[24:27], v[72:75], v[224:227]
  ds_read_b64_tr_b16 v[38:39], v2 offset:9216
  v_mfma_f32_16x16x32_bf16 v[240:243], v[24:27], v[80:83], v[240:243]
  ds_read_b64_tr_b16 v[24:25], v3 offset:0
  v_mfma_f32_16x16x32_bf16 v[240:243], v[40:43], v[84:87], v[240:243]
  ds_read_b64_tr_b16 v[26:27], v3 offset:1024
  v_mfma_f32_16x16x32_bf16 v[244:247], v[44:47], v[84:87], v[244:247]
  ds_read_b64_tr_b16 v[40:41], v3 offset:8192
  v_mfma_f32_16x16x32_bf16 v[244:247], v[28:31], v[80:83], v[244:247]
  s_nop 0
  ds_read_b64_tr_b16 v[42:43], v3 offset:9216
  v_mfma_f32_16x16x32_bf16 v[228:231], v[28:31], v[72:75], v[228:231]
  ds_read_b64_tr_b16 v[28:29], v4 offset:0
  s_waitcnt lgkmcnt(9)
  v_mfma_f32_16x16x32_bf16 v[228:231], v[44:47], v[76:79], v[228:231]
  ds_read_b64_tr_b16 v[30:31], v4 offset:1024
L_dnn_loop0:
  v_mfma_f32_16x16x32_bf16 v[88:91], v[16:19], v[48:51], v[88:91]
  ds_read_b64_tr_b16 v[44:45], v4 offset:8192
  v_mfma_f32_16x16x32_bf16 v[88:91], v[32:35], v[52:55], v[88:91]
  ds_read_b64_tr_b16 v[46:47], v4 offset:9216
  v_mfma_f32_16x16x32_bf16 v[104:107], v[32:35], v[60:63], v[104:107]
  ds_read_b128 v[72:75], v5 offset:47104
  s_waitcnt lgkmcnt(9)
  v_mfma_f32_16x16x32_bf16 v[104:107], v[16:19], v[56:59], v[104:107]
  s_nop 0
  ds_read_b128 v[76:79], v7 offset:47104
  v_mfma_f32_16x16x32_bf16 v[108:111], v[20:23], v[56:59], v[108:111]
  ds_read_b128 v[80:83], v5 offset:49152
  v_mfma_f32_16x16x32_bf16 v[108:111], v[36:39], v[60:63], v[108:111]
  ds_read_b128 v[84:87], v7 offset:49152
  v_mfma_f32_16x16x32_bf16 v[92:95], v[36:39], v[52:55], v[92:95]
  s_waitcnt lgkmcnt(8)
  v_mfma_f32_16x16x32_bf16 v[92:95], v[20:23], v[48:51], v[92:95]
  s_nop 0
  v_mfma_f32_16x16x32_bf16 v[96:99], v[24:27], v[48:51], v[96:99]
  v_xor_b32 v1, 16384, v1
  v_mfma_f32_16x16x32_bf16 v[96:99], v[40:43], v[52:55], v[96:99]
  v_xor_b32 v2, 16384, v2
  v_mfma_f32_16x16x32_bf16 v[112:115], v[40:43], v[60:63], v[112:115]
  v_xor_b32 v3, 16384, v3
  s_waitcnt lgkmcnt(4)
  v_mfma_f32_16x16x32_bf16 v[112:115], v[24:27], v[56:59], v[112:115]
  s_nop 0
  v_xor_b32 v4, 16384, v4
  v_mfma_f32_16x16x32_bf16 v[116:119], v[28:31], v[56:59], v[116:119]
  ds_read_b128 v[56:59], v5 offset:53248
  v_mfma_f32_16x16x32_bf16 v[116:119], v[44:47], v[60:63], v[116:119]
  ds_read_b128 v[60:63], v7 offset:53248
  v_mfma_f32_16x16x32_bf16 v[100:103], v[44:47], v[52:55], v[100:103]
  ds_read_b128 v[52:55], v7 offset:51200
  v_mfma_f32_16x16x32_bf16 v[100:103], v[28:31], v[48:51], v[100:103]
  ds_read_b128 v[48:51], v5 offset:51200
  v_mfma_f32_16x16x32_bf16 v[120:123], v[16:19], v[64:67], v[120:123]
  s_waitcnt lgkmcnt(6)
  v_mfma_f32_16x16x32_bf16 v[120:123], v[32:35], v[68:71], v[120:123]
  v_mfma_f32_16x16x32_bf16 v[136:139], v[32:35], v[76:79], v[136:139]
  v_mfma_f32_16x16x32_bf16 v[136:139], v[16:19], v[72:75], v[136:139]
  v_mfma_f32_16x16x32_bf16 v[140:143], v[20:23], v[72:75], v[140:143]
  v_mfma_f32_16x16x32_bf16 v[140:143], v[36:39], v[76:79], v[140:143]
  s_nop 0
  v_mfma_f32_16x16x32_bf16 v[124:127], v[36:39], v[68:71], v[124:127]
  v_mfma_f32_16x16x32_bf16 v[124:127], v[20:23], v[64:67], v[124:127]
  v_mfma_f32_16x16x32_bf16 v[128:131], v[24:27], v[64:67], v[128:131]
  v_mfma_f32_16x16x32_bf16 v[128:131], v[40:43], v[68:71], v[128:131]
  v_mfma_f32_16x16x32_bf16 v[144:147], v[40:43], v[76:79], v[144:147]
  v_mfma_f32_16x16x32_bf16 v[144:147], v[24:27], v[72:75], v[144:147]
  v_mfma_f32_16x16x32_bf16 v[148:151], v[28:31], v[72:75], v[148:151]
  ds_read_b128 v[72:75], v5 offset:57344
  v_mfma_f32_16x16x32_bf16 v[148:151], v[44:47], v[76:79], v[148:151]
  ds_read_b128 v[76:79], v7 offset:57344
  v_mfma_f32_16x16x32_bf16 v[132:135], v[44:47], v[68:71], v[132:135]
  ds_read_b128 v[68:71], v7 offset:55296
  s_waitcnt lgkmcnt(7)
  v_mfma_f32_16x16x32_bf16 v[132:135], v[28:31], v[64:67], v[132:135]
  ds_read_b128 v[64:67], v5 offset:55296
  v_mfma_f32_16x16x32_bf16 v[152:155], v[16:19], v[80:83], v[152:155]
  s_waitcnt lgkmcnt(4)
  v_mfma_f32_16x16x32_bf16 v[152:155], v[32:35], v[84:87], v[152:155]
  v_mfma_f32_16x16x32_bf16 v[168:171], v[32:35], v[52:55], v[168:171]
  v_mfma_f32_16x16x32_bf16 v[168:171], v[16:19], v[48:51], v[168:171]
  v_mfma_f32_16x16x32_bf16 v[172:175], v[20:23], v[48:51], v[172:175]
  v_mfma_f32_16x16x32_bf16 v[172:175], v[36:39], v[52:55], v[172:175]
  v_mfma_f32_16x16x32_bf16 v[156:159], v[36:39], v[84:87], v[156:159]
  v_mfma_f32_16x16x32_bf16 v[156:159], v[20:23], v[80:83], v[156:159]
  v_mfma_f32_16x16x32_bf16 v[160:163], v[24:27], v[80:83], v[160:163]
  v_mfma_f32_16x16x32_bf16 v[160:163], v[40:43], v[84:87], v[160:163]
  v_mfma_f32_16x16x32_bf16 v[176:179], v[40:43], v[52:55], v[176:179]
  v_mfma_f32_16x16x32_bf16 v[176:179], v[24:27], v[48:51], v[176:179]
  v_mfma_f32_16x16x32_bf16 v[180:183], v[28:31], v[48:51], v[180:183]
  v_mfma_f32_16x16x32_bf16 v[180:183], v[44:47], v[52:55], v[180:183]
  v_mfma_f32_16x16x32_bf16 v[164:167], v[44:47], v[84:87], v[164:167]
  ds_read_b128 v[84:87], v7 offset:59392
  v_mfma_f32_16x16x32_bf16 v[164:167], v[28:31], v[80:83], v[164:167]
  ds_read_b128 v[80:83], v5 offset:59392
  v_mfma_f32_16x16x32_bf16 v[184:187], v[16:19], v[56:59], v[184:187]
  s_waitcnt lgkmcnt(2)
  v_mfma_f32_16x16x32_bf16 v[184:187], v[32:35], v[60:63], v[184:187]
  v_mfma_f32_16x16x32_bf16 v[200:203], v[32:35], v[68:71], v[200:203]
  v_mfma_f32_16x16x32_bf16 v[200:203], v[16:19], v[64:67], v[200:203]
  v_mfma_f32_16x16x32_bf16 v[204:207], v[20:23], v[64:67], v[204:207]
  v_mfma_f32_16x16x32_bf16 v[204:207], v[36:39], v[68:71], v[204:207]
  s_waitcnt lgkmcnt(0)
  s_barrier
  v_mfma_f32_16x16x32_bf16 v[188:191], v[36:39], v[60:63], v[188:191]
  ds_read_b128 v[48:51], v6 offset:0
  v_mfma_f32_16x16x32_bf16 v[188:191], v[20:23], v[56:59], v[188:191]
  ds_read_b128 v[52:55], v8 offset:0
  v_mfma_f32_16x16x32_bf16 v[192:195], v[24:27], v[56:59], v[192:195]
  v_mfma_f32_16x16x32_bf16 v[192:195], v[40:43], v[60:63], v[192:195]
  v_mfma_f32_16x16x32_bf16 v[208:211], v[40:43], v[68:71], v[208:211]
  s_nop 0
  v_mfma_f32_16x16x32_bf16 v[208:211], v[24:27], v[64:67], v[208:211]
  v_mfma_f32_16x16x32_bf16 v[212:215], v[28:31], v[64:67], v[212:215]
  ds_read_b128 v[64:67], v6 offset:4096
  v_mfma_f32_16x16x32_bf16 v[212:215], v[44:47], v[68:71], v[212:215]
  ds_read_b128 v[68:71], v8 offset:4096
  v_mfma_f32_16x16x32_bf16 v[196:199], v[44:47], v[60:63], v[196:199]
  ds_read_b128 v[60:63], v8 offset:2048
  v_mfma_f32_16x16x32_bf16 v[196:199], v[28:31], v[56:59], v[196:199]
  ds_read_b128 v[56:59], v6 offset:2048
  v_mfma_f32_16x16x32_bf16 v[216:219], v[32:35], v[76:79], v[216:219]
  v_mfma_f32_16x16x32_bf16 v[216:219], v[16:19], v[72:75], v[216:219]
  v_mfma_f32_16x16x32_bf16 v[232:235], v[16:19], v[80:83], v[232:235]
  ds_read_b64_tr_b16 v[16:17], v1 offset:0
  v_mfma_f32_16x16x32_bf16 v[232:235], v[32:35], v[84:87], v[232:235]
  ds_read_b64_tr_b16 v[18:19], v1 offset:1024
  v_mfma_f32_16x16x32_bf16 v[236:239], v[36:39], v[84:87], v[236:239]
  ds_read_b64_tr_b16 v[32:33], v1 offset:8192
  v_mfma_f32_16x16x32_bf16 v[236:239], v[20:23], v[80:83], v[236:239]
  ds_read_b64_tr_b16 v[34:35], v1 offset:9216
  v_mfma_f32_16x16x32_bf16 v[220:223], v[20:23], v[72:75], v[220:223]
  ds_read_b64_tr_b16 v[20:21], v2 offset:0
  v_mfma_f32_16x16x32_bf16 v[220:223], v[36:39], v[76:79], v[220:223]
  ds_read_b64_tr_b16 v[22:23], v2 offset:1024
  v_mfma_f32_16x16x32_bf16 v[224:227], v[40:43], v[76:79], v[224:227]
  ds_read_b64_tr_b16 v[36:37], v2 offset:8192
  v_mfma_f32_16x16x32_bf16 v[224:227], v[24:27], v[72:75], v[224:227]
  ds_read_b64_tr_b16 v[38:39], v2 offset:9216
  v_mfma_f32_16x16x32_bf16 v[240:243], v[24:27], v[80:83], v[240:243]
  ds_read_b64_tr_b16 v[24:25], v3 offset:0
  v_mfma_f32_16x16x32_bf16 v[240:243], v[40:43], v[84:87], v[240:243]
  ds_read_b64_tr_b16 v[26:27], v3 offset:1024
  v_mfma_f32_16x16x32_bf16 v[244:247], v[44:47], v[84:87], v[244:247]
  ds_read_b64_tr_b16 v[40:41], v3 offset:8192
  v_mfma_f32_16x16x32_bf16 v[244:247], v[28:31], v[80:83], v[244:247]
  ds_read_b64_tr_b16 v[42:43], v3 offset:9216
  v_mfma_f32_16x16x32_bf16 v[228:231], v[28:31], v[72:75], v[228:231]
  ds_read_b64_tr_b16 v[28:29], v4 offset:0
  s_waitcnt lgkmcnt(9)
  v_mfma_f32_16x16x32_bf16 v[228:231], v[44:47], v[76:79], v[228:231]
  s_nop 0
  ds_read_b64_tr_b16 v[30:31], v4 offset:1024
  v_mfma_f32_16x16x32_bf16 v[88:91], v[16:19], v[48:51], v[88:91]
  ds_read_b64_tr_b16 v[44:45], v4 offset:8192
  v_mfma_f32_16x16x32_bf16 v[88:91], v[32:35], v[52:55], v[88:91]
  ds_read_b64_tr_b16 v[46:47], v4 offset:9216
  v_mfma_f32_16x16x32_bf16 v[104:107], v[32:35], v[60:63], v[104:107]
  ds_read_b128 v[72:75], v6 offset:6144
  s_waitcnt lgkmcnt(9)
  v_mfma_f32_16x16x32_bf16 v[104:107], v[16:19], v[56:59], v[104:107]
  s_nop 0
  ds_read_b128 v[76:79], v8 offset:6144
  v_mfma_f32_16x16x32_bf16 v[108:111], v[20:23], v[56:59], v[108:111]
  ds_read_b128 v[80:83], v6 offset:8192
  v_mfma_f32_16x16x32_bf16 v[108:111], v[36:39], v[60:63], v[108:111]
  ds_read_b128 v[84:87], v8 offset:8192
  v_mfma_f32_16x16x32_bf16 v[92:95], v[36:39], v[52:55], v[92:95]
  s_waitcnt lgkmcnt(8)
  v_mfma_f32_16x16x32_bf16 v[92:95], v[20:23], v[48:51], v[92:95]
  s_nop 0
  v_mfma_f32_16x16x32_bf16 v[96:99], v[24:27], v[48:51], v[96:99]
  v_xor_b32 v1, 16384, v1
  v_mfma_f32_16x16x32_bf16 v[96:99], v[40:43], v[52:55], v[96:99]
  v_xor_b32 v2, 16384, v2
  v_mfma_f32_16x16x32_bf16 v[112:115], v[40:43], v[60:63], v[112:115]
  v_xor_b32 v3, 16384, v3
  s_waitcnt lgkmcnt(4)
  v_mfma_f32_16x16x32_bf16 v[112:115], v[24:27], v[56:59], v[112:115]
  s_nop 0
  v_xor_b32 v4, 16384, v4
  v_mfma_f32_16x16x32_bf16 v[116:119], v[28:31], v[56:59], v[116:119]
  ds_read_b128 v[56:59], v6 offset:12288
  v_mfma_f32_16x16x32_bf16 v[116:119], v[44:47], v[60:63], v[116:119]
  ds_read_b128 v[60:63], v8 offset:12288
  v_mfma_f32_16x16x32_bf16 v[100:103], v[44:47], v[52:55], v[100:103]
  ds_read_b128 v[52:55], v8 offset:10240
  v_mfma_f32_16x16x32_bf16 v[100:103], v[28:31], v[48:51], v[100:103]
  ds_read_b128 v[48:51], v6 offset:10240
  v_mfma_f32_16x16x32_bf16 v[120:123], v[16:19], v[64:67], v[120:123]
  s_waitcnt lgkmcnt(6)
  v_mfma_f32_16x16x32_bf16 v[120:123], v[32:35], v[68:71], v[120:123]
  v_mfma_f32_16x16x32_bf16 v[136:139], v[32:35], v[76:79], v[136:139]
  v_mfma_f32_16x16x32_bf16 v[136:139], v[16:19], v[72:75], v[136:139]
  v_mfma_f32_16x16x32_bf16 v[140:143], v[20:23], v[72:75], v[140:143]
  v_mfma_f32_16x16x32_bf16 v[140:143], v[36:39], v[76:79], v[140:143]
  s_nop 0
  v_mfma_f32_16x16x32_bf16 v[124:127], v[36:39], v[68:71], v[124:127]
  v_mfma_f32_16x16x32_bf16 v[124:127], v[20:23], v[64:67], v[124:127]
  v_mfma_f32_16x16x32_bf16 v[128:131], v[24:27], v[64:67], v[128:131]
  v_mfma_f32_16x16x32_bf16 v[128:131], v[40:43], v[68:71], v[128:131]
  v_mfma_f32_16x16x32_bf16 v[144:147], v[40:43], v[76:79], v[144:147]
  v_mfma_f32_16x16x32_bf16 v[144:147], v[24:27], v[72:75], v[144:147]
  v_mfma_f32_16x16x32_bf16 v[148:151], v[28:31], v[72:75], v[148:151]
  ds_read_b128 v[72:75], v6 offset:16384
  v_mfma_f32_16x16x32_bf16 v[148:151], v[44:47], v[76:79], v[148:151]
  ds_read_b128 v[76:79], v8 offset:16384
  v_mfma_f32_16x16x32_bf16 v[132:135], v[44:47], v[68:71], v[132:135]
  ds_read_b128 v[68:71], v8 offset:14336
  s_waitcnt lgkmcnt(7)
  v_mfma_f32_16x16x32_bf16 v[132:135], v[28:31], v[64:67], v[132:135]
  ds_read_b128 v[64:67], v6 offset:14336
  v_mfma_f32_16x16x32_bf16 v[152:155], v[16:19], v[80:83], v[152:155]
  s_waitcnt lgkmcnt(4)
  v_mfma_f32_16x16x32_bf16 v[152:155], v[32:35], v[84:87], v[152:155]
  v_mfma_f32_16x16x32_bf16 v[168:171], v[32:35], v[52:55], v[168:171]
  v_mfma_f32_16x16x32_bf16 v[168:171], v[16:19], v[48:51], v[168:171]
  v_mfma_f32_16x16x32_bf16 v[172:175], v[20:23], v[48:51], v[172:175]
  v_mfma_f32_16x16x32_bf16 v[172:175], v[36:39], v[52:55], v[172:175]
  v_mfma_f32_16x16x32_bf16 v[156:159], v[36:39], v[84:87], v[156:159]
  v_mfma_f32_16x16x32_bf16 v[156:159], v[20:23], v[80:83], v[156:159]
  v_mfma_f32_16x16x32_bf16 v[160:163], v[24:27], v[80:83], v[160:163]
  v_mfma_f32_16x16x32_bf16 v[160:163], v[40:43], v[84:87], v[160:163]
  v_mfma_f32_16x16x32_bf16 v[176:179], v[40:43], v[52:55], v[176:179]
  v_mfma_f32_16x16x32_bf16 v[176:179], v[24:27], v[48:51], v[176:179]
  v_mfma_f32_16x16x32_bf16 v[180:183], v[28:31], v[48:51], v[180:183]
  v_mfma_f32_16x16x32_bf16 v[180:183], v[44:47], v[52:55], v[180:183]
  v_mfma_f32_16x16x32_bf16 v[164:167], v[44:47], v[84:87], v[164:167]
  ds_read_b128 v[84:87], v8 offset:18432
  v_mfma_f32_16x16x32_bf16 v[164:167], v[28:31], v[80:83], v[164:167]
  ds_read_b128 v[80:83], v6 offset:18432
  v_mfma_f32_16x16x32_bf16 v[184:187], v[16:19], v[56:59], v[184:187]
  s_waitcnt lgkmcnt(2)
  v_mfma_f32_16x16x32_bf16 v[184:187], v[32:35], v[60:63], v[184:187]
  v_mfma_f32_16x16x32_bf16 v[200:203], v[32:35], v[68:71], v[200:203]
  v_mfma_f32_16x16x32_bf16 v[200:203], v[16:19], v[64:67], v[200:203]
  v_mfma_f32_16x16x32_bf16 v[204:207], v[20:23], v[64:67], v[204:207]
  v_mfma_f32_16x16x32_bf16 v[204:207], v[36:39], v[68:71], v[204:207]
  s_waitcnt lgkmcnt(0)
  s_barrier
  v_mfma_f32_16x16x32_bf16 v[188:191], v[36:39], v[60:63], v[188:191]
  ds_read_b128 v[48:51], v5 offset:0
  v_mfma_f32_16x16x32_bf16 v[188:191], v[20:23], v[56:59], v[188:191]
  ds_read_b128 v[52:55], v7 offset:0
  v_mfma_f32_16x16x32_bf16 v[192:195], v[24:27], v[56:59], v[192:195]
  v_mfma_f32_16x16x32_bf16 v[192:195], v[40:43], v[60:63], v[192:195]
  v_mfma_f32_16x16x32_bf16 v[208:211], v[40:43], v[68:71], v[208:211]
  s_nop 0
  v_mfma_f32_16x16x32_bf16 v[208:211], v[24:27], v[64:67], v[208:211]
  v_mfma_f32_16x16x32_bf16 v[212:215], v[28:31], v[64:67], v[212:215]
  ds_read_b128 v[64:67], v5 offset:4096
  v_mfma_f32_16x16x32_bf16 v[212:215], v[44:47], v[68:71], v[212:215]
  ds_read_b128 v[68:71], v7 offset:4096
  v_mfma_f32_16x16x32_bf16 v[196:199], v[44:47], v[60:63], v[196:199]
  ds_read_b128 v[60:63], v7 offset:2048
  v_mfma_f32_16x16x32_bf16 v[196:199], v[28:31], v[56:59], v[196:199]
  ds_read_b128 v[56:59], v5 offset:2048
  v_mfma_f32_16x16x32_bf16 v[216:219], v[32:35], v[76:79], v[216:219]
  v_mfma_f32_16x16x32_bf16 v[216:219], v[16:19], v[72:75], v[216:219]
  v_mfma_f32_16x16x32_bf16 v[232:235], v[16:19], v[80:83], v[232:235]
  ds_read_b64_tr_b16 v[16:17], v1 offset:0
  v_mfma_f32_16x16x32_bf16 v[232:235], v[32:35], v[84:87], v[232:235]
  ds_read_b64_tr_b16 v[18:19], v1 offset:1024
  v_mfma_f32_16x16x32_bf16 v[236:239], v[36:39], v[84:87], v[236:239]
  ds_read_b64_tr_b16 v[32:33], v1 offset:8192
  v_mfma_f32_16x16x32_bf16 v[236:239], v[20:23], v[80:83], v[236:239]
  ds_read_b64_tr_b16 v[34:35], v1 offset:9216
  v_mfma_f32_16x16x32_bf16 v[220:223], v[20:23], v[72:75], v[220:223]
  ds_read_b64_tr_b16 v[20:21], v2 offset:0
  v_mfma_f32_16x16x32_bf16 v[220:223], v[36:39], v[76:79], v[220:223]
  ds_read_b64_tr_b16 v[22:23], v2 offset:1024
  v_mfma_f32_16x16x32_bf16 v[224:227], v[40:43], v[76:79], v[224:227]
  ds_read_b64_tr_b16 v[36:37], v2 offset:8192
  v_mfma_f32_16x16x32_bf16 v[224:227], v[24:27], v[72:75], v[224:227]
  ds_read_b64_tr_b16 v[38:39], v2 offset:9216
  v_mfma_f32_16x16x32_bf16 v[240:243], v[24:27], v[80:83], v[240:243]
  ds_read_b64_tr_b16 v[24:25], v3 offset:0
  v_mfma_f32_16x16x32_bf16 v[240:243], v[40:43], v[84:87], v[240:243]
  ds_read_b64_tr_b16 v[26:27], v3 offset:1024
  v_mfma_f32_16x16x32_bf16 v[244:247], v[44:47], v[84:87], v[244:247]
  ds_read_b64_tr_b16 v[40:41], v3 offset:8192
  v_mfma_f32_16x16x32_bf16 v[244:247], v[28:31], v[80:83], v[244:247]
  ds_read_b64_tr_b16 v[42:43], v3 offset:9216
  v_mfma_f32_16x16x32_bf16 v[228:231], v[28:31], v[72:75], v[228:231]
  ds_read_b64_tr_b16 v[28:29], v4 offset:0
  s_waitcnt lgkmcnt(9)
  v_mfma_f32_16x16x32_bf16 v[228:231], v[44:47], v[76:79], v[228:231]
  s_nop 0
  ds_read_b64_tr_b16 v[30:31], v4 offset:1024
  v_mfma_f32_16x16x32_bf16 v[88:91], v[16:19], v[48:51], v[88:91]
  ds_read_b64_tr_b16 v[44:45], v4 offset:8192
  v_mfma_f32_16x16x32_bf16 v[88:91], v[32:35], v[52:55], v[88:91]
  ds_read_b64_tr_b16 v[46:47], v4 offset:9216
  v_mfma_f32_16x16x32_bf16 v[104:107], v[32:35], v[60:63], v[104:107]
  ds_read_b128 v[72:75], v5 offset:6144
  s_waitcnt lgkmcnt(9)
  v_mfma_f32_16x16x32_bf16 v[104:107], v[16:19], v[56:59], v[104:107]
  s_nop 0
  ds_read_b128 v[76:79], v7 offset:6144
  v_mfma_f32_16x16x32_bf16 v[108:111], v[20:23], v[56:59], v[108:111]
  ds_read_b128 v[80:83], v5 offset:8192
  v_mfma_f32_16x16x32_bf16 v[108:111], v[36:39], v[60:63], v[108:111]
  ds_read_b128 v[84:87], v7 offset:8192
  v_mfma_f32_16x16x32_bf16 v[92:95], v[36:39], v[52:55], v[92:95]
  s_waitcnt lgkmcnt(8)
  v_mfma_f32_16x16x32_bf16 v[92:95], v[20:23], v[48:51], v[92:95]
  s_nop 0
  v_mfma_f32_16x16x32_bf16 v[96:99], v[24:27], v[48:51], v[96:99]
  v_xor_b32 v1, 16384, v1
  v_mfma_f32_16x16x32_bf16 v[96:99], v[40:43], v[52:55], v[96:99]
  v_xor_b32 v2, 16384, v2
  v_mfma_f32_16x16x32_bf16 v[112:115], v[40:43], v[60:63], v[112:115]
  v_xor_b32 v3, 16384, v3
  s_waitcnt lgkmcnt(4)
  v_mfma_f32_16x16x32_bf16 v[112:115], v[24:27], v[56:59], v[112:115]
  s_nop 0
  v_xor_b32 v4, 16384, v4
  v_mfma_f32_16x16x32_bf16 v[116:119], v[28:31], v[56:59], v[116:119]
  ds_read_b128 v[56:59], v5 offset:12288
  v_mfma_f32_16x16x32_bf16 v[116:119], v[44:47], v[60:63], v[116:119]
  ds_read_b128 v[60:63], v7 offset:12288
  v_mfma_f32_16x16x32_bf16 v[100:103], v[44:47], v[52:55], v[100:103]
  ds_read_b128 v[52:55], v7 offset:10240
  v_mfma_f32_16x16x32_bf16 v[100:103], v[28:31], v[48:51], v[100:103]
  ds_read_b128 v[48:51], v5 offset:10240
  v_mfma_f32_16x16x32_bf16 v[120:123], v[16:19], v[64:67], v[120:123]
  s_waitcnt lgkmcnt(6)
  v_mfma_f32_16x16x32_bf16 v[120:123], v[32:35], v[68:71], v[120:123]
  v_mfma_f32_16x16x32_bf16 v[136:139], v[32:35], v[76:79], v[136:139]
  v_mfma_f32_16x16x32_bf16 v[136:139], v[16:19], v[72:75], v[136:139]
  v_mfma_f32_16x16x32_bf16 v[140:143], v[20:23], v[72:75], v[140:143]
  v_mfma_f32_16x16x32_bf16 v[140:143], v[36:39], v[76:79], v[140:143]
  s_nop 0
  v_mfma_f32_16x16x32_bf16 v[124:127], v[36:39], v[68:71], v[124:127]
  v_mfma_f32_16x16x32_bf16 v[124:127], v[20:23], v[64:67], v[124:127]
  v_mfma_f32_16x16x32_bf16 v[128:131], v[24:27], v[64:67], v[128:131]
  v_mfma_f32_16x16x32_bf16 v[128:131], v[40:43], v[68:71], v[128:131]
  v_mfma_f32_16x16x32_bf16 v[144:147], v[40:43], v[76:79], v[144:147]
  v_mfma_f32_16x16x32_bf16 v[144:147], v[24:27], v[72:75], v[144:147]
  v_mfma_f32_16x16x32_bf16 v[148:151], v[28:31], v[72:75], v[148:151]
  ds_read_b128 v[72:75], v5 offset:16384
  v_mfma_f32_16x16x32_bf16 v[148:151], v[44:47], v[76:79], v[148:151]
  ds_read_b128 v[76:79], v7 offset:16384
  v_mfma_f32_16x16x32_bf16 v[132:135], v[44:47], v[68:71], v[132:135]
  ds_read_b128 v[68:71], v7 offset:14336
  s_waitcnt lgkmcnt(7)
  v_mfma_f32_16x16x32_bf16 v[132:135], v[28:31], v[64:67], v[132:135]
  ds_read_b128 v[64:67], v5 offset:14336
  v_mfma_f32_16x16x32_bf16 v[152:155], v[16:19], v[80:83], v[152:155]
  s_waitcnt lgkmcnt(4)
  v_mfma_f32_16x16x32_bf16 v[152:155], v[32:35], v[84:87], v[152:155]
  v_mfma_f32_16x16x32_bf16 v[168:171], v[32:35], v[52:55], v[168:171]
  v_mfma_f32_16x16x32_bf16 v[168:171], v[16:19], v[48:51], v[168:171]
  v_mfma_f32_16x16x32_bf16 v[172:175], v[20:23], v[48:51], v[172:175]
  v_mfma_f32_16x16x32_bf16 v[172:175], v[36:39], v[52:55], v[172:175]
  v_mfma_f32_16x16x32_bf16 v[156:159], v[36:39], v[84:87], v[156:159]
  v_mfma_f32_16x16x32_bf16 v[156:159], v[20:23], v[80:83], v[156:159]
  v_mfma_f32_16x16x32_bf16 v[160:163], v[24:27], v[80:83], v[160:163]
  v_mfma_f32_16x16x32_bf16 v[160:163], v[40:43], v[84:87], v[160:163]
  v_mfma_f32_16x16x32_bf16 v[176:179], v[40:43], v[52:55], v[176:179]
  v_mfma_f32_16x16x32_bf16 v[176:179], v[24:27], v[48:51], v[176:179]
  v_mfma_f32_16x16x32_bf16 v[180:183], v[28:31], v[48:51], v[180:183]
  v_mfma_f32_16x16x32_bf16 v[180:183], v[44:47], v[52:55], v[180:183]
  v_mfma_f32_16x16x32_bf16 v[164:167], v[44:47], v[84:87], v[164:167]
  ds_read_b128 v[84:87], v7 offset:18432
  v_mfma_f32_16x16x32_bf16 v[164:167], v[28:31], v[80:83], v[164:167]
  ds_read_b128 v[80:83], v5 offset:18432
  v_mfma_f32_16x16x32_bf16 v[184:187], v[16:19], v[56:59], v[184:187]
  s_waitcnt lgkmcnt(2)
  s_add_u32 s72, s72, 1
  s_cmp_lt_u32 s72, 8
  v_mfma_f32_16x16x32_bf16 v[184:187], v[32:35], v[60:63], v[184:187]
  v_mfma_f32_16x16x32_bf16 v[200:203], v[32:35], v[68:71], v[200:203]
  v_mfma_f32_16x16x32_bf16 v[200:203], v[16:19], v[64:67], v[200:203]
  v_mfma_f32_16x16x32_bf16 v[204:207], v[20:23], v[64:67], v[204:207]
  s_nop 0
  v_mfma_f32_16x16x32_bf16 v[204:207], v[36:39], v[68:71], v[204:207]
  s_waitcnt lgkmcnt(0)
  s_barrier
  v_mfma_f32_16x16x32_bf16 v[188:191], v[36:39], v[60:63], v[188:191]
  ds_read_b128 v[48:51], v5 offset:40960
  v_mfma_f32_16x16x32_bf16 v[188:191], v[20:23], v[56:59], v[188:191]
  ds_read_b128 v[52:55], v7 offset:40960
  v_mfma_f32_16x16x32_bf16 v[192:195], v[24:27], v[56:59], v[192:195]
  v_mfma_f32_16x16x32_bf16 v[192:195], v[40:43], v[60:63], v[192:195]
  v_mfma_f32_16x16x32_bf16 v[208:211], v[40:43], v[68:71], v[208:211]
  v_mfma_f32_16x16x32_bf16 v[208:211], v[24:27], v[64:67], v[208:211]
  v_mfma_f32_16x16x32_bf16 v[212:215], v[28:31], v[64:67], v[212:215]
  ds_read_b128 v[64:67], v5 offset:45056
  v_mfma_f32_16x16x32_bf16 v[212:215], v[44:47], v[68:71], v[212:215]
  ds_read_b128 v[68:71], v7 offset:45056
  v_mfma_f32_16x16x32_bf16 v[196:199], v[44:47], v[60:63], v[196:199]
  ds_read_b128 v[60:63], v7 offset:43008
  v_mfma_f32_16x16x32_bf16 v[196:199], v[28:31], v[56:59], v[196:199]
  ds_read_b128 v[56:59], v5 offset:43008
  v_mfma_f32_16x16x32_bf16 v[216:219], v[32:35], v[76:79], v[216:219]
  v_mfma_f32_16x16x32_bf16 v[216:219], v[16:19], v[72:75], v[216:219]
  v_mfma_f32_16x16x32_bf16 v[232:235], v[16:19], v[80:83], v[232:235]
  ds_read_b64_tr_b16 v[16:17], v1 offset:0
  v_mfma_f32_16x16x32_bf16 v[232:235], v[32:35], v[84:87], v[232:235]
  ds_read_b64_tr_b16 v[18:19], v1 offset:1024
  v_mfma_f32_16x16x32_bf16 v[236:239], v[36:39], v[84:87], v[236:239]
  ds_read_b64_tr_b16 v[32:33], v1 offset:8192
  v_mfma_f32_16x16x32_bf16 v[236:239], v[20:23], v[80:83], v[236:239]
  ds_read_b64_tr_b16 v[34:35], v1 offset:9216
  v_mfma_f32_16x16x32_bf16 v[220:223], v[20:23], v[72:75], v[220:223]
  ds_read_b64_tr_b16 v[20:21], v2 offset:0
  v_mfma_f32_16x16x32_bf16 v[220:223], v[36:39], v[76:79], v[220:223]
  ds_read_b64_tr_b16 v[22:23], v2 offset:1024
  v_mfma_f32_16x16x32_bf16 v[224:227], v[40:43], v[76:79], v[224:227]
  ds_read_b64_tr_b16 v[36:37], v2 offset:8192
  v_mfma_f32_16x16x32_bf16 v[224:227], v[24:27], v[72:75], v[224:227]
  ds_read_b64_tr_b16 v[38:39], v2 offset:9216
  v_mfma_f32_16x16x32_bf16 v[240:243], v[24:27], v[80:83], v[240:243]
  ds_read_b64_tr_b16 v[24:25], v3 offset:0
  v_mfma_f32_16x16x32_bf16 v[240:243], v[40:43], v[84:87], v[240:243]
  ds_read_b64_tr_b16 v[26:27], v3 offset:1024
  v_mfma_f32_16x16x32_bf16 v[244:247], v[44:47], v[84:87], v[244:247]
  ds_read_b64_tr_b16 v[40:41], v3 offset:8192
  v_mfma_f32_16x16x32_bf16 v[244:247], v[28:31], v[80:83], v[244:247]
  s_nop 0
  ds_read_b64_tr_b16 v[42:43], v3 offset:9216
  v_mfma_f32_16x16x32_bf16 v[228:231], v[28:31], v[72:75], v[228:231]
  ds_read_b64_tr_b16 v[28:29], v4 offset:0
  s_waitcnt lgkmcnt(9)
  v_mfma_f32_16x16x32_bf16 v[228:231], v[44:47], v[76:79], v[228:231]
  ds_read_b64_tr_b16 v[30:31], v4 offset:1024
  s_cbranch_scc1 L_dnn_loop0
L_tail:
  v_mfma_f32_16x16x32_bf16 v[88:91], v[16:19], v[48:51], v[88:91]
  ds_read_b64_tr_b16 v[44:45], v4 offset:8192
  v_mfma_f32_16x16x32_bf16 v[88:91], v[32:35], v[52:55], v[88:91]
  ds_read_b64_tr_b16 v[46:47], v4 offset:9216
  v_mfma_f32_16x16x32_bf16 v[104:107], v[32:35], v[60:63], v[104:107]
  ds_read_b128 v[72:75], v5 offset:47104
  s_waitcnt lgkmcnt(9)
  v_mfma_f32_16x16x32_bf16 v[104:107], v[16:19], v[56:59], v[104:107]
  ds_read_b128 v[76:79], v7 offset:47104
  v_mfma_f32_16x16x32_bf16 v[108:111], v[20:23], v[56:59], v[108:111]
  ds_read_b128 v[80:83], v5 offset:49152
  v_mfma_f32_16x16x32_bf16 v[108:111], v[36:39], v[60:63], v[108:111]
  ds_read_b128 v[84:87], v7 offset:49152
  v_mul_f32 v11, v88, v88
  v_mfma_f32_16x16x32_bf16 v[92:95], v[36:39], v[52:55], v[92:95]
  s_waitcnt lgkmcnt(8)
  v_mul_f32 v248, v89, v89
  v_mul_f32 v249, v90, v90
  v_mfma_f32_16x16x32_bf16 v[92:95], v[20:23], v[48:51], v[92:95]
  v_mul_f32_e64 v250, v91, v91
  v_fma_f32 v11, v11, v14, v12
  v_mfma_f32_16x16x32_bf16 v[96:99], v[24:27], v[48:51], v[96:99]
  v_fma_f32 v248, v248, v14, v12
  v_fma_f32 v249, v249, v14, v12
  v_mfma_f32_16x16x32_bf16 v[96:99], v[40:43], v[52:55], v[96:99]
  v_fma_f32 v250, v250, v14, v12
  v_mul_f32 v11, v11, v88
  v_mfma_f32_16x16x32_bf16 v[112:115], v[40:43], v[60:63], v[112:115]
  s_waitcnt lgkmcnt(4)
  v_mul_f32 v248, v248, v89
  v_mul_f32 v249, v249, v90
  v_mfma_f32_16x16x32_bf16 v[112:115], v[24:27], v[56:59], v[112:115]
  v_mul_f32_e64 v250, v250, v91
  v_mfma_f32_16x16x32_bf16 v[116:119], v[28:31], v[56:59], v[116:119]
  ds_read_b128 v[56:59], v5 offset:53248
  v_mfma_f32_16x16x32_bf16 v[116:119], v[44:47], v[60:63], v[116:119]
  ds_read_b128 v[60:63], v7 offset:53248
  v_mfma_f32_16x16x32_bf16 v[100:103], v[44:47], v[52:55], v[100:103]
  ds_read_b128 v[52:55], v7 offset:51200
  v_mfma_f32_16x16x32_bf16 v[100:103], v[28:31], v[48:51], v[100:103]
  ds_read_b128 v[48:51], v5 offset:51200
  v_mfma_f32_16x16x32_bf16 v[120:123], v[16:19], v[64:67], v[120:123]
  s_waitcnt lgkmcnt(6)
  v_exp_f32 v11, v11
  v_mfma_f32_16x16x32_bf16 v[120:123], v[32:35], v[68:71], v[120:123]
  v_exp_f32 v248, v248
  v_mfma_f32_16x16x32_bf16 v[136:139], v[32:35], v[76:79], v[136:139]
  v_exp_f32 v249, v249
  v_mfma_f32_16x16x32_bf16 v[136:139], v[16:19], v[72:75], v[136:139]
  v_exp_f32 v250, v250
  v_mfma_f32_16x16x32_bf16 v[140:143], v[20:23], v[72:75], v[140:143]
  v_add_f32 v11, 1.0, v11
  v_add_f32 v248, 1.0, v248
  v_mfma_f32_16x16x32_bf16 v[140:143], v[36:39], v[76:79], v[140:143]
  v_add_f32 v249, 1.0, v249
  v_add_f32 v250, 1.0, v250
  v_mfma_f32_16x16x32_bf16 v[124:127], v[36:39], v[68:71], v[124:127]
  v_rcp_f32 v11, v11
  v_mfma_f32_16x16x32_bf16 v[124:127], v[20:23], v[64:67], v[124:127]
  v_rcp_f32 v248, v248
  v_mfma_f32_16x16x32_bf16 v[128:131], v[24:27], v[64:67], v[128:131]
  v_rcp_f32 v249, v249
  v_mfma_f32_16x16x32_bf16 v[128:131], v[40:43], v[68:71], v[128:131]
  v_rcp_f32 v250, v250
  v_mfma_f32_16x16x32_bf16 v[144:147], v[40:43], v[76:79], v[144:147]
  v_mul_f32 v88, v88, v11
  v_mul_f32 v89, v89, v248
  v_mfma_f32_16x16x32_bf16 v[144:147], v[24:27], v[72:75], v[144:147]
  v_mul_f32 v90, v90, v249
  v_mul_f32 v91, v91, v250
  v_mfma_f32_16x16x32_bf16 v[148:151], v[28:31], v[72:75], v[148:151]
  ds_read_b128 v[72:75], v5 offset:57344
  v_mul_f32 v11, v92, v92
  v_mfma_f32_16x16x32_bf16 v[148:151], v[44:47], v[76:79], v[148:151]
  ds_read_b128 v[76:79], v7 offset:57344
  v_mul_f32_e64 v248, v93, v93
  v_mfma_f32_16x16x32_bf16 v[132:135], v[44:47], v[68:71], v[132:135]
  ds_read_b128 v[68:71], v7 offset:55296
  s_waitcnt lgkmcnt(7)
  v_mul_f32 v249, v94, v94
  v_mfma_f32_16x16x32_bf16 v[132:135], v[28:31], v[64:67], v[132:135]
  ds_read_b128 v[64:67], v5 offset:55296
  v_mul_f32 v250, v95, v95
  v_mfma_f32_16x16x32_bf16 v[152:155], v[16:19], v[80:83], v[152:155]
  s_waitcnt lgkmcnt(4)
  v_fma_f32 v11, v11, v14, v12
  v_fma_f32 v248, v248, v14, v12
  v_mfma_f32_16x16x32_bf16 v[152:155], v[32:35], v[84:87], v[152:155]
  v_fma_f32 v249, v249, v14, v12
  v_fma_f32 v250, v250, v14, v12
  v_mfma_f32_16x16x32_bf16 v[168:171], v[32:35], v[52:55], v[168:171]
  v_mul_f32 v11, v11, v92
  v_mul_f32 v248, v248, v93
  v_mfma_f32_16x16x32_bf16 v[168:171], v[16:19], v[48:51], v[168:171]
  v_mul_f32 v249, v249, v94
  v_mul_f32 v250, v250, v95
  v_mfma_f32_16x16x32_bf16 v[172:175], v[20:23], v[48:51], v[172:175]
  v_exp_f32 v11, v11
  v_mfma_f32_16x16x32_bf16 v[172:175], v[36:39], v[52:55], v[172:175]
  v_exp_f32 v248, v248
  v_mfma_f32_16x16x32_bf16 v[156:159], v[36:39], v[84:87], v[156:159]
  v_exp_f32 v249, v249
  v_mfma_f32_16x16x32_bf16 v[156:159], v[20:23], v[80:83], v[156:159]
  v_exp_f32 v250, v250
  v_mfma_f32_16x16x32_bf16 v[160:163], v[24:27], v[80:83], v[160:163]
  v_add_f32 v11, 1.0, v11
  v_add_f32 v248, 1.0, v248
  v_mfma_f32_16x16x32_bf16 v[160:163], v[40:43], v[84:87], v[160:163]
  v_add_f32 v249, 1.0, v249
  v_add_f32 v250, 1.0, v250
  v_mfma_f32_16x16x32_bf16 v[176:179], v[40:43], v[52:55], v[176:179]
  v_rcp_f32 v11, v11
  v_mfma_f32_16x16x32_bf16 v[176:179], v[24:27], v[48:51], v[176:179]
  v_rcp_f32 v248, v248
  v_mfma_f32_16x16x32_bf16 v[180:183], v[28:31], v[48:51], v[180:183]
  v_rcp_f32 v249, v249
  v_mfma_f32_16x16x32_bf16 v[180:183], v[44:47], v[52:55], v[180:183]
  v_rcp_f32 v250, v250
  v_mfma_f32_16x16x32_bf16 v[164:167], v[44:47], v[84:87], v[164:167]
  ds_read_b128 v[84:87], v7 offset:59392
  v_mul_f32 v92, v92, v11
  v_mfma_f32_16x16x32_bf16 v[164:167], v[28:31], v[80:83], v[164:167]
  ds_read_b128 v[80:83], v5 offset:59392
  v_mul_f32 v93, v93, v248
  v_mfma_f32_16x16x32_bf16 v[184:187], v[16:19], v[56:59], v[184:187]
  s_waitcnt lgkmcnt(2)
  v_mul_f32 v94, v94, v249
  v_mul_f32_e64 v95, v95, v250
  v_mfma_f32_16x16x32_bf16 v[184:187], v[32:35], v[60:63], v[184:187]
  v_mul_f32 v11, v96, v96
  v_mul_f32 v248, v97, v97
  v_mfma_f32_16x16x32_bf16 v[200:203], v[32:35], v[68:71], v[200:203]
  v_mul_f32 v249, v98, v98
  v_mul_f32 v250, v99, v99
  v_mfma_f32_16x16x32_bf16 v[200:203], v[16:19], v[64:67], v[200:203]
  v_fma_f32 v11, v11, v14, v12
  v_fma_f32 v248, v248, v14, v12
  v_mfma_f32_16x16x32_bf16 v[204:207], v[20:23], v[64:67], v[204:207]
  v_fma_f32 v249, v249, v14, v12
  v_fma_f32 v250, v250, v14, v12
  v_mfma_f32_16x16x32_bf16 v[204:207], v[36:39], v[68:71], v[204:207]
  v_mul_f32 v11, v11, v96
  v_mul_f32 v248, v248, v97
  v_mfma_f32_16x16x32_bf16 v[188:191], v[36:39], v[60:63], v[188:191]
  v_mul_f32 v249, v249, v98
  v_mul_f32 v250, v250, v99
  v_mfma_f32_16x16x32_bf16 v[188:191], v[20:23], v[56:59], v[188:191]
  v_exp_f32_e64 v11, v11
  v_mfma_f32_16x16x32_bf16 v[192:195], v[24:27], v[56:59], v[192:195]
  v_exp_f32 v248, v248
  v_mfma_f32_16x16x32_bf16 v[192:195], v[40:43], v[60:63], v[192:195]
  v_exp_f32 v249, v249
  v_mfma_f32_16x16x32_bf16 v[208:211], v[40:43], v[68:71], v[208:211]
  v_exp_f32 v250, v250
  v_mfma_f32_16x16x32_bf16 v[208:211], v[24:27], v[64:67], v[208:211]
  v_add_f32 v11, 1.0, v11
  v_add_f32 v248, 1.0, v248
  v_mfma_f32_16x16x32_bf16 v[212:215], v[28:31], v[64:67], v[212:215]
  v_add_f32 v249, 1.0, v249
  v_add_f32 v250, 1.0, v250
  v_mfma_f32_16x16x32_bf16 v[212:215], v[44:47], v[68:71], v[212:215]
  v_rcp_f32 v11, v11
  v_mfma_f32_16x16x32_bf16 v[196:199], v[44:47], v[60:63], v[196:199]
  v_rcp_f32 v248, v248
  v_mfma_f32_16x16x32_bf16 v[196:199], v[28:31], v[56:59], v[196:199]
  v_rcp_f32 v249, v249
  v_mfma_f32_16x16x32_bf16 v[216:219], v[32:35], v[76:79], v[216:219]
  s_waitcnt lgkmcnt(0)
  v_rcp_f32 v250, v250
  v_mfma_f32_16x16x32_bf16 v[216:219], v[16:19], v[72:75], v[216:219]
  v_mul_f32 v96, v96, v11
  v_mul_f32 v97, v97, v248
  v_mfma_f32_16x16x32_bf16 v[232:235], v[16:19], v[80:83], v[232:235]
  v_mul_f32 v98, v98, v249
  v_mul_f32 v99, v99, v250
  v_mfma_f32_16x16x32_bf16 v[232:235], v[32:35], v[84:87], v[232:235]
  v_mul_f32 v11, v100, v100
  v_mul_f32 v248, v101, v101
  v_mfma_f32_16x16x32_bf16 v[236:239], v[36:39], v[84:87], v[236:239]
  v_mul_f32 v249, v102, v102
  v_mul_f32 v250, v103, v103
  v_mfma_f32_16x16x32_bf16 v[236:239], v[20:23], v[80:83], v[236:239]
  v_fma_f32 v11, v11, v14, v12
  v_fma_f32 v248, v248, v14, v12
  v_mfma_f32_16x16x32_bf16 v[220:223], v[20:23], v[72:75], v[220:223]
  v_fma_f32 v249, v249, v14, v12
  v_fma_f32 v250, v250, v14, v12
  v_mfma_f32_16x16x32_bf16 v[220:223], v[36:39], v[76:79], v[220:223]
  v_mul_f32 v11, v11, v100
  v_mul_f32 v248, v248, v101
  v_mfma_f32_16x16x32_bf16 v[224:227], v[40:43], v[76:79], v[224:227]
  v_mul_f32 v249, v249, v102
  v_mul_f32 v250, v250, v103
  v_mfma_f32_16x16x32_bf16 v[224:227], v[24:27], v[72:75], v[224:227]
  v_exp_f32 v11, v11
  v_mfma_f32_16x16x32_bf16 v[240:243], v[24:27], v[80:83], v[240:243]
  v_exp_f32 v248, v248
  v_mfma_f32_16x16x32_bf16 v[240:243], v[40:43], v[84:87], v[240:243]
  v_exp_f32 v249, v249
  v_mfma_f32_16x16x32_bf16 v[244:247], v[44:47], v[84:87], v[244:247]
  v_exp_f32 v250, v250
  v_mfma_f32_16x16x32_bf16 v[244:247], v[28:31], v[80:83], v[244:247]
  v_add_f32 v11, 1.0, v11
  v_add_f32 v248, 1.0, v248
  v_mfma_f32_16x16x32_bf16 v[228:231], v[28:31], v[72:75], v[228:231]
  v_add_f32 v249, 1.0, v249
  v_add_f32 v250, 1.0, v250
  v_mfma_f32_16x16x32_bf16 v[228:231], v[44:47], v[76:79], v[228:231]
  v_rcp_f32 v11, v11
  v_rcp_f32 v248, v248
  v_rcp_f32 v249, v249
  v_rcp_f32 v250, v250
  v_mul_f32 v100, v100, v11
  v_mul_f32 v101, v101, v248
  v_mul_f32 v102, v102, v249
  v_mul_f32 v103, v103, v250
  ds_read_b64 v[18:19], v9 offset:256
  ds_read_b64 v[22:23], v9 offset:288
  ds_read_b64 v[26:27], v9 offset:320
  ds_read_b64 v[30:31], v9 offset:352
  v_mov_b32 v248, 1.0
  v_mov_b32 v249, 1.0
L_epi:
  v_mov_b32 v84, 0xc1c00000
  v_mov_b32 v85, 0xc1c00000
  v_mov_b32 v86, 0x4b800000
  v_mov_b32 v87, 0x4b800000
  v_pk_mul_f32 v[52:53], v[104:105], v[104:105]
  v_pk_mul_f32 v[56:57], v[106:107], v[106:107]
  v_pk_mul_f32 v[60:61], v[108:109], v[108:109]
  v_pk_mul_f32 v[64:65], v[110:111], v[110:111]
  v_pk_mul_f32 v[68:69], v[120:121], v[120:121]
  v_pk_mul_f32 v[72:73], v[122:123], v[122:123]
  v_pk_mul_f32 v[76:77], v[124:125], v[124:125]
  v_pk_mul_f32 v[80:81], v[126:127], v[126:127]
  v_pk_fma_f32 v[52:53], v[52:53], v[14:15], v[12:13]
  v_pk_fma_f32 v[56:57], v[56:57], v[14:15], v[12:13]
  v_pk_fma_f32 v[60:61], v[60:61], v[14:15], v[12:13]
  v_pk_fma_f32 v[64:65], v[64:65], v[14:15], v[12:13]
  v_pk_fma_f32 v[68:69], v[68:69], v[14:15], v[12:13]
  v_pk_fma_f32 v[72:73], v[72:73], v[14:15], v[12:13]
  v_pk_fma_f32 v[76:77], v[76:77], v[14:15], v[12:13]
  v_pk_fma_f32 v[80:81], v[80:81], v[14:15], v[12:13]
  v_pk_fma_f32 v[52:53], v[52:53], v[104:105], v[84:85]
  v_pk_fma_f32 v[56:57], v[56:57], v[106:107], v[84:85]
  v_pk_fma_f32 v[60:61], v[60:61], v[108:109], v[84:85]
  v_pk_fma_f32 v[64:65], v[64:65], v[110:111], v[84:85]
  v_pk_fma_f32 v[68:69], v[68:69], v[120:121], v[84:85]
  v_pk_fma_f32 v[72:73], v[72:73], v[122:123], v[84:85]
  v_pk_fma_f32 v[76:77], v[76:77], v[124:125], v[84:85]
  v_pk_fma_f32 v[80:81], v[80:81], v[126:127], v[84:85]
  v_exp_f32 v52, v52 clamp
  v_exp_f32 v53, v53 clamp
  v_exp_f32 v56, v56 clamp
  v_exp_f32 v57, v57 clamp
  v_exp_f32 v60, v60 clamp
  v_exp_f32 v61, v61 clamp
  v_exp_f32 v64, v64 clamp
  v_exp_f32 v65, v65 clamp
  v_exp_f32 v68, v68 clamp
  v_exp_f32 v69, v69 clamp
  v_exp_f32 v72, v72 clamp
  v_exp_f32 v73, v73 clamp
  v_exp_f32 v76, v76 clamp
  v_exp_f32 v77, v77 clamp
  v_exp_f32 v80, v80 clamp
  v_exp_f32 v81, v81 clamp
  s_waitcnt lgkmcnt(3)
  v_lshlrev_b32 v16, 16, v18
  v_and_b32 v17, 0xffff0000, v18
  v_lshlrev_b32 v18, 16, v19
  v_and_b32 v19, 0xffff0000, v19
  s_waitcnt lgkmcnt(2)
  v_lshlrev_b32 v20, 16, v22
  v_and_b32 v21, 0xffff0000, v22
  v_lshlrev_b32 v22, 16, v23
  v_and_b32 v23, 0xffff0000, v23
  s_waitcnt lgkmcnt(1)
  v_lshlrev_b32 v24, 16, v26
  v_and_b32 v25, 0xffff0000, v26
  v_lshlrev_b32 v26, 16, v27
  v_and_b32 v27, 0xffff0000, v27
  s_waitcnt lgkmcnt(0)
  v_lshlrev_b32 v28, 16, v30
  v_and_b32 v29, 0xffff0000, v30
  v_lshlrev_b32 v30, 16, v31
  v_and_b32 v31, 0xffff0000, v31
  v_pk_mul_f32 v[54:55], v[104:105], v[16:17]
  v_pk_mul_f32 v[58:59], v[106:107], v[18:19]
  v_pk_mul_f32 v[62:63], v[108:109], v[20:21]
  v_pk_mul_f32 v[66:67], v[110:111], v[22:23]
  v_pk_mul_f32 v[70:71], v[120:121], v[16:17]
  v_pk_mul_f32 v[74:75], v[122:123], v[18:19]
  v_pk_mul_f32 v[78:79], v[124:125], v[20:21]
  v_pk_mul_f32 v[82:83], v[126:127], v[22:23]
  v_pk_fma_f32 v[52:53], v[52:53], v[86:87], v[248:249]
  v_pk_fma_f32 v[56:57], v[56:57], v[86:87], v[248:249]
  v_pk_fma_f32 v[60:61], v[60:61], v[86:87], v[248:249]
  v_pk_fma_f32 v[64:65], v[64:65], v[86:87], v[248:249]
  v_pk_fma_f32 v[68:69], v[68:69], v[86:87], v[248:249]
  v_pk_fma_f32 v[72:73], v[72:73], v[86:87], v[248:249]
  v_pk_fma_f32 v[76:77], v[76:77], v[86:87], v[248:249]
  v_pk_fma_f32 v[80:81], v[80:81], v[86:87], v[248:249]
  v_pk_mul_f32 v[54:55], v[54:55], v[56:57]
  v_pk_mul_f32 v[62:63], v[62:63], v[64:65]
  v_pk_mul_f32 v[70:71], v[70:71], v[72:73]
  v_pk_mul_f32 v[78:79], v[78:79], v[80:81]
  v_pk_fma_f32 v[54:55], v[58:59], v[52:53], v[54:55]
  v_pk_fma_f32 v[62:63], v[66:67], v[60:61], v[62:63]
  v_pk_fma_f32 v[70:71], v[74:75], v[68:69], v[70:71]
  v_pk_fma_f32 v[78:79], v[82:83], v[76:77], v[78:79]
  v_pk_mul_f32 v[52:53], v[52:53], v[56:57]
  v_pk_mul_f32 v[60:61], v[60:61], v[64:65]
  v_pk_mul_f32 v[68:69], v[68:69], v[72:73]
  v_pk_mul_f32 v[76:77], v[76:77], v[80:81]
  v_pk_mul_f32 v[54:55], v[54:55], v[60:61]
  v_pk_mul_f32 v[70:71], v[70:71], v[76:77]
  v_pk_fma_f32 v[54:55], v[62:63], v[52:53], v[54:55]
  v_pk_fma_f32 v[70:71], v[78:79], v[68:69], v[70:71]
  v_pk_mul_f32 v[52:53], v[52:53], v[60:61]
  v_pk_mul_f32 v[68:69], v[68:69], v[76:77]
  v_rcp_f32 v52, v52
  v_rcp_f32 v53, v53
  v_rcp_f32 v68, v68
  v_rcp_f32 v69, v69
  v_pk_mul_f32 v[34:35], v[52:53], v[54:55]
  v_pk_mul_f32 v[36:37], v[68:69], v[70:71]
  v_pk_mul_f32 v[52:53], v[112:113], v[112:113]
  v_pk_mul_f32 v[56:57], v[114:115], v[114:115]
  v_pk_mul_f32 v[60:61], v[116:117], v[116:117]
  v_pk_mul_f32 v[64:65], v[118:119], v[118:119]
  v_pk_mul_f32 v[68:69], v[128:129], v[128:129]
  v_pk_mul_f32 v[72:73], v[130:131], v[130:131]
  v_pk_mul_f32 v[76:77], v[132:133], v[132:133]
  v_pk_mul_f32 v[80:81], v[134:135], v[134:135]
  v_pk_fma_f32 v[52:53], v[52:53], v[14:15], v[12:13]
  v_pk_fma_f32 v[56:57], v[56:57], v[14:15], v[12:13]
  v_pk_fma_f32 v[60:61], v[60:61], v[14:15], v[12:13]
  v_pk_fma_f32 v[64:65], v[64:65], v[14:15], v[12:13]
  v_pk_fma_f32 v[68:69], v[68:69], v[14:15], v[12:13]
  v_pk_fma_f32 v[72:73], v[72:73], v[14:15], v[12:13]
  v_pk_fma_f32 v[76:77], v[76:77], v[14:15], v[12:13]
  v_pk_fma_f32 v[80:81], v[80:81], v[14:15], v[12:13]
  v_pk_fma_f32 v[52:53], v[52:53], v[112:113], v[84:85]
  v_pk_fma_f32 v[56:57], v[56:57], v[114:115], v[84:85]
  v_pk_fma_f32 v[60:61], v[60:61], v[116:117], v[84:85]
  v_pk_fma_f32 v[64:65], v[64:65], v[118:119], v[84:85]
  v_pk_fma_f32 v[68:69], v[68:69], v[128:129], v[84:85]
  v_pk_fma_f32 v[72:73], v[72:73], v[130:131], v[84:85]
  v_pk_fma_f32 v[76:77], v[76:77], v[132:133], v[84:85]
  v_pk_fma_f32 v[80:81], v[80:81], v[134:135], v[84:85]
  v_exp_f32 v52, v52 clamp
  v_exp_f32 v53, v53 clamp
  v_exp_f32 v56, v56 clamp
  v_exp_f32 v57, v57 clamp
  v_exp_f32 v60, v60 clamp
  v_exp_f32 v61, v61 clamp
  v_exp_f32 v64, v64 clamp
  v_exp_f32 v65, v65 clamp
  v_exp_f32 v68, v68 clamp
  v_exp_f32 v69, v69 clamp
  v_exp_f32 v72, v72 clamp
  v_exp_f32 v73, v73 clamp
  v_exp_f32 v76, v76 clamp
  v_exp_f32 v77, v77 clamp
  v_exp_f32 v80, v80 clamp
  v_exp_f32 v81, v81 clamp
  v_pk_mul_f32 v[54:55], v[112:113], v[24:25]
  v_pk_mul_f32 v[58:59], v[114:115], v[26:27]
  v_pk_mul_f32 v[62:63], v[116:117], v[28:29]
  v_pk_mul_f32 v[66:67], v[118:119], v[30:31]
  v_pk_mul_f32 v[70:71], v[128:129], v[24:25]
  v_pk_mul_f32 v[74:75], v[130:131], v[26:27]
  v_pk_mul_f32 v[78:79], v[132:133], v[28:29]
  v_pk_mul_f32 v[82:83], v[134:135], v[30:31]
  v_pk_fma_f32 v[52:53], v[52:53], v[86:87], v[248:249]
  v_pk_fma_f32 v[56:57], v[56:57], v[86:87], v[248:249]
  v_pk_fma_f32 v[60:61], v[60:61], v[86:87], v[248:249]
  v_pk_fma_f32 v[64:65], v[64:65], v[86:87], v[248:249]
  v_pk_fma_f32 v[68:69], v[68:69], v[86:87], v[248:249]
  v_pk_fma_f32 v[72:73], v[72:73], v[86:87], v[248:249]
  v_pk_fma_f32 v[76:77], v[76:77], v[86:87], v[248:249]
  v_pk_fma_f32 v[80:81], v[80:81], v[86:87], v[248:249]
  v_pk_mul_f32 v[54:55], v[54:55], v[56:57]
  v_pk_mul_f32 v[62:63], v[62:63], v[64:65]
  v_pk_mul_f32 v[70:71], v[70:71], v[72:73]
  v_pk_mul_f32 v[78:79], v[78:79], v[80:81]
  v_pk_fma_f32 v[54:55], v[58:59], v[52:53], v[54:55]
  v_pk_fma_f32 v[62:63], v[66:67], v[60:61], v[62:63]
  v_pk_fma_f32 v[70:71], v[74:75], v[68:69], v[70:71]
  v_pk_fma_f32 v[78:79], v[82:83], v[76:77], v[78:79]
  v_pk_mul_f32 v[52:53], v[52:53], v[56:57]
  v_pk_mul_f32 v[60:61], v[60:61], v[64:65]
  v_pk_mul_f32 v[68:69], v[68:69], v[72:73]
  v_pk_mul_f32 v[76:77], v[76:77], v[80:81]
  v_pk_mul_f32 v[54:55], v[54:55], v[60:61]
  v_pk_mul_f32 v[70:71], v[70:71], v[76:77]
  v_pk_fma_f32 v[54:55], v[62:63], v[52:53], v[54:55]
  v_pk_fma_f32 v[70:71], v[78:79], v[68:69], v[70:71]
  v_pk_mul_f32 v[52:53], v[52:53], v[60:61]
  v_pk_mul_f32 v[68:69], v[68:69], v[76:77]
  v_rcp_f32 v52, v52
  v_rcp_f32 v53, v53
  v_rcp_f32 v68, v68
  v_rcp_f32 v69, v69
  v_pk_fma_f32 v[34:35], v[52:53], v[54:55], v[34:35]
  v_pk_fma_f32 v[36:37], v[68:69], v[70:71], v[36:37]
  v_pk_mul_f32 v[52:53], v[136:137], v[136:137]
  v_pk_mul_f32 v[56:57], v[138:139], v[138:139]
  v_pk_mul_f32 v[60:61], v[140:141], v[140:141]
  v_pk_mul_f32 v[64:65], v[142:143], v[142:143]
  v_pk_mul_f32 v[68:69], v[152:153], v[152:153]
  v_pk_mul_f32 v[72:73], v[154:155], v[154:155]
  v_pk_mul_f32 v[76:77], v[156:157], v[156:157]
  v_pk_mul_f32 v[80:81], v[158:159], v[158:159]
  v_pk_fma_f32 v[52:53], v[52:53], v[14:15], v[12:13]
  v_pk_fma_f32 v[56:57], v[56:57], v[14:15], v[12:13]
  v_pk_fma_f32 v[60:61], v[60:61], v[14:15], v[12:13]
  v_pk_fma_f32 v[64:65], v[64:65], v[14:15], v[12:13]
  v_pk_fma_f32 v[68:69], v[68:69], v[14:15], v[12:13]
  v_pk_fma_f32 v[72:73], v[72:73], v[14:15], v[12:13]
  v_pk_fma_f32 v[76:77], v[76:77], v[14:15], v[12:13]
  v_pk_fma_f32 v[80:81], v[80:81], v[14:15], v[12:13]
  v_pk_fma_f32 v[52:53], v[52:53], v[136:137], v[84:85]
  v_pk_fma_f32 v[56:57], v[56:57], v[138:139], v[84:85]
  v_pk_fma_f32 v[60:61], v[60:61], v[140:141], v[84:85]
  v_pk_fma_f32 v[64:65], v[64:65], v[142:143], v[84:85]
  v_pk_fma_f32 v[68:69], v[68:69], v[152:153], v[84:85]
  v_pk_fma_f32 v[72:73], v[72:73], v[154:155], v[84:85]
  v_pk_fma_f32 v[76:77], v[76:77], v[156:157], v[84:85]
  v_pk_fma_f32 v[80:81], v[80:81], v[158:159], v[84:85]
  v_exp_f32 v52, v52 clamp
  v_exp_f32 v53, v53 clamp
  v_exp_f32 v56, v56 clamp
  v_exp_f32 v57, v57 clamp
  v_exp_f32 v60, v60 clamp
  v_exp_f32 v61, v61 clamp
  v_exp_f32 v64, v64 clamp
  v_exp_f32 v65, v65 clamp
  v_exp_f32 v68, v68 clamp
  v_exp_f32 v69, v69 clamp
  v_exp_f32 v72, v72 clamp
  v_exp_f32 v73, v73 clamp
  v_exp_f32 v76, v76 clamp
  v_exp_f32 v77, v77 clamp
  v_exp_f32 v80, v80 clamp
  v_exp_f32 v81, v81 clamp
  v_pk_mul_f32 v[54:55], v[136:137], v[16:17]
  v_pk_mul_f32 v[58:59], v[138:139], v[18:19]
  v_pk_mul_f32 v[62:63], v[140:141], v[20:21]
  v_pk_mul_f32 v[66:67], v[142:143], v[22:23]
  v_pk_mul_f32 v[70:71], v[152:153], v[16:17]
  v_pk_mul_f32 v[74:75], v[154:155], v[18:19]
  v_pk_mul_f32 v[78:79], v[156:157], v[20:21]
  v_pk_mul_f32 v[82:83], v[158:159], v[22:23]
  v_pk_fma_f32 v[52:53], v[52:53], v[86:87], v[248:249]
  v_pk_fma_f32 v[56:57], v[56:57], v[86:87], v[248:249]
  v_pk_fma_f32 v[60:61], v[60:61], v[86:87], v[248:249]
  v_pk_fma_f32 v[64:65], v[64:65], v[86:87], v[248:249]
  v_pk_fma_f32 v[68:69], v[68:69], v[86:87], v[248:249]
  v_pk_fma_f32 v[72:73], v[72:73], v[86:87], v[248:249]
  v_pk_fma_f32 v[76:77], v[76:77], v[86:87], v[248:249]
  v_pk_fma_f32 v[80:81], v[80:81], v[86:87], v[248:249]
  v_pk_mul_f32 v[54:55], v[54:55], v[56:57]
  v_pk_mul_f32 v[62:63], v[62:63], v[64:65]
  v_pk_mul_f32 v[70:71], v[70:71], v[72:73]
  v_pk_mul_f32 v[78:79], v[78:79], v[80:81]
  v_pk_fma_f32 v[54:55], v[58:59], v[52:53], v[54:55]
  v_pk_fma_f32 v[62:63], v[66:67], v[60:61], v[62:63]
  v_pk_fma_f32 v[70:71], v[74:75], v[68:69], v[70:71]
  v_pk_fma_f32 v[78:79], v[82:83], v[76:77], v[78:79]
  v_pk_mul_f32 v[52:53], v[52:53], v[56:57]
  v_pk_mul_f32 v[60:61], v[60:61], v[64:65]
  v_pk_mul_f32 v[68:69], v[68:69], v[72:73]
  v_pk_mul_f32 v[76:77], v[76:77], v[80:81]
  v_pk_mul_f32 v[54:55], v[54:55], v[60:61]
  v_pk_mul_f32 v[70:71], v[70:71], v[76:77]
  v_pk_fma_f32 v[54:55], v[62:63], v[52:53], v[54:55]
  v_pk_fma_f32 v[70:71], v[78:79], v[68:69], v[70:71]
  v_pk_mul_f32 v[52:53], v[52:53], v[60:61]
  v_pk_mul_f32 v[68:69], v[68:69], v[76:77]
  v_rcp_f32 v52, v52
  v_rcp_f32 v53, v53
  v_rcp_f32 v68, v68
  v_rcp_f32 v69, v69
  v_pk_mul_f32 v[38:39], v[52:53], v[54:55]
  v_pk_mul_f32 v[40:41], v[68:69], v[70:71]
  v_pk_mul_f32 v[52:53], v[144:145], v[144:145]
  v_pk_mul_f32 v[56:57], v[146:147], v[146:147]
  v_pk_mul_f32 v[60:61], v[148:149], v[148:149]
  v_pk_mul_f32 v[64:65], v[150:151], v[150:151]
  v_pk_mul_f32 v[68:69], v[160:161], v[160:161]
  v_pk_mul_f32 v[72:73], v[162:163], v[162:163]
  v_pk_mul_f32 v[76:77], v[164:165], v[164:165]
  v_pk_mul_f32 v[80:81], v[166:167], v[166:167]
  v_pk_fma_f32 v[52:53], v[52:53], v[14:15], v[12:13]
  v_pk_fma_f32 v[56:57], v[56:57], v[14:15], v[12:13]
  v_pk_fma_f32 v[60:61], v[60:61], v[14:15], v[12:13]
  v_pk_fma_f32 v[64:65], v[64:65], v[14:15], v[12:13]
  v_pk_fma_f32 v[68:69], v[68:69], v[14:15], v[12:13]
  v_pk_fma_f32 v[72:73], v[72:73], v[14:15], v[12:13]
  v_pk_fma_f32 v[76:77], v[76:77], v[14:15], v[12:13]
  v_pk_fma_f32 v[80:81], v[80:81], v[14:15], v[12:13]
  v_pk_fma_f32 v[52:53], v[52:53], v[144:145], v[84:85]
  v_pk_fma_f32 v[56:57], v[56:57], v[146:147], v[84:85]
  v_pk_fma_f32 v[60:61], v[60:61], v[148:149], v[84:85]
  v_pk_fma_f32 v[64:65], v[64:65], v[150:151], v[84:85]
  v_pk_fma_f32 v[68:69], v[68:69], v[160:161], v[84:85]
  v_pk_fma_f32 v[72:73], v[72:73], v[162:163], v[84:85]
  v_pk_fma_f32 v[76:77], v[76:77], v[164:165], v[84:85]
  v_pk_fma_f32 v[80:81], v[80:81], v[166:167], v[84:85]
  v_exp_f32 v52, v52 clamp
  v_exp_f32 v53, v53 clamp
  v_exp_f32 v56, v56 clamp
  v_exp_f32 v57, v57 clamp
  v_exp_f32 v60, v60 clamp
  v_exp_f32 v61, v61 clamp
  v_exp_f32 v64, v64 clamp
  v_exp_f32 v65, v65 clamp
  v_exp_f32 v68, v68 clamp
  v_exp_f32 v69, v69 clamp
  v_exp_f32 v72, v72 clamp
  v_exp_f32 v73, v73 clamp
  v_exp_f32 v76, v76 clamp
  v_exp_f32 v77, v77 clamp
  v_exp_f32 v80, v80 clamp
  v_exp_f32 v81, v81 clamp
  v_pk_mul_f32 v[54:55], v[144:145], v[24:25]
  v_pk_mul_f32 v[58:59], v[146:147], v[26:27]
  v_pk_mul_f32 v[62:63], v[148:149], v[28:29]
  v_pk_mul_f32 v[66:67], v[150:151], v[30:31]
  v_pk_mul_f32 v[70:71], v[160:161], v[24:25]
  v_pk_mul_f32 v[74:75], v[162:163], v[26:27]
  v_pk_mul_f32 v[78:79], v[164:165], v[28:29]
  v_pk_mul_f32 v[82:83], v[166:167], v[30:31]
  v_pk_fma_f32 v[52:53], v[52:53], v[86:87], v[248:249]
  v_pk_fma_f32 v[56:57], v[56:57], v[86:87], v[248:249]
  v_pk_fma_f32 v[60:61], v[60:61], v[86:87], v[248:249]
  v_pk_fma_f32 v[64:65], v[64:65], v[86:87], v[248:249]
  v_pk_fma_f32 v[68:69], v[68:69], v[86:87], v[248:249]
  v_pk_fma_f32 v[72:73], v[72:73], v[86:87], v[248:249]
  v_pk_fma_f32 v[76:77], v[76:77], v[86:87], v[248:249]
  v_pk_fma_f32 v[80:81], v[80:81], v[86:87], v[248:249]
  v_pk_mul_f32 v[54:55], v[54:55], v[56:57]
  v_pk_mul_f32 v[62:63], v[62:63], v[64:65]
  v_pk_mul_f32 v[70:71], v[70:71], v[72:73]
  v_pk_mul_f32 v[78:79], v[78:79], v[80:81]
  v_pk_fma_f32 v[54:55], v[58:59], v[52:53], v[54:55]
  v_pk_fma_f32 v[62:63], v[66:67], v[60:61], v[62:63]
  v_pk_fma_f32 v[70:71], v[74:75], v[68:69], v[70:71]
  v_pk_fma_f32 v[78:79], v[82:83], v[76:77], v[78:79]
  v_pk_mul_f32 v[52:53], v[52:53], v[56:57]
  v_pk_mul_f32 v[60:61], v[60:61], v[64:65]
  v_pk_mul_f32 v[68:69], v[68:69], v[72:73]
  v_pk_mul_f32 v[76:77], v[76:77], v[80:81]
  v_pk_mul_f32 v[54:55], v[54:55], v[60:61]
  v_pk_mul_f32 v[70:71], v[70:71], v[76:77]
  v_pk_fma_f32 v[54:55], v[62:63], v[52:53], v[54:55]
  v_pk_fma_f32 v[70:71], v[78:79], v[68:69], v[70:71]
  v_pk_mul_f32 v[52:53], v[52:53], v[60:61]
  v_pk_mul_f32 v[68:69], v[68:69], v[76:77]
  v_rcp_f32 v52, v52
  v_rcp_f32 v53, v53
  v_rcp_f32 v68, v68
  v_rcp_f32 v69, v69
  v_pk_fma_f32 v[38:39], v[52:53], v[54:55], v[38:39]
  v_pk_fma_f32 v[40:41], v[68:69], v[70:71], v[40:41]
  v_pk_mul_f32 v[52:53], v[168:169], v[168:169]
  v_pk_mul_f32 v[56:57], v[170:171], v[170:171]
  v_pk_mul_f32 v[60:61], v[172:173], v[172:173]
  v_pk_mul_f32 v[64:65], v[174:175], v[174:175]
  v_pk_mul_f32 v[68:69], v[184:185], v[184:185]
  v_pk_mul_f32 v[72:73], v[186:187], v[186:187]
  v_pk_mul_f32 v[76:77], v[188:189], v[188:189]
  v_pk_mul_f32 v[80:81], v[190:191], v[190:191]
  v_pk_fma_f32 v[52:53], v[52:53], v[14:15], v[12:13]
  v_pk_fma_f32 v[56:57], v[56:57], v[14:15], v[12:13]
  v_pk_fma_f32 v[60:61], v[60:61], v[14:15], v[12:13]
  v_pk_fma_f32 v[64:65], v[64:65], v[14:15], v[12:13]
  v_pk_fma_f32 v[68:69], v[68:69], v[14:15], v[12:13]
  v_pk_fma_f32 v[72:73], v[72:73], v[14:15], v[12:13]
  v_pk_fma_f32 v[76:77], v[76:77], v[14:15], v[12:13]
  v_pk_fma_f32 v[80:81], v[80:81], v[14:15], v[12:13]
  v_pk_fma_f32 v[52:53], v[52:53], v[168:169], v[84:85]
  v_pk_fma_f32 v[56:57], v[56:57], v[170:171], v[84:85]
  v_pk_fma_f32 v[60:61], v[60:61], v[172:173], v[84:85]
  v_pk_fma_f32 v[64:65], v[64:65], v[174:175], v[84:85]
  v_pk_fma_f32 v[68:69], v[68:69], v[184:185], v[84:85]
  v_pk_fma_f32 v[72:73], v[72:73], v[186:187], v[84:85]
  v_pk_fma_f32 v[76:77], v[76:77], v[188:189], v[84:85]
  v_pk_fma_f32 v[80:81], v[80:81], v[190:191], v[84:85]
  v_exp_f32 v52, v52 clamp
  v_exp_f32 v53, v53 clamp
  v_exp_f32 v56, v56 clamp
  v_exp_f32 v57, v57 clamp
  v_exp_f32 v60, v60 clamp
  v_exp_f32 v61, v61 clamp
  v_exp_f32 v64, v64 clamp
  v_exp_f32 v65, v65 clamp
  v_exp_f32 v68, v68 clamp
  v_exp_f32 v69, v69 clamp
  v_exp_f32 v72, v72 clamp
  v_exp_f32 v73, v73 clamp
  v_exp_f32 v76, v76 clamp
  v_exp_f32 v77, v77 clamp
  v_exp_f32 v80, v80 clamp
  v_exp_f32 v81, v81 clamp
  v_pk_mul_f32 v[54:55], v[168:169], v[16:17]
  v_pk_mul_f32 v[58:59], v[170:171], v[18:19]
  v_pk_mul_f32 v[62:63], v[172:173], v[20:21]
  v_pk_mul_f32 v[66:67], v[174:175], v[22:23]
  v_pk_mul_f32 v[70:71], v[184:185], v[16:17]
  v_pk_mul_f32 v[74:75], v[186:187], v[18:19]
  v_pk_mul_f32 v[78:79], v[188:189], v[20:21]
  v_pk_mul_f32 v[82:83], v[190:191], v[22:23]
  v_pk_fma_f32 v[52:53], v[52:53], v[86:87], v[248:249]
  v_pk_fma_f32 v[56:57], v[56:57], v[86:87], v[248:249]
  v_pk_fma_f32 v[60:61], v[60:61], v[86:87], v[248:249]
  v_pk_fma_f32 v[64:65], v[64:65], v[86:87], v[248:249]
  v_pk_fma_f32 v[68:69], v[68:69], v[86:87], v[248:249]
  v_pk_fma_f32 v[72:73], v[72:73], v[86:87], v[248:249]
  v_pk_fma_f32 v[76:77], v[76:77], v[86:87], v[248:249]
  v_pk_fma_f32 v[80:81], v[80:81], v[86:87], v[248:249]
  v_pk_mul_f32 v[54:55], v[54:55], v[56:57]
  v_pk_mul_f32 v[62:63], v[62:63], v[64:65]
  v_pk_mul_f32 v[70:71], v[70:71], v[72:73]
  v_pk_mul_f32 v[78:79], v[78:79], v[80:81]
  v_pk_fma_f32 v[54:55], v[58:59], v[52:53], v[54:55]
  v_pk_fma_f32 v[62:63], v[66:67], v[60:61], v[62:63]
  v_pk_fma_f32 v[70:71], v[74:75], v[68:69], v[70:71]
  v_pk_fma_f32 v[78:79], v[82:83], v[76:77], v[78:79]
  v_pk_mul_f32 v[52:53], v[52:53], v[56:57]
  v_pk_mul_f32 v[60:61], v[60:61], v[64:65]
  v_pk_mul_f32 v[68:69], v[68:69], v[72:73]
  v_pk_mul_f32 v[76:77], v[76:77], v[80:81]
  v_pk_mul_f32 v[54:55], v[54:55], v[60:61]
  v_pk_mul_f32 v[70:71], v[70:71], v[76:77]
  v_pk_fma_f32 v[54:55], v[62:63], v[52:53], v[54:55]
  v_pk_fma_f32 v[70:71], v[78:79], v[68:69], v[70:71]
  v_pk_mul_f32 v[52:53], v[52:53], v[60:61]
  v_pk_mul_f32 v[68:69], v[68:69], v[76:77]
  v_rcp_f32 v52, v52
  v_rcp_f32 v53, v53
  v_rcp_f32 v68, v68
  v_rcp_f32 v69, v69
  v_pk_mul_f32 v[42:43], v[52:53], v[54:55]
  v_pk_mul_f32 v[44:45], v[68:69], v[70:71]
  v_pk_mul_f32 v[52:53], v[176:177], v[176:177]
  v_pk_mul_f32 v[56:57], v[178:179], v[178:179]
  v_pk_mul_f32 v[60:61], v[180:181], v[180:181]
  v_pk_mul_f32 v[64:65], v[182:183], v[182:183]
  v_pk_mul_f32 v[68:69], v[192:193], v[192:193]
  v_pk_mul_f32 v[72:73], v[194:195], v[194:195]
  v_pk_mul_f32 v[76:77], v[196:197], v[196:197]
  v_pk_mul_f32 v[80:81], v[198:199], v[198:199]
  v_pk_fma_f32 v[52:53], v[52:53], v[14:15], v[12:13]
  v_pk_fma_f32 v[56:57], v[56:57], v[14:15], v[12:13]
  v_pk_fma_f32 v[60:61], v[60:61], v[14:15], v[12:13]
  v_pk_fma_f32 v[64:65], v[64:65], v[14:15], v[12:13]
  v_pk_fma_f32 v[68:69], v[68:69], v[14:15], v[12:13]
  v_pk_fma_f32 v[72:73], v[72:73], v[14:15], v[12:13]
  v_pk_fma_f32 v[76:77], v[76:77], v[14:15], v[12:13]
  v_pk_fma_f32 v[80:81], v[80:81], v[14:15], v[12:13]
  v_pk_fma_f32 v[52:53], v[52:53], v[176:177], v[84:85]
  v_pk_fma_f32 v[56:57], v[56:57], v[178:179], v[84:85]
  v_pk_fma_f32 v[60:61], v[60:61], v[180:181], v[84:85]
  v_pk_fma_f32 v[64:65], v[64:65], v[182:183], v[84:85]
  v_pk_fma_f32 v[68:69], v[68:69], v[192:193], v[84:85]
  v_pk_fma_f32 v[72:73], v[72:73], v[194:195], v[84:85]
  v_pk_fma_f32 v[76:77], v[76:77], v[196:197], v[84:85]
  v_pk_fma_f32 v[80:81], v[80:81], v[198:199], v[84:85]
  v_exp_f32 v52, v52 clamp
  v_exp_f32 v53, v53 clamp
  v_exp_f32 v56, v56 clamp
  v_exp_f32 v57, v57 clamp
  v_exp_f32 v60, v60 clamp
  v_exp_f32 v61, v61 clamp
  v_exp_f32 v64, v64 clamp
  v_exp_f32 v65, v65 clamp
  v_exp_f32 v68, v68 clamp
  v_exp_f32 v69, v69 clamp
  v_exp_f32 v72, v72 clamp
  v_exp_f32 v73, v73 clamp
  v_exp_f32 v76, v76 clamp
  v_exp_f32 v77, v77 clamp
  v_exp_f32 v80, v80 clamp
  v_exp_f32 v81, v81 clamp
  v_pk_mul_f32 v[54:55], v[176:177], v[24:25]
  v_pk_mul_f32 v[58:59], v[178:179], v[26:27]
  v_pk_mul_f32 v[62:63], v[180:181], v[28:29]
  v_pk_mul_f32 v[66:67], v[182:183], v[30:31]
  v_pk_mul_f32 v[70:71], v[192:193], v[24:25]
  v_pk_mul_f32 v[74:75], v[194:195], v[26:27]
  v_pk_mul_f32 v[78:79], v[196:197], v[28:29]
  v_pk_mul_f32 v[82:83], v[198:199], v[30:31]
  v_pk_fma_f32 v[52:53], v[52:53], v[86:87], v[248:249]
  v_pk_fma_f32 v[56:57], v[56:57], v[86:87], v[248:249]
  v_pk_fma_f32 v[60:61], v[60:61], v[86:87], v[248:249]
  v_pk_fma_f32 v[64:65], v[64:65], v[86:87], v[248:249]
  v_pk_fma_f32 v[68:69], v[68:69], v[86:87], v[248:249]
  v_pk_fma_f32 v[72:73], v[72:73], v[86:87], v[248:249]
  v_pk_fma_f32 v[76:77], v[76:77], v[86:87], v[248:249]
  v_pk_fma_f32 v[80:81], v[80:81], v[86:87], v[248:249]
  v_pk_mul_f32 v[54:55], v[54:55], v[56:57]
  v_pk_mul_f32 v[62:63], v[62:63], v[64:65]
  v_pk_mul_f32 v[70:71], v[70:71], v[72:73]
  v_pk_mul_f32 v[78:79], v[78:79], v[80:81]
  v_pk_fma_f32 v[54:55], v[58:59], v[52:53], v[54:55]
  v_pk_fma_f32 v[62:63], v[66:67], v[60:61], v[62:63]
  v_pk_fma_f32 v[70:71], v[74:75], v[68:69], v[70:71]
  v_pk_fma_f32 v[78:79], v[82:83], v[76:77], v[78:79]
  v_pk_mul_f32 v[52:53], v[52:53], v[56:57]
  v_pk_mul_f32 v[60:61], v[60:61], v[64:65]
  v_pk_mul_f32 v[68:69], v[68:69], v[72:73]
  v_pk_mul_f32 v[76:77], v[76:77], v[80:81]
  v_pk_mul_f32 v[54:55], v[54:55], v[60:61]
  v_pk_mul_f32 v[70:71], v[70:71], v[76:77]
  v_pk_fma_f32 v[54:55], v[62:63], v[52:53], v[54:55]
  v_pk_fma_f32 v[70:71], v[78:79], v[68:69], v[70:71]
  v_pk_mul_f32 v[52:53], v[52:53], v[60:61]
  v_pk_mul_f32 v[68:69], v[68:69], v[76:77]
  v_rcp_f32 v52, v52
  v_rcp_f32 v53, v53
  v_rcp_f32 v68, v68
  v_rcp_f32 v69, v69
  v_pk_fma_f32 v[42:43], v[52:53], v[54:55], v[42:43]
  v_pk_fma_f32 v[44:45], v[68:69], v[70:71], v[44:45]
  v_pk_mul_f32 v[52:53], v[200:201], v[200:201]
  v_pk_mul_f32 v[56:57], v[202:203], v[202:203]
  v_pk_mul_f32 v[60:61], v[204:205], v[204:205]
  v_pk_mul_f32 v[64:65], v[206:207], v[206:207]
  v_pk_mul_f32 v[68:69], v[216:217], v[216:217]
  v_pk_mul_f32 v[72:73], v[218:219], v[218:219]
  v_pk_mul_f32 v[76:77], v[220:221], v[220:221]
  v_pk_mul_f32 v[80:81], v[222:223], v[222:223]
  v_pk_fma_f32 v[52:53], v[52:53], v[14:15], v[12:13]
  v_pk_fma_f32 v[56:57], v[56:57], v[14:15], v[12:13]
  v_pk_fma_f32 v[60:61], v[60:61], v[14:15], v[12:13]
  v_pk_fma_f32 v[64:65], v[64:65], v[14:15], v[12:13]
  v_pk_fma_f32 v[68:69], v[68:69], v[14:15], v[12:13]
  v_pk_fma_f32 v[72:73], v[72:73], v[14:15], v[12:13]
  v_pk_fma_f32 v[76:77], v[76:77], v[14:15], v[12:13]
  v_pk_fma_f32 v[80:81], v[80:81], v[14:15], v[12:13]
  v_pk_fma_f32 v[52:53], v[52:53], v[200:201], v[84:85]
  v_pk_fma_f32 v[56:57], v[56:57], v[202:203], v[84:85]
  v_pk_fma_f32 v[60:61], v[60:61], v[204:205], v[84:85]
  v_pk_fma_f32 v[64:65], v[64:65], v[206:207], v[84:85]
  v_pk_fma_f32 v[68:69], v[68:69], v[216:217], v[84:85]
  v_pk_fma_f32 v[72:73], v[72:73], v[218:219], v[84:85]
  v_pk_fma_f32 v[76:77], v[76:77], v[220:221], v[84:85]
  v_pk_fma_f32 v[80:81], v[80:81], v[222:223], v[84:85]
  v_exp_f32 v52, v52 clamp
  v_exp_f32 v53, v53 clamp
  v_exp_f32 v56, v56 clamp
  v_exp_f32 v57, v57 clamp
  v_exp_f32 v60, v60 clamp
  v_exp_f32 v61, v61 clamp
  v_exp_f32 v64, v64 clamp
  v_exp_f32 v65, v65 clamp
  v_exp_f32 v68, v68 clamp
  v_exp_f32 v69, v69 clamp
  v_exp_f32 v72, v72 clamp
  v_exp_f32 v73, v73 clamp
  v_exp_f32 v76, v76 clamp
  v_exp_f32 v77, v77 clamp
  v_exp_f32 v80, v80 clamp
  v_exp_f32 v81, v81 clamp
  v_pk_mul_f32 v[54:55], v[200:201], v[16:17]
  v_pk_mul_f32 v[58:59], v[202:203], v[18:19]
  v_pk_mul_f32 v[62:63], v[204:205], v[20:21]
  v_pk_mul_f32 v[66:67], v[206:207], v[22:23]
  v_pk_mul_f32 v[70:71], v[216:217], v[16:17]
  v_pk_mul_f32 v[74:75], v[218:219], v[18:19]
  v_pk_mul_f32 v[78:79], v[220:221], v[20:21]
  v_pk_mul_f32 v[82:83], v[222:223], v[22:23]
  v_pk_fma_f32 v[52:53], v[52:53], v[86:87], v[248:249]
  v_pk_fma_f32 v[56:57], v[56:57], v[86:87], v[248:249]
  v_pk_fma_f32 v[60:61], v[60:61], v[86:87], v[248:249]
  v_pk_fma_f32 v[64:65], v[64:65], v[86:87], v[248:249]
  v_pk_fma_f32 v[68:69], v[68:69], v[86:87], v[248:249]
  v_pk_fma_f32 v[72:73], v[72:73], v[86:87], v[248:249]
  v_pk_fma_f32 v[76:77], v[76:77], v[86:87], v[248:249]
  v_pk_fma_f32 v[80:81], v[80:81], v[86:87], v[248:249]
  v_pk_mul_f32 v[54:55], v[54:55], v[56:57]
  v_pk_mul_f32 v[62:63], v[62:63], v[64:65]
  v_pk_mul_f32 v[70:71], v[70:71], v[72:73]
  v_pk_mul_f32 v[78:79], v[78:79], v[80:81]
  v_pk_fma_f32 v[54:55], v[58:59], v[52:53], v[54:55]
  v_pk_fma_f32 v[62:63], v[66:67], v[60:61], v[62:63]
  v_pk_fma_f32 v[70:71], v[74:75], v[68:69], v[70:71]
  v_pk_fma_f32 v[78:79], v[82:83], v[76:77], v[78:79]
  v_pk_mul_f32 v[52:53], v[52:53], v[56:57]
  v_pk_mul_f32 v[60:61], v[60:61], v[64:65]
  v_pk_mul_f32 v[68:69], v[68:69], v[72:73]
  v_pk_mul_f32 v[76:77], v[76:77], v[80:81]
  v_pk_mul_f32 v[54:55], v[54:55], v[60:61]
  v_pk_mul_f32 v[70:71], v[70:71], v[76:77]
  v_pk_fma_f32 v[54:55], v[62:63], v[52:53], v[54:55]
  v_pk_fma_f32 v[70:71], v[78:79], v[68:69], v[70:71]
  v_pk_mul_f32 v[52:53], v[52:53], v[60:61]
  v_pk_mul_f32 v[68:69], v[68:69], v[76:77]
  v_rcp_f32 v52, v52
  v_rcp_f32 v53, v53
  v_rcp_f32 v68, v68
  v_rcp_f32 v69, v69
  v_pk_mul_f32 v[46:47], v[52:53], v[54:55]
  v_pk_mul_f32 v[48:49], v[68:69], v[70:71]
  v_pk_mul_f32 v[52:53], v[208:209], v[208:209]
  v_pk_mul_f32 v[56:57], v[210:211], v[210:211]
  v_pk_mul_f32 v[60:61], v[212:213], v[212:213]
  v_pk_mul_f32 v[64:65], v[214:215], v[214:215]
  v_pk_mul_f32 v[68:69], v[224:225], v[224:225]
  v_pk_mul_f32 v[72:73], v[226:227], v[226:227]
  v_pk_mul_f32 v[76:77], v[228:229], v[228:229]
  v_pk_mul_f32 v[80:81], v[230:231], v[230:231]
  v_pk_fma_f32 v[52:53], v[52:53], v[14:15], v[12:13]
  v_pk_fma_f32 v[56:57], v[56:57], v[14:15], v[12:13]
  v_pk_fma_f32 v[60:61], v[60:61], v[14:15], v[12:13]
  v_pk_fma_f32 v[64:65], v[64:65], v[14:15], v[12:13]
  v_pk_fma_f32 v[68:69], v[68:69], v[14:15], v[12:13]
  v_pk_fma_f32 v[72:73], v[72:73], v[14:15], v[12:13]
  v_pk_fma_f32 v[76:77], v[76:77], v[14:15], v[12:13]
  v_pk_fma_f32 v[80:81], v[80:81], v[14:15], v[12:13]
  v_pk_fma_f32 v[52:53], v[52:53], v[208:209], v[84:85]
  v_pk_fma_f32 v[56:57], v[56:57], v[210:211], v[84:85]
  v_pk_fma_f32 v[60:61], v[60:61], v[212:213], v[84:85]
  v_pk_fma_f32 v[64:65], v[64:65], v[214:215], v[84:85]
  v_pk_fma_f32 v[68:69], v[68:69], v[224:225], v[84:85]
  v_pk_fma_f32 v[72:73], v[72:73], v[226:227], v[84:85]
  v_pk_fma_f32 v[76:77], v[76:77], v[228:229], v[84:85]
  v_pk_fma_f32 v[80:81], v[80:81], v[230:231], v[84:85]
  v_exp_f32 v52, v52 clamp
  v_exp_f32 v53, v53 clamp
  v_exp_f32 v56, v56 clamp
  v_exp_f32 v57, v57 clamp
  v_exp_f32 v60, v60 clamp
  v_exp_f32 v61, v61 clamp
  v_exp_f32 v64, v64 clamp
  v_exp_f32 v65, v65 clamp
  v_exp_f32 v68, v68 clamp
  v_exp_f32 v69, v69 clamp
  v_exp_f32 v72, v72 clamp
  v_exp_f32 v73, v73 clamp
  v_exp_f32 v76, v76 clamp
  v_exp_f32 v77, v77 clamp
  v_exp_f32 v80, v80 clamp
  v_exp_f32 v81, v81 clamp
  v_pk_mul_f32 v[54:55], v[208:209], v[24:25]
  v_pk_mul_f32 v[58:59], v[210:211], v[26:27]
  v_pk_mul_f32 v[62:63], v[212:213], v[28:29]
  v_pk_mul_f32 v[66:67], v[214:215], v[30:31]
  v_pk_mul_f32 v[70:71], v[224:225], v[24:25]
  v_pk_mul_f32 v[74:75], v[226:227], v[26:27]
  v_pk_mul_f32 v[78:79], v[228:229], v[28:29]
  v_pk_mul_f32 v[82:83], v[230:231], v[30:31]
  v_pk_fma_f32 v[52:53], v[52:53], v[86:87], v[248:249]
  v_pk_fma_f32 v[56:57], v[56:57], v[86:87], v[248:249]
  v_pk_fma_f32 v[60:61], v[60:61], v[86:87], v[248:249]
  v_pk_fma_f32 v[64:65], v[64:65], v[86:87], v[248:249]
  v_pk_fma_f32 v[68:69], v[68:69], v[86:87], v[248:249]
  v_pk_fma_f32 v[72:73], v[72:73], v[86:87], v[248:249]
  v_pk_fma_f32 v[76:77], v[76:77], v[86:87], v[248:249]
  v_pk_fma_f32 v[80:81], v[80:81], v[86:87], v[248:249]
  v_pk_mul_f32 v[54:55], v[54:55], v[56:57]
  v_pk_mul_f32 v[62:63], v[62:63], v[64:65]
  v_pk_mul_f32 v[70:71], v[70:71], v[72:73]
  v_pk_mul_f32 v[78:79], v[78:79], v[80:81]
  v_pk_fma_f32 v[54:55], v[58:59], v[52:53], v[54:55]
  v_pk_fma_f32 v[62:63], v[66:67], v[60:61], v[62:63]
  v_pk_fma_f32 v[70:71], v[74:75], v[68:69], v[70:71]
  v_pk_fma_f32 v[78:79], v[82:83], v[76:77], v[78:79]
  v_pk_mul_f32 v[52:53], v[52:53], v[56:57]
  v_pk_mul_f32 v[60:61], v[60:61], v[64:65]
  v_pk_mul_f32 v[68:69], v[68:69], v[72:73]
  v_pk_mul_f32 v[76:77], v[76:77], v[80:81]
  v_pk_mul_f32 v[54:55], v[54:55], v[60:61]
  v_pk_mul_f32 v[70:71], v[70:71], v[76:77]
  v_pk_fma_f32 v[54:55], v[62:63], v[52:53], v[54:55]
  v_pk_fma_f32 v[70:71], v[78:79], v[68:69], v[70:71]
  v_pk_mul_f32 v[52:53], v[52:53], v[60:61]
  v_pk_mul_f32 v[68:69], v[68:69], v[76:77]
  v_rcp_f32 v52, v52
  v_rcp_f32 v53, v53
  v_rcp_f32 v68, v68
  v_rcp_f32 v69, v69
  v_pk_fma_f32 v[46:47], v[52:53], v[54:55], v[46:47]
  v_pk_fma_f32 v[48:49], v[68:69], v[70:71], v[48:49]
  v_pk_mul_f32 v[52:53], v[232:233], v[232:233]
  v_pk_mul_f32 v[56:57], v[234:235], v[234:235]
  v_pk_mul_f32 v[60:61], v[236:237], v[236:237]
  v_pk_mul_f32 v[64:65], v[238:239], v[238:239]
  v_pk_mul_f32 v[68:69], v[240:241], v[240:241]
  v_pk_mul_f32 v[72:73], v[242:243], v[242:243]
  v_pk_mul_f32 v[76:77], v[244:245], v[244:245]
  v_pk_mul_f32 v[80:81], v[246:247], v[246:247]
  v_pk_fma_f32 v[52:53], v[52:53], v[14:15], v[12:13]
  v_pk_fma_f32 v[56:57], v[56:57], v[14:15], v[12:13]
  v_pk_fma_f32 v[60:61], v[60:61], v[14:15], v[12:13]
  v_pk_fma_f32 v[64:65], v[64:65], v[14:15], v[12:13]
  v_pk_fma_f32 v[68:69], v[68:69], v[14:15], v[12:13]
  v_pk_fma_f32 v[72:73], v[72:73], v[14:15], v[12:13]
  v_pk_fma_f32 v[76:77], v[76:77], v[14:15], v[12:13]
  v_pk_fma_f32 v[80:81], v[80:81], v[14:15], v[12:13]
  v_pk_fma_f32 v[52:53], v[52:53], v[232:233], v[84:85]
  v_pk_fma_f32 v[56:57], v[56:57], v[234:235], v[84:85]
  v_pk_fma_f32 v[60:61], v[60:61], v[236:237], v[84:85]
  v_pk_fma_f32 v[64:65], v[64:65], v[238:239], v[84:85]
  v_pk_fma_f32 v[68:69], v[68:69], v[240:241], v[84:85]
  v_pk_fma_f32 v[72:73], v[72:73], v[242:243], v[84:85]
  v_pk_fma_f32 v[76:77], v[76:77], v[244:245], v[84:85]
  v_pk_fma_f32 v[80:81], v[80:81], v[246:247], v[84:85]
  v_exp_f32 v52, v52 clamp
  v_exp_f32 v53, v53 clamp
  v_exp_f32 v56, v56 clamp
  v_exp_f32 v57, v57 clamp
  v_exp_f32 v60, v60 clamp
  v_exp_f32 v61, v61 clamp
  v_exp_f32 v64, v64 clamp
  v_exp_f32 v65, v65 clamp
  v_exp_f32 v68, v68 clamp
  v_exp_f32 v69, v69 clamp
  v_exp_f32 v72, v72 clamp
  v_exp_f32 v73, v73 clamp
  v_exp_f32 v76, v76 clamp
  v_exp_f32 v77, v77 clamp
  v_exp_f32 v80, v80 clamp
  v_exp_f32 v81, v81 clamp
  v_pk_mul_f32 v[54:55], v[232:233], v[16:17]
  v_pk_mul_f32 v[58:59], v[234:235], v[18:19]
  v_pk_mul_f32 v[62:63], v[236:237], v[20:21]
  v_pk_mul_f32 v[66:67], v[238:239], v[22:23]
  v_pk_mul_f32 v[70:71], v[240:241], v[24:25]
  v_pk_mul_f32 v[74:75], v[242:243], v[26:27]
  v_pk_mul_f32 v[78:79], v[244:245], v[28:29]
  v_pk_mul_f32 v[82:83], v[246:247], v[30:31]
  v_pk_fma_f32 v[52:53], v[52:53], v[86:87], v[248:249]
  v_pk_fma_f32 v[56:57], v[56:57], v[86:87], v[248:249]
  v_pk_fma_f32 v[60:61], v[60:61], v[86:87], v[248:249]
  v_pk_fma_f32 v[64:65], v[64:65], v[86:87], v[248:249]
  v_pk_fma_f32 v[68:69], v[68:69], v[86:87], v[248:249]
  v_pk_fma_f32 v[72:73], v[72:73], v[86:87], v[248:249]
  v_pk_fma_f32 v[76:77], v[76:77], v[86:87], v[248:249]
  v_pk_fma_f32 v[80:81], v[80:81], v[86:87], v[248:249]
  v_pk_mul_f32 v[54:55], v[54:55], v[56:57]
  v_pk_mul_f32 v[62:63], v[62:63], v[64:65]
  v_pk_mul_f32 v[70:71], v[70:71], v[72:73]
  v_pk_mul_f32 v[78:79], v[78:79], v[80:81]
  v_pk_fma_f32 v[54:55], v[58:59], v[52:53], v[54:55]
  v_pk_fma_f32 v[62:63], v[66:67], v[60:61], v[62:63]
  v_pk_fma_f32 v[70:71], v[74:75], v[68:69], v[70:71]
  v_pk_fma_f32 v[78:79], v[82:83], v[76:77], v[78:79]
  v_pk_mul_f32 v[52:53], v[52:53], v[56:57]
  v_pk_mul_f32 v[60:61], v[60:61], v[64:65]
  v_pk_mul_f32 v[68:69], v[68:69], v[72:73]
  v_pk_mul_f32 v[76:77], v[76:77], v[80:81]
  v_pk_mul_f32 v[54:55], v[54:55], v[60:61]
  v_pk_mul_f32 v[70:71], v[70:71], v[76:77]
  v_pk_fma_f32 v[54:55], v[62:63], v[52:53], v[54:55]
  v_pk_fma_f32 v[70:71], v[78:79], v[68:69], v[70:71]
  v_pk_mul_f32 v[52:53], v[52:53], v[60:61]
  v_pk_mul_f32 v[68:69], v[68:69], v[76:77]
  v_rcp_f32 v52, v52
  v_rcp_f32 v53, v53
  v_rcp_f32 v68, v68
  v_rcp_f32 v69, v69
  v_pk_mul_f32 v[50:51], v[52:53], v[54:55]
  v_pk_fma_f32 v[50:51], v[68:69], v[70:71], v[50:51]
  v_pk_mul_f32 v[32:33], v[88:89], v[16:17]
  v_pk_fma_f32 v[32:33], v[90:91], v[18:19], v[32:33]
  v_pk_fma_f32 v[32:33], v[92:93], v[20:21], v[32:33]
  v_pk_fma_f32 v[32:33], v[94:95], v[22:23], v[32:33]
  v_pk_fma_f32 v[32:33], v[96:97], v[24:25], v[32:33]
  v_pk_fma_f32 v[32:33], v[98:99], v[26:27], v[32:33]
  v_pk_fma_f32 v[32:33], v[100:101], v[28:29], v[32:33]
  v_pk_fma_f32 v[32:33], v[102:103], v[30:31], v[32:33]
  v_add_f32 v32, v32, v33
  v_add_f32 v34, v34, v35
  v_add_f32 v36, v36, v37
  v_add_f32 v38, v38, v39
  v_add_f32 v40, v40, v41
  v_add_f32 v42, v42, v43
  v_add_f32 v44, v44, v45
  v_add_f32 v46, v46, v47
  v_add_f32 v48, v48, v49
  v_add_f32 v50, v50, v51
  v_permlane32_swap_b32 v32, v34
  v_permlane32_swap_b32 v36, v38
  v_permlane32_swap_b32 v40, v42
  v_permlane32_swap_b32 v44, v46
  v_permlane32_swap_b32 v48, v50
  v_add_f32 v48, v48, v50
  v_add_f32 v32, v32, v34
  v_add_f32 v36, v36, v38
  v_add_f32 v40, v40, v42
  v_add_f32 v44, v44, v46
  v_mov_b32 v50, v48
  v_permlane16_swap_b32 v32, v36
  v_permlane16_swap_b32 v40, v44
  v_permlane16_swap_b32 v48, v50
  v_add_f32 v32, v32, v36
  v_add_f32 v40, v40, v44
  v_add_f32 v48, v48, v50
  ds_write_b32 v10, v32
  ds_write_b32 v10, v40 offset:256
  s_mov_b32 exec_lo, 0xffff
  s_mov_b32 exec_hi, 0xffff
  ds_write_b32 v10, v48 offset:512
  s_mov_b64 exec, -1
  s_waitcnt lgkmcnt(0)
  s_barrier
  s_endpgm
L_ld_tail:
  s_barrier
  s_mov_b32 s60, s24
  s_and_b32 s61, s25, 0xffff
  s_mov_b32 s62, 268435456
  s_mov_b32 s63, 0x20000
  s_mov_b32 s56, s20
  s_and_b32 s57, s21, 0xffff
  s_mov_b32 s58, 8192
  s_mov_b32 s59, 0x20000
  s_mov_b32 s64, s22
  s_and_b32 s65, s23, 0xffff
  s_mov_b32 s66, 256
  s_mov_b32 s67, 0x20000
  s_load_dword s80, s[18:19], 0
  v_mov_b32_e64 v100, 0
  s_mov_b64 exec, 1
  s_mov_b32 s81, 0x80000
  buffer_load_dword v101, v100, s[60:63], s81 offen
  buffer_load_dword v102, v100, s[56:59], 0 offen
  s_mov_b64 exec, -1
  s_mov_b64 exec, 1
  buffer_load_dword v250, v100, s[64:67], 0 offen offset:240 sc1
  s_mov_b64 exec, -1
  s_cmp_lg_u32 s3, 4
  s_cbranch_scc1 L_end
  v_lshlrev_b32 v3, 4, v0
  v_lshlrev_b32_e64 v4, 2, v0
  v_add_u32 v1, 123392, v3
  v_add_u32 v2, 124416, v4
  v_add_u32 v4, 1024, v4
  v_mov_b32 v5, 32
  v_mov_b32 v7, s26
  s_mul_i32 s68, s26, 1280
  s_mul_i32 s69, s27, 16640
  s_add_u32 s69, s69, s68
  s_setprio 3
  v_mov_b32 v64, -1
  v_mov_b32 v65, -1
  v_mov_b32 v66, -1
  v_mov_b32 v67, -1
  buffer_store_dwordx4 v[64:67], v3, s[60:63], s69 offen sc1
  buffer_store_dword v64, v4, s[60:63], s69 offen sc1
  s_waitcnt vmcnt(0)
  s_barrier
  ds_read_b128 v[64:67], v1
  ds_read_b128 v[72:75], v1 offset:1280
  ds_read2st64_b32 v[68:69], v2 offset0:0 offset1:5
  s_waitcnt lgkmcnt(0)
  v_pk_add_f32 v[64:65], v[64:65], v[72:73]
  v_pk_add_f32 v[66:67], v[66:67], v[74:75]
  v_add_f32 v68, v68, v69
  v_min_u32 v64, -2, v64
  v_min_u32 v65, -2, v65
  v_min_u32 v66, -2, v66
  v_min_u32 v67, -2, v67
  v_min_u32 v68, -2, v68
  buffer_store_dwordx4 v[64:67], v3, s[60:63], s69 offen sc1
  buffer_store_dword v68, v4, s[60:63], s69 offen sc1
  s_mov_b64 exec, 1
L_pub:
  v_lshlrev_b32 v6, 4, v7
  v_mov_b32 v13, v5
  buffer_atomic_add v5, v6, s[64:67], 0 offen sc0
  v_cmp_eq_u32 vcc, 12, v7
  v_mov_b32 v8, 436
  v_mov_b32 v9, 434
  v_cndmask_b32 v8, v8, v9, vcc
  v_sub_u32 v8, v8, v13
  s_waitcnt vmcnt(0) lgkmcnt(0)
  v_cmp_eq_u32 s[82:83], v5, v8
  s_mov_b64 exec, -1
  s_lshl_b32 s80, s80, 16
  v_lshrrev_b32 v1, 1, v3
  v_lshrrev_b32 v2, 1, v4
L_fin:
  s_cmp_eq_u32 s82, 0
  s_cbranch_scc1 L_done
  s_ff1_i32_b32 s70, s82
  s_bitset0_b32 s82, s70
  v_readlane_b32 s71, v7, s70
  s_waitcnt vmcnt(0)
L_again:
  s_mul_i32 s68, s71, 1280
  buffer_load_dwordx4 v[64:67], v3, s[60:63], s68 offen sc1
  buffer_load_dword v68, v4, s[60:63], s68 offen sc1
  s_add_u32 s68, s68, 16640
  buffer_load_dwordx4 v[72:75], v3, s[60:63], s68 offen sc1
  buffer_load_dword v76, v4, s[60:63], s68 offen sc1
  s_add_u32 s68, s68, 16640
  buffer_load_dwordx4 v[80:83], v3, s[60:63], s68 offen sc1
  buffer_load_dword v84, v4, s[60:63], s68 offen sc1
  s_add_u32 s68, s68, 16640
  buffer_load_dwordx4 v[88:91], v3, s[60:63], s68 offen sc1
  buffer_load_dword v92, v4, s[60:63], s68 offen sc1
  s_add_u32 s68, s68, 16640
  buffer_load_dwordx4 v[96:99], v3, s[60:63], s68 offen sc1
  buffer_load_dword v100, v4, s[60:63], s68 offen sc1
  s_add_u32 s68, s68, 16640
  buffer_load_dwordx4 v[104:107], v3, s[60:63], s68 offen sc1
  buffer_load_dword v108, v4, s[60:63], s68 offen sc1
  s_add_u32 s68, s68, 16640
  buffer_load_dwordx4 v[112:115], v3, s[60:63], s68 offen sc1
  buffer_load_dword v116, v4, s[60:63], s68 offen sc1
  s_add_u32 s68, s68, 16640
  buffer_load_dwordx4 v[120:123], v3, s[60:63], s68 offen sc1
  buffer_load_dword v124, v4, s[60:63], s68 offen sc1
  s_add_u32 s68, s68, 16640
  buffer_load_dwordx4 v[128:131], v3, s[60:63], s68 offen sc1
  buffer_load_dword v132, v4, s[60:63], s68 offen sc1
  s_add_u32 s68, s68, 16640
  buffer_load_dwordx4 v[136:139], v3, s[60:63], s68 offen sc1
  buffer_load_dword v140, v4, s[60:63], s68 offen sc1
  s_add_u32 s68, s68, 16640
  buffer_load_dwordx4 v[144:147], v3, s[60:63], s68 offen sc1
  buffer_load_dword v148, v4, s[60:63], s68 offen sc1
  s_add_u32 s68, s68, 16640
  buffer_load_dwordx4 v[152:155], v3, s[60:63], s68 offen sc1
  buffer_load_dword v156, v4, s[60:63], s68 offen sc1
  s_add_u32 s68, s68, 16640
  buffer_load_dwordx4 v[160:163], v3, s[60:63], s68 offen sc1
  buffer_load_dword v164, v4, s[60:63], s68 offen sc1
  s_add_u32 s68, s68, 16640
  buffer_load_dwordx4 v[168:171], v3, s[60:63], s68 offen sc1
  buffer_load_dword v172, v4, s[60:63], s68 offen sc1
  s_add_u32 s68, s68, 16640
L_sum:
  s_waitcnt vmcnt(25)
  v_pk_add_f32 v[56:57], v[64:65], v[72:73]
  v_pk_add_f32 v[58:59], v[66:67], v[74:75]
  s_waitcnt vmcnt(24)
  v_add_f32 v60, v68, v76
  s_waitcnt vmcnt(23)
  v_pk_add_f32 v[56:57], v[56:57], v[80:81]
  v_pk_add_f32 v[58:59], v[58:59], v[82:83]
  s_waitcnt vmcnt(22)
  v_add_f32 v60, v60, v84
  s_waitcnt vmcnt(21)
  v_pk_add_f32 v[56:57], v[56:57], v[88:89]
  v_pk_add_f32 v[58:59], v[58:59], v[90:91]
  s_waitcnt vmcnt(20)
  v_add_f32 v60, v60, v92
  s_waitcnt vmcnt(19)
  v_pk_add_f32 v[56:57], v[56:57], v[96:97]
  v_pk_add_f32 v[58:59], v[58:59], v[98:99]
  s_waitcnt vmcnt(18)
  v_add_f32 v60, v60, v100
  s_waitcnt vmcnt(17)
  v_pk_add_f32 v[56:57], v[56:57], v[104:105]
  v_pk_add_f32 v[58:59], v[58:59], v[106:107]
  s_waitcnt vmcnt(16)
  v_add_f32_e64 v60, v60, v108
  s_waitcnt vmcnt(15)
  v_pk_add_f32 v[56:57], v[56:57], v[112:113]
  v_pk_add_f32 v[58:59], v[58:59], v[114:115]
  s_waitcnt vmcnt(14)
  v_add_f32 v60, v60, v116
  s_waitcnt vmcnt(13)
  v_pk_add_f32 v[56:57], v[56:57], v[120:121]
  v_pk_add_f32 v[58:59], v[58:59], v[122:123]
  s_waitcnt vmcnt(12)
  v_add_f32 v60, v60, v124
  s_waitcnt vmcnt(11)
  v_pk_add_f32 v[56:57], v[56:57], v[128:129]
  v_pk_add_f32 v[58:59], v[58:59], v[130:131]
  s_waitcnt vmcnt(10)
  v_add_f32 v60, v60, v132
  s_waitcnt vmcnt(9)
  v_pk_add_f32 v[56:57], v[56:57], v[136:137]
  v_pk_add_f32 v[58:59], v[58:59], v[138:139]
  s_waitcnt vmcnt(8)
  v_add_f32 v60, v60, v140
  s_waitcnt vmcnt(7)
  v_pk_add_f32 v[56:57], v[56:57], v[144:145]
  v_pk_add_f32 v[58:59], v[58:59], v[146:147]
  s_waitcnt vmcnt(6)
  v_add_f32 v60, v60, v148
  s_waitcnt vmcnt(5)
  v_pk_add_f32 v[56:57], v[56:57], v[152:153]
  v_pk_add_f32 v[58:59], v[58:59], v[154:155]
  s_waitcnt vmcnt(4)
  v_add_f32 v60, v60, v156
  s_waitcnt vmcnt(3)
  v_pk_add_f32 v[56:57], v[56:57], v[160:161]
  v_pk_add_f32 v[58:59], v[58:59], v[162:163]
  s_waitcnt vmcnt(2)
  v_add_f32 v60, v60, v164
  s_waitcnt vmcnt(1)
  v_pk_add_f32 v[56:57], v[56:57], v[168:169]
  v_pk_add_f32 v[58:59], v[58:59], v[170:171]
  s_waitcnt vmcnt(0)
  v_add_f32 v60, v60, v172
  v_cmp_u_f32 vcc, v56, v57
  v_cmp_u_f32 s[92:93], v58, v59
  s_nop 0
  s_or_b64 s[92:93], s[92:93], vcc
  v_cmp_u_f32 vcc, v60, v60
  s_nop 0
  s_or_b64 vcc, s[92:93], vcc
  s_cbranch_vccnz L_chk
L_ok:
  s_mul_i32 s71, s71, 640
  v_add_f32 v56, s80, v56
  v_add_f32 v57, s80, v57
  v_add_f32 v58, s80, v58
  v_add_f32 v59, s80, v59
  v_add_f32_e64 v60, s80, v60
  v_cvt_pk_bf16_f32 v10, v56, v57
  v_cvt_pk_bf16_f32 v11, v58, v59
  v_cvt_pk_bf16_f32 v12, v60, v60
  buffer_store_dwordx2 v[10:11], v1, s[56:59], s71 offen
  buffer_store_short v12, v2, s[56:59], s71 offen
  s_branch L_fin
L_chk:
  v_mov_b32 v14, 0
  v_mov_b32 v15, 0
  v_max3_u32 v14, v14, v64, v65
  v_max3_u32 v14, v14, v66, v67
  v_max_u32 v15, v15, v68
  v_max3_u32 v14, v14, v72, v73
  v_max3_u32 v14, v14, v74, v75
  v_max_u32_e64 v15, v15, v76
  v_max3_u32 v14, v14, v80, v81
  v_max3_u32 v14, v14, v82, v83
  v_max_u32 v15, v15, v84
  v_max3_u32 v14, v14, v88, v89
  v_max3_u32 v14, v14, v90, v91
  v_max_u32 v15, v15, v92
  v_max3_u32 v14, v14, v96, v97
  v_max3_u32 v14, v14, v98, v99
  v_max_u32_e64 v15, v15, v100
  v_max3_u32 v14, v14, v104, v105
  v_max3_u32 v14, v14, v106, v107
  v_max_u32 v15, v15, v108
  v_max3_u32 v14, v14, v112, v113
  v_max3_u32 v14, v14, v114, v115
  v_max_u32 v15, v15, v116
  v_max3_u32 v14, v14, v120, v121
  v_max3_u32 v14, v14, v122, v123
  v_max_u32_e64 v15, v15, v124
  v_max3_u32 v14, v14, v128, v129
  v_max3_u32 v14, v14, v130, v131
  v_max_u32 v15, v15, v132
  v_max3_u32 v14, v14, v136, v137
  v_max3_u32 v14, v14, v138, v139
  v_max_u32 v15, v15, v140
  v_max3_u32 v14, v14, v144, v145
  v_max3_u32 v14, v14, v146, v147
  v_max_u32_e64 v15, v15, v148
  v_max3_u32 v14, v14, v152, v153
  v_max3_u32 v14, v14, v154, v155
  v_max_u32 v15, v15, v156
  v_max3_u32 v14, v14, v160, v161
  v_max3_u32 v14, v14, v162, v163
  v_max_u32 v15, v15, v164
  v_max3_u32 v14, v14, v168, v169
  v_max3_u32 v14, v14, v170, v171
  v_max_u32 v15, v15, v172
  s_cmp_eq_u32 s71, 12
  s_cselect_b32 s68, 0, -1
  v_and_b32 v15, s68, v15
  v_max_u32 v14, v14, v15
  v_cmp_eq_u32 vcc, -1, v14
  s_cbranch_vccnz L_again
  s_branch L_ok
L_done:
  s_endpgm
L_cin_done:
  s_mul_i32 s98, s3, 1536
  s_add_u32 s98, s98, 116736
  v_lshlrev_b32 v120, 5, v0
  v_add_u32_e64 v120, s98, v120
  ds_read_b128 v[60:63], v120
  ds_read_b128 v[64:67], v120 offset:16
  v_mul_f32 v116, v184, v192
  v_mul_f32 v117, v185, v193
  v_mul_f32 v118, v186, v194
  v_mul_f32 v119, v187, v195
  v_fmac_f32 v116, v188, v191
  v_fmac_f32 v117, v200, v208
  v_fmac_f32 v118, v201, v209
  v_fmac_f32 v119, v202, v210
  v_fmac_f32 v116, v203, v211
  v_fmac_f32 v117, v204, v207
  v_fmac_f32 v118, v216, v224
  v_fmac_f32 v119, v217, v225
  v_fmac_f32 v116, v218, v226
  v_fmac_f32 v117, v219, v227
  v_fmac_f32 v118, v220, v223
  v_fmac_f32 v119, v232, v240
  v_fmac_f32 v116, v233, v241
  v_fmac_f32 v117, v234, v242
  v_fmac_f32 v118, v235, v243
  v_fmac_f32 v119, v236, v239
  v_fmac_f32 v116, v189, v196
  v_fmac_f32 v117, v189, v197
  v_fmac_f32 v118, v190, v198
  v_fmac_f32 v119, v190, v199
  v_fmac_f32 v116, v205, v212
  v_fmac_f32 v117, v205, v213
  v_fmac_f32 v118, v206, v214
  v_fmac_f32 v119, v206, v215
  v_fmac_f32 v116, v221, v228
  v_fmac_f32 v117, v221, v229
  v_fmac_f32 v118, v222, v230
  v_fmac_f32 v119, v222, v231
  v_fmac_f32 v116, v237, v244
  v_fmac_f32 v117, v237, v245
  v_fmac_f32 v118, v238, v246
  v_fmac_f32 v119, v238, v247
  v_add_f32 v116, v116, v117
  v_add_f32 v118, v118, v119
  v_add_f32 v116, v116, v118
  v_mul_f32 v116, s74, v116
  v_mul_f32 v116, s75, v116
  s_nop 1
  v_add_f32_dpp v116, v116, v116 row_shr:1 row_mask:0xf bank_mask:0xf
  v_subrev_u32 v122, s98, v7
  v_lshrrev_b32 v122, 8, v122
  v_lshrrev_b32 v121, 3, v0
  v_add_f32_dpp v116, v116, v116 row_shr:2 row_mask:0xf bank_mask:0xf
  v_cmp_gt_u32 vcc, v122, v121
  v_min_u32 v121, v121, v122
  v_lshlrev_b32 v121, 4, v121
  v_add_f32_dpp v116, v116, v116 row_shr:4 row_mask:0xf bank_mask:0xf
  v_add_u32 v121, s85, v121
  s_waitcnt lgkmcnt(1)
  v_add_f32 v60, v60, v61
  v_add_f32 v62, v62, v63
  v_add_f32_dpp v116, v116, v116 row_shr:8 row_mask:0xf bank_mask:0xf
  s_waitcnt lgkmcnt(0)
  v_add_f32 v64, v64, v65
  v_add_f32 v66, v66, v67
  v_add_f32 v60, v60, v62
  v_add_f32_dpp v116, v116, v116 row_bcast:15 row_mask:0xa bank_mask:0xf
  v_add_f32 v64, v64, v66
  v_add_f32_e64 v60, v60, v64
  s_nop 1
  v_add_f32_dpp v60, v60, v60 quad_perm:[1,0,3,2] row_mask:0xf bank_mask:0xf
  v_add_f32_dpp v116, v116, v116 row_bcast:31 row_mask:0xc bank_mask:0xf
  s_nop 0
  v_add_f32_dpp v60, v60, v60 quad_perm:[2,3,0,1] row_mask:0xf bank_mask:0xf
  s_nop 1
  v_add_f32_dpp v60, v60, v60 row_half_mirror row_mask:0xf bank_mask:0xf
  v_cndmask_b32 v60, v116, v60, vcc
  s_bitset1_b32 vcc_hi, 31
  s_mov_b64 exec, vcc
  ds_write_b32 v121, v60
  s_mov_b64 exec, -1
  s_cmp_eq_u32 s3, 0
  s_cbranch_scc1 L_cpub
  s_waitcnt lgkmcnt(0)
  s_barrier
  s_endpgm
L_cpub:
  s_load_dword s80, s[18:19], 0
  s_mov_b32 s60, s24
  s_and_b32 s61, s25, 0xffff
  s_mov_b32 s62, 268435456
  s_mov_b32 s63, 0x20000
  s_mov_b32 s56, s20
  s_and_b32 s57, s21, 0xffff
  s_mov_b32 s58, 8192
  s_mov_b32 s59, 0x20000
  s_mov_b32 s64, s22
  s_and_b32 s65, s23, 0xffff
  s_mov_b32 s66, 256
  s_mov_b32 s67, 0x20000
  v_lshlrev_b32 v6, 2, v0
  v_add_u32 v2, 129728, v6
  v_add_u32 v4, 1024, v6
  s_mul_i32 s69, s26, 192
  s_add_u32 s69, s69, 216320
  v_mov_b32 v13, -1
  s_mov_b32 exec_hi, 0xffff
  buffer_store_dword v13, v6, s[60:63], s69 offen sc1
  s_mov_b64 exec, 1
  buffer_load_dword v250, v6, s[56:59], 0 offen
  buffer_load_dword v251, v6, s[64:67], 0 offen offset:240 sc1
  s_mov_b64 exec, -1
  s_mul_i32 s68, s26, 3
  s_mul_i32 s70, s68, 3277
  s_lshr_b32 s70, s70, 16
  v_add_u32 v7, s70, v0
  s_mul_i32 s70, s70, 20
  s_add_u32 s70, s70, 20
  s_sub_u32 s70, s70, s68
  s_min_u32 s70, s70, 3
  s_sub_u32 s68, 3, s70
  v_mov_b32 v5, s68
  v_writelane_b32 v5, s70, 0
  s_cmp_eq_u32 s68, 0
  s_cselect_b32 s68, 1, 3
  s_waitcnt vmcnt(2)
  v_lshlrev_b32 v3, 4, v0
  s_mov_b32 exec_hi, 0xffff
  s_waitcnt vmcnt(0) lgkmcnt(0)
  s_barrier
  ds_read_b32 v64, v2
  s_waitcnt lgkmcnt(0)
  v_min_u32_e64 v64, -2, v64
  buffer_store_dword v64, v6, s[60:63], s69 offen sc1
  s_mov_b32 exec_lo, s68
  s_mov_b32 exec_hi, 0
  s_branch L_pub
L_dnn_loop1:
  s_barrier
L_ld_in:
  s_add_u32 m0, s75, 131072
  s_nop 0
  buffer_load_dwordx4 v4, s[44:47], s74 offen lds
  s_add_u32 m0, s75, 132096
  s_nop 0
  buffer_load_dwordx4 v5, s[44:47], s74 offen lds
  s_add_u32 s74, s74, 106496
  s_add_u32 m0, s75, 139264
  s_nop 0
  buffer_load_dwordx4 v4, s[44:47], s74 offen lds
  s_add_u32 m0, s75, 140288
  s_nop 0
  buffer_load_dwordx4 v5, s[44:47], s74 offen lds
  s_add_u32 s74, s74, 106496
  s_add_u32 m0, s76, 0
  s_nop 0
  buffer_load_dwordx4 v56, s[32:35], 0 offen lds
  s_add_u32 m0, s76, 2048
  v_add_u32_dpp v56, v16, v2 row_newbcast:1 row_mask:0xf bank_mask:0x3
  buffer_load_dwordx4 v57, s[32:35], 0 offen lds
  s_nop 0
  v_add_u32_dpp v56, v18, v2 row_newbcast:7 row_mask:0xf bank_mask:0xc
  s_add_u32 m0, s76, 4096
  v_add_u32_dpp v57, v20, v2 row_newbcast:1 row_mask:0xf bank_mask:0x3
  buffer_load_dwordx4 v58, s[32:35], 0 offen lds
  s_nop 0
  v_add_u32_dpp v57, v22, v2 row_newbcast:7 row_mask:0xf bank_mask:0xc
  s_add_u32 m0, s76, 6144
  v_add_u32_dpp v58, v24, v2 row_newbcast:1 row_mask:0xf bank_mask:0x3
  buffer_load_dwordx4 v59, s[32:35], 0 offen lds
  s_nop 0
  v_add_u32_dpp v58, v26, v2 row_newbcast:7 row_mask:0xf bank_mask:0xc
  s_add_u32 m0, s76, 8192
  v_add_u32_dpp v59, v28, v2 row_newbcast:1 row_mask:0xf bank_mask:0x3
  buffer_load_dwordx4 v60, s[32:35], 0 offen lds
  s_nop 0
  v_add_u32_dpp v59, v30, v2 row_newbcast:7 row_mask:0xf bank_mask:0xc
  s_add_u32 m0, s76, 10240
  v_add_u32_dpp v60, v32, v2 row_newbcast:1 row_mask:0xf bank_mask:0x3
  buffer_load_dwordx4 v61, s[32:35], 0 offen lds
  s_nop 0
  v_add_u32_dpp v60, v34, v2 row_newbcast:7 row_mask:0xf bank_mask:0xc
  s_add_u32 m0, s76, 12288
  v_add_u32_dpp v61, v36, v2 row_newbcast:1 row_mask:0xf bank_mask:0x3
  buffer_load_dwordx4 v62, s[32:35], 0 offen lds
  s_nop 0
  v_add_u32_dpp v61, v38, v2 row_newbcast:7 row_mask:0xf bank_mask:0xc
  s_add_u32 m0, s76, 14336
  v_add_u32_dpp v62, v40, v2 row_newbcast:1 row_mask:0xf bank_mask:0x3
  buffer_load_dwordx4 v63, s[32:35], 0 offen lds
  s_nop 0
  v_add_u32_dpp v62, v42, v2 row_newbcast:7 row_mask:0xf bank_mask:0xc
  s_add_u32 m0, s76, 16384
  v_add_u32_dpp v63, v44, v2 row_newbcast:1 row_mask:0xf bank_mask:0x3
  buffer_load_dwordx4 v64, s[32:35], 0 offen lds
  s_nop 0
  v_add_u32_dpp v63, v46, v2 row_newbcast:7 row_mask:0xf bank_mask:0xc
  s_add_u32 m0, s76, 18432
  v_add_u32_dpp v64, v48, v2 row_newbcast:1 row_mask:0xf bank_mask:0x3
  buffer_load_dwordx4 v65, s[32:35], 0 offen lds
  s_nop 0
  v_add_u32_dpp v64, v50, v2 row_newbcast:7 row_mask:0xf bank_mask:0xc
  v_add_u32_dpp v65, v52, v2 row_newbcast:1 row_mask:0xf bank_mask:0x3
  s_nop 1
  v_add_u32_dpp v65, v54, v2 row_newbcast:7 row_mask:0xf bank_mask:0xc
  s_waitcnt vmcnt(10)
  s_barrier
  s_add_u32 m0, s75, 147456
  s_nop 0
  buffer_load_dwordx4 v4, s[44:47], s74 offen lds
  s_add_u32 m0, s75, 148480
  s_nop 0
  buffer_load_dwordx4 v5, s[44:47], s74 offen lds
  s_add_u32 s74, s74, 106496
  s_add_u32 m0, s75, 155648
  s_nop 0
  buffer_load_dwordx4 v4, s[44:47], s74 offen lds
  s_add_u32 m0, s75, 156672
  s_nop 0
  buffer_load_dwordx4 v5, s[44:47], s74 offen lds
  s_add_u32 s74, s74, 106496
  s_add_u32 m0, s76, 40960
  s_nop 0
  buffer_load_dwordx4 v56, s[32:35], 0 offen lds
  s_add_u32 m0, s76, 43008
  v_add_u32_dpp v56, v17, v2 row_newbcast:1 row_mask:0xf bank_mask:0x3
  buffer_load_dwordx4 v57, s[32:35], 0 offen lds
  s_nop 0
  v_add_u32_dpp v56, v19, v2 row_newbcast:7 row_mask:0xf bank_mask:0xc
  s_add_u32 m0, s76, 45056
  v_add_u32_dpp v57, v21, v2 row_newbcast:1 row_mask:0xf bank_mask:0x3
  buffer_load_dwordx4 v58, s[32:35], 0 offen lds
  s_nop 0
  v_add_u32_dpp v57, v23, v2 row_newbcast:7 row_mask:0xf bank_mask:0xc
  s_add_u32 m0, s76, 47104
  v_add_u32_dpp v58, v25, v2 row_newbcast:1 row_mask:0xf bank_mask:0x3
  buffer_load_dwordx4 v59, s[32:35], 0 offen lds
  s_nop 0
  v_add_u32_dpp v58, v27, v2 row_newbcast:7 row_mask:0xf bank_mask:0xc
  s_add_u32 m0, s76, 49152
  v_add_u32_dpp v59, v29, v2 row_newbcast:1 row_mask:0xf bank_mask:0x3
  buffer_load_dwordx4 v60, s[32:35], 0 offen lds
  s_nop 0
  v_add_u32_dpp v59, v31, v2 row_newbcast:7 row_mask:0xf bank_mask:0xc
  s_add_u32 m0, s76, 51200
  v_add_u32_dpp v60, v33, v2 row_newbcast:1 row_mask:0xf bank_mask:0x3
  buffer_load_dwordx4 v61, s[32:35], 0 offen lds
  s_nop 0
  v_add_u32_dpp v60, v35, v2 row_newbcast:7 row_mask:0xf bank_mask:0xc
  s_add_u32 m0, s76, 53248
  v_add_u32_dpp v61, v37, v2 row_newbcast:1 row_mask:0xf bank_mask:0x3
  buffer_load_dwordx4 v62, s[32:35], 0 offen lds
  s_nop 0
  v_add_u32_dpp v61, v39, v2 row_newbcast:7 row_mask:0xf bank_mask:0xc
  s_add_u32 m0, s76, 55296
  v_add_u32_dpp v62, v41, v2 row_newbcast:1 row_mask:0xf bank_mask:0x3
  buffer_load_dwordx4 v63, s[32:35], 0 offen lds
  s_nop 0
  v_add_u32_dpp v62, v43, v2 row_newbcast:7 row_mask:0xf bank_mask:0xc
  s_add_u32 m0, s76, 57344
  v_add_u32_dpp v63, v45, v2 row_newbcast:1 row_mask:0xf bank_mask:0x3
  buffer_load_dwordx4 v64, s[32:35], 0 offen lds
  s_nop 0
  v_add_u32_dpp v63, v47, v2 row_newbcast:7 row_mask:0xf bank_mask:0xc
  s_add_u32 m0, s76, 59392
  v_add_u32_dpp v64, v49, v2 row_newbcast:1 row_mask:0xf bank_mask:0x3
  buffer_load_dwordx4 v65, s[32:35], 0 offen lds
  s_nop 0
  v_add_u32_dpp v64, v51, v2 row_newbcast:7 row_mask:0xf bank_mask:0xc
  v_add_u32_dpp v65, v53, v2 row_newbcast:1 row_mask:0xf bank_mask:0x3
  s_nop 1
  v_add_u32_dpp v65, v55, v2 row_newbcast:7 row_mask:0xf bank_mask:0xc
  s_waitcnt vmcnt(10)
  s_barrier
  s_add_u32 m0, s75, 131072
  s_nop 0
  buffer_load_dwordx4 v4, s[44:47], s74 offen lds
  s_add_u32 m0, s75, 132096
  s_nop 0
  buffer_load_dwordx4 v5, s[44:47], s74 offen lds
  s_add_u32 s74, s74, 106496
  s_add_u32 m0, s75, 139264
  s_nop 0
  buffer_load_dwordx4 v4, s[44:47], s74 offen lds
  s_add_u32 m0, s75, 140288
  s_nop 0
  buffer_load_dwordx4 v5, s[44:47], s74 offen lds
  s_add_u32 s74, s74, 106496
  s_add_u32 m0, s76, 81920
  s_nop 0
  buffer_load_dwordx4 v56, s[32:35], 0 offen lds
  s_add_u32 m0, s76, 83968
  v_add_u32_dpp v56, v18, v2 row_newbcast:1 row_mask:0xf bank_mask:0x3
  buffer_load_dwordx4 v57, s[32:35], 0 offen lds
  s_nop 0
  v_add_u32_dpp v56, v16, v2 row_newbcast:8 row_mask:0xf bank_mask:0xc
  s_add_u32 m0, s76, 86016
  v_add_u32_dpp v57, v22, v2 row_newbcast:1 row_mask:0xf bank_mask:0x3
  buffer_load_dwordx4 v58, s[32:35], 0 offen lds
  s_nop 0
  v_add_u32_dpp v57, v20, v2 row_newbcast:8 row_mask:0xf bank_mask:0xc
  s_add_u32 m0, s76, 88064
  v_add_u32_dpp v58, v26, v2 row_newbcast:1 row_mask:0xf bank_mask:0x3
  buffer_load_dwordx4 v59, s[32:35], 0 offen lds
  s_nop 0
  v_add_u32_dpp v58, v24, v2 row_newbcast:8 row_mask:0xf bank_mask:0xc
  s_add_u32 m0, s76, 90112
  v_add_u32_dpp v59, v30, v2 row_newbcast:1 row_mask:0xf bank_mask:0x3
  buffer_load_dwordx4 v60, s[32:35], 0 offen lds
  s_nop 0
  v_add_u32_dpp v59, v28, v2 row_newbcast:8 row_mask:0xf bank_mask:0xc
  s_add_u32 m0, s76, 92160
  v_add_u32_dpp v60, v34, v2 row_newbcast:1 row_mask:0xf bank_mask:0x3
  buffer_load_dwordx4 v61, s[32:35], 0 offen lds
  s_nop 0
  v_add_u32_dpp v60, v32, v2 row_newbcast:8 row_mask:0xf bank_mask:0xc
  s_add_u32 m0, s76, 94208
  v_add_u32_dpp v61, v38, v2 row_newbcast:1 row_mask:0xf bank_mask:0x3
  buffer_load_dwordx4 v62, s[32:35], 0 offen lds
  s_nop 0
  v_add_u32_dpp v61, v36, v2 row_newbcast:8 row_mask:0xf bank_mask:0xc
  s_add_u32 m0, s76, 96256
  v_add_u32_dpp v62, v42, v2 row_newbcast:1 row_mask:0xf bank_mask:0x3
  buffer_load_dwordx4 v63, s[32:35], 0 offen lds
  s_nop 0
  v_add_u32_dpp v62, v40, v2 row_newbcast:8 row_mask:0xf bank_mask:0xc
  s_add_u32 m0, s76, 98304
  v_add_u32_dpp v63, v46, v2 row_newbcast:1 row_mask:0xf bank_mask:0x3
  buffer_load_dwordx4 v64, s[32:35], 0 offen lds
  s_nop 0
  v_add_u32_dpp v63, v44, v2 row_newbcast:8 row_mask:0xf bank_mask:0xc
  s_add_u32 m0, s76, 100352
  v_add_u32_dpp v64, v50, v2 row_newbcast:1 row_mask:0xf bank_mask:0x3
  buffer_load_dwordx4 v65, s[32:35], 0 offen lds
  s_nop 0
  v_add_u32_dpp v64, v48, v2 row_newbcast:8 row_mask:0xf bank_mask:0xc
  v_add_u32_dpp v65, v54, v2 row_newbcast:1 row_mask:0xf bank_mask:0x3
  s_nop 1
  v_add_u32_dpp v65, v52, v2 row_newbcast:8 row_mask:0xf bank_mask:0xc
  s_waitcnt vmcnt(10)
  s_barrier
  s_add_u32 m0, s75, 147456
  s_nop 0
  buffer_load_dwordx4 v4, s[44:47], s74 offen lds
  s_add_u32 m0, s75, 148480
  s_nop 0
  buffer_load_dwordx4 v5, s[44:47], s74 offen lds
  s_add_u32 s74, s74, 106496
  s_add_u32 m0, s75, 155648
  s_nop 0
  buffer_load_dwordx4 v4, s[44:47], s74 offen lds
  s_add_u32 m0, s75, 156672
  s_nop 0
  buffer_load_dwordx4 v5, s[44:47], s74 offen lds
  s_add_u32 s74, s74, 106496
  s_add_u32 m0, s76, 0
  s_nop 0
  buffer_load_dwordx4 v56, s[32:35], 0 offen lds
  s_add_u32 m0, s76, 2048
  v_add_u32_dpp v56, v19, v2 row_newbcast:1 row_mask:0xf bank_mask:0x3
  buffer_load_dwordx4 v57, s[32:35], 0 offen lds
  s_nop 0
  v_add_u32_dpp v56, v17, v2 row_newbcast:8 row_mask:0xf bank_mask:0xc
  s_add_u32 m0, s76, 4096
  v_add_u32_dpp v57, v23, v2 row_newbcast:1 row_mask:0xf bank_mask:0x3
  buffer_load_dwordx4 v58, s[32:35], 0 offen lds
  s_nop 0
  v_add_u32_dpp v57, v21, v2 row_newbcast:8 row_mask:0xf bank_mask:0xc
  s_add_u32 m0, s76, 6144
  v_add_u32_dpp v58, v27, v2 row_newbcast:1 row_mask:0xf bank_mask:0x3
  buffer_load_dwordx4 v59, s[32:35], 0 offen lds
  s_nop 0
  v_add_u32_dpp v58, v25, v2 row_newbcast:8 row_mask:0xf bank_mask:0xc
  s_add_u32 m0, s76, 8192
  v_add_u32_dpp v59, v31, v2 row_newbcast:1 row_mask:0xf bank_mask:0x3
  buffer_load_dwordx4 v60, s[32:35], 0 offen lds
  s_nop 0
  v_add_u32_dpp v59, v29, v2 row_newbcast:8 row_mask:0xf bank_mask:0xc
  s_add_u32 m0, s76, 10240
  v_add_u32_dpp v60, v35, v2 row_newbcast:1 row_mask:0xf bank_mask:0x3
  buffer_load_dwordx4 v61, s[32:35], 0 offen lds
  s_nop 0
  v_add_u32_dpp v60, v33, v2 row_newbcast:8 row_mask:0xf bank_mask:0xc
  s_add_u32 m0, s76, 12288
  v_add_u32_dpp v61, v39, v2 row_newbcast:1 row_mask:0xf bank_mask:0x3
  buffer_load_dwordx4 v62, s[32:35], 0 offen lds
  s_nop 0
  v_add_u32_dpp v61, v37, v2 row_newbcast:8 row_mask:0xf bank_mask:0xc
  s_add_u32 m0, s76, 14336
  v_add_u32_dpp v62, v43, v2 row_newbcast:1 row_mask:0xf bank_mask:0x3
  buffer_load_dwordx4 v63, s[32:35], 0 offen lds
  s_nop 0
  v_add_u32_dpp v62, v41, v2 row_newbcast:8 row_mask:0xf bank_mask:0xc
  s_add_u32 m0, s76, 16384
  v_add_u32_dpp v63, v47, v2 row_newbcast:1 row_mask:0xf bank_mask:0x3
  buffer_load_dwordx4 v64, s[32:35], 0 offen lds
  s_nop 0
  v_add_u32_dpp v63, v45, v2 row_newbcast:8 row_mask:0xf bank_mask:0xc
  s_add_u32 m0, s76, 18432
  v_add_u32_dpp v64, v51, v2 row_newbcast:1 row_mask:0xf bank_mask:0x3
  buffer_load_dwordx4 v65, s[32:35], 0 offen lds
  s_nop 0
  v_add_u32_dpp v64, v49, v2 row_newbcast:8 row_mask:0xf bank_mask:0xc
  v_add_u32_dpp v65, v55, v2 row_newbcast:1 row_mask:0xf bank_mask:0x3
  s_nop 1
  v_add_u32_dpp v65, v53, v2 row_newbcast:8 row_mask:0xf bank_mask:0xc
  s_waitcnt vmcnt(10)
  s_barrier
  s_add_u32 m0, s75, 131072
  s_nop 0
  buffer_load_dwordx4 v4, s[44:47], s74 offen lds
  s_add_u32 m0, s75, 132096
  s_nop 0
  buffer_load_dwordx4 v5, s[44:47], s74 offen lds
  s_add_u32 s74, s74, 106496
  s_add_u32 m0, s75, 139264
  s_nop 0
  buffer_load_dwordx4 v4, s[44:47], s74 offen lds
  s_add_u32 m0, s75, 140288
  s_nop 0
  buffer_load_dwordx4 v5, s[44:47], s74 offen lds
  s_add_u32 s74, s74, 106496
  s_add_u32 m0, s76, 40960
  s_nop 0
  buffer_load_dwordx4 v56, s[32:35], 0 offen lds
  s_add_u32 m0, s76, 43008
  v_add_u32_dpp v56, v16, v2 row_newbcast:2 row_mask:0xf bank_mask:0x3
  buffer_load_dwordx4 v57, s[32:35], 0 offen lds
  s_nop 0
  v_add_u32_dpp v56, v18, v2 row_newbcast:8 row_mask:0xf bank_mask:0xc
  s_add_u32 m0, s76, 45056
  v_add_u32_dpp v57, v20, v2 row_newbcast:2 row_mask:0xf bank_mask:0x3
  buffer_load_dwordx4 v58, s[32:35], 0 offen lds
  s_nop 0
  v_add_u32_dpp v57, v22, v2 row_newbcast:8 row_mask:0xf bank_mask:0xc
  s_add_u32 m0, s76, 47104
  v_add_u32_dpp v58, v24, v2 row_newbcast:2 row_mask:0xf bank_mask:0x3
  buffer_load_dwordx4 v59, s[32:35], 0 offen lds
  s_nop 0
  v_add_u32_dpp v58, v26, v2 row_newbcast:8 row_mask:0xf bank_mask:0xc
  s_add_u32 m0, s76, 49152
  v_add_u32_dpp v59, v28, v2 row_newbcast:2 row_mask:0xf bank_mask:0x3
  buffer_load_dwordx4 v60, s[32:35], 0 offen lds
  s_nop 0
  v_add_u32_dpp v59, v30, v2 row_newbcast:8 row_mask:0xf bank_mask:0xc
  s_add_u32 m0, s76, 51200
  v_add_u32_dpp v60, v32, v2 row_newbcast:2 row_mask:0xf bank_mask:0x3
  buffer_load_dwordx4 v61, s[32:35], 0 offen lds
  s_nop 0
  v_add_u32_dpp v60, v34, v2 row_newbcast:8 row_mask:0xf bank_mask:0xc
  s_add_u32 m0, s76, 53248
  v_add_u32_dpp v61, v36, v2 row_newbcast:2 row_mask:0xf bank_mask:0x3
  buffer_load_dwordx4 v62, s[32:35], 0 offen lds
  s_nop 0
  v_add_u32_dpp v61, v38, v2 row_newbcast:8 row_mask:0xf bank_mask:0xc
  s_add_u32 m0, s76, 55296
  v_add_u32_dpp v62, v40, v2 row_newbcast:2 row_mask:0xf bank_mask:0x3
  buffer_load_dwordx4 v63, s[32:35], 0 offen lds
  s_nop 0
  v_add_u32_dpp v62, v42, v2 row_newbcast:8 row_mask:0xf bank_mask:0xc
  s_add_u32 m0, s76, 57344
  v_add_u32_dpp v63, v44, v2 row_newbcast:2 row_mask:0xf bank_mask:0x3
  buffer_load_dwordx4 v64, s[32:35], 0 offen lds
  s_nop 0
  v_add_u32_dpp v63, v46, v2 row_newbcast:8 row_mask:0xf bank_mask:0xc
  s_add_u32 m0, s76, 59392
  v_add_u32_dpp v64, v48, v2 row_newbcast:2 row_mask:0xf bank_mask:0x3
  buffer_load_dwordx4 v65, s[32:35], 0 offen lds
  s_nop 0
  v_add_u32_dpp v64, v50, v2 row_newbcast:8 row_mask:0xf bank_mask:0xc
  v_add_u32_dpp v65, v52, v2 row_newbcast:2 row_mask:0xf bank_mask:0x3
  s_nop 1
  v_add_u32_dpp v65, v54, v2 row_newbcast:8 row_mask:0xf bank_mask:0xc
  s_waitcnt vmcnt(10)
  s_barrier
  s_add_u32 m0, s75, 147456
  s_nop 0
  buffer_load_dwordx4 v4, s[44:47], s74 offen lds
  s_add_u32 m0, s75, 148480
  s_nop 0
  buffer_load_dwordx4 v5, s[44:47], s74 offen lds
  s_add_u32 s74, s74, 106496
  s_add_u32 m0, s75, 155648
  s_nop 0
  buffer_load_dwordx4 v4, s[44:47], s74 offen lds
  s_add_u32 m0, s75, 156672
  s_nop 0
  buffer_load_dwordx4 v5, s[44:47], s74 offen lds
  s_add_u32 s74, s74, 106496
  s_add_u32 m0, s76, 81920
  s_nop 0
  buffer_load_dwordx4 v56, s[32:35], 0 offen lds
  s_add_u32 m0, s76, 83968
  v_add_u32_dpp v56, v17, v2 row_newbcast:2 row_mask:0xf bank_mask:0x3
  buffer_load_dwordx4 v57, s[32:35], 0 offen lds
  s_nop 0
  v_add_u32_dpp v56, v19, v2 row_newbcast:8 row_mask:0xf bank_mask:0xc
  s_add_u32 m0, s76, 86016
  v_add_u32_dpp v57, v21, v2 row_newbcast:2 row_mask:0xf bank_mask:0x3
  buffer_load_dwordx4 v58, s[32:35], 0 offen lds
  s_nop 0
  v_add_u32_dpp v57, v23, v2 row_newbcast:8 row_mask:0xf bank_mask:0xc
  s_add_u32 m0, s76, 88064
  v_add_u32_dpp v58, v25, v2 row_newbcast:2 row_mask:0xf bank_mask:0x3
  buffer_load_dwordx4 v59, s[32:35], 0 offen lds
  s_nop 0
  v_add_u32_dpp v58, v27, v2 row_newbcast:8 row_mask:0xf bank_mask:0xc
  s_add_u32 m0, s76, 90112
  v_add_u32_dpp v59, v29, v2 row_newbcast:2 row_mask:0xf bank_mask:0x3
  buffer_load_dwordx4 v60, s[32:35], 0 offen lds
  s_nop 0
  v_add_u32_dpp v59, v31, v2 row_newbcast:8 row_mask:0xf bank_mask:0xc
  s_add_u32 m0, s76, 92160
  v_add_u32_dpp v60, v33, v2 row_newbcast:2 row_mask:0xf bank_mask:0x3
  buffer_load_dwordx4 v61, s[32:35], 0 offen lds
  s_nop 0
  v_add_u32_dpp v60, v35, v2 row_newbcast:8 row_mask:0xf bank_mask:0xc
  s_add_u32 m0, s76, 94208
  v_add_u32_dpp v61, v37, v2 row_newbcast:2 row_mask:0xf bank_mask:0x3
  buffer_load_dwordx4 v62, s[32:35], 0 offen lds
  s_nop 0
  v_add_u32_dpp v61, v39, v2 row_newbcast:8 row_mask:0xf bank_mask:0xc
  s_add_u32 m0, s76, 96256
  v_add_u32_dpp v62, v41, v2 row_newbcast:2 row_mask:0xf bank_mask:0x3
  buffer_load_dwordx4 v63, s[32:35], 0 offen lds
  s_nop 0
  v_add_u32_dpp v62, v43, v2 row_newbcast:8 row_mask:0xf bank_mask:0xc
  s_add_u32 m0, s76, 98304
  v_add_u32_dpp v63, v45, v2 row_newbcast:2 row_mask:0xf bank_mask:0x3
  buffer_load_dwordx4 v64, s[32:35], 0 offen lds
  s_nop 0
  v_add_u32_dpp v63, v47, v2 row_newbcast:8 row_mask:0xf bank_mask:0xc
  s_add_u32 m0, s76, 100352
  v_add_u32_dpp v64, v49, v2 row_newbcast:2 row_mask:0xf bank_mask:0x3
  buffer_load_dwordx4 v65, s[32:35], 0 offen lds
  s_nop 0
  v_add_u32_dpp v64, v51, v2 row_newbcast:8 row_mask:0xf bank_mask:0xc
  v_add_u32_dpp v65, v53, v2 row_newbcast:2 row_mask:0xf bank_mask:0x3
  s_nop 1
  v_add_u32_dpp v65, v55, v2 row_newbcast:8 row_mask:0xf bank_mask:0xc
  s_waitcnt vmcnt(10)
  s_barrier
  s_add_u32 m0, s75, 131072
  s_nop 0
  buffer_load_dwordx4 v4, s[44:47], s74 offen lds
  s_add_u32 m0, s75, 132096
  s_nop 0
  buffer_load_dwordx4 v5, s[44:47], s74 offen lds
  s_add_u32 s74, s74, 106496
  s_add_u32 m0, s75, 139264
  s_nop 0
  buffer_load_dwordx4 v4, s[44:47], s74 offen lds
  s_add_u32 m0, s75, 140288
  s_nop 0
  buffer_load_dwordx4 v5, s[44:47], s74 offen lds
  s_add_u32 s74, s74, 106496
  s_add_u32 m0, s76, 0
  s_nop 0
  buffer_load_dwordx4 v56, s[32:35], 0 offen lds
  s_add_u32 m0, s76, 2048
  v_add_u32_dpp v56, v18, v2 row_newbcast:2 row_mask:0xf bank_mask:0x3
  buffer_load_dwordx4 v57, s[32:35], 0 offen lds
  s_nop 0
  v_add_u32_dpp v56, v16, v2 row_newbcast:9 row_mask:0xf bank_mask:0xc
  s_add_u32 m0, s76, 4096
  v_add_u32_dpp v57, v22, v2 row_newbcast:2 row_mask:0xf bank_mask:0x3
  buffer_load_dwordx4 v58, s[32:35], 0 offen lds
  s_nop 0
  v_add_u32_dpp v57, v20, v2 row_newbcast:9 row_mask:0xf bank_mask:0xc
  s_add_u32 m0, s76, 6144
  v_add_u32_dpp v58, v26, v2 row_newbcast:2 row_mask:0xf bank_mask:0x3
  buffer_load_dwordx4 v59, s[32:35], 0 offen lds
  s_nop 0
  v_add_u32_dpp v58, v24, v2 row_newbcast:9 row_mask:0xf bank_mask:0xc
  s_add_u32 m0, s76, 8192
  v_add_u32_dpp v59, v30, v2 row_newbcast:2 row_mask:0xf bank_mask:0x3
  buffer_load_dwordx4 v60, s[32:35], 0 offen lds
  s_nop 0
  v_add_u32_dpp v59, v28, v2 row_newbcast:9 row_mask:0xf bank_mask:0xc
  s_add_u32 m0, s76, 10240
  v_add_u32_dpp v60, v34, v2 row_newbcast:2 row_mask:0xf bank_mask:0x3
  buffer_load_dwordx4 v61, s[32:35], 0 offen lds
  s_nop 0
  v_add_u32_dpp v60, v32, v2 row_newbcast:9 row_mask:0xf bank_mask:0xc
  s_add_u32 m0, s76, 12288
  v_add_u32_dpp v61, v38, v2 row_newbcast:2 row_mask:0xf bank_mask:0x3
  buffer_load_dwordx4 v62, s[32:35], 0 offen lds
  s_nop 0
  v_add_u32_dpp v61, v36, v2 row_newbcast:9 row_mask:0xf bank_mask:0xc
  s_add_u32 m0, s76, 14336
  v_add_u32_dpp v62, v42, v2 row_newbcast:2 row_mask:0xf bank_mask:0x3
  buffer_load_dwordx4 v63, s[32:35], 0 offen lds
  s_nop 0
  v_add_u32_dpp v62, v40, v2 row_newbcast:9 row_mask:0xf bank_mask:0xc
  s_add_u32 m0, s76, 16384
  v_add_u32_dpp v63, v46, v2 row_newbcast:2 row_mask:0xf bank_mask:0x3
  buffer_load_dwordx4 v64, s[32:35], 0 offen lds
  s_nop 0
  v_add_u32_dpp v63, v44, v2 row_newbcast:9 row_mask:0xf bank_mask:0xc
  s_add_u32 m0, s76, 18432
  v_add_u32_dpp v64, v50, v2 row_newbcast:2 row_mask:0xf bank_mask:0x3
  buffer_load_dwordx4 v65, s[32:35], 0 offen lds
  s_nop 0
  v_add_u32_dpp v64, v48, v2 row_newbcast:9 row_mask:0xf bank_mask:0xc
  v_add_u32_dpp v65, v54, v2 row_newbcast:2 row_mask:0xf bank_mask:0x3
  s_nop 1
  v_add_u32_dpp v65, v52, v2 row_newbcast:9 row_mask:0xf bank_mask:0xc
  s_waitcnt vmcnt(10)
  s_barrier
  s_add_u32 m0, s75, 147456
  s_nop 0
  buffer_load_dwordx4 v4, s[44:47], s74 offen lds
  s_add_u32 m0, s75, 148480
  s_nop 0
  buffer_load_dwordx4 v5, s[44:47], s74 offen lds
  s_add_u32 s74, s74, 106496
  s_add_u32 m0, s75, 155648
  s_nop 0
  buffer_load_dwordx4 v4, s[44:47], s74 offen lds
  s_add_u32 m0, s75, 156672
  s_nop 0
  buffer_load_dwordx4 v5, s[44:47], s74 offen lds
  s_add_u32 s74, s74, 106496
  s_add_u32 m0, s76, 40960
  s_nop 0
  buffer_load_dwordx4 v56, s[32:35], 0 offen lds
  s_add_u32 m0, s76, 43008
  v_add_u32_dpp v56, v19, v2 row_newbcast:2 row_mask:0xf bank_mask:0x3
  buffer_load_dwordx4 v57, s[32:35], 0 offen lds
  s_nop 0
  v_add_u32_dpp v56, v17, v2 row_newbcast:9 row_mask:0xf bank_mask:0xc
  s_add_u32 m0, s76, 45056
  v_add_u32_dpp v57, v23, v2 row_newbcast:2 row_mask:0xf bank_mask:0x3
  buffer_load_dwordx4 v58, s[32:35], 0 offen lds
  s_nop 0
  v_add_u32_dpp v57, v21, v2 row_newbcast:9 row_mask:0xf bank_mask:0xc
  s_add_u32 m0, s76, 47104
  v_add_u32_dpp v58, v27, v2 row_newbcast:2 row_mask:0xf bank_mask:0x3
  buffer_load_dwordx4 v59, s[32:35], 0 offen lds
  s_nop 0
  v_add_u32_dpp v58, v25, v2 row_newbcast:9 row_mask:0xf bank_mask:0xc
  s_add_u32 m0, s76, 49152
  v_add_u32_dpp v59, v31, v2 row_newbcast:2 row_mask:0xf bank_mask:0x3
  buffer_load_dwordx4 v60, s[32:35], 0 offen lds
  s_nop 0
  v_add_u32_dpp v59, v29, v2 row_newbcast:9 row_mask:0xf bank_mask:0xc
  s_add_u32 m0, s76, 51200
  v_add_u32_dpp v60, v35, v2 row_newbcast:2 row_mask:0xf bank_mask:0x3
  buffer_load_dwordx4 v61, s[32:35], 0 offen lds
  s_nop 0
  v_add_u32_dpp v60, v33, v2 row_newbcast:9 row_mask:0xf bank_mask:0xc
  s_add_u32 m0, s76, 53248
  v_add_u32_dpp v61, v39, v2 row_newbcast:2 row_mask:0xf bank_mask:0x3
  buffer_load_dwordx4 v62, s[32:35], 0 offen lds
  s_nop 0
  v_add_u32_dpp v61, v37, v2 row_newbcast:9 row_mask:0xf bank_mask:0xc
  s_add_u32 m0, s76, 55296
  v_add_u32_dpp v62, v43, v2 row_newbcast:2 row_mask:0xf bank_mask:0x3
  buffer_load_dwordx4 v63, s[32:35], 0 offen lds
  s_nop 0
  v_add_u32_dpp v62, v41, v2 row_newbcast:9 row_mask:0xf bank_mask:0xc
  s_add_u32 m0, s76, 57344
  v_add_u32_dpp v63, v47, v2 row_newbcast:2 row_mask:0xf bank_mask:0x3
  buffer_load_dwordx4 v64, s[32:35], 0 offen lds
  s_nop 0
  v_add_u32_dpp v63, v45, v2 row_newbcast:9 row_mask:0xf bank_mask:0xc
  s_add_u32 m0, s76, 59392
  v_add_u32_dpp v64, v51, v2 row_newbcast:2 row_mask:0xf bank_mask:0x3
  buffer_load_dwordx4 v65, s[32:35], 0 offen lds
  s_nop 0
  v_add_u32_dpp v64, v49, v2 row_newbcast:9 row_mask:0xf bank_mask:0xc
  v_add_u32_dpp v65, v55, v2 row_newbcast:2 row_mask:0xf bank_mask:0x3
  s_nop 1
  v_add_u32_dpp v65, v53, v2 row_newbcast:9 row_mask:0xf bank_mask:0xc
  s_waitcnt vmcnt(10)
  s_cmp_lg_u32 s72, 1
  s_cbranch_scc1 L_nolpf
  s_mov_b64 exec, 1048575
  global_load_dword v10, v[8:9], off
  s_mov_b64 exec, -1
  s_mov_b32 m0, 123136
  s_mov_b64 exec, 0xffff
  buffer_load_dwordx4 v11, s[52:55], s77 offen lds
  s_mov_b64 exec, -1
L_nolpf:
  s_barrier
  s_add_u32 m0, s75, 131072
  s_nop 0
  buffer_load_dwordx4 v4, s[44:47], s74 offen lds
  s_add_u32 m0, s75, 132096
  s_nop 0
  buffer_load_dwordx4 v5, s[44:47], s74 offen lds
  s_add_u32 s74, s74, 106496
  s_add_u32 m0, s75, 139264
  s_nop 0
  buffer_load_dwordx4 v4, s[44:47], s74 offen lds
  s_add_u32 m0, s75, 140288
  s_nop 0
  buffer_load_dwordx4 v5, s[44:47], s74 offen lds
  s_add_u32 s74, s74, 106496
  s_add_u32 m0, s76, 81920
  s_nop 0
  buffer_load_dwordx4 v56, s[32:35], 0 offen lds
  s_add_u32 m0, s76, 83968
  v_add_u32_dpp v56, v16, v2 row_newbcast:3 row_mask:0xf bank_mask:0x3
  buffer_load_dwordx4 v57, s[32:35], 0 offen lds
  s_nop 0
  v_add_u32_dpp v56, v18, v2 row_newbcast:9 row_mask:0xf bank_mask:0xc
  s_add_u32 m0, s76, 86016
  v_add_u32_dpp v57, v20, v2 row_newbcast:3 row_mask:0xf bank_mask:0x3
  buffer_load_dwordx4 v58, s[32:35], 0 offen lds
  s_nop 0
  v_add_u32_dpp v57, v22, v2 row_newbcast:9 row_mask:0xf bank_mask:0xc
  s_add_u32 m0, s76, 88064
  v_add_u32_dpp v58, v24, v2 row_newbcast:3 row_mask:0xf bank_mask:0x3
  buffer_load_dwordx4 v59, s[32:35], 0 offen lds
  s_nop 0
  v_add_u32_dpp v58, v26, v2 row_newbcast:9 row_mask:0xf bank_mask:0xc
  s_add_u32 m0, s76, 90112
  v_add_u32_dpp v59, v28, v2 row_newbcast:3 row_mask:0xf bank_mask:0x3
  buffer_load_dwordx4 v60, s[32:35], 0 offen lds
  s_nop 0
  v_add_u32_dpp v59, v30, v2 row_newbcast:9 row_mask:0xf bank_mask:0xc
  s_add_u32 m0, s76, 92160
  v_add_u32_dpp v60, v32, v2 row_newbcast:3 row_mask:0xf bank_mask:0x3
  buffer_load_dwordx4 v61, s[32:35], 0 offen lds
  s_nop 0
  v_add_u32_dpp v60, v34, v2 row_newbcast:9 row_mask:0xf bank_mask:0xc
  s_add_u32 m0, s76, 94208
  v_add_u32_dpp v61, v36, v2 row_newbcast:3 row_mask:0xf bank_mask:0x3
  buffer_load_dwordx4 v62, s[32:35], 0 offen lds
  s_nop 0
  v_add_u32_dpp v61, v38, v2 row_newbcast:9 row_mask:0xf bank_mask:0xc
  s_add_u32 m0, s76, 96256
  v_add_u32_dpp v62, v40, v2 row_newbcast:3 row_mask:0xf bank_mask:0x3
  buffer_load_dwordx4 v63, s[32:35], 0 offen lds
  s_nop 0
  v_add_u32_dpp v62, v42, v2 row_newbcast:9 row_mask:0xf bank_mask:0xc
  s_add_u32 m0, s76, 98304
  v_add_u32_dpp v63, v44, v2 row_newbcast:3 row_mask:0xf bank_mask:0x3
  buffer_load_dwordx4 v64, s[32:35], 0 offen lds
  s_nop 0
  v_add_u32_dpp v63, v46, v2 row_newbcast:9 row_mask:0xf bank_mask:0xc
  s_add_u32 m0, s76, 100352
  v_add_u32_dpp v64, v48, v2 row_newbcast:3 row_mask:0xf bank_mask:0x3
  buffer_load_dwordx4 v65, s[32:35], 0 offen lds
  s_nop 0
  v_add_u32_dpp v64, v50, v2 row_newbcast:9 row_mask:0xf bank_mask:0xc
  v_add_u32_dpp v65, v52, v2 row_newbcast:3 row_mask:0xf bank_mask:0x3
  s_nop 1
  v_add_u32_dpp v65, v54, v2 row_newbcast:9 row_mask:0xf bank_mask:0xc
  s_waitcnt vmcnt(10)
  s_barrier
  s_add_u32 m0, s75, 147456
  s_nop 0
  buffer_load_dwordx4 v4, s[44:47], s74 offen lds
  s_add_u32 m0, s75, 148480
  s_nop 0
  buffer_load_dwordx4 v5, s[44:47], s74 offen lds
  s_add_u32 s74, s74, 106496
  s_add_u32 m0, s75, 155648
  s_nop 0
  buffer_load_dwordx4 v4, s[44:47], s74 offen lds
  s_add_u32 m0, s75, 156672
  s_nop 0
  buffer_load_dwordx4 v5, s[44:47], s74 offen lds
  s_add_u32 s74, s74, 106496
  s_add_u32 m0, s76, 0
  s_nop 0
  buffer_load_dwordx4 v56, s[32:35], 0 offen lds
  s_add_u32 m0, s76, 2048
  v_add_u32_dpp v56, v17, v2 row_newbcast:3 row_mask:0xf bank_mask:0x3
  buffer_load_dwordx4 v57, s[32:35], 0 offen lds
  s_nop 0
  v_add_u32_dpp v56, v19, v2 row_newbcast:9 row_mask:0xf bank_mask:0xc
  s_add_u32 m0, s76, 4096
  v_add_u32_dpp v57, v21, v2 row_newbcast:3 row_mask:0xf bank_mask:0x3
  buffer_load_dwordx4 v58, s[32:35], 0 offen lds
  s_nop 0
  v_add_u32_dpp v57, v23, v2 row_newbcast:9 row_mask:0xf bank_mask:0xc
  s_add_u32 m0, s76, 6144
  v_add_u32_dpp v58, v25, v2 row_newbcast:3 row_mask:0xf bank_mask:0x3
  buffer_load_dwordx4 v59, s[32:35], 0 offen lds
  s_nop 0
  v_add_u32_dpp v58, v27, v2 row_newbcast:9 row_mask:0xf bank_mask:0xc
  s_add_u32 m0, s76, 8192
  v_add_u32_dpp v59, v29, v2 row_newbcast:3 row_mask:0xf bank_mask:0x3
  buffer_load_dwordx4 v60, s[32:35], 0 offen lds
  s_nop 0
  v_add_u32_dpp v59, v31, v2 row_newbcast:9 row_mask:0xf bank_mask:0xc
  s_add_u32 m0, s76, 10240
  v_add_u32_dpp v60, v33, v2 row_newbcast:3 row_mask:0xf bank_mask:0x3
  buffer_load_dwordx4 v61, s[32:35], 0 offen lds
  s_nop 0
  v_add_u32_dpp v60, v35, v2 row_newbcast:9 row_mask:0xf bank_mask:0xc
  s_add_u32 m0, s76, 12288
  v_add_u32_dpp v61, v37, v2 row_newbcast:3 row_mask:0xf bank_mask:0x3
  buffer_load_dwordx4 v62, s[32:35], 0 offen lds
  s_nop 0
  v_add_u32_dpp v61, v39, v2 row_newbcast:9 row_mask:0xf bank_mask:0xc
  s_add_u32 m0, s76, 14336
  v_add_u32_dpp v62, v41, v2 row_newbcast:3 row_mask:0xf bank_mask:0x3
  buffer_load_dwordx4 v63, s[32:35], 0 offen lds
  s_nop 0
  v_add_u32_dpp v62, v43, v2 row_newbcast:9 row_mask:0xf bank_mask:0xc
  s_add_u32 m0, s76, 16384
  v_add_u32_dpp v63, v45, v2 row_newbcast:3 row_mask:0xf bank_mask:0x3
  buffer_load_dwordx4 v64, s[32:35], 0 offen lds
  s_nop 0
  v_add_u32_dpp v63, v47, v2 row_newbcast:9 row_mask:0xf bank_mask:0xc
  s_add_u32 m0, s76, 18432
  v_add_u32_dpp v64, v49, v2 row_newbcast:3 row_mask:0xf bank_mask:0x3
  buffer_load_dwordx4 v65, s[32:35], 0 offen lds
  s_nop 0
  v_add_u32_dpp v64, v51, v2 row_newbcast:9 row_mask:0xf bank_mask:0xc
  v_add_u32_dpp v65, v53, v2 row_newbcast:3 row_mask:0xf bank_mask:0x3
  s_nop 1
  v_add_u32_dpp v65, v55, v2 row_newbcast:9 row_mask:0xf bank_mask:0xc
  s_waitcnt vmcnt(10)
  s_barrier
  s_add_u32 m0, s75, 131072
  s_nop 0
  buffer_load_dwordx4 v4, s[44:47], s74 offen lds
  s_add_u32 m0, s75, 132096
  s_nop 0
  buffer_load_dwordx4 v5, s[44:47], s74 offen lds
  s_add_u32 s74, s74, 106496
  s_add_u32 m0, s75, 139264
  s_nop 0
  buffer_load_dwordx4 v4, s[44:47], s74 offen lds
  s_add_u32 m0, s75, 140288
  s_nop 0
  buffer_load_dwordx4 v5, s[44:47], s74 offen lds
  s_add_u32 s74, s74, 106496
  s_add_u32 m0, s76, 40960
  s_nop 0
  buffer_load_dwordx4 v56, s[32:35], 0 offen lds
  s_add_u32 m0, s76, 43008
  v_add_u32_dpp v56, v18, v2 row_newbcast:3 row_mask:0xf bank_mask:0x3
  buffer_load_dwordx4 v57, s[32:35], 0 offen lds
  s_nop 0
  v_add_u32_dpp v56, v16, v2 row_newbcast:10 row_mask:0xf bank_mask:0xc
  s_add_u32 m0, s76, 45056
  v_add_u32_dpp v57, v22, v2 row_newbcast:3 row_mask:0xf bank_mask:0x3
  buffer_load_dwordx4 v58, s[32:35], 0 offen lds
  s_nop 0
  v_add_u32_dpp v57, v20, v2 row_newbcast:10 row_mask:0xf bank_mask:0xc
  s_add_u32 m0, s76, 47104
  v_add_u32_dpp v58, v26, v2 row_newbcast:3 row_mask:0xf bank_mask:0x3
  buffer_load_dwordx4 v59, s[32:35], 0 offen lds
  s_nop 0
  v_add_u32_dpp v58, v24, v2 row_newbcast:10 row_mask:0xf bank_mask:0xc
  s_add_u32 m0, s76, 49152
  v_add_u32_dpp v59, v30, v2 row_newbcast:3 row_mask:0xf bank_mask:0x3
  buffer_load_dwordx4 v60, s[32:35], 0 offen lds
  s_nop 0
  v_add_u32_dpp v59, v28, v2 row_newbcast:10 row_mask:0xf bank_mask:0xc
  s_add_u32 m0, s76, 51200
  v_add_u32_dpp v60, v34, v2 row_newbcast:3 row_mask:0xf bank_mask:0x3
  buffer_load_dwordx4 v61, s[32:35], 0 offen lds
  s_nop 0
  v_add_u32_dpp v60, v32, v2 row_newbcast:10 row_mask:0xf bank_mask:0xc
  s_add_u32 m0, s76, 53248
  v_add_u32_dpp v61, v38, v2 row_newbcast:3 row_mask:0xf bank_mask:0x3
  buffer_load_dwordx4 v62, s[32:35], 0 offen lds
  s_nop 0
  v_add_u32_dpp v61, v36, v2 row_newbcast:10 row_mask:0xf bank_mask:0xc
  s_add_u32 m0, s76, 55296
  v_add_u32_dpp v62, v42, v2 row_newbcast:3 row_mask:0xf bank_mask:0x3
  buffer_load_dwordx4 v63, s[32:35], 0 offen lds
  s_nop 0
  v_add_u32_dpp v62, v40, v2 row_newbcast:10 row_mask:0xf bank_mask:0xc
  s_add_u32 m0, s76, 57344
  v_add_u32_dpp v63, v46, v2 row_newbcast:3 row_mask:0xf bank_mask:0x3
  buffer_load_dwordx4 v64, s[32:35], 0 offen lds
  s_nop 0
  v_add_u32_dpp v63, v44, v2 row_newbcast:10 row_mask:0xf bank_mask:0xc
  s_add_u32 m0, s76, 59392
  v_add_u32_dpp v64, v50, v2 row_newbcast:3 row_mask:0xf bank_mask:0x3
  buffer_load_dwordx4 v65, s[32:35], 0 offen lds
  s_nop 0
  v_add_u32_dpp v64, v48, v2 row_newbcast:10 row_mask:0xf bank_mask:0xc
  v_add_u32_dpp v65, v54, v2 row_newbcast:3 row_mask:0xf bank_mask:0x3
  s_nop 1
  v_add_u32_dpp v65, v52, v2 row_newbcast:10 row_mask:0xf bank_mask:0xc
  v_mov_b32_dpp v16, v16 row_shl:3 row_mask:0xf bank_mask:0xf
  v_mov_b32_dpp v18, v18 row_shl:3 row_mask:0xf bank_mask:0xf
  v_mov_b32_dpp v20, v20 row_shl:3 row_mask:0xf bank_mask:0xf
  v_mov_b32_dpp v22, v22 row_shl:3 row_mask:0xf bank_mask:0xf
  v_mov_b32_dpp v24, v24 row_shl:3 row_mask:0xf bank_mask:0xf
  v_mov_b32_dpp v26, v26 row_shl:3 row_mask:0xf bank_mask:0xf
  v_mov_b32_dpp v28, v28 row_shl:3 row_mask:0xf bank_mask:0xf
  v_mov_b32_dpp v30, v30 row_shl:3 row_mask:0xf bank_mask:0xf
  v_mov_b32_dpp v32, v32 row_shl:3 row_mask:0xf bank_mask:0xf
  v_mov_b32_dpp v34, v34 row_shl:3 row_mask:0xf bank_mask:0xf
  v_mov_b32_dpp v36, v36 row_shl:3 row_mask:0xf bank_mask:0xf
  v_mov_b32_dpp v38, v38 row_shl:3 row_mask:0xf bank_mask:0xf
  v_mov_b32_dpp v40, v40 row_shl:3 row_mask:0xf bank_mask:0xf
  v_mov_b32_dpp v42, v42 row_shl:3 row_mask:0xf bank_mask:0xf
  v_mov_b32_dpp v44, v44 row_shl:3 row_mask:0xf bank_mask:0xf
  v_mov_b32_dpp v46, v46 row_shl:3 row_mask:0xf bank_mask:0xf
  v_mov_b32_dpp v48, v48 row_shl:3 row_mask:0xf bank_mask:0xf
  v_mov_b32_dpp v50, v50 row_shl:3 row_mask:0xf bank_mask:0xf
  v_mov_b32_dpp v52, v52 row_shl:3 row_mask:0xf bank_mask:0xf
  v_mov_b32_dpp v54, v54 row_shl:3 row_mask:0xf bank_mask:0xf
  s_waitcnt vmcnt(10)
  s_barrier
  s_add_u32 m0, s75, 147456
  s_nop 0
  buffer_load_dwordx4 v4, s[44:47], s74 offen lds
  s_add_u32 m0, s75, 148480
  s_nop 0
  buffer_load_dwordx4 v5, s[44:47], s74 offen lds
  s_add_u32 s74, s74, 106496
  s_add_u32 m0, s75, 155648
  s_nop 0
  buffer_load_dwordx4 v4, s[44:47], s74 offen lds
  s_add_u32 m0, s75, 156672
  s_nop 0
  buffer_load_dwordx4 v5, s[44:47], s74 offen lds
  s_add_u32 s74, s74, 106496
  s_add_u32 m0, s76, 81920
  s_nop 0
  buffer_load_dwordx4 v56, s[32:35], 0 offen lds
  s_add_u32 m0, s76, 83968
  v_add_u32_dpp v56, v19, v2 row_newbcast:3 row_mask:0xf bank_mask:0x3
  buffer_load_dwordx4 v57, s[32:35], 0 offen lds
  s_nop 0
  v_add_u32_dpp v56, v17, v2 row_newbcast:10 row_mask:0xf bank_mask:0xc
  s_add_u32 m0, s76, 86016
  v_add_u32_dpp v57, v23, v2 row_newbcast:3 row_mask:0xf bank_mask:0x3
  buffer_load_dwordx4 v58, s[32:35], 0 offen lds
  s_nop 0
  v_add_u32_dpp v57, v21, v2 row_newbcast:10 row_mask:0xf bank_mask:0xc
  s_add_u32 m0, s76, 88064
  v_add_u32_dpp v58, v27, v2 row_newbcast:3 row_mask:0xf bank_mask:0x3
  buffer_load_dwordx4 v59, s[32:35], 0 offen lds
  s_nop 0
  v_add_u32_dpp v58, v25, v2 row_newbcast:10 row_mask:0xf bank_mask:0xc
  s_add_u32 m0, s76, 90112
  v_add_u32_dpp v59, v31, v2 row_newbcast:3 row_mask:0xf bank_mask:0x3
  buffer_load_dwordx4 v60, s[32:35], 0 offen lds
  s_nop 0
  v_add_u32_dpp v59, v29, v2 row_newbcast:10 row_mask:0xf bank_mask:0xc
  s_add_u32 m0, s76, 92160
  v_add_u32_dpp v60, v35, v2 row_newbcast:3 row_mask:0xf bank_mask:0x3
  buffer_load_dwordx4 v61, s[32:35], 0 offen lds
  s_nop 0
  v_add_u32_dpp v60, v33, v2 row_newbcast:10 row_mask:0xf bank_mask:0xc
  s_add_u32 m0, s76, 94208
  v_add_u32_dpp v61, v39, v2 row_newbcast:3 row_mask:0xf bank_mask:0x3
  buffer_load_dwordx4 v62, s[32:35], 0 offen lds
  s_nop 0
  v_add_u32_dpp v61, v37, v2 row_newbcast:10 row_mask:0xf bank_mask:0xc
  s_add_u32 m0, s76, 96256
  v_add_u32_dpp v62, v43, v2 row_newbcast:3 row_mask:0xf bank_mask:0x3
  buffer_load_dwordx4 v63, s[32:35], 0 offen lds
  s_nop 0
  v_add_u32_dpp v62, v41, v2 row_newbcast:10 row_mask:0xf bank_mask:0xc
  s_add_u32 m0, s76, 98304
  v_add_u32_dpp v63, v47, v2 row_newbcast:3 row_mask:0xf bank_mask:0x3
  buffer_load_dwordx4 v64, s[32:35], 0 offen lds
  s_nop 0
  v_add_u32_dpp v63, v45, v2 row_newbcast:10 row_mask:0xf bank_mask:0xc
  s_add_u32 m0, s76, 100352
  v_add_u32_dpp v64, v51, v2 row_newbcast:3 row_mask:0xf bank_mask:0x3
  buffer_load_dwordx4 v65, s[32:35], 0 offen lds
  s_nop 0
  v_add_u32_dpp v64, v49, v2 row_newbcast:10 row_mask:0xf bank_mask:0xc
  v_add_u32_dpp v65, v55, v2 row_newbcast:3 row_mask:0xf bank_mask:0x3
  s_nop 1
  v_add_u32_dpp v65, v53, v2 row_newbcast:10 row_mask:0xf bank_mask:0xc
  v_mov_b32_dpp v17, v17 row_shl:3 row_mask:0xf bank_mask:0xf
  v_mov_b32_dpp v19, v19 row_shl:3 row_mask:0xf bank_mask:0xf
  v_mov_b32_dpp v21, v21 row_shl:3 row_mask:0xf bank_mask:0xf
  v_mov_b32_dpp v23, v23 row_shl:3 row_mask:0xf bank_mask:0xf
  v_mov_b32_dpp v25, v25 row_shl:3 row_mask:0xf bank_mask:0xf
  v_mov_b32_dpp v27, v27 row_shl:3 row_mask:0xf bank_mask:0xf
  v_mov_b32_dpp v29, v29 row_shl:3 row_mask:0xf bank_mask:0xf
  v_mov_b32_dpp v31, v31 row_shl:3 row_mask:0xf bank_mask:0xf
  v_mov_b32_dpp v33, v33 row_shl:3 row_mask:0xf bank_mask:0xf
  v_mov_b32_dpp v35, v35 row_shl:3 row_mask:0xf bank_mask:0xf
  v_mov_b32_dpp v37, v37 row_shl:3 row_mask:0xf bank_mask:0xf
  v_mov_b32_dpp v39, v39 row_shl:3 row_mask:0xf bank_mask:0xf
  v_mov_b32_dpp v41, v41 row_shl:3 row_mask:0xf bank_mask:0xf
  v_mov_b32_dpp v43, v43 row_shl:3 row_mask:0xf bank_mask:0xf
  v_mov_b32_dpp v45, v45 row_shl:3 row_mask:0xf bank_mask:0xf
  v_mov_b32_dpp v47, v47 row_shl:3 row_mask:0xf bank_mask:0xf
  v_mov_b32_dpp v49, v49 row_shl:3 row_mask:0xf bank_mask:0xf
  v_mov_b32_dpp v51, v51 row_shl:3 row_mask:0xf bank_mask:0xf
  v_mov_b32_dpp v53, v53 row_shl:3 row_mask:0xf bank_mask:0xf
  v_mov_b32_dpp v55, v55 row_shl:3 row_mask:0xf bank_mask:0xf
  s_add_u32 s72, s72, 1
  s_cmp_lt_u32 s72, 2
  s_waitcnt vmcnt(10)
  s_cbranch_scc1 L_dnn_loop1
  s_branch L_ld_tail
L_cin:
  v_lshlrev_b32 v1, 4, v0
  s_and_b32 s79, s3, 3
  s_lshr_b32 s84, s3, 2
  s_lshl_b32 s95, s79, 10
  s_mul_i32 s26, s68, 11
  s_add_u32 s26, s26, s69
  s_sub_u32 s26, s26, 22
  s_cmp_eq_u32 s26, 86
  s_cbranch_scc1 L_end
  s_cmp_eq_u32 s84, 0
  s_cbranch_scc1 L_sc
  s_setprio 2
  v_add_u32 v2, L_tables-L_pc+4096, v1
  v_mov_b32 v3, s93
  v_add_co_u32 v2, vcc, s92, v2
  s_nop 1
  v_addc_co_u32 v3, vcc, 0, v3, vcc
  v_add_co_u32 v32, vcc, s95, v2
  s_nop 1
  v_addc_co_u32 v33, vcc, 0, v3, vcc
  global_load_dwordx4 v[224:227], v[2:3], off offset:-4096
  v_add_co_u32 v2, vcc, 0x1800, v2
  s_nop 1
  v_addc_co_u32 v3, vcc, 0, v3, vcc
  global_load_dwordx4 v[240:243], v[2:3], off
  s_cmp_lt_u32 s79, 3
  s_mov_b32 s70, 122176
  s_cselect_b32 s70, 81920, s70
  s_add_u32 m0, s95, 81920
  s_nop 0
  global_load_lds_dwordx4 v[32:33], off offset:-4096
  s_add_u32 m0, s95, s70
  s_nop 0
  global_load_lds_dwordx4 v[32:33], off offset:0
  v_add_co_u32 v32, vcc, 0x2000, v32
  s_nop 1
  v_addc_co_u32 v33, vcc, 0, v33, vcc
  s_add_u32 m0, s95, 2048
  s_nop 0
  global_load_lds_dwordx4 v[32:33], off offset:0
  s_add_u32 m0, s95, 130368
  s_cmp_ge_u32 s79, 2
  s_cbranch_scc1 L_sc
  global_load_lds_dwordx4 v[32:33], off offset:-4096
L_sc:
  s_mul_i32 s85, s84, 20
  s_add_u32 s85, s85, s3
  s_mul_i32 s94, s26, 48
  s_add_u32 s94, s94, s85
  s_mul_i32 s94, s94, 104
  v_lshrrev_b32 v30, 3, v0
  v_lshlrev_b32 v30, 4, v30
  v_and_b32 v29, 0x70, v1
  s_mul_i32 s76, s3, 4064
  s_add_u32 s76, s76, 131136
  s_cmp_eq_u32 s84, 0
  s_cbranch_scc1 L_g0
  s_waitcnt lgkmcnt(0)
  s_mov_b32 s40, s10
  s_and_b32 s41, s11, 0xffff
  s_mov_b32 s42, 156
  s_mov_b32 s43, 0x20000
  s_mov_b32 m0, 129472
  s_mov_b64 exec, 0x7ff
  buffer_load_dwordx4 v1, s[40:43], 0 offen lds
  s_mov_b64 exec, -1
  s_lshl_b32 s85, s85, 2
  s_add_u32 s85, s85, 129728
  s_mul_i32 s72, s84, 3
  s_sub_u32 s72, 4, s72
  s_cmp_eq_u32 s26, 85
  s_cselect_b32 s72, s72, 6
  s_lshl_b32 s52, s3, 7
  s_mul_i32 s53, s3, 5280
  s_lshl_b32 s54, s3, 2
  s_lshl_b32 s55, s3, 1
  s_lshl_b32 s82, s3, 12
  s_and_b32 s98, s3, 1
  s_lshr_b32 s99, s3, 1
  s_mul_i32 s68, s99, 3072
  s_lshl_b32 s83, s98, 3
  s_add_u32 s68, s68, s83
  v_add_u32 v59, s68, v1
  s_lshl_b32 s69, s99, 3
  s_lshr_b32 s69, 0x05030200, s69
  s_and_b32 s69, s69, 0xff
  s_lshl_b32 s69, s69, 9
  s_lshl_b32 s70, s98, 2
  s_add_u32 s91, s69, s70
  s_mov_b32 s99, 0x05040100
  s_mov_b32 s100, 0x07060302
  v_mov_b32 v2, 129664
  v_mov_b32 v109, 0
  v_mov_b32 v108, 0
  v_mov_b64 v[32:33], 0
  v_mov_b64 v[34:35], 0
  v_mov_b64 v[36:37], 0
  v_mov_b64 v[38:39], 0
  v_mov_b64 v[40:41], 0
  v_mov_b64 v[42:43], 0
  v_mov_b64 v[44:45], 0
  v_mov_b64 v[46:47], 0
  v_mov_b64 v[48:49], 0
  v_mov_b64 v[50:51], 0
  v_mov_b64 v[52:53], 0
  v_mov_b64 v[54:55], 0
  v_mov_b64 v[56:57], 0
  s_mov_b32 s44, s12
  s_and_b32 s45, s13, 0xffff
  s_mov_b32 s46, 5537792
  s_mov_b32 s47, 0x20000
  s_lshl_b32 s101, s26, 3
  s_add_u32 s101, s101, s3
  s_add_u32 s101, s101, 1664
  s_lshl_b32 s101, s101, 7
  s_mov_b32 s71, 88064
  v_min_u32 v12, 12, v0
  v_mul_lo_u32 v12, s71, v12
  s_lshl_b32 s77, s26, 3
  s_add_u32 s77, s77, s3
  s_mul_i32 s77, s77, 624
  s_add_u32 s73, s77, 80
  s_add_u32 s77, s77, 16
  v_min_u32 v14, 35, v0
  v_mul_u32_u24 v13, 10923, v14
  v_lshrrev_b32 v13, 16, v13
  v_mul_u32_u24 v13, 80, v13
  v_lshl_add_u32 v13, v14, 2, v13
  v_add_u32 v250, 77824, v1
  s_waitcnt vmcnt(6)
  v_add_u32 v251, 125248, v1
  v_lshrrev_b32_e64 v3, 5, v0
  v_lshl_add_u32 v3, v3, 2, v2
  s_mov_b32 s28, s4
  s_and_b32 s29, s5, 0xffff
  s_mov_b32 s30, 425984
  s_mov_b32 s31, 0x20000
  s_mov_b32 s32, s6
  s_and_b32 s33, s7, 0xffff
  s_mov_b32 s34, 12800000
  s_mov_b32 s35, 0x20000
  ds_write_b128 v2, v[32:35] offset:16
  s_lshl_b32 s68, s79, 6
  v_add_u32 v29, s68, v0
  v_mul_u32_u24 v30, 2521, v29
  v_lshrrev_b32 v30, 16, v30
  v_mul_u32_u24 v30, 12, v30
  v_lshl_add_u32 v28, v29, 1, v30
  v_add_u32 v29, 256, v29
  v_mul_u32_u24 v30, 2521, v29
  v_lshrrev_b32 v30, 16, v30
  v_mul_u32_u24 v30, 12, v30
  v_lshl_add_u32 v58, v29, 1, v30
  v_add_u32 v29, 256, v29
  v_mul_u32_u24 v30, 2521, v29
  v_lshrrev_b32 v30, 16, v30
  v_mul_u32_u24 v30, 12, v30
  v_lshl_add_u32 v111, v29, 1, v30
  v_cmp_gt_u32 vcc, 676, v29
  s_nop 0
  s_mov_b64 s[92:93], vcc
  v_lshlrev_b32 v29, 3, v0
  s_mov_b32 exec_hi, 0xffff
  ds_write_b64 v29, v[32:33] offset:1664
  s_mov_b32 exec_hi, -1
  s_waitcnt vmcnt(4)
  ds_write_b32 v243, v32
  ds_write_b32 v243, v32 offset:43328
  s_waitcnt vmcnt(0)
  ds_read_b64 v[112:113], v240 offset:0
  ds_read_b64 v[114:115], v240 offset:8
  ds_read_b64 v[116:117], v240 offset:32
  ds_read_b64 v[118:119], v240 offset:40
  ds_read_u16 v110, v241
  s_mov_b64 exec, 0x3ffffff
  s_waitcnt lgkmcnt(0)
  ds_write_b16 v242, v110
  v_lshlrev_b32 v109, 17, v110
  v_lshrrev_b32 v109, 1, v109
  s_mov_b64 exec, -1
  v_add_u32 v225, s52, v225
  v_add_u32 v226, s52, v226
  v_add_u32_e64 v227, s52, v227
  s_waitcnt lgkmcnt(0)
  buffer_load_dword v15, v12, s[44:47], s101 offen
  s_add_u32 s101, s101, 1144832
  s_barrier
  ds_read_b64_tr_b16 v[60:61], v225 offset:35328
  ds_read_b64_tr_b16 v[62:63], v225 offset:40736
  ds_read_b64_tr_b16 v[64:65], v226 offset:35328
  ds_read_b64_tr_b16 v[66:67], v227 offset:35328
  ds_read_b64_tr_b16 v[68:69], v225 offset:35392
  ds_read_b64_tr_b16 v[70:71], v225 offset:40800
  ds_read_b64_tr_b16 v[72:73], v226 offset:35392
  ds_read_b64_tr_b16 v[74:75], v227 offset:35392
  ds_read_b64_tr_b16 v[76:77], v225 offset:35840
  ds_read_b64_tr_b16 v[78:79], v225 offset:41248
  ds_read_b64_tr_b16 v[80:81], v226 offset:35840
  ds_read_b64_tr_b16 v[82:83], v227 offset:35840
  ds_read_b64_tr_b16 v[84:85], v225 offset:35904
  ds_read_b64_tr_b16 v[86:87], v225 offset:41312
  ds_read_b64_tr_b16 v[88:89], v226 offset:35904
  ds_read_b64_tr_b16 v[90:91], v227 offset:35904
  s_waitcnt lgkmcnt(14)
  v_mfma_f32_32x32x16_bf16 v[120:135], v[112:115], v[60:63], 0
  s_waitcnt lgkmcnt(12)
  v_mfma_f32_32x32x16_bf16 v[120:135], v[116:119], v[64:67], v[120:135]
  ds_read_b64_tr_b16 v[92:93], v225 offset:36352
  ds_read_b64_tr_b16 v[94:95], v225 offset:41760
  ds_read_b64_tr_b16 v[96:97], v226 offset:36352
  ds_read_b64_tr_b16 v[98:99], v227 offset:36352
  s_waitcnt lgkmcnt(14)
  v_mfma_f32_32x32x16_bf16 v[136:151], v[112:115], v[68:71], 0
  s_waitcnt lgkmcnt(12)
  v_mfma_f32_32x32x16_bf16 v[136:151], v[116:119], v[72:75], v[136:151]
  ds_read_b64_tr_b16 v[100:101], v225 offset:36416
  ds_read_b64_tr_b16 v[102:103], v225 offset:41824
  ds_read_b64_tr_b16 v[104:105], v226 offset:36416
  ds_read_b64_tr_b16 v[106:107], v227 offset:36416
  s_waitcnt lgkmcnt(14)
  v_mfma_f32_32x32x16_bf16 v[152:167], v[112:115], v[76:79], 0
  s_waitcnt lgkmcnt(12)
  v_mfma_f32_32x32x16_bf16 v[152:167], v[116:119], v[80:83], v[152:167]
  s_waitcnt lgkmcnt(10)
  v_mfma_f32_32x32x16_bf16 v[168:183], v[112:115], v[84:87], 0
  s_waitcnt lgkmcnt(8)
  v_mfma_f32_32x32x16_bf16 v[168:183], v[116:119], v[88:91], v[168:183]
  ds_read_b128 v[228:231], v250 offset:6144
  ds_read_b128 v[232:235], v251 offset:0
  ds_read_b128 v[4:7], v250 offset:3072
  ds_read_b128 v[8:11], v251 offset:2048
  ds_read_b128 v[20:23], v250 offset:1024
  ds_read_b128 v[24:27], v250 offset:2048
  ds_read_b128 v[216:219], v250 offset:4096
  ds_read_b128 v[220:223], v250 offset:5120
  ds_read_b128 v[236:239], v251 offset:1024
  s_waitcnt lgkmcnt(14)
  v_mfma_f32_32x32x16_bf16 v[184:199], v[112:115], v[92:95], 0
  s_waitcnt lgkmcnt(13)
  v_mfma_f32_32x32x16_bf16 v[184:199], v[116:119], v[96:99], v[184:199]
  s_waitcnt lgkmcnt(11)
  v_mfma_f32_32x32x16_bf16 v[200:215], v[112:115], v[100:103], 0
  s_waitcnt lgkmcnt(9)
  v_mfma_f32_32x32x16_bf16 v[200:215], v[116:119], v[104:107], v[200:215]
  s_waitcnt lgkmcnt(8)
  v_add_u32 v228, s54, v228
  v_add_u32 v229, s54, v229
  v_add_u32 v231, s83, v231
  v_add_u32 v230, s91, v230
  s_waitcnt lgkmcnt(7)
  v_mad_u32_u24 v232, v233, s3, v232
  v_add_u32 v234, s55, v234
  v_mad_u32_u24 v233, v233, 8, v232
  v_add_u32 v246, s82, v235
  v_add_u32 v247, 2048, v246
  v_add_u32 v31, 0, v234
  v_and_b32 v31, 3, v31
  v_lshl_add_u32 v244, v31, 4, v232
  v_add_u32 v31, 1, v234
  v_and_b32 v31, 3, v31
  v_lshl_add_u32 v245, v31, 4, v232
  v_add_u32 v245, 1664, v245
  v_add_u32 v31, 0, v234
  v_and_b32 v31, 3, v31
  v_lshl_add_u32 v248, v31, 4, v233
  v_add_u32 v31, 1, v234
  v_and_b32 v31, 3, v31
  v_lshl_add_u32 v249, v31, 4, v233
  v_add_u32 v249, 1664, v249
  s_waitcnt lgkmcnt(5)
  v_add_u32 v10, s76, v10
  v_add_u32 v4, s76, v4
  v_add_u32 v5, s76, v5
  ds_write_b32 v10, v7 offset:2880
  v_add_u32 v11, s53, v11
  s_waitcnt lgkmcnt(5)
  v_add_u32 v20, s53, v20
  v_add_u32 v21, s53, v21
  v_add_u32 v22, s53, v22
  v_add_u32 v23, s53, v23
  s_waitcnt lgkmcnt(4)
  v_add_u32 v24, s53, v24
  v_add_u32 v25, s53, v25
  v_add_u32 v26, s53, v26
  v_add_u32 v27, s53, v27
  s_mov_b32 exec_lo, 0
  v_mov_b32 v120, v136
  s_mov_b32 exec_lo, -1
  v_cvt_pk_bf16_f32 v60, 0, v120
  ds_write_b16_d16_hi v28, v60
  v_max_f32 v108, |v60|, v108
  s_mov_b32 exec_lo, 0
  v_mov_b32_e64 v152, v168
  s_mov_b32 exec_lo, -1
  v_cvt_pk_bf16_f32 v61, 0, v152
  ds_write_b16_d16_hi v58, v61
  v_max_f32 v108, |v61|, v108
  s_mov_b32 exec_lo, 0
  v_mov_b32 v184, v200
  s_mov_b32 exec_lo, -1
  v_cvt_pk_bf16_f32 v62, 0, v184
  s_mov_b64 exec, s[92:93]
  ds_write_b16_d16_hi v111, v62
  v_max_f32 v108, |v62|, v108
  s_mov_b64 exec, -1
  s_nop 0
  v_permlane32_swap_b32 v108, v109
  v_max_u32 v108, v108, v109
  s_nop 1
  v_max_u32_dpp v108, v108, v108 row_shr:1 row_mask:0xf bank_mask:0xf
  s_nop 1
  v_max_u32_dpp v108, v108, v108 row_shr:2 row_mask:0xf bank_mask:0xf
  s_nop 1
  v_max_u32_dpp v108, v108, v108 row_shr:4 row_mask:0xf bank_mask:0xf
  s_nop 1
  v_max_u32_dpp v108, v108, v108 row_shr:8 row_mask:0xf bank_mask:0xf
  s_nop 1
  v_max_u32_dpp v108, v108, v108 row_bcast:15 row_mask:0xa bank_mask:0xf
  s_mov_b32 exec_lo, 0x80000000
  s_mov_b32 exec_hi, 0x80000000
  ds_max_u32 v3, v108 offset:24
  s_mov_b64 exec, -1
  s_setprio 0
  s_waitcnt lgkmcnt(0)
  s_barrier
  s_branch L_w2
L_g0:
  s_waitcnt lgkmcnt(0)
  s_mov_b32 s36, s8
  s_and_b32 s37, s9, 0xffff
  s_mov_b32 s38, 105456
  s_mov_b32 s39, 0x20000
  s_add_u32 m0, s95, 41984
  s_add_u32 s81, s95, 70304
  buffer_load_dwordx4 v1, s[36:39], s81 offen lds
  s_add_u32 m0, s95, 46080
  s_add_u32 s81, s95, 74400
  buffer_load_dwordx4 v1, s[36:39], s81 offen lds
  s_add_u32 m0, s95, 50176
  s_add_u32 s81, s95, 78496
  buffer_load_dwordx4 v1, s[36:39], s81 offen lds
  s_add_u32 m0, s95, 54272
  s_add_u32 s81, s95, 82592
  buffer_load_dwordx4 v1, s[36:39], s81 offen lds
  s_add_u32 m0, s95, 58368
  s_add_u32 s81, s95, 86688
  buffer_load_dwordx4 v1, s[36:39], s81 offen lds
  s_add_u32 m0, s95, 62464
  s_add_u32 s81, s95, 90784
  buffer_load_dwordx4 v1, s[36:39], s81 offen lds
  s_add_u32 m0, s95, 66560
  s_add_u32 s81, s95, 94880
  buffer_load_dwordx4 v1, s[36:39], s81 offen lds
  s_add_u32 m0, s95, 70656
  s_add_u32 s81, s95, 98976
  buffer_load_dwordx4 v1, s[36:39], s81 offen lds
  s_cmp_eq_u32 s79, 3
  s_cbranch_scc1 L_st3
  s_add_u32 m0, s95, 74752
  s_add_u32 s81, s95, 103072
  buffer_load_dwordx4 v1, s[36:39], s81 offen lds
L_st3:
  s_mov_b32 s28, s4
  s_and_b32 s29, s5, 0xffff
  s_mov_b32 s30, 425984
  s_mov_b32 s31, 0x20000
  buffer_load_dwordx4 v[16:19], v30, s[28:31], s94 offen
  s_add_u32 s94, s94, 416
  buffer_load_dwordx4 v[104:107], v30, s[28:31], s94 offen
  s_add_u32 s94, s94, 416
  s_mov_b32 s32, s6
  s_and_b32 s33, s7, 0xffff
  s_mov_b32 s34, 12800000
  s_mov_b32 s35, 0x20000
  s_mul_i32 s96, s79, 3072
  s_mul_i32 s97, s79, 2704
  v_lshrrev_b32 v31, 5, v0
  v_mul_u32_u24 v31, 184, v31
  v_sub_u32 v31, v1, v31
  s_add_u32 m0, s96, 85312
  s_add_u32 s81, s97, 35152
  buffer_load_dwordx4 v1, s[36:39], s81 offen lds
  s_lshl_b32 s85, s85, 2
  s_add_u32 s85, s85, 129728
  s_mul_i32 s72, s84, 3
  s_sub_u32 s72, 4, s72
  s_cmp_eq_u32 s26, 85
  s_cselect_b32 s72, s72, 6
  s_lshl_b32 s52, s3, 7
  s_mul_i32 s53, s3, 5280
  s_lshl_b32 s54, s3, 2
  s_add_u32 m0, s96, 86336
  s_add_u32 s81, s97, 36176
  buffer_load_dwordx4 v31, s[36:39], s81 offen lds
  s_lshl_b32 s55, s3, 1
  s_lshl_b32 s82, s3, 12
  s_and_b32 s98, s3, 1
  s_lshr_b32 s99, s3, 1
  s_mul_i32 s68, s99, 3072
  s_lshl_b32 s83, s98, 3
  s_add_u32 s68, s68, s83
  s_add_u32 m0, s96, 87360
  s_add_u32 s81, s97, 37016
  buffer_load_dwordx4 v1, s[36:39], s81 offen lds
  v_add_u32_e64 v59, s68, v1
  s_lshl_b32 s69, s99, 3
  s_lshr_b32 s69, 0x05030200, s69
  s_and_b32 s69, s69, 0xff
  s_lshl_b32 s69, s69, 9
  s_lshl_b32 s70, s98, 2
  s_add_u32 s91, s69, s70
  s_add_u32 m0, s96, 97600
  s_add_u32 s81, s97, 45968
  buffer_load_dwordx4 v1, s[36:39], s81 offen lds
  s_mov_b32 s99, 0x05040100
  s_mov_b32 s100, 0x07060302
  v_mov_b32 v2, 129664
  v_mov_b32 v109, 0
  v_mov_b32 v108, 0
  v_mov_b64 v[32:33], 0
  v_mov_b64 v[34:35], 0
  s_add_u32 m0, s96, 98624
  s_add_u32 s81, s97, 46992
  buffer_load_dwordx4 v31, s[36:39], s81 offen lds
  v_mov_b64 v[36:37], 0
  v_mov_b64 v[38:39], 0
  v_mov_b64 v[40:41], 0
  v_mov_b64 v[42:43], 0
  v_mov_b64 v[44:45], 0
  v_mov_b64 v[46:47], 0
  v_mov_b64 v[48:49], 0
  v_mov_b64 v[50:51], 0
  s_add_u32 m0, s96, 99648
  s_add_u32 s81, s97, 47832
  buffer_load_dwordx4 v1, s[36:39], s81 offen lds
  v_mov_b64 v[52:53], 0
  v_mov_b64 v[54:55], 0
  v_mov_b64 v[56:57], 0
  s_mov_b32 s44, s12
  s_and_b32 s45, s13, 0xffff
  s_mov_b32 s46, 5537792
  s_mov_b32 s47, 0x20000
  s_add_u32 m0, s96, 109888
  s_add_u32 s81, s97, 56784
  buffer_load_dwordx4 v1, s[36:39], s81 offen lds
  s_lshl_b32 s101, s26, 3
  s_add_u32 s101, s101, s3
  s_add_u32 s101, s101, 1664
  s_lshl_b32 s101, s101, 7
  s_mov_b32 s71, 88064
  v_min_u32 v12, 12, v0
  v_mul_lo_u32 v12, s71, v12
  s_add_u32 m0, s96, 110912
  s_add_u32 s81, s97, 57808
  buffer_load_dwordx4 v31, s[36:39], s81 offen lds
  s_lshl_b32 s77, s26, 3
  s_add_u32 s77, s77, s3
  s_mul_i32 s77, s77, 624
  s_add_u32 s73, s77, 80
  s_add_u32 s77, s77, 16
  v_min_u32 v14, 35, v0
  v_mul_u32_u24 v13, 10923, v14
  s_add_u32 m0, s96, 111936
  s_add_u32 s81, s97, 58648
  buffer_load_dwordx4 v1, s[36:39], s81 offen lds
  v_lshrrev_b32 v13, 16, v13
  v_mul_u32_u24 v13, 80, v13
  v_lshl_add_u32 v13, v14, 2, v13
  v_add_u32 v250, 77824, v1
  s_waitcnt vmcnt(19)
  v_add_u32 v251, 125248, v1
  v_lshrrev_b32_e64 v3, 5, v0
  v_lshl_add_u32 v3, v3, 2, v2
  s_cmp_lg_u32 s79, 0
  s_cbranch_scc1 L_st2
  s_add_u32 m0, s96, 122176
  s_add_u32 s81, s97, 67600
  buffer_load_dwordx4 v1, s[36:39], s81 offen lds
  s_add_u32 m0, s96, 123200
  s_add_u32 s81, s97, 68624
  buffer_load_dwordx4 v31, s[36:39], s81 offen lds
  s_add_u32 m0, s96, 124224
  s_add_u32 s81, s97, 69464
  buffer_load_dwordx4 v1, s[36:39], s81 offen lds
L_st2:
  s_add_u32 m0, s95, 6144
  s_add_u32 s81, s95, 0
  buffer_load_dwordx4 v1, s[36:39], s81 offen lds
  s_add_u32 m0, s95, 10240
  s_add_u32 s81, s95, 4096
  buffer_load_dwordx4 v1, s[36:39], s81 offen lds
  s_add_u32 m0, s95, 14336
  s_add_u32 s81, s95, 8192
  buffer_load_dwordx4 v1, s[36:39], s81 offen lds
  s_add_u32 m0, s95, 18432
  s_add_u32 s81, s95, 12288
  buffer_load_dwordx4 v1, s[36:39], s81 offen lds
  s_waitcnt vmcnt(15)
  s_barrier
  ds_read_b128 v[224:227], v250 offset:0
  ds_read_b128 v[228:231], v250 offset:6144
  ds_read_b128 v[232:235], v251 offset:0
  ds_read_b128 v[4:7], v250 offset:3072
  ds_read_b128 v[8:11], v251 offset:2048
  ds_read_b128 v[20:23], v250 offset:1024
  ds_read_b128 v[24:27], v250 offset:2048
  ds_read_b128 v[216:219], v250 offset:4096
  ds_read_b128 v[220:223], v250 offset:5120
  ds_read_b128 v[236:239], v251 offset:1024
  s_add_u32 m0, s95, 22528
  s_add_u32 s81, s95, 16384
  buffer_load_dwordx4 v1, s[36:39], s81 offen lds
  s_add_u32 m0, s95, 26624
  s_add_u32 s81, s95, 20480
  buffer_load_dwordx4 v1, s[36:39], s81 offen lds
  s_add_u32 m0, s95, 30720
  s_add_u32 s81, s95, 24576
  buffer_load_dwordx4 v1, s[36:39], s81 offen lds
  s_add_u32 m0, s95, 34816
  s_add_u32 s81, s95, 28672
  buffer_load_dwordx4 v1, s[36:39], s81 offen lds
  s_cmp_eq_u32 s79, 3
  s_cbranch_scc1 L_st1
  s_add_u32 m0, s95, 38912
  s_add_u32 s81, s95, 32768
  buffer_load_dwordx4 v1, s[36:39], s81 offen lds
L_st1:
  s_waitcnt vmcnt(18)
  v_lshl_add_u32 v16, v16, 7, v29
  v_lshl_add_u32 v17, v17, 7, v29
  v_lshl_add_u32 v18, v18, 7, v29
  v_lshl_add_u32 v19, v19, 7, v29
  s_add_u32 m0, s76, 0
  s_mov_b32 exec_hi, 0xffffff
  buffer_load_dwordx4 v16, s[32:35], 0 offen lds
  s_add_u32 m0, s76, 1056
  s_nop 0
  buffer_load_dwordx4 v17, s[32:35], 0 offen lds
  s_add_u32 m0, s76, 2112
  s_mov_b32 exec_hi, 0xffff
  buffer_load_dwordx4 v18, s[32:35], 0 offen lds
  s_add_u32 m0, s76, 3168
  s_nop 0
  buffer_load_dwordx4 v19, s[32:35], 0 offen lds
  s_mov_b32 exec_hi, -1
  s_waitcnt vmcnt(21)
  v_lshl_add_u32 v104, v104, 7, v29
  v_lshl_add_u32 v105, v105, 7, v29
  v_lshl_add_u32 v106, v106, 7, v29
  v_lshl_add_u32 v107, v107, 7, v29
  s_add_u32 m0, s76, 16256
  s_mov_b32 exec_hi, 0xffffff
  buffer_load_dwordx4 v104, s[32:35], 0 offen lds
  s_add_u32 m0, s76, 17312
  s_nop 0
  buffer_load_dwordx4 v105, s[32:35], 0 offen lds
  s_add_u32 m0, s76, 18368
  s_mov_b32 exec_hi, 0xffff
  buffer_load_dwordx4 v106, s[32:35], 0 offen lds
  s_add_u32 m0, s76, 19424
  s_nop 0
  buffer_load_dwordx4 v107, s[32:35], 0 offen lds
  s_mov_b32 exec_hi, -1
  buffer_load_dword v15, v12, s[44:47], s101 offen
  s_add_u32 s101, s101, 1144832
  s_waitcnt lgkmcnt(9)
  v_add_u32 v225, s52, v225
  v_add_u32 v226, s52, v226
  v_add_u32 v227, s52, v227
  s_waitcnt lgkmcnt(8)
  v_add_u32 v228, s54, v228
  v_add_u32 v229, s54, v229
  v_add_u32 v231, s83, v231
  v_add_u32 v230, s91, v230
  s_waitcnt lgkmcnt(7)
  v_mad_u32_u24 v232, v233, s3, v232
  v_add_u32_e64 v234, s55, v234
  v_mad_u32_u24 v233, v233, 8, v232
  v_add_u32 v246, s82, v235
  v_add_u32 v247, 2048, v246
  v_add_u32 v31, 0, v234
  v_and_b32 v31, 3, v31
  v_lshl_add_u32 v244, v31, 4, v232
  v_add_u32 v31, 1, v234
  v_and_b32 v31, 3, v31
  v_lshl_add_u32 v245, v31, 4, v232
  v_add_u32 v245, 1664, v245
  v_add_u32 v31, 0, v234
  v_and_b32 v31, 3, v31
  v_lshl_add_u32 v248, v31, 4, v233
  v_add_u32 v31, 1, v234
  v_and_b32 v31, 3, v31
  v_lshl_add_u32 v249, v31, 4, v233
  v_add_u32 v249, 1664, v249
  s_waitcnt lgkmcnt(5)
  v_add_u32 v10, s76, v10
  v_add_u32 v4, s76, v4
  v_add_u32 v5, s76, v5
  ds_write_b32 v10, v7 offset:2880
  v_add_u32 v11, s53, v11
  s_waitcnt lgkmcnt(5)
  v_add_u32 v20, s53, v20
  v_add_u32 v21, s53, v21
  v_add_u32 v22, s53, v22
  v_add_u32 v23, s53, v23
  s_waitcnt lgkmcnt(4)
  v_add_u32 v24, s53, v24
  v_add_u32 v25, s53, v25
  v_add_u32 v26, s53, v26
  v_add_u32 v27, s53, v27
  s_waitcnt vmcnt(9)
  s_barrier
L_w2:
  ds_read2st64_b32 v[60:61], v228 offset0:0 offset1:6
  ds_read2st64_b32 v[62:63], v228 offset0:12 offset1:18
  ds_read2st64_b32 v[64:65], v228 offset0:24 offset1:30
  ds_read2st64_b32 v[66:67], v228 offset0:36 offset1:42
  ds_read2st64_b32 v[68:69], v228 offset0:96 offset1:102
  ds_read2st64_b32 v[70:71], v229 offset0:108 offset1:114
  ds_read2st64_b32 v[72:73], v229 offset0:120 offset1:126
  ds_read2st64_b32 v[74:75], v229 offset0:132 offset1:138
  buffer_load_dword v14, v13, s[28:31], s77 offen
  s_cmp_eq_u32 s77, s73
  s_cselect_b32 s73, 0x7000000, s73
  s_cselect_b32 s77, 0x7000000, s77
  s_add_u32 s77, s77, 24
  s_min_u32 s77, s77, s73
  s_cmp_ge_u32 s3, 5
  s_cbranch_scc1 L_u0
  v_add_u32 v228, 32, v228
  v_add_u32_e64 v229, 32, v229
  ds_read2st64_b32 v[92:93], v228 offset0:0 offset1:6
  ds_read2st64_b32 v[94:95], v228 offset0:12 offset1:18
  ds_read2st64_b32 v[96:97], v228 offset0:24 offset1:30
  ds_read2st64_b32 v[98:99], v228 offset0:36 offset1:42
  ds_read2st64_b32 v[100:101], v228 offset0:96 offset1:102
  ds_read2st64_b32 v[102:103], v229 offset0:108 offset1:114
  ds_read2st64_b32 v[104:105], v229 offset0:120 offset1:126
  ds_read2st64_b32 v[106:107], v229 offset0:132 offset1:138
  ds_read_b64_tr_b16 v[76:77], v225 offset:0
  ds_read_b64_tr_b16 v[78:79], v225 offset:5408
  ds_read_b64_tr_b16 v[80:81], v226 offset:0
  ds_read_b64_tr_b16 v[82:83], v227 offset:0
  ds_read_b64_tr_b16 v[84:85], v225 offset:64
  ds_read_b64_tr_b16 v[86:87], v225 offset:5472
  ds_read_b64_tr_b16 v[88:89], v226 offset:64
  ds_read_b64_tr_b16 v[90:91], v227 offset:64
  ds_read_b64_tr_b16 v[112:113], v224 offset:0
  ds_read_b64_tr_b16 v[114:115], v224 offset:256
  ds_read_b64_tr_b16 v[116:117], v224 offset:1024
  ds_read_b64_tr_b16 v[118:119], v224 offset:1280
  s_waitcnt lgkmcnt(14)
  v_mfma_f32_16x16x32_bf16 v[108:111], v[60:63], v[60:63], 0
  v_mfma_f32_16x16x32_bf16 v[108:111], v[64:67], v[64:67], v[108:111]
  v_mfma_f32_16x16x32_bf16 v[108:111], v[68:71], v[68:71], v[108:111]
  s_nop 0
  v_mfma_f32_16x16x32_bf16 v[108:111], v[72:75], v[72:75], v[108:111]
  v_perm_b32 v184, v61, v60, s99
  v_perm_b32 v185, v63, v62, s99
  v_perm_b32 v186, v65, v64, s99
  v_perm_b32 v187, v67, v66, s99
  v_perm_b32 v188, v69, v68, s99
  v_perm_b32 v189, v71, v70, s99
  v_perm_b32 v190, v73, v72, s99
  v_perm_b32 v191, v75, v74, s99
  v_mfma_f32_16x16x32_bf16 v[108:111], v[92:95], v[92:95], v[108:111]
  v_mfma_f32_16x16x32_bf16 v[108:111], v[96:99], v[96:99], v[108:111]
  v_mfma_f32_16x16x32_bf16 v[108:111], v[100:103], v[100:103], v[108:111]
  s_waitcnt lgkmcnt(12)
  v_mfma_f32_16x16x32_bf16 v[108:111], v[104:107], v[104:107], v[108:111]
  s_waitcnt lgkmcnt(10)
  v_mfma_f32_16x16x32_bf16 v[28:31], v[76:79], v[76:79], 0
  s_waitcnt lgkmcnt(8)
  v_mfma_f32_16x16x32_bf16 v[28:31], v[80:83], v[80:83], v[28:31]
  s_waitcnt lgkmcnt(6)
  v_mfma_f32_16x16x32_bf16 v[28:31], v[84:87], v[84:87], v[28:31]
  s_nop 0
  s_waitcnt lgkmcnt(4)
  v_mfma_f32_16x16x32_bf16 v[28:31], v[88:91], v[88:91], v[28:31]
  v_perm_b32 v192, v61, v60, s100
  v_perm_b32 v193, v63, v62, s100
  v_perm_b32 v194, v65, v64, s100
  v_perm_b32 v195, v67, v66, s100
  v_perm_b32 v196, v69, v68, s100
  v_perm_b32 v197, v71, v70, s100
  v_perm_b32 v198, v73, v72, s100
  v_perm_b32 v199, v75, v74, s100
  v_max3_f32 v28, v28, v29, 0
  v_perm_b32 v60, v93, v92, s99
  v_perm_b32 v61, v95, v94, s99
  v_max3_f32 v108, v108, v109, 0
  v_perm_b32 v62, v97, v96, s99
  v_max3_f32 v28, v28, v30, v31
  v_perm_b32 v63, v99, v98, s99
  v_max3_f32 v108, v108, v110, v111
  v_perm_b32 v64, v101, v100, s99
  v_perm_b32 v65, v103, v102, s99
  v_permlane32_swap_b32 v28, v108
  v_perm_b32 v66, v105, v104, s99
  v_max_u32_e64 v28, v28, v108
  v_perm_b32 v67, v107, v106, s99
  s_nop 0
  v_max_u32_dpp v28, v28, v28 row_shr:1 row_mask:0xf bank_mask:0xf
  v_perm_b32 v68, v93, v92, s100
  v_perm_b32 v69, v95, v94, s100
  v_max_u32_dpp v28, v28, v28 row_shr:2 row_mask:0xf bank_mask:0xf
  v_perm_b32 v70, v97, v96, s100
  s_nop 0
  v_max_u32_dpp v28, v28, v28 row_shr:4 row_mask:0xf bank_mask:0xf
  v_perm_b32 v71, v99, v98, s100
  s_nop 0
  v_max_u32_dpp v28, v28, v28 row_shr:8 row_mask:0xf bank_mask:0xf
  v_perm_b32 v72, v101, v100, s100
  v_perm_b32 v73, v103, v102, s100
  v_max_u32_dpp v28, v28, v28 row_bcast:15 row_mask:0xa bank_mask:0xf
  v_perm_b32 v74, v105, v104, s100
  s_mov_b32 exec_lo, 0x80000000
  s_mov_b32 exec_hi, 0x80000000
  ds_max_u32 v3, v28 offset:16
  s_mov_b64 exec, -1
  v_perm_b32 v75, v107, v106, s100
  s_branch L_u1
L_u0:
  ds_read_b64_tr_b16 v[76:77], v225 offset:0
  ds_read_b64_tr_b16 v[78:79], v225 offset:5408
  ds_read_b64_tr_b16 v[80:81], v226 offset:0
  ds_read_b64_tr_b16 v[82:83], v227 offset:0
  ds_read_b64_tr_b16 v[84:85], v225 offset:64
  ds_read_b64_tr_b16 v[86:87], v225 offset:5472
  ds_read_b64_tr_b16 v[88:89], v226 offset:64
  ds_read_b64_tr_b16 v[90:91], v227 offset:64
  ds_read_b64_tr_b16 v[92:93], v225 offset:384
  ds_read_b64_tr_b16 v[94:95], v225 offset:5792
  ds_read_b64_tr_b16 v[96:97], v226 offset:384
  ds_read_b64_tr_b16 v[98:99], v227 offset:384
  ds_read_b64_tr_b16 v[100:101], v225 offset:448
  ds_read_b64_tr_b16 v[102:103], v225 offset:5856
  ds_read_b64_tr_b16 v[104:105], v226 offset:448
  ds_read_b64_tr_b16 v[106:107], v227 offset:448
  ds_read_b64_tr_b16 v[112:113], v224 offset:0
  ds_read_b64_tr_b16 v[114:115], v224 offset:256
  ds_read_b64_tr_b16 v[116:117], v224 offset:1024
  ds_read_b64_tr_b16 v[118:119], v224 offset:1280
  s_waitcnt lgkmcnt(14)
  v_mfma_f32_16x16x32_bf16 v[108:111], v[60:63], v[60:63], 0
  v_mfma_f32_16x16x32_bf16 v[108:111], v[64:67], v[64:67], v[108:111]
  s_nop 0
  v_mfma_f32_16x16x32_bf16 v[108:111], v[68:71], v[68:71], v[108:111]
  v_mfma_f32_16x16x32_bf16 v[108:111], v[72:75], v[72:75], v[108:111]
  v_mfma_f32_16x16x32_bf16 v[28:31], v[76:79], v[76:79], 0
  v_mfma_f32_16x16x32_bf16 v[28:31], v[80:83], v[80:83], v[28:31]
  v_mfma_f32_16x16x32_bf16 v[28:31], v[84:87], v[84:87], v[28:31]
  s_waitcnt lgkmcnt(12)
  v_mfma_f32_16x16x32_bf16 v[28:31], v[88:91], v[88:91], v[28:31]
  s_waitcnt lgkmcnt(10)
  v_mfma_f32_16x16x32_bf16 v[28:31], v[92:95], v[92:95], v[28:31]
  s_waitcnt lgkmcnt(8)
  v_mfma_f32_16x16x32_bf16 v[28:31], v[96:99], v[96:99], v[28:31]
  s_waitcnt lgkmcnt(6)
  v_mfma_f32_16x16x32_bf16 v[28:31], v[100:103], v[100:103], v[28:31]
  s_nop 0
  s_waitcnt lgkmcnt(4)
  v_mfma_f32_16x16x32_bf16 v[28:31], v[104:107], v[104:107], v[28:31]
  v_perm_b32 v184, v61, v60, s99
  v_perm_b32 v185, v63, v62, s99
  v_perm_b32 v186, v65, v64, s99
  v_perm_b32 v187, v67, v66, s99
  s_nop 3
  v_max3_f32 v28, v28, v29, 0
  v_perm_b32 v188, v69, v68, s99
  v_max3_f32 v108, v108, v109, 0
  v_perm_b32 v189, v71, v70, s99
  v_max3_f32 v28, v28, v30, v31
  v_perm_b32 v190, v73, v72, s99
  v_max3_f32 v108, v108, v110, v111
  v_perm_b32 v191, v75, v74, s99
  s_nop 0
  v_permlane32_swap_b32 v28, v108
  v_perm_b32 v192, v61, v60, s100
  v_max_u32 v28, v28, v108
  v_perm_b32 v193, v63, v62, s100
  s_nop 0
  v_max_u32_dpp v28, v28, v28 row_shr:1 row_mask:0xf bank_mask:0xf
  v_perm_b32 v194, v65, v64, s100
  s_nop 0
  v_max_u32_dpp v28, v28, v28 row_shr:2 row_mask:0xf bank_mask:0xf
  v_perm_b32 v195, v67, v66, s100
  s_nop 0
  v_max_u32_dpp v28, v28, v28 row_shr:4 row_mask:0xf bank_mask:0xf
  v_perm_b32 v196, v69, v68, s100
  s_nop 0
  v_max_u32_dpp v28, v28, v28 row_shr:8 row_mask:0xf bank_mask:0xf
  v_perm_b32 v197, v71, v70, s100
  s_nop 0
  v_max_u32_dpp v28, v28, v28 row_bcast:15 row_mask:0xa bank_mask:0xf
  v_perm_b32 v198, v73, v72, s100
  s_mov_b32 exec_lo, 0x80000000
  s_mov_b32 exec_hi, 0x80000000
  ds_max_u32 v3, v28 offset:16
  s_mov_b64 exec, -1
  v_perm_b32 v199, v75, v74, s100
  v_add_u32 v248, 12288, v246
  v_add_u32 v249, 12288, v247
  s_cmp_lg_u32 s3, 7
  s_cbranch_scc1 L_u1
  s_mov_b32 exec_lo, 0xfffffff0
  s_mov_b32 exec_hi, 0xfffffff0
  v_mov_b32 v249, 1048576
  s_mov_b64 exec, -1
L_u1:
  s_waitcnt lgkmcnt(0)
  s_barrier
  ds_read_b128 v[108:111], v2 offset:16
  s_waitcnt vmcnt(0)
  v_lshlrev_b32_e64 v14, 7, v14
  buffer_load_dword v15, v14, s[32:35], 0 offen
  buffer_load_dword v14, v13, s[28:31], s77 offen
  s_cmp_eq_u32 s77, s73
  s_cselect_b32 s73, 0x7000000, s73
  s_cselect_b32 s77, 0x7000000, s77
  s_add_u32 s77, s77, 24
  s_min_u32 s77, s77, s73
  s_mul_i32 s68, s3, 384
  v_lshrrev_b32 v29, 2, v0
  v_mul_u32_u24 v29, 24, v29
  v_add_u32 v29, s68, v29
  v_and_b32 v30, 3, v0
  v_lshlrev_b32 v30, 3, v30
  ds_read_b64 v[224:225], v29 offset:2048
  ds_read_b64 v[226:227], v29 offset:2056
  ds_read_b64 v[228:229], v29 offset:2064
  s_waitcnt lgkmcnt(3)
  v_add_u32 v108, 0x3f800000, v108
  v_add_u32 v109, 0x3f800000, v109
  v_lshrrev_b32 v108, 24, v108
  v_lshrrev_b32_e64 v109, 24, v109
  v_sub_u32 v108, 267, v108
  s_mov_b32 vcc_lo, 0x4000000
  v_min_u32 v108, 167, v108
  s_mov_b32 vcc_hi, 0x4000000
  v_readfirstlane_b32 s74, v108
  v_cndmask_b32 v250, v110, v111, vcc
  v_mul_u32_u24 v108, 0x800080, v108
  v_lshrrev_b32 v250, 23, v250
  v_and_b32 v216, v216, v108
  v_and_b32 v217, v217, v108
  v_and_b32 v218, v218, v108
  v_and_b32 v219, v219, v108
  v_and_b32 v220, v220, v108
  v_and_b32 v221, v221, v108
  v_and_b32 v222, v222, v108
  v_and_b32 v223, v223, v108
  v_mfma_f32_32x32x16_bf16 v[152:167], v[216:219], v[76:79], 0
  v_add_u32 v250, v250, v109
  v_sub_u32 v250, 388, v250
  v_mfma_f32_32x32x16_bf16 v[168:183], v[216:219], v[84:87], 0
  s_movk_i32 s98, 167
  v_med3_i32 v250, v250, 1, s98
  v_mfma_f32_32x32x16_bf16 v[152:167], v[220:223], v[80:83], v[152:167]
  v_subrev_u32 v110, 127, v250
  v_lshlrev_b32 v250, 23, v250
  v_mfma_f32_32x32x16_bf16 v[168:183], v[220:223], v[88:91], v[168:183]
  v_cmp_gt_i32 vcc, 0, v110
  v_mul_u32_u24 v110, 0x800080, v110
  s_cbranch_vccnz L_sdown
  v_add_u32 v112, v112, v110
  v_add_u32 v113, v113, v110
  v_add_u32 v114, v114, v110
  v_add_u32 v115, v115, v110
  v_add_u32 v116, v116, v110
  v_add_u32 v117, v117, v110
  v_add_u32 v118, v118, v110
  v_add_u32 v119, v119, v110
L_scaled:
  v_mfma_f32_32x32x16_bf16 v[120:135], v[184:187], v[112:115], 0
  v_cvt_pk_f16_f32 v152, v152, v153
  v_cvt_pk_f16_f32 v153, v154, v155
  v_cvt_pk_f16_f32 v154, v156, v157
  v_cvt_pk_f16_f32 v155, v158, v159
  ds_write_b128 v246, v[152:155]
  v_xor_b32_e64 v246, 16, v246
  v_mfma_f32_32x32x16_bf16 v[120:135], v[188:191], v[116:119], v[120:135]
  v_cvt_pk_f16_f32 v156, v160, v161
  v_cvt_pk_f16_f32 v157, v162, v163
  v_cvt_pk_f16_f32 v158, v164, v165
  v_cvt_pk_f16_f32 v159, v166, v167
  ds_write_b128 v246, v[156:159]
  v_mfma_f32_32x32x16_bf16 v[136:151], v[192:195], v[112:115], 0
  v_cvt_pk_f16_f32 v168, v168, v169
  v_cvt_pk_f16_f32 v169, v170, v171
  v_cvt_pk_f16_f32 v170, v172, v173
  v_cvt_pk_f16_f32 v171, v174, v175
  ds_write_b128 v247, v[168:171]
  v_xor_b32_e64 v247, 16, v247
  v_mfma_f32_32x32x16_bf16 v[136:151], v[196:199], v[116:119], v[136:151]
  v_cvt_pk_f16_f32 v172, v176, v177
  v_cvt_pk_f16_f32 v173, v178, v179
  v_cvt_pk_f16_f32 v174, v180, v181
  v_cvt_pk_f16_f32 v175, v182, v183
  ds_write_b128 v247, v[172:175]
  s_cmp_ge_u32 s3, 5
  s_cbranch_scc1 L_u2
  v_mfma_f32_32x32x16_bf16 v[184:199], v[60:63], v[112:115], 0
  v_cvt_pk_f16_f32 v120, v120, v121
  v_cvt_pk_f16_f32 v121, v122, v123
  v_cvt_pk_f16_f32 v122, v124, v125
  v_mfma_f32_32x32x16_bf16 v[184:199], v[64:67], v[116:119], v[184:199]
  v_cvt_pk_f16_f32 v123, v126, v127
  ds_write_b128 v244, v[120:123]
  v_xor_b32_e64 v244, 16, v244
  v_mfma_f32_32x32x16_bf16 v[200:215], v[68:71], v[112:115], 0
  v_cvt_pk_f16_f32 v124, v128, v129
  v_cvt_pk_f16_f32 v125, v130, v131
  v_cvt_pk_f16_f32 v126, v132, v133
  v_mfma_f32_32x32x16_bf16 v[200:215], v[72:75], v[116:119], v[200:215]
  v_cvt_pk_f16_f32 v127, v134, v135
  ds_write_b128 v244, v[124:127]
  s_branch L_u3
L_u2:
  v_mfma_f32_32x32x16_bf16 v[184:199], v[216:219], v[92:95], 0
  v_cvt_pk_f16_f32 v120, v120, v121
  v_cvt_pk_f16_f32 v121, v122, v123
  v_cvt_pk_f16_f32 v122, v124, v125
  v_mfma_f32_32x32x16_bf16 v[184:199], v[220:223], v[96:99], v[184:199]
  v_cvt_pk_f16_f32 v123, v126, v127
  ds_write_b128 v244, v[120:123]
  v_xor_b32 v244, 16, v244
  v_mfma_f32_32x32x16_bf16 v[200:215], v[216:219], v[100:103], 0
  v_cvt_pk_f16_f32 v124, v128, v129
  v_cvt_pk_f16_f32 v125, v130, v131
  v_cvt_pk_f16_f32 v126, v132, v133
  v_mfma_f32_32x32x16_bf16 v[200:215], v[220:223], v[104:107], v[200:215]
  v_cvt_pk_f16_f32 v127, v134, v135
  ds_write_b128 v244, v[124:127]
L_u3:
  buffer_load_dwordx4 v[16:19], v6, s[28:31], s94 offen
  s_add_u32 s94, s94, 416
  buffer_load_dwordx4 v[112:115], v6, s[28:31], s94 offen
  s_add_u32 s94, s94, 416
  v_cvt_pk_f16_f32 v136, v136, v137
  s_waitcnt lgkmcnt(8)
  v_xor_b32 v224, v224, v30
  v_cvt_pk_f16_f32 v137, v138, v139
  v_cvt_pk_f16_f32 v138, v140, v141
  v_xor_b32 v232, 32, v224
  v_cvt_pk_f16_f32 v139, v142, v143
  ds_write_b128 v245, v[136:139]
  v_xor_b32 v245, 16, v245
  v_xor_b32 v225, v225, v30
  v_cvt_pk_f16_f32 v140, v144, v145
  v_cvt_pk_f16_f32 v141, v146, v147
  v_cvt_pk_f16_f32 v142, v148, v149
  v_xor_b32 v233, 32, v225
  v_cvt_pk_f16_f32 v143, v150, v151
  ds_write_b128 v245, v[140:143]
  v_cvt_pk_f16_f32 v184, v184, v185
  s_waitcnt lgkmcnt(9)
  v_xor_b32 v226, v226, v30
  v_cvt_pk_f16_f32 v185, v186, v187
  v_cvt_pk_f16_f32 v186, v188, v189
  v_xor_b32 v234, 32, v226
  v_cvt_pk_f16_f32 v187, v190, v191
  ds_write_b128 v248, v[184:187]
  v_xor_b32 v248, 16, v248
  v_xor_b32 v227, v227, v30
  v_cvt_pk_f16_f32 v188, v192, v193
  v_cvt_pk_f16_f32 v189, v194, v195
  v_cvt_pk_f16_f32 v190, v196, v197
  v_xor_b32 v235, 32, v227
  v_cvt_pk_f16_f32 v191, v198, v199
  ds_write_b128 v248, v[188:191]
  v_cvt_pk_f16_f32 v200, v200, v201
  s_waitcnt lgkmcnt(10)
  v_xor_b32 v228, v228, v30
  v_cvt_pk_f16_f32 v201, v202, v203
  v_cvt_pk_f16_f32 v202, v204, v205
  v_xor_b32 v240, 32, v228
  v_cvt_pk_f16_f32 v203, v206, v207
  ds_write_b128 v249, v[200:203]
  v_xor_b32 v249, 16, v249
  v_xor_b32_e64 v229, v229, v30
  v_cvt_pk_f16_f32 v204, v208, v209
  v_cvt_pk_f16_f32 v205, v210, v211
  v_cvt_pk_f16_f32 v206, v212, v213
  v_xor_b32_e64 v241, 32, v229
  v_cvt_pk_f16_f32 v207, v214, v215
  ds_write_b128 v249, v[204:207]
  v_readlane_b32 s0, v250, 0
  v_readlane_b32 s1, v250, 26
  s_sub_u32 s75, 0x7f000000, s0
  s_sub_u32 s1, 0x7f000000, s1
  s_sub_u32 s74, 254, s74
  s_lshl_b32 s74, s74, 23
  s_mov_b32 s92, 0x88888888
  s_mov_b32 s93, 0x88888888
  s_waitcnt lgkmcnt(0)
  s_barrier
  ds_read_b64_tr_b16 v[60:61], v224 offset:0
  ds_read_b64_tr_b16 v[62:63], v225 offset:0
  ds_read_b64_tr_b16 v[64:65], v232 offset:0
  ds_read_b64_tr_b16 v[66:67], v233 offset:0
  ds_read_b64_tr_b16 v[68:69], v224 offset:43328
  ds_read_b64_tr_b16 v[70:71], v225 offset:43328
  ds_read_b64_tr_b16 v[72:73], v232 offset:43328
  ds_read_b64_tr_b16 v[74:75], v233 offset:43328
  ds_read_b64_tr_b16 v[76:77], v226 offset:0
  ds_read_b64_tr_b16 v[78:79], v227 offset:0
  ds_read_b64_tr_b16 v[80:81], v234 offset:0
  ds_read_b64_tr_b16 v[82:83], v235 offset:0
  ds_read_b64_tr_b16 v[84:85], v226 offset:43328
  ds_read_b64_tr_b16 v[86:87], v227 offset:43328
  ds_read_b64_tr_b16 v[88:89], v234 offset:43328
  ds_read_b64_tr_b16 v[90:91], v235 offset:43328
  s_cmp_ge_u32 s3, 6
  s_cbranch_scc1 L_lin
  ds_read_b64_tr_b16 v[92:93], v228 offset:0
  ds_read_b64_tr_b16 v[94:95], v229 offset:0
  ds_read_b64_tr_b16 v[96:97], v240 offset:0
  ds_read_b64_tr_b16 v[98:99], v241 offset:0
  ds_read_b64_tr_b16 v[100:101], v228 offset:43328
  ds_read_b64_tr_b16 v[102:103], v229 offset:43328
  ds_read_b64_tr_b16 v[104:105], v240 offset:43328
  ds_read_b64_tr_b16 v[106:107], v241 offset:43328
  s_waitcnt lgkmcnt(6)
  v_pk_add_f16 v92, v92, v94
  v_pk_add_f16 v93, v93, v95
  ds_write_b64 v59, v[92:93] offset:30720
  s_waitcnt lgkmcnt(5)
  v_pk_add_f16 v96, v96, v98
  v_pk_add_f16 v97, v97, v99
  s_waitcnt lgkmcnt(3)
  v_pk_add_f16 v100, v100, v102
  v_pk_add_f16 v101, v101, v103
  ds_write_b64 v59, v[100:101] offset:32768
  s_waitcnt lgkmcnt(2)
  v_pk_add_f16 v104, v104, v106
  v_pk_add_f16 v105, v105, v107
  v_cndmask_b32 v96, v96, v104, s[92:93]
  v_cndmask_b32 v97, v97, v105, s[92:93]
  ds_write_b64 v59, v[96:97] offset:31744
  ds_write_b32 v230, v104 offset:3072
  ds_write_b32 v230, v105 offset:3088
  s_branch L_p2
L_lin:
  s_and_b32 s98, s3, 1
  s_cselect_b64 vcc, -1, 0
  s_lshl_b32 s99, s98, 5
  v_mov_b32 v31, 0
  v_xor_b32 v236, s99, v236
  v_xor_b32 v237, s99, v237
  v_cndmask_b32 v238, v238, v239, vcc
  ds_read_b64_tr_b16 v[92:93], v236
  ds_read_b64_tr_b16 v[94:95], v237
  ds_read_u16_d16_hi v31, v238
  s_lshl_b32 s98, s98, 10
  v_add_u32 v29, s98, v1
  s_waitcnt lgkmcnt(2)
  v_cvt_f32_f16_e64 v96, v92
  v_cvt_f32_f16_sdwa v97, v92 dst_sel:DWORD dst_unused:UNUSED_PAD src0_sel:WORD_1
  v_mul_f32 v96, s1, v96
  v_mul_f32 v97, s1, v97
  v_mul_f32 v96, s0, v96
  v_mul_f32 v97, s0, v97
  v_cvt_pk_bf16_f32 v92, v96, v97
  v_cvt_f32_f16 v98, v93
  v_cvt_f32_f16_sdwa v99, v93 dst_sel:DWORD dst_unused:UNUSED_PAD src0_sel:WORD_1
  v_mul_f32 v98, s1, v98
  v_mul_f32 v99, s1, v99
  v_mul_f32 v98, s0, v98
  v_mul_f32_e64 v99, s0, v99
  v_cvt_pk_bf16_f32 v93, v98, v99
  s_waitcnt lgkmcnt(1)
  v_cvt_f32_f16 v100, v94
  v_cvt_f32_f16_sdwa v101, v94 dst_sel:DWORD dst_unused:UNUSED_PAD src0_sel:WORD_1
  v_mul_f32 v100, s1, v100
  v_mul_f32 v101, s1, v101
  v_mul_f32 v100, s0, v100
  v_mul_f32 v101, s0, v101
  v_cvt_pk_bf16_f32 v94, v100, v101
  v_cvt_f32_f16 v102, v95
  v_cvt_f32_f16_sdwa v103, v95 dst_sel:DWORD dst_unused:UNUSED_PAD src0_sel:WORD_1
  v_mul_f32 v102, s1, v102
  v_mul_f32 v103, s1, v103
  s_mov_b32 exec_lo, 0
  s_mov_b32 exec_hi, 0xffff
  s_waitcnt lgkmcnt(0)
  v_mov_b32 v102, v31
  s_mov_b64 exec, -1
  v_mul_f32 v102, s0, v102
  v_mul_f32_e64 v103, s0, v103
  v_cvt_pk_bf16_f32 v95, v102, v103
  ds_write_b128 v29, v[92:95] offset:39936
L_p2:
  v_pk_add_f16 v76, v76, v78
  v_pk_add_f16 v77, v77, v79
  ds_write_b64 v59, v[76:77] offset:18432
  v_pk_add_f16 v80, v80, v82
  v_pk_add_f16 v81, v81, v83
  v_pk_add_f16 v84, v84, v86
  v_pk_add_f16 v85, v85, v87
  ds_write_b64 v59, v[84:85] offset:20480
  v_pk_add_f16 v88, v88, v90
  v_pk_add_f16 v89, v89, v91
  v_cndmask_b32 v80, v80, v88, s[92:93]
  v_cndmask_b32 v81, v81, v89, s[92:93]
  ds_write_b64 v59, v[80:81] offset:19456
  ds_write_b32 v230, v88 offset:1024
  ds_write_b32 v230, v89 offset:1040
  v_pk_add_f16 v60, v60, v62
  v_pk_add_f16 v61, v61, v63
  ds_write_b64 v59, v[60:61] offset:6144
  v_pk_add_f16 v64, v64, v66
  v_pk_add_f16 v65, v65, v67
  v_pk_add_f16 v68, v68, v70
  v_pk_add_f16 v69, v69, v71
  ds_write_b64 v59, v[68:69] offset:8192
  v_pk_add_f16 v72, v72, v74
  v_pk_add_f16 v73, v73, v75
  v_cndmask_b32 v64, v64, v72, s[92:93]
  v_cndmask_b32 v65, v65, v73, s[92:93]
  ds_write_b64 v59, v[64:65] offset:7168
  s_cmp_lt_u32 s3, 2
  s_cbranch_scc1 L_p2d
  v_subrev_u32 v230, 1024, v230
  ds_write_b32 v230, v72 offset:0
  ds_write_b32 v230, v73 offset:16
  s_branch L_built
L_p2d:
  ds_write_b64 v231, v[72:73] offset:5120
L_built:
  s_mov_b32 s0, s74
  s_mov_b32 s1, s75
  s_mov_b32 s96, 0x3e000000
  s_mov_b32 s97, 0x43000000
  s_mov_b32 s51, 1
  s_mul_i32 s98, s3, 1536
  s_add_u32 s98, s98, 116736
  s_cmp_lg_u32 s84, 0
  s_cbranch_scc1 L_g1c
  s_sub_u32 s94, s94, 416
  s_waitcnt vmcnt(0)
  ds_read_u16_d16_hi v32, v10 offset:0
  ds_read_u16_d16_hi v33, v10 offset:2
  ds_read_u16_d16_hi v34, v10 offset:2112
  ds_read_u16_d16_hi v35, v10 offset:2114
  ds_read_u16_d16_hi v36, v10 offset:128
  ds_read_u16_d16_hi v37, v10 offset:130
  ds_read_u16_d16_hi v38, v10 offset:2240
  ds_read_u16_d16_hi v39, v10 offset:2242
  ds_read_u16_d16_hi v40, v10 offset:256
  ds_read_u16_d16_hi v41, v10 offset:258
  ds_read_u16_d16_hi v42, v10 offset:2368
  ds_read_u16_d16_hi v43, v10 offset:2370
  ds_read_u16_d16_hi v44, v10 offset:384
  ds_read_u16_d16_hi v45, v10 offset:386
  ds_read_u16_d16_hi v46, v10 offset:2496
  ds_read_u16_d16_hi v47, v10 offset:2498
  ds_read_u16_d16_hi v48, v10 offset:512
  ds_read_u16_d16_hi v49, v10 offset:514
  ds_read_u16_d16_hi v50, v10 offset:2624
  ds_read_u16_d16_hi v51, v10 offset:2626
  ds_read_u16_d16_hi v52, v10 offset:640
  ds_read_u16_d16_hi v53, v10 offset:642
  ds_read_u16_d16_hi v54, v10 offset:2752
  ds_read_u16_d16_hi v55, v10 offset:2754
  ds_read_u16_d16_hi v56, v10 offset:768
  ds_read_u16_d16_hi v57, v10 offset:770
  s_waitcnt lgkmcnt(14)
  v_max3_f32 v58, |v32|, |v33|, 0
  v_cvt_pk_f16_f32 v184, v32, v33
  v_max3_f32 v58, |v34|, |v35|, v58
  v_cvt_pk_f16_f32 v185, v34, v35
  v_max3_f32 v58, |v36|, |v37|, v58
  v_cvt_pk_f16_f32 v186, v36, v37
  v_max3_f32 v58, |v38|, |v39|, v58
  v_cvt_pk_f16_f32 v187, v38, v39
  v_max3_f32 v58, |v40|, |v41|, v58
  v_cvt_pk_f16_f32 v188, v40, v41
  v_max3_f32 v58, |v42|, |v43|, v58
  v_cvt_pk_f16_f32 v189, v42, v43
  s_waitcnt lgkmcnt(12)
  v_max3_f32 v58, |v44|, |v45|, v58
  v_cvt_pk_f16_f32 v190, v44, v45
  s_waitcnt lgkmcnt(10)
  v_max3_f32 v58, |v46|, |v47|, v58
  v_cvt_pk_f16_f32 v191, v46, v47
  s_waitcnt lgkmcnt(8)
  v_max3_f32 v58, |v48|, |v49|, v58
  v_cvt_pk_f16_f32 v192, v48, v49
  s_waitcnt lgkmcnt(6)
  v_max3_f32 v58, |v50|, |v51|, v58
  v_cvt_pk_f16_f32 v193, v50, v51
  s_waitcnt lgkmcnt(4)
  v_max3_f32 v58, |v52|, |v53|, v58
  v_cvt_pk_f16_f32 v194, v52, v53
  s_waitcnt lgkmcnt(2)
  v_max3_f32 v58, |v54|, |v55|, v58
  v_cvt_pk_f16_f32 v195, v54, v55
  s_waitcnt lgkmcnt(0)
  v_max3_f32 v58, |v56|, |v57|, v58
  v_cvt_pk_f16_f32 v196, v56, v57
  s_waitcnt lgkmcnt(0)
  s_barrier
  s_branch L_cin_go
L_g1c:
  s_waitcnt lgkmcnt(0)
  s_barrier
  s_add_u32 s76, s76, -63168
  s_waitcnt vmcnt(1)
  v_lshl_add_u32 v16, v16, 7, v8
  v_lshl_add_u32 v17, v17, 7, v8
  v_lshl_add_u32 v18, v18, 7, v8
  v_lshl_add_u32 v19, v19, 7, v8
  s_add_u32 m0, s76, 0
  s_mov_b32 exec_hi, 0xffffff
  buffer_load_dwordx4 v16, s[32:35], 0 offen lds
  s_add_u32 m0, s76, 1056
  s_nop 0
  buffer_load_dwordx4 v17, s[32:35], 0 offen lds
  s_add_u32 m0, s76, 2112
  s_mov_b32 exec_hi, 0xffff
  buffer_load_dwordx4 v18, s[32:35], 0 offen lds
  s_add_u32 m0, s76, 3168
  s_nop 0
  buffer_load_dwordx4 v19, s[32:35], 0 offen lds
  s_mov_b32 exec_hi, -1
  s_waitcnt vmcnt(4)
  v_lshl_add_u32 v112, v112, 7, v8
  v_lshl_add_u32 v113, v113, 7, v8
  v_lshl_add_u32 v114, v114, 7, v8
  v_lshl_add_u32 v115, v115, 7, v8
  s_add_u32 m0, s76, 16256
  s_mov_b32 exec_hi, 0xffffff
  buffer_load_dwordx4 v112, s[32:35], 0 offen lds
  s_add_u32 m0, s76, 17312
  s_nop 0
  buffer_load_dwordx4 v113, s[32:35], 0 offen lds
  s_add_u32 m0, s76, 18368
  s_mov_b32 exec_hi, 0xffff
  buffer_load_dwordx4 v114, s[32:35], 0 offen lds
  s_add_u32 m0, s76, 19424
  s_nop 0
  buffer_load_dwordx4 v115, s[32:35], 0 offen lds
  s_mov_b32 exec_hi, -1
  buffer_load_dwordx4 v[16:19], v6, s[28:31], s94 offen
  s_add_u32 s94, s94, 416
  v_lshlrev_b32 v14, 7, v14
  buffer_load_dword v15, v14, s[32:35], 0 offen
  buffer_load_dword v14, v13, s[28:31], s77 offen
  s_cmp_eq_u32 s77, s73
  s_cselect_b32 s73, 0x7000000, s73
  s_cselect_b32 s77, 0x7000000, s77
  s_add_u32 s77, s77, 24
  s_min_u32 s77, s77, s73
  buffer_load_dword v3, v12, s[44:47], s101 offen
  s_add_u32 s101, s101, 1144832
  v_add_u32 v10, -63168, v10
  v_add_u32 v4, -63168, v4
  v_add_u32 v5, -63168, v5
  ds_write_b32 v10, v7 offset:2880
  ds_write_b32 v10, v7 offset:19136
L_g1d:
  s_waitcnt vmcnt(8)
  ds_read_u16_d16_hi v32, v10 offset:0
  ds_read_u16_d16_hi v33, v10 offset:2
  ds_read_u16_d16_hi v34, v10 offset:2112
  ds_read_u16_d16_hi v35, v10 offset:2114
  ds_read_u16_d16_hi v36, v10 offset:128
  ds_read_u16_d16_hi v37, v10 offset:130
  ds_read_u16_d16_hi v38, v10 offset:2240
  ds_read_u16_d16_hi v39, v10 offset:2242
  ds_read_u16_d16_hi v40, v10 offset:256
  ds_read_u16_d16_hi v41, v10 offset:258
  ds_read_u16_d16_hi v42, v10 offset:2368
  ds_read_u16_d16_hi v43, v10 offset:2370
  ds_read_u16_d16_hi v44, v10 offset:384
  ds_read_u16_d16_hi v45, v10 offset:386
  ds_read_u16_d16_hi v46, v10 offset:2496
  ds_read_u16_d16_hi v47, v10 offset:2498
  ds_read_u16_d16_hi v48, v10 offset:512
  ds_read_u16_d16_hi v49, v10 offset:514
  ds_read_u16_d16_hi v50, v10 offset:2624
  ds_read_u16_d16_hi v51, v10 offset:2626
  ds_read_u16_d16_hi v52, v10 offset:640
  ds_read_u16_d16_hi v53, v10 offset:642
  ds_read_u16_d16_hi v54, v10 offset:2752
  ds_read_u16_d16_hi v55, v10 offset:2754
  ds_read_u16_d16_hi v56, v10 offset:768
  ds_read_u16_d16_hi v57, v10 offset:770
  s_waitcnt lgkmcnt(14)
  v_max3_f32 v58, |v32|, |v33|, 0
  v_cvt_pk_f16_f32 v184, v32, v33
  v_max3_f32 v58, |v34|, |v35|, v58
  v_cvt_pk_f16_f32 v185, v34, v35
  v_max3_f32 v58, |v36|, |v37|, v58
  v_cvt_pk_f16_f32 v186, v36, v37
  v_max3_f32 v58, |v38|, |v39|, v58
  v_cvt_pk_f16_f32 v187, v38, v39
  v_max3_f32 v58, |v40|, |v41|, v58
  v_cvt_pk_f16_f32 v188, v40, v41
  v_max3_f32 v58, |v42|, |v43|, v58
  v_cvt_pk_f16_f32 v189, v42, v43
  s_waitcnt lgkmcnt(12)
  v_max3_f32 v58, |v44|, |v45|, v58
  v_cvt_pk_f16_f32 v190, v44, v45
  s_waitcnt lgkmcnt(10)
  v_max3_f32 v58, |v46|, |v47|, v58
  v_cvt_pk_f16_f32 v191, v46, v47
  s_waitcnt lgkmcnt(8)
  v_max3_f32 v58, |v48|, |v49|, v58
  v_cvt_pk_f16_f32 v192, v48, v49
  s_waitcnt lgkmcnt(6)
  v_max3_f32 v58, |v50|, |v51|, v58
  v_cvt_pk_f16_f32 v193, v50, v51
  s_waitcnt lgkmcnt(4)
  v_max3_f32 v58, |v52|, |v53|, v58
  v_cvt_pk_f16_f32 v194, v52, v53
  s_waitcnt lgkmcnt(2)
  v_max3_f32 v58, |v54|, |v55|, v58
  v_cvt_pk_f16_f32 v195, v54, v55
  s_waitcnt lgkmcnt(0)
  v_max3_f32 v58, |v56|, |v57|, v58
  v_cvt_pk_f16_f32 v196, v56, v57
L_cin_go:
  ds_write_b32 v11, v184 offset:0
  ds_write_b32 v11, v185 offset:160
  ds_write_b32 v11, v186 offset:320
  ds_write_b32 v11, v187 offset:480
  ds_write_b32 v11, v188 offset:640
  ds_write_b32 v11, v189 offset:800
  ds_write_b32 v11, v190 offset:960
  ds_write_b32 v11, v191 offset:1120
  ds_write_b32 v11, v192 offset:1280
  ds_write_b32 v11, v193 offset:1440
  ds_write_b32 v11, v194 offset:1600
  ds_write_b32 v11, v195 offset:1760
  ds_write_b32 v11, v196 offset:1920
  s_mov_b32 s81, 16256
  s_add_u32 s76, s76, 16256
  v_lshlrev_b32 v7, 2, v0
  v_add_u32 v7, s98, v7
L_cin_loop:
  v_cmp_le_f32 s[90:91], s97, v58
  v_cmp_le_f32 vcc, s96, v58
  s_mov_b32 s49, s74
  s_mov_b32 s50, s75
  s_cmp_lg_u64 s[90:91], 0
  s_cbranch_scc1 L_cslow
  s_cbranch_vccz L_cslow
L_cconv:
  s_cmp_lg_u32 s51, 0
  s_cbranch_scc1 L_first
  ds_read_b64_tr_b16 v[60:61], v20 offset:0
  v_mul_f32 v116, v184, v192
  v_mul_f32 v117, v185, v193
  ds_read_b64_tr_b16 v[74:75], v20 offset:32
  v_mul_f32 v118, v186, v194
  ds_read_b64_tr_b16 v[88:89], v20 offset:64
  v_mul_f32 v119, v187, v195
  ds_read_b64_tr_b16 v[102:103], v20 offset:96
  v_fmac_f32 v116, v188, v191
  ds_read_b64_tr_b16 v[66:67], v23 offset:0
  v_fmac_f32 v117, v200, v208
  ds_read_b64_tr_b16 v[80:81], v23 offset:32
  v_fmac_f32 v118, v201, v209
  ds_read_b64_tr_b16 v[94:95], v23 offset:64
  v_fmac_f32 v119, v202, v210
  ds_read_b64_tr_b16 v[108:109], v23 offset:96
  v_fmac_f32 v116, v203, v211
  ds_read_b64_tr_b16 v[68:69], v24 offset:0
  v_fmac_f32 v117, v204, v207
  ds_read_b64_tr_b16 v[82:83], v24 offset:32
  v_fmac_f32_e64 v118, v216, v224
  ds_read_b64_tr_b16 v[96:97], v24 offset:64
  v_fmac_f32 v119, v217, v225
  ds_read_b64_tr_b16 v[110:111], v24 offset:96
  v_fmac_f32 v116, v218, v226
  ds_read_b64_tr_b16 v[124:125], v4 offset:0
  v_fmac_f32 v117, v219, v227
  ds_read_b64_tr_b16 v[126:127], v5 offset:0
  v_fmac_f32 v118, v220, v223
  v_fmac_f32 v119, v232, v240
  ds_read_b64_tr_b16 v[136:137], v4 offset:32
  v_fmac_f32 v116, v233, v241
  ds_read_b64_tr_b16 v[138:139], v5 offset:32
  v_fmac_f32 v117, v234, v242
  ds_read_b64_tr_b16 v[148:149], v4 offset:64
  v_fmac_f32 v118, v235, v243
  ds_read_b64_tr_b16 v[150:151], v5 offset:64
  v_fmac_f32 v119, v236, v239
  ds_read_b64_tr_b16 v[160:161], v4 offset:96
  v_fmac_f32 v116, v189, v196
  ds_read_b64_tr_b16 v[162:163], v5 offset:96
  v_fmac_f32_e64 v117, v189, v197
  ds_read_b128 v[164:167], v1 offset:39936
  v_fmac_f32 v118, v190, v198
  ds_read_b128 v[168:171], v1 offset:40960
  v_fmac_f32 v119, v190, v199
  ds_read_b128 v[172:175], v1 offset:8192
  v_fmac_f32 v116, v205, v212
  ds_read_b128 v[176:179], v1 offset:6144
  v_fmac_f32 v117, v205, v213
  ds_read_b64_tr_b16 v[70:71], v25 offset:0
  v_fmac_f32_e64 v118, v206, v214
  ds_read_b64_tr_b16 v[84:85], v25 offset:32
  v_fmac_f32 v119, v206, v215
  ds_read_b64_tr_b16 v[98:99], v25 offset:64
  v_fmac_f32 v116, v221, v228
  v_fmac_f32 v117, v221, v229
  ds_read_b64_tr_b16 v[112:113], v25 offset:96
  v_fmac_f32 v118, v222, v230
  ds_read_b64_tr_b16 v[72:73], v26 offset:0
  v_fmac_f32 v119, v222, v231
  ds_read_b64_tr_b16 v[86:87], v26 offset:32
  v_fmac_f32 v116, v237, v244
  ds_read_b64_tr_b16 v[100:101], v26 offset:64
  v_fmac_f32 v117, v237, v245
  ds_read_b64_tr_b16 v[114:115], v26 offset:96
  v_fmac_f32 v118, v238, v246
  ds_read_b64_tr_b16 v[62:63], v21 offset:0
  v_fmac_f32 v119, v238, v247
  ds_read_b64_tr_b16 v[76:77], v21 offset:32
  v_add_f32 v116, v116, v117
  ds_read_b64_tr_b16 v[90:91], v21 offset:64
  v_add_f32_e64 v118, v118, v119
  ds_read_b64_tr_b16 v[104:105], v21 offset:96
  v_add_f32 v116, v116, v118
  ds_read_b64_tr_b16 v[64:65], v22 offset:0
  v_mul_f32 v116, s49, v116
  ds_read_b64_tr_b16 v[78:79], v22 offset:32
  v_mul_f32_e64 v116, s50, v116
  ds_read_b64_tr_b16 v[92:93], v22 offset:64
  ds_write_b32 v7, v116
  ds_read_b64_tr_b16 v[106:107], v22 offset:96
  v_add_u32 v7, 256, v7
  s_waitcnt lgkmcnt(14)
  v_pk_mul_f16 v120, v60, v67 op_sel:[0,0] op_sel_hi:[0,1]
  v_pk_mul_f16 v121, v60, v67 op_sel:[1,0] op_sel_hi:[1,1]
  v_pk_mul_f16 v122, v60, v68 op_sel:[0,0] op_sel_hi:[0,1]
  v_pk_mul_f16 v123, v60, v68 op_sel:[1,0] op_sel_hi:[1,1]
  v_pk_mul_f16 v132, v74, v81 op_sel:[0,0] op_sel_hi:[0,1]
  v_pk_mul_f16 v133, v74, v81 op_sel:[1,0] op_sel_hi:[1,1]
  v_pk_mul_f16 v134, v74, v82 op_sel:[0,0] op_sel_hi:[0,1]
  v_pk_mul_f16 v135, v74, v82 op_sel:[1,0] op_sel_hi:[1,1]
  v_pk_mul_f16 v144, v88, v95 op_sel:[0,0] op_sel_hi:[0,1]
  v_pk_mul_f16 v145, v88, v95 op_sel:[1,0] op_sel_hi:[1,1]
  v_pk_mul_f16 v146, v88, v96 op_sel:[0,0] op_sel_hi:[0,1]
  v_pk_mul_f16 v147, v88, v96 op_sel:[1,0] op_sel_hi:[1,1]
  v_pk_mul_f16 v156, v102, v109 op_sel:[0,0] op_sel_hi:[0,1]
  v_pk_mul_f16 v157, v102, v109 op_sel:[1,0] op_sel_hi:[1,1]
  v_pk_mul_f16 v158, v102, v110 op_sel:[0,0] op_sel_hi:[0,1]
  v_pk_mul_f16 v159, v102, v110 op_sel:[1,0] op_sel_hi:[1,1]
  s_waitcnt vmcnt(3)
  v_lshl_add_u32 v16, v16, 7, v8
  v_lshl_add_u32 v17, v17, 7, v8
  v_lshl_add_u32 v18, v18, 7, v8
  v_lshl_add_u32 v19, v19, 7, v8
  s_add_u32 m0, s76, 0
  s_mov_b32 exec_hi, 0xffffff
  buffer_load_dwordx4 v16, s[32:35], 0 offen lds
  s_add_u32 m0, s76, 1056
  s_nop 0
  buffer_load_dwordx4 v17, s[32:35], 0 offen lds
  s_add_u32 m0, s76, 2112
  s_mov_b32 exec_hi, 0xffff
  buffer_load_dwordx4 v18, s[32:35], 0 offen lds
  s_add_u32 m0, s76, 3168
  s_nop 0
  buffer_load_dwordx4 v19, s[32:35], 0 offen lds
  s_mov_b32 exec_hi, -1
  buffer_load_dwordx4 v[16:19], v6, s[28:31], s94 offen
  s_add_u32 s94, s94, 416
  s_waitcnt vmcnt(6)
  v_lshlrev_b32_e64 v14, 7, v14
  buffer_load_dword v15, v14, s[32:35], 0 offen
  buffer_load_dword v14, v13, s[28:31], s77 offen
  s_cmp_eq_u32 s77, s73
  s_cselect_b32 s73, 0x7000000, s73
  s_cselect_b32 s77, 0x7000000, s77
  s_add_u32 s77, s77, 24
  s_min_u32 s77, s77, s73
  s_waitcnt vmcnt(7)
  buffer_load_dword v3, v12, s[44:47], s101 offen
  s_add_u32 s101, s101, 1144832
L_novm:
  v_add_u32 v10, s81, v10
  v_add_u32 v4, s81, v4
  v_add_u32 v5, s81, v5
  s_sub_u32 s76, s76, s81
  s_sub_u32 s81, 0, s81
  s_mov_b32 s51, 0
  s_waitcnt lgkmcnt(14)
  s_setprio 1
  v_mfma_f32_16x16x32_bf16 v[184:187], v[164:167], v[124:127], 0
  ds_read_b128 v[180:183], v1 offset:7168
  v_pk_mul_f16 v116, v60, v69 op_sel:[0,0] op_sel_hi:[0,1]
  v_mfma_f32_16x16x32_bf16 v[200:203], v[164:167], v[136:139], 0
  v_pk_mul_f16 v117, v60, v69 op_sel:[1,0] op_sel_hi:[1,1]
  v_mfma_f32_16x16x32_bf16 v[216:219], v[164:167], v[148:151], 0
  s_nop 0
  v_pk_mul_f16 v118, v60, v70 op_sel:[0,0] op_sel_hi:[0,1]
  v_mfma_f32_16x16x32_bf16 v[232:235], v[164:167], v[160:163], 0
  v_pk_mul_f16 v119, v60, v70 op_sel:[1,0] op_sel_hi:[1,1]
  v_mfma_f32_16x16x32_bf16 v[188:191], v[168:171], v[124:127], 0
  ds_read_b128 v[164:167], v1 offset:5120
  v_pk_mul_f16 v128, v74, v83 op_sel:[0,0] op_sel_hi:[0,1]
  v_mfma_f32_16x16x32_bf16 v[204:207], v[168:171], v[136:139], 0
  v_pk_mul_f16 v129, v74, v83 op_sel:[1,0] op_sel_hi:[1,1]
  v_mfma_f32_16x16x32_bf16 v[220:223], v[168:171], v[148:151], 0
  v_pk_mul_f16 v130, v74, v84 op_sel:[0,0] op_sel_hi:[0,1]
  v_mfma_f32_16x16x32_bf16 v[236:239], v[168:171], v[160:163], 0
  v_pk_mul_f16 v131, v74, v84 op_sel:[1,0] op_sel_hi:[1,1]
  v_mfma_f32_16x16x32_f16 v[192:195], v[172:175], v[120:123], 0
  ds_read_b128 v[168:171], v1 offset:11264
  v_pk_mul_f16 v140, v88, v97 op_sel:[0,0] op_sel_hi:[0,1]
  v_mfma_f32_16x16x32_f16 v[208:211], v[172:175], v[132:135], 0
  v_pk_mul_f16 v141, v88, v97 op_sel:[1,0] op_sel_hi:[1,1]
  v_mfma_f32_16x16x32_f16 v[224:227], v[172:175], v[144:147], 0
  s_waitcnt lgkmcnt(14)
  v_pk_mul_f16 v142, v88, v98 op_sel:[0,0] op_sel_hi:[0,1]
  v_mfma_f32_16x16x32_f16 v[240:243], v[172:175], v[156:159], 0
  s_nop 0
  v_pk_mul_f16 v143, v88, v98 op_sel:[1,0] op_sel_hi:[1,1]
  v_mfma_f32_16x16x32_f16 v[184:187], v[176:179], v[120:123], v[184:187]
  ds_read_b128 v[172:175], v1 offset:9216
  v_pk_mul_f16 v152, v102, v111 op_sel:[0,0] op_sel_hi:[0,1]
  v_mfma_f32_16x16x32_f16 v[200:203], v[176:179], v[132:135], v[200:203]
  v_pk_mul_f16 v153, v102, v111 op_sel:[1,0] op_sel_hi:[1,1]
  v_mfma_f32_16x16x32_f16 v[216:219], v[176:179], v[144:147], v[216:219]
  s_setprio 2
  s_waitcnt lgkmcnt(14)
  v_pk_mul_f16 v154, v102, v112 op_sel:[0,0] op_sel_hi:[0,1]
  v_mfma_f32_16x16x32_f16 v[232:235], v[176:179], v[156:159], v[232:235]
  s_nop 0
  s_waitcnt lgkmcnt(3)
  v_pk_mul_f16 v155, v102, v112 op_sel:[1,0] op_sel_hi:[1,1]
  v_mfma_f32_16x16x32_f16 v[188:191], v[180:183], v[120:123], v[188:191]
  ds_read_b128 v[176:179], v1 offset:10240
  v_pk_mul_f16 v124, v61, v68 op_sel:[0,0] op_sel_hi:[0,1]
  v_mfma_f32_16x16x32_f16 v[204:207], v[180:183], v[132:135], v[204:207]
  v_pk_mul_f16 v125, v61, v68 op_sel:[1,0] op_sel_hi:[1,1]
  v_mfma_f32_16x16x32_f16 v[220:223], v[180:183], v[144:147], v[220:223]
  v_pk_mul_f16 v126, v61, v69 op_sel:[0,0] op_sel_hi:[0,1]
  v_mfma_f32_16x16x32_f16 v[236:239], v[180:183], v[156:159], v[236:239]
  s_waitcnt lgkmcnt(3)
  v_pk_mul_f16 v127, v61, v69 op_sel:[1,0] op_sel_hi:[1,1]
  v_mfma_f32_16x16x32_f16 v[196:199], v[164:167], v[120:123], 0
  ds_read_b128 v[180:183], v1 offset:14336
  v_pk_mul_f16 v136, v75, v82 op_sel:[0,0] op_sel_hi:[0,1]
  v_mfma_f32_16x16x32_f16 v[212:215], v[164:167], v[132:135], 0
  v_pk_mul_f16 v120, v60, v71 op_sel:[0,0] op_sel_hi:[0,1]
  v_mfma_f32_16x16x32_f16 v[228:231], v[164:167], v[144:147], 0
  s_nop 0
  v_pk_mul_f16 v121, v60, v71 op_sel:[1,0] op_sel_hi:[1,1]
  v_mfma_f32_16x16x32_f16 v[244:247], v[164:167], v[156:159], 0
  s_waitcnt lgkmcnt(3)
  v_pk_mul_f16 v122, v60, v66 op_sel:[0,1] op_sel_hi:[0,0]
  v_mfma_f32_16x16x32_f16 v[192:195], v[168:171], v[116:119], v[192:195]
  ds_read_b128 v[164:167], v1 offset:12288
  v_pk_mul_f16 v123, v60, v72 op_sel:[0,0] op_sel_hi:[1,0]
  v_mfma_f32_16x16x32_f16 v[208:211], v[168:171], v[128:131], v[208:211]
  s_nop 0
  v_pk_mul_f16 v132, v74, v85 op_sel:[0,0] op_sel_hi:[0,1]
  v_mfma_f32_16x16x32_f16 v[224:227], v[168:171], v[140:143], v[224:227]
  v_pk_mul_f16 v133, v74, v85 op_sel:[1,0] op_sel_hi:[1,1]
  v_mfma_f32_16x16x32_f16 v[240:243], v[168:171], v[152:155], v[240:243]
  s_nop 0
  s_waitcnt lgkmcnt(3)
  v_pk_mul_f16 v134, v74, v80 op_sel:[0,1] op_sel_hi:[0,0]
  v_mfma_f32_16x16x32_f16 v[184:187], v[172:175], v[116:119], v[184:187]
  ds_read_b128 v[168:171], v1 offset:13312
  v_pk_mul_f16 v135, v74, v86 op_sel:[0,0] op_sel_hi:[1,0]
  v_mfma_f32_16x16x32_f16 v[200:203], v[172:175], v[128:131], v[200:203]
  v_pk_mul_f16 v144, v88, v99 op_sel:[0,0] op_sel_hi:[0,1]
  v_mfma_f32_16x16x32_f16 v[216:219], v[172:175], v[140:143], v[216:219]
  v_pk_mul_f16 v145, v88, v99 op_sel:[1,0] op_sel_hi:[1,1]
  v_mfma_f32_16x16x32_f16 v[232:235], v[172:175], v[152:155], v[232:235]
  s_nop 0
  s_waitcnt lgkmcnt(3)
  v_pk_mul_f16 v146, v88, v94 op_sel:[0,1] op_sel_hi:[0,0]
  v_mfma_f32_16x16x32_f16 v[188:191], v[176:179], v[116:119], v[188:191]
  ds_read_b128 v[172:175], v1 offset:0
  v_pk_mul_f16 v147, v88, v100 op_sel:[0,0] op_sel_hi:[1,0]
  v_mfma_f32_16x16x32_f16 v[204:207], v[176:179], v[128:131], v[204:207]
  v_pk_mul_f16 v156, v102, v113 op_sel:[0,0] op_sel_hi:[0,1]
  v_mfma_f32_16x16x32_f16 v[220:223], v[176:179], v[140:143], v[220:223]
  v_pk_mul_f16 v157, v102, v113 op_sel:[1,0] op_sel_hi:[1,1]
  v_mfma_f32_16x16x32_f16 v[236:239], v[176:179], v[152:155], v[236:239]
  s_waitcnt lgkmcnt(3)
  v_pk_mul_f16 v158, v102, v108 op_sel:[0,1] op_sel_hi:[0,0]
  v_mfma_f32_16x16x32_f16 v[192:195], v[180:183], v[120:123], v[192:195]
  ds_read_b128 v[176:179], v1 offset:17408
  v_pk_mul_f16 v159, v102, v114 op_sel:[0,0] op_sel_hi:[1,0]
  v_mfma_f32_16x16x32_f16 v[208:211], v[180:183], v[132:135], v[208:211]
  v_pk_mul_f16 v137, v75, v82 op_sel:[1,0] op_sel_hi:[1,1]
  v_mfma_f32_16x16x32_f16 v[224:227], v[180:183], v[144:147], v[224:227]
  s_nop 0
  v_pk_mul_f16 v138, v75, v83 op_sel:[0,0] op_sel_hi:[0,1]
  v_mfma_f32_16x16x32_f16 v[240:243], v[180:183], v[156:159], v[240:243]
  s_waitcnt lgkmcnt(3)
  v_pk_mul_f16 v139, v75, v83 op_sel:[1,0] op_sel_hi:[1,1]
  v_mfma_f32_16x16x32_f16 v[184:187], v[164:167], v[120:123], v[184:187]
  ds_read_b128 v[180:183], v1 offset:15360
  v_pk_mul_f16 v148, v89, v96 op_sel:[0,0] op_sel_hi:[0,1]
  v_mfma_f32_16x16x32_f16 v[200:203], v[164:167], v[132:135], v[200:203]
  s_nop 0
  v_pk_mul_f16 v149, v89, v96 op_sel:[1,0] op_sel_hi:[1,1]
  v_mfma_f32_16x16x32_f16 v[216:219], v[164:167], v[144:147], v[216:219]
  v_pk_mul_f16 v150, v89, v97 op_sel:[0,0] op_sel_hi:[0,1]
  v_mfma_f32_16x16x32_f16 v[232:235], v[164:167], v[156:159], v[232:235]
  s_nop 0
  s_waitcnt lgkmcnt(3)
  v_pk_mul_f16 v151, v89, v97 op_sel:[1,0] op_sel_hi:[1,1]
  v_mfma_f32_16x16x32_f16 v[188:191], v[168:171], v[120:123], v[188:191]
  ds_read_b128 v[164:167], v1 offset:16384
  v_pk_mul_f16 v160, v103, v110 op_sel:[0,0] op_sel_hi:[0,1]
  v_mfma_f32_16x16x32_f16 v[204:207], v[168:171], v[132:135], v[204:207]
  v_pk_mul_f16 v161, v103, v110 op_sel:[1,0] op_sel_hi:[1,1]
  v_mfma_f32_16x16x32_f16 v[220:223], v[168:171], v[144:147], v[220:223]
  v_pk_mul_f16 v162, v103, v111 op_sel:[0,0] op_sel_hi:[0,1]
  v_mfma_f32_16x16x32_f16 v[236:239], v[168:171], v[156:159], v[236:239]
  s_nop 0
  s_waitcnt lgkmcnt(3)
  v_pk_mul_f16 v163, v103, v111 op_sel:[1,0] op_sel_hi:[1,1]
  v_smfmac_f32_16x16x64_f16 v[196:199], v[172:175], v[116:123], v9
  ds_read_b128 v[168:171], v1 offset:20480
  v_smfmac_f32_16x16x64_f16 v[212:215], v[172:175], v[128:135], v9
  v_pk_mul_f16 v120, v61, v70 op_sel:[0,0] op_sel_hi:[0,1]
  v_smfmac_f32_16x16x64_f16 v[228:231], v[172:175], v[140:147], v9
  v_pk_mul_f16 v121, v61, v70 op_sel:[1,0] op_sel_hi:[1,1]
  v_smfmac_f32_16x16x64_f16 v[244:247], v[172:175], v[152:159], v9
  s_nop 0
  s_waitcnt lgkmcnt(3)
  v_pk_mul_f16 v122, v61, v71 op_sel:[0,0] op_sel_hi:[0,1]
  v_mfma_f32_16x16x32_f16 v[192:195], v[176:179], v[124:127], v[192:195]
  ds_read_b128 v[172:175], v1 offset:18432
  v_pk_mul_f16 v123, v61, v71 op_sel:[1,0] op_sel_hi:[1,1]
  v_mfma_f32_16x16x32_f16 v[208:211], v[176:179], v[136:139], v[208:211]
  v_pk_mul_f16 v132, v75, v84 op_sel:[0,0] op_sel_hi:[0,1]
  v_mfma_f32_16x16x32_f16 v[224:227], v[176:179], v[148:151], v[224:227]
  v_pk_mul_f16 v133, v75, v84 op_sel:[1,0] op_sel_hi:[1,1]
  v_mfma_f32_16x16x32_f16 v[240:243], v[176:179], v[160:163], v[240:243]
  s_waitcnt lgkmcnt(3)
  v_pk_mul_f16 v134, v75, v85 op_sel:[0,0] op_sel_hi:[0,1]
  v_mfma_f32_16x16x32_f16 v[184:187], v[180:183], v[124:127], v[184:187]
  ds_read_b128 v[176:179], v1 offset:19456
  v_pk_mul_f16 v135, v75, v85 op_sel:[1,0] op_sel_hi:[1,1]
  v_mfma_f32_16x16x32_f16 v[200:203], v[180:183], v[136:139], v[200:203]
  s_nop 0
  v_pk_mul_f16 v144, v89, v98 op_sel:[0,0] op_sel_hi:[0,1]
  v_mfma_f32_16x16x32_f16 v[216:219], v[180:183], v[148:151], v[216:219]
  v_pk_mul_f16 v145, v89, v98 op_sel:[1,0] op_sel_hi:[1,1]
  v_mfma_f32_16x16x32_f16 v[232:235], v[180:183], v[160:163], v[232:235]
  s_nop 0
  s_waitcnt lgkmcnt(3)
  v_pk_mul_f16 v146, v89, v99 op_sel:[0,0] op_sel_hi:[0,1]
  v_mfma_f32_16x16x32_f16 v[188:191], v[164:167], v[124:127], v[188:191]
  ds_read_b128 v[180:183], v1 offset:1024
  v_pk_mul_f16 v147, v89, v99 op_sel:[1,0] op_sel_hi:[1,1]
  v_mfma_f32_16x16x32_f16 v[204:207], v[164:167], v[136:139], v[204:207]
  s_waitcnt vmcnt(4)
  ds_read_u16_d16_hi v32, v10 offset:0
  v_pk_mul_f16 v156, v103, v112 op_sel:[0,0] op_sel_hi:[0,1]
  v_mfma_f32_16x16x32_f16 v[220:223], v[164:167], v[148:151], v[220:223]
  ds_read_u16_d16_hi v33, v10 offset:2
  v_pk_mul_f16 v157, v103, v112 op_sel:[1,0] op_sel_hi:[1,1]
  v_mfma_f32_16x16x32_f16 v[236:239], v[164:167], v[160:163], v[236:239]
  s_waitcnt lgkmcnt(5)
  v_pk_mul_f16 v158, v103, v113 op_sel:[0,0] op_sel_hi:[0,1]
  v_mfma_f32_16x16x32_f16 v[192:195], v[168:171], v[120:123], v[192:195]
  ds_read_b128 v[164:167], v1 offset:23552
  v_pk_mul_f16 v159, v103, v113 op_sel:[1,0] op_sel_hi:[1,1]
  v_mfma_f32_16x16x32_f16 v[208:211], v[168:171], v[132:135], v[208:211]
  ds_read_u16_d16_hi v34, v10 offset:2112
  v_pk_mul_f16 v116, v61, v67 op_sel:[0,1] op_sel_hi:[0,0]
  v_mfma_f32_16x16x32_f16 v[224:227], v[168:171], v[144:147], v[224:227]
  ds_read_u16_d16_hi v35, v10 offset:2114
  v_pk_mul_f16 v117, v61, v72 op_sel:[0,0] op_sel_hi:[1,0]
  v_mfma_f32_16x16x32_f16 v[240:243], v[168:171], v[156:159], v[240:243]
  s_nop 0
  s_waitcnt lgkmcnt(7)
  v_pk_mul_f16 v118, v62, v69 op_sel:[0,0] op_sel_hi:[0,1]
  v_mfma_f32_16x16x32_f16 v[184:187], v[172:175], v[120:123], v[184:187]
  ds_read_b128 v[168:171], v1 offset:21504
  v_pk_mul_f16 v119, v62, v69 op_sel:[1,0] op_sel_hi:[1,1]
  v_mfma_f32_16x16x32_f16 v[200:203], v[172:175], v[132:135], v[200:203]
  ds_read_b64_tr_b16 v[60:61], v27 offset:0
  v_pk_mul_f16 v128, v75, v81 op_sel:[0,1] op_sel_hi:[0,0]
  v_mfma_f32_16x16x32_f16 v[216:219], v[172:175], v[144:147], v[216:219]
  ds_read_u16_d16_hi v36, v10 offset:128
  v_pk_mul_f16 v129, v75, v86 op_sel:[0,0] op_sel_hi:[1,0]
  v_mfma_f32_16x16x32_f16 v[232:235], v[172:175], v[156:159], v[232:235]
  s_waitcnt lgkmcnt(9)
  v_pk_mul_f16 v130, v76, v83 op_sel:[0,0] op_sel_hi:[0,1]
  v_pk_mul_f16 v131, v76, v83 op_sel:[1,0] op_sel_hi:[1,1]
  v_mfma_f32_16x16x32_f16 v[188:191], v[176:179], v[120:123], v[188:191]
  ds_read_b128 v[172:175], v1 offset:22528
  v_pk_mul_f16 v140, v89, v95 op_sel:[0,1] op_sel_hi:[0,0]
  v_mfma_f32_16x16x32_f16 v[204:207], v[176:179], v[132:135], v[204:207]
  ds_read_b64_tr_b16 v[74:75], v27 offset:32
  v_pk_mul_f16 v141, v89, v100 op_sel:[0,0] op_sel_hi:[1,0]
  v_mfma_f32_16x16x32_f16 v[220:223], v[176:179], v[144:147], v[220:223]
  ds_read_b64_tr_b16 v[88:89], v27 offset:64
  v_pk_mul_f16 v142, v90, v97 op_sel:[0,0] op_sel_hi:[0,1]
  v_mfma_f32_16x16x32_f16 v[236:239], v[176:179], v[156:159], v[236:239]
  s_waitcnt lgkmcnt(11)
  v_pk_mul_f16 v143, v90, v97 op_sel:[1,0] op_sel_hi:[1,1]
  v_pk_mul_f16 v152, v103, v109 op_sel:[0,1] op_sel_hi:[0,0]
  v_smfmac_f32_16x16x64_f16 v[196:199], v[180:183], v[120:127], v9
  ds_read_b128 v[176:179], v1 offset:26624
  v_pk_mul_f16 v153, v103, v114 op_sel:[0,0] op_sel_hi:[1,0]
  v_smfmac_f32_16x16x64_f16 v[212:215], v[180:183], v[132:139], v9
  ds_read_b64_tr_b16 v[102:103], v27 offset:96
  v_pk_mul_f16 v154, v104, v111 op_sel:[0,0] op_sel_hi:[0,1]
  v_smfmac_f32_16x16x64_f16 v[228:231], v[180:183], v[144:151], v9
  ds_read_u16_d16_hi v37, v10 offset:130
  v_pk_mul_f16 v155, v104, v111 op_sel:[1,0] op_sel_hi:[1,1]
  v_smfmac_f32_16x16x64_f16 v[244:247], v[180:183], v[156:163], v9
  s_waitcnt lgkmcnt(11)
  v_pk_mul_f16 v120, v62, v70 op_sel:[0,0] op_sel_hi:[0,1]
  v_mfma_f32_16x16x32_f16 v[192:195], v[164:167], v[116:119], v[192:195]
  ds_read_b128 v[180:183], v1 offset:24576
  v_pk_mul_f16 v121, v62, v70 op_sel:[1,0] op_sel_hi:[1,1]
  v_mfma_f32_16x16x32_f16 v[208:211], v[164:167], v[128:131], v[208:211]
  ds_read_u16_d16_hi v38, v10 offset:2240
  v_pk_mul_f16 v122, v62, v71 op_sel:[0,0] op_sel_hi:[0,1]
  v_mfma_f32_16x16x32_f16 v[224:227], v[164:167], v[140:143], v[224:227]
  ds_read_u16_d16_hi v39, v10 offset:2242
  v_pk_mul_f16 v123, v62, v71 op_sel:[1,0] op_sel_hi:[1,1]
  v_mfma_f32_16x16x32_f16 v[240:243], v[164:167], v[152:155], v[240:243]
  s_waitcnt lgkmcnt(11)
  v_pk_mul_f16 v132, v76, v84 op_sel:[0,0] op_sel_hi:[0,1]
  v_max3_f32 v58, |v32|, |v33|, 0
  v_mfma_f32_16x16x32_f16 v[184:187], v[168:171], v[116:119], v[184:187]
  ds_read_b128 v[164:167], v1 offset:25600
  v_pk_mul_f16 v133, v76, v84 op_sel:[1,0] op_sel_hi:[1,1]
  v_mfma_f32_16x16x32_f16 v[200:203], v[168:171], v[128:131], v[200:203]
  ds_read_u16_d16_hi v40, v10 offset:256
  v_pk_mul_f16 v134, v76, v85 op_sel:[0,0] op_sel_hi:[0,1]
  v_mfma_f32_16x16x32_f16 v[216:219], v[168:171], v[140:143], v[216:219]
  ds_read_u16_d16_hi v41, v10 offset:258
  v_pk_mul_f16 v135, v76, v85 op_sel:[1,0] op_sel_hi:[1,1]
  v_mfma_f32_16x16x32_f16 v[232:235], v[168:171], v[152:155], v[232:235]
  s_waitcnt lgkmcnt(11)
  v_pk_mul_f16 v144, v90, v98 op_sel:[0,0] op_sel_hi:[0,1]
  v_max3_f32 v58, |v34|, |v35|, v58
  v_mfma_f32_16x16x32_f16 v[188:191], v[172:175], v[116:119], v[188:191]
  ds_read_b128 v[168:171], v1 offset:2048
  v_pk_mul_f16 v145, v90, v98 op_sel:[1,0] op_sel_hi:[1,1]
  v_mfma_f32_16x16x32_f16 v[204:207], v[172:175], v[128:131], v[204:207]
  ds_read_u16_d16_hi v42, v10 offset:2368
  v_pk_mul_f16 v146, v90, v99 op_sel:[0,0] op_sel_hi:[0,1]
  v_mfma_f32_16x16x32_f16 v[220:223], v[172:175], v[140:143], v[220:223]
  ds_read_u16_d16_hi v43, v10 offset:2370
  v_pk_mul_f16 v147, v90, v99 op_sel:[1,0] op_sel_hi:[1,1]
  v_mfma_f32_16x16x32_f16 v[236:239], v[172:175], v[152:155], v[236:239]
  s_waitcnt lgkmcnt(11)
  v_pk_mul_f16 v156, v104, v112 op_sel:[0,0] op_sel_hi:[0,1]
  v_mfma_f32_16x16x32_f16 v[192:195], v[176:179], v[120:123], v[192:195]
  ds_read_b128 v[172:175], v1 offset:29696
  v_pk_mul_f16 v157, v104, v112 op_sel:[1,0] op_sel_hi:[1,1]
  v_mfma_f32_16x16x32_f16 v[208:211], v[176:179], v[132:135], v[208:211]
  ds_read_u16_d16_hi v44, v10 offset:384
  v_pk_mul_f16 v158, v104, v113 op_sel:[0,0] op_sel_hi:[0,1]
  v_mfma_f32_16x16x32_f16 v[224:227], v[176:179], v[144:147], v[224:227]
  ds_read_u16_d16_hi v45, v10 offset:386
  v_pk_mul_f16 v159, v104, v113 op_sel:[1,0] op_sel_hi:[1,1]
  s_nop 1
  v_mfma_f32_16x16x32_f16 v[240:243], v[176:179], v[156:159], v[240:243]
  s_waitcnt lgkmcnt(11)
  v_pk_mul_f16 v124, v62, v68 op_sel:[0,1] op_sel_hi:[0,0]
  v_mfma_f32_16x16x32_f16 v[184:187], v[180:183], v[120:123], v[184:187]
  ds_read_b128 v[176:179], v1 offset:27648
  v_pk_mul_f16 v125, v62, v72 op_sel:[0,0] op_sel_hi:[1,0]
  v_mfma_f32_16x16x32_f16 v[200:203], v[180:183], v[132:135], v[200:203]
  ds_read_u16_d16_hi v46, v10 offset:2496
  v_pk_mul_f16 v126, v63, v70 op_sel:[0,0] op_sel_hi:[0,1]
  v_mfma_f32_16x16x32_f16 v[216:219], v[180:183], v[144:147], v[216:219]
  ds_read_u16_d16_hi v47, v10 offset:2498
  v_pk_mul_f16 v127, v63, v70 op_sel:[1,0] op_sel_hi:[1,1]
  v_mfma_f32_16x16x32_f16 v[232:235], v[180:183], v[156:159], v[232:235]
  s_waitcnt lgkmcnt(11)
  v_pk_mul_f16 v136, v76, v82 op_sel:[0,1] op_sel_hi:[0,0]
  v_pk_mul_f16 v137, v76, v86 op_sel:[0,0] op_sel_hi:[1,0]
  v_mfma_f32_16x16x32_f16 v[188:191], v[164:167], v[120:123], v[188:191]
  ds_read_b128 v[180:183], v1 offset:28672
  v_pk_mul_f16 v138, v77, v84 op_sel:[0,0] op_sel_hi:[0,1]
  v_mfma_f32_16x16x32_f16 v[204:207], v[164:167], v[132:135], v[204:207]
  ds_read_u16_d16_hi v48, v10 offset:512
  v_pk_mul_f16 v139, v77, v84 op_sel:[1,0] op_sel_hi:[1,1]
  v_mfma_f32_16x16x32_f16 v[220:223], v[164:167], v[144:147], v[220:223]
  ds_read_u16_d16_hi v49, v10 offset:514
  v_pk_mul_f16 v148, v90, v96 op_sel:[0,1] op_sel_hi:[0,0]
  v_mfma_f32_16x16x32_f16 v[236:239], v[164:167], v[156:159], v[236:239]
  s_waitcnt lgkmcnt(11)
  v_pk_mul_f16 v149, v90, v100 op_sel:[0,0] op_sel_hi:[1,0]
  v_pk_mul_f16 v150, v91, v98 op_sel:[0,0] op_sel_hi:[0,1]
  v_smfmac_f32_16x16x64_f16 v[196:199], v[168:171], v[116:123], v9
  ds_read_b128 v[164:167], v1 offset:32768
  v_pk_mul_f16 v151, v91, v98 op_sel:[1,0] op_sel_hi:[1,1]
  v_smfmac_f32_16x16x64_f16 v[212:215], v[168:171], v[128:135], v9
  ds_read_u16_d16_hi v50, v10 offset:2624
  v_pk_mul_f16 v160, v104, v110 op_sel:[0,1] op_sel_hi:[0,0]
  v_smfmac_f32_16x16x64_f16 v[228:231], v[168:171], v[140:147], v9
  ds_read_u16_d16_hi v51, v10 offset:2626
  v_pk_mul_f16 v161, v104, v114 op_sel:[0,0] op_sel_hi:[1,0]
  v_smfmac_f32_16x16x64_f16 v[244:247], v[168:171], v[152:159], v9
  s_nop 0
  s_waitcnt lgkmcnt(11)
  v_pk_mul_f16 v162, v105, v112 op_sel:[0,0] op_sel_hi:[0,1]
  v_mfma_f32_16x16x32_f16 v[192:195], v[172:175], v[124:127], v[192:195]
  ds_read_b128 v[168:171], v1 offset:30720
  v_pk_mul_f16 v163, v105, v112 op_sel:[1,0] op_sel_hi:[1,1]
  v_mfma_f32_16x16x32_f16 v[208:211], v[172:175], v[136:139], v[208:211]
  ds_read_u16_d16_hi v52, v10 offset:640
  v_pk_mul_f16 v120, v63, v71 op_sel:[0,0] op_sel_hi:[0,1]
  v_mfma_f32_16x16x32_f16 v[224:227], v[172:175], v[148:151], v[224:227]
  ds_read_u16_d16_hi v53, v10 offset:642
  v_pk_mul_f16 v121, v63, v71 op_sel:[1,0] op_sel_hi:[1,1]
  v_mfma_f32_16x16x32_f16 v[240:243], v[172:175], v[160:163], v[240:243]
  s_waitcnt lgkmcnt(11)
  v_pk_mul_f16 v122, v63, v69 op_sel:[0,1] op_sel_hi:[1,1]
  v_pk_mul_f16 v123, v63, v72 op_sel:[0,0] op_sel_hi:[1,0]
  v_mfma_f32_16x16x32_f16 v[184:187], v[176:179], v[124:127], v[184:187]
  ds_read_b128 v[172:175], v1 offset:31744
  v_pk_mul_f16 v132, v77, v85 op_sel:[0,0] op_sel_hi:[0,1]
  v_mfma_f32_16x16x32_f16 v[200:203], v[176:179], v[136:139], v[200:203]
  ds_read_u16_d16_hi v54, v10 offset:2752
  v_pk_mul_f16 v133, v77, v85 op_sel:[1,0] op_sel_hi:[1,1]
  v_mfma_f32_16x16x32_f16 v[216:219], v[176:179], v[148:151], v[216:219]
  ds_read_u16_d16_hi v55, v10 offset:2754
  v_pk_mul_f16 v134, v77, v83 op_sel:[0,1] op_sel_hi:[1,1]
  v_mfma_f32_16x16x32_f16 v[232:235], v[176:179], v[160:163], v[232:235]
  s_waitcnt lgkmcnt(11)
  v_pk_mul_f16 v135, v77, v86 op_sel:[0,0] op_sel_hi:[1,0]
  v_pk_mul_f16 v144, v91, v99 op_sel:[0,0] op_sel_hi:[0,1]
  v_mfma_f32_16x16x32_f16 v[188:191], v[180:183], v[124:127], v[188:191]
  ds_read_b128 v[176:179], v1 offset:3072
  v_pk_mul_f16 v145, v91, v99 op_sel:[1,0] op_sel_hi:[1,1]
  v_mfma_f32_16x16x32_f16 v[204:207], v[180:183], v[136:139], v[204:207]
  ds_read_u16_d16_hi v56, v10 offset:768
  v_pk_mul_f16 v146, v91, v97 op_sel:[0,1] op_sel_hi:[1,1]
  v_mfma_f32_16x16x32_f16 v[220:223], v[180:183], v[148:151], v[220:223]
  ds_read_u16_d16_hi v57, v10 offset:770
  v_pk_mul_f16 v147, v91, v100 op_sel:[0,0] op_sel_hi:[1,0]
  v_mfma_f32_16x16x32_f16 v[236:239], v[180:183], v[160:163], v[236:239]
  s_waitcnt lgkmcnt(11)
  v_pk_mul_f16 v156, v105, v113 op_sel:[0,0] op_sel_hi:[0,1]
  v_max3_f32 v58, |v36|, |v37|, v58
  v_mfma_f32_16x16x32_f16 v[192:195], v[164:167], v[120:123], v[192:195]
  ds_read_b128 v[180:183], v1 offset:35840
  v_pk_mul_f16 v157, v105, v113 op_sel:[1,0] op_sel_hi:[1,1]
  v_mfma_f32_16x16x32_f16 v[208:211], v[164:167], v[132:135], v[208:211]
  v_pk_mul_f16 v158, v105, v111 op_sel:[0,1] op_sel_hi:[1,1]
  v_max3_f32 v58, |v38|, |v39|, v58
  v_mfma_f32_16x16x32_f16 v[224:227], v[164:167], v[144:147], v[224:227]
  v_pk_mul_f16 v159, v105, v114 op_sel:[0,0] op_sel_hi:[1,0]
  v_max3_f32 v58, |v40|, |v41|, v58
  s_nop 0
  v_mfma_f32_16x16x32_f16 v[240:243], v[164:167], v[156:159], v[240:243]
  s_nop 0
  s_waitcnt lgkmcnt(9)
  v_pk_mul_f16 v116, v64, v71 op_sel:[0,0] op_sel_hi:[0,1]
  v_mfma_f32_16x16x32_f16 v[184:187], v[168:171], v[120:123], v[184:187]
  ds_read_b128 v[164:167], v1 offset:33792
  v_pk_mul_f16 v117, v64, v71 op_sel:[1,0] op_sel_hi:[1,1]
  v_mfma_f32_16x16x32_f16 v[200:203], v[168:171], v[132:135], v[200:203]
  v_pk_mul_f16 v118, v64, v70 op_sel:[0,1] op_sel_hi:[1,1]
  v_max3_f32 v58, |v42|, |v43|, v58
  v_mfma_f32_16x16x32_f16 v[216:219], v[168:171], v[144:147], v[216:219]
  v_pk_mul_f16 v119, v64, v72 op_sel:[0,0] op_sel_hi:[1,0]
  v_pk_mul_f16 v128, v78, v85 op_sel:[0,0] op_sel_hi:[0,1]
  v_mfma_f32_16x16x32_f16 v[232:235], v[168:171], v[156:159], v[232:235]
  s_waitcnt lgkmcnt(7)
  v_pk_mul_f16 v129, v78, v85 op_sel:[1,0] op_sel_hi:[1,1]
  v_pk_mul_f16 v130, v78, v84 op_sel:[0,1] op_sel_hi:[1,1]
  v_mfma_f32_16x16x32_f16 v[188:191], v[172:175], v[120:123], v[188:191]
  ds_read_b128 v[168:171], v1 offset:34816
  v_pk_mul_f16 v131, v78, v86 op_sel:[0,0] op_sel_hi:[1,0]
  v_mfma_f32_16x16x32_f16 v[204:207], v[172:175], v[132:135], v[204:207]
  v_pk_mul_f16 v140, v92, v99 op_sel:[0,0] op_sel_hi:[0,1]
  v_pk_mul_f16 v141, v92, v99 op_sel:[1,0] op_sel_hi:[1,1]
  v_mfma_f32_16x16x32_f16 v[220:223], v[172:175], v[144:147], v[220:223]
  v_pk_mul_f16 v142, v92, v98 op_sel:[0,1] op_sel_hi:[1,1]
  v_pk_mul_f16 v143, v92, v100 op_sel:[0,0] op_sel_hi:[1,0]
  v_mfma_f32_16x16x32_f16 v[236:239], v[172:175], v[156:159], v[236:239]
  s_waitcnt lgkmcnt(5)
  v_pk_mul_f16 v152, v106, v113 op_sel:[0,0] op_sel_hi:[0,1]
  v_smfmac_f32_16x16x64_f16 v[196:199], v[176:179], v[120:127], v9
  ds_read_b128 v[172:175], v1 offset:38912
  v_pk_mul_f16 v153, v106, v113 op_sel:[1,0] op_sel_hi:[1,1]
  v_smfmac_f32_16x16x64_f16 v[212:215], v[176:179], v[132:139], v9
  v_pk_mul_f16 v154, v106, v112 op_sel:[0,1] op_sel_hi:[1,1]
  v_smfmac_f32_16x16x64_f16 v[228:231], v[176:179], v[144:151], v9
  v_pk_mul_f16 v155, v106, v114 op_sel:[0,0] op_sel_hi:[1,0]
  v_smfmac_f32_16x16x64_f16 v[244:247], v[176:179], v[156:163], v9
  s_waitcnt lgkmcnt(3)
  v_pk_mul_f16 v120, v65, v71 op_sel:[0,1] op_sel_hi:[1,1]
  v_mfma_f32_16x16x32_f16 v[192:195], v[180:183], v[116:119], v[192:195]
  ds_read_b128 v[176:179], v1 offset:36864
  v_pk_mul_f16 v121, v65, v72 op_sel:[0,0] op_sel_hi:[1,0]
  v_mfma_f32_16x16x32_f16 v[208:211], v[180:183], v[128:131], v[208:211]
  s_nop 0
  v_pk_mul_f16 v122, v72, v72 op_sel:[0,0] op_sel_hi:[1,1]
  v_max3_f32 v58, |v44|, |v45|, v58
  v_mfma_f32_16x16x32_f16 v[224:227], v[180:183], v[140:143], v[224:227]
  v_pk_mul_f16 v123, v60, v61 op_sel:[0,0] op_sel_hi:[1,1]
  v_max3_f32 v58, |v46|, |v47|, v58
  v_mfma_f32_16x16x32_f16 v[240:243], v[180:183], v[152:155], v[240:243]
  s_nop 0
  s_waitcnt lgkmcnt(3)
  v_pk_mul_f16 v132, v79, v85 op_sel:[0,1] op_sel_hi:[1,1]
  v_mfma_f32_16x16x32_f16 v[184:187], v[164:167], v[116:119], v[184:187]
  ds_read_b128 v[180:183], v1 offset:37888
  v_pk_mul_f16 v133, v79, v86 op_sel:[0,0] op_sel_hi:[1,0]
  v_mfma_f32_16x16x32_f16 v[200:203], v[164:167], v[128:131], v[200:203]
  v_pk_mul_f16 v134, v86, v86 op_sel:[0,0] op_sel_hi:[1,1]
  v_max3_f32 v58, |v48|, |v49|, v58
  v_mfma_f32_16x16x32_f16 v[216:219], v[164:167], v[140:143], v[216:219]
  v_pk_mul_f16 v135, v74, v75 op_sel:[0,0] op_sel_hi:[1,1]
  v_max3_f32 v58, |v50|, |v51|, v58
  v_mfma_f32_16x16x32_f16 v[232:235], v[164:167], v[152:155], v[232:235]
  s_waitcnt lgkmcnt(3)
  v_pk_mul_f16 v144, v93, v99 op_sel:[0,1] op_sel_hi:[1,1]
  v_mfma_f32_16x16x32_f16 v[188:191], v[168:171], v[116:119], v[188:191]
  ds_read_b128 v[164:167], v1 offset:4096
  v_pk_mul_f16 v145, v93, v100 op_sel:[0,0] op_sel_hi:[1,0]
  v_mfma_f32_16x16x32_f16 v[204:207], v[168:171], v[128:131], v[204:207]
  s_nop 0
  v_pk_mul_f16 v146, v100, v100 op_sel:[0,0] op_sel_hi:[1,1]
  v_max3_f32 v58, |v52|, |v53|, v58
  v_mfma_f32_16x16x32_f16 v[220:223], v[168:171], v[140:143], v[220:223]
  v_pk_mul_f16 v147, v88, v89 op_sel:[0,0] op_sel_hi:[1,1]
  v_max3_f32 v58, |v54|, |v55|, v58
  v_mfma_f32_16x16x32_f16 v[236:239], v[168:171], v[152:155], v[236:239]
  s_waitcnt lgkmcnt(3)
  v_pk_mul_f16 v156, v107, v113 op_sel:[0,1] op_sel_hi:[1,1]
  v_mfma_f32_16x16x32_f16 v[192:195], v[172:175], v[120:123], v[192:195]
  s_nop 0
  v_pk_mul_f16 v157, v107, v114 op_sel:[0,0] op_sel_hi:[1,0]
  v_max3_f32 v58, |v56|, |v57|, v58
  v_mfma_f32_16x16x32_f16 v[208:211], v[172:175], v[132:135], v[208:211]
  v_pk_mul_f16 v158, v114, v114 op_sel:[0,0] op_sel_hi:[1,1]
  v_cvt_pk_f16_f32 v62, v32, v33
  v_mfma_f32_16x16x32_f16 v[224:227], v[172:175], v[144:147], v[224:227]
  s_nop 0
  v_pk_mul_f16 v159, v102, v103 op_sel:[0,0] op_sel_hi:[1,1]
  s_nop 1
  v_mfma_f32_16x16x32_f16 v[240:243], v[172:175], v[156:159], v[240:243]
  s_waitcnt lgkmcnt(2)
  v_cvt_pk_f16_f32 v76, v34, v35
  v_cvt_pk_f16_f32 v90, v36, v37
  v_mfma_f32_16x16x32_f16 v[184:187], v[176:179], v[120:123], v[184:187]
  ds_write_b32 v11, v62 offset:0
  v_mfma_f32_16x16x32_f16 v[200:203], v[176:179], v[132:135], v[200:203]
  ds_write_b32 v11, v76 offset:160
  v_mfma_f32_16x16x32_f16 v[216:219], v[176:179], v[144:147], v[216:219]
  ds_write_b32 v11, v90 offset:320
  v_mfma_f32_16x16x32_f16 v[232:235], v[176:179], v[156:159], v[232:235]
  s_waitcnt lgkmcnt(4)
  v_cvt_pk_f16_f32 v104, v38, v39
  v_cvt_pk_f16_f32 v63, v40, v41
  v_mfma_f32_16x16x32_f16 v[188:191], v[180:183], v[120:123], v[188:191]
  ds_write_b32 v11, v104 offset:480
  v_mfma_f32_16x16x32_f16 v[204:207], v[180:183], v[132:135], v[204:207]
  ds_write_b32 v11, v63 offset:640
  v_mfma_f32_16x16x32_f16 v[220:223], v[180:183], v[144:147], v[220:223]
  s_nop 0
  v_cvt_pk_f16_f32 v77, v42, v43
  v_cvt_pk_f16_f32 v91, v44, v45
  v_mfma_f32_16x16x32_f16 v[236:239], v[180:183], v[156:159], v[236:239]
  s_waitcnt lgkmcnt(5)
  v_cvt_pk_f16_f32 v105, v46, v47
  v_cvt_pk_f16_f32 v66, v48, v49
  v_smfmac_f32_16x16x64_f16 v[196:199], v[164:167], v[116:123], v9
  ds_write_b32 v11, v77 offset:800
  v_smfmac_f32_16x16x64_f16 v[212:215], v[164:167], v[128:135], v9
  ds_write_b32 v11, v91 offset:960
  v_smfmac_f32_16x16x64_f16 v[228:231], v[164:167], v[140:147], v9
  ds_write_b32 v11, v105 offset:1120
  v_smfmac_f32_16x16x64_f16 v[244:247], v[164:167], v[152:159], v9
  ds_write_b32 v11, v66 offset:1280
  s_setprio 0
  s_sub_u32 s72, s72, 1
  s_cmp_eq_u32 s72, 0
  s_cbranch_scc1 L_cin_done
  v_cvt_pk_f16_f32 v80, v50, v51
  v_cvt_pk_f16_f32 v94, v52, v53
  v_cvt_pk_f16_f32 v108, v54, v55
  v_cvt_pk_f16_f32 v67, v56, v57
  ds_write_b32 v11, v80 offset:1440
  ds_write_b32 v11, v94 offset:1600
  ds_write_b32 v11, v108 offset:1760
  ds_write_b32 v11, v67 offset:1920
  s_branch L_cin_loop
L_cslow:
  v_max_f32_dpp v58, v58, v58 row_shr:1 row_mask:0xf bank_mask:0xf
  s_nop 1
  v_max_f32_dpp v58, v58, v58 row_shr:2 row_mask:0xf bank_mask:0xf
  s_nop 1
  v_max_f32_dpp v58, v58, v58 row_shr:4 row_mask:0xf bank_mask:0xf
  s_nop 1
  v_max_f32_dpp v58, v58, v58 row_shr:8 row_mask:0xf bank_mask:0xf
  s_nop 1
  v_max_f32_dpp v58, v58, v58 row_bcast:15 row_mask:0xa bank_mask:0xf
  s_nop 1
  v_max_f32_dpp v58, v58, v58 row_bcast:31 row_mask:0xc bank_mask:0xf
  s_nop 0
  v_readlane_b32 s98, v58, 63
  s_mov_b32 s97, 0
  s_lshr_b32 s98, s98, 23
  s_min_u32 s98, s98, 182
  s_lshr_b32 s99, s1, 23
  s_sub_u32 s99, s99, 47
  s_lshr_b32 s99, s99, 1
  s_min_u32 s99, s99, 59
  s_sub_u32 s99, 131, s99
  s_max_u32 s98, s98, s99
  s_sub_u32 s99, 258, s98
  s_lshl_b32 s100, s99, 1
  s_sub_u32 s100, s100, 127
  s_sub_u32 s95, 254, s100
  s_lshl_b32 s95, s95, 23
  v_mov_b32 v60, s95
  v_mul_f32 v61, s0, v60
  v_mul_f32 v60, s1, v60
  v_readfirstlane_b32 s74, v61
  v_readfirstlane_b32 s75, v60
  s_lshl_b32 s99, s99, 23
  s_lshl_b32 s100, s100, 23
  v_mul_f32 v60, s99, v32
  v_mul_f32 v61, s99, v33
  v_mul_f32 v62, s100, v32
  v_mul_f32 v63, s100, v33
  v_cvt_pk_f16_f32 v80, v60, v61
  v_cvt_pk_bf16_f32 v64, v62, v63
  ds_write_b32 v11, v80 offset:0
  ds_write_b32 v10, v64 offset:0
  v_mul_f32 v60, s99, v34
  v_mul_f32 v61, s99, v35
  v_mul_f32 v62, s100, v34
  v_mul_f32 v63, s100, v35
  v_cvt_pk_f16_f32 v81, v60, v61
  v_cvt_pk_bf16_f32 v65, v62, v63
  ds_write_b32 v11, v81 offset:160
  ds_write_b32 v10, v65 offset:2112
  v_mul_f32 v60, s99, v36
  v_mul_f32 v61, s99, v37
  v_mul_f32 v62, s100, v36
  v_mul_f32_e64 v63, s100, v37
  v_cvt_pk_f16_f32 v82, v60, v61
  v_cvt_pk_bf16_f32 v66, v62, v63
  ds_write_b32 v11, v82 offset:320
  ds_write_b32 v10, v66 offset:128
  v_mul_f32 v60, s99, v38
  v_mul_f32 v61, s99, v39
  v_mul_f32 v62, s100, v38
  v_mul_f32 v63, s100, v39
  v_cvt_pk_f16_f32 v83, v60, v61
  v_cvt_pk_bf16_f32 v67, v62, v63
  ds_write_b32 v11, v83 offset:480
  ds_write_b32 v10, v67 offset:2240
  v_mul_f32 v60, s99, v40
  v_mul_f32 v61, s99, v41
  v_mul_f32 v62, s100, v40
  v_mul_f32 v63, s100, v41
  v_cvt_pk_f16_f32 v84, v60, v61
  v_cvt_pk_bf16_f32 v68, v62, v63
  ds_write_b32 v11, v84 offset:640
  ds_write_b32 v10, v68 offset:256
  v_mul_f32 v60, s99, v42
  v_mul_f32 v61, s99, v43
  v_mul_f32 v62, s100, v42
  v_mul_f32 v63, s100, v43
  v_cvt_pk_f16_f32 v85, v60, v61
  v_cvt_pk_bf16_f32 v69, v62, v63
  ds_write_b32 v11, v85 offset:800
  ds_write_b32 v10, v69 offset:2368
  v_mul_f32 v60, s99, v44
  v_mul_f32 v61, s99, v45
  v_mul_f32 v62, s100, v44
  v_mul_f32 v63, s100, v45
  v_cvt_pk_f16_f32 v86, v60, v61
  v_cvt_pk_bf16_f32 v70, v62, v63
  ds_write_b32 v11, v86 offset:960
  ds_write_b32 v10, v70 offset:384
  v_mul_f32 v60, s99, v46
  v_mul_f32 v61, s99, v47
  v_mul_f32 v62, s100, v46
  v_mul_f32 v63, s100, v47
  v_cvt_pk_f16_f32 v87, v60, v61
  v_cvt_pk_bf16_f32 v71, v62, v63
  ds_write_b32 v11, v87 offset:1120
  ds_write_b32 v10, v71 offset:2496
  v_mul_f32 v60, s99, v48
  v_mul_f32 v61, s99, v49
  v_mul_f32 v62, s100, v48
  v_mul_f32 v63, s100, v49
  v_cvt_pk_f16_f32 v88, v60, v61
  v_cvt_pk_bf16_f32 v72, v62, v63
  ds_write_b32 v11, v88 offset:1280
  ds_write_b32 v10, v72 offset:512
  v_mul_f32 v60, s99, v50
  v_mul_f32 v61, s99, v51
  v_mul_f32 v62, s100, v50
  v_mul_f32 v63, s100, v51
  v_cvt_pk_f16_f32 v89, v60, v61
  v_cvt_pk_bf16_f32 v73, v62, v63
  ds_write_b32 v11, v89 offset:1440
  ds_write_b32 v10, v73 offset:2624
  v_mul_f32 v60, s99, v52
  v_mul_f32 v61, s99, v53
  v_mul_f32 v62, s100, v52
  v_mul_f32 v63, s100, v53
  v_cvt_pk_f16_f32 v90, v60, v61
  v_cvt_pk_bf16_f32 v74, v62, v63
  ds_write_b32 v11, v90 offset:1600
  ds_write_b32 v10, v74 offset:640
  v_mul_f32 v60, s99, v54
  v_mul_f32 v61, s99, v55
  v_mul_f32 v62, s100, v54
  v_mul_f32 v63, s100, v55
  v_cvt_pk_f16_f32 v91, v60, v61
  v_cvt_pk_bf16_f32 v75, v62, v63
  ds_write_b32 v11, v91 offset:1760
  ds_write_b32 v10, v75 offset:2752
  v_mul_f32 v60, s99, v56
  v_mul_f32 v61, s99, v57
  v_mul_f32 v62, s100, v56
  v_mul_f32 v63, s100, v57
  v_cvt_pk_f16_f32 v92, v60, v61
  v_cvt_pk_bf16_f32 v76, v62, v63
  ds_write_b32 v11, v92 offset:1920
  ds_write_b32 v10, v76 offset:768
  v_mov_b32 v60, s100
  v_cvt_pk_bf16_f32 v60, v60, v60
  s_mov_b32 exec_hi, 0
  ds_write_b32 v10, v60 offset:2880
  s_mov_b32 exec_hi, -1
  s_waitcnt lgkmcnt(0)
  s_branch L_cconv
L_sdown:
  v_lshlrev_b32 v108, 16, v112
  v_and_b32 v109, 0xffff0000, v112
  v_mul_f32 v108, v108, v250
  v_mul_f32 v109, v109, v250
  v_cvt_pk_bf16_f32 v112, v108, v109
  v_lshlrev_b32 v108, 16, v113
  v_and_b32 v109, 0xffff0000, v113
  v_mul_f32 v108, v108, v250
  v_mul_f32 v109, v109, v250
  v_cvt_pk_bf16_f32 v113, v108, v109
  v_lshlrev_b32 v108, 16, v114
  v_and_b32 v109, 0xffff0000, v114
  v_mul_f32 v108, v108, v250
  v_mul_f32 v109, v109, v250
  v_cvt_pk_bf16_f32 v114, v108, v109
  v_lshlrev_b32_e64 v108, 16, v115
  v_and_b32 v109, 0xffff0000, v115
  v_mul_f32 v108, v108, v250
  v_mul_f32 v109, v109, v250
  v_cvt_pk_bf16_f32 v115, v108, v109
  v_lshlrev_b32 v108, 16, v116
  v_and_b32 v109, 0xffff0000, v116
  v_mul_f32 v108, v108, v250
  v_mul_f32 v109, v109, v250
  v_cvt_pk_bf16_f32 v116, v108, v109
  v_lshlrev_b32 v108, 16, v117
  v_and_b32 v109, 0xffff0000, v117
  v_mul_f32 v108, v108, v250
  v_mul_f32 v109, v109, v250
  v_cvt_pk_bf16_f32 v117, v108, v109
  v_lshlrev_b32 v108, 16, v118
  v_and_b32 v109, 0xffff0000, v118
  v_mul_f32 v108, v108, v250
  v_mul_f32 v109, v109, v250
  v_cvt_pk_bf16_f32 v118, v108, v109
  v_lshlrev_b32 v108, 16, v119
  v_and_b32 v109, 0xffff0000, v119
  v_mul_f32 v108, v108, v250
  v_mul_f32 v109, v109, v250
  v_cvt_pk_bf16_f32 v119, v108, v109
  s_branch L_scaled
L_first:
  ds_read_b64_tr_b16 v[60:61], v20 offset:0
  ds_read_b64_tr_b16 v[74:75], v20 offset:32
  ds_read_b64_tr_b16 v[88:89], v20 offset:64
  ds_read_b64_tr_b16 v[102:103], v20 offset:96
  ds_read_b64_tr_b16 v[66:67], v23 offset:0
  ds_read_b64_tr_b16 v[80:81], v23 offset:32
  ds_read_b64_tr_b16 v[94:95], v23 offset:64
  ds_read_b64_tr_b16 v[108:109], v23 offset:96
  ds_read_b64_tr_b16 v[68:69], v24 offset:0
  ds_read_b64_tr_b16 v[82:83], v24 offset:32
  ds_read_b64_tr_b16 v[96:97], v24 offset:64
  ds_read_b64_tr_b16 v[110:111], v24 offset:96
  ds_read_b64_tr_b16 v[124:125], v4 offset:0
  ds_read_b64_tr_b16 v[126:127], v5 offset:0
  ds_read_b64_tr_b16 v[136:137], v4 offset:32
  ds_read_b64_tr_b16 v[138:139], v5 offset:32
  ds_read_b64_tr_b16 v[148:149], v4 offset:64
  ds_read_b64_tr_b16 v[150:151], v5 offset:64
  ds_read_b64_tr_b16 v[160:161], v4 offset:96
  ds_read_b64_tr_b16 v[162:163], v5 offset:96
  ds_read_b128 v[164:167], v1 offset:39936
  ds_read_b128 v[168:171], v1 offset:40960
  ds_read_b128 v[172:175], v1 offset:8192
  ds_read_b128 v[176:179], v1 offset:6144
  ds_read_b64_tr_b16 v[70:71], v25 offset:0
  ds_read_b64_tr_b16 v[84:85], v25 offset:32
  ds_read_b64_tr_b16 v[98:99], v25 offset:64
  ds_read_b64_tr_b16 v[112:113], v25 offset:96
  ds_read_b64_tr_b16 v[72:73], v26 offset:0
  s_waitcnt lgkmcnt(14)
  v_pk_mul_f16 v120, v60, v67 op_sel:[0,0] op_sel_hi:[0,1]
  v_pk_mul_f16 v121, v60, v67 op_sel:[1,0] op_sel_hi:[1,1]
  ds_read_b64_tr_b16 v[86:87], v26 offset:32
  v_pk_mul_f16 v122, v60, v68 op_sel:[0,0] op_sel_hi:[0,1]
  ds_read_b64_tr_b16 v[100:101], v26 offset:64
  v_pk_mul_f16 v123, v60, v68 op_sel:[1,0] op_sel_hi:[1,1]
  ds_read_b64_tr_b16 v[114:115], v26 offset:96
  v_pk_mul_f16 v132, v74, v81 op_sel:[0,0] op_sel_hi:[0,1]
  v_pk_mul_f16 v133, v74, v81 op_sel:[1,0] op_sel_hi:[1,1]
  ds_read_b64_tr_b16 v[62:63], v21 offset:0
  v_pk_mul_f16 v134, v74, v82 op_sel:[0,0] op_sel_hi:[0,1]
  ds_read_b64_tr_b16 v[76:77], v21 offset:32
  v_pk_mul_f16 v135, v74, v82 op_sel:[1,0] op_sel_hi:[1,1]
  ds_read_b64_tr_b16 v[90:91], v21 offset:64
  v_pk_mul_f16 v144, v88, v95 op_sel:[0,0] op_sel_hi:[0,1]
  v_pk_mul_f16 v145, v88, v95 op_sel:[1,0] op_sel_hi:[1,1]
  ds_read_b64_tr_b16 v[104:105], v21 offset:96
  v_pk_mul_f16 v146, v88, v96 op_sel:[0,0] op_sel_hi:[0,1]
  ds_read_b64_tr_b16 v[64:65], v22 offset:0
  v_pk_mul_f16 v147, v88, v96 op_sel:[1,0] op_sel_hi:[1,1]
  ds_read_b64_tr_b16 v[78:79], v22 offset:32
  v_pk_mul_f16 v156, v102, v109 op_sel:[0,0] op_sel_hi:[0,1]
  v_pk_mul_f16 v157, v102, v109 op_sel:[1,0] op_sel_hi:[1,1]
  ds_read_b64_tr_b16 v[92:93], v22 offset:64
  v_pk_mul_f16 v158, v102, v110 op_sel:[0,0] op_sel_hi:[0,1]
  ds_read_b64_tr_b16 v[106:107], v22 offset:96
  v_pk_mul_f16 v159, v102, v110 op_sel:[1,0] op_sel_hi:[1,1]
  s_branch L_novm
L_end:
  s_endpgm
.p2align 8
L_tables:
.long 0x0, 0x1800, 0x6c80, 0x81a0, 0x8, 0x1808, 0x6c88, 0x81a8
.long 0x10, 0x1810, 0x6c90, 0x81b0, 0x18, 0x1818, 0x6c98, 0x81b8
.long 0x40, 0x1d48, 0x71c8, 0x86e8, 0x48, 0x1d50, 0x71d0, 0x86f0
.long 0x50, 0x1d58, 0x71d8, 0x86f8, 0x58, 0x1d60, 0x71e0, 0x8700
.long 0x80, 0x2290, 0x7710, 0x8c30, 0x88, 0x2298, 0x7718, 0x8c38
.long 0x90, 0x22a0, 0x7720, 0x8c40, 0x98, 0x22a8, 0x7728, 0x8c48
.long 0xc0, 0x27d8, 0x7c58, 0x9178, 0xc8, 0x27e0, 0x7c60, 0x9180
.long 0xd0, 0x27e8, 0x7c68, 0x9188, 0xd8, 0x27f0, 0x7c70, 0x9190
.long 0x20, 0x1820, 0x6ca0, 0x81c0, 0x28, 0x1828, 0x6ca8, 0x81c8
.long 0x30, 0x1830, 0x6cb0, 0x81d0, 0x38, 0x1838, 0x6cb8, 0x81d8
.long 0x60, 0x1d68, 0x71e8, 0x8708, 0x68, 0x1d70, 0x71f0, 0x8710
.long 0x70, 0x1d78, 0x71f8, 0x8718, 0x78, 0x1d80, 0x7200, 0x8720
.long 0xa0, 0x22b0, 0x7730, 0x8c50, 0xa8, 0x22b8, 0x7738, 0x8c58
.long 0xb0, 0x22c0, 0x7740, 0x8c60, 0xb8, 0x22c8, 0x7748, 0x8c68
.long 0xe0, 0x27f8, 0x7c78, 0x9198, 0xe8, 0x2800, 0x7c80, 0x91a0
.long 0xf0, 0x2808, 0x7c88, 0x91a8, 0xf8, 0x2810, 0x7c90, 0x91b0
.long 0x200, 0x4240, 0x96c0, 0x9c08, 0x208, 0x4248, 0x96c8, 0x9c10
.long 0x210, 0x4250, 0x96d0, 0x9c18, 0x218, 0x4258, 0x96d8, 0x9c20
.long 0x240, 0x4788, 0x9c08, 0x9c08, 0x248, 0x4790, 0x9c10, 0x9c10
.long 0x250, 0x4798, 0x9c18, 0x9c18, 0x258, 0x47a0, 0x9c20, 0x9c20
.long 0x280, 0x4cd0, 0x9c08, 0x9c08, 0x288, 0x4cd8, 0x9c10, 0x9c10
.long 0x290, 0x4ce0, 0x9c18, 0x9c18, 0x298, 0x4ce8, 0x9c20, 0x9c20
.long 0x2c0, 0x5218, 0x9c08, 0x9c08, 0x2c8, 0x5220, 0x9c10, 0x9c10
.long 0x2d0, 0x5228, 0x9c18, 0x9c18, 0x2d8, 0x5230, 0x9c20, 0x9c20
.long 0x220, 0x4260, 0x96e0, 0x9c28, 0x228, 0x4268, 0x96e8, 0x9c30
.long 0x230, 0x4270, 0x96f0, 0x9c38, 0x238, 0x4278, 0x96f8, 0x9c40
.long 0x260, 0x47a8, 0x9c28, 0x9c28, 0x268, 0x47b0, 0x9c30, 0x9c30
.long 0x270, 0x47b8, 0x9c38, 0x9c38, 0x278, 0x47c0, 0x9c40, 0x9c40
.long 0x2a0, 0x4cf0, 0x9c28, 0x9c28, 0x2a8, 0x4cf8, 0x9c30, 0x9c30
.long 0x2b0, 0x4d00, 0x9c38, 0x9c38, 0x2b8, 0x4d08, 0x9c40, 0x9c40
.long 0x2e0, 0x5238, 0x9c28, 0x9c28, 0x2e8, 0x5240, 0x9c30, 0x9c30
.long 0x2f0, 0x5248, 0x9c38, 0x9c38, 0x2f8, 0x5250, 0x9c40, 0x9c40
.long 0xaae0, 0xa680, 0xa900, 0xaae0, 0xaae8, 0xa688, 0xa908, 0xaae8
.long 0xaaf0, 0xa690, 0xa910, 0xaaf0, 0xaaf8, 0xa698, 0xa918, 0xaaf8
.long 0xaa40, 0xa860, 0xa9a0, 0xaa40, 0xaa48, 0xa868, 0xa9a8, 0xaa48
.long 0xaa50, 0xa870, 0xa9b0, 0xaa50, 0xaa58, 0xa878, 0xa9b8, 0xaa58
.long 0xa400, 0xa7c0, 0xa540, 0xa400, 0xa408, 0xa7c8, 0xa548, 0xa408
.long 0xa410, 0xa7d0, 0xa550, 0xa410, 0xa418, 0xa7d8, 0xa558, 0xa418
.long 0xa4a0, 0xa720, 0xa5e0, 0xa4a0, 0xa4a8, 0xa728, 0xa5e8, 0xa4a8
.long 0xa4b0, 0xa730, 0xa5f0, 0xa4b0, 0xa4b8, 0xa738, 0xa5f8, 0xa4b8
.long 0xb260, 0xb4e0, 0xb6c0, 0xb260, 0xb268, 0xb4e8, 0xb6c8, 0xb268
.long 0xb270, 0xb4f0, 0xb6d0, 0xb270, 0xb278, 0xb4f8, 0xb6d8, 0xb278
.long 0xb1c0, 0xb300, 0xb760, 0xb1c0, 0xb1c8, 0xb308, 0xb768, 0xb1c8
.long 0xb1d0, 0xb310, 0xb770, 0xb1d0, 0xb1d8, 0xb318, 0xb778, 0xb1d8
.long 0xb580, 0xb440, 0xb080, 0xb580, 0xb588, 0xb448, 0xb088, 0xb588
.long 0xb590, 0xb450, 0xb090, 0xb590, 0xb598, 0xb458, 0xb098, 0xb598
.long 0xb620, 0xb3a0, 0xb120, 0xb620, 0xb628, 0xb3a8, 0xb128, 0xb628
.long 0xb630, 0xb3b0, 0xb130, 0xb630, 0xb638, 0xb3b8, 0xb138, 0xb638
.long 0xa900, 0xa400, 0xaae0, 0xb620, 0xa908, 0xa408, 0xaae8, 0xb628
.long 0xa910, 0xa410, 0xaaf0, 0xb630, 0xa918, 0xa418, 0xaaf8, 0xb638
.long 0xa9a0, 0xa4a0, 0xab80, 0xb800, 0xa9a8, 0xa4a8, 0xab88, 0xb808
.long 0xa9b0, 0xa4b0, 0xab90, 0xb810, 0xa9b8, 0xa4b8, 0xab98, 0xb818
.long 0xaa40, 0xa680, 0xa860, 0xb3a0, 0xaa48, 0xa688, 0xa868, 0xb3a8
.long 0xaa50, 0xa690, 0xa870, 0xb3b0, 0xaa58, 0xa698, 0xa878, 0xb3b8
.long 0xa720, 0xa540, 0xa7c0, 0xb1c0, 0xa728, 0xa548, 0xa7c8, 0xb1c8
.long 0xa730, 0xa550, 0xa7d0, 0xb1d0, 0xa738, 0xa558, 0xa7d8, 0xb1d8
.long 0xa5e0, 0xaae0, 0xa400, 0xb080, 0xa5e8, 0xaae8, 0xa408, 0xb088
.long 0xa5f0, 0xaaf0, 0xa410, 0xb090, 0xa5f8, 0xaaf8, 0xa418, 0xb098
.long 0xa7c0, 0xa540, 0xa720, 0xb760, 0xa7c8, 0xa548, 0xa728, 0xb768
.long 0xa7d0, 0xa550, 0xa730, 0xb770, 0xa7d8, 0xa558, 0xa738, 0xb778
.long 0xa860, 0xa680, 0xaa40, 0xb440, 0xa868, 0xa688, 0xaa48, 0xb448
.long 0xa870, 0xa690, 0xaa50, 0xb450, 0xa878, 0xa698, 0xaa58, 0xb458
.long 0xab80, 0xa4a0, 0xa9a0, 0xb4e0, 0xab88, 0xa4a8, 0xa9a8, 0xb4e8
.long 0xab90, 0xa4b0, 0xa9b0, 0xb4f0, 0xab98, 0xa4b8, 0xa9b8, 0xb4f8
.long 0xa680, 0xa900, 0xab80, 0xa4a0, 0xa688, 0xa908, 0xab88, 0xa4a8
.long 0xa690, 0xa910, 0xab90, 0xa4b0, 0xa698, 0xa918, 0xab98, 0xa4b8
.long 0xa860, 0xa9a0, 0xb1c0, 0xb440, 0xa868, 0xa9a8, 0xb1c8, 0xb448
.long 0xa870, 0xa9b0, 0xb1d0, 0xb450, 0xa878, 0xa9b8, 0xb1d8, 0xb458
.long 0xa7c0, 0xa540, 0xab80, 0xa4a0, 0xa7c8, 0xa548, 0xab88, 0xa4a8
.long 0xa7d0, 0xa550, 0xab90, 0xa4b0, 0xa7d8, 0xa558, 0xab98, 0xa4b8
.long 0xa720, 0xa5e0, 0xb1c0, 0xb440, 0xa728, 0xa5e8, 0xb1c8, 0xb448
.long 0xa730, 0xa5f0, 0xb1d0, 0xb450, 0xa738, 0xa5f8, 0xb1d8, 0xb458
.long 0xb4e0, 0xb6c0, 0xb800, 0xa860, 0xb4e8, 0xb6c8, 0xb808, 0xa868
.long 0xb4f0, 0xb6d0, 0xb810, 0xa870, 0xb4f8, 0xb6d8, 0xb818, 0xa878
.long 0xb300, 0xb760, 0xa540, 0xa900, 0xb308, 0xb768, 0xa548, 0xa908
.long 0xb310, 0xb770, 0xa550, 0xa910, 0xb318, 0xb778, 0xa558, 0xa918
.long 0xb440, 0xb080, 0xb800, 0xa860, 0xb448, 0xb088, 0xb808, 0xa868
.long 0xb450, 0xb090, 0xb810, 0xa870, 0xb458, 0xb098, 0xb818, 0xa878
.long 0xb3a0, 0xb120, 0xa540, 0xa900, 0xb3a8, 0xb128, 0xa548, 0xa908
.long 0xb3b0, 0xb130, 0xa550, 0xa910, 0xb3b8, 0xb138, 0xa558, 0xa918
.long 0xb120, 0xb580, 0xb080, 0xb300, 0xb128, 0xb588, 0xb088, 0xb308
.long 0xb130, 0xb590, 0xb090, 0xb310, 0xb138, 0xb598, 0xb098, 0xb318
.long 0xb6c0, 0xb4e0, 0xaa40, 0xb6c0, 0xb6c8, 0xb4e8, 0xaa48, 0xb6c8
.long 0xb6d0, 0xb4f0, 0xaa50, 0xb6d0, 0xb6d8, 0xb4f8, 0xaa58, 0xb6d8
.long 0xb300, 0xb440, 0xb080, 0xb300, 0xb308, 0xb448, 0xb088, 0xb308
.long 0xb310, 0xb450, 0xb090, 0xb310, 0xb318, 0xb458, 0xb098, 0xb318
.long 0xb260, 0xb760, 0xaa40, 0xb6c0, 0xb268, 0xb768, 0xaa48, 0xb6c8
.long 0xb270, 0xb770, 0xaa50, 0xb6d0, 0xb278, 0xb778, 0xaa58, 0xb6d8
.long 0xb580, 0xb120, 0xb620, 0xa680, 0xb588, 0xb128, 0xb628, 0xa688
.long 0xb590, 0xb130, 0xb630, 0xa690, 0xb598, 0xb138, 0xb638, 0xa698
.long 0xb260, 0xb1c0, 0xa7c0, 0xa680, 0xb268, 0xb1c8, 0xa7c8, 0xa688
.long 0xb270, 0xb1d0, 0xa7d0, 0xa690, 0xb278, 0xb1d8, 0xa7d8, 0xa698
.long 0xb300, 0xb3a0, 0xb620, 0xb300, 0xb308, 0xb3a8, 0xb628, 0xb308
.long 0xb310, 0xb3b0, 0xb630, 0xb310, 0xb318, 0xb3b8, 0xb638, 0xb318
.long 0xb6c0, 0xb800, 0xa7c0, 0xb300, 0xb6c8, 0xb808, 0xa7c8, 0xb308
.long 0xb6d0, 0xb810, 0xa7d0, 0xb310, 0xb6d8, 0xb818, 0xa7d8, 0xb318
.long 0x0, 0x200, 0x0, 0x3f803f80, 0x8, 0x208, 0x0, 0x3f803f80
.long 0x10, 0x210, 0x0, 0x3f803f80, 0x18, 0x218, 0x0, 0x3f803f80
.long 0x420, 0x620, 0x0, 0x3f803f80, 0x428, 0x628, 0x0, 0x3f803f80
.long 0x430, 0x630, 0x0, 0x3f803f80, 0x438, 0x638, 0x0, 0x3f803f80
.long 0x840, 0xa40, 0x10, 0x3f803f80, 0x848, 0xa48, 0x10, 0x3f803f80
.long 0x850, 0xa50, 0x10, 0x3f803f80, 0x858, 0xa58, 0x10, 0x3f803f80
.long 0xc60, 0xe60, 0x10, 0x3f803f80, 0xc68, 0xe68, 0x10, 0x3f803f80
.long 0xc70, 0xe70, 0x10, 0x3f803f80, 0xc78, 0xe78, 0x10, 0x3f803f80
.long 0x80, 0x280, 0x20, 0x3f803f80, 0x88, 0x288, 0x20, 0x3f803f80
.long 0x90, 0x290, 0x20, 0x3f803f80, 0x98, 0x298, 0x20, 0x3f803f80
.long 0x4a0, 0x6a0, 0x20, 0x3f803f80, 0x4a8, 0x6a8, 0x20, 0x3f803f80
.long 0x4b0, 0x6b0, 0x20, 0x3f803f80, 0x4b8, 0x6b8, 0x20, 0x3f803f80
.long 0x8c0, 0xac0, 0x30, 0x3f803f80, 0x8c8, 0xac8, 0x30, 0x3f803f80
.long 0x8d0, 0xad0, 0x30, 0x3f803f80, 0x8d8, 0xad8, 0x30, 0x3f803f80
.long 0xce0, 0xee0, 0x30, 0x3f803f80, 0xce8, 0xee8, 0x30, 0x3f803f80
.long 0xcf0, 0xef0, 0x30, 0x3f803f80, 0xcf8, 0xef8, 0x30, 0x3f803f80
.long 0x100, 0x300, 0x40, 0x0, 0x108, 0x308, 0x40, 0x0
.long 0x110, 0x310, 0x40, 0x0, 0x118, 0x318, 0x40, 0x0
.long 0x520, 0x720, 0x40, 0x0, 0x528, 0x728, 0x40, 0x0
.long 0x530, 0x730, 0x40, 0x0, 0x538, 0x738, 0x40, 0x0
.long 0x940, 0xb40, 0x50, 0x0, 0x948, 0xb48, 0x50, 0x0
.long 0x950, 0xb50, 0x50, 0x0, 0x958, 0xb58, 0x50, 0x0
.long 0xd60, 0xf60, 0x50, 0x0, 0xd68, 0xf68, 0x50, 0x0
.long 0xd70, 0xf70, 0x50, 0x0, 0xd78, 0xf78, 0x50, 0x0
.long 0x180, 0xf60, 0x60, 0x0, 0x188, 0xf68, 0x60, 0x0
.long 0x190, 0xf70, 0x60, 0x0, 0x198, 0xf78, 0x60, 0x0
.long 0x5a0, 0xf60, 0x60, 0x0, 0x5a8, 0xf68, 0x60, 0x0
.long 0x5b0, 0xf70, 0x60, 0x0, 0x5b8, 0xf78, 0x60, 0x0
.long 0x9c0, 0xf60, 0x70, 0x0, 0x9c8, 0xf68, 0x70, 0x0
.long 0x9d0, 0xf70, 0x70, 0x0, 0x9d8, 0xf78, 0x70, 0x0
.long 0xde0, 0xf60, 0x70, 0x0, 0xde8, 0xf68, 0x70, 0x0
.long 0xdf0, 0xf70, 0x70, 0x0, 0xdf8, 0xf78, 0x70, 0x0
.long 0xffff, 0x0, 0x0, 0x0, 0x0, 0x0, 0xffff, 0x0
.long 0x0, 0x0, 0x0, 0x0, 0x0, 0x0, 0x0, 0x0
.long 0x0, 0x0, 0x0, 0x0, 0x0, 0x0, 0x0, 0x0
.long 0x0, 0x0, 0x0, 0x0, 0x0, 0x0, 0x0, 0x0
.long 0xffff0000, 0x0, 0x0, 0x0, 0x0, 0x0, 0xffff0000, 0x0
.long 0x0, 0x0, 0x0, 0x0, 0x0, 0x0, 0x0, 0x0
.long 0x0, 0x0, 0x0, 0x0, 0x0, 0x0, 0x0, 0x0
.long 0x0, 0x0, 0x0, 0x0, 0x0, 0x0, 0x0, 0x0
.long 0x0, 0xffff, 0x0, 0x0, 0x0, 0x0, 0x0, 0xffff
.long 0x0, 0x0, 0x0, 0x0, 0x0, 0x0, 0x0, 0x0
.long 0x0, 0x0, 0x0, 0x0, 0x0, 0x0, 0x0, 0x0
.long 0x0, 0x0, 0x0, 0x0, 0x0, 0x0, 0x0, 0x0
.long 0x0, 0xffff0000, 0x0, 0x0, 0x0, 0x0, 0x0, 0xffff0000
.long 0x0, 0x0, 0x0, 0x0, 0x0, 0x0, 0x0, 0x0
.long 0x0, 0x0, 0x0, 0x0, 0x0, 0x0, 0x0, 0x0
.long 0x0, 0x0, 0x0, 0x0, 0x0, 0x0, 0x0, 0x0
.long 0x0, 0x0, 0x0, 0x0, 0x0, 0x0, 0x0, 0x0
.long 0xffff, 0x0, 0x0, 0x0, 0x0, 0x0, 0xffff, 0x0
.long 0x0, 0x0, 0x0, 0x0, 0x0, 0x0, 0x0, 0x0
.long 0x0, 0x0, 0x0, 0x0, 0x0, 0x0, 0x0, 0x0
.long 0x0, 0x0, 0x0, 0x0, 0x0, 0x0, 0x0, 0x0
.long 0xffff0000, 0x0, 0x0, 0x0, 0x0, 0x0, 0xffff0000, 0x0
.long 0x0, 0x0, 0x0, 0x0, 0x0, 0x0, 0x0, 0x0
.long 0x0, 0x0, 0x0, 0x0, 0x0, 0x0, 0x0, 0x0
.long 0x0, 0x0, 0x0, 0x0, 0x0, 0x0, 0x0, 0x0
.long 0x0, 0xffff, 0x0, 0x0, 0x0, 0x0, 0x0, 0xffff
.long 0x0, 0x0, 0x0, 0x0, 0x0, 0x0, 0x0, 0x0
.long 0x0, 0x0, 0x0, 0x0, 0x0, 0x0, 0x0, 0x0
.long 0x0, 0x0, 0x0, 0x0, 0x0, 0x0, 0x0, 0x0
.long 0x0, 0xffff0000, 0x0, 0x0, 0x0, 0x0, 0x0, 0xffff0000
.long 0x0, 0x0, 0x0, 0x0, 0x0, 0x0, 0x0, 0x0
.long 0x0, 0x0, 0x0, 0x0, 0x0, 0x0, 0x0, 0x0
.long 0x0, 0x0, 0x0, 0x0, 0x0, 0x0, 0x0, 0x0
.long 0x0, 0x0, 0x0, 0x0, 0x0, 0x0, 0x0, 0x0
.long 0x0, 0x0, 0xffff, 0x0, 0x0, 0x0, 0x0, 0x0
.long 0x0, 0x0, 0x0, 0x0, 0xffff, 0x0, 0x0, 0x0
.long 0x0, 0x0, 0x0, 0x0, 0x0, 0x0, 0x0, 0x0
.long 0x0, 0x0, 0x0, 0x0, 0x0, 0x0, 0x0, 0x0
.long 0x0, 0x0, 0xffff0000, 0x0, 0x0, 0x0, 0x0, 0x0
.long 0x0, 0x0, 0x0, 0x0, 0xffff0000, 0x0, 0x0, 0x0
.long 0x0, 0x0, 0x0, 0x0, 0x0, 0x0, 0x0, 0x0
.long 0x0, 0x0, 0x0, 0x0, 0x0, 0x0, 0x0, 0x0
.long 0x0, 0x0, 0x0, 0xffff, 0x0, 0x0, 0x0, 0x0
.long 0x0, 0x0, 0x0, 0x0, 0x0, 0xffff, 0x0, 0x0
.long 0x0, 0x0, 0x0, 0x0, 0x0, 0x0, 0x0, 0x0
.long 0x0, 0x0, 0x0, 0x0, 0x0, 0x0, 0x0, 0x0
.long 0x0, 0x0, 0x0, 0xffff0000, 0x0, 0x0, 0x0, 0x0
.long 0x0, 0x0, 0x0, 0x0, 0x0, 0xffff0000, 0x0, 0x0
.long 0x0, 0x0, 0x0, 0x0, 0x0, 0x0, 0x0, 0x0
.long 0x0, 0x0, 0x0, 0x0, 0x0, 0x0, 0x0, 0x0
.long 0x0, 0x0, 0x0, 0x0, 0xffff, 0x0, 0x0, 0x0
.long 0x0, 0x0, 0x0, 0x0, 0x0, 0x0, 0x0, 0x0
.long 0x0, 0x0, 0x0, 0x0, 0x0, 0x0, 0x0, 0x0
.long 0x0, 0x0, 0x0, 0x0, 0x0, 0x0, 0x0, 0x0
.long 0x0, 0x0, 0x0, 0x0, 0xffff0000, 0x0, 0x0, 0x0
.long 0x0, 0x0, 0x0, 0x0, 0x0, 0x0, 0x0, 0x0
.long 0x0, 0x0, 0x0, 0x0, 0x0, 0x0, 0x0, 0x0
.long 0x0, 0x0, 0x0, 0x0, 0x0, 0x0, 0x0, 0x0
.long 0x0, 0x0, 0x0, 0x0, 0x0, 0x0, 0x0, 0x0
.long 0x0, 0x0, 0x0, 0x0, 0x0, 0x0, 0x0, 0x0
.long 0x0, 0x0, 0x0, 0x0, 0x0, 0x0, 0x0, 0x0
.long 0x0, 0x0, 0x0, 0x0, 0x0, 0x0, 0x0, 0x0
.long 0x0, 0x0, 0x0, 0x0, 0x0, 0x0, 0x0, 0x0
.long 0x0, 0x0, 0x0, 0x0, 0x0, 0x0, 0x0, 0x0
.long 0x14d40, 0x14d40, 0x0, 0x0, 0x14e10, 0x14e10, 0x20, 0x20
.long 0x14ee0, 0x14ee0, 0x100000, 0x100000, 0x14fb0, 0x14fb0, 0x100020, 0x100020
.long 0x15080, 0x15080, 0x40, 0x40, 0x15150, 0x15150, 0x60, 0x60
.long 0x15220, 0x15220, 0x100040, 0x100040, 0x100000, 0x100000, 0x100060, 0x100060
.long 0x14d74, 0x14d74, 0x80, 0x80, 0x14e44, 0x14e44, 0xa0, 0xa0
.long 0x14f14, 0x14f14, 0x100080, 0x100080, 0x14fe4, 0x14fe4, 0x1000a0, 0x1000a0
.long 0x150b4, 0x150b4, 0xc0, 0xc0, 0x15184, 0x15184, 0xe0, 0xe0
.long 0x15254, 0x15254, 0x1000c0, 0x1000c0, 0x100000, 0x100000, 0x1000e0, 0x1000e0
.long 0x14da8, 0x14da8, 0x8, 0x100, 0x14e78, 0x14e78, 0x28, 0x120
.long 0x14f48, 0x14f48, 0x100008, 0x100100, 0x15018, 0x15018, 0x100028, 0x100120
.long 0x150e8, 0x150e8, 0x48, 0x140, 0x151b8, 0x151b8, 0x68, 0x160
.long 0x100000, 0x100000, 0x100048, 0x100140, 0x100000, 0x100000, 0x100068, 0x100160
.long 0x14ddc, 0x14ddc, 0x88, 0x180, 0x14eac, 0x14eac, 0xa8, 0x1a0
.long 0x14f7c, 0x14f7c, 0x100088, 0x100180, 0x1504c, 0x1504c, 0x1000a8, 0x1001a0
.long 0x1511c, 0x1511c, 0xc8, 0x1c0, 0x151ec, 0x151ec, 0xe8, 0x1e0
.long 0x100000, 0x100000, 0x1000c8, 0x1001c0, 0x100000, 0x100000, 0x1000e8, 0x1001e0
.long 0x17d40, 0x114d40, 0x100, 0x200, 0x17e10, 0x114e10, 0x120, 0x220
.long 0x17ee0, 0x114ee0, 0x100100, 0x100200, 0x17fb0, 0x114fb0, 0x100120, 0x100220
.long 0x18080, 0x115080, 0x140, 0x240, 0x18150, 0x115150, 0x160, 0x260
.long 0x18220, 0x115220, 0x100140, 0x100240, 0x103000, 0x200000, 0x100160, 0x100260
.long 0x17d74, 0x114d74, 0x180, 0x280, 0x17e44, 0x114e44, 0x1a0, 0x2a0
.long 0x17f14, 0x114f14, 0x100180, 0x100280, 0x17fe4, 0x114fe4, 0x1001a0, 0x1002a0
.long 0x180b4, 0x1150b4, 0x1c0, 0x2c0, 0x18184, 0x115184, 0x1e0, 0x2e0
.long 0x18254, 0x115254, 0x1001c0, 0x1002c0, 0x103000, 0x200000, 0x1001e0, 0x1002e0
.long 0x17da8, 0x114da8, 0x108, 0x300, 0x17e78, 0x114e78, 0x128, 0x320
.long 0x17f48, 0x114f48, 0x100108, 0x100300, 0x18018, 0x115018, 0x100128, 0x100320
.long 0x180e8, 0x1150e8, 0x148, 0x340, 0x181b8, 0x1151b8, 0x168, 0x360
.long 0x103000, 0x200000, 0x100148, 0x100340, 0x103000, 0x200000, 0x100168, 0x100360
.long 0x17ddc, 0x114ddc, 0x188, 0x380, 0x17eac, 0x114eac, 0x1a8, 0x3a0
.long 0x17f7c, 0x114f7c, 0x100188, 0x100380, 0x1804c, 0x11504c, 0x1001a8, 0x1003a0
.long 0x1811c, 0x11511c, 0x1c8, 0x3c0, 0x181ec, 0x1151ec, 0x1e8, 0x3e0
.long 0x103000, 0x200000, 0x1001c8, 0x1003c0, 0x103000, 0x200000, 0x1001e8, 0x1003e0
.long 0xa400, 0xd00, 0x0, 0x14d40, 0xa440, 0xd00, 0x0, 0x14d80
.long 0xa480, 0xd00, 0x1, 0x14dd0, 0xa4c0, 0xd00, 0x1, 0x14e10
.long 0xa500, 0xd00, 0x2, 0x14e60, 0xa540, 0xd00, 0x2, 0x14ea0
.long 0xa580, 0xd00, 0x3, 0x14ef0, 0xa5c0, 0xd00, 0x3, 0x14f30
.long 0xa600, 0xd00, 0x4, 0x14f40, 0xa640, 0xd00, 0x4, 0x14f80
.long 0xa680, 0xd00, 0x5, 0x14fd0, 0xa6c0, 0xd00, 0x5, 0x15010
.long 0xa700, 0xd00, 0x6, 0x15060, 0xa740, 0xd00, 0x6, 0x150a0
.long 0xa780, 0xd00, 0x7, 0x150f0, 0xa7c0, 0xd00, 0x7, 0x15130
.long 0xa800, 0xd00, 0x8, 0x15140, 0xa840, 0xd00, 0x8, 0x15180
.long 0xa880, 0xd00, 0x9, 0x151d0, 0xa8c0, 0xd00, 0x9, 0x15210
.long 0xa900, 0xd00, 0xa, 0x15260, 0xa940, 0xd00, 0xa, 0x152a0
.long 0xa980, 0xd00, 0xb, 0x152f0, 0xa9c0, 0xd00, 0xb, 0x15330
.long 0xaa00, 0xd00, 0xc, 0x15340, 0xaa40, 0xd00, 0xc, 0x15380
.long 0x1f680, 0x40, 0xd, 0x153d0, 0x100000, 0xd00, 0xd, 0x15410
.long 0x100000, 0xd00, 0xe, 0x15460, 0x100000, 0xd00, 0xe, 0x154a0
.long 0x100000, 0xd00, 0xf, 0x154f0, 0x100000, 0xd00, 0xf, 0x15530
.long 0xa400, 0xd00, 0x2, 0x14d60, 0xa440, 0xd00, 0x2, 0x14da0
.long 0xa480, 0xd00, 0x3, 0x14df0, 0xa4c0, 0xd00, 0x3, 0x14e30
.long 0xa500, 0xd00, 0x4, 0x14e40, 0xa540, 0xd00, 0x4, 0x14e80
.long 0xa580, 0xd00, 0x5, 0x14ed0, 0xa5c0, 0xd00, 0x5, 0x14f10
.long 0xa600, 0xd00, 0x6, 0x14f60, 0xa640, 0xd00, 0x6, 0x14fa0
.long 0xa680, 0xd00, 0x7, 0x14ff0, 0xa6c0, 0xd00, 0x7, 0x15030
.long 0xa700, 0xd00, 0x8, 0x15040, 0xa740, 0xd00, 0x8, 0x15080
.long 0xa780, 0xd00, 0x9, 0x150d0, 0xa7c0, 0xd00, 0x9, 0x15110
.long 0xa800, 0xd00, 0xa, 0x15160, 0xa840, 0xd00, 0xa, 0x151a0
.long 0xa880, 0xd00, 0xb, 0x151f0, 0xa8c0, 0xd00, 0xb, 0x15230
.long 0xa900, 0xd00, 0xc, 0x15240, 0xa940, 0xd00, 0xc, 0x15280
.long 0xa980, 0xd00, 0xd, 0x152d0, 0xa9c0, 0xd00, 0xd, 0x15310
.long 0xaa00, 0xd00, 0xe, 0x15360, 0xaa40, 0xd00, 0xe, 0x153a0
.long 0x1f680, 0x40, 0xf, 0x153f0, 0x100000, 0xd00, 0xf, 0x15430
.long 0x100000, 0xd00, 0x10, 0x15440, 0x100000, 0xd00, 0x10, 0x15480
.long 0x100000, 0xd00, 0x11, 0x154d0, 0x100000, 0xd00, 0x11, 0x15510
.long 0x1f690, 0x1f890, 0x1f9c0, 0x1f9e0, 0x1f698, 0x1f898, 0x1f9c8, 0x1f9e8
.long 0x1f680, 0x1f880, 0x1f9d0, 0x1f9f0, 0x1f688, 0x1f888, 0x1f9d8, 0x100000
.long 0x1fd20, 0x1ff20, 0x1f9c2, 0x1f9e2, 0x1fd28, 0x1ff28, 0x1f9ca, 0x1f9ea
.long 0x1fd30, 0x1ff30, 0x1f9d2, 0x1f9f2, 0x1fd38, 0x1ff38, 0x1f9da, 0x100000
.long 0x1f6f0, 0x1f8f0, 0x1f9c4, 0x1f9e4, 0x1f6f8, 0x1f8f8, 0x1f9cc, 0x1f9ec
.long 0x1f6e0, 0x1f8e0, 0x1f9d4, 0x100000, 0x1f6e8, 0x1f8e8, 0x1f9dc, 0x100000
.long 0x1fd40, 0x1ff40, 0x1f9c6, 0x1f9e6, 0x1fd48, 0x1ff48, 0x1f9ce, 0x1f9ee
.long 0x1fd50, 0x1ff50, 0x1f9d6, 0x100000, 0x1fd58, 0x1ff58, 0x1f9de, 0x100000
.long 0x1f710, 0x1f910, 0x1f9c0, 0x1f9e0, 0x1f718, 0x1f918, 0x1f9c8, 0x1f9e8
.long 0x1f700, 0x1f900, 0x1f9d0, 0x1f9f0, 0x1f708, 0x1f908, 0x1f9d8, 0x100000
.long 0x1fda0, 0x1ffa0, 0x1f9c2, 0x1f9e2, 0x1fda8, 0x1ffa8, 0x1f9ca, 0x1f9ea
.long 0x1fdb0, 0x1ffb0, 0x1f9d2, 0x1f9f2, 0x1fdb8, 0x1ffb8, 0x1f9da, 0x100000
.long 0x1f770, 0x1f970, 0x1f9c4, 0x1f9e4, 0x1f778, 0x1f978, 0x1f9cc, 0x1f9ec
.long 0x1f760, 0x1f960, 0x1f9d4, 0x100000, 0x1f768, 0x1f968, 0x1f9dc, 0x100000
.long 0x1fdc0, 0x1ffc0, 0x1f9c6, 0x1f9e6, 0x1fdc8, 0x1ffc8, 0x1f9ce, 0x1f9ee
.long 0x1fdd0, 0x1ffd0, 0x1f9d6, 0x100000, 0x1fdd8, 0x1ffd8, 0x1f9de, 0x100000
.long 0x1f790, 0x1f990, 0x1f9c0, 0x1f9e0, 0x1f798, 0x1f998, 0x1f9c8, 0x1f9e8
.long 0x1f780, 0x1f980, 0x1f9d0, 0x1f9f0, 0x1f788, 0x1f988, 0x1f9d8, 0x100000
.long 0x1fe20, 0x20020, 0x1f9c2, 0x1f9e2, 0x1fe28, 0x20028, 0x1f9ca, 0x1f9ea
.long 0x1fe30, 0x20030, 0x1f9d2, 0x1f9f2, 0x1fe38, 0x20038, 0x1f9da, 0x100000
.long 0x1f7f0, 0x14d00, 0x1f9c4, 0x1f9e4, 0x1f7f8, 0x14d08, 0x1f9cc, 0x1f9ec
.long 0x1f7e0, 0x14d10, 0x1f9d4, 0x100000, 0x1f7e8, 0x14d18, 0x1f9dc, 0x100000
.long 0x1fe40, 0x14d00, 0x1f9c6, 0x1f9e6, 0x1fe48, 0x14d08, 0x1f9ce, 0x1f9ee
.long 0x1fe50, 0x14d10, 0x1f9d6, 0x100000, 0x1fe58, 0x14d18, 0x1f9de, 0x100000
.long 0x1f810, 0x14d00, 0x1f9c0, 0x1f9e0, 0x1f818, 0x14d08, 0x1f9c8, 0x1f9e8
.long 0x1f800, 0x14d10, 0x1f9d0, 0x1f9f0, 0x1f808, 0x14d18, 0x1f9d8, 0x100000
.long 0x1fea0, 0x14d00, 0x1f9c2, 0x1f9e2, 0x1fea8, 0x14d08, 0x1f9ca, 0x1f9ea
.long 0x1feb0, 0x14d10, 0x1f9d2, 0x1f9f2, 0x1feb8, 0x14d18, 0x1f9da, 0x100000
.long 0x1f870, 0x14d00, 0x1f9c4, 0x1f9e4, 0x1f878, 0x14d08, 0x1f9cc, 0x1f9ec
.long 0x1f860, 0x14d10, 0x1f9d4, 0x100000, 0x1f868, 0x14d18, 0x1f9dc, 0x100000
.long 0x1fec0, 0x14d00, 0x1f9c6, 0x1f9e6, 0x1fec8, 0x14d08, 0x1f9ce, 0x1f9ee
.long 0x1fed0, 0x14d10, 0x1f9d6, 0x100000, 0x1fed8, 0x14d18, 0x1f9de, 0x100000
.long 0x0, 0x4444, 0x0, 0xa400, 0x10, 0xeeee, 0x4, 0xa404
.long 0x20, 0x4444, 0x8, 0xa408, 0x30, 0xeeee, 0xc, 0xa40c
.long 0x40, 0x4444, 0x10, 0xa410, 0x50, 0xeeee, 0x14, 0xa414
.long 0x60, 0x4444, 0x18, 0xa418, 0x70, 0xeeee, 0x1c, 0xa41c
.long 0x0, 0x4444, 0x20, 0xa420, 0x10, 0xeeee, 0x24, 0xa424
.long 0x20, 0x4444, 0x28, 0xa428, 0x30, 0xeeee, 0x2c, 0xa42c
.long 0x40, 0x4444, 0x30, 0xa430, 0x50, 0xeeee, 0x34, 0xa434
.long 0x60, 0x4444, 0x38, 0xa438, 0x70, 0xeeee, 0x3c, 0xa43c
.long 0x0, 0x4444, 0x40, 0xa440, 0x10, 0xeeee, 0x44, 0xa444
.long 0x20, 0x4444, 0x48, 0xa448, 0x30, 0xeeee, 0x4c, 0xa44c
.long 0x40, 0x4444, 0x50, 0xa450, 0x50, 0xeeee, 0x54, 0xa454
.long 0x60, 0x4444, 0x58, 0xa458, 0x70, 0xeeee, 0x5c, 0xa45c
.long 0x0, 0x4444, 0x60, 0xa460, 0x10, 0xeeee, 0x64, 0xa464
.long 0x20, 0x4444, 0x68, 0xa468, 0x30, 0xeeee, 0x6c, 0xa46c
.long 0x40, 0x4444, 0x70, 0xa470, 0x50, 0xeeee, 0x74, 0xa474
.long 0x60, 0x4444, 0x78, 0xa478, 0x70, 0xeeee, 0x7c, 0xa47c
.long 0x0, 0x4444, 0x420, 0xb080, 0x10, 0xeeee, 0x424, 0xb084
.long 0x20, 0x4444, 0x428, 0xb088, 0x30, 0xeeee, 0x42c, 0xb08c
.long 0x40, 0x4444, 0x430, 0xb090, 0x50, 0xeeee, 0x434, 0xb094
.long 0x60, 0x4444, 0x438, 0xb098, 0x70, 0xeeee, 0x43c, 0xb09c
.long 0x0, 0x4444, 0x440, 0xb0a0, 0x10, 0xeeee, 0x444, 0xb0a4
.long 0x20, 0x4444, 0x448, 0xb0a8, 0x30, 0xeeee, 0x44c, 0xb0ac
.long 0x40, 0x4444, 0x450, 0xb0b0, 0x50, 0xeeee, 0x454, 0xb0b4
.long 0x60, 0x4444, 0x458, 0xb0b8, 0x70, 0xeeee, 0x45c, 0xb0bc
.long 0x0, 0x4444, 0x460, 0xb0c0, 0x10, 0xeeee, 0x464, 0xb0c4
.long 0x20, 0x4444, 0x468, 0xb0c8, 0x30, 0xeeee, 0x46c, 0xb0cc
.long 0x40, 0x4444, 0x470, 0xb0d0, 0x50, 0xeeee, 0x474, 0xb0d4
.long 0x60, 0x4444, 0x478, 0xb0d8, 0x70, 0xeeee, 0x47c, 0xb0dc
.long 0x0, 0x4444, 0x480, 0xb0e0, 0x10, 0xeeee, 0x484, 0xb0e4
.long 0x20, 0x4444, 0x488, 0xb0e8, 0x30, 0xeeee, 0x48c, 0xb0ec
.long 0x40, 0x4444, 0x490, 0xb0f0, 0x50, 0xeeee, 0x494, 0xb0f4
.long 0x60, 0x4444, 0x498, 0xb0f8, 0x70, 0xeeee, 0x49c, 0xb0fc
.long 0x1fa28, 0x1f9f4, 0x34, 0x14d00, 0x1fa28, 0x1f9f6, 0x74, 0x14d04
.long 0x1fa28, 0x1f9f8, 0xb4, 0x14d08, 0x1fa28, 0x1f9fa, 0xf4, 0x14d0c
.long 0x1fa28, 0x1f9fc, 0x134, 0x14d10, 0x1fa28, 0x1f9fe, 0x174, 0x14d14
.long 0x1fa28, 0x1fa00, 0x1b4, 0x14d18, 0x1fa28, 0x1fa02, 0x1f4, 0x14d1c
.long 0x1fa28, 0x1fa04, 0x234, 0x14d20, 0x1fa28, 0x1fa06, 0x274, 0x14d24
.long 0x1fa28, 0x1fa08, 0x2b4, 0x14d28, 0x1fa28, 0x1fa0a, 0x2f4, 0x14d2c
.long 0x1fa28, 0x1fa0c, 0x334, 0x14d30, 0x1fa28, 0x1fa0e, 0x374, 0x14d34
.long 0x1fa28, 0x1fa10, 0x3b4, 0x14d38, 0x1fa28, 0x1fa12, 0x3f4, 0x14d3c
.long 0x1fa28, 0x1fa14, 0x434, 0x14d00, 0x1fa28, 0x1fa16, 0x474, 0x14d04
.long 0x1fa28, 0x1fa18, 0x4b4, 0x14d08, 0x1fa28, 0x1fa1a, 0x4f4, 0x14d0c
.long 0x1fa28, 0x1fa1c, 0x534, 0x14d10, 0x1fa28, 0x1fa1e, 0x574, 0x14d14
.long 0x1fa28, 0x1fa20, 0x5b4, 0x14d18, 0x1fa28, 0x1fa22, 0x5f4, 0x14d1c
.long 0x1fa28, 0x1fa24, 0x634, 0x14d20, 0x1fa28, 0x1fa26, 0x674, 0x14d24
.long 0x1fa28, 0x1fa28, 0x6b4, 0x14d28, 0x1fa28, 0x1fa2a, 0x6f4, 0x14d2c
.long 0x1fa28, 0x1fa2c, 0x734, 0x14d30, 0x1fa28, 0x1fa2e, 0x774, 0x14d34
.long 0x1fa28, 0x1fa30, 0x7b4, 0x14d38, 0x1fa28, 0x1fa32, 0x7f4, 0x14d3c
.long 0x1fa38, 0x1fa34, 0x834, 0x14d00, 0x1fa38, 0x1fa36, 0x874, 0x14d04
.long 0x1fa38, 0x1fa38, 0x8b4, 0x14d08, 0x1fa38, 0x1fa3a, 0x8f4, 0x14d0c
.long 0x1fa38, 0x1fa3c, 0x934, 0x14d10, 0x1fa38, 0x1fa3e, 0x974, 0x14d14
.long 0x1fa38, 0x1fa40, 0x9b4, 0x14d18, 0x1fa38, 0x1fa42, 0x9f4, 0x14d1c
.long 0x1fa38, 0x1fa44, 0xa34, 0x14d20, 0x1fa38, 0x1fa46, 0xa74, 0x14d24
.long 0x1fa38, 0x1fa48, 0xab4, 0x14d28, 0x1fa38, 0x1fa4a, 0xaf4, 0x14d2c
.long 0x1fa38, 0x1fa4c, 0xb34, 0x14d30, 0x1fa38, 0x1fa4e, 0xb74, 0x14d34
.long 0x1fa38, 0x1fa50, 0xbb4, 0x14d38, 0x1fa38, 0x1fa52, 0xbf4, 0x14d3c
.long 0x1fa38, 0x1fa54, 0xc34, 0x14d00, 0x1fa38, 0x1fa56, 0xc74, 0x14d04
.long 0x1fa38, 0x1fa58, 0xcb4, 0x14d08, 0x1fa38, 0x1fa5a, 0xcf4, 0x14d0c
.long 0x1fa38, 0x1fa5c, 0xd34, 0x14d10, 0x1fa38, 0x1fa5e, 0xd74, 0x14d14
.long 0x1fa38, 0x1fa60, 0xdb4, 0x14d18, 0x1fa38, 0x1fa62, 0xdf4, 0x14d1c
.long 0x1fa38, 0x1fa64, 0xe34, 0x14d20, 0x1fa38, 0x1fa66, 0xe74, 0x14d24
.long 0x1fa38, 0x1fa68, 0xeb4, 0x14d28, 0x1fa38, 0x1fa6a, 0xef4, 0x14d2c
.long 0x1fa38, 0x1fa6c, 0xf34, 0x14d30, 0x1fa38, 0x1fa6e, 0xf74, 0x14d34
.long 0x1fa38, 0x1fa70, 0xfb4, 0x14d38, 0x1fa38, 0x1fa72, 0xff4, 0x14d3c
.long 0x0, 0x0, 0x0, 0x0, 0x0, 0x0, 0x0, 0x0
.long 0x0, 0x0, 0x0, 0x0, 0x0, 0x0, 0x0, 0x0
.long 0x0, 0x0, 0x0, 0x0, 0x0, 0x0, 0x0, 0x0
.long 0x0, 0x0, 0x0, 0x0, 0x0, 0x0, 0x0, 0x0
.long 0x0, 0x0, 0x0, 0x0, 0x0, 0x0, 0x0, 0x0
.long 0x0, 0x0, 0x0, 0x0, 0x0, 0x0, 0x0, 0x0
.long 0x0, 0x0, 0x0, 0x0, 0x0, 0x0, 0x0, 0x0
.long 0x0, 0x0, 0x0, 0x0, 0x0, 0x0, 0x0, 0x0
.long 0x0, 0x0, 0x0, 0x0, 0x0, 0x0, 0x0, 0x0
.long 0x0, 0x0, 0x0, 0x0, 0x0, 0x0, 0x0, 0x0
.long 0x0, 0x0, 0x0, 0x0, 0x0, 0x0, 0x0, 0x0
.long 0x0, 0x0, 0x0, 0x0, 0x0, 0x0, 0x0, 0x0
.long 0x0, 0x0, 0x0, 0x0, 0x0, 0x0, 0x0, 0x0
.long 0x0, 0x0, 0x0, 0x0, 0x0, 0x0, 0x0, 0x0
.long 0x0, 0x0, 0x0, 0x0, 0x0, 0x0, 0x0, 0x0
.long 0x0, 0x0, 0x0, 0x0, 0x0, 0x0, 0x0, 0x0
.long 0x0, 0x0, 0x0, 0x0, 0x0, 0x0, 0x0, 0x0
.long 0x0, 0x0, 0x0, 0x0, 0x0, 0x0, 0x0, 0x0
.long 0x0, 0x0, 0x0, 0x0, 0x0, 0x0, 0x0, 0x0
.long 0x0, 0x0, 0x0, 0x0, 0x0, 0x0, 0x0, 0x0
.long 0x0, 0x0, 0x0, 0x0, 0x0, 0x0, 0x0, 0x0
.long 0x0, 0x0, 0x0, 0x0, 0x0, 0x0, 0x0, 0x0
.long 0x0, 0x0, 0x0, 0x0, 0x0, 0x0, 0x0, 0x0
.long 0x0, 0x0, 0x0, 0x0, 0x0, 0x0, 0x0, 0x0
.long 0x0, 0x0, 0x0, 0x0, 0x0, 0x0, 0x0, 0x0
.long 0x0, 0x0, 0x0, 0x0, 0x0, 0x0, 0x0, 0x0
.long 0x0, 0x0, 0x0, 0x0, 0x0, 0x0, 0x0, 0x0
.long 0x0, 0x0, 0x0, 0x0, 0x0, 0x0, 0x0, 0x0
.long 0x0, 0x0, 0x0, 0x0, 0x0, 0x0, 0x0, 0x0
.long 0x0, 0x0, 0x0, 0x0, 0x0, 0x0, 0x0, 0x0
.long 0x0, 0x0, 0x0, 0x0, 0x0, 0x0, 0x0, 0x0
.long 0x0, 0x0, 0x0, 0x0, 0x0, 0x0, 0x0, 0x0
.long 0x13320, 0xa9b0, 0xa800, 0x10c00, 0xf320, 0xc120, 0x133b0, 0xb690
.long 0xa890, 0x11920, 0xf3b0, 0xce00, 0x12600, 0xa920, 0xb520, 0x10c90
.long 0xe600, 0xc090, 0x12690, 0xb600, 0xb5b0, 0x119b0, 0xe690, 0xcdb0
.long 0xd5f0, 0x11440, 0x117f0, 0x130d0, 0xf8d0, 0xadf0, 0xd640, 0x12160
.long 0x11840, 0x13df0, 0xf960, 0xbad0, 0xc8d0, 0x113f0, 0x124d0, 0x13160
.long 0xebf0, 0xad60, 0xc960, 0x120d0, 0x12560, 0x13e40, 0xec40, 0xba40
.long 0xefb0, 0x10ed0, 0x117b0, 0x12a40, 0xfa90, 0xdb60, 0xc890, 0x10d60
.long 0x10a90, 0x129f0, 0x13bb0, 0xddf0, 0xf000, 0x11bf0, 0x11520, 0xe960
.long 0xc160, 0xf9b0, 0xc920, 0x11a40, 0x10800, 0xe8d0, 0xc3f0, 0x13a90
.long 0xce40, 0xfa00, 0xfff0, 0xbb20, 0xedb0, 0xdad0, 0xced0, 0x10720
.long 0x10040, 0xc800, 0x14890, 0xde40, 0xf560, 0xfbb0, 0x140d0, 0xbdb0
.long 0xb3f0, 0xec00, 0xf5f0, 0x10890, 0x14160, 0xca90, 0xb760, 0x14720
.long 0x13520, 0xddb0, 0xa520, 0xbe00, 0xf490, 0xe800, 0x13690, 0x10490
.long 0xa5b0, 0xcb20, 0xe7b0, 0x14d00, 0x12800, 0xdd20, 0xb200, 0xbe90
.long 0xf800, 0x14320, 0x129b0, 0x10400, 0xb290, 0xcbb0, 0xeb20, 0x14290
.long 0xd560, 0x10760, 0x112d0, 0xaed0, 0xfb60, 0xeed0, 0xd3f0, 0xe040
.long 0x11360, 0xbbf0, 0xee40, 0x14d00, 0xc840, 0x106d0, 0x11ff0, 0xaf60
.long 0xfed0, 0x149f0, 0xc6d0, 0xdff0, 0x12040, 0xbc40, 0xf1f0, 0x14960
.long 0xbbb0, 0x10cd0, 0xfdb0, 0x12960, 0xd3b0, 0xd9f0, 0x13090, 0x11160
.long 0x13e90, 0x12bf0, 0xbff0, 0xd290, 0xbc00, 0x119f0, 0xfb20, 0xe840
.long 0xac90, 0xd840, 0x13120, 0x11e40, 0x13c00, 0xead0, 0xbe40, 0xabb0
.long 0xcf60, 0x11400, 0x101f0, 0xef20, 0x12e90, 0xdd60, 0xccd0, 0xd320
.long 0x10560, 0x14a00, 0xb640, 0x12d20, 0xf640, 0x115b0, 0x142d0, 0xf1b0
.long 0x121b0, 0xdcd0, 0xf3f0, 0xd490, 0x14640, 0x14c90, 0xb5f0, 0x12000
.long 0x13600, 0xf7b0, 0xa490, 0xb120, 0x10d20, 0xc200, 0x135b0, 0xea90
.long 0xa400, 0x14d00, 0x10db0, 0xcf20, 0x12920, 0xf720, 0xaa00, 0x14000
.long 0x11a00, 0xc290, 0x12890, 0xea00, 0xb720, 0x14090, 0x11a90, 0xcfb0
.long 0xd4d0, 0xfa40, 0x11760, 0x123f0, 0x12cd0, 0xaff0, 0xd440, 0xed60
.long 0x116d0, 0x14d00, 0x12d60, 0xbcd0, 0xc7f0, 0xf9f0, 0x118d0, 0x14ad0
.long 0x139f0, 0xb040, 0xc760, 0xecd0, 0x125f0, 0x14b60, 0x13a40, 0xbd60
.long 0xe290, 0x10e40, 0xc9b0, 0x12760, 0xfe00, 0x13640, 0x10df0, 0xd5b0
.long 0xf090, 0x128d0, 0x13f20, 0x138d0, 0xe320, 0x11b60, 0x12640, 0xafb0
.long 0xfe90, 0x14360, 0x11ad0, 0xd600, 0xe560, 0xad20, 0x13fb0, 0x145f0
.long 0xe000, 0xcd60, 0x10920, 0x102d0, 0xa6d0, 0xebb0, 0xd040, 0x12e00
.long 0xfc00, 0x10240, 0xaa40, 0x14690, 0xe1b0, 0xf440, 0x103f0, 0x12320
.long 0xe7f0, 0xee00, 0xf760, 0x12fb0, 0x144d0, 0x125b0, 0xeb60, 0x14920
.long 0x13720, 0x111b0, 0xdb20, 0xf400, 0x11090, 0x11d20, 0x137b0, 0x11e90
.long 0xda90, 0xe720, 0x11db0, 0x14d00, 0x12a00, 0x11120, 0x10200, 0xf5b0
.long 0x11200, 0x14400, 0x12a90, 0x11e00, 0x101b0, 0xe890, 0x11f20, 0x14490
.long 0xd6d0, 0x12e40, 0x108d0, 0xfc40, 0x13240, 0x13ed0, 0xd760, 0x13b60
.long 0x10840, 0xef60, 0x13f60, 0x14d00, 0xc9f0, 0x12df0, 0xe1f0, 0xfad0
.long 0x132d0, 0x14bf0, 0xca40, 0x13ad0, 0xe160, 0xedf0, 0x13ff0, 0x14c40
.long 0x11690, 0x11040, 0xde90, 0xa640, 0x10b20, 0x136d0, 0x109b0, 0x10ff0
.long 0xa5f0, 0xd1b0, 0x10bb0, 0x143f0, 0x11720, 0x11d60, 0xdf20, 0xb360
.long 0xb000, 0x13360, 0x10a00, 0x11cd0, 0xb2d0, 0xd200, 0xb090, 0x14040
.long 0xcbf0, 0xb920, 0xe400, 0x13560, 0xa560, 0xc490, 0xcc40, 0xc600
.long 0x13840, 0x13200, 0xe640, 0xc720, 0xf2d0, 0xba90, 0xdfb0, 0xc040
.long 0xa8d0, 0x11fb0, 0xf360, 0xc7b0, 0xc360, 0x12db0, 0xe9f0, 0x12200
.long 0x13400, 0xc3b0, 0xdc00, 0x10e00, 0xbfb0, 0xcc00, 0x13490, 0xd090
.long 0xdc90, 0x11b20, 0xcc90, 0x14d00, 0x12720, 0xc320, 0x10320, 0x10fb0
.long 0xc400, 0x14120, 0x127b0, 0xd000, 0x103b0, 0x11c90, 0xd120, 0x141b0
.long 0xd1f0, 0xac40, 0x10ad0, 0x13040, 0xab60, 0xb7f0, 0xd240, 0xb960
.long 0x10b60, 0x13d60, 0xb840, 0x14d00, 0xc4d0, 0xabf0, 0xe3f0, 0x12ed0
.long 0xb0d0, 0x146d0, 0xc560, 0xb8d0, 0xe440, 0x13bf0, 0xbdf0, 0x14760
.long 0xfc90, 0x10f60, 0x11290, 0xa840, 0x13d20, 0x104d0, 0x13db0, 0x111f0
.long 0x105b0, 0xa7f0, 0x13c90, 0xf7f0, 0xfd20, 0x11c40, 0x11320, 0xb560
.long 0xae00, 0xff60, 0x13e00, 0x11ed0, 0x10600, 0xb4d0, 0xadb0, 0xf240
.long 0xcdf0, 0xed20, 0x133f0, 0xbd20, 0x12c40, 0x14bb0, 0xd160, 0x14800
.long 0x13440, 0xca00, 0x11f60, 0x14b20, 0xf4d0, 0xee90, 0xbed0, 0xb890
.long 0x12ad0, 0x12490, 0xf840, 0x149b0, 0xbf60, 0xc5b0, 0x11df0, 0x12400
.long 0x12bb0, 0x13800, 0xd920, 0xc000, 0x14600, 0x14d00, 0x13890, 0x14d00
.long 0xd9b0, 0xcd20, 0xc5f0, 0x14d00, 0x13920, 0x145b0, 0x10000, 0xc1b0
.long 0xb1b0, 0x14d00, 0x12c00, 0x14520, 0x10090, 0xce90, 0xfbf0, 0x14d00
.long 0xc640, 0xd2d0, 0x105f0, 0xae40, 0x14cd0, 0x14d00, 0xd360, 0x14d00
.long 0x10640, 0xbb60, 0xbf20, 0x14d00, 0xd7f0, 0x14840, 0xded0, 0xacd0
.long 0x10290, 0x14d00, 0xcad0, 0x147f0, 0xdf60, 0xb9f0, 0x11000, 0x14d00
.long 0x14a90, 0x11240, 0xf890, 0xa760, 0x14d00, 0xaad0, 0x123b0, 0x110d0
.long 0x139b0, 0xa9f0, 0x14d00, 0x12b20, 0x10c40, 0xae90, 0xf920, 0xb440
.long 0xe0d0, 0x14d00, 0x11960, 0xaf20, 0x13a00, 0xb6d0, 0x131f0, 0x14d00
.long 0x13b20, 0xd0d0, 0x135f0, 0xf120, 0x14d00, 0x12440, 0xac00, 0xcb60
.long 0x13960, 0x14c00, 0xf520, 0x14d00, 0xcff0, 0x12120, 0xc0d0, 0xec90
.long 0xda40, 0xe090, 0xf6d0, 0x12290, 0xc440, 0x147b0, 0x14d00, 0x14d00
.long 0xa600, 0xd800, 0xdbb0, 0x10120, 0x0, 0x0, 0xa7b0, 0xff20
.long 0xda00, 0x14d00, 0x0, 0x0, 0xb320, 0xd890, 0xde00, 0x14200
.long 0x0, 0x0, 0xb490, 0xffb0, 0x10520, 0x143b0, 0x0, 0x0
.long 0x11640, 0x109f0, 0x107f0, 0xe240, 0x0, 0x0, 0x114d0, 0xe2d0
.long 0x10960, 0x14d00, 0x0, 0x0, 0x12360, 0x10a40, 0x10bf0, 0x14a40
.long 0x0, 0x0, 0x121f0, 0xe360, 0xe4d0, 0x148d0, 0x0, 0x0
.long 0xbc90, 0x126d0, 0x12c90, 0xa960, 0x0, 0x0, 0x131b0, 0x12b60
.long 0xb7b0, 0xa4d0, 0x0, 0x0, 0xba00, 0xe5f0, 0xa440, 0xaa90
.long 0x0, 0x0, 0x12f20, 0xea40, 0xb160, 0xab20, 0x0, 0x0
.long 0x10360, 0x11600, 0xd720, 0x134d0, 0x0, 0x0, 0x100d0, 0xd520
.long 0x11800, 0x13760, 0x0, 0x0, 0x14440, 0x11890, 0x137f0, 0x12520
.long 0x0, 0x0, 0x141f0, 0xd7b0, 0xc2d0, 0x12090, 0x0, 0x0
.long 0xa720, 0xf200, 0xf600, 0x10f20, 0x0, 0x0, 0xa690, 0xe520
.long 0xf690, 0x11c00, 0x0, 0x0, 0xb400, 0xf290, 0xe920, 0x10e90
.long 0x0, 0x0, 0xb3b0, 0xe5b0, 0xe9b0, 0x11bb0, 0x0, 0x0
.long 0x115f0, 0xfcd0, 0xfdf0, 0x12ff0, 0x0, 0x0, 0x11560, 0xeff0
.long 0xfe40, 0x13cd0, 0x0, 0x0, 0x122d0, 0xfd60, 0xf0d0, 0x12f60
.long 0x0, 0x0, 0x12240, 0xf040, 0xf160, 0x13c40, 0x0, 0x0
.long 0xe3b0, 0x12840, 0x11490, 0xdc40, 0x0, 0x0, 0x127f0, 0xd690
.long 0x107b0, 0xdbf0, 0x0, 0x0, 0xe120, 0xe760, 0xc240, 0x113b0
.long 0x0, 0x0, 0xe6d0, 0xd400, 0xc1f0, 0x10690, 0x0, 0x0
.long 0xe200, 0x10160, 0xb9b0, 0xd8d0, 0x0, 0x0, 0x10440, 0x13000
.long 0xc690, 0xd960, 0x0, 0x0, 0xe490, 0x14240, 0xb1f0, 0xb800
.long 0x0, 0x0, 0x14560, 0x13290, 0xb240, 0xc520, 0x0, 0x0
.long 0x0, 0x0, 0x0, 0x0, 0x0, 0x0, 0x0, 0x0
.long 0x0, 0x0, 0x0, 0x0, 0x0, 0x0, 0x0, 0x0
.long 0x0, 0x0, 0x0, 0x0, 0x0, 0x0, 0x0, 0x0
.long 0x0, 0x0, 0x0, 0x0, 0x0, 0x0, 0x0, 0x0
.long 0x0, 0x0, 0x0, 0x0, 0x0, 0x0, 0x0, 0x0
.long 0x0, 0x0, 0x0, 0x0, 0x0, 0x0, 0x0, 0x0
.long 0x0, 0x0, 0x0, 0x0, 0x0, 0x0, 0x0, 0x0
.long 0x0, 0x0, 0x0, 0x0, 0x0, 0x0, 0x0, 0x0
.long 0x0, 0x0, 0x0, 0x0, 0x0, 0x0, 0x0, 0x0
.long 0x0, 0x0, 0x0, 0x0, 0x0, 0x0, 0x0, 0x0
.long 0x0, 0x0, 0x0, 0x0, 0x0, 0x0, 0x0, 0x0
.long 0x0, 0x0, 0x0, 0x0, 0x0, 0x0, 0x0, 0x0
.long 0x0, 0x0, 0x0, 0x0, 0x0, 0x0, 0x0, 0x0
.long 0x0, 0x0, 0x0, 0x0, 0x0, 0x0, 0x0, 0x0
.long 0x0, 0x0, 0x0, 0x0, 0x0, 0x0, 0x0, 0x0
.long 0x0, 0x0, 0x0, 0x0, 0x0, 0x0, 0x0, 0x0
.long 0x0, 0x0, 0x0, 0x0, 0x0, 0x0, 0x0, 0x0
.long 0x0, 0x0, 0x0, 0x0, 0x0, 0x0, 0x0, 0x0
.long 0x0, 0x0, 0x0, 0x0, 0x0, 0x0, 0x0, 0x0
.long 0x0, 0x0, 0x0, 0x0, 0x0, 0x0, 0x0, 0x0
.long 0x0, 0x0, 0x0, 0x0, 0x0, 0x0, 0x0, 0x0
.long 0x0, 0x0, 0x0, 0x0, 0x0, 0x0, 0x0, 0x0
.long 0x0, 0x0, 0x0, 0x0, 0x0, 0x0, 0x0, 0x0
.long 0x0, 0x0, 0x0, 0x0, 0x0, 0x0, 0x0, 0x0
.long 0x0, 0x0, 0x0, 0x0, 0x0, 0x0, 0x0, 0x0
.long 0x0, 0x0, 0x0, 0x0, 0x0, 0x0, 0x0, 0x0
.long 0x0, 0x0, 0x0, 0x0, 0x0, 0x0, 0x0, 0x0
.long 0x0, 0x0, 0x0, 0x0, 0x0, 0x0, 0x0, 0x0
.long 0x0, 0x0, 0x0, 0x0, 0x0, 0x0, 0x0, 0x0
.long 0x0, 0x0, 0x0, 0x0, 0x0, 0x0, 0x0, 0x0
.long 0x0, 0x0, 0x0, 0x0, 0x0, 0x0, 0x0, 0x0
.long 0x0, 0x0, 0x0, 0x0, 0x0, 0x0, 0x0, 0x0
.section .rodata,"a"
.p2align 6
.amdhsa_kernel standalone__deep_cross_xdeepfm__recsys_kernel
  .amdhsa_next_free_vgpr 256
  .amdhsa_next_free_sgpr 102
  .amdhsa_accum_offset 256
  .amdhsa_group_segment_fixed_size 0
  .amdhsa_kernarg_size 88
  .amdhsa_user_sgpr_count 2
  .amdhsa_user_sgpr_kernarg_segment_ptr 1
  .amdhsa_system_sgpr_workgroup_id_x 1
  .amdhsa_float_denorm_mode_32 3
.end_amdhsa_kernel
```

```asm
; @launch grid=(256,1,1) block=(512,1,1) lds=163840
.amdgcn_target "amdgcn-amd-amdhsa--gfx950"
.text
.globl standalone__deep_cross_xdeepfm__recsys_kernel
.p2align 8
.type standalone__deep_cross_xdeepfm__recsys_kernel,@function
standalone__deep_cross_xdeepfm__recsys_kernel:
  s_cmp_ge_u32 s2, 256
  s_cbranch_scc1 L_end
  s_load_dwordx16 s[4:19], s[0:1], 0
  s_load_dwordx4 s[20:23], s[0:1], 64
  s_load_dwordx2 s[24:25], s[0:1], 80
  v_lshrrev_b32 v1, 6, v0
  s_getpc_b64 s[92:93]
L_pc:
  s_and_b32 s68, s2, 0xf8
  v_add_u32 v2, s68, v1
  v_and_b32_e64 v3, 32, v0
  v_lshl_add_u32 v2, v3, 3, v2
  v_lshlrev_b32 v2, 7, v2
  v_min_u32 v2, L_end-L_pc, v2
  v_mov_b32 v3, s93
  v_add_co_u32 v2, vcc, s92, v2
  s_nop 1
  v_addc_co_u32 v3, vcc, 0, v3, vcc
  global_load_dword v251, v[2:3], off
  v_and_b32 v0, 63, v0
  v_readfirstlane_b32 s3, v1
  s_and_b32 s68, s2, 7
  s_lshr_b32 s69, s2, 3
  s_xor_b32 s69, s69, 31
  s_and_b32 s80, s2, 0xf8
  s_add_u32 s80, s80, s3
  s_lshl_b32 s80, s80, 0
  s_min_u32 s70, s68, 1
  s_add_u32 s71, s69, s70
  s_cmp_ge_u32 s71, 22
  s_cbranch_scc1 L_cin
  s_mul_i32 s68, s68, 21
  s_add_u32 s68, s68, s71
  s_mul_i32 s26, s68, 5042
  s_lshr_b32 s26, s26, 16
  s_mul_i32 s69, s26, 13
  s_sub_u32 s27, s68, s69
  s_lshl_b32 s77, s27, 8
  s_mul_i32 s71, s26, 320
  v_lshrrev_b32 v116, 4, v0
  v_lshlrev_b32 v11, 4, v0
  s_and_b32 s79, s3, 3
  s_cmp_lt_u32 s3, 4
  s_cbranch_scc1 L_cmp
  s_lshr_b32 s68, s79, 1
  s_mul_i32 s68, s68, 20
  s_and_b32 s69, s79, 1
  s_add_u32 s68, s68, s69
  s_lshl_b32 s76, s68, 10
  s_mul_i32 s78, s71, 104
  s_mul_i32 s68, s68, 832
  s_add_u32 s94, s78, s68
  v_mul_u32_u24 v118, 48, v116
  v_sub_u32 v12, v11, v118
  s_add_u32 s95, s94, 3328
  s_add_u32 s96, s94, 6656
  s_add_u32 s97, s94, 9984
  s_add_u32 s98, s94, 13312
  s_and_b32 s70, s79, 1
  s_lshl_b32 s70, s70, 3
  v_lshlrev_b32 v117, 1, v116
  v_or_b32 v117, s70, v117
  v_xor_b32 v117, v117, v0
  v_and_b32_e64 v117, 15, v117
  v_mul_u32_u24 v4, 3328, v116
  v_lshl_add_u32 v4, v117, 4, v4
  v_add_u32 v5, 13312, v4
  s_mul_i32 s74, s79, 26624
  s_add_u32 s74, s74, s77
  s_lshl_b32 s75, s79, 11
  s_waitcnt lgkmcnt(0)
  s_mov_b32 s28, s4
  s_and_b32 s29, s5, 0xffff
  s_mov_b32 s30, 425984
  s_mov_b32 s31, 0x20000
  buffer_load_dwordx4 v[16:19], v12, s[28:31], s94 offen offset:0
  s_mov_b32 s32, s6
  s_and_b32 s33, s7, 0xffff
  s_mov_b32 s34, 12800000
  s_mov_b32 s35, 0x20000
  s_mov_b32 s44, s12
  s_and_b32 s45, s13, 0xffff
  s_mov_b32 s46, 5537792
  s_mov_b32 s47, 0x20000
  s_add_u32 m0, s75, 131072
  s_nop 0
  buffer_load_dwordx4 v4, s[44:47], s74 offen lds
  s_add_u32 m0, s75, 132096
  s_nop 0
  buffer_load_dwordx4 v5, s[44:47], s74 offen lds
  s_add_u32 s74, s74, 106496
  s_add_u32 m0, s75, 139264
  s_nop 0
  buffer_load_dwordx4 v4, s[44:47], s74 offen lds
  s_add_u32 m0, s75, 140288
  s_nop 0
  buffer_load_dwordx4 v5, s[44:47], s74 offen lds
  s_add_u32 s74, s74, 106496
  buffer_load_dwordx4 v[20:23], v12, s[28:31], s94 offen offset:1664
  buffer_load_dwordx4 v[24:27], v12, s[28:31], s95 offen offset:0
  buffer_load_dwordx4 v[28:31], v12, s[28:31], s95 offen offset:1664
  buffer_load_dwordx4 v[32:35], v12, s[28:31], s96 offen offset:0
  buffer_load_dwordx4 v[36:39], v12, s[28:31], s96 offen offset:1664
  buffer_load_dwordx4 v[40:43], v12, s[28:31], s97 offen offset:0
  buffer_load_dwordx4 v[44:47], v12, s[28:31], s97 offen offset:1664
  buffer_load_dwordx4 v[48:51], v12, s[28:31], s98 offen offset:0
  buffer_load_dwordx4 v[52:55], v12, s[28:31], s98 offen offset:1664
  s_lshl_b32 s70, s69, 6
  v_and_b32 v118, 7, v0
  v_xor_b32 v118, v118, v116
  v_lshlrev_b32 v118, 4, v118
  v_xor_b32 v2, s70, v118
  v_xor_b32 v3, 64, v2
  s_mov_b32 s72, 0
  s_mul_i32 s70, s79, 13
  s_add_u32 s70, s70, s27
  s_min_u32 s70, s70, 39
  s_lshl_b32 s70, s70, 3
  s_add_u32 s70, s70, s71
  s_mul_i32 s84, s70, 104
  v_lshrrev_b32 v118, 2, v0
  v_min_u32 v118, 7, v118
  v_mul_u32_u24 v118, 104, v118
  v_and_b32 v117, 3, v0
  v_lshl_add_u32 v7, v117, 2, v118
  s_lshl_b32 s70, s26, 2
  s_add_u32 s70, s70, s79
  s_add_u32 s70, s70, 256
  s_mul_i32 s85, s70, 3328
  s_add_u32 s85, s85, s77
  s_mov_b32 s70, 173056
  v_lshrrev_b32 v118, 1, v0
  v_mul_lo_u32 v118, s70, v118
  v_and_b32 v117, 1, v0
  v_lshl_add_u32 v84, v117, 7, v118
  s_mov_b32 s52, s16
  s_and_b32 s53, s17, 0xffff
  s_mov_b32 s54, 3328
  s_mov_b32 s55, 0x20000
  s_mul_i32 s70, s79, 2560
  s_add_u32 s70, s70, L_tail-L_pc
  v_lshlrev_b32 v8, 7, v0
  v_add_u32 v8, s70, v8
  v_mov_b32 v9, s93
  v_add_co_u32 v8, vcc, s92, v8
  s_nop 1
  v_addc_co_u32 v9, vcc, 0, v9, vcc
  s_waitcnt vmcnt(13)
  v_lshlrev_b32 v16, 7, v16
  v_lshlrev_b32 v18, 7, v18
  v_lshlrev_b32 v17, 7, v17
  v_lshlrev_b32_e64 v19, 7, v19
  v_add_u32_dpp v56, v16, v2 row_newbcast:0 row_mask:0xf bank_mask:0x3
  s_nop 1
  v_add_u32_dpp v56, v18, v2 row_newbcast:6 row_mask:0xf bank_mask:0xc
  s_add_u32 m0, s76, 0
  s_nop 0
  buffer_load_dwordx4 v56, s[32:35], 0 offen lds
  s_waitcnt vmcnt(10)
  s_barrier
  s_waitcnt vmcnt(9)
  v_lshlrev_b32 v20, 7, v20
  v_lshlrev_b32 v22, 7, v22
  v_lshlrev_b32 v21, 7, v21
  v_lshlrev_b32 v23, 7, v23
  v_add_u32_dpp v57, v20, v2 row_newbcast:0 row_mask:0xf bank_mask:0x3
  s_nop 1
  v_add_u32_dpp v57, v22, v2 row_newbcast:6 row_mask:0xf bank_mask:0xc
  s_add_u32 m0, s76, 2048
  s_nop 0
  buffer_load_dwordx4 v57, s[32:35], 0 offen lds
  s_waitcnt vmcnt(9)
  v_lshlrev_b32 v24, 7, v24
  v_lshlrev_b32 v26, 7, v26
  v_lshlrev_b32 v25, 7, v25
  v_lshlrev_b32 v27, 7, v27
  v_add_u32_dpp v58, v24, v2 row_newbcast:0 row_mask:0xf bank_mask:0x3
  s_nop 1
  v_add_u32_dpp v58, v26, v2 row_newbcast:6 row_mask:0xf bank_mask:0xc
  s_add_u32 m0, s76, 4096
  s_nop 0
  buffer_load_dwordx4 v58, s[32:35], 0 offen lds
  s_waitcnt vmcnt(9)
  v_lshlrev_b32 v28, 7, v28
  v_lshlrev_b32 v30, 7, v30
  v_lshlrev_b32 v29, 7, v29
  v_lshlrev_b32_e64 v31, 7, v31
  v_add_u32_dpp v59, v28, v2 row_newbcast:0 row_mask:0xf bank_mask:0x3
  s_nop 1
  v_add_u32_dpp v59, v30, v2 row_newbcast:6 row_mask:0xf bank_mask:0xc
  s_add_u32 m0, s76, 6144
  s_nop 0
  buffer_load_dwordx4 v59, s[32:35], 0 offen lds
  s_waitcnt vmcnt(9)
  v_lshlrev_b32 v32, 7, v32
  v_lshlrev_b32 v34, 7, v34
  v_lshlrev_b32 v33, 7, v33
  v_lshlrev_b32_e64 v35, 7, v35
  v_add_u32_dpp v60, v32, v2 row_newbcast:0 row_mask:0xf bank_mask:0x3
  s_nop 1
  v_add_u32_dpp v60, v34, v2 row_newbcast:6 row_mask:0xf bank_mask:0xc
  s_add_u32 m0, s76, 8192
  s_nop 0
  buffer_load_dwordx4 v60, s[32:35], 0 offen lds
  s_waitcnt vmcnt(9)
  v_lshlrev_b32 v36, 7, v36
  v_lshlrev_b32 v38, 7, v38
  v_lshlrev_b32 v37, 7, v37
  v_lshlrev_b32_e64 v39, 7, v39
  v_add_u32_dpp v61, v36, v2 row_newbcast:0 row_mask:0xf bank_mask:0x3
  s_nop 1
  v_add_u32_dpp v61, v38, v2 row_newbcast:6 row_mask:0xf bank_mask:0xc
  s_add_u32 m0, s76, 10240
  s_nop 0
  buffer_load_dwordx4 v61, s[32:35], 0 offen lds
  s_waitcnt vmcnt(9)
  v_lshlrev_b32 v40, 7, v40
  v_lshlrev_b32 v42, 7, v42
  v_lshlrev_b32 v41, 7, v41
  v_lshlrev_b32_e64 v43, 7, v43
  v_add_u32_dpp v62, v40, v2 row_newbcast:0 row_mask:0xf bank_mask:0x3
  s_nop 1
  v_add_u32_dpp v62, v42, v2 row_newbcast:6 row_mask:0xf bank_mask:0xc
  s_add_u32 m0, s76, 12288
  s_nop 0
  buffer_load_dwordx4 v62, s[32:35], 0 offen lds
  s_waitcnt vmcnt(9)
  v_lshlrev_b32 v44, 7, v44
  v_lshlrev_b32 v46, 7, v46
  v_lshlrev_b32 v45, 7, v45
  v_lshlrev_b32_e64 v47, 7, v47
  v_add_u32_dpp v63, v44, v2 row_newbcast:0 row_mask:0xf bank_mask:0x3
  s_nop 1
  v_add_u32_dpp v63, v46, v2 row_newbcast:6 row_mask:0xf bank_mask:0xc
  s_add_u32 m0, s76, 14336
  s_nop 0
  buffer_load_dwordx4 v63, s[32:35], 0 offen lds
  s_waitcnt vmcnt(9)
  v_lshlrev_b32 v48, 7, v48
  v_lshlrev_b32 v50, 7, v50
  v_lshlrev_b32 v49, 7, v49
  v_lshlrev_b32_e64 v51, 7, v51
  v_add_u32_dpp v64, v48, v2 row_newbcast:0 row_mask:0xf bank_mask:0x3
  s_nop 1
  v_add_u32_dpp v64, v50, v2 row_newbcast:6 row_mask:0xf bank_mask:0xc
  s_add_u32 m0, s76, 16384
  s_nop 0
  buffer_load_dwordx4 v64, s[32:35], 0 offen lds
  s_waitcnt vmcnt(9)
  v_lshlrev_b32 v52, 7, v52
  v_lshlrev_b32 v54, 7, v54
  v_lshlrev_b32 v53, 7, v53
  v_lshlrev_b32_e64 v55, 7, v55
  v_add_u32_dpp v65, v52, v2 row_newbcast:0 row_mask:0xf bank_mask:0x3
  s_nop 1
  v_add_u32_dpp v65, v54, v2 row_newbcast:6 row_mask:0xf bank_mask:0xc
  s_add_u32 m0, s76, 18432
  s_nop 0
  buffer_load_dwordx4 v65, s[32:35], 0 offen lds
  v_add_u32_dpp v56, v17, v2 row_newbcast:0 row_mask:0xf bank_mask:0x3
  s_nop 1
  v_add_u32_dpp v56, v19, v2 row_newbcast:6 row_mask:0xf bank_mask:0xc
  s_add_u32 m0, s76, 40960
  s_nop 0
  buffer_load_dwordx4 v56, s[32:35], 0 offen lds
  v_add_u32_dpp v57, v21, v2 row_newbcast:0 row_mask:0xf bank_mask:0x3
  s_nop 1
  v_add_u32_dpp v57, v23, v2 row_newbcast:6 row_mask:0xf bank_mask:0xc
  s_add_u32 m0, s76, 43008
  s_nop 0
  buffer_load_dwordx4 v57, s[32:35], 0 offen lds
  v_add_u32_dpp v58, v25, v2 row_newbcast:0 row_mask:0xf bank_mask:0x3
  s_nop 1
  v_add_u32_dpp v58, v27, v2 row_newbcast:6 row_mask:0xf bank_mask:0xc
  s_add_u32 m0, s76, 45056
  s_nop 0
  buffer_load_dwordx4 v58, s[32:35], 0 offen lds
  v_add_u32_dpp v59, v29, v2 row_newbcast:0 row_mask:0xf bank_mask:0x3
  s_nop 1
  v_add_u32_dpp v59, v31, v2 row_newbcast:6 row_mask:0xf bank_mask:0xc
  s_add_u32 m0, s76, 47104
  s_nop 0
  buffer_load_dwordx4 v59, s[32:35], 0 offen lds
  v_add_u32_dpp v60, v33, v2 row_newbcast:0 row_mask:0xf bank_mask:0x3
  s_nop 1
  v_add_u32_dpp v60, v35, v2 row_newbcast:6 row_mask:0xf bank_mask:0xc
  s_add_u32 m0, s76, 49152
  s_nop 0
  buffer_load_dwordx4 v60, s[32:35], 0 offen lds
  s_waitcnt vmcnt(11)
  s_barrier
  v_add_u32_dpp v61, v37, v2 row_newbcast:0 row_mask:0xf bank_mask:0x3
  s_nop 1
  v_add_u32_dpp v61, v39, v2 row_newbcast:6 row_mask:0xf bank_mask:0xc
  s_add_u32 m0, s76, 51200
  s_nop 0
  buffer_load_dwordx4 v61, s[32:35], 0 offen lds
  v_add_u32_dpp v62, v41, v2 row_newbcast:0 row_mask:0xf bank_mask:0x3
  s_nop 1
  v_add_u32_dpp v62, v43, v2 row_newbcast:6 row_mask:0xf bank_mask:0xc
  s_add_u32 m0, s76, 53248
  s_nop 0
  buffer_load_dwordx4 v62, s[32:35], 0 offen lds
  v_add_u32_dpp v63, v45, v2 row_newbcast:0 row_mask:0xf bank_mask:0x3
  s_nop 1
  v_add_u32_dpp v63, v47, v2 row_newbcast:6 row_mask:0xf bank_mask:0xc
  s_add_u32 m0, s76, 55296
  s_nop 0
  buffer_load_dwordx4 v63, s[32:35], 0 offen lds
  v_add_u32_dpp v64, v49, v2 row_newbcast:0 row_mask:0xf bank_mask:0x3
  s_nop 1
  v_add_u32_dpp v64, v51, v2 row_newbcast:6 row_mask:0xf bank_mask:0xc
  s_add_u32 m0, s76, 57344
  s_nop 0
  buffer_load_dwordx4 v64, s[32:35], 0 offen lds
  v_add_u32_dpp v65, v53, v2 row_newbcast:0 row_mask:0xf bank_mask:0x3
  s_nop 1
  v_add_u32_dpp v65, v55, v2 row_newbcast:6 row_mask:0xf bank_mask:0xc
  s_add_u32 m0, s76, 59392
  s_nop 0
  buffer_load_dwordx4 v65, s[32:35], 0 offen lds
  s_waitcnt vmcnt(10)
  s_barrier
  s_add_u32 m0, s75, 147456
  s_nop 0
  buffer_load_dwordx4 v4, s[44:47], s74 offen lds
  s_add_u32 m0, s75, 148480
  s_nop 0
  buffer_load_dwordx4 v5, s[44:47], s74 offen lds
  s_add_u32 s74, s74, 106496
  s_add_u32 m0, s75, 155648
  s_nop 0
  buffer_load_dwordx4 v4, s[44:47], s74 offen lds
  s_add_u32 m0, s75, 156672
  s_nop 0
  buffer_load_dwordx4 v5, s[44:47], s74 offen lds
  s_add_u32 s74, s74, 106496
  v_add_u32_dpp v56, v18, v2 row_newbcast:0 row_mask:0xf bank_mask:0x3
  v_add_u32_dpp v57, v22, v2 row_newbcast:0 row_mask:0xf bank_mask:0x3
  v_add_u32_dpp v58, v26, v2 row_newbcast:0 row_mask:0xf bank_mask:0x3
  v_add_u32_dpp v59, v30, v2 row_newbcast:0 row_mask:0xf bank_mask:0x3
  v_add_u32_dpp v60, v34, v2 row_newbcast:0 row_mask:0xf bank_mask:0x3
  v_add_u32_dpp v61, v38, v2 row_newbcast:0 row_mask:0xf bank_mask:0x3
  v_add_u32_dpp v62, v42, v2 row_newbcast:0 row_mask:0xf bank_mask:0x3
  v_add_u32_dpp v63, v46, v2 row_newbcast:0 row_mask:0xf bank_mask:0x3
  v_add_u32_dpp v64, v50, v2 row_newbcast:0 row_mask:0xf bank_mask:0x3
  v_add_u32_dpp v65, v54, v2 row_newbcast:0 row_mask:0xf bank_mask:0x3
  v_add_u32_dpp v56, v16, v2 row_newbcast:7 row_mask:0xf bank_mask:0xc
  v_add_u32_dpp v57, v20, v2 row_newbcast:7 row_mask:0xf bank_mask:0xc
  v_add_u32_dpp v58, v24, v2 row_newbcast:7 row_mask:0xf bank_mask:0xc
  v_add_u32_dpp v59, v28, v2 row_newbcast:7 row_mask:0xf bank_mask:0xc
  v_add_u32_dpp v60, v32, v2 row_newbcast:7 row_mask:0xf bank_mask:0xc
  v_add_u32_dpp v61, v36, v2 row_newbcast:7 row_mask:0xf bank_mask:0xc
  v_add_u32_dpp v62, v40, v2 row_newbcast:7 row_mask:0xf bank_mask:0xc
  v_add_u32_dpp v63, v44, v2 row_newbcast:7 row_mask:0xf bank_mask:0xc
  v_add_u32_dpp v64, v48, v2 row_newbcast:7 row_mask:0xf bank_mask:0xc
  v_add_u32_dpp v65, v52, v2 row_newbcast:7 row_mask:0xf bank_mask:0xc
  buffer_load_dword v70, v7, s[28:31], s84 offen offset:24
  buffer_load_dword v71, v7, s[28:31], s84 offen offset:40
  buffer_load_dword v72, v7, s[28:31], s84 offen offset:56
  buffer_load_dword v73, v7, s[28:31], s84 offen offset:72
  buffer_load_dword v74, v7, s[28:31], s84 offen offset:88
  s_add_u32 m0, s76, 81920
  s_nop 0
  buffer_load_dwordx4 v56, s[32:35], 0 offen lds
  s_add_u32 m0, s76, 83968
  s_nop 0
  buffer_load_dwordx4 v57, s[32:35], 0 offen lds
  s_add_u32 m0, s76, 86016
  s_nop 0
  buffer_load_dwordx4 v58, s[32:35], 0 offen lds
  s_add_u32 m0, s76, 88064
  s_nop 0
  buffer_load_dwordx4 v59, s[32:35], 0 offen lds
  s_add_u32 m0, s76, 90112
  s_nop 0
  buffer_load_dwordx4 v60, s[32:35], 0 offen lds
  s_add_u32 m0, s76, 92160
  s_nop 0
  buffer_load_dwordx4 v61, s[32:35], 0 offen lds
  s_add_u32 m0, s76, 94208
  s_nop 0
  buffer_load_dwordx4 v62, s[32:35], 0 offen lds
  s_add_u32 m0, s76, 96256
  s_nop 0
  buffer_load_dwordx4 v63, s[32:35], 0 offen lds
  s_waitcnt vmcnt(13)
  s_barrier
  s_add_u32 m0, s76, 98304
  s_nop 0
  buffer_load_dwordx4 v64, s[32:35], 0 offen lds
  s_add_u32 m0, s76, 100352
  s_nop 0
  buffer_load_dwordx4 v65, s[32:35], 0 offen lds
  v_add_u32_dpp v56, v19, v2 row_newbcast:0 row_mask:0xf bank_mask:0x3
  v_add_u32_dpp v57, v23, v2 row_newbcast:0 row_mask:0xf bank_mask:0x3
  v_add_u32_dpp v58, v27, v2 row_newbcast:0 row_mask:0xf bank_mask:0x3
  v_add_u32_dpp v59, v31, v2 row_newbcast:0 row_mask:0xf bank_mask:0x3
  v_add_u32_dpp v60, v35, v2 row_newbcast:0 row_mask:0xf bank_mask:0x3
  v_add_u32_dpp v61, v39, v2 row_newbcast:0 row_mask:0xf bank_mask:0x3
  v_add_u32_dpp v62, v43, v2 row_newbcast:0 row_mask:0xf bank_mask:0x3
  v_add_u32_dpp v63, v47, v2 row_newbcast:0 row_mask:0xf bank_mask:0x3
  v_add_u32_dpp v64, v51, v2 row_newbcast:0 row_mask:0xf bank_mask:0x3
  v_add_u32_dpp v65, v55, v2 row_newbcast:0 row_mask:0xf bank_mask:0x3
  v_add_u32_dpp v56, v17, v2 row_newbcast:7 row_mask:0xf bank_mask:0xc
  v_add_u32_dpp v57, v21, v2 row_newbcast:7 row_mask:0xf bank_mask:0xc
  v_add_u32_dpp v58, v25, v2 row_newbcast:7 row_mask:0xf bank_mask:0xc
  v_add_u32_dpp v59, v29, v2 row_newbcast:7 row_mask:0xf bank_mask:0xc
  v_add_u32_dpp v60, v33, v2 row_newbcast:7 row_mask:0xf bank_mask:0xc
  v_add_u32_dpp v61, v37, v2 row_newbcast:7 row_mask:0xf bank_mask:0xc
  v_add_u32_dpp v62, v41, v2 row_newbcast:7 row_mask:0xf bank_mask:0xc
  v_add_u32_dpp v63, v45, v2 row_newbcast:7 row_mask:0xf bank_mask:0xc
  v_add_u32_dpp v64, v49, v2 row_newbcast:7 row_mask:0xf bank_mask:0xc
  v_add_u32_dpp v65, v53, v2 row_newbcast:7 row_mask:0xf bank_mask:0xc
  s_setprio 0
  s_branch L_ld_in
L_cmp:
  s_mul_i32 s70, s3, 13
  v_min_u32 v118, 12, v0
  v_add_u32 v118, s70, v118
  v_lshrrev_b32 v117, 1, v118
  v_mul_u32_u24 v117, 96, v117
  v_lshl_add_u32 v118, v118, 2, v117
  s_mul_i32 s78, s27, 25
  s_min_u32 s78, s78, 294
  s_add_u32 s78, s78, s71
  s_mul_i32 s78, s78, 104
  s_waitcnt lgkmcnt(0)
  s_mov_b32 s28, s4
  s_and_b32 s29, s5, 0xffff
  s_mov_b32 s30, 425984
  s_mov_b32 s31, 0x20000
  buffer_load_dwordx4 v[100:103], v118, s[28:31], s78 offen
  buffer_load_dwordx4 v[104:107], v118, s[28:31], s78 offen offset:16
  s_mov_b32 s32, s6
  s_and_b32 s33, s7, 0xffff
  s_mov_b32 s34, 12800000
  s_mov_b32 s35, 0x20000
  s_mov_b32 s48, s14
  s_and_b32 s49, s15, 0xffff
  s_mov_b32 s50, 3328
  s_mov_b32 s51, 0x20000
  s_mov_b32 m0, 122880
  s_mov_b64 exec, 0xffff
  buffer_load_dwordx4 v11, s[48:51], s77 offen lds
  s_mov_b64 exec, -1
  s_mov_b32 s44, s12
  s_and_b32 s45, s13, 0xffff
  s_mov_b32 s46, 5537792
  s_mov_b32 s47, 0x20000
  s_lshl_b32 s70, s26, 2
  s_add_u32 s70, s70, s3
  s_add_u32 s70, s70, 64
  s_mul_i32 s70, s70, 3328
  s_add_u32 s70, s70, s77
  s_mov_b32 s81, 173056
  v_lshrrev_b32 v118, 1, v0
  v_mul_lo_u32 v118, s81, v118
  v_and_b32 v117, 1, v0
  v_lshl_add_u32 v118, v117, 7, v118
  v_add_u32_e64 v112, s70, v118
  s_mov_b64 exec, 255
  s_waitcnt vmcnt(3)
  buffer_load_dword v251, v112, s[44:47], 0 offen
  s_mov_b64 exec, -1
  s_and_b32 s68, s3, 1
  s_lshr_b32 s69, s3, 1
  v_bfe_u32 v117, v0, 2, 2
  v_lshl_add_u32 v118, v116, 3, v117
  v_lshlrev_b32 v118, 8, v118
  v_bfe_u32 v117, v0, 2, 3
  s_lshl_b32 s70, s69, 2
  v_xor_b32 v117, s70, v117
  v_lshl_add_u32 v118, v117, 5, v118
  v_and_b32 v117, 3, v0
  v_lshl_add_u32 v118, v117, 3, v118
  v_add_u32 v1, 131072, v118
  v_xor_b32 v2, 32, v1
  v_xor_b32 v3, 64, v1
  v_xor_b32 v4, 96, v1
  s_lshl_b32 s70, s69, 7
  s_add_u32 s70, s70, 122880
  v_lshlrev_b32 v118, 3, v116
  v_add_u32 v9, s70, v118
  v_and_b32 v118, 15, v0
  v_lshlrev_b32 v118, 7, v118
  v_bfe_u32 v117, v0, 1, 3
  v_xor_b32 v117, v117, v116
  v_lshl_add_u32 v118, v117, 4, v118
  s_mul_i32 s70, s68, 20480
  v_add_u32 v5, s70, v118
  v_xor_b32 v7, 64, v5
  v_add_u32 v6, 81920, v5
  v_add_u32 v8, 81920, v7
  s_mul_i32 s70, s3, 640
  s_add_u32 s70, s70, 123392
  v_and_b32 v118, 15, v0
  v_lshlrev_b32 v118, 2, v118
  v_add_u32 v118, s70, v118
  v_lshrrev_b32 v117, 5, v0
  v_lshl_add_u32 v118, v117, 6, v118
  v_bfe_u32 v117, v0, 4, 1
  v_lshl_add_u32 v10, v117, 7, v118
  s_mov_b32 s72, 0
  v_mov_b32 v12, 0xc0135761
  v_mov_b32 v13, 0xc0135761
  v_mov_b32 v14, 0xbdd2d3e8
  v_mov_b32 v15, 0xbdd2d3e8
  s_waitcnt vmcnt(3)
  v_lshlrev_b32 v100, 7, v100
  buffer_load_dword v200, v100, s[32:35], 0 offen
  v_lshlrev_b32 v102, 7, v102
  buffer_load_dword v202, v102, s[32:35], 0 offen
  s_waitcnt vmcnt(4)
  v_lshlrev_b32_e64 v104, 7, v104
  buffer_load_dword v204, v104, s[32:35], 0 offen
  s_barrier
  ds_read_b64_tr_b16 v[16:17], v1 offset:0
  ds_read_b64_tr_b16 v[18:19], v1 offset:1024
  ds_read_b64_tr_b16 v[32:33], v1 offset:8192
  ds_read_b64_tr_b16 v[34:35], v1 offset:9216
  ds_read_b64_tr_b16 v[20:21], v2 offset:0
  ds_read_b64_tr_b16 v[22:23], v2 offset:1024
  ds_read_b64_tr_b16 v[36:37], v2 offset:8192
  ds_read_b64_tr_b16 v[38:39], v2 offset:9216
  ds_read_b64_tr_b16 v[24:25], v3 offset:0
  ds_read_b64_tr_b16 v[26:27], v3 offset:1024
  ds_read_b64_tr_b16 v[40:41], v3 offset:8192
  ds_read_b64_tr_b16 v[42:43], v3 offset:9216
  ds_read_b64_tr_b16 v[28:29], v4 offset:0
  ds_read_b64_tr_b16 v[30:31], v4 offset:1024
  ds_read_b64_tr_b16 v[44:45], v4 offset:8192
  ds_read_b64_tr_b16 v[46:47], v4 offset:9216
  s_waitcnt vmcnt(4)
  ds_read_b64 v[234:235], v9 offset:0
  ds_read_b64 v[238:239], v9 offset:32
  ds_read_b64 v[242:243], v9 offset:64
  ds_read_b64 v[246:247], v9 offset:96
  s_waitcnt lgkmcnt(3)
  v_lshlrev_b32 v232, 16, v234
  v_and_b32 v233, 0xffff0000, v234
  v_lshlrev_b32 v234, 16, v235
  v_and_b32 v235, 0xffff0000, v235
  s_waitcnt lgkmcnt(2)
  v_lshlrev_b32 v236, 16, v238
  v_and_b32 v237, 0xffff0000, v238
  v_lshlrev_b32 v238, 16, v239
  v_and_b32 v239, 0xffff0000, v239
  s_waitcnt lgkmcnt(1)
  v_lshlrev_b32 v240, 16, v242
  v_and_b32 v241, 0xffff0000, v242
  v_lshlrev_b32 v242, 16, v243
  v_and_b32 v243, 0xffff0000, v243
  s_waitcnt lgkmcnt(0)
  v_lshlrev_b32 v244, 16, v246
  v_and_b32 v245, 0xffff0000, v246
  v_lshlrev_b32_e64 v246, 16, v247
  v_and_b32 v247, 0xffff0000, v247
  v_mov_b64 v[216:217], v[232:233]
  v_mov_b64 v[218:219], v[234:235]
  v_mov_b64 v[220:221], v[236:237]
  v_mov_b64 v[222:223], v[238:239]
  v_mov_b64 v[224:225], v[240:241]
  v_mov_b64 v[226:227], v[242:243]
  v_mov_b64 v[228:229], v[244:245]
  v_mov_b64 v[230:231], v[246:247]
  s_waitcnt lgkmcnt(0)
  s_setprio 1
  s_barrier
  ds_read_b128 v[48:51], v5 offset:0
  ds_read_b128 v[52:55], v7 offset:0
  ds_read_b128 v[56:59], v5 offset:2048
  ds_read_b128 v[60:63], v7 offset:2048
  ds_read_b128 v[64:67], v5 offset:4096
  ds_read_b128 v[68:71], v7 offset:4096
  ds_read_b128 v[72:75], v5 offset:6144
  ds_read_b128 v[76:79], v7 offset:6144
  s_waitcnt lgkmcnt(7)
  v_mfma_f32_16x16x32_bf16 v[88:91], v[16:19], v[48:51], v[232:235]
  s_waitcnt lgkmcnt(4)
  v_mfma_f32_16x16x32_bf16 v[88:91], v[32:35], v[52:55], v[88:91]
  v_mfma_f32_16x16x32_bf16 v[104:107], v[32:35], v[60:63], v[232:235]
  v_mfma_f32_16x16x32_bf16 v[104:107], v[16:19], v[56:59], v[104:107]
  v_mfma_f32_16x16x32_bf16 v[108:111], v[20:23], v[56:59], v[236:239]
  v_mfma_f32_16x16x32_bf16 v[108:111], v[36:39], v[60:63], v[108:111]
  v_mfma_f32_16x16x32_bf16 v[92:95], v[36:39], v[52:55], v[236:239]
  v_mfma_f32_16x16x32_bf16 v[92:95], v[20:23], v[48:51], v[92:95]
  s_nop 0
  v_mfma_f32_16x16x32_bf16 v[96:99], v[24:27], v[48:51], v[240:243]
  v_xor_b32 v1, 16384, v1
  v_mfma_f32_16x16x32_bf16 v[96:99], v[40:43], v[52:55], v[96:99]
  v_xor_b32 v2, 16384, v2
  v_mfma_f32_16x16x32_bf16 v[112:115], v[40:43], v[60:63], v[240:243]
  v_xor_b32 v3, 16384, v3
  v_mfma_f32_16x16x32_bf16 v[112:115], v[24:27], v[56:59], v[112:115]
  v_xor_b32 v4, 16384, v4
  v_mfma_f32_16x16x32_bf16 v[116:119], v[28:31], v[56:59], v[244:247]
  v_mfma_f32_16x16x32_bf16 v[116:119], v[44:47], v[60:63], v[116:119]
  v_mfma_f32_16x16x32_bf16 v[100:103], v[44:47], v[52:55], v[244:247]
  s_waitcnt lgkmcnt(2)
  v_mfma_f32_16x16x32_bf16 v[100:103], v[28:31], v[48:51], v[100:103]
  v_mfma_f32_16x16x32_bf16 v[120:123], v[16:19], v[64:67], v[232:235]
  s_barrier
  s_waitcnt lgkmcnt(0)
  v_mfma_f32_16x16x32_bf16 v[120:123], v[32:35], v[68:71], v[120:123]
  s_nop 0
  ds_read_b128 v[80:83], v5 offset:8192
  v_mfma_f32_16x16x32_bf16 v[136:139], v[32:35], v[76:79], v[232:235]
  ds_read_b128 v[84:87], v7 offset:8192
  v_mfma_f32_16x16x32_bf16 v[136:139], v[16:19], v[72:75], v[136:139]
  ds_read_b128 v[48:51], v5 offset:10240
  v_mfma_f32_16x16x32_bf16 v[140:143], v[20:23], v[72:75], v[236:239]
  ds_read_b128 v[52:55], v7 offset:10240
  v_mfma_f32_16x16x32_bf16 v[140:143], v[36:39], v[76:79], v[140:143]
  ds_read_b128 v[56:59], v5 offset:12288
  v_mfma_f32_16x16x32_bf16 v[124:127], v[36:39], v[68:71], v[236:239]
  ds_read_b128 v[60:63], v7 offset:12288
  v_mfma_f32_16x16x32_bf16 v[124:127], v[20:23], v[64:67], v[124:127]
  v_mfma_f32_16x16x32_bf16 v[128:131], v[24:27], v[64:67], v[240:243]
  v_mfma_f32_16x16x32_bf16 v[128:131], v[40:43], v[68:71], v[128:131]
  v_mfma_f32_16x16x32_bf16 v[144:147], v[40:43], v[76:79], v[240:243]
  v_mfma_f32_16x16x32_bf16 v[144:147], v[24:27], v[72:75], v[144:147]
  v_mfma_f32_16x16x32_bf16 v[148:151], v[28:31], v[72:75], v[244:247]
  ds_read_b128 v[72:75], v5 offset:16384
  v_mfma_f32_16x16x32_bf16 v[148:151], v[44:47], v[76:79], v[148:151]
  ds_read_b128 v[76:79], v7 offset:16384
  v_mfma_f32_16x16x32_bf16 v[132:135], v[44:47], v[68:71], v[244:247]
  ds_read_b128 v[68:71], v7 offset:14336
  s_waitcnt lgkmcnt(7)
  v_mfma_f32_16x16x32_bf16 v[132:135], v[28:31], v[64:67], v[132:135]
  s_nop 0
  ds_read_b128 v[64:67], v5 offset:14336
  v_mfma_f32_16x16x32_bf16 v[152:155], v[16:19], v[80:83], v[232:235]
  s_waitcnt lgkmcnt(6)
  v_mfma_f32_16x16x32_bf16 v[152:155], v[32:35], v[84:87], v[152:155]
  v_mfma_f32_16x16x32_bf16 v[168:171], v[32:35], v[52:55], v[232:235]
  v_mfma_f32_16x16x32_bf16 v[168:171], v[16:19], v[48:51], v[168:171]
  v_mfma_f32_16x16x32_bf16 v[172:175], v[20:23], v[48:51], v[236:239]
  v_mfma_f32_16x16x32_bf16 v[172:175], v[36:39], v[52:55], v[172:175]
  s_nop 0
  v_mfma_f32_16x16x32_bf16 v[156:159], v[36:39], v[84:87], v[236:239]
  v_mfma_f32_16x16x32_bf16 v[156:159], v[20:23], v[80:83], v[156:159]
  v_mfma_f32_16x16x32_bf16 v[160:163], v[24:27], v[80:83], v[240:243]
  v_mfma_f32_16x16x32_bf16 v[160:163], v[40:43], v[84:87], v[160:163]
  v_mfma_f32_16x16x32_bf16 v[176:179], v[40:43], v[52:55], v[240:243]
  v_mfma_f32_16x16x32_bf16 v[176:179], v[24:27], v[48:51], v[176:179]
  v_mfma_f32_16x16x32_bf16 v[180:183], v[28:31], v[48:51], v[244:247]
  v_mfma_f32_16x16x32_bf16 v[180:183], v[44:47], v[52:55], v[180:183]
  v_mfma_f32_16x16x32_bf16 v[164:167], v[44:47], v[84:87], v[244:247]
  ds_read_b128 v[84:87], v7 offset:18432
  s_waitcnt lgkmcnt(5)
  v_mfma_f32_16x16x32_bf16 v[164:167], v[28:31], v[80:83], v[164:167]
  ds_read_b128 v[80:83], v5 offset:18432
  v_mfma_f32_16x16x32_bf16 v[184:187], v[16:19], v[56:59], v[232:235]
  s_waitcnt lgkmcnt(2)
  v_mfma_f32_16x16x32_bf16 v[184:187], v[32:35], v[60:63], v[184:187]
  s_nop 0
  s_waitcnt vmcnt(1)
  v_mfma_f32_16x16x32_bf16 v[200:203], v[32:35], v[68:71], v[232:235]
  v_mfma_f32_16x16x32_bf16 v[200:203], v[16:19], v[64:67], v[200:203]
  s_waitcnt vmcnt(0)
  v_mfma_f32_16x16x32_bf16 v[204:207], v[20:23], v[64:67], v[236:239]
  v_mfma_f32_16x16x32_bf16 v[204:207], v[36:39], v[68:71], v[204:207]
  s_waitcnt lgkmcnt(0)
  s_barrier
  v_mfma_f32_16x16x32_bf16 v[188:191], v[36:39], v[60:63], v[236:239]
  s_nop 0
  ds_read_b128 v[48:51], v5 offset:40960
  v_mfma_f32_16x16x32_bf16 v[188:191], v[20:23], v[56:59], v[188:191]
  ds_read_b128 v[52:55], v7 offset:40960
  v_mfma_f32_16x16x32_bf16 v[192:195], v[24:27], v[56:59], v[240:243]
  v_mfma_f32_16x16x32_bf16 v[192:195], v[40:43], v[60:63], v[192:195]
  v_mfma_f32_16x16x32_bf16 v[208:211], v[40:43], v[68:71], v[240:243]
  v_mfma_f32_16x16x32_bf16 v[208:211], v[24:27], v[64:67], v[208:211]
  v_mfma_f32_16x16x32_bf16 v[212:215], v[28:31], v[64:67], v[244:247]
  ds_read_b128 v[64:67], v5 offset:45056
  v_mfma_f32_16x16x32_bf16 v[212:215], v[44:47], v[68:71], v[212:215]
  ds_read_b128 v[68:71], v7 offset:45056
  v_mfma_f32_16x16x32_bf16 v[196:199], v[44:47], v[60:63], v[244:247]
  ds_read_b128 v[60:63], v7 offset:43008
  v_mfma_f32_16x16x32_bf16 v[196:199], v[28:31], v[56:59], v[196:199]
  ds_read_b128 v[56:59], v5 offset:43008
  v_mfma_f32_16x16x32_bf16 v[216:219], v[32:35], v[76:79], v[216:219]
  v_mfma_f32_16x16x32_bf16 v[216:219], v[16:19], v[72:75], v[216:219]
  v_mfma_f32_16x16x32_bf16 v[232:235], v[16:19], v[80:83], v[232:235]
  ds_read_b64_tr_b16 v[16:17], v1 offset:0
  v_mfma_f32_16x16x32_bf16 v[232:235], v[32:35], v[84:87], v[232:235]
  ds_read_b64_tr_b16 v[18:19], v1 offset:1024
  v_mfma_f32_16x16x32_bf16 v[236:239], v[36:39], v[84:87], v[236:239]
  ds_read_b64_tr_b16 v[32:33], v1 offset:8192
  v_mfma_f32_16x16x32_bf16 v[236:239], v[20:23], v[80:83], v[236:239]
  ds_read_b64_tr_b16 v[34:35], v1 offset:9216
  v_mfma_f32_16x16x32_bf16 v[220:223], v[20:23], v[72:75], v[220:223]
  ds_read_b64_tr_b16 v[20:21], v2 offset:0
  v_mfma_f32_16x16x32_bf16 v[220:223], v[36:39], v[76:79], v[220:223]
  ds_read_b64_tr_b16 v[22:23], v2 offset:1024
  v_mfma_f32_16x16x32_bf16 v[224:227], v[40:43], v[76:79], v[224:227]
  ds_read_b64_tr_b16 v[36:37], v2 offset:8192
  v_mfma_f32_16x16x32_bf16 v[224:227], v[24:27], v[72:75], v[224:227]
  ds_read_b64_tr_b16 v[38:39], v2 offset:9216
  v_mfma_f32_16x16x32_bf16 v[240:243], v[24:27], v[80:83], v[240:243]
  ds_read_b64_tr_b16 v[24:25], v3 offset:0
  v_mfma_f32_16x16x32_bf16 v[240:243], v[40:43], v[84:87], v[240:243]
  ds_read_b64_tr_b16 v[26:27], v3 offset:1024
  v_mfma_f32_16x16x32_bf16 v[244:247], v[44:47], v[84:87], v[244:247]
  ds_read_b64_tr_b16 v[40:41], v3 offset:8192
  v_mfma_f32_16x16x32_bf16 v[244:247], v[28:31], v[80:83], v[244:247]
  ds_read_b64_tr_b16 v[42:43], v3 offset:9216
  v_mfma_f32_16x16x32_bf16 v[228:231], v[28:31], v[72:75], v[228:231]
  ds_read_b64_tr_b16 v[28:29], v4 offset:0
  s_waitcnt lgkmcnt(9)
  v_mfma_f32_16x16x32_bf16 v[228:231], v[44:47], v[76:79], v[228:231]
  ds_read_b64_tr_b16 v[30:31], v4 offset:1024
L_dnn_loop0:
  v_mfma_f32_16x16x32_bf16 v[88:91], v[16:19], v[48:51], v[88:91]
  ds_read_b64_tr_b16 v[44:45], v4 offset:8192
  v_mfma_f32_16x16x32_bf16 v[88:91], v[32:35], v[52:55], v[88:91]
  s_nop 0
  ds_read_b64_tr_b16 v[46:47], v4 offset:9216
  v_mfma_f32_16x16x32_bf16 v[104:107], v[32:35], v[60:63], v[104:107]
  ds_read_b128 v[72:75], v5 offset:47104
  s_waitcnt lgkmcnt(9)
  v_mfma_f32_16x16x32_bf16 v[104:107], v[16:19], v[56:59], v[104:107]
  ds_read_b128 v[76:79], v7 offset:47104
  v_mfma_f32_16x16x32_bf16 v[108:111], v[20:23], v[56:59], v[108:111]
  s_nop 0
  ds_read_b128 v[80:83], v5 offset:49152
  v_mfma_f32_16x16x32_bf16 v[108:111], v[36:39], v[60:63], v[108:111]
  ds_read_b128 v[84:87], v7 offset:49152
  v_mfma_f32_16x16x32_bf16 v[92:95], v[36:39], v[52:55], v[92:95]
  s_waitcnt lgkmcnt(8)
  v_mfma_f32_16x16x32_bf16 v[92:95], v[20:23], v[48:51], v[92:95]
  v_mfma_f32_16x16x32_bf16 v[96:99], v[24:27], v[48:51], v[96:99]
  v_xor_b32 v1, 16384, v1
  v_mfma_f32_16x16x32_bf16 v[96:99], v[40:43], v[52:55], v[96:99]
  s_nop 0
  v_xor_b32 v2, 16384, v2
  v_mfma_f32_16x16x32_bf16 v[112:115], v[40:43], v[60:63], v[112:115]
  v_xor_b32 v3, 16384, v3
  s_waitcnt lgkmcnt(4)
  v_mfma_f32_16x16x32_bf16 v[112:115], v[24:27], v[56:59], v[112:115]
  v_xor_b32 v4, 16384, v4
  v_mfma_f32_16x16x32_bf16 v[116:119], v[28:31], v[56:59], v[116:119]
  s_nop 0
  ds_read_b128 v[56:59], v5 offset:53248
  v_mfma_f32_16x16x32_bf16 v[116:119], v[44:47], v[60:63], v[116:119]
  ds_read_b128 v[60:63], v7 offset:53248
  v_mfma_f32_16x16x32_bf16 v[100:103], v[44:47], v[52:55], v[100:103]
  ds_read_b128 v[52:55], v7 offset:51200
  v_mfma_f32_16x16x32_bf16 v[100:103], v[28:31], v[48:51], v[100:103]
  ds_read_b128 v[48:51], v5 offset:51200
  v_mfma_f32_16x16x32_bf16 v[120:123], v[16:19], v[64:67], v[120:123]
  s_nop 0
  s_waitcnt lgkmcnt(6)
  v_mfma_f32_16x16x32_bf16 v[120:123], v[32:35], v[68:71], v[120:123]
  v_mfma_f32_16x16x32_bf16 v[136:139], v[32:35], v[76:79], v[136:139]
  v_mfma_f32_16x16x32_bf16 v[136:139], v[16:19], v[72:75], v[136:139]
  v_mfma_f32_16x16x32_bf16 v[140:143], v[20:23], v[72:75], v[140:143]
  v_mfma_f32_16x16x32_bf16 v[140:143], v[36:39], v[76:79], v[140:143]
  v_mfma_f32_16x16x32_bf16 v[124:127], v[36:39], v[68:71], v[124:127]
  v_mfma_f32_16x16x32_bf16 v[124:127], v[20:23], v[64:67], v[124:127]
  v_mfma_f32_16x16x32_bf16 v[128:131], v[24:27], v[64:67], v[128:131]
  v_mfma_f32_16x16x32_bf16 v[128:131], v[40:43], v[68:71], v[128:131]
  v_mfma_f32_16x16x32_bf16 v[144:147], v[40:43], v[76:79], v[144:147]
  v_mfma_f32_16x16x32_bf16 v[144:147], v[24:27], v[72:75], v[144:147]
  v_mfma_f32_16x16x32_bf16 v[148:151], v[28:31], v[72:75], v[148:151]
  ds_read_b128 v[72:75], v5 offset:57344
  v_mfma_f32_16x16x32_bf16 v[148:151], v[44:47], v[76:79], v[148:151]
  ds_read_b128 v[76:79], v7 offset:57344
  v_mfma_f32_16x16x32_bf16 v[132:135], v[44:47], v[68:71], v[132:135]
  ds_read_b128 v[68:71], v7 offset:55296
  s_waitcnt lgkmcnt(7)
  v_mfma_f32_16x16x32_bf16 v[132:135], v[28:31], v[64:67], v[132:135]
  ds_read_b128 v[64:67], v5 offset:55296
  v_mfma_f32_16x16x32_bf16 v[152:155], v[16:19], v[80:83], v[152:155]
  s_waitcnt lgkmcnt(4)
  v_mfma_f32_16x16x32_bf16 v[152:155], v[32:35], v[84:87], v[152:155]
  v_mfma_f32_16x16x32_bf16 v[168:171], v[32:35], v[52:55], v[168:171]
  v_mfma_f32_16x16x32_bf16 v[168:171], v[16:19], v[48:51], v[168:171]
  v_mfma_f32_16x16x32_bf16 v[172:175], v[20:23], v[48:51], v[172:175]
  v_mfma_f32_16x16x32_bf16 v[172:175], v[36:39], v[52:55], v[172:175]
  v_mfma_f32_16x16x32_bf16 v[156:159], v[36:39], v[84:87], v[156:159]
  v_mfma_f32_16x16x32_bf16 v[156:159], v[20:23], v[80:83], v[156:159]
  v_mfma_f32_16x16x32_bf16 v[160:163], v[24:27], v[80:83], v[160:163]
  v_mfma_f32_16x16x32_bf16 v[160:163], v[40:43], v[84:87], v[160:163]
  v_mfma_f32_16x16x32_bf16 v[176:179], v[40:43], v[52:55], v[176:179]
  v_mfma_f32_16x16x32_bf16 v[176:179], v[24:27], v[48:51], v[176:179]
  v_mfma_f32_16x16x32_bf16 v[180:183], v[28:31], v[48:51], v[180:183]
  v_mfma_f32_16x16x32_bf16 v[180:183], v[44:47], v[52:55], v[180:183]
  v_mfma_f32_16x16x32_bf16 v[164:167], v[44:47], v[84:87], v[164:167]
  ds_read_b128 v[84:87], v7 offset:59392
  v_mfma_f32_16x16x32_bf16 v[164:167], v[28:31], v[80:83], v[164:167]
  ds_read_b128 v[80:83], v5 offset:59392
  v_mfma_f32_16x16x32_bf16 v[184:187], v[16:19], v[56:59], v[184:187]
  s_nop 0
  s_waitcnt lgkmcnt(2)
  v_mfma_f32_16x16x32_bf16 v[184:187], v[32:35], v[60:63], v[184:187]
  v_mfma_f32_16x16x32_bf16 v[200:203], v[32:35], v[68:71], v[200:203]
  v_mfma_f32_16x16x32_bf16 v[200:203], v[16:19], v[64:67], v[200:203]
  v_mfma_f32_16x16x32_bf16 v[204:207], v[20:23], v[64:67], v[204:207]
  v_mfma_f32_16x16x32_bf16 v[204:207], v[36:39], v[68:71], v[204:207]
  s_waitcnt lgkmcnt(0)
  s_barrier
  v_mfma_f32_16x16x32_bf16 v[188:191], v[36:39], v[60:63], v[188:191]
  ds_read_b128 v[48:51], v6 offset:0
  v_mfma_f32_16x16x32_bf16 v[188:191], v[20:23], v[56:59], v[188:191]
  ds_read_b128 v[52:55], v8 offset:0
  v_mfma_f32_16x16x32_bf16 v[192:195], v[24:27], v[56:59], v[192:195]
  v_mfma_f32_16x16x32_bf16 v[192:195], v[40:43], v[60:63], v[192:195]
  v_mfma_f32_16x16x32_bf16 v[208:211], v[40:43], v[68:71], v[208:211]
  v_mfma_f32_16x16x32_bf16 v[208:211], v[24:27], v[64:67], v[208:211]
  v_mfma_f32_16x16x32_bf16 v[212:215], v[28:31], v[64:67], v[212:215]
  ds_read_b128 v[64:67], v6 offset:4096
  v_mfma_f32_16x16x32_bf16 v[212:215], v[44:47], v[68:71], v[212:215]
  ds_read_b128 v[68:71], v8 offset:4096
  v_mfma_f32_16x16x32_bf16 v[196:199], v[44:47], v[60:63], v[196:199]
  ds_read_b128 v[60:63], v8 offset:2048
  v_mfma_f32_16x16x32_bf16 v[196:199], v[28:31], v[56:59], v[196:199]
  ds_read_b128 v[56:59], v6 offset:2048
  v_mfma_f32_16x16x32_bf16 v[216:219], v[32:35], v[76:79], v[216:219]
  v_mfma_f32_16x16x32_bf16 v[216:219], v[16:19], v[72:75], v[216:219]
  v_mfma_f32_16x16x32_bf16 v[232:235], v[16:19], v[80:83], v[232:235]
  ds_read_b64_tr_b16 v[16:17], v1 offset:0
  v_mfma_f32_16x16x32_bf16 v[232:235], v[32:35], v[84:87], v[232:235]
  ds_read_b64_tr_b16 v[18:19], v1 offset:1024
  v_mfma_f32_16x16x32_bf16 v[236:239], v[36:39], v[84:87], v[236:239]
  ds_read_b64_tr_b16 v[32:33], v1 offset:8192
  v_mfma_f32_16x16x32_bf16 v[236:239], v[20:23], v[80:83], v[236:239]
  ds_read_b64_tr_b16 v[34:35], v1 offset:9216
  v_mfma_f32_16x16x32_bf16 v[220:223], v[20:23], v[72:75], v[220:223]
  ds_read_b64_tr_b16 v[20:21], v2 offset:0
  v_mfma_f32_16x16x32_bf16 v[220:223], v[36:39], v[76:79], v[220:223]
  ds_read_b64_tr_b16 v[22:23], v2 offset:1024
  v_mfma_f32_16x16x32_bf16 v[224:227], v[40:43], v[76:79], v[224:227]
  ds_read_b64_tr_b16 v[36:37], v2 offset:8192
  v_mfma_f32_16x16x32_bf16 v[224:227], v[24:27], v[72:75], v[224:227]
  ds_read_b64_tr_b16 v[38:39], v2 offset:9216
  v_mfma_f32_16x16x32_bf16 v[240:243], v[24:27], v[80:83], v[240:243]
  ds_read_b64_tr_b16 v[24:25], v3 offset:0
  v_mfma_f32_16x16x32_bf16 v[240:243], v[40:43], v[84:87], v[240:243]
  ds_read_b64_tr_b16 v[26:27], v3 offset:1024
  v_mfma_f32_16x16x32_bf16 v[244:247], v[44:47], v[84:87], v[244:247]
  ds_read_b64_tr_b16 v[40:41], v3 offset:8192
  v_mfma_f32_16x16x32_bf16 v[244:247], v[28:31], v[80:83], v[244:247]
  ds_read_b64_tr_b16 v[42:43], v3 offset:9216
  v_mfma_f32_16x16x32_bf16 v[228:231], v[28:31], v[72:75], v[228:231]
  ds_read_b64_tr_b16 v[28:29], v4 offset:0
  s_waitcnt lgkmcnt(9)
  v_mfma_f32_16x16x32_bf16 v[228:231], v[44:47], v[76:79], v[228:231]
  ds_read_b64_tr_b16 v[30:31], v4 offset:1024
  v_mfma_f32_16x16x32_bf16 v[88:91], v[16:19], v[48:51], v[88:91]
  ds_read_b64_tr_b16 v[44:45], v4 offset:8192
  v_mfma_f32_16x16x32_bf16 v[88:91], v[32:35], v[52:55], v[88:91]
  s_nop 0
  ds_read_b64_tr_b16 v[46:47], v4 offset:9216
  v_mfma_f32_16x16x32_bf16 v[104:107], v[32:35], v[60:63], v[104:107]
  ds_read_b128 v[72:75], v6 offset:6144
  s_waitcnt lgkmcnt(9)
  v_mfma_f32_16x16x32_bf16 v[104:107], v[16:19], v[56:59], v[104:107]
  ds_read_b128 v[76:79], v8 offset:6144
  v_mfma_f32_16x16x32_bf16 v[108:111], v[20:23], v[56:59], v[108:111]
  s_nop 0
  ds_read_b128 v[80:83], v6 offset:8192
  v_mfma_f32_16x16x32_bf16 v[108:111], v[36:39], v[60:63], v[108:111]
  ds_read_b128 v[84:87], v8 offset:8192
  v_mfma_f32_16x16x32_bf16 v[92:95], v[36:39], v[52:55], v[92:95]
  s_waitcnt lgkmcnt(8)
  v_mfma_f32_16x16x32_bf16 v[92:95], v[20:23], v[48:51], v[92:95]
  v_mfma_f32_16x16x32_bf16 v[96:99], v[24:27], v[48:51], v[96:99]
  v_xor_b32 v1, 16384, v1
  v_mfma_f32_16x16x32_bf16 v[96:99], v[40:43], v[52:55], v[96:99]
  s_nop 0
  v_xor_b32 v2, 16384, v2
  v_mfma_f32_16x16x32_bf16 v[112:115], v[40:43], v[60:63], v[112:115]
  v_xor_b32 v3, 16384, v3
  s_waitcnt lgkmcnt(4)
  v_mfma_f32_16x16x32_bf16 v[112:115], v[24:27], v[56:59], v[112:115]
  v_xor_b32 v4, 16384, v4
  v_mfma_f32_16x16x32_bf16 v[116:119], v[28:31], v[56:59], v[116:119]
  s_nop 0
  ds_read_b128 v[56:59], v6 offset:12288
  v_mfma_f32_16x16x32_bf16 v[116:119], v[44:47], v[60:63], v[116:119]
  ds_read_b128 v[60:63], v8 offset:12288
  v_mfma_f32_16x16x32_bf16 v[100:103], v[44:47], v[52:55], v[100:103]
  ds_read_b128 v[52:55], v8 offset:10240
  v_mfma_f32_16x16x32_bf16 v[100:103], v[28:31], v[48:51], v[100:103]
  ds_read_b128 v[48:51], v6 offset:10240
  v_mfma_f32_16x16x32_bf16 v[120:123], v[16:19], v[64:67], v[120:123]
  s_nop 0
  s_waitcnt lgkmcnt(6)
  v_mfma_f32_16x16x32_bf16 v[120:123], v[32:35], v[68:71], v[120:123]
  v_mfma_f32_16x16x32_bf16 v[136:139], v[32:35], v[76:79], v[136:139]
  v_mfma_f32_16x16x32_bf16 v[136:139], v[16:19], v[72:75], v[136:139]
  v_mfma_f32_16x16x32_bf16 v[140:143], v[20:23], v[72:75], v[140:143]
  v_mfma_f32_16x16x32_bf16 v[140:143], v[36:39], v[76:79], v[140:143]
  v_mfma_f32_16x16x32_bf16 v[124:127], v[36:39], v[68:71], v[124:127]
  v_mfma_f32_16x16x32_bf16 v[124:127], v[20:23], v[64:67], v[124:127]
  v_mfma_f32_16x16x32_bf16 v[128:131], v[24:27], v[64:67], v[128:131]
  v_mfma_f32_16x16x32_bf16 v[128:131], v[40:43], v[68:71], v[128:131]
  v_mfma_f32_16x16x32_bf16 v[144:147], v[40:43], v[76:79], v[144:147]
  v_mfma_f32_16x16x32_bf16 v[144:147], v[24:27], v[72:75], v[144:147]
  v_mfma_f32_16x16x32_bf16 v[148:151], v[28:31], v[72:75], v[148:151]
  ds_read_b128 v[72:75], v6 offset:16384
  v_mfma_f32_16x16x32_bf16 v[148:151], v[44:47], v[76:79], v[148:151]
  ds_read_b128 v[76:79], v8 offset:16384
  v_mfma_f32_16x16x32_bf16 v[132:135], v[44:47], v[68:71], v[132:135]
  ds_read_b128 v[68:71], v8 offset:14336
  s_waitcnt lgkmcnt(7)
  v_mfma_f32_16x16x32_bf16 v[132:135], v[28:31], v[64:67], v[132:135]
  ds_read_b128 v[64:67], v6 offset:14336
  v_mfma_f32_16x16x32_bf16 v[152:155], v[16:19], v[80:83], v[152:155]
  s_waitcnt lgkmcnt(4)
  v_mfma_f32_16x16x32_bf16 v[152:155], v[32:35], v[84:87], v[152:155]
  v_mfma_f32_16x16x32_bf16 v[168:171], v[32:35], v[52:55], v[168:171]
  v_mfma_f32_16x16x32_bf16 v[168:171], v[16:19], v[48:51], v[168:171]
  v_mfma_f32_16x16x32_bf16 v[172:175], v[20:23], v[48:51], v[172:175]
  v_mfma_f32_16x16x32_bf16 v[172:175], v[36:39], v[52:55], v[172:175]
  v_mfma_f32_16x16x32_bf16 v[156:159], v[36:39], v[84:87], v[156:159]
  v_mfma_f32_16x16x32_bf16 v[156:159], v[20:23], v[80:83], v[156:159]
  v_mfma_f32_16x16x32_bf16 v[160:163], v[24:27], v[80:83], v[160:163]
  v_mfma_f32_16x16x32_bf16 v[160:163], v[40:43], v[84:87], v[160:163]
  v_mfma_f32_16x16x32_bf16 v[176:179], v[40:43], v[52:55], v[176:179]
  v_mfma_f32_16x16x32_bf16 v[176:179], v[24:27], v[48:51], v[176:179]
  v_mfma_f32_16x16x32_bf16 v[180:183], v[28:31], v[48:51], v[180:183]
  v_mfma_f32_16x16x32_bf16 v[180:183], v[44:47], v[52:55], v[180:183]
  v_mfma_f32_16x16x32_bf16 v[164:167], v[44:47], v[84:87], v[164:167]
  ds_read_b128 v[84:87], v8 offset:18432
  v_mfma_f32_16x16x32_bf16 v[164:167], v[28:31], v[80:83], v[164:167]
  ds_read_b128 v[80:83], v6 offset:18432
  v_mfma_f32_16x16x32_bf16 v[184:187], v[16:19], v[56:59], v[184:187]
  s_nop 0
  s_waitcnt lgkmcnt(2)
  v_mfma_f32_16x16x32_bf16 v[184:187], v[32:35], v[60:63], v[184:187]
  v_mfma_f32_16x16x32_bf16 v[200:203], v[32:35], v[68:71], v[200:203]
  v_mfma_f32_16x16x32_bf16 v[200:203], v[16:19], v[64:67], v[200:203]
  v_mfma_f32_16x16x32_bf16 v[204:207], v[20:23], v[64:67], v[204:207]
  v_mfma_f32_16x16x32_bf16 v[204:207], v[36:39], v[68:71], v[204:207]
  s_waitcnt lgkmcnt(0)
  s_barrier
  v_mfma_f32_16x16x32_bf16 v[188:191], v[36:39], v[60:63], v[188:191]
  ds_read_b128 v[48:51], v5 offset:0
  v_mfma_f32_16x16x32_bf16 v[188:191], v[20:23], v[56:59], v[188:191]
  ds_read_b128 v[52:55], v7 offset:0
  v_mfma_f32_16x16x32_bf16 v[192:195], v[24:27], v[56:59], v[192:195]
  v_mfma_f32_16x16x32_bf16 v[192:195], v[40:43], v[60:63], v[192:195]
  v_mfma_f32_16x16x32_bf16 v[208:211], v[40:43], v[68:71], v[208:211]
  v_mfma_f32_16x16x32_bf16 v[208:211], v[24:27], v[64:67], v[208:211]
  v_mfma_f32_16x16x32_bf16 v[212:215], v[28:31], v[64:67], v[212:215]
  ds_read_b128 v[64:67], v5 offset:4096
  v_mfma_f32_16x16x32_bf16 v[212:215], v[44:47], v[68:71], v[212:215]
  ds_read_b128 v[68:71], v7 offset:4096
  v_mfma_f32_16x16x32_bf16 v[196:199], v[44:47], v[60:63], v[196:199]
  ds_read_b128 v[60:63], v7 offset:2048
  v_mfma_f32_16x16x32_bf16 v[196:199], v[28:31], v[56:59], v[196:199]
  ds_read_b128 v[56:59], v5 offset:2048
  v_mfma_f32_16x16x32_bf16 v[216:219], v[32:35], v[76:79], v[216:219]
  v_mfma_f32_16x16x32_bf16 v[216:219], v[16:19], v[72:75], v[216:219]
  v_mfma_f32_16x16x32_bf16 v[232:235], v[16:19], v[80:83], v[232:235]
  ds_read_b64_tr_b16 v[16:17], v1 offset:0
  v_mfma_f32_16x16x32_bf16 v[232:235], v[32:35], v[84:87], v[232:235]
  ds_read_b64_tr_b16 v[18:19], v1 offset:1024
  v_mfma_f32_16x16x32_bf16 v[236:239], v[36:39], v[84:87], v[236:239]
  ds_read_b64_tr_b16 v[32:33], v1 offset:8192
  v_mfma_f32_16x16x32_bf16 v[236:239], v[20:23], v[80:83], v[236:239]
  ds_read_b64_tr_b16 v[34:35], v1 offset:9216
  v_mfma_f32_16x16x32_bf16 v[220:223], v[20:23], v[72:75], v[220:223]
  ds_read_b64_tr_b16 v[20:21], v2 offset:0
  v_mfma_f32_16x16x32_bf16 v[220:223], v[36:39], v[76:79], v[220:223]
  ds_read_b64_tr_b16 v[22:23], v2 offset:1024
  v_mfma_f32_16x16x32_bf16 v[224:227], v[40:43], v[76:79], v[224:227]
  ds_read_b64_tr_b16 v[36:37], v2 offset:8192
  v_mfma_f32_16x16x32_bf16 v[224:227], v[24:27], v[72:75], v[224:227]
  ds_read_b64_tr_b16 v[38:39], v2 offset:9216
  v_mfma_f32_16x16x32_bf16 v[240:243], v[24:27], v[80:83], v[240:243]
  ds_read_b64_tr_b16 v[24:25], v3 offset:0
  v_mfma_f32_16x16x32_bf16 v[240:243], v[40:43], v[84:87], v[240:243]
  ds_read_b64_tr_b16 v[26:27], v3 offset:1024
  v_mfma_f32_16x16x32_bf16 v[244:247], v[44:47], v[84:87], v[244:247]
  ds_read_b64_tr_b16 v[40:41], v3 offset:8192
  v_mfma_f32_16x16x32_bf16 v[244:247], v[28:31], v[80:83], v[244:247]
  ds_read_b64_tr_b16 v[42:43], v3 offset:9216
  v_mfma_f32_16x16x32_bf16 v[228:231], v[28:31], v[72:75], v[228:231]
  ds_read_b64_tr_b16 v[28:29], v4 offset:0
  s_waitcnt lgkmcnt(9)
  v_mfma_f32_16x16x32_bf16 v[228:231], v[44:47], v[76:79], v[228:231]
  ds_read_b64_tr_b16 v[30:31], v4 offset:1024
  v_mfma_f32_16x16x32_bf16 v[88:91], v[16:19], v[48:51], v[88:91]
  ds_read_b64_tr_b16 v[44:45], v4 offset:8192
  v_mfma_f32_16x16x32_bf16 v[88:91], v[32:35], v[52:55], v[88:91]
  s_nop 0
  ds_read_b64_tr_b16 v[46:47], v4 offset:9216
  v_mfma_f32_16x16x32_bf16 v[104:107], v[32:35], v[60:63], v[104:107]
  ds_read_b128 v[72:75], v5 offset:6144
  s_waitcnt lgkmcnt(9)
  v_mfma_f32_16x16x32_bf16 v[104:107], v[16:19], v[56:59], v[104:107]
  ds_read_b128 v[76:79], v7 offset:6144
  v_mfma_f32_16x16x32_bf16 v[108:111], v[20:23], v[56:59], v[108:111]
  s_nop 0
  ds_read_b128 v[80:83], v5 offset:8192
  v_mfma_f32_16x16x32_bf16 v[108:111], v[36:39], v[60:63], v[108:111]
  ds_read_b128 v[84:87], v7 offset:8192
  v_mfma_f32_16x16x32_bf16 v[92:95], v[36:39], v[52:55], v[92:95]
  s_waitcnt lgkmcnt(8)
  v_mfma_f32_16x16x32_bf16 v[92:95], v[20:23], v[48:51], v[92:95]
  v_mfma_f32_16x16x32_bf16 v[96:99], v[24:27], v[48:51], v[96:99]
  v_xor_b32 v1, 16384, v1
  v_mfma_f32_16x16x32_bf16 v[96:99], v[40:43], v[52:55], v[96:99]
  s_nop 0
  v_xor_b32 v2, 16384, v2
  v_mfma_f32_16x16x32_bf16 v[112:115], v[40:43], v[60:63], v[112:115]
  v_xor_b32 v3, 16384, v3
  s_waitcnt lgkmcnt(4)
  v_mfma_f32_16x16x32_bf16 v[112:115], v[24:27], v[56:59], v[112:115]
  v_xor_b32 v4, 16384, v4
  v_mfma_f32_16x16x32_bf16 v[116:119], v[28:31], v[56:59], v[116:119]
  s_nop 0
  ds_read_b128 v[56:59], v5 offset:12288
  v_mfma_f32_16x16x32_bf16 v[116:119], v[44:47], v[60:63], v[116:119]
  ds_read_b128 v[60:63], v7 offset:12288
  v_mfma_f32_16x16x32_bf16 v[100:103], v[44:47], v[52:55], v[100:103]
  ds_read_b128 v[52:55], v7 offset:10240
  v_mfma_f32_16x16x32_bf16 v[100:103], v[28:31], v[48:51], v[100:103]
  ds_read_b128 v[48:51], v5 offset:10240
  v_mfma_f32_16x16x32_bf16 v[120:123], v[16:19], v[64:67], v[120:123]
  s_nop 0
  s_waitcnt lgkmcnt(6)
  v_mfma_f32_16x16x32_bf16 v[120:123], v[32:35], v[68:71], v[120:123]
  v_mfma_f32_16x16x32_bf16 v[136:139], v[32:35], v[76:79], v[136:139]
  v_mfma_f32_16x16x32_bf16 v[136:139], v[16:19], v[72:75], v[136:139]
  v_mfma_f32_16x16x32_bf16 v[140:143], v[20:23], v[72:75], v[140:143]
  v_mfma_f32_16x16x32_bf16 v[140:143], v[36:39], v[76:79], v[140:143]
  v_mfma_f32_16x16x32_bf16 v[124:127], v[36:39], v[68:71], v[124:127]
  v_mfma_f32_16x16x32_bf16 v[124:127], v[20:23], v[64:67], v[124:127]
  v_mfma_f32_16x16x32_bf16 v[128:131], v[24:27], v[64:67], v[128:131]
  v_mfma_f32_16x16x32_bf16 v[128:131], v[40:43], v[68:71], v[128:131]
  v_mfma_f32_16x16x32_bf16 v[144:147], v[40:43], v[76:79], v[144:147]
  v_mfma_f32_16x16x32_bf16 v[144:147], v[24:27], v[72:75], v[144:147]
  v_mfma_f32_16x16x32_bf16 v[148:151], v[28:31], v[72:75], v[148:151]
  ds_read_b128 v[72:75], v5 offset:16384
  v_mfma_f32_16x16x32_bf16 v[148:151], v[44:47], v[76:79], v[148:151]
  ds_read_b128 v[76:79], v7 offset:16384
  v_mfma_f32_16x16x32_bf16 v[132:135], v[44:47], v[68:71], v[132:135]
  ds_read_b128 v[68:71], v7 offset:14336
  s_waitcnt lgkmcnt(7)
  v_mfma_f32_16x16x32_bf16 v[132:135], v[28:31], v[64:67], v[132:135]
  ds_read_b128 v[64:67], v5 offset:14336
  v_mfma_f32_16x16x32_bf16 v[152:155], v[16:19], v[80:83], v[152:155]
  s_waitcnt lgkmcnt(4)
  v_mfma_f32_16x16x32_bf16 v[152:155], v[32:35], v[84:87], v[152:155]
  v_mfma_f32_16x16x32_bf16 v[168:171], v[32:35], v[52:55], v[168:171]
  v_mfma_f32_16x16x32_bf16 v[168:171], v[16:19], v[48:51], v[168:171]
  v_mfma_f32_16x16x32_bf16 v[172:175], v[20:23], v[48:51], v[172:175]
  v_mfma_f32_16x16x32_bf16 v[172:175], v[36:39], v[52:55], v[172:175]
  v_mfma_f32_16x16x32_bf16 v[156:159], v[36:39], v[84:87], v[156:159]
  v_mfma_f32_16x16x32_bf16 v[156:159], v[20:23], v[80:83], v[156:159]
  v_mfma_f32_16x16x32_bf16 v[160:163], v[24:27], v[80:83], v[160:163]
  v_mfma_f32_16x16x32_bf16 v[160:163], v[40:43], v[84:87], v[160:163]
  v_mfma_f32_16x16x32_bf16 v[176:179], v[40:43], v[52:55], v[176:179]
  v_mfma_f32_16x16x32_bf16 v[176:179], v[24:27], v[48:51], v[176:179]
  v_mfma_f32_16x16x32_bf16 v[180:183], v[28:31], v[48:51], v[180:183]
  v_mfma_f32_16x16x32_bf16 v[180:183], v[44:47], v[52:55], v[180:183]
  v_mfma_f32_16x16x32_bf16 v[164:167], v[44:47], v[84:87], v[164:167]
  ds_read_b128 v[84:87], v7 offset:18432
  v_mfma_f32_16x16x32_bf16 v[164:167], v[28:31], v[80:83], v[164:167]
  ds_read_b128 v[80:83], v5 offset:18432
  v_mfma_f32_16x16x32_bf16 v[184:187], v[16:19], v[56:59], v[184:187]
  s_waitcnt lgkmcnt(2)
  s_add_u32 s72, s72, 1
  s_cmp_lt_u32 s72, 8
  v_mfma_f32_16x16x32_bf16 v[184:187], v[32:35], v[60:63], v[184:187]
  v_mfma_f32_16x16x32_bf16 v[200:203], v[32:35], v[68:71], v[200:203]
  v_mfma_f32_16x16x32_bf16 v[200:203], v[16:19], v[64:67], v[200:203]
  v_mfma_f32_16x16x32_bf16 v[204:207], v[20:23], v[64:67], v[204:207]
  v_mfma_f32_16x16x32_bf16 v[204:207], v[36:39], v[68:71], v[204:207]
  s_waitcnt lgkmcnt(0)
  s_barrier
  v_mfma_f32_16x16x32_bf16 v[188:191], v[36:39], v[60:63], v[188:191]
  s_nop 0
  ds_read_b128 v[48:51], v5 offset:40960
  v_mfma_f32_16x16x32_bf16 v[188:191], v[20:23], v[56:59], v[188:191]
  ds_read_b128 v[52:55], v7 offset:40960
  v_mfma_f32_16x16x32_bf16 v[192:195], v[24:27], v[56:59], v[192:195]
  v_mfma_f32_16x16x32_bf16 v[192:195], v[40:43], v[60:63], v[192:195]
  v_mfma_f32_16x16x32_bf16 v[208:211], v[40:43], v[68:71], v[208:211]
  v_mfma_f32_16x16x32_bf16 v[208:211], v[24:27], v[64:67], v[208:211]
  v_mfma_f32_16x16x32_bf16 v[212:215], v[28:31], v[64:67], v[212:215]
  ds_read_b128 v[64:67], v5 offset:45056
  v_mfma_f32_16x16x32_bf16 v[212:215], v[44:47], v[68:71], v[212:215]
  ds_read_b128 v[68:71], v7 offset:45056
  v_mfma_f32_16x16x32_bf16 v[196:199], v[44:47], v[60:63], v[196:199]
  ds_read_b128 v[60:63], v7 offset:43008
  v_mfma_f32_16x16x32_bf16 v[196:199], v[28:31], v[56:59], v[196:199]
  ds_read_b128 v[56:59], v5 offset:43008
  v_mfma_f32_16x16x32_bf16 v[216:219], v[32:35], v[76:79], v[216:219]
  v_mfma_f32_16x16x32_bf16 v[216:219], v[16:19], v[72:75], v[216:219]
  v_mfma_f32_16x16x32_bf16 v[232:235], v[16:19], v[80:83], v[232:235]
  ds_read_b64_tr_b16 v[16:17], v1 offset:0
  v_mfma_f32_16x16x32_bf16 v[232:235], v[32:35], v[84:87], v[232:235]
  ds_read_b64_tr_b16 v[18:19], v1 offset:1024
  v_mfma_f32_16x16x32_bf16 v[236:239], v[36:39], v[84:87], v[236:239]
  ds_read_b64_tr_b16 v[32:33], v1 offset:8192
  v_mfma_f32_16x16x32_bf16 v[236:239], v[20:23], v[80:83], v[236:239]
  ds_read_b64_tr_b16 v[34:35], v1 offset:9216
  v_mfma_f32_16x16x32_bf16 v[220:223], v[20:23], v[72:75], v[220:223]
  ds_read_b64_tr_b16 v[20:21], v2 offset:0
  v_mfma_f32_16x16x32_bf16 v[220:223], v[36:39], v[76:79], v[220:223]
  ds_read_b64_tr_b16 v[22:23], v2 offset:1024
  v_mfma_f32_16x16x32_bf16 v[224:227], v[40:43], v[76:79], v[224:227]
  ds_read_b64_tr_b16 v[36:37], v2 offset:8192
  v_mfma_f32_16x16x32_bf16 v[224:227], v[24:27], v[72:75], v[224:227]
  ds_read_b64_tr_b16 v[38:39], v2 offset:9216
  v_mfma_f32_16x16x32_bf16 v[240:243], v[24:27], v[80:83], v[240:243]
  ds_read_b64_tr_b16 v[24:25], v3 offset:0
  v_mfma_f32_16x16x32_bf16 v[240:243], v[40:43], v[84:87], v[240:243]
  ds_read_b64_tr_b16 v[26:27], v3 offset:1024
  v_mfma_f32_16x16x32_bf16 v[244:247], v[44:47], v[84:87], v[244:247]
  ds_read_b64_tr_b16 v[40:41], v3 offset:8192
  v_mfma_f32_16x16x32_bf16 v[244:247], v[28:31], v[80:83], v[244:247]
  ds_read_b64_tr_b16 v[42:43], v3 offset:9216
  v_mfma_f32_16x16x32_bf16 v[228:231], v[28:31], v[72:75], v[228:231]
  ds_read_b64_tr_b16 v[28:29], v4 offset:0
  s_waitcnt lgkmcnt(9)
  v_mfma_f32_16x16x32_bf16 v[228:231], v[44:47], v[76:79], v[228:231]
  ds_read_b64_tr_b16 v[30:31], v4 offset:1024
  s_cbranch_scc1 L_dnn_loop0
L_tail:
  v_mfma_f32_16x16x32_bf16 v[88:91], v[16:19], v[48:51], v[88:91]
  ds_read_b64_tr_b16 v[44:45], v4 offset:8192
  v_mfma_f32_16x16x32_bf16 v[88:91], v[32:35], v[52:55], v[88:91]
  ds_read_b64_tr_b16 v[46:47], v4 offset:9216
  v_mfma_f32_16x16x32_bf16 v[104:107], v[32:35], v[60:63], v[104:107]
  ds_read_b128 v[72:75], v5 offset:47104
  s_waitcnt lgkmcnt(9)
  v_mfma_f32_16x16x32_bf16 v[104:107], v[16:19], v[56:59], v[104:107]
  ds_read_b128 v[76:79], v7 offset:47104
  v_mfma_f32_16x16x32_bf16 v[108:111], v[20:23], v[56:59], v[108:111]
  s_nop 0
  ds_read_b128 v[80:83], v5 offset:49152
  v_mfma_f32_16x16x32_bf16 v[108:111], v[36:39], v[60:63], v[108:111]
  ds_read_b128 v[84:87], v7 offset:49152
  v_mul_f32 v11, v88, v88
  v_mfma_f32_16x16x32_bf16 v[92:95], v[36:39], v[52:55], v[92:95]
  s_waitcnt lgkmcnt(8)
  v_mul_f32 v248, v89, v89
  v_mul_f32 v249, v90, v90
  v_mfma_f32_16x16x32_bf16 v[92:95], v[20:23], v[48:51], v[92:95]
  v_mul_f32_e64 v250, v91, v91
  v_fma_f32 v11, v11, v14, v12
  v_mfma_f32_16x16x32_bf16 v[96:99], v[24:27], v[48:51], v[96:99]
  v_fma_f32 v248, v248, v14, v12
  v_fma_f32 v249, v249, v14, v12
  v_mfma_f32_16x16x32_bf16 v[96:99], v[40:43], v[52:55], v[96:99]
  v_fma_f32 v250, v250, v14, v12
  v_mul_f32 v11, v11, v88
  v_mfma_f32_16x16x32_bf16 v[112:115], v[40:43], v[60:63], v[112:115]
  s_waitcnt lgkmcnt(4)
  v_mul_f32 v248, v248, v89
  v_mul_f32 v249, v249, v90
  v_mfma_f32_16x16x32_bf16 v[112:115], v[24:27], v[56:59], v[112:115]
  v_mul_f32_e64 v250, v250, v91
  v_mfma_f32_16x16x32_bf16 v[116:119], v[28:31], v[56:59], v[116:119]
  ds_read_b128 v[56:59], v5 offset:53248
  v_mfma_f32_16x16x32_bf16 v[116:119], v[44:47], v[60:63], v[116:119]
  ds_read_b128 v[60:63], v7 offset:53248
  v_mfma_f32_16x16x32_bf16 v[100:103], v[44:47], v[52:55], v[100:103]
  ds_read_b128 v[52:55], v7 offset:51200
  v_mfma_f32_16x16x32_bf16 v[100:103], v[28:31], v[48:51], v[100:103]
  ds_read_b128 v[48:51], v5 offset:51200
  v_mfma_f32_16x16x32_bf16 v[120:123], v[16:19], v[64:67], v[120:123]
  s_waitcnt lgkmcnt(6)
  v_exp_f32 v11, v11
  v_mfma_f32_16x16x32_bf16 v[120:123], v[32:35], v[68:71], v[120:123]
  v_exp_f32 v248, v248
  v_mfma_f32_16x16x32_bf16 v[136:139], v[32:35], v[76:79], v[136:139]
  v_exp_f32 v249, v249
  v_mfma_f32_16x16x32_bf16 v[136:139], v[16:19], v[72:75], v[136:139]
  v_exp_f32 v250, v250
  v_mfma_f32_16x16x32_bf16 v[140:143], v[20:23], v[72:75], v[140:143]
  v_add_f32 v11, 1.0, v11
  v_add_f32 v248, 1.0, v248
  v_mfma_f32_16x16x32_bf16 v[140:143], v[36:39], v[76:79], v[140:143]
  v_add_f32 v249, 1.0, v249
  v_add_f32 v250, 1.0, v250
  v_mfma_f32_16x16x32_bf16 v[124:127], v[36:39], v[68:71], v[124:127]
  v_rcp_f32 v11, v11
  v_mfma_f32_16x16x32_bf16 v[124:127], v[20:23], v[64:67], v[124:127]
  v_rcp_f32 v248, v248
  v_mfma_f32_16x16x32_bf16 v[128:131], v[24:27], v[64:67], v[128:131]
  v_rcp_f32 v249, v249
  v_mfma_f32_16x16x32_bf16 v[128:131], v[40:43], v[68:71], v[128:131]
  v_rcp_f32 v250, v250
  v_mfma_f32_16x16x32_bf16 v[144:147], v[40:43], v[76:79], v[144:147]
  v_mul_f32 v88, v88, v11
  v_mul_f32 v89, v89, v248
  v_mfma_f32_16x16x32_bf16 v[144:147], v[24:27], v[72:75], v[144:147]
  v_mul_f32 v90, v90, v249
  v_mul_f32_e64 v91, v91, v250
  v_mfma_f32_16x16x32_bf16 v[148:151], v[28:31], v[72:75], v[148:151]
  ds_read_b128 v[72:75], v5 offset:57344
  v_mul_f32 v11, v92, v92
  v_mfma_f32_16x16x32_bf16 v[148:151], v[44:47], v[76:79], v[148:151]
  ds_read_b128 v[76:79], v7 offset:57344
  v_mul_f32 v248, v93, v93
  v_mfma_f32_16x16x32_bf16 v[132:135], v[44:47], v[68:71], v[132:135]
  ds_read_b128 v[68:71], v7 offset:55296
  s_waitcnt lgkmcnt(7)
  v_mul_f32 v249, v94, v94
  v_mfma_f32_16x16x32_bf16 v[132:135], v[28:31], v[64:67], v[132:135]
  ds_read_b128 v[64:67], v5 offset:55296
  v_mul_f32 v250, v95, v95
  v_mfma_f32_16x16x32_bf16 v[152:155], v[16:19], v[80:83], v[152:155]
  s_waitcnt lgkmcnt(4)
  v_fma_f32 v11, v11, v14, v12
  v_fma_f32 v248, v248, v14, v12
  v_mfma_f32_16x16x32_bf16 v[152:155], v[32:35], v[84:87], v[152:155]
  v_fma_f32 v249, v249, v14, v12
  v_fma_f32 v250, v250, v14, v12
  v_mfma_f32_16x16x32_bf16 v[168:171], v[32:35], v[52:55], v[168:171]
  v_mul_f32 v11, v11, v92
  v_mul_f32 v248, v248, v93
  v_mfma_f32_16x16x32_bf16 v[168:171], v[16:19], v[48:51], v[168:171]
  v_mul_f32 v249, v249, v94
  v_mul_f32 v250, v250, v95
  v_mfma_f32_16x16x32_bf16 v[172:175], v[20:23], v[48:51], v[172:175]
  v_exp_f32 v11, v11
  v_mfma_f32_16x16x32_bf16 v[172:175], v[36:39], v[52:55], v[172:175]
  v_exp_f32 v248, v248
  v_mfma_f32_16x16x32_bf16 v[156:159], v[36:39], v[84:87], v[156:159]
  v_exp_f32 v249, v249
  v_mfma_f32_16x16x32_bf16 v[156:159], v[20:23], v[80:83], v[156:159]
  v_exp_f32 v250, v250
  v_mfma_f32_16x16x32_bf16 v[160:163], v[24:27], v[80:83], v[160:163]
  v_add_f32 v11, 1.0, v11
  v_add_f32 v248, 1.0, v248
  v_mfma_f32_16x16x32_bf16 v[160:163], v[40:43], v[84:87], v[160:163]
  v_add_f32 v249, 1.0, v249
  v_add_f32 v250, 1.0, v250
  v_mfma_f32_16x16x32_bf16 v[176:179], v[40:43], v[52:55], v[176:179]
  v_rcp_f32 v11, v11
  v_mfma_f32_16x16x32_bf16 v[176:179], v[24:27], v[48:51], v[176:179]
  v_rcp_f32 v248, v248
  v_mfma_f32_16x16x32_bf16 v[180:183], v[28:31], v[48:51], v[180:183]
  v_rcp_f32 v249, v249
  v_mfma_f32_16x16x32_bf16 v[180:183], v[44:47], v[52:55], v[180:183]
  v_rcp_f32 v250, v250
  v_mfma_f32_16x16x32_bf16 v[164:167], v[44:47], v[84:87], v[164:167]
  ds_read_b128 v[84:87], v7 offset:59392
  v_mul_f32_e64 v92, v92, v11
  v_mfma_f32_16x16x32_bf16 v[164:167], v[28:31], v[80:83], v[164:167]
  ds_read_b128 v[80:83], v5 offset:59392
  v_mul_f32 v93, v93, v248
  v_mfma_f32_16x16x32_bf16 v[184:187], v[16:19], v[56:59], v[184:187]
  s_waitcnt lgkmcnt(2)
  v_mul_f32 v94, v94, v249
  v_mul_f32 v95, v95, v250
  v_mfma_f32_16x16x32_bf16 v[184:187], v[32:35], v[60:63], v[184:187]
  v_mul_f32 v11, v96, v96
  v_mul_f32 v248, v97, v97
  v_mfma_f32_16x16x32_bf16 v[200:203], v[32:35], v[68:71], v[200:203]
  v_mul_f32 v249, v98, v98
  v_mul_f32 v250, v99, v99
  v_mfma_f32_16x16x32_bf16 v[200:203], v[16:19], v[64:67], v[200:203]
  v_fma_f32 v11, v11, v14, v12
  v_fma_f32 v248, v248, v14, v12
  v_mfma_f32_16x16x32_bf16 v[204:207], v[20:23], v[64:67], v[204:207]
  v_fma_f32 v249, v249, v14, v12
  v_fma_f32 v250, v250, v14, v12
  v_mfma_f32_16x16x32_bf16 v[204:207], v[36:39], v[68:71], v[204:207]
  v_mul_f32 v11, v11, v96
  v_mul_f32 v248, v248, v97
  v_mfma_f32_16x16x32_bf16 v[188:191], v[36:39], v[60:63], v[188:191]
  v_mul_f32 v249, v249, v98
  v_mul_f32 v250, v250, v99
  v_mfma_f32_16x16x32_bf16 v[188:191], v[20:23], v[56:59], v[188:191]
  v_exp_f32 v11, v11
  v_mfma_f32_16x16x32_bf16 v[192:195], v[24:27], v[56:59], v[192:195]
  v_exp_f32 v248, v248
  v_mfma_f32_16x16x32_bf16 v[192:195], v[40:43], v[60:63], v[192:195]
  v_exp_f32_e64 v249, v249
  v_mfma_f32_16x16x32_bf16 v[208:211], v[40:43], v[68:71], v[208:211]
  v_exp_f32 v250, v250
  v_mfma_f32_16x16x32_bf16 v[208:211], v[24:27], v[64:67], v[208:211]
  v_add_f32 v11, 1.0, v11
  v_add_f32 v248, 1.0, v248
  v_mfma_f32_16x16x32_bf16 v[212:215], v[28:31], v[64:67], v[212:215]
  v_add_f32 v249, 1.0, v249
  v_add_f32 v250, 1.0, v250
  v_mfma_f32_16x16x32_bf16 v[212:215], v[44:47], v[68:71], v[212:215]
  v_rcp_f32 v11, v11
  v_mfma_f32_16x16x32_bf16 v[196:199], v[44:47], v[60:63], v[196:199]
  v_rcp_f32 v248, v248
  v_mfma_f32_16x16x32_bf16 v[196:199], v[28:31], v[56:59], v[196:199]
  v_rcp_f32 v249, v249
  v_mfma_f32_16x16x32_bf16 v[216:219], v[32:35], v[76:79], v[216:219]
  s_waitcnt lgkmcnt(0)
  v_rcp_f32 v250, v250
  v_mfma_f32_16x16x32_bf16 v[216:219], v[16:19], v[72:75], v[216:219]
  v_mul_f32 v96, v96, v11
  v_mul_f32 v97, v97, v248
  v_mfma_f32_16x16x32_bf16 v[232:235], v[16:19], v[80:83], v[232:235]
  v_mul_f32 v98, v98, v249
  v_mul_f32 v99, v99, v250
  v_mfma_f32_16x16x32_bf16 v[232:235], v[32:35], v[84:87], v[232:235]
  v_mul_f32 v11, v100, v100
  v_mul_f32 v248, v101, v101
  v_mfma_f32_16x16x32_bf16 v[236:239], v[36:39], v[84:87], v[236:239]
  v_mul_f32 v249, v102, v102
  v_mul_f32 v250, v103, v103
  v_mfma_f32_16x16x32_bf16 v[236:239], v[20:23], v[80:83], v[236:239]
  v_fma_f32 v11, v11, v14, v12
  v_fma_f32 v248, v248, v14, v12
  v_mfma_f32_16x16x32_bf16 v[220:223], v[20:23], v[72:75], v[220:223]
  v_fma_f32 v249, v249, v14, v12
  v_fma_f32 v250, v250, v14, v12
  v_mfma_f32_16x16x32_bf16 v[220:223], v[36:39], v[76:79], v[220:223]
  v_mul_f32 v11, v11, v100
  v_mul_f32 v248, v248, v101
  v_mfma_f32_16x16x32_bf16 v[224:227], v[40:43], v[76:79], v[224:227]
  v_mul_f32 v249, v249, v102
  v_mul_f32 v250, v250, v103
  v_mfma_f32_16x16x32_bf16 v[224:227], v[24:27], v[72:75], v[224:227]
  v_exp_f32_e64 v11, v11
  v_mfma_f32_16x16x32_bf16 v[240:243], v[24:27], v[80:83], v[240:243]
  v_exp_f32 v248, v248
  v_mfma_f32_16x16x32_bf16 v[240:243], v[40:43], v[84:87], v[240:243]
  v_exp_f32 v249, v249
  v_mfma_f32_16x16x32_bf16 v[244:247], v[44:47], v[84:87], v[244:247]
  v_exp_f32 v250, v250
  v_mfma_f32_16x16x32_bf16 v[244:247], v[28:31], v[80:83], v[244:247]
  v_add_f32 v11, 1.0, v11
  v_add_f32 v248, 1.0, v248
  v_mfma_f32_16x16x32_bf16 v[228:231], v[28:31], v[72:75], v[228:231]
  v_add_f32 v249, 1.0, v249
  v_add_f32 v250, 1.0, v250
  v_mfma_f32_16x16x32_bf16 v[228:231], v[44:47], v[76:79], v[228:231]
  v_rcp_f32 v11, v11
  v_rcp_f32 v248, v248
  v_rcp_f32 v249, v249
  v_rcp_f32 v250, v250
  v_mul_f32 v100, v100, v11
  v_mul_f32 v101, v101, v248
  v_mul_f32 v102, v102, v249
  v_mul_f32_e64 v103, v103, v250
  ds_read_b64 v[18:19], v9 offset:256
  ds_read_b64 v[22:23], v9 offset:288
  ds_read_b64 v[26:27], v9 offset:320
  ds_read_b64 v[30:31], v9 offset:352
  v_mov_b32 v248, 1.0
  v_mov_b32 v249, 1.0
L_epi:
  v_mov_b32 v84, 0xc1c00000
  v_mov_b32 v85, 0xc1c00000
  v_mov_b32 v86, 0x4b800000
  v_mov_b32 v87, 0x4b800000
  v_pk_mul_f32 v[52:53], v[104:105], v[104:105]
  v_pk_mul_f32 v[56:57], v[106:107], v[106:107]
  v_pk_mul_f32 v[60:61], v[108:109], v[108:109]
  v_pk_mul_f32 v[64:65], v[110:111], v[110:111]
  v_pk_mul_f32 v[68:69], v[120:121], v[120:121]
  v_pk_mul_f32 v[72:73], v[122:123], v[122:123]
  v_pk_mul_f32 v[76:77], v[124:125], v[124:125]
  v_pk_mul_f32 v[80:81], v[126:127], v[126:127]
  v_pk_fma_f32 v[52:53], v[52:53], v[14:15], v[12:13]
  v_pk_fma_f32 v[56:57], v[56:57], v[14:15], v[12:13]
  v_pk_fma_f32 v[60:61], v[60:61], v[14:15], v[12:13]
  v_pk_fma_f32 v[64:65], v[64:65], v[14:15], v[12:13]
  v_pk_fma_f32 v[68:69], v[68:69], v[14:15], v[12:13]
  v_pk_fma_f32 v[72:73], v[72:73], v[14:15], v[12:13]
  v_pk_fma_f32 v[76:77], v[76:77], v[14:15], v[12:13]
  v_pk_fma_f32 v[80:81], v[80:81], v[14:15], v[12:13]
  v_pk_fma_f32 v[52:53], v[52:53], v[104:105], v[84:85]
  v_pk_fma_f32 v[56:57], v[56:57], v[106:107], v[84:85]
  v_pk_fma_f32 v[60:61], v[60:61], v[108:109], v[84:85]
  v_pk_fma_f32 v[64:65], v[64:65], v[110:111], v[84:85]
  v_pk_fma_f32 v[68:69], v[68:69], v[120:121], v[84:85]
  v_pk_fma_f32 v[72:73], v[72:73], v[122:123], v[84:85]
  v_pk_fma_f32 v[76:77], v[76:77], v[124:125], v[84:85]
  v_pk_fma_f32 v[80:81], v[80:81], v[126:127], v[84:85]
  v_exp_f32 v52, v52 clamp
  v_exp_f32 v53, v53 clamp
  v_exp_f32 v56, v56 clamp
  v_exp_f32 v57, v57 clamp
  v_exp_f32 v60, v60 clamp
  v_exp_f32 v61, v61 clamp
  v_exp_f32 v64, v64 clamp
  v_exp_f32 v65, v65 clamp
  v_exp_f32 v68, v68 clamp
  v_exp_f32 v69, v69 clamp
  v_exp_f32 v72, v72 clamp
  v_exp_f32 v73, v73 clamp
  v_exp_f32 v76, v76 clamp
  v_exp_f32 v77, v77 clamp
  v_exp_f32 v80, v80 clamp
  v_exp_f32 v81, v81 clamp
  s_waitcnt lgkmcnt(3)
  v_lshlrev_b32 v16, 16, v18
  v_and_b32 v17, 0xffff0000, v18
  v_lshlrev_b32 v18, 16, v19
  v_and_b32 v19, 0xffff0000, v19
  s_waitcnt lgkmcnt(2)
  v_lshlrev_b32 v20, 16, v22
  v_and_b32 v21, 0xffff0000, v22
  v_lshlrev_b32 v22, 16, v23
  v_and_b32 v23, 0xffff0000, v23
  s_waitcnt lgkmcnt(1)
  v_lshlrev_b32 v24, 16, v26
  v_and_b32 v25, 0xffff0000, v26
  v_lshlrev_b32 v26, 16, v27
  v_and_b32 v27, 0xffff0000, v27
  s_waitcnt lgkmcnt(0)
  v_lshlrev_b32 v28, 16, v30
  v_and_b32 v29, 0xffff0000, v30
  v_lshlrev_b32 v30, 16, v31
  v_and_b32 v31, 0xffff0000, v31
  v_pk_mul_f32 v[54:55], v[104:105], v[16:17]
  v_pk_mul_f32 v[58:59], v[106:107], v[18:19]
  v_pk_mul_f32 v[62:63], v[108:109], v[20:21]
  v_pk_mul_f32 v[66:67], v[110:111], v[22:23]
  v_pk_mul_f32 v[70:71], v[120:121], v[16:17]
  v_pk_mul_f32 v[74:75], v[122:123], v[18:19]
  v_pk_mul_f32 v[78:79], v[124:125], v[20:21]
  v_pk_mul_f32 v[82:83], v[126:127], v[22:23]
  v_pk_fma_f32 v[52:53], v[52:53], v[86:87], v[248:249]
  v_pk_fma_f32 v[56:57], v[56:57], v[86:87], v[248:249]
  v_pk_fma_f32 v[60:61], v[60:61], v[86:87], v[248:249]
  v_pk_fma_f32 v[64:65], v[64:65], v[86:87], v[248:249]
  v_pk_fma_f32 v[68:69], v[68:69], v[86:87], v[248:249]
  v_pk_fma_f32 v[72:73], v[72:73], v[86:87], v[248:249]
  v_pk_fma_f32 v[76:77], v[76:77], v[86:87], v[248:249]
  v_pk_fma_f32 v[80:81], v[80:81], v[86:87], v[248:249]
  v_pk_mul_f32 v[54:55], v[54:55], v[56:57]
  v_pk_mul_f32 v[62:63], v[62:63], v[64:65]
  v_pk_mul_f32 v[70:71], v[70:71], v[72:73]
  v_pk_mul_f32 v[78:79], v[78:79], v[80:81]
  v_pk_fma_f32 v[54:55], v[58:59], v[52:53], v[54:55]
  v_pk_fma_f32 v[62:63], v[66:67], v[60:61], v[62:63]
  v_pk_fma_f32 v[70:71], v[74:75], v[68:69], v[70:71]
  v_pk_fma_f32 v[78:79], v[82:83], v[76:77], v[78:79]
  v_pk_mul_f32 v[52:53], v[52:53], v[56:57]
  v_pk_mul_f32 v[60:61], v[60:61], v[64:65]
  v_pk_mul_f32 v[68:69], v[68:69], v[72:73]
  v_pk_mul_f32 v[76:77], v[76:77], v[80:81]
  v_pk_mul_f32 v[54:55], v[54:55], v[60:61]
  v_pk_mul_f32 v[70:71], v[70:71], v[76:77]
  v_pk_fma_f32 v[54:55], v[62:63], v[52:53], v[54:55]
  v_pk_fma_f32 v[70:71], v[78:79], v[68:69], v[70:71]
  v_pk_mul_f32 v[52:53], v[52:53], v[60:61]
  v_pk_mul_f32 v[68:69], v[68:69], v[76:77]
  v_rcp_f32 v52, v52
  v_rcp_f32 v53, v53
  v_rcp_f32 v68, v68
  v_rcp_f32 v69, v69
  v_pk_mul_f32 v[34:35], v[52:53], v[54:55]
  v_pk_mul_f32 v[36:37], v[68:69], v[70:71]
  v_pk_mul_f32 v[52:53], v[112:113], v[112:113]
  v_pk_mul_f32 v[56:57], v[114:115], v[114:115]
  v_pk_mul_f32 v[60:61], v[116:117], v[116:117]
  v_pk_mul_f32 v[64:65], v[118:119], v[118:119]
  v_pk_mul_f32 v[68:69], v[128:129], v[128:129]
  v_pk_mul_f32 v[72:73], v[130:131], v[130:131]
  v_pk_mul_f32 v[76:77], v[132:133], v[132:133]
  v_pk_mul_f32 v[80:81], v[134:135], v[134:135]
  v_pk_fma_f32 v[52:53], v[52:53], v[14:15], v[12:13]
  v_pk_fma_f32 v[56:57], v[56:57], v[14:15], v[12:13]
  v_pk_fma_f32 v[60:61], v[60:61], v[14:15], v[12:13]
  v_pk_fma_f32 v[64:65], v[64:65], v[14:15], v[12:13]
  v_pk_fma_f32 v[68:69], v[68:69], v[14:15], v[12:13]
  v_pk_fma_f32 v[72:73], v[72:73], v[14:15], v[12:13]
  v_pk_fma_f32 v[76:77], v[76:77], v[14:15], v[12:13]
  v_pk_fma_f32 v[80:81], v[80:81], v[14:15], v[12:13]
  v_pk_fma_f32 v[52:53], v[52:53], v[112:113], v[84:85]
  v_pk_fma_f32 v[56:57], v[56:57], v[114:115], v[84:85]
  v_pk_fma_f32 v[60:61], v[60:61], v[116:117], v[84:85]
  v_pk_fma_f32 v[64:65], v[64:65], v[118:119], v[84:85]
  v_pk_fma_f32 v[68:69], v[68:69], v[128:129], v[84:85]
  v_pk_fma_f32 v[72:73], v[72:73], v[130:131], v[84:85]
  v_pk_fma_f32 v[76:77], v[76:77], v[132:133], v[84:85]
  v_pk_fma_f32 v[80:81], v[80:81], v[134:135], v[84:85]
  v_exp_f32 v52, v52 clamp
  v_exp_f32 v53, v53 clamp
  v_exp_f32 v56, v56 clamp
  v_exp_f32 v57, v57 clamp
  v_exp_f32 v60, v60 clamp
  v_exp_f32 v61, v61 clamp
  v_exp_f32 v64, v64 clamp
  v_exp_f32 v65, v65 clamp
  v_exp_f32 v68, v68 clamp
  v_exp_f32 v69, v69 clamp
  v_exp_f32 v72, v72 clamp
  v_exp_f32 v73, v73 clamp
  v_exp_f32 v76, v76 clamp
  v_exp_f32 v77, v77 clamp
  v_exp_f32 v80, v80 clamp
  v_exp_f32 v81, v81 clamp
  v_pk_mul_f32 v[54:55], v[112:113], v[24:25]
  v_pk_mul_f32 v[58:59], v[114:115], v[26:27]
  v_pk_mul_f32 v[62:63], v[116:117], v[28:29]
  v_pk_mul_f32 v[66:67], v[118:119], v[30:31]
  v_pk_mul_f32 v[70:71], v[128:129], v[24:25]
  v_pk_mul_f32 v[74:75], v[130:131], v[26:27]
  v_pk_mul_f32 v[78:79], v[132:133], v[28:29]
  v_pk_mul_f32 v[82:83], v[134:135], v[30:31]
  v_pk_fma_f32 v[52:53], v[52:53], v[86:87], v[248:249]
  v_pk_fma_f32 v[56:57], v[56:57], v[86:87], v[248:249]
  v_pk_fma_f32 v[60:61], v[60:61], v[86:87], v[248:249]
  v_pk_fma_f32 v[64:65], v[64:65], v[86:87], v[248:249]
  v_pk_fma_f32 v[68:69], v[68:69], v[86:87], v[248:249]
  v_pk_fma_f32 v[72:73], v[72:73], v[86:87], v[248:249]
  v_pk_fma_f32 v[76:77], v[76:77], v[86:87], v[248:249]
  v_pk_fma_f32 v[80:81], v[80:81], v[86:87], v[248:249]
  v_pk_mul_f32 v[54:55], v[54:55], v[56:57]
  v_pk_mul_f32 v[62:63], v[62:63], v[64:65]
  v_pk_mul_f32 v[70:71], v[70:71], v[72:73]
  v_pk_mul_f32 v[78:79], v[78:79], v[80:81]
  v_pk_fma_f32 v[54:55], v[58:59], v[52:53], v[54:55]
  v_pk_fma_f32 v[62:63], v[66:67], v[60:61], v[62:63]
  v_pk_fma_f32 v[70:71], v[74:75], v[68:69], v[70:71]
  v_pk_fma_f32 v[78:79], v[82:83], v[76:77], v[78:79]
  v_pk_mul_f32 v[52:53], v[52:53], v[56:57]
  v_pk_mul_f32 v[60:61], v[60:61], v[64:65]
  v_pk_mul_f32 v[68:69], v[68:69], v[72:73]
  v_pk_mul_f32 v[76:77], v[76:77], v[80:81]
  v_pk_mul_f32 v[54:55], v[54:55], v[60:61]
  v_pk_mul_f32 v[70:71], v[70:71], v[76:77]
  v_pk_fma_f32 v[54:55], v[62:63], v[52:53], v[54:55]
  v_pk_fma_f32 v[70:71], v[78:79], v[68:69], v[70:71]
  v_pk_mul_f32 v[52:53], v[52:53], v[60:61]
  v_pk_mul_f32 v[68:69], v[68:69], v[76:77]
  v_rcp_f32 v52, v52
  v_rcp_f32 v53, v53
  v_rcp_f32 v68, v68
  v_rcp_f32 v69, v69
  v_pk_fma_f32 v[34:35], v[52:53], v[54:55], v[34:35]
  v_pk_fma_f32 v[36:37], v[68:69], v[70:71], v[36:37]
  v_pk_mul_f32 v[52:53], v[136:137], v[136:137]
  v_pk_mul_f32 v[56:57], v[138:139], v[138:139]
  v_pk_mul_f32 v[60:61], v[140:141], v[140:141]
  v_pk_mul_f32 v[64:65], v[142:143], v[142:143]
  v_pk_mul_f32 v[68:69], v[152:153], v[152:153]
  v_pk_mul_f32 v[72:73], v[154:155], v[154:155]
  v_pk_mul_f32 v[76:77], v[156:157], v[156:157]
  v_pk_mul_f32 v[80:81], v[158:159], v[158:159]
  v_pk_fma_f32 v[52:53], v[52:53], v[14:15], v[12:13]
  v_pk_fma_f32 v[56:57], v[56:57], v[14:15], v[12:13]
  v_pk_fma_f32 v[60:61], v[60:61], v[14:15], v[12:13]
  v_pk_fma_f32 v[64:65], v[64:65], v[14:15], v[12:13]
  v_pk_fma_f32 v[68:69], v[68:69], v[14:15], v[12:13]
  v_pk_fma_f32 v[72:73], v[72:73], v[14:15], v[12:13]
  v_pk_fma_f32 v[76:77], v[76:77], v[14:15], v[12:13]
  v_pk_fma_f32 v[80:81], v[80:81], v[14:15], v[12:13]
  v_pk_fma_f32 v[52:53], v[52:53], v[136:137], v[84:85]
  v_pk_fma_f32 v[56:57], v[56:57], v[138:139], v[84:85]
  v_pk_fma_f32 v[60:61], v[60:61], v[140:141], v[84:85]
  v_pk_fma_f32 v[64:65], v[64:65], v[142:143], v[84:85]
  v_pk_fma_f32 v[68:69], v[68:69], v[152:153], v[84:85]
  v_pk_fma_f32 v[72:73], v[72:73], v[154:155], v[84:85]
  v_pk_fma_f32 v[76:77], v[76:77], v[156:157], v[84:85]
  v_pk_fma_f32 v[80:81], v[80:81], v[158:159], v[84:85]
  v_exp_f32 v52, v52 clamp
  v_exp_f32 v53, v53 clamp
  v_exp_f32 v56, v56 clamp
  v_exp_f32 v57, v57 clamp
  v_exp_f32 v60, v60 clamp
  v_exp_f32 v61, v61 clamp
  v_exp_f32 v64, v64 clamp
  v_exp_f32 v65, v65 clamp
  v_exp_f32 v68, v68 clamp
  v_exp_f32 v69, v69 clamp
  v_exp_f32 v72, v72 clamp
  v_exp_f32 v73, v73 clamp
  v_exp_f32 v76, v76 clamp
  v_exp_f32 v77, v77 clamp
  v_exp_f32 v80, v80 clamp
  v_exp_f32 v81, v81 clamp
  v_pk_mul_f32 v[54:55], v[136:137], v[16:17]
  v_pk_mul_f32 v[58:59], v[138:139], v[18:19]
  v_pk_mul_f32 v[62:63], v[140:141], v[20:21]
  v_pk_mul_f32 v[66:67], v[142:143], v[22:23]
  v_pk_mul_f32 v[70:71], v[152:153], v[16:17]
  v_pk_mul_f32 v[74:75], v[154:155], v[18:19]
  v_pk_mul_f32 v[78:79], v[156:157], v[20:21]
  v_pk_mul_f32 v[82:83], v[158:159], v[22:23]
  v_pk_fma_f32 v[52:53], v[52:53], v[86:87], v[248:249]
  v_pk_fma_f32 v[56:57], v[56:57], v[86:87], v[248:249]
  v_pk_fma_f32 v[60:61], v[60:61], v[86:87], v[248:249]
  v_pk_fma_f32 v[64:65], v[64:65], v[86:87], v[248:249]
  v_pk_fma_f32 v[68:69], v[68:69], v[86:87], v[248:249]
  v_pk_fma_f32 v[72:73], v[72:73], v[86:87], v[248:249]
  v_pk_fma_f32 v[76:77], v[76:77], v[86:87], v[248:249]
  v_pk_fma_f32 v[80:81], v[80:81], v[86:87], v[248:249]
  v_pk_mul_f32 v[54:55], v[54:55], v[56:57]
  v_pk_mul_f32 v[62:63], v[62:63], v[64:65]
  v_pk_mul_f32 v[70:71], v[70:71], v[72:73]
  v_pk_mul_f32 v[78:79], v[78:79], v[80:81]
  v_pk_fma_f32 v[54:55], v[58:59], v[52:53], v[54:55]
  v_pk_fma_f32 v[62:63], v[66:67], v[60:61], v[62:63]
  v_pk_fma_f32 v[70:71], v[74:75], v[68:69], v[70:71]
  v_pk_fma_f32 v[78:79], v[82:83], v[76:77], v[78:79]
  v_pk_mul_f32 v[52:53], v[52:53], v[56:57]
  v_pk_mul_f32 v[60:61], v[60:61], v[64:65]
  v_pk_mul_f32 v[68:69], v[68:69], v[72:73]
  v_pk_mul_f32 v[76:77], v[76:77], v[80:81]
  v_pk_mul_f32 v[54:55], v[54:55], v[60:61]
  v_pk_mul_f32 v[70:71], v[70:71], v[76:77]
  v_pk_fma_f32 v[54:55], v[62:63], v[52:53], v[54:55]
  v_pk_fma_f32 v[70:71], v[78:79], v[68:69], v[70:71]
  v_pk_mul_f32 v[52:53], v[52:53], v[60:61]
  v_pk_mul_f32 v[68:69], v[68:69], v[76:77]
  v_rcp_f32 v52, v52
  v_rcp_f32 v53, v53
  v_rcp_f32 v68, v68
  v_rcp_f32 v69, v69
  v_pk_mul_f32 v[38:39], v[52:53], v[54:55]
  v_pk_mul_f32 v[40:41], v[68:69], v[70:71]
  v_pk_mul_f32 v[52:53], v[144:145], v[144:145]
  v_pk_mul_f32 v[56:57], v[146:147], v[146:147]
  v_pk_mul_f32 v[60:61], v[148:149], v[148:149]
  v_pk_mul_f32 v[64:65], v[150:151], v[150:151]
  v_pk_mul_f32 v[68:69], v[160:161], v[160:161]
  v_pk_mul_f32 v[72:73], v[162:163], v[162:163]
  v_pk_mul_f32 v[76:77], v[164:165], v[164:165]
  v_pk_mul_f32 v[80:81], v[166:167], v[166:167]
  v_pk_fma_f32 v[52:53], v[52:53], v[14:15], v[12:13]
  v_pk_fma_f32 v[56:57], v[56:57], v[14:15], v[12:13]
  v_pk_fma_f32 v[60:61], v[60:61], v[14:15], v[12:13]
  v_pk_fma_f32 v[64:65], v[64:65], v[14:15], v[12:13]
  v_pk_fma_f32 v[68:69], v[68:69], v[14:15], v[12:13]
  v_pk_fma_f32 v[72:73], v[72:73], v[14:15], v[12:13]
  v_pk_fma_f32 v[76:77], v[76:77], v[14:15], v[12:13]
  v_pk_fma_f32 v[80:81], v[80:81], v[14:15], v[12:13]
  v_pk_fma_f32 v[52:53], v[52:53], v[144:145], v[84:85]
  v_pk_fma_f32 v[56:57], v[56:57], v[146:147], v[84:85]
  v_pk_fma_f32 v[60:61], v[60:61], v[148:149], v[84:85]
  v_pk_fma_f32 v[64:65], v[64:65], v[150:151], v[84:85]
  v_pk_fma_f32 v[68:69], v[68:69], v[160:161], v[84:85]
  v_pk_fma_f32 v[72:73], v[72:73], v[162:163], v[84:85]
  v_pk_fma_f32 v[76:77], v[76:77], v[164:165], v[84:85]
  v_pk_fma_f32 v[80:81], v[80:81], v[166:167], v[84:85]
  v_exp_f32 v52, v52 clamp
  v_exp_f32 v53, v53 clamp
  v_exp_f32 v56, v56 clamp
  v_exp_f32 v57, v57 clamp
  v_exp_f32 v60, v60 clamp
  v_exp_f32 v61, v61 clamp
  v_exp_f32 v64, v64 clamp
  v_exp_f32 v65, v65 clamp
  v_exp_f32 v68, v68 clamp
  v_exp_f32 v69, v69 clamp
  v_exp_f32 v72, v72 clamp
  v_exp_f32 v73, v73 clamp
  v_exp_f32 v76, v76 clamp
  v_exp_f32 v77, v77 clamp
  v_exp_f32 v80, v80 clamp
  v_exp_f32 v81, v81 clamp
  v_pk_mul_f32 v[54:55], v[144:145], v[24:25]
  v_pk_mul_f32 v[58:59], v[146:147], v[26:27]
  v_pk_mul_f32 v[62:63], v[148:149], v[28:29]
  v_pk_mul_f32 v[66:67], v[150:151], v[30:31]
  v_pk_mul_f32 v[70:71], v[160:161], v[24:25]
  v_pk_mul_f32 v[74:75], v[162:163], v[26:27]
  v_pk_mul_f32 v[78:79], v[164:165], v[28:29]
  v_pk_mul_f32 v[82:83], v[166:167], v[30:31]
  v_pk_fma_f32 v[52:53], v[52:53], v[86:87], v[248:249]
  v_pk_fma_f32 v[56:57], v[56:57], v[86:87], v[248:249]
  v_pk_fma_f32 v[60:61], v[60:61], v[86:87], v[248:249]
  v_pk_fma_f32 v[64:65], v[64:65], v[86:87], v[248:249]
  v_pk_fma_f32 v[68:69], v[68:69], v[86:87], v[248:249]
  v_pk_fma_f32 v[72:73], v[72:73], v[86:87], v[248:249]
  v_pk_fma_f32 v[76:77], v[76:77], v[86:87], v[248:249]
  v_pk_fma_f32 v[80:81], v[80:81], v[86:87], v[248:249]
  v_pk_mul_f32 v[54:55], v[54:55], v[56:57]
  v_pk_mul_f32 v[62:63], v[62:63], v[64:65]
  v_pk_mul_f32 v[70:71], v[70:71], v[72:73]
  v_pk_mul_f32 v[78:79], v[78:79], v[80:81]
  v_pk_fma_f32 v[54:55], v[58:59], v[52:53], v[54:55]
  v_pk_fma_f32 v[62:63], v[66:67], v[60:61], v[62:63]
  v_pk_fma_f32 v[70:71], v[74:75], v[68:69], v[70:71]
  v_pk_fma_f32 v[78:79], v[82:83], v[76:77], v[78:79]
  v_pk_mul_f32 v[52:53], v[52:53], v[56:57]
  v_pk_mul_f32 v[60:61], v[60:61], v[64:65]
  v_pk_mul_f32 v[68:69], v[68:69], v[72:73]
  v_pk_mul_f32 v[76:77], v[76:77], v[80:81]
  v_pk_mul_f32 v[54:55], v[54:55], v[60:61]
  v_pk_mul_f32 v[70:71], v[70:71], v[76:77]
  v_pk_fma_f32 v[54:55], v[62:63], v[52:53], v[54:55]
  v_pk_fma_f32 v[70:71], v[78:79], v[68:69], v[70:71]
  v_pk_mul_f32 v[52:53], v[52:53], v[60:61]
  v_pk_mul_f32 v[68:69], v[68:69], v[76:77]
  v_rcp_f32 v52, v52
  v_rcp_f32 v53, v53
  v_rcp_f32 v68, v68
  v_rcp_f32 v69, v69
  v_pk_fma_f32 v[38:39], v[52:53], v[54:55], v[38:39]
  v_pk_fma_f32 v[40:41], v[68:69], v[70:71], v[40:41]
  v_pk_mul_f32 v[52:53], v[168:169], v[168:169]
  v_pk_mul_f32 v[56:57], v[170:171], v[170:171]
  v_pk_mul_f32 v[60:61], v[172:173], v[172:173]
  v_pk_mul_f32 v[64:65], v[174:175], v[174:175]
  v_pk_mul_f32 v[68:69], v[184:185], v[184:185]
  v_pk_mul_f32 v[72:73], v[186:187], v[186:187]
  v_pk_mul_f32 v[76:77], v[188:189], v[188:189]
  v_pk_mul_f32 v[80:81], v[190:191], v[190:191]
  v_pk_fma_f32 v[52:53], v[52:53], v[14:15], v[12:13]
  v_pk_fma_f32 v[56:57], v[56:57], v[14:15], v[12:13]
  v_pk_fma_f32 v[60:61], v[60:61], v[14:15], v[12:13]
  v_pk_fma_f32 v[64:65], v[64:65], v[14:15], v[12:13]
  v_pk_fma_f32 v[68:69], v[68:69], v[14:15], v[12:13]
  v_pk_fma_f32 v[72:73], v[72:73], v[14:15], v[12:13]
  v_pk_fma_f32 v[76:77], v[76:77], v[14:15], v[12:13]
  v_pk_fma_f32 v[80:81], v[80:81], v[14:15], v[12:13]
  v_pk_fma_f32 v[52:53], v[52:53], v[168:169], v[84:85]
  v_pk_fma_f32 v[56:57], v[56:57], v[170:171], v[84:85]
  v_pk_fma_f32 v[60:61], v[60:61], v[172:173], v[84:85]
  v_pk_fma_f32 v[64:65], v[64:65], v[174:175], v[84:85]
  v_pk_fma_f32 v[68:69], v[68:69], v[184:185], v[84:85]
  v_pk_fma_f32 v[72:73], v[72:73], v[186:187], v[84:85]
  v_pk_fma_f32 v[76:77], v[76:77], v[188:189], v[84:85]
  v_pk_fma_f32 v[80:81], v[80:81], v[190:191], v[84:85]
  v_exp_f32 v52, v52 clamp
  v_exp_f32 v53, v53 clamp
  v_exp_f32 v56, v56 clamp
  v_exp_f32 v57, v57 clamp
  v_exp_f32 v60, v60 clamp
  v_exp_f32 v61, v61 clamp
  v_exp_f32 v64, v64 clamp
  v_exp_f32 v65, v65 clamp
  v_exp_f32 v68, v68 clamp
  v_exp_f32 v69, v69 clamp
  v_exp_f32 v72, v72 clamp
  v_exp_f32 v73, v73 clamp
  v_exp_f32 v76, v76 clamp
  v_exp_f32 v77, v77 clamp
  v_exp_f32 v80, v80 clamp
  v_exp_f32 v81, v81 clamp
  v_pk_mul_f32 v[54:55], v[168:169], v[16:17]
  v_pk_mul_f32 v[58:59], v[170:171], v[18:19]
  v_pk_mul_f32 v[62:63], v[172:173], v[20:21]
  v_pk_mul_f32 v[66:67], v[174:175], v[22:23]
  v_pk_mul_f32 v[70:71], v[184:185], v[16:17]
  v_pk_mul_f32 v[74:75], v[186:187], v[18:19]
  v_pk_mul_f32 v[78:79], v[188:189], v[20:21]
  v_pk_mul_f32 v[82:83], v[190:191], v[22:23]
  v_pk_fma_f32 v[52:53], v[52:53], v[86:87], v[248:249]
  v_pk_fma_f32 v[56:57], v[56:57], v[86:87], v[248:249]
  v_pk_fma_f32 v[60:61], v[60:61], v[86:87], v[248:249]
  v_pk_fma_f32 v[64:65], v[64:65], v[86:87], v[248:249]
  v_pk_fma_f32 v[68:69], v[68:69], v[86:87], v[248:249]
  v_pk_fma_f32 v[72:73], v[72:73], v[86:87], v[248:249]
  v_pk_fma_f32 v[76:77], v[76:77], v[86:87], v[248:249]
  v_pk_fma_f32 v[80:81], v[80:81], v[86:87], v[248:249]
  v_pk_mul_f32 v[54:55], v[54:55], v[56:57]
  v_pk_mul_f32 v[62:63], v[62:63], v[64:65]
  v_pk_mul_f32 v[70:71], v[70:71], v[72:73]
  v_pk_mul_f32 v[78:79], v[78:79], v[80:81]
  v_pk_fma_f32 v[54:55], v[58:59], v[52:53], v[54:55]
  v_pk_fma_f32 v[62:63], v[66:67], v[60:61], v[62:63]
  v_pk_fma_f32 v[70:71], v[74:75], v[68:69], v[70:71]
  v_pk_fma_f32 v[78:79], v[82:83], v[76:77], v[78:79]
  v_pk_mul_f32 v[52:53], v[52:53], v[56:57]
  v_pk_mul_f32 v[60:61], v[60:61], v[64:65]
  v_pk_mul_f32 v[68:69], v[68:69], v[72:73]
  v_pk_mul_f32 v[76:77], v[76:77], v[80:81]
  v_pk_mul_f32 v[54:55], v[54:55], v[60:61]
  v_pk_mul_f32 v[70:71], v[70:71], v[76:77]
  v_pk_fma_f32 v[54:55], v[62:63], v[52:53], v[54:55]
  v_pk_fma_f32 v[70:71], v[78:79], v[68:69], v[70:71]
  v_pk_mul_f32 v[52:53], v[52:53], v[60:61]
  v_pk_mul_f32 v[68:69], v[68:69], v[76:77]
  v_rcp_f32 v52, v52
  v_rcp_f32 v53, v53
  v_rcp_f32 v68, v68
  v_rcp_f32 v69, v69
  v_pk_mul_f32 v[42:43], v[52:53], v[54:55]
  v_pk_mul_f32 v[44:45], v[68:69], v[70:71]
  v_pk_mul_f32 v[52:53], v[176:177], v[176:177]
  v_pk_mul_f32 v[56:57], v[178:179], v[178:179]
  v_pk_mul_f32 v[60:61], v[180:181], v[180:181]
  v_pk_mul_f32 v[64:65], v[182:183], v[182:183]
  v_pk_mul_f32 v[68:69], v[192:193], v[192:193]
  v_pk_mul_f32 v[72:73], v[194:195], v[194:195]
  v_pk_mul_f32 v[76:77], v[196:197], v[196:197]
  v_pk_mul_f32 v[80:81], v[198:199], v[198:199]
  v_pk_fma_f32 v[52:53], v[52:53], v[14:15], v[12:13]
  v_pk_fma_f32 v[56:57], v[56:57], v[14:15], v[12:13]
  v_pk_fma_f32 v[60:61], v[60:61], v[14:15], v[12:13]
  v_pk_fma_f32 v[64:65], v[64:65], v[14:15], v[12:13]
  v_pk_fma_f32 v[68:69], v[68:69], v[14:15], v[12:13]
  v_pk_fma_f32 v[72:73], v[72:73], v[14:15], v[12:13]
  v_pk_fma_f32 v[76:77], v[76:77], v[14:15], v[12:13]
  v_pk_fma_f32 v[80:81], v[80:81], v[14:15], v[12:13]
  v_pk_fma_f32 v[52:53], v[52:53], v[176:177], v[84:85]
  v_pk_fma_f32 v[56:57], v[56:57], v[178:179], v[84:85]
  v_pk_fma_f32 v[60:61], v[60:61], v[180:181], v[84:85]
  v_pk_fma_f32 v[64:65], v[64:65], v[182:183], v[84:85]
  v_pk_fma_f32 v[68:69], v[68:69], v[192:193], v[84:85]
  v_pk_fma_f32 v[72:73], v[72:73], v[194:195], v[84:85]
  v_pk_fma_f32 v[76:77], v[76:77], v[196:197], v[84:85]
  v_pk_fma_f32 v[80:81], v[80:81], v[198:199], v[84:85]
  v_exp_f32 v52, v52 clamp
  v_exp_f32 v53, v53 clamp
  v_exp_f32 v56, v56 clamp
  v_exp_f32 v57, v57 clamp
  v_exp_f32 v60, v60 clamp
  v_exp_f32 v61, v61 clamp
  v_exp_f32 v64, v64 clamp
  v_exp_f32 v65, v65 clamp
  v_exp_f32 v68, v68 clamp
  v_exp_f32 v69, v69 clamp
  v_exp_f32 v72, v72 clamp
  v_exp_f32 v73, v73 clamp
  v_exp_f32 v76, v76 clamp
  v_exp_f32 v77, v77 clamp
  v_exp_f32 v80, v80 clamp
  v_exp_f32 v81, v81 clamp
  v_pk_mul_f32 v[54:55], v[176:177], v[24:25]
  v_pk_mul_f32 v[58:59], v[178:179], v[26:27]
  v_pk_mul_f32 v[62:63], v[180:181], v[28:29]
  v_pk_mul_f32 v[66:67], v[182:183], v[30:31]
  v_pk_mul_f32 v[70:71], v[192:193], v[24:25]
  v_pk_mul_f32 v[74:75], v[194:195], v[26:27]
  v_pk_mul_f32 v[78:79], v[196:197], v[28:29]
  v_pk_mul_f32 v[82:83], v[198:199], v[30:31]
  v_pk_fma_f32 v[52:53], v[52:53], v[86:87], v[248:249]
  v_pk_fma_f32 v[56:57], v[56:57], v[86:87], v[248:249]
  v_pk_fma_f32 v[60:61], v[60:61], v[86:87], v[248:249]
  v_pk_fma_f32 v[64:65], v[64:65], v[86:87], v[248:249]
  v_pk_fma_f32 v[68:69], v[68:69], v[86:87], v[248:249]
  v_pk_fma_f32 v[72:73], v[72:73], v[86:87], v[248:249]
  v_pk_fma_f32 v[76:77], v[76:77], v[86:87], v[248:249]
  v_pk_fma_f32 v[80:81], v[80:81], v[86:87], v[248:249]
  v_pk_mul_f32 v[54:55], v[54:55], v[56:57]
  v_pk_mul_f32 v[62:63], v[62:63], v[64:65]
  v_pk_mul_f32 v[70:71], v[70:71], v[72:73]
  v_pk_mul_f32 v[78:79], v[78:79], v[80:81]
  v_pk_fma_f32 v[54:55], v[58:59], v[52:53], v[54:55]
  v_pk_fma_f32 v[62:63], v[66:67], v[60:61], v[62:63]
  v_pk_fma_f32 v[70:71], v[74:75], v[68:69], v[70:71]
  v_pk_fma_f32 v[78:79], v[82:83], v[76:77], v[78:79]
  v_pk_mul_f32 v[52:53], v[52:53], v[56:57]
  v_pk_mul_f32 v[60:61], v[60:61], v[64:65]
  v_pk_mul_f32 v[68:69], v[68:69], v[72:73]
  v_pk_mul_f32 v[76:77], v[76:77], v[80:81]
  v_pk_mul_f32 v[54:55], v[54:55], v[60:61]
  v_pk_mul_f32 v[70:71], v[70:71], v[76:77]
  v_pk_fma_f32 v[54:55], v[62:63], v[52:53], v[54:55]
  v_pk_fma_f32 v[70:71], v[78:79], v[68:69], v[70:71]
  v_pk_mul_f32 v[52:53], v[52:53], v[60:61]
  v_pk_mul_f32 v[68:69], v[68:69], v[76:77]
  v_rcp_f32 v52, v52
  v_rcp_f32 v53, v53
  v_rcp_f32 v68, v68
  v_rcp_f32 v69, v69
  v_pk_fma_f32 v[42:43], v[52:53], v[54:55], v[42:43]
  v_pk_fma_f32 v[44:45], v[68:69], v[70:71], v[44:45]
  v_pk_mul_f32 v[52:53], v[200:201], v[200:201]
  v_pk_mul_f32 v[56:57], v[202:203], v[202:203]
  v_pk_mul_f32 v[60:61], v[204:205], v[204:205]
  v_pk_mul_f32 v[64:65], v[206:207], v[206:207]
  v_pk_mul_f32 v[68:69], v[216:217], v[216:217]
  v_pk_mul_f32 v[72:73], v[218:219], v[218:219]
  v_pk_mul_f32 v[76:77], v[220:221], v[220:221]
  v_pk_mul_f32 v[80:81], v[222:223], v[222:223]
  v_pk_fma_f32 v[52:53], v[52:53], v[14:15], v[12:13]
  v_pk_fma_f32 v[56:57], v[56:57], v[14:15], v[12:13]
  v_pk_fma_f32 v[60:61], v[60:61], v[14:15], v[12:13]
  v_pk_fma_f32 v[64:65], v[64:65], v[14:15], v[12:13]
  v_pk_fma_f32 v[68:69], v[68:69], v[14:15], v[12:13]
  v_pk_fma_f32 v[72:73], v[72:73], v[14:15], v[12:13]
  v_pk_fma_f32 v[76:77], v[76:77], v[14:15], v[12:13]
  v_pk_fma_f32 v[80:81], v[80:81], v[14:15], v[12:13]
  v_pk_fma_f32 v[52:53], v[52:53], v[200:201], v[84:85]
  v_pk_fma_f32 v[56:57], v[56:57], v[202:203], v[84:85]
  v_pk_fma_f32 v[60:61], v[60:61], v[204:205], v[84:85]
  v_pk_fma_f32 v[64:65], v[64:65], v[206:207], v[84:85]
  v_pk_fma_f32 v[68:69], v[68:69], v[216:217], v[84:85]
  v_pk_fma_f32 v[72:73], v[72:73], v[218:219], v[84:85]
  v_pk_fma_f32 v[76:77], v[76:77], v[220:221], v[84:85]
  v_pk_fma_f32 v[80:81], v[80:81], v[222:223], v[84:85]
  v_exp_f32 v52, v52 clamp
  v_exp_f32 v53, v53 clamp
  v_exp_f32 v56, v56 clamp
  v_exp_f32 v57, v57 clamp
  v_exp_f32 v60, v60 clamp
  v_exp_f32 v61, v61 clamp
  v_exp_f32 v64, v64 clamp
  v_exp_f32 v65, v65 clamp
  v_exp_f32 v68, v68 clamp
  v_exp_f32 v69, v69 clamp
  v_exp_f32 v72, v72 clamp
  v_exp_f32 v73, v73 clamp
  v_exp_f32 v76, v76 clamp
  v_exp_f32 v77, v77 clamp
  v_exp_f32 v80, v80 clamp
  v_exp_f32 v81, v81 clamp
  v_pk_mul_f32 v[54:55], v[200:201], v[16:17]
  v_pk_mul_f32 v[58:59], v[202:203], v[18:19]
  v_pk_mul_f32 v[62:63], v[204:205], v[20:21]
  v_pk_mul_f32 v[66:67], v[206:207], v[22:23]
  v_pk_mul_f32 v[70:71], v[216:217], v[16:17]
  v_pk_mul_f32 v[74:75], v[218:219], v[18:19]
  v_pk_mul_f32 v[78:79], v[220:221], v[20:21]
  v_pk_mul_f32 v[82:83], v[222:223], v[22:23]
  v_pk_fma_f32 v[52:53], v[52:53], v[86:87], v[248:249]
  v_pk_fma_f32 v[56:57], v[56:57], v[86:87], v[248:249]
  v_pk_fma_f32 v[60:61], v[60:61], v[86:87], v[248:249]
  v_pk_fma_f32 v[64:65], v[64:65], v[86:87], v[248:249]
  v_pk_fma_f32 v[68:69], v[68:69], v[86:87], v[248:249]
  v_pk_fma_f32 v[72:73], v[72:73], v[86:87], v[248:249]
  v_pk_fma_f32 v[76:77], v[76:77], v[86:87], v[248:249]
  v_pk_fma_f32 v[80:81], v[80:81], v[86:87], v[248:249]
  v_pk_mul_f32 v[54:55], v[54:55], v[56:57]
  v_pk_mul_f32 v[62:63], v[62:63], v[64:65]
  v_pk_mul_f32 v[70:71], v[70:71], v[72:73]
  v_pk_mul_f32 v[78:79], v[78:79], v[80:81]
  v_pk_fma_f32 v[54:55], v[58:59], v[52:53], v[54:55]
  v_pk_fma_f32 v[62:63], v[66:67], v[60:61], v[62:63]
  v_pk_fma_f32 v[70:71], v[74:75], v[68:69], v[70:71]
  v_pk_fma_f32 v[78:79], v[82:83], v[76:77], v[78:79]
  v_pk_mul_f32 v[52:53], v[52:53], v[56:57]
  v_pk_mul_f32 v[60:61], v[60:61], v[64:65]
  v_pk_mul_f32 v[68:69], v[68:69], v[72:73]
  v_pk_mul_f32 v[76:77], v[76:77], v[80:81]
  v_pk_mul_f32 v[54:55], v[54:55], v[60:61]
  v_pk_mul_f32 v[70:71], v[70:71], v[76:77]
  v_pk_fma_f32 v[54:55], v[62:63], v[52:53], v[54:55]
  v_pk_fma_f32 v[70:71], v[78:79], v[68:69], v[70:71]
  v_pk_mul_f32 v[52:53], v[52:53], v[60:61]
  v_pk_mul_f32 v[68:69], v[68:69], v[76:77]
  v_rcp_f32 v52, v52
  v_rcp_f32 v53, v53
  v_rcp_f32 v68, v68
  v_rcp_f32 v69, v69
  v_pk_mul_f32 v[46:47], v[52:53], v[54:55]
  v_pk_mul_f32 v[48:49], v[68:69], v[70:71]
  v_pk_mul_f32 v[52:53], v[208:209], v[208:209]
  v_pk_mul_f32 v[56:57], v[210:211], v[210:211]
  v_pk_mul_f32 v[60:61], v[212:213], v[212:213]
  v_pk_mul_f32 v[64:65], v[214:215], v[214:215]
  v_pk_mul_f32 v[68:69], v[224:225], v[224:225]
  v_pk_mul_f32 v[72:73], v[226:227], v[226:227]
  v_pk_mul_f32 v[76:77], v[228:229], v[228:229]
  v_pk_mul_f32 v[80:81], v[230:231], v[230:231]
  v_pk_fma_f32 v[52:53], v[52:53], v[14:15], v[12:13]
  v_pk_fma_f32 v[56:57], v[56:57], v[14:15], v[12:13]
  v_pk_fma_f32 v[60:61], v[60:61], v[14:15], v[12:13]
  v_pk_fma_f32 v[64:65], v[64:65], v[14:15], v[12:13]
  v_pk_fma_f32 v[68:69], v[68:69], v[14:15], v[12:13]
  v_pk_fma_f32 v[72:73], v[72:73], v[14:15], v[12:13]
  v_pk_fma_f32 v[76:77], v[76:77], v[14:15], v[12:13]
  v_pk_fma_f32 v[80:81], v[80:81], v[14:15], v[12:13]
  v_pk_fma_f32 v[52:53], v[52:53], v[208:209], v[84:85]
  v_pk_fma_f32 v[56:57], v[56:57], v[210:211], v[84:85]
  v_pk_fma_f32 v[60:61], v[60:61], v[212:213], v[84:85]
  v_pk_fma_f32 v[64:65], v[64:65], v[214:215], v[84:85]
  v_pk_fma_f32 v[68:69], v[68:69], v[224:225], v[84:85]
  v_pk_fma_f32 v[72:73], v[72:73], v[226:227], v[84:85]
  v_pk_fma_f32 v[76:77], v[76:77], v[228:229], v[84:85]
  v_pk_fma_f32 v[80:81], v[80:81], v[230:231], v[84:85]
  v_exp_f32 v52, v52 clamp
  v_exp_f32 v53, v53 clamp
  v_exp_f32 v56, v56 clamp
  v_exp_f32 v57, v57 clamp
  v_exp_f32 v60, v60 clamp
  v_exp_f32 v61, v61 clamp
  v_exp_f32 v64, v64 clamp
  v_exp_f32 v65, v65 clamp
  v_exp_f32 v68, v68 clamp
  v_exp_f32 v69, v69 clamp
  v_exp_f32 v72, v72 clamp
  v_exp_f32 v73, v73 clamp
  v_exp_f32 v76, v76 clamp
  v_exp_f32 v77, v77 clamp
  v_exp_f32 v80, v80 clamp
  v_exp_f32 v81, v81 clamp
  v_pk_mul_f32 v[54:55], v[208:209], v[24:25]
  v_pk_mul_f32 v[58:59], v[210:211], v[26:27]
  v_pk_mul_f32 v[62:63], v[212:213], v[28:29]
  v_pk_mul_f32 v[66:67], v[214:215], v[30:31]
  v_pk_mul_f32 v[70:71], v[224:225], v[24:25]
  v_pk_mul_f32 v[74:75], v[226:227], v[26:27]
  v_pk_mul_f32 v[78:79], v[228:229], v[28:29]
  v_pk_mul_f32 v[82:83], v[230:231], v[30:31]
  v_pk_fma_f32 v[52:53], v[52:53], v[86:87], v[248:249]
  v_pk_fma_f32 v[56:57], v[56:57], v[86:87], v[248:249]
  v_pk_fma_f32 v[60:61], v[60:61], v[86:87], v[248:249]
  v_pk_fma_f32 v[64:65], v[64:65], v[86:87], v[248:249]
  v_pk_fma_f32 v[68:69], v[68:69], v[86:87], v[248:249]
  v_pk_fma_f32 v[72:73], v[72:73], v[86:87], v[248:249]
  v_pk_fma_f32 v[76:77], v[76:77], v[86:87], v[248:249]
  v_pk_fma_f32 v[80:81], v[80:81], v[86:87], v[248:249]
  v_pk_mul_f32 v[54:55], v[54:55], v[56:57]
  v_pk_mul_f32 v[62:63], v[62:63], v[64:65]
  v_pk_mul_f32 v[70:71], v[70:71], v[72:73]
  v_pk_mul_f32 v[78:79], v[78:79], v[80:81]
  v_pk_fma_f32 v[54:55], v[58:59], v[52:53], v[54:55]
  v_pk_fma_f32 v[62:63], v[66:67], v[60:61], v[62:63]
  v_pk_fma_f32 v[70:71], v[74:75], v[68:69], v[70:71]
  v_pk_fma_f32 v[78:79], v[82:83], v[76:77], v[78:79]
  v_pk_mul_f32 v[52:53], v[52:53], v[56:57]
  v_pk_mul_f32 v[60:61], v[60:61], v[64:65]
  v_pk_mul_f32 v[68:69], v[68:69], v[72:73]
  v_pk_mul_f32 v[76:77], v[76:77], v[80:81]
  v_pk_mul_f32 v[54:55], v[54:55], v[60:61]
  v_pk_mul_f32 v[70:71], v[70:71], v[76:77]
  v_pk_fma_f32 v[54:55], v[62:63], v[52:53], v[54:55]
  v_pk_fma_f32 v[70:71], v[78:79], v[68:69], v[70:71]
  v_pk_mul_f32 v[52:53], v[52:53], v[60:61]
  v_pk_mul_f32 v[68:69], v[68:69], v[76:77]
  v_rcp_f32 v52, v52
  v_rcp_f32 v53, v53
  v_rcp_f32 v68, v68
  v_rcp_f32 v69, v69
  v_pk_fma_f32 v[46:47], v[52:53], v[54:55], v[46:47]
  v_pk_fma_f32 v[48:49], v[68:69], v[70:71], v[48:49]
  v_pk_mul_f32 v[52:53], v[232:233], v[232:233]
  v_pk_mul_f32 v[56:57], v[234:235], v[234:235]
  v_pk_mul_f32 v[60:61], v[236:237], v[236:237]
  v_pk_mul_f32 v[64:65], v[238:239], v[238:239]
  v_pk_mul_f32 v[68:69], v[240:241], v[240:241]
  v_pk_mul_f32 v[72:73], v[242:243], v[242:243]
  v_pk_mul_f32 v[76:77], v[244:245], v[244:245]
  v_pk_mul_f32 v[80:81], v[246:247], v[246:247]
  v_pk_fma_f32 v[52:53], v[52:53], v[14:15], v[12:13]
  v_pk_fma_f32 v[56:57], v[56:57], v[14:15], v[12:13]
  v_pk_fma_f32 v[60:61], v[60:61], v[14:15], v[12:13]
  v_pk_fma_f32 v[64:65], v[64:65], v[14:15], v[12:13]
  v_pk_fma_f32 v[68:69], v[68:69], v[14:15], v[12:13]
  v_pk_fma_f32 v[72:73], v[72:73], v[14:15], v[12:13]
  v_pk_fma_f32 v[76:77], v[76:77], v[14:15], v[12:13]
  v_pk_fma_f32 v[80:81], v[80:81], v[14:15], v[12:13]
  v_pk_fma_f32 v[52:53], v[52:53], v[232:233], v[84:85]
  v_pk_fma_f32 v[56:57], v[56:57], v[234:235], v[84:85]
  v_pk_fma_f32 v[60:61], v[60:61], v[236:237], v[84:85]
  v_pk_fma_f32 v[64:65], v[64:65], v[238:239], v[84:85]
  v_pk_fma_f32 v[68:69], v[68:69], v[240:241], v[84:85]
  v_pk_fma_f32 v[72:73], v[72:73], v[242:243], v[84:85]
  v_pk_fma_f32 v[76:77], v[76:77], v[244:245], v[84:85]
  v_pk_fma_f32 v[80:81], v[80:81], v[246:247], v[84:85]
  v_exp_f32 v52, v52 clamp
  v_exp_f32 v53, v53 clamp
  v_exp_f32 v56, v56 clamp
  v_exp_f32 v57, v57 clamp
  v_exp_f32 v60, v60 clamp
  v_exp_f32 v61, v61 clamp
  v_exp_f32 v64, v64 clamp
  v_exp_f32 v65, v65 clamp
  v_exp_f32 v68, v68 clamp
  v_exp_f32 v69, v69 clamp
  v_exp_f32 v72, v72 clamp
  v_exp_f32 v73, v73 clamp
  v_exp_f32 v76, v76 clamp
  v_exp_f32 v77, v77 clamp
  v_exp_f32 v80, v80 clamp
  v_exp_f32 v81, v81 clamp
  v_pk_mul_f32 v[54:55], v[232:233], v[16:17]
  v_pk_mul_f32 v[58:59], v[234:235], v[18:19]
  v_pk_mul_f32 v[62:63], v[236:237], v[20:21]
  v_pk_mul_f32 v[66:67], v[238:239], v[22:23]
  v_pk_mul_f32 v[70:71], v[240:241], v[24:25]
  v_pk_mul_f32 v[74:75], v[242:243], v[26:27]
  v_pk_mul_f32 v[78:79], v[244:245], v[28:29]
  v_pk_mul_f32 v[82:83], v[246:247], v[30:31]
  v_pk_fma_f32 v[52:53], v[52:53], v[86:87], v[248:249]
  v_pk_fma_f32 v[56:57], v[56:57], v[86:87], v[248:249]
  v_pk_fma_f32 v[60:61], v[60:61], v[86:87], v[248:249]
  v_pk_fma_f32 v[64:65], v[64:65], v[86:87], v[248:249]
  v_pk_fma_f32 v[68:69], v[68:69], v[86:87], v[248:249]
  v_pk_fma_f32 v[72:73], v[72:73], v[86:87], v[248:249]
  v_pk_fma_f32 v[76:77], v[76:77], v[86:87], v[248:249]
  v_pk_fma_f32 v[80:81], v[80:81], v[86:87], v[248:249]
  v_pk_mul_f32 v[54:55], v[54:55], v[56:57]
  v_pk_mul_f32 v[62:63], v[62:63], v[64:65]
  v_pk_mul_f32 v[70:71], v[70:71], v[72:73]
  v_pk_mul_f32 v[78:79], v[78:79], v[80:81]
  v_pk_fma_f32 v[54:55], v[58:59], v[52:53], v[54:55]
  v_pk_fma_f32 v[62:63], v[66:67], v[60:61], v[62:63]
  v_pk_fma_f32 v[70:71], v[74:75], v[68:69], v[70:71]
  v_pk_fma_f32 v[78:79], v[82:83], v[76:77], v[78:79]
  v_pk_mul_f32 v[52:53], v[52:53], v[56:57]
  v_pk_mul_f32 v[60:61], v[60:61], v[64:65]
  v_pk_mul_f32 v[68:69], v[68:69], v[72:73]
  v_pk_mul_f32 v[76:77], v[76:77], v[80:81]
  v_pk_mul_f32 v[54:55], v[54:55], v[60:61]
  v_pk_mul_f32 v[70:71], v[70:71], v[76:77]
  v_pk_fma_f32 v[54:55], v[62:63], v[52:53], v[54:55]
  v_pk_fma_f32 v[70:71], v[78:79], v[68:69], v[70:71]
  v_pk_mul_f32 v[52:53], v[52:53], v[60:61]
  v_pk_mul_f32 v[68:69], v[68:69], v[76:77]
  v_rcp_f32 v52, v52
  v_rcp_f32 v53, v53
  v_rcp_f32 v68, v68
  v_rcp_f32 v69, v69
  v_pk_mul_f32 v[50:51], v[52:53], v[54:55]
  v_pk_fma_f32 v[50:51], v[68:69], v[70:71], v[50:51]
  v_pk_mul_f32 v[32:33], v[88:89], v[16:17]
  v_pk_fma_f32 v[32:33], v[90:91], v[18:19], v[32:33]
  v_pk_fma_f32 v[32:33], v[92:93], v[20:21], v[32:33]
  v_pk_fma_f32 v[32:33], v[94:95], v[22:23], v[32:33]
  v_pk_fma_f32 v[32:33], v[96:97], v[24:25], v[32:33]
  v_pk_fma_f32 v[32:33], v[98:99], v[26:27], v[32:33]
  v_pk_fma_f32 v[32:33], v[100:101], v[28:29], v[32:33]
  v_pk_fma_f32 v[32:33], v[102:103], v[30:31], v[32:33]
  v_add_f32 v32, v32, v33
  v_add_f32 v34, v34, v35
  v_add_f32 v36, v36, v37
  v_add_f32 v38, v38, v39
  v_add_f32 v40, v40, v41
  v_add_f32 v42, v42, v43
  v_add_f32 v44, v44, v45
  v_add_f32 v46, v46, v47
  v_add_f32 v48, v48, v49
  v_add_f32 v50, v50, v51
  v_permlane32_swap_b32 v32, v34
  v_permlane32_swap_b32 v36, v38
  v_permlane32_swap_b32 v40, v42
  v_permlane32_swap_b32 v44, v46
  v_permlane32_swap_b32 v48, v50
  v_add_f32 v48, v48, v50
  v_add_f32 v32, v32, v34
  v_add_f32 v36, v36, v38
  v_add_f32 v40, v40, v42
  v_add_f32 v44, v44, v46
  v_mov_b32 v50, v48
  v_permlane16_swap_b32 v32, v36
  v_permlane16_swap_b32 v40, v44
  v_permlane16_swap_b32 v48, v50
  v_add_f32 v32, v32, v36
  v_add_f32 v40, v40, v44
  v_add_f32 v48, v48, v50
  ds_write_b32 v10, v32
  ds_write_b32 v10, v40 offset:256
  s_mov_b32 exec_lo, 0xffff
  s_mov_b32 exec_hi, 0xffff
  ds_write_b32 v10, v48 offset:512
  s_mov_b64 exec, -1
  s_waitcnt lgkmcnt(0)
  s_barrier
  s_endpgm
L_ld_tail:
  s_barrier
  s_mov_b32 s60, s24
  s_and_b32 s61, s25, 0xffff
  s_mov_b32 s62, 268435456
  s_mov_b32 s63, 0x20000
  s_mov_b32 s56, s20
  s_and_b32 s57, s21, 0xffff
  s_mov_b32 s58, 8192
  s_mov_b32 s59, 0x20000
  s_mov_b32 s64, s22
  s_and_b32 s65, s23, 0xffff
  s_mov_b32 s66, 256
  s_mov_b32 s67, 0x20000
  s_load_dword s80, s[18:19], 0
  v_mov_b32 v100, 0
  s_mov_b64 exec, 1
  s_mov_b32 s81, 0x80000
  buffer_load_dword v101, v100, s[60:63], s81 offen
  buffer_load_dword v102, v100, s[56:59], 0 offen
  s_mov_b64 exec, -1
  s_mov_b64 exec, 1
  buffer_load_dword v250, v100, s[64:67], 0 offen offset:240 sc1
  s_mov_b64 exec, -1
  s_cmp_lg_u32 s3, 4
  s_cbranch_scc1 L_end
  v_lshlrev_b32 v3, 4, v0
  v_lshlrev_b32 v4, 2, v0
  v_add_u32 v1, 123392, v3
  v_add_u32 v2, 124416, v4
  v_add_u32 v4, 1024, v4
  v_mov_b32 v5, 32
  v_mov_b32 v7, s26
  s_mul_i32 s68, s26, 1280
  s_mul_i32 s69, s27, 16640
  s_add_u32 s69, s69, s68
  s_setprio 3
  v_mov_b32 v64, -1
  v_mov_b32 v65, -1
  v_mov_b32 v66, -1
  v_mov_b32 v67, -1
  buffer_store_dwordx4 v[64:67], v3, s[60:63], s69 offen sc1
  buffer_store_dword v64, v4, s[60:63], s69 offen sc1
  s_waitcnt vmcnt(0)
  s_barrier
  ds_read_b128 v[64:67], v1
  ds_read_b128 v[72:75], v1 offset:1280
  ds_read2st64_b32 v[68:69], v2 offset0:0 offset1:5
  s_waitcnt lgkmcnt(0)
  v_pk_add_f32 v[64:65], v[64:65], v[72:73]
  v_pk_add_f32 v[66:67], v[66:67], v[74:75]
  v_add_f32 v68, v68, v69
  v_min_u32 v64, -2, v64
  v_min_u32 v65, -2, v65
  v_min_u32 v66, -2, v66
  v_min_u32 v67, -2, v67
  v_min_u32 v68, -2, v68
  buffer_store_dwordx4 v[64:67], v3, s[60:63], s69 offen sc1
  buffer_store_dword v68, v4, s[60:63], s69 offen sc1
  s_mov_b64 exec, 1
L_pub:
  v_lshlrev_b32 v6, 4, v7
  v_mov_b32 v13, v5
  buffer_atomic_add v5, v6, s[64:67], 0 offen sc0
  v_cmp_eq_u32 vcc, 12, v7
  v_mov_b32 v8, 436
  v_mov_b32 v9, 434
  v_cndmask_b32 v8, v8, v9, vcc
  v_sub_u32 v8, v8, v13
  s_waitcnt vmcnt(0) lgkmcnt(0)
  v_cmp_eq_u32 s[82:83], v5, v8
  s_mov_b64 exec, -1
  s_lshl_b32 s80, s80, 16
  v_lshrrev_b32 v1, 1, v3
  v_lshrrev_b32_e64 v2, 1, v4
L_fin:
  s_cmp_eq_u32 s82, 0
  s_cbranch_scc1 L_done
  s_ff1_i32_b32 s70, s82
  s_bitset0_b32 s82, s70
  v_readlane_b32 s71, v7, s70
  s_waitcnt vmcnt(0)
L_again:
  s_mul_i32 s68, s71, 1280
  buffer_load_dwordx4 v[64:67], v3, s[60:63], s68 offen sc1
  buffer_load_dword v68, v4, s[60:63], s68 offen sc1
  s_add_u32 s68, s68, 16640
  buffer_load_dwordx4 v[72:75], v3, s[60:63], s68 offen sc1
  buffer_load_dword v76, v4, s[60:63], s68 offen sc1
  s_add_u32 s68, s68, 16640
  buffer_load_dwordx4 v[80:83], v3, s[60:63], s68 offen sc1
  buffer_load_dword v84, v4, s[60:63], s68 offen sc1
  s_add_u32 s68, s68, 16640
  buffer_load_dwordx4 v[88:91], v3, s[60:63], s68 offen sc1
  buffer_load_dword v92, v4, s[60:63], s68 offen sc1
  s_add_u32 s68, s68, 16640
  buffer_load_dwordx4 v[96:99], v3, s[60:63], s68 offen sc1
  buffer_load_dword v100, v4, s[60:63], s68 offen sc1
  s_add_u32 s68, s68, 16640
  buffer_load_dwordx4 v[104:107], v3, s[60:63], s68 offen sc1
  buffer_load_dword v108, v4, s[60:63], s68 offen sc1
  s_add_u32 s68, s68, 16640
  buffer_load_dwordx4 v[112:115], v3, s[60:63], s68 offen sc1
  buffer_load_dword v116, v4, s[60:63], s68 offen sc1
  s_add_u32 s68, s68, 16640
  buffer_load_dwordx4 v[120:123], v3, s[60:63], s68 offen sc1
  buffer_load_dword v124, v4, s[60:63], s68 offen sc1
  s_add_u32 s68, s68, 16640
  buffer_load_dwordx4 v[128:131], v3, s[60:63], s68 offen sc1
  buffer_load_dword v132, v4, s[60:63], s68 offen sc1
  s_add_u32 s68, s68, 16640
  buffer_load_dwordx4 v[136:139], v3, s[60:63], s68 offen sc1
  buffer_load_dword v140, v4, s[60:63], s68 offen sc1
  s_add_u32 s68, s68, 16640
  buffer_load_dwordx4 v[144:147], v3, s[60:63], s68 offen sc1
  buffer_load_dword v148, v4, s[60:63], s68 offen sc1
  s_add_u32 s68, s68, 16640
  buffer_load_dwordx4 v[152:155], v3, s[60:63], s68 offen sc1
  buffer_load_dword v156, v4, s[60:63], s68 offen sc1
  s_add_u32 s68, s68, 16640
  buffer_load_dwordx4 v[160:163], v3, s[60:63], s68 offen sc1
  buffer_load_dword v164, v4, s[60:63], s68 offen sc1
  s_add_u32 s68, s68, 16640
  buffer_load_dwordx4 v[168:171], v3, s[60:63], s68 offen sc1
  buffer_load_dword v172, v4, s[60:63], s68 offen sc1
  s_add_u32 s68, s68, 16640
L_sum:
  s_waitcnt vmcnt(25)
  v_pk_add_f32 v[56:57], v[64:65], v[72:73]
  v_pk_add_f32 v[58:59], v[66:67], v[74:75]
  s_waitcnt vmcnt(24)
  v_add_f32 v60, v68, v76
  s_waitcnt vmcnt(23)
  v_pk_add_f32 v[56:57], v[56:57], v[80:81]
  v_pk_add_f32 v[58:59], v[58:59], v[82:83]
  s_waitcnt vmcnt(22)
  v_add_f32 v60, v60, v84
  s_waitcnt vmcnt(21)
  v_pk_add_f32 v[56:57], v[56:57], v[88:89]
  v_pk_add_f32 v[58:59], v[58:59], v[90:91]
  s_waitcnt vmcnt(20)
  v_add_f32 v60, v60, v92
  s_waitcnt vmcnt(19)
  v_pk_add_f32 v[56:57], v[56:57], v[96:97]
  v_pk_add_f32 v[58:59], v[58:59], v[98:99]
  s_waitcnt vmcnt(18)
  v_add_f32 v60, v60, v100
  s_waitcnt vmcnt(17)
  v_pk_add_f32 v[56:57], v[56:57], v[104:105]
  v_pk_add_f32 v[58:59], v[58:59], v[106:107]
  s_waitcnt vmcnt(16)
  v_add_f32 v60, v60, v108
  s_waitcnt vmcnt(15)
  v_pk_add_f32 v[56:57], v[56:57], v[112:113]
  v_pk_add_f32 v[58:59], v[58:59], v[114:115]
  s_waitcnt vmcnt(14)
  v_add_f32 v60, v60, v116
  s_waitcnt vmcnt(13)
  v_pk_add_f32 v[56:57], v[56:57], v[120:121]
  v_pk_add_f32 v[58:59], v[58:59], v[122:123]
  s_waitcnt vmcnt(12)
  v_add_f32 v60, v60, v124
  s_waitcnt vmcnt(11)
  v_pk_add_f32 v[56:57], v[56:57], v[128:129]
  v_pk_add_f32 v[58:59], v[58:59], v[130:131]
  s_waitcnt vmcnt(10)
  v_add_f32_e64 v60, v60, v132
  s_waitcnt vmcnt(9)
  v_pk_add_f32 v[56:57], v[56:57], v[136:137]
  v_pk_add_f32 v[58:59], v[58:59], v[138:139]
  s_waitcnt vmcnt(8)
  v_add_f32 v60, v60, v140
  s_waitcnt vmcnt(7)
  v_pk_add_f32 v[56:57], v[56:57], v[144:145]
  v_pk_add_f32 v[58:59], v[58:59], v[146:147]
  s_waitcnt vmcnt(6)
  v_add_f32 v60, v60, v148
  s_waitcnt vmcnt(5)
  v_pk_add_f32 v[56:57], v[56:57], v[152:153]
  v_pk_add_f32 v[58:59], v[58:59], v[154:155]
  s_waitcnt vmcnt(4)
  v_add_f32 v60, v60, v156
  s_waitcnt vmcnt(3)
  v_pk_add_f32 v[56:57], v[56:57], v[160:161]
  v_pk_add_f32 v[58:59], v[58:59], v[162:163]
  s_waitcnt vmcnt(2)
  v_add_f32 v60, v60, v164
  s_waitcnt vmcnt(1)
  v_pk_add_f32 v[56:57], v[56:57], v[168:169]
  v_pk_add_f32 v[58:59], v[58:59], v[170:171]
  s_waitcnt vmcnt(0)
  v_add_f32 v60, v60, v172
  v_cmp_u_f32 vcc, v56, v57
  v_cmp_u_f32 s[92:93], v58, v59
  s_nop 0
  s_or_b64 s[92:93], s[92:93], vcc
  v_cmp_u_f32 vcc, v60, v60
  s_nop 0
  s_or_b64 vcc, s[92:93], vcc
  s_cbranch_vccnz L_chk
L_ok:
  s_mul_i32 s71, s71, 640
  v_add_f32 v56, s80, v56
  v_add_f32 v57, s80, v57
  v_add_f32 v58, s80, v58
  v_add_f32 v59, s80, v59
  v_add_f32 v60, s80, v60
  v_cvt_pk_bf16_f32 v10, v56, v57
  v_cvt_pk_bf16_f32 v11, v58, v59
  v_cvt_pk_bf16_f32 v12, v60, v60
  buffer_store_dwordx2 v[10:11], v1, s[56:59], s71 offen
  buffer_store_short v12, v2, s[56:59], s71 offen
  s_branch L_fin
L_chk:
  v_mov_b32 v14, 0
  v_mov_b32_e64 v15, 0
  v_max3_u32 v14, v14, v64, v65
  v_max3_u32 v14, v14, v66, v67
  v_max_u32 v15, v15, v68
  v_max3_u32 v14, v14, v72, v73
  v_max3_u32 v14, v14, v74, v75
  v_max_u32 v15, v15, v76
  v_max3_u32 v14, v14, v80, v81
  v_max3_u32 v14, v14, v82, v83
  v_max_u32_e64 v15, v15, v84
  v_max3_u32 v14, v14, v88, v89
  v_max3_u32 v14, v14, v90, v91
  v_max_u32 v15, v15, v92
  v_max3_u32 v14, v14, v96, v97
  v_max3_u32 v14, v14, v98, v99
  v_max_u32 v15, v15, v100
  v_max3_u32 v14, v14, v104, v105
  v_max3_u32 v14, v14, v106, v107
  v_max_u32_e64 v15, v15, v108
  v_max3_u32 v14, v14, v112, v113
  v_max3_u32 v14, v14, v114, v115
  v_max_u32 v15, v15, v116
  v_max3_u32 v14, v14, v120, v121
  v_max3_u32 v14, v14, v122, v123
  v_max_u32 v15, v15, v124
  v_max3_u32 v14, v14, v128, v129
  v_max3_u32 v14, v14, v130, v131
  v_max_u32_e64 v15, v15, v132
  v_max3_u32 v14, v14, v136, v137
  v_max3_u32 v14, v14, v138, v139
  v_max_u32 v15, v15, v140
  v_max3_u32 v14, v14, v144, v145
  v_max3_u32 v14, v14, v146, v147
  v_max_u32 v15, v15, v148
  v_max3_u32 v14, v14, v152, v153
  v_max3_u32 v14, v14, v154, v155
  v_max_u32_e64 v15, v15, v156
  v_max3_u32 v14, v14, v160, v161
  v_max3_u32 v14, v14, v162, v163
  v_max_u32 v15, v15, v164
  v_max3_u32 v14, v14, v168, v169
  v_max3_u32 v14, v14, v170, v171
  v_max_u32 v15, v15, v172
  s_cmp_eq_u32 s71, 12
  s_cselect_b32 s68, 0, -1
  v_and_b32 v15, s68, v15
  v_max_u32 v14, v14, v15
  v_cmp_eq_u32 vcc, -1, v14
  s_cbranch_vccnz L_again
  s_branch L_ok
L_done:
  s_endpgm
L_cin_done:
  s_mul_i32 s98, s3, 1536
  s_add_u32 s98, s98, 116736
  v_lshlrev_b32 v120, 5, v0
  v_add_u32 v120, s98, v120
  ds_read_b128 v[60:63], v120
  ds_read_b128 v[64:67], v120 offset:16
  v_mul_f32 v116, v184, v192
  v_mul_f32 v117, v185, v193
  v_mul_f32 v118, v186, v194
  v_mul_f32 v119, v187, v195
  v_fmac_f32 v116, v188, v191
  v_fmac_f32 v117, v200, v208
  v_fmac_f32 v118, v201, v209
  v_fmac_f32 v119, v202, v210
  v_fmac_f32 v116, v203, v211
  v_fmac_f32 v117, v204, v207
  v_fmac_f32 v118, v216, v224
  v_fmac_f32 v119, v217, v225
  v_fmac_f32 v116, v218, v226
  v_fmac_f32 v117, v219, v227
  v_fmac_f32 v118, v220, v223
  v_fmac_f32 v119, v232, v240
  v_fmac_f32 v116, v233, v241
  v_fmac_f32 v117, v234, v242
  v_fmac_f32 v118, v235, v243
  v_fmac_f32 v119, v236, v239
  v_fmac_f32 v116, v189, v196
  v_fmac_f32 v117, v189, v197
  v_fmac_f32 v118, v190, v198
  v_fmac_f32 v119, v190, v199
  v_fmac_f32 v116, v205, v212
  v_fmac_f32 v117, v205, v213
  v_fmac_f32 v118, v206, v214
  v_fmac_f32 v119, v206, v215
  v_fmac_f32 v116, v221, v228
  v_fmac_f32 v117, v221, v229
  v_fmac_f32 v118, v222, v230
  v_fmac_f32 v119, v222, v231
  v_fmac_f32 v116, v237, v244
  v_fmac_f32 v117, v237, v245
  v_fmac_f32 v118, v238, v246
  v_fmac_f32 v119, v238, v247
  v_add_f32 v116, v116, v117
  v_add_f32 v118, v118, v119
  v_add_f32 v116, v116, v118
  v_mul_f32 v116, s74, v116
  v_mul_f32 v116, s75, v116
  s_nop 1
  v_add_f32_dpp v116, v116, v116 row_shr:1 row_mask:0xf bank_mask:0xf
  v_subrev_u32 v122, s98, v7
  v_lshrrev_b32 v122, 8, v122
  v_lshrrev_b32 v121, 3, v0
  v_add_f32_dpp v116, v116, v116 row_shr:2 row_mask:0xf bank_mask:0xf
  v_cmp_gt_u32 vcc, v122, v121
  v_min_u32 v121, v121, v122
  v_lshlrev_b32 v121, 4, v121
  v_add_f32_dpp v116, v116, v116 row_shr:4 row_mask:0xf bank_mask:0xf
  v_add_u32 v121, s85, v121
  s_waitcnt lgkmcnt(1)
  v_add_f32 v60, v60, v61
  v_add_f32 v62, v62, v63
  v_add_f32_dpp v116, v116, v116 row_shr:8 row_mask:0xf bank_mask:0xf
  s_waitcnt lgkmcnt(0)
  v_add_f32 v64, v64, v65
  v_add_f32 v66, v66, v67
  v_add_f32 v60, v60, v62
  v_add_f32_dpp v116, v116, v116 row_bcast:15 row_mask:0xa bank_mask:0xf
  v_add_f32 v64, v64, v66
  v_add_f32 v60, v60, v64
  s_nop 1
  v_add_f32_dpp v60, v60, v60 quad_perm:[1,0,3,2] row_mask:0xf bank_mask:0xf
  v_add_f32_dpp v116, v116, v116 row_bcast:31 row_mask:0xc bank_mask:0xf
  s_nop 0
  v_add_f32_dpp v60, v60, v60 quad_perm:[2,3,0,1] row_mask:0xf bank_mask:0xf
  s_nop 1
  v_add_f32_dpp v60, v60, v60 row_half_mirror row_mask:0xf bank_mask:0xf
  v_cndmask_b32 v60, v116, v60, vcc
  s_bitset1_b32 vcc_hi, 31
  s_mov_b64 exec, vcc
  ds_write_b32 v121, v60
  s_mov_b64 exec, -1
  s_cmp_eq_u32 s3, 0
  s_cbranch_scc1 L_cpub
  s_waitcnt lgkmcnt(0)
  s_barrier
  s_endpgm
L_cpub:
  s_load_dword s80, s[18:19], 0
  s_mov_b32 s60, s24
  s_and_b32 s61, s25, 0xffff
  s_mov_b32 s62, 268435456
  s_mov_b32 s63, 0x20000
  s_mov_b32 s56, s20
  s_and_b32 s57, s21, 0xffff
  s_mov_b32 s58, 8192
  s_mov_b32 s59, 0x20000
  s_mov_b32 s64, s22
  s_and_b32 s65, s23, 0xffff
  s_mov_b32 s66, 256
  s_mov_b32 s67, 0x20000
  v_lshlrev_b32 v6, 2, v0
  v_add_u32 v2, 129728, v6
  v_add_u32 v4, 1024, v6
  s_mul_i32 s69, s26, 192
  s_add_u32 s69, s69, 216320
  v_mov_b32 v13, -1
  s_mov_b32 exec_hi, 0xffff
  buffer_store_dword v13, v6, s[60:63], s69 offen sc1
  s_mov_b64 exec, 1
  buffer_load_dword v250, v6, s[56:59], 0 offen
  buffer_load_dword v251, v6, s[64:67], 0 offen offset:240 sc1
  s_mov_b64 exec, -1
  s_mul_i32 s68, s26, 3
  s_mul_i32 s70, s68, 3277
  s_lshr_b32 s70, s70, 16
  v_add_u32 v7, s70, v0
  s_mul_i32 s70, s70, 20
  s_add_u32 s70, s70, 20
  s_sub_u32 s70, s70, s68
  s_min_u32 s70, s70, 3
  s_sub_u32 s68, 3, s70
  v_mov_b32 v5, s68
  v_writelane_b32 v5, s70, 0
  s_cmp_eq_u32 s68, 0
  s_cselect_b32 s68, 1, 3
  v_lshlrev_b32 v3, 4, v0
  s_mov_b32 exec_hi, 0xffff
  s_waitcnt vmcnt(0) lgkmcnt(0)
  s_barrier
  ds_read_b32 v64, v2
  s_waitcnt lgkmcnt(0)
  v_min_u32_e64 v64, -2, v64
  buffer_store_dword v64, v6, s[60:63], s69 offen sc1
  s_mov_b32 exec_lo, s68
  s_mov_b32 exec_hi, 0
  s_branch L_pub
L_dnn_loop1:
  s_barrier
L_ld_in:
  s_add_u32 m0, s75, 131072
  s_nop 0
  buffer_load_dwordx4 v4, s[44:47], s74 offen lds
  s_add_u32 m0, s75, 132096
  s_nop 0
  buffer_load_dwordx4 v5, s[44:47], s74 offen lds
  s_add_u32 s74, s74, 106496
  s_add_u32 m0, s75, 139264
  s_nop 0
  buffer_load_dwordx4 v4, s[44:47], s74 offen lds
  s_add_u32 m0, s75, 140288
  s_nop 0
  buffer_load_dwordx4 v5, s[44:47], s74 offen lds
  s_add_u32 s74, s74, 106496
  s_add_u32 m0, s76, 0
  s_nop 0
  buffer_load_dwordx4 v56, s[32:35], 0 offen lds
  s_add_u32 m0, s76, 2048
  v_add_u32_dpp v56, v16, v2 row_newbcast:1 row_mask:0xf bank_mask:0x3
  buffer_load_dwordx4 v57, s[32:35], 0 offen lds
  s_nop 0
  v_add_u32_dpp v56, v18, v2 row_newbcast:7 row_mask:0xf bank_mask:0xc
  s_add_u32 m0, s76, 4096
  v_add_u32_dpp v57, v20, v2 row_newbcast:1 row_mask:0xf bank_mask:0x3
  buffer_load_dwordx4 v58, s[32:35], 0 offen lds
  s_nop 0
  v_add_u32_dpp v57, v22, v2 row_newbcast:7 row_mask:0xf bank_mask:0xc
  s_add_u32 m0, s76, 6144
  v_add_u32_dpp v58, v24, v2 row_newbcast:1 row_mask:0xf bank_mask:0x3
  buffer_load_dwordx4 v59, s[32:35], 0 offen lds
  s_nop 0
  v_add_u32_dpp v58, v26, v2 row_newbcast:7 row_mask:0xf bank_mask:0xc
  s_add_u32 m0, s76, 8192
  v_add_u32_dpp v59, v28, v2 row_newbcast:1 row_mask:0xf bank_mask:0x3
  buffer_load_dwordx4 v60, s[32:35], 0 offen lds
  s_nop 0
  v_add_u32_dpp v59, v30, v2 row_newbcast:7 row_mask:0xf bank_mask:0xc
  s_add_u32 m0, s76, 10240
  v_add_u32_dpp v60, v32, v2 row_newbcast:1 row_mask:0xf bank_mask:0x3
  buffer_load_dwordx4 v61, s[32:35], 0 offen lds
  s_nop 0
  v_add_u32_dpp v60, v34, v2 row_newbcast:7 row_mask:0xf bank_mask:0xc
  s_add_u32 m0, s76, 12288
  v_add_u32_dpp v61, v36, v2 row_newbcast:1 row_mask:0xf bank_mask:0x3
  buffer_load_dwordx4 v62, s[32:35], 0 offen lds
  s_nop 0
  v_add_u32_dpp v61, v38, v2 row_newbcast:7 row_mask:0xf bank_mask:0xc
  s_add_u32 m0, s76, 14336
  v_add_u32_dpp v62, v40, v2 row_newbcast:1 row_mask:0xf bank_mask:0x3
  buffer_load_dwordx4 v63, s[32:35], 0 offen lds
  s_nop 0
  v_add_u32_dpp v62, v42, v2 row_newbcast:7 row_mask:0xf bank_mask:0xc
  s_add_u32 m0, s76, 16384
  v_add_u32_dpp v63, v44, v2 row_newbcast:1 row_mask:0xf bank_mask:0x3
  buffer_load_dwordx4 v64, s[32:35], 0 offen lds
  s_nop 0
  v_add_u32_dpp v63, v46, v2 row_newbcast:7 row_mask:0xf bank_mask:0xc
  s_add_u32 m0, s76, 18432
  v_add_u32_dpp v64, v48, v2 row_newbcast:1 row_mask:0xf bank_mask:0x3
  buffer_load_dwordx4 v65, s[32:35], 0 offen lds
  s_nop 0
  v_add_u32_dpp v64, v50, v2 row_newbcast:7 row_mask:0xf bank_mask:0xc
  v_add_u32_dpp v65, v52, v2 row_newbcast:1 row_mask:0xf bank_mask:0x3
  s_nop 1
  v_add_u32_dpp v65, v54, v2 row_newbcast:7 row_mask:0xf bank_mask:0xc
  s_mov_b64 exec, 0x3ff
  buffer_load_dword v103, v84, s[44:47], s85 offen
  s_mov_b64 exec, -1
  s_add_u32 s85, s85, 865280
  s_waitcnt vmcnt(11)
  s_barrier
  s_add_u32 m0, s75, 147456
  s_nop 0
  buffer_load_dwordx4 v4, s[44:47], s74 offen lds
  s_add_u32 m0, s75, 148480
  s_nop 0
  buffer_load_dwordx4 v5, s[44:47], s74 offen lds
  s_add_u32 s74, s74, 106496
  s_add_u32 m0, s75, 155648
  s_nop 0
  buffer_load_dwordx4 v4, s[44:47], s74 offen lds
  s_add_u32 m0, s75, 156672
  s_nop 0
  buffer_load_dwordx4 v5, s[44:47], s74 offen lds
  s_add_u32 s74, s74, 106496
  s_add_u32 m0, s76, 40960
  s_nop 0
  buffer_load_dwordx4 v56, s[32:35], 0 offen lds
  s_add_u32 m0, s76, 43008
  v_add_u32_dpp v56, v17, v2 row_newbcast:1 row_mask:0xf bank_mask:0x3
  buffer_load_dwordx4 v57, s[32:35], 0 offen lds
  s_nop 0
  v_add_u32_dpp v56, v19, v2 row_newbcast:7 row_mask:0xf bank_mask:0xc
  s_add_u32 m0, s76, 45056
  v_add_u32_dpp v57, v21, v2 row_newbcast:1 row_mask:0xf bank_mask:0x3
  buffer_load_dwordx4 v58, s[32:35], 0 offen lds
  s_nop 0
  v_add_u32_dpp v57, v23, v2 row_newbcast:7 row_mask:0xf bank_mask:0xc
  s_add_u32 m0, s76, 47104
  v_add_u32_dpp v58, v25, v2 row_newbcast:1 row_mask:0xf bank_mask:0x3
  buffer_load_dwordx4 v59, s[32:35], 0 offen lds
  s_nop 0
  v_add_u32_dpp v58, v27, v2 row_newbcast:7 row_mask:0xf bank_mask:0xc
  s_add_u32 m0, s76, 49152
  v_add_u32_dpp v59, v29, v2 row_newbcast:1 row_mask:0xf bank_mask:0x3
  buffer_load_dwordx4 v60, s[32:35], 0 offen lds
  s_nop 0
  v_add_u32_dpp v59, v31, v2 row_newbcast:7 row_mask:0xf bank_mask:0xc
  s_add_u32 m0, s76, 51200
  v_add_u32_dpp v60, v33, v2 row_newbcast:1 row_mask:0xf bank_mask:0x3
  buffer_load_dwordx4 v61, s[32:35], 0 offen lds
  s_nop 0
  v_add_u32_dpp v60, v35, v2 row_newbcast:7 row_mask:0xf bank_mask:0xc
  s_add_u32 m0, s76, 53248
  v_add_u32_dpp v61, v37, v2 row_newbcast:1 row_mask:0xf bank_mask:0x3
  buffer_load_dwordx4 v62, s[32:35], 0 offen lds
  s_nop 0
  v_add_u32_dpp v61, v39, v2 row_newbcast:7 row_mask:0xf bank_mask:0xc
  s_add_u32 m0, s76, 55296
  v_add_u32_dpp v62, v41, v2 row_newbcast:1 row_mask:0xf bank_mask:0x3
  buffer_load_dwordx4 v63, s[32:35], 0 offen lds
  s_nop 0
  v_add_u32_dpp v62, v43, v2 row_newbcast:7 row_mask:0xf bank_mask:0xc
  s_add_u32 m0, s76, 57344
  v_add_u32_dpp v63, v45, v2 row_newbcast:1 row_mask:0xf bank_mask:0x3
  buffer_load_dwordx4 v64, s[32:35], 0 offen lds
  s_nop 0
  v_add_u32_dpp v63, v47, v2 row_newbcast:7 row_mask:0xf bank_mask:0xc
  s_add_u32 m0, s76, 59392
  v_add_u32_dpp v64, v49, v2 row_newbcast:1 row_mask:0xf bank_mask:0x3
  buffer_load_dwordx4 v65, s[32:35], 0 offen lds
  s_nop 0
  v_add_u32_dpp v64, v51, v2 row_newbcast:7 row_mask:0xf bank_mask:0xc
  v_add_u32_dpp v65, v53, v2 row_newbcast:1 row_mask:0xf bank_mask:0x3
  s_nop 1
  v_add_u32_dpp v65, v55, v2 row_newbcast:7 row_mask:0xf bank_mask:0xc
  v_lshlrev_b32 v101, 7, v70
  s_mov_b32 exec_lo, 0xffffffff
  s_mov_b32 exec_hi, 0x0
  buffer_load_dword v102, v101, s[32:35], 0 offen
  s_mov_b64 exec, -1
  v_mov_b32 v70, v71
  v_mov_b32 v71, v72
  v_mov_b32 v72, v73
  v_mov_b32_e64 v73, v74
  v_mov_b32 v74, 0xffffff
  s_waitcnt vmcnt(11)
  s_barrier
  s_add_u32 m0, s75, 131072
  s_nop 0
  buffer_load_dwordx4 v4, s[44:47], s74 offen lds
  s_add_u32 m0, s75, 132096
  s_nop 0
  buffer_load_dwordx4 v5, s[44:47], s74 offen lds
  s_add_u32 s74, s74, 106496
  s_add_u32 m0, s75, 139264
  s_nop 0
  buffer_load_dwordx4 v4, s[44:47], s74 offen lds
  s_add_u32 m0, s75, 140288
  s_nop 0
  buffer_load_dwordx4 v5, s[44:47], s74 offen lds
  s_add_u32 s74, s74, 106496
  s_add_u32 m0, s76, 81920
  s_nop 0
  buffer_load_dwordx4 v56, s[32:35], 0 offen lds
  s_add_u32 m0, s76, 83968
  v_add_u32_dpp v56, v18, v2 row_newbcast:1 row_mask:0xf bank_mask:0x3
  buffer_load_dwordx4 v57, s[32:35], 0 offen lds
  s_nop 0
  v_add_u32_dpp v56, v16, v2 row_newbcast:8 row_mask:0xf bank_mask:0xc
  s_add_u32 m0, s76, 86016
  v_add_u32_dpp v57, v22, v2 row_newbcast:1 row_mask:0xf bank_mask:0x3
  buffer_load_dwordx4 v58, s[32:35], 0 offen lds
  s_nop 0
  v_add_u32_dpp v57, v20, v2 row_newbcast:8 row_mask:0xf bank_mask:0xc
  s_add_u32 m0, s76, 88064
  v_add_u32_dpp v58, v26, v2 row_newbcast:1 row_mask:0xf bank_mask:0x3
  buffer_load_dwordx4 v59, s[32:35], 0 offen lds
  s_nop 0
  v_add_u32_dpp v58, v24, v2 row_newbcast:8 row_mask:0xf bank_mask:0xc
  s_add_u32 m0, s76, 90112
  v_add_u32_dpp v59, v30, v2 row_newbcast:1 row_mask:0xf bank_mask:0x3
  buffer_load_dwordx4 v60, s[32:35], 0 offen lds
  s_nop 0
  v_add_u32_dpp v59, v28, v2 row_newbcast:8 row_mask:0xf bank_mask:0xc
  s_add_u32 m0, s76, 92160
  v_add_u32_dpp v60, v34, v2 row_newbcast:1 row_mask:0xf bank_mask:0x3
  buffer_load_dwordx4 v61, s[32:35], 0 offen lds
  s_nop 0
  v_add_u32_dpp v60, v32, v2 row_newbcast:8 row_mask:0xf bank_mask:0xc
  s_add_u32 m0, s76, 94208
  v_add_u32_dpp v61, v38, v2 row_newbcast:1 row_mask:0xf bank_mask:0x3
  buffer_load_dwordx4 v62, s[32:35], 0 offen lds
  s_nop 0
  v_add_u32_dpp v61, v36, v2 row_newbcast:8 row_mask:0xf bank_mask:0xc
  s_add_u32 m0, s76, 96256
  v_add_u32_dpp v62, v42, v2 row_newbcast:1 row_mask:0xf bank_mask:0x3
  buffer_load_dwordx4 v63, s[32:35], 0 offen lds
  s_nop 0
  v_add_u32_dpp v62, v40, v2 row_newbcast:8 row_mask:0xf bank_mask:0xc
  s_add_u32 m0, s76, 98304
  v_add_u32_dpp v63, v46, v2 row_newbcast:1 row_mask:0xf bank_mask:0x3
  buffer_load_dwordx4 v64, s[32:35], 0 offen lds
  s_nop 0
  v_add_u32_dpp v63, v44, v2 row_newbcast:8 row_mask:0xf bank_mask:0xc
  s_add_u32 m0, s76, 100352
  v_add_u32_dpp v64, v50, v2 row_newbcast:1 row_mask:0xf bank_mask:0x3
  buffer_load_dwordx4 v65, s[32:35], 0 offen lds
  s_nop 0
  v_add_u32_dpp v64, v48, v2 row_newbcast:8 row_mask:0xf bank_mask:0xc
  v_add_u32_dpp v65, v54, v2 row_newbcast:1 row_mask:0xf bank_mask:0x3
  s_nop 1
  v_add_u32_dpp v65, v52, v2 row_newbcast:8 row_mask:0xf bank_mask:0xc
  s_waitcnt vmcnt(10)
  s_barrier
  s_add_u32 m0, s75, 147456
  s_nop 0
  buffer_load_dwordx4 v4, s[44:47], s74 offen lds
  s_add_u32 m0, s75, 148480
  s_nop 0
  buffer_load_dwordx4 v5, s[44:47], s74 offen lds
  s_add_u32 s74, s74, 106496
  s_add_u32 m0, s75, 155648
  s_nop 0
  buffer_load_dwordx4 v4, s[44:47], s74 offen lds
  s_add_u32 m0, s75, 156672
  s_nop 0
  buffer_load_dwordx4 v5, s[44:47], s74 offen lds
  s_add_u32 s74, s74, 106496
  s_add_u32 m0, s76, 0
  s_nop 0
  buffer_load_dwordx4 v56, s[32:35], 0 offen lds
  s_add_u32 m0, s76, 2048
  v_add_u32_dpp v56, v19, v2 row_newbcast:1 row_mask:0xf bank_mask:0x3
  buffer_load_dwordx4 v57, s[32:35], 0 offen lds
  s_nop 0
  v_add_u32_dpp v56, v17, v2 row_newbcast:8 row_mask:0xf bank_mask:0xc
  s_add_u32 m0, s76, 4096
  v_add_u32_dpp v57, v23, v2 row_newbcast:1 row_mask:0xf bank_mask:0x3
  buffer_load_dwordx4 v58, s[32:35], 0 offen lds
  s_nop 0
  v_add_u32_dpp v57, v21, v2 row_newbcast:8 row_mask:0xf bank_mask:0xc
  s_add_u32 m0, s76, 6144
  v_add_u32_dpp v58, v27, v2 row_newbcast:1 row_mask:0xf bank_mask:0x3
  buffer_load_dwordx4 v59, s[32:35], 0 offen lds
  s_nop 0
  v_add_u32_dpp v58, v25, v2 row_newbcast:8 row_mask:0xf bank_mask:0xc
  s_add_u32 m0, s76, 8192
  v_add_u32_dpp v59, v31, v2 row_newbcast:1 row_mask:0xf bank_mask:0x3
  buffer_load_dwordx4 v60, s[32:35], 0 offen lds
  s_nop 0
  v_add_u32_dpp v59, v29, v2 row_newbcast:8 row_mask:0xf bank_mask:0xc
  s_add_u32 m0, s76, 10240
  v_add_u32_dpp v60, v35, v2 row_newbcast:1 row_mask:0xf bank_mask:0x3
  buffer_load_dwordx4 v61, s[32:35], 0 offen lds
  s_nop 0
  v_add_u32_dpp v60, v33, v2 row_newbcast:8 row_mask:0xf bank_mask:0xc
  s_add_u32 m0, s76, 12288
  v_add_u32_dpp v61, v39, v2 row_newbcast:1 row_mask:0xf bank_mask:0x3
  buffer_load_dwordx4 v62, s[32:35], 0 offen lds
  s_nop 0
  v_add_u32_dpp v61, v37, v2 row_newbcast:8 row_mask:0xf bank_mask:0xc
  s_add_u32 m0, s76, 14336
  v_add_u32_dpp v62, v43, v2 row_newbcast:1 row_mask:0xf bank_mask:0x3
  buffer_load_dwordx4 v63, s[32:35], 0 offen lds
  s_nop 0
  v_add_u32_dpp v62, v41, v2 row_newbcast:8 row_mask:0xf bank_mask:0xc
  s_add_u32 m0, s76, 16384
  v_add_u32_dpp v63, v47, v2 row_newbcast:1 row_mask:0xf bank_mask:0x3
  buffer_load_dwordx4 v64, s[32:35], 0 offen lds
  s_nop 0
  v_add_u32_dpp v63, v45, v2 row_newbcast:8 row_mask:0xf bank_mask:0xc
  s_add_u32 m0, s76, 18432
  v_add_u32_dpp v64, v51, v2 row_newbcast:1 row_mask:0xf bank_mask:0x3
  buffer_load_dwordx4 v65, s[32:35], 0 offen lds
  s_nop 0
  v_add_u32_dpp v64, v49, v2 row_newbcast:8 row_mask:0xf bank_mask:0xc
  v_add_u32_dpp v65, v55, v2 row_newbcast:1 row_mask:0xf bank_mask:0x3
  s_nop 1
  v_add_u32_dpp v65, v53, v2 row_newbcast:8 row_mask:0xf bank_mask:0xc
  s_waitcnt vmcnt(10)
  s_barrier
  s_add_u32 m0, s75, 131072
  s_nop 0
  buffer_load_dwordx4 v4, s[44:47], s74 offen lds
  s_add_u32 m0, s75, 132096
  s_nop 0
  buffer_load_dwordx4 v5, s[44:47], s74 offen lds
  s_add_u32 s74, s74, 106496
  s_add_u32 m0, s75, 139264
  s_nop 0
  buffer_load_dwordx4 v4, s[44:47], s74 offen lds
  s_add_u32 m0, s75, 140288
  s_nop 0
  buffer_load_dwordx4 v5, s[44:47], s74 offen lds
  s_add_u32 s74, s74, 106496
  s_add_u32 m0, s76, 40960
  s_nop 0
  buffer_load_dwordx4 v56, s[32:35], 0 offen lds
  s_add_u32 m0, s76, 43008
  v_add_u32_dpp v56, v16, v2 row_newbcast:2 row_mask:0xf bank_mask:0x3
  buffer_load_dwordx4 v57, s[32:35], 0 offen lds
  s_nop 0
  v_add_u32_dpp v56, v18, v2 row_newbcast:8 row_mask:0xf bank_mask:0xc
  s_add_u32 m0, s76, 45056
  v_add_u32_dpp v57, v20, v2 row_newbcast:2 row_mask:0xf bank_mask:0x3
  buffer_load_dwordx4 v58, s[32:35], 0 offen lds
  s_nop 0
  v_add_u32_dpp v57, v22, v2 row_newbcast:8 row_mask:0xf bank_mask:0xc
  s_add_u32 m0, s76, 47104
  v_add_u32_dpp v58, v24, v2 row_newbcast:2 row_mask:0xf bank_mask:0x3
  buffer_load_dwordx4 v59, s[32:35], 0 offen lds
  s_nop 0
  v_add_u32_dpp v58, v26, v2 row_newbcast:8 row_mask:0xf bank_mask:0xc
  s_add_u32 m0, s76, 49152
  v_add_u32_dpp v59, v28, v2 row_newbcast:2 row_mask:0xf bank_mask:0x3
  buffer_load_dwordx4 v60, s[32:35], 0 offen lds
  s_nop 0
  v_add_u32_dpp v59, v30, v2 row_newbcast:8 row_mask:0xf bank_mask:0xc
  s_add_u32 m0, s76, 51200
  v_add_u32_dpp v60, v32, v2 row_newbcast:2 row_mask:0xf bank_mask:0x3
  buffer_load_dwordx4 v61, s[32:35], 0 offen lds
  s_nop 0
  v_add_u32_dpp v60, v34, v2 row_newbcast:8 row_mask:0xf bank_mask:0xc
  s_add_u32 m0, s76, 53248
  v_add_u32_dpp v61, v36, v2 row_newbcast:2 row_mask:0xf bank_mask:0x3
  buffer_load_dwordx4 v62, s[32:35], 0 offen lds
  s_nop 0
  v_add_u32_dpp v61, v38, v2 row_newbcast:8 row_mask:0xf bank_mask:0xc
  s_add_u32 m0, s76, 55296
  v_add_u32_dpp v62, v40, v2 row_newbcast:2 row_mask:0xf bank_mask:0x3
  buffer_load_dwordx4 v63, s[32:35], 0 offen lds
  s_nop 0
  v_add_u32_dpp v62, v42, v2 row_newbcast:8 row_mask:0xf bank_mask:0xc
  s_add_u32 m0, s76, 57344
  v_add_u32_dpp v63, v44, v2 row_newbcast:2 row_mask:0xf bank_mask:0x3
  buffer_load_dwordx4 v64, s[32:35], 0 offen lds
  s_nop 0
  v_add_u32_dpp v63, v46, v2 row_newbcast:8 row_mask:0xf bank_mask:0xc
  s_add_u32 m0, s76, 59392
  v_add_u32_dpp v64, v48, v2 row_newbcast:2 row_mask:0xf bank_mask:0x3
  buffer_load_dwordx4 v65, s[32:35], 0 offen lds
  s_nop 0
  v_add_u32_dpp v64, v50, v2 row_newbcast:8 row_mask:0xf bank_mask:0xc
  v_add_u32_dpp v65, v52, v2 row_newbcast:2 row_mask:0xf bank_mask:0x3
  s_nop 1
  v_add_u32_dpp v65, v54, v2 row_newbcast:8 row_mask:0xf bank_mask:0xc
  s_mov_b64 exec, 0x3ff
  buffer_load_dword v103, v84, s[44:47], s85 offen
  s_mov_b64 exec, -1
  s_add_u32 s85, s85, 865280
  s_waitcnt vmcnt(11)
  s_barrier
  s_add_u32 m0, s75, 147456
  s_nop 0
  buffer_load_dwordx4 v4, s[44:47], s74 offen lds
  s_add_u32 m0, s75, 148480
  s_nop 0
  buffer_load_dwordx4 v5, s[44:47], s74 offen lds
  s_add_u32 s74, s74, 106496
  s_add_u32 m0, s75, 155648
  s_nop 0
  buffer_load_dwordx4 v4, s[44:47], s74 offen lds
  s_add_u32 m0, s75, 156672
  s_nop 0
  buffer_load_dwordx4 v5, s[44:47], s74 offen lds
  s_add_u32 s74, s74, 106496
  s_add_u32 m0, s76, 81920
  s_nop 0
  buffer_load_dwordx4 v56, s[32:35], 0 offen lds
  s_add_u32 m0, s76, 83968
  v_add_u32_dpp v56, v17, v2 row_newbcast:2 row_mask:0xf bank_mask:0x3
  buffer_load_dwordx4 v57, s[32:35], 0 offen lds
  s_nop 0
  v_add_u32_dpp v56, v19, v2 row_newbcast:8 row_mask:0xf bank_mask:0xc
  s_add_u32 m0, s76, 86016
  v_add_u32_dpp v57, v21, v2 row_newbcast:2 row_mask:0xf bank_mask:0x3
  buffer_load_dwordx4 v58, s[32:35], 0 offen lds
  s_nop 0
  v_add_u32_dpp v57, v23, v2 row_newbcast:8 row_mask:0xf bank_mask:0xc
  s_add_u32 m0, s76, 88064
  v_add_u32_dpp v58, v25, v2 row_newbcast:2 row_mask:0xf bank_mask:0x3
  buffer_load_dwordx4 v59, s[32:35], 0 offen lds
  s_nop 0
  v_add_u32_dpp v58, v27, v2 row_newbcast:8 row_mask:0xf bank_mask:0xc
  s_add_u32 m0, s76, 90112
  v_add_u32_dpp v59, v29, v2 row_newbcast:2 row_mask:0xf bank_mask:0x3
  buffer_load_dwordx4 v60, s[32:35], 0 offen lds
  s_nop 0
  v_add_u32_dpp v59, v31, v2 row_newbcast:8 row_mask:0xf bank_mask:0xc
  s_add_u32 m0, s76, 92160
  v_add_u32_dpp v60, v33, v2 row_newbcast:2 row_mask:0xf bank_mask:0x3
  buffer_load_dwordx4 v61, s[32:35], 0 offen lds
  s_nop 0
  v_add_u32_dpp v60, v35, v2 row_newbcast:8 row_mask:0xf bank_mask:0xc
  s_add_u32 m0, s76, 94208
  v_add_u32_dpp v61, v37, v2 row_newbcast:2 row_mask:0xf bank_mask:0x3
  buffer_load_dwordx4 v62, s[32:35], 0 offen lds
  s_nop 0
  v_add_u32_dpp v61, v39, v2 row_newbcast:8 row_mask:0xf bank_mask:0xc
  s_add_u32 m0, s76, 96256
  v_add_u32_dpp v62, v41, v2 row_newbcast:2 row_mask:0xf bank_mask:0x3
  buffer_load_dwordx4 v63, s[32:35], 0 offen lds
  s_nop 0
  v_add_u32_dpp v62, v43, v2 row_newbcast:8 row_mask:0xf bank_mask:0xc
  s_add_u32 m0, s76, 98304
  v_add_u32_dpp v63, v45, v2 row_newbcast:2 row_mask:0xf bank_mask:0x3
  buffer_load_dwordx4 v64, s[32:35], 0 offen lds
  s_nop 0
  v_add_u32_dpp v63, v47, v2 row_newbcast:8 row_mask:0xf bank_mask:0xc
  s_add_u32 m0, s76, 100352
  v_add_u32_dpp v64, v49, v2 row_newbcast:2 row_mask:0xf bank_mask:0x3
  buffer_load_dwordx4 v65, s[32:35], 0 offen lds
  s_nop 0
  v_add_u32_dpp v64, v51, v2 row_newbcast:8 row_mask:0xf bank_mask:0xc
  v_add_u32_dpp v65, v53, v2 row_newbcast:2 row_mask:0xf bank_mask:0x3
  s_nop 1
  v_add_u32_dpp v65, v55, v2 row_newbcast:8 row_mask:0xf bank_mask:0xc
  v_lshlrev_b32 v101, 7, v70
  s_mov_b32 exec_lo, 0xffffffff
  s_mov_b32 exec_hi, 0x0
  buffer_load_dword v102, v101, s[32:35], 0 offen
  s_mov_b64 exec, -1
  v_mov_b32 v70, v71
  v_mov_b32 v71, v72
  v_mov_b32 v72, v73
  v_mov_b32_e64 v73, v74
  v_mov_b32 v74, 0xffffff
  s_waitcnt vmcnt(11)
  s_barrier
  s_add_u32 m0, s75, 131072
  s_nop 0
  buffer_load_dwordx4 v4, s[44:47], s74 offen lds
  s_add_u32 m0, s75, 132096
  s_nop 0
  buffer_load_dwordx4 v5, s[44:47], s74 offen lds
  s_add_u32 s74, s74, 106496
  s_add_u32 m0, s75, 139264
  s_nop 0
  buffer_load_dwordx4 v4, s[44:47], s74 offen lds
  s_add_u32 m0, s75, 140288
  s_nop 0
  buffer_load_dwordx4 v5, s[44:47], s74 offen lds
  s_add_u32 s74, s74, 106496
  s_add_u32 m0, s76, 0
  s_nop 0
  buffer_load_dwordx4 v56, s[32:35], 0 offen lds
  s_add_u32 m0, s76, 2048
  v_add_u32_dpp v56, v18, v2 row_newbcast:2 row_mask:0xf bank_mask:0x3
  buffer_load_dwordx4 v57, s[32:35], 0 offen lds
  s_nop 0
  v_add_u32_dpp v56, v16, v2 row_newbcast:9 row_mask:0xf bank_mask:0xc
  s_add_u32 m0, s76, 4096
  v_add_u32_dpp v57, v22, v2 row_newbcast:2 row_mask:0xf bank_mask:0x3
  buffer_load_dwordx4 v58, s[32:35], 0 offen lds
  s_nop 0
  v_add_u32_dpp v57, v20, v2 row_newbcast:9 row_mask:0xf bank_mask:0xc
  s_add_u32 m0, s76, 6144
  v_add_u32_dpp v58, v26, v2 row_newbcast:2 row_mask:0xf bank_mask:0x3
  buffer_load_dwordx4 v59, s[32:35], 0 offen lds
  s_nop 0
  v_add_u32_dpp v58, v24, v2 row_newbcast:9 row_mask:0xf bank_mask:0xc
  s_add_u32 m0, s76, 8192
  v_add_u32_dpp v59, v30, v2 row_newbcast:2 row_mask:0xf bank_mask:0x3
  buffer_load_dwordx4 v60, s[32:35], 0 offen lds
  s_nop 0
  v_add_u32_dpp v59, v28, v2 row_newbcast:9 row_mask:0xf bank_mask:0xc
  s_add_u32 m0, s76, 10240
  v_add_u32_dpp v60, v34, v2 row_newbcast:2 row_mask:0xf bank_mask:0x3
  buffer_load_dwordx4 v61, s[32:35], 0 offen lds
  s_nop 0
  v_add_u32_dpp v60, v32, v2 row_newbcast:9 row_mask:0xf bank_mask:0xc
  s_add_u32 m0, s76, 12288
  v_add_u32_dpp v61, v38, v2 row_newbcast:2 row_mask:0xf bank_mask:0x3
  buffer_load_dwordx4 v62, s[32:35], 0 offen lds
  s_nop 0
  v_add_u32_dpp v61, v36, v2 row_newbcast:9 row_mask:0xf bank_mask:0xc
  s_add_u32 m0, s76, 14336
  v_add_u32_dpp v62, v42, v2 row_newbcast:2 row_mask:0xf bank_mask:0x3
  buffer_load_dwordx4 v63, s[32:35], 0 offen lds
  s_nop 0
  v_add_u32_dpp v62, v40, v2 row_newbcast:9 row_mask:0xf bank_mask:0xc
  s_add_u32 m0, s76, 16384
  v_add_u32_dpp v63, v46, v2 row_newbcast:2 row_mask:0xf bank_mask:0x3
  buffer_load_dwordx4 v64, s[32:35], 0 offen lds
  s_nop 0
  v_add_u32_dpp v63, v44, v2 row_newbcast:9 row_mask:0xf bank_mask:0xc
  s_add_u32 m0, s76, 18432
  v_add_u32_dpp v64, v50, v2 row_newbcast:2 row_mask:0xf bank_mask:0x3
  buffer_load_dwordx4 v65, s[32:35], 0 offen lds
  s_nop 0
  v_add_u32_dpp v64, v48, v2 row_newbcast:9 row_mask:0xf bank_mask:0xc
  v_add_u32_dpp v65, v54, v2 row_newbcast:2 row_mask:0xf bank_mask:0x3
  s_nop 1
  v_add_u32_dpp v65, v52, v2 row_newbcast:9 row_mask:0xf bank_mask:0xc
  s_waitcnt vmcnt(10)
  s_barrier
  s_add_u32 m0, s75, 147456
  s_nop 0
  buffer_load_dwordx4 v4, s[44:47], s74 offen lds
  s_add_u32 m0, s75, 148480
  s_nop 0
  buffer_load_dwordx4 v5, s[44:47], s74 offen lds
  s_add_u32 s74, s74, 106496
  s_add_u32 m0, s75, 155648
  s_nop 0
  buffer_load_dwordx4 v4, s[44:47], s74 offen lds
  s_add_u32 m0, s75, 156672
  s_nop 0
  buffer_load_dwordx4 v5, s[44:47], s74 offen lds
  s_add_u32 s74, s74, 106496
  s_add_u32 m0, s76, 40960
  s_nop 0
  buffer_load_dwordx4 v56, s[32:35], 0 offen lds
  s_add_u32 m0, s76, 43008
  v_add_u32_dpp v56, v19, v2 row_newbcast:2 row_mask:0xf bank_mask:0x3
  buffer_load_dwordx4 v57, s[32:35], 0 offen lds
  s_nop 0
  v_add_u32_dpp v56, v17, v2 row_newbcast:9 row_mask:0xf bank_mask:0xc
  s_add_u32 m0, s76, 45056
  v_add_u32_dpp v57, v23, v2 row_newbcast:2 row_mask:0xf bank_mask:0x3
  buffer_load_dwordx4 v58, s[32:35], 0 offen lds
  s_nop 0
  v_add_u32_dpp v57, v21, v2 row_newbcast:9 row_mask:0xf bank_mask:0xc
  s_add_u32 m0, s76, 47104
  v_add_u32_dpp v58, v27, v2 row_newbcast:2 row_mask:0xf bank_mask:0x3
  buffer_load_dwordx4 v59, s[32:35], 0 offen lds
  s_nop 0
  v_add_u32_dpp v58, v25, v2 row_newbcast:9 row_mask:0xf bank_mask:0xc
  s_add_u32 m0, s76, 49152
  v_add_u32_dpp v59, v31, v2 row_newbcast:2 row_mask:0xf bank_mask:0x3
  buffer_load_dwordx4 v60, s[32:35], 0 offen lds
  s_nop 0
  v_add_u32_dpp v59, v29, v2 row_newbcast:9 row_mask:0xf bank_mask:0xc
  s_add_u32 m0, s76, 51200
  v_add_u32_dpp v60, v35, v2 row_newbcast:2 row_mask:0xf bank_mask:0x3
  buffer_load_dwordx4 v61, s[32:35], 0 offen lds
  s_nop 0
  v_add_u32_dpp v60, v33, v2 row_newbcast:9 row_mask:0xf bank_mask:0xc
  s_add_u32 m0, s76, 53248
  v_add_u32_dpp v61, v39, v2 row_newbcast:2 row_mask:0xf bank_mask:0x3
  buffer_load_dwordx4 v62, s[32:35], 0 offen lds
  s_nop 0
  v_add_u32_dpp v61, v37, v2 row_newbcast:9 row_mask:0xf bank_mask:0xc
  s_add_u32 m0, s76, 55296
  v_add_u32_dpp v62, v43, v2 row_newbcast:2 row_mask:0xf bank_mask:0x3
  buffer_load_dwordx4 v63, s[32:35], 0 offen lds
  s_nop 0
  v_add_u32_dpp v62, v41, v2 row_newbcast:9 row_mask:0xf bank_mask:0xc
  s_add_u32 m0, s76, 57344
  v_add_u32_dpp v63, v47, v2 row_newbcast:2 row_mask:0xf bank_mask:0x3
  buffer_load_dwordx4 v64, s[32:35], 0 offen lds
  s_nop 0
  v_add_u32_dpp v63, v45, v2 row_newbcast:9 row_mask:0xf bank_mask:0xc
  s_add_u32 m0, s76, 59392
  v_add_u32_dpp v64, v51, v2 row_newbcast:2 row_mask:0xf bank_mask:0x3
  buffer_load_dwordx4 v65, s[32:35], 0 offen lds
  s_nop 0
  v_add_u32_dpp v64, v49, v2 row_newbcast:9 row_mask:0xf bank_mask:0xc
  v_add_u32_dpp v65, v55, v2 row_newbcast:2 row_mask:0xf bank_mask:0x3
  s_nop 1
  v_add_u32_dpp v65, v53, v2 row_newbcast:9 row_mask:0xf bank_mask:0xc
  s_waitcnt vmcnt(10)
  s_cmp_lg_u32 s72, 1
  s_cbranch_scc1 L_nolpf
  s_mov_b64 exec, 1048575
  global_load_dword v10, v[8:9], off
  s_mov_b64 exec, -1
  s_mov_b32 m0, 123136
  s_mov_b64 exec, 0xffff
  buffer_load_dwordx4 v11, s[52:55], s77 offen lds
  s_mov_b64 exec, -1
L_nolpf:
  s_barrier
  s_add_u32 m0, s75, 131072
  s_nop 0
  buffer_load_dwordx4 v4, s[44:47], s74 offen lds
  s_add_u32 m0, s75, 132096
  s_nop 0
  buffer_load_dwordx4 v5, s[44:47], s74 offen lds
  s_add_u32 s74, s74, 106496
  s_add_u32 m0, s75, 139264
  s_nop 0
  buffer_load_dwordx4 v4, s[44:47], s74 offen lds
  s_add_u32 m0, s75, 140288
  s_nop 0
  buffer_load_dwordx4 v5, s[44:47], s74 offen lds
  s_add_u32 s74, s74, 106496
  s_add_u32 m0, s76, 81920
  s_nop 0
  buffer_load_dwordx4 v56, s[32:35], 0 offen lds
  s_add_u32 m0, s76, 83968
  v_add_u32_dpp v56, v16, v2 row_newbcast:3 row_mask:0xf bank_mask:0x3
  buffer_load_dwordx4 v57, s[32:35], 0 offen lds
  s_nop 0
  v_add_u32_dpp v56, v18, v2 row_newbcast:9 row_mask:0xf bank_mask:0xc
  s_add_u32 m0, s76, 86016
  v_add_u32_dpp v57, v20, v2 row_newbcast:3 row_mask:0xf bank_mask:0x3
  buffer_load_dwordx4 v58, s[32:35], 0 offen lds
  s_nop 0
  v_add_u32_dpp v57, v22, v2 row_newbcast:9 row_mask:0xf bank_mask:0xc
  s_add_u32 m0, s76, 88064
  v_add_u32_dpp v58, v24, v2 row_newbcast:3 row_mask:0xf bank_mask:0x3
  buffer_load_dwordx4 v59, s[32:35], 0 offen lds
  s_nop 0
  v_add_u32_dpp v58, v26, v2 row_newbcast:9 row_mask:0xf bank_mask:0xc
  s_add_u32 m0, s76, 90112
  v_add_u32_dpp v59, v28, v2 row_newbcast:3 row_mask:0xf bank_mask:0x3
  buffer_load_dwordx4 v60, s[32:35], 0 offen lds
  s_nop 0
  v_add_u32_dpp v59, v30, v2 row_newbcast:9 row_mask:0xf bank_mask:0xc
  s_add_u32 m0, s76, 92160
  v_add_u32_dpp v60, v32, v2 row_newbcast:3 row_mask:0xf bank_mask:0x3
  buffer_load_dwordx4 v61, s[32:35], 0 offen lds
  s_nop 0
  v_add_u32_dpp v60, v34, v2 row_newbcast:9 row_mask:0xf bank_mask:0xc
  s_add_u32 m0, s76, 94208
  v_add_u32_dpp v61, v36, v2 row_newbcast:3 row_mask:0xf bank_mask:0x3
  buffer_load_dwordx4 v62, s[32:35], 0 offen lds
  s_nop 0
  v_add_u32_dpp v61, v38, v2 row_newbcast:9 row_mask:0xf bank_mask:0xc
  s_add_u32 m0, s76, 96256
  v_add_u32_dpp v62, v40, v2 row_newbcast:3 row_mask:0xf bank_mask:0x3
  buffer_load_dwordx4 v63, s[32:35], 0 offen lds
  s_nop 0
  v_add_u32_dpp v62, v42, v2 row_newbcast:9 row_mask:0xf bank_mask:0xc
  s_add_u32 m0, s76, 98304
  v_add_u32_dpp v63, v44, v2 row_newbcast:3 row_mask:0xf bank_mask:0x3
  buffer_load_dwordx4 v64, s[32:35], 0 offen lds
  s_nop 0
  v_add_u32_dpp v63, v46, v2 row_newbcast:9 row_mask:0xf bank_mask:0xc
  s_add_u32 m0, s76, 100352
  v_add_u32_dpp v64, v48, v2 row_newbcast:3 row_mask:0xf bank_mask:0x3
  buffer_load_dwordx4 v65, s[32:35], 0 offen lds
  s_nop 0
  v_add_u32_dpp v64, v50, v2 row_newbcast:9 row_mask:0xf bank_mask:0xc
  v_add_u32_dpp v65, v52, v2 row_newbcast:3 row_mask:0xf bank_mask:0x3
  s_nop 1
  v_add_u32_dpp v65, v54, v2 row_newbcast:9 row_mask:0xf bank_mask:0xc
  s_mov_b64 exec, 0x3ff
  buffer_load_dword v103, v84, s[44:47], s85 offen
  s_mov_b64 exec, -1
  s_add_u32 s85, s85, 865280
  s_waitcnt vmcnt(11)
  s_barrier
  s_add_u32 m0, s75, 147456
  s_nop 0
  buffer_load_dwordx4 v4, s[44:47], s74 offen lds
  s_add_u32 m0, s75, 148480
  s_nop 0
  buffer_load_dwordx4 v5, s[44:47], s74 offen lds
  s_add_u32 s74, s74, 106496
  s_add_u32 m0, s75, 155648
  s_nop 0
  buffer_load_dwordx4 v4, s[44:47], s74 offen lds
  s_add_u32 m0, s75, 156672
  s_nop 0
  buffer_load_dwordx4 v5, s[44:47], s74 offen lds
  s_add_u32 s74, s74, 106496
  s_add_u32 m0, s76, 0
  s_nop 0
  buffer_load_dwordx4 v56, s[32:35], 0 offen lds
  s_add_u32 m0, s76, 2048
  v_add_u32_dpp v56, v17, v2 row_newbcast:3 row_mask:0xf bank_mask:0x3
  buffer_load_dwordx4 v57, s[32:35], 0 offen lds
  s_nop 0
  v_add_u32_dpp v56, v19, v2 row_newbcast:9 row_mask:0xf bank_mask:0xc
  s_add_u32 m0, s76, 4096
  v_add_u32_dpp v57, v21, v2 row_newbcast:3 row_mask:0xf bank_mask:0x3
  buffer_load_dwordx4 v58, s[32:35], 0 offen lds
  s_nop 0
  v_add_u32_dpp v57, v23, v2 row_newbcast:9 row_mask:0xf bank_mask:0xc
  s_add_u32 m0, s76, 6144
  v_add_u32_dpp v58, v25, v2 row_newbcast:3 row_mask:0xf bank_mask:0x3
  buffer_load_dwordx4 v59, s[32:35], 0 offen lds
  s_nop 0
  v_add_u32_dpp v58, v27, v2 row_newbcast:9 row_mask:0xf bank_mask:0xc
  s_add_u32 m0, s76, 8192
  v_add_u32_dpp v59, v29, v2 row_newbcast:3 row_mask:0xf bank_mask:0x3
  buffer_load_dwordx4 v60, s[32:35], 0 offen lds
  s_nop 0
  v_add_u32_dpp v59, v31, v2 row_newbcast:9 row_mask:0xf bank_mask:0xc
  s_add_u32 m0, s76, 10240
  v_add_u32_dpp v60, v33, v2 row_newbcast:3 row_mask:0xf bank_mask:0x3
  buffer_load_dwordx4 v61, s[32:35], 0 offen lds
  s_nop 0
  v_add_u32_dpp v60, v35, v2 row_newbcast:9 row_mask:0xf bank_mask:0xc
  s_add_u32 m0, s76, 12288
  v_add_u32_dpp v61, v37, v2 row_newbcast:3 row_mask:0xf bank_mask:0x3
  buffer_load_dwordx4 v62, s[32:35], 0 offen lds
  s_nop 0
  v_add_u32_dpp v61, v39, v2 row_newbcast:9 row_mask:0xf bank_mask:0xc
  s_add_u32 m0, s76, 14336
  v_add_u32_dpp v62, v41, v2 row_newbcast:3 row_mask:0xf bank_mask:0x3
  buffer_load_dwordx4 v63, s[32:35], 0 offen lds
  s_nop 0
  v_add_u32_dpp v62, v43, v2 row_newbcast:9 row_mask:0xf bank_mask:0xc
  s_add_u32 m0, s76, 16384
  v_add_u32_dpp v63, v45, v2 row_newbcast:3 row_mask:0xf bank_mask:0x3
  buffer_load_dwordx4 v64, s[32:35], 0 offen lds
  s_nop 0
  v_add_u32_dpp v63, v47, v2 row_newbcast:9 row_mask:0xf bank_mask:0xc
  s_add_u32 m0, s76, 18432
  v_add_u32_dpp v64, v49, v2 row_newbcast:3 row_mask:0xf bank_mask:0x3
  buffer_load_dwordx4 v65, s[32:35], 0 offen lds
  s_nop 0
  v_add_u32_dpp v64, v51, v2 row_newbcast:9 row_mask:0xf bank_mask:0xc
  v_add_u32_dpp v65, v53, v2 row_newbcast:3 row_mask:0xf bank_mask:0x3
  s_nop 1
  v_add_u32_dpp v65, v55, v2 row_newbcast:9 row_mask:0xf bank_mask:0xc
  v_lshlrev_b32 v101, 7, v70
  s_mov_b32 exec_lo, 0xffffffff
  s_mov_b32 exec_hi, 0x0
  buffer_load_dword v102, v101, s[32:35], 0 offen
  s_mov_b64 exec, -1
  v_mov_b32 v70, v71
  v_mov_b32 v71, v72
  v_mov_b32 v72, v73
  v_mov_b32_e64 v73, v74
  v_mov_b32 v74, 0xffffff
  s_waitcnt vmcnt(11)
  s_barrier
  s_add_u32 m0, s75, 131072
  s_nop 0
  buffer_load_dwordx4 v4, s[44:47], s74 offen lds
  s_add_u32 m0, s75, 132096
  s_nop 0
  buffer_load_dwordx4 v5, s[44:47], s74 offen lds
  s_add_u32 s74, s74, 106496
  s_add_u32 m0, s75, 139264
  s_nop 0
  buffer_load_dwordx4 v4, s[44:47], s74 offen lds
  s_add_u32 m0, s75, 140288
  s_nop 0
  buffer_load_dwordx4 v5, s[44:47], s74 offen lds
  s_add_u32 s74, s74, 106496
  s_add_u32 m0, s76, 40960
  s_nop 0
  buffer_load_dwordx4 v56, s[32:35], 0 offen lds
  s_add_u32 m0, s76, 43008
  v_add_u32_dpp v56, v18, v2 row_newbcast:3 row_mask:0xf bank_mask:0x3
  buffer_load_dwordx4 v57, s[32:35], 0 offen lds
  s_nop 0
  v_add_u32_dpp v56, v16, v2 row_newbcast:10 row_mask:0xf bank_mask:0xc
  s_add_u32 m0, s76, 45056
  v_add_u32_dpp v57, v22, v2 row_newbcast:3 row_mask:0xf bank_mask:0x3
  buffer_load_dwordx4 v58, s[32:35], 0 offen lds
  s_nop 0
  v_add_u32_dpp v57, v20, v2 row_newbcast:10 row_mask:0xf bank_mask:0xc
  s_add_u32 m0, s76, 47104
  v_add_u32_dpp v58, v26, v2 row_newbcast:3 row_mask:0xf bank_mask:0x3
  buffer_load_dwordx4 v59, s[32:35], 0 offen lds
  s_nop 0
  v_add_u32_dpp v58, v24, v2 row_newbcast:10 row_mask:0xf bank_mask:0xc
  s_add_u32 m0, s76, 49152
  v_add_u32_dpp v59, v30, v2 row_newbcast:3 row_mask:0xf bank_mask:0x3
  buffer_load_dwordx4 v60, s[32:35], 0 offen lds
  s_nop 0
  v_add_u32_dpp v59, v28, v2 row_newbcast:10 row_mask:0xf bank_mask:0xc
  s_add_u32 m0, s76, 51200
  v_add_u32_dpp v60, v34, v2 row_newbcast:3 row_mask:0xf bank_mask:0x3
  buffer_load_dwordx4 v61, s[32:35], 0 offen lds
  s_nop 0
  v_add_u32_dpp v60, v32, v2 row_newbcast:10 row_mask:0xf bank_mask:0xc
  s_add_u32 m0, s76, 53248
  v_add_u32_dpp v61, v38, v2 row_newbcast:3 row_mask:0xf bank_mask:0x3
  buffer_load_dwordx4 v62, s[32:35], 0 offen lds
  s_nop 0
  v_add_u32_dpp v61, v36, v2 row_newbcast:10 row_mask:0xf bank_mask:0xc
  s_add_u32 m0, s76, 55296
  v_add_u32_dpp v62, v42, v2 row_newbcast:3 row_mask:0xf bank_mask:0x3
  buffer_load_dwordx4 v63, s[32:35], 0 offen lds
  s_nop 0
  v_add_u32_dpp v62, v40, v2 row_newbcast:10 row_mask:0xf bank_mask:0xc
  s_add_u32 m0, s76, 57344
  v_add_u32_dpp v63, v46, v2 row_newbcast:3 row_mask:0xf bank_mask:0x3
  buffer_load_dwordx4 v64, s[32:35], 0 offen lds
  s_nop 0
  v_add_u32_dpp v63, v44, v2 row_newbcast:10 row_mask:0xf bank_mask:0xc
  s_add_u32 m0, s76, 59392
  v_add_u32_dpp v64, v50, v2 row_newbcast:3 row_mask:0xf bank_mask:0x3
  buffer_load_dwordx4 v65, s[32:35], 0 offen lds
  s_nop 0
  v_add_u32_dpp v64, v48, v2 row_newbcast:10 row_mask:0xf bank_mask:0xc
  v_add_u32_dpp v65, v54, v2 row_newbcast:3 row_mask:0xf bank_mask:0x3
  s_nop 1
  v_add_u32_dpp v65, v52, v2 row_newbcast:10 row_mask:0xf bank_mask:0xc
  v_mov_b32_dpp v16, v16 row_shl:3 row_mask:0xf bank_mask:0xf
  v_mov_b32_dpp v18, v18 row_shl:3 row_mask:0xf bank_mask:0xf
  v_mov_b32_dpp v20, v20 row_shl:3 row_mask:0xf bank_mask:0xf
  v_mov_b32_dpp v22, v22 row_shl:3 row_mask:0xf bank_mask:0xf
  v_mov_b32_dpp v24, v24 row_shl:3 row_mask:0xf bank_mask:0xf
  v_mov_b32_dpp v26, v26 row_shl:3 row_mask:0xf bank_mask:0xf
  v_mov_b32_dpp v28, v28 row_shl:3 row_mask:0xf bank_mask:0xf
  v_mov_b32_dpp v30, v30 row_shl:3 row_mask:0xf bank_mask:0xf
  v_mov_b32_dpp v32, v32 row_shl:3 row_mask:0xf bank_mask:0xf
  v_mov_b32_dpp v34, v34 row_shl:3 row_mask:0xf bank_mask:0xf
  v_mov_b32_dpp v36, v36 row_shl:3 row_mask:0xf bank_mask:0xf
  v_mov_b32_dpp v38, v38 row_shl:3 row_mask:0xf bank_mask:0xf
  v_mov_b32_dpp v40, v40 row_shl:3 row_mask:0xf bank_mask:0xf
  v_mov_b32_dpp v42, v42 row_shl:3 row_mask:0xf bank_mask:0xf
  v_mov_b32_dpp v44, v44 row_shl:3 row_mask:0xf bank_mask:0xf
  v_mov_b32_dpp v46, v46 row_shl:3 row_mask:0xf bank_mask:0xf
  v_mov_b32_dpp v48, v48 row_shl:3 row_mask:0xf bank_mask:0xf
  v_mov_b32_dpp v50, v50 row_shl:3 row_mask:0xf bank_mask:0xf
  v_mov_b32_dpp v52, v52 row_shl:3 row_mask:0xf bank_mask:0xf
  v_mov_b32_dpp v54, v54 row_shl:3 row_mask:0xf bank_mask:0xf
  s_waitcnt vmcnt(10)
  s_barrier
  s_add_u32 m0, s75, 147456
  s_nop 0
  buffer_load_dwordx4 v4, s[44:47], s74 offen lds
  s_add_u32 m0, s75, 148480
  s_nop 0
  buffer_load_dwordx4 v5, s[44:47], s74 offen lds
  s_add_u32 s74, s74, 106496
  s_add_u32 m0, s75, 155648
  s_nop 0
  buffer_load_dwordx4 v4, s[44:47], s74 offen lds
  s_add_u32 m0, s75, 156672
  s_nop 0
  buffer_load_dwordx4 v5, s[44:47], s74 offen lds
  s_add_u32 s74, s74, 106496
  s_add_u32 m0, s76, 81920
  s_nop 0
  buffer_load_dwordx4 v56, s[32:35], 0 offen lds
  s_add_u32 m0, s76, 83968
  v_add_u32_dpp v56, v19, v2 row_newbcast:3 row_mask:0xf bank_mask:0x3
  buffer_load_dwordx4 v57, s[32:35], 0 offen lds
  s_nop 0
  v_add_u32_dpp v56, v17, v2 row_newbcast:10 row_mask:0xf bank_mask:0xc
  s_add_u32 m0, s76, 86016
  v_add_u32_dpp v57, v23, v2 row_newbcast:3 row_mask:0xf bank_mask:0x3
  buffer_load_dwordx4 v58, s[32:35], 0 offen lds
  s_nop 0
  v_add_u32_dpp v57, v21, v2 row_newbcast:10 row_mask:0xf bank_mask:0xc
  s_add_u32 m0, s76, 88064
  v_add_u32_dpp v58, v27, v2 row_newbcast:3 row_mask:0xf bank_mask:0x3
  buffer_load_dwordx4 v59, s[32:35], 0 offen lds
  s_nop 0
  v_add_u32_dpp v58, v25, v2 row_newbcast:10 row_mask:0xf bank_mask:0xc
  s_add_u32 m0, s76, 90112
  v_add_u32_dpp v59, v31, v2 row_newbcast:3 row_mask:0xf bank_mask:0x3
  buffer_load_dwordx4 v60, s[32:35], 0 offen lds
  s_nop 0
  v_add_u32_dpp v59, v29, v2 row_newbcast:10 row_mask:0xf bank_mask:0xc
  s_add_u32 m0, s76, 92160
  v_add_u32_dpp v60, v35, v2 row_newbcast:3 row_mask:0xf bank_mask:0x3
  buffer_load_dwordx4 v61, s[32:35], 0 offen lds
  s_nop 0
  v_add_u32_dpp v60, v33, v2 row_newbcast:10 row_mask:0xf bank_mask:0xc
  s_add_u32 m0, s76, 94208
  v_add_u32_dpp v61, v39, v2 row_newbcast:3 row_mask:0xf bank_mask:0x3
  buffer_load_dwordx4 v62, s[32:35], 0 offen lds
  s_nop 0
  v_add_u32_dpp v61, v37, v2 row_newbcast:10 row_mask:0xf bank_mask:0xc
  s_add_u32 m0, s76, 96256
  v_add_u32_dpp v62, v43, v2 row_newbcast:3 row_mask:0xf bank_mask:0x3
  buffer_load_dwordx4 v63, s[32:35], 0 offen lds
  s_nop 0
  v_add_u32_dpp v62, v41, v2 row_newbcast:10 row_mask:0xf bank_mask:0xc
  s_add_u32 m0, s76, 98304
  v_add_u32_dpp v63, v47, v2 row_newbcast:3 row_mask:0xf bank_mask:0x3
  buffer_load_dwordx4 v64, s[32:35], 0 offen lds
  s_nop 0
  v_add_u32_dpp v63, v45, v2 row_newbcast:10 row_mask:0xf bank_mask:0xc
  s_add_u32 m0, s76, 100352
  v_add_u32_dpp v64, v51, v2 row_newbcast:3 row_mask:0xf bank_mask:0x3
  buffer_load_dwordx4 v65, s[32:35], 0 offen lds
  s_nop 0
  v_add_u32_dpp v64, v49, v2 row_newbcast:10 row_mask:0xf bank_mask:0xc
  v_add_u32_dpp v65, v55, v2 row_newbcast:3 row_mask:0xf bank_mask:0x3
  s_nop 1
  v_add_u32_dpp v65, v53, v2 row_newbcast:10 row_mask:0xf bank_mask:0xc
  v_mov_b32_dpp v17, v17 row_shl:3 row_mask:0xf bank_mask:0xf
  v_mov_b32_dpp v19, v19 row_shl:3 row_mask:0xf bank_mask:0xf
  v_mov_b32_dpp v21, v21 row_shl:3 row_mask:0xf bank_mask:0xf
  v_mov_b32_dpp v23, v23 row_shl:3 row_mask:0xf bank_mask:0xf
  v_mov_b32_dpp v25, v25 row_shl:3 row_mask:0xf bank_mask:0xf
  v_mov_b32_dpp v27, v27 row_shl:3 row_mask:0xf bank_mask:0xf
  v_mov_b32_dpp v29, v29 row_shl:3 row_mask:0xf bank_mask:0xf
  v_mov_b32_dpp v31, v31 row_shl:3 row_mask:0xf bank_mask:0xf
  v_mov_b32_dpp v33, v33 row_shl:3 row_mask:0xf bank_mask:0xf
  v_mov_b32_dpp v35, v35 row_shl:3 row_mask:0xf bank_mask:0xf
  v_mov_b32_dpp v37, v37 row_shl:3 row_mask:0xf bank_mask:0xf
  v_mov_b32_dpp v39, v39 row_shl:3 row_mask:0xf bank_mask:0xf
  v_mov_b32_dpp v41, v41 row_shl:3 row_mask:0xf bank_mask:0xf
  v_mov_b32_dpp v43, v43 row_shl:3 row_mask:0xf bank_mask:0xf
  v_mov_b32_dpp v45, v45 row_shl:3 row_mask:0xf bank_mask:0xf
  v_mov_b32_dpp v47, v47 row_shl:3 row_mask:0xf bank_mask:0xf
  v_mov_b32_dpp v49, v49 row_shl:3 row_mask:0xf bank_mask:0xf
  v_mov_b32_dpp v51, v51 row_shl:3 row_mask:0xf bank_mask:0xf
  v_mov_b32_dpp v53, v53 row_shl:3 row_mask:0xf bank_mask:0xf
  v_mov_b32_dpp v55, v55 row_shl:3 row_mask:0xf bank_mask:0xf
  s_add_u32 s72, s72, 1
  s_cmp_lt_u32 s72, 2
  s_waitcnt vmcnt(10)
  s_cbranch_scc1 L_dnn_loop1
  s_branch L_ld_tail
L_cin:
  v_lshlrev_b32 v1, 4, v0
  s_and_b32 s79, s3, 3
  s_lshr_b32 s84, s3, 2
  s_lshl_b32 s95, s79, 10
  s_mul_i32 s26, s68, 11
  s_add_u32 s26, s26, s69
  s_sub_u32 s26, s26, 22
  s_cmp_eq_u32 s26, 86
  s_cbranch_scc1 L_end
  s_cmp_eq_u32 s84, 0
  s_cbranch_scc1 L_sc
  s_setprio 2
  v_add_u32 v2, L_tables-L_pc+4096, v1
  v_mov_b32 v3, s93
  v_add_co_u32 v2, vcc, s92, v2
  s_nop 1
  v_addc_co_u32 v3, vcc, 0, v3, vcc
  v_add_co_u32 v32, vcc, s95, v2
  s_nop 1
  v_addc_co_u32 v33, vcc, 0, v3, vcc
  global_load_dwordx4 v[224:227], v[2:3], off offset:-4096
  v_add_co_u32 v2, vcc, 0x1800, v2
  s_nop 1
  v_addc_co_u32 v3, vcc, 0, v3, vcc
  global_load_dwordx4 v[240:243], v[2:3], off
  s_cmp_lt_u32 s79, 3
  s_mov_b32 s70, 122176
  s_cselect_b32 s70, 81920, s70
  s_add_u32 m0, s95, 81920
  s_nop 0
  global_load_lds_dwordx4 v[32:33], off offset:-4096
  s_add_u32 m0, s95, s70
  s_nop 0
  global_load_lds_dwordx4 v[32:33], off offset:0
  v_add_co_u32 v32, vcc, 0x2000, v32
  s_nop 1
  v_addc_co_u32 v33, vcc, 0, v33, vcc
  s_add_u32 m0, s95, 2048
  s_nop 0
  global_load_lds_dwordx4 v[32:33], off offset:0
  s_add_u32 m0, s95, 130368
  s_cmp_ge_u32 s79, 2
  s_cbranch_scc1 L_sc
  global_load_lds_dwordx4 v[32:33], off offset:-4096
L_sc:
  s_mul_i32 s85, s84, 20
  s_add_u32 s85, s85, s3
  s_mul_i32 s94, s26, 48
  s_add_u32 s94, s94, s85
  s_mul_i32 s94, s94, 104
  v_lshrrev_b32 v30, 3, v0
  v_lshlrev_b32 v30, 4, v30
  v_and_b32 v29, 0x70, v1
  s_mul_i32 s76, s3, 4064
  s_add_u32 s76, s76, 131136
  s_cmp_eq_u32 s84, 0
  s_cbranch_scc1 L_g0
  s_sub_u32 s68, s71, 22
  s_min_u32 s68, s68, 9
  s_lshl_b32 s68, s68, 2
  s_add_u32 s68, s68, s79
  s_lshl_b32 s68, s68, 7
  v_mul_u32_u24 v31, 5120, v0
  s_waitcnt lgkmcnt(0)
  s_mov_b32 s36, s8
  s_and_b32 s37, s9, 0xffff
  s_mov_b32 s38, 105456
  s_mov_b32 s39, 0x20000
  buffer_load_dword v107, v31, s[36:39], s68 offen
  s_waitcnt lgkmcnt(0)
  s_mov_b32 s40, s10
  s_and_b32 s41, s11, 0xffff
  s_mov_b32 s42, 156
  s_mov_b32 s43, 0x20000
  s_mov_b32 m0, 129472
  s_mov_b64 exec, 0x7ff
  buffer_load_dwordx4 v1, s[40:43], 0 offen lds
  s_mov_b64 exec, -1
  s_lshl_b32 s85, s85, 2
  s_add_u32 s85, s85, 129728
  s_mul_i32 s72, s84, 3
  s_sub_u32 s72, 4, s72
  s_cmp_eq_u32 s26, 85
  s_cselect_b32 s72, s72, 6
  s_lshl_b32 s52, s3, 7
  s_mul_i32 s53, s3, 5280
  s_lshl_b32 s54, s3, 2
  s_lshl_b32 s55, s3, 1
  s_lshl_b32 s82, s3, 12
  s_and_b32 s98, s3, 1
  s_lshr_b32 s99, s3, 1
  s_mul_i32 s68, s99, 3072
  s_lshl_b32 s83, s98, 3
  s_add_u32 s68, s68, s83
  v_add_u32_e64 v59, s68, v1
  s_lshl_b32 s69, s99, 3
  s_lshr_b32 s69, 0x05030200, s69
  s_and_b32 s69, s69, 0xff
  s_lshl_b32 s69, s69, 9
  s_lshl_b32 s70, s98, 2
  s_add_u32 s91, s69, s70
  s_mov_b32 s99, 0x05040100
  s_mov_b32 s100, 0x07060302
  v_mov_b32 v2, 129664
  v_mov_b32 v109, 0
  v_mov_b32 v108, 0
  v_mov_b64 v[32:33], 0
  v_mov_b64 v[34:35], 0
  v_mov_b64 v[36:37], 0
  v_mov_b64 v[38:39], 0
  v_mov_b64 v[40:41], 0
  v_mov_b64 v[42:43], 0
  v_mov_b64 v[44:45], 0
  v_mov_b64 v[46:47], 0
  v_mov_b64 v[48:49], 0
  v_mov_b64 v[50:51], 0
  v_mov_b64 v[52:53], 0
  v_mov_b64 v[54:55], 0
  v_mov_b64 v[56:57], 0
  v_add_u32 v250, 77824, v1
  s_waitcnt vmcnt(7)
  v_add_u32 v251, 125248, v1
  v_lshrrev_b32 v3, 5, v0
  v_lshl_add_u32 v3, v3, 2, v2
  s_mov_b32 s28, s4
  s_and_b32 s29, s5, 0xffff
  s_mov_b32 s30, 425984
  s_mov_b32 s31, 0x20000
  s_mov_b32 s32, s6
  s_and_b32 s33, s7, 0xffff
  s_mov_b32 s34, 12800000
  s_mov_b32 s35, 0x20000
  v_and_b32 v13, 31, v0
  v_min_u32 v13, 25, v13
  v_lshrrev_b32 v14, 5, v0
  v_mul_u32_u24 v14, 416, v14
  v_lshl_add_u32 v13, v13, 2, v14
  buffer_load_dword v14, v13, s[28:31], s94 offen
  ds_write_b128 v2, v[32:35] offset:16
  s_lshl_b32 s68, s79, 6
  v_add_u32 v29, s68, v0
  v_mul_u32_u24 v30, 2521, v29
  v_lshrrev_b32 v30, 16, v30
  v_mul_u32_u24 v30, 12, v30
  v_lshl_add_u32 v28, v29, 1, v30
  v_add_u32 v29, 256, v29
  v_mul_u32_u24 v30, 2521, v29
  v_lshrrev_b32 v30, 16, v30
  v_mul_u32_u24 v30, 12, v30
  v_lshl_add_u32 v58, v29, 1, v30
  v_add_u32 v29, 256, v29
  v_mul_u32_u24 v30, 2521, v29
  v_lshrrev_b32 v30, 16, v30
  v_mul_u32_u24 v30, 12, v30
  v_lshl_add_u32 v111, v29, 1, v30
  v_cmp_gt_u32 vcc, 676, v29
  s_nop 0
  s_mov_b64 s[92:93], vcc
  v_lshlrev_b32 v29, 3, v0
  s_mov_b32 exec_hi, 0xffff
  ds_write_b64 v29, v[32:33] offset:1664
  s_mov_b32 exec_hi, -1
  s_waitcnt vmcnt(6)
  ds_write_b32 v243, v32
  ds_write_b32 v243, v32 offset:43328
  s_waitcnt vmcnt(1)
  ds_read_b64 v[112:113], v240 offset:0
  ds_read_b64 v[114:115], v240 offset:8
  ds_read_b64 v[116:117], v240 offset:32
  ds_read_b64 v[118:119], v240 offset:40
  ds_read_u16 v110, v241
  s_mov_b64 exec, 0x3ffffff
  s_waitcnt lgkmcnt(0)
  ds_write_b16 v242, v110
  v_lshlrev_b32 v109, 17, v110
  v_lshrrev_b32 v109, 1, v109
  s_mov_b64 exec, -1
  v_add_u32 v225, s52, v225
  v_add_u32 v226, s52, v226
  v_add_u32_e64 v227, s52, v227
  s_waitcnt lgkmcnt(0)
  s_barrier
  ds_read_b64_tr_b16 v[60:61], v225 offset:35328
  ds_read_b64_tr_b16 v[62:63], v225 offset:40736
  ds_read_b64_tr_b16 v[64:65], v226 offset:35328
  ds_read_b64_tr_b16 v[66:67], v227 offset:35328
  ds_read_b64_tr_b16 v[68:69], v225 offset:35392
  ds_read_b64_tr_b16 v[70:71], v225 offset:40800
  ds_read_b64_tr_b16 v[72:73], v226 offset:35392
  ds_read_b64_tr_b16 v[74:75], v227 offset:35392
  ds_read_b64_tr_b16 v[76:77], v225 offset:35840
  ds_read_b64_tr_b16 v[78:79], v225 offset:41248
  ds_read_b64_tr_b16 v[80:81], v226 offset:35840
  ds_read_b64_tr_b16 v[82:83], v227 offset:35840
  ds_read_b64_tr_b16 v[84:85], v225 offset:35904
  ds_read_b64_tr_b16 v[86:87], v225 offset:41312
  ds_read_b64_tr_b16 v[88:89], v226 offset:35904
  ds_read_b64_tr_b16 v[90:91], v227 offset:35904
  s_waitcnt lgkmcnt(14)
  v_mfma_f32_32x32x16_bf16 v[120:135], v[112:115], v[60:63], 0
  s_waitcnt lgkmcnt(12)
  v_mfma_f32_32x32x16_bf16 v[120:135], v[116:119], v[64:67], v[120:135]
  ds_read_b64_tr_b16 v[92:93], v225 offset:36352
  ds_read_b64_tr_b16 v[94:95], v225 offset:41760
  ds_read_b64_tr_b16 v[96:97], v226 offset:36352
  ds_read_b64_tr_b16 v[98:99], v227 offset:36352
  s_waitcnt lgkmcnt(14)
  v_mfma_f32_32x32x16_bf16 v[136:151], v[112:115], v[68:71], 0
  s_waitcnt lgkmcnt(12)
  v_mfma_f32_32x32x16_bf16 v[136:151], v[116:119], v[72:75], v[136:151]
  ds_read_b64_tr_b16 v[100:101], v225 offset:36416
  ds_read_b64_tr_b16 v[102:103], v225 offset:41824
  ds_read_b64_tr_b16 v[104:105], v226 offset:36416
  ds_read_b64_tr_b16 v[106:107], v227 offset:36416
  s_waitcnt lgkmcnt(14)
  v_mfma_f32_32x32x16_bf16 v[152:167], v[112:115], v[76:79], 0
  s_waitcnt lgkmcnt(12)
  v_mfma_f32_32x32x16_bf16 v[152:167], v[116:119], v[80:83], v[152:167]
  s_waitcnt lgkmcnt(10)
  v_mfma_f32_32x32x16_bf16 v[168:183], v[112:115], v[84:87], 0
  s_waitcnt lgkmcnt(8)
  v_mfma_f32_32x32x16_bf16 v[168:183], v[116:119], v[88:91], v[168:183]
  ds_read_b128 v[228:231], v250 offset:6144
  ds_read_b128 v[232:235], v251 offset:0
  ds_read_b128 v[4:7], v250 offset:3072
  ds_read_b128 v[8:11], v251 offset:2048
  ds_read_b128 v[20:23], v250 offset:1024
  ds_read_b128 v[24:27], v250 offset:2048
  ds_read_b128 v[216:219], v250 offset:4096
  ds_read_b128 v[220:223], v250 offset:5120
  ds_read_b128 v[236:239], v251 offset:1024
  s_waitcnt lgkmcnt(14)
  v_mfma_f32_32x32x16_bf16 v[184:199], v[112:115], v[92:95], 0
  s_waitcnt lgkmcnt(13)
  v_mfma_f32_32x32x16_bf16 v[184:199], v[116:119], v[96:99], v[184:199]
  s_waitcnt lgkmcnt(11)
  v_mfma_f32_32x32x16_bf16 v[200:215], v[112:115], v[100:103], 0
  s_waitcnt lgkmcnt(9)
  v_mfma_f32_32x32x16_bf16 v[200:215], v[116:119], v[104:107], v[200:215]
  s_waitcnt lgkmcnt(8)
  v_add_u32 v228, s54, v228
  v_add_u32 v229, s54, v229
  v_add_u32 v231, s83, v231
  v_add_u32 v230, s91, v230
  s_waitcnt lgkmcnt(7)
  v_mad_u32_u24 v232, v233, s3, v232
  v_add_u32 v234, s55, v234
  v_mad_u32_u24 v233, v233, 8, v232
  v_add_u32 v246, s82, v235
  v_add_u32 v247, 2048, v246
  v_add_u32 v31, 0, v234
  v_and_b32 v31, 3, v31
  v_lshl_add_u32 v244, v31, 4, v232
  v_add_u32 v31, 1, v234
  v_and_b32 v31, 3, v31
  v_lshl_add_u32 v245, v31, 4, v232
  v_add_u32 v245, 1664, v245
  v_add_u32 v31, 0, v234
  v_and_b32 v31, 3, v31
  v_lshl_add_u32 v248, v31, 4, v233
  v_add_u32 v31, 1, v234
  v_and_b32 v31, 3, v31
  v_lshl_add_u32 v249, v31, 4, v233
  v_add_u32 v249, 1664, v249
  s_waitcnt lgkmcnt(5)
  v_add_u32 v10, s76, v10
  v_add_u32 v4, s76, v4
  v_add_u32 v5, s76, v5
  ds_write_b32 v10, v7 offset:2880
  v_add_u32 v11, s53, v11
  s_waitcnt lgkmcnt(5)
  v_add_u32 v20, s53, v20
  v_add_u32 v21, s53, v21
  v_add_u32 v22, s53, v22
  v_add_u32 v23, s53, v23
  s_waitcnt lgkmcnt(4)
  v_add_u32 v24, s53, v24
  v_add_u32 v25, s53, v25
  v_add_u32 v26, s53, v26
  v_add_u32 v27, s53, v27
  s_mov_b32 exec_lo, 0
  v_mov_b32 v120, v136
  s_mov_b32 exec_lo, -1
  v_cvt_pk_bf16_f32 v60, 0, v120
  ds_write_b16_d16_hi v28, v60
  v_max_f32 v108, |v60|, v108
  s_mov_b32 exec_lo, 0
  v_mov_b32 v152, v168
  s_mov_b32 exec_lo, -1
  v_cvt_pk_bf16_f32 v61, 0, v152
  ds_write_b16_d16_hi v58, v61
  v_max_f32 v108, |v61|, v108
  s_mov_b32 exec_lo, 0
  v_mov_b32 v184, v200
  s_mov_b32 exec_lo, -1
  v_cvt_pk_bf16_f32 v62, 0, v184
  s_mov_b64 exec, s[92:93]
  ds_write_b16_d16_hi v111, v62
  v_max_f32 v108, |v62|, v108
  s_mov_b64 exec, -1
  s_nop 0
  v_permlane32_swap_b32 v108, v109
  v_max_u32 v108, v108, v109
  s_nop 1
  v_max_u32_dpp v108, v108, v108 row_shr:1 row_mask:0xf bank_mask:0xf
  s_nop 1
  v_max_u32_dpp v108, v108, v108 row_shr:2 row_mask:0xf bank_mask:0xf
  s_nop 1
  v_max_u32_dpp v108, v108, v108 row_shr:4 row_mask:0xf bank_mask:0xf
  s_nop 1
  v_max_u32_dpp v108, v108, v108 row_shr:8 row_mask:0xf bank_mask:0xf
  s_nop 1
  v_max_u32_dpp v108, v108, v108 row_bcast:15 row_mask:0xa bank_mask:0xf
  s_mov_b32 exec_lo, 0x80000000
  s_mov_b32 exec_hi, 0x80000000
  ds_max_u32 v3, v108 offset:24
  s_mov_b64 exec, -1
  s_setprio 0
  s_waitcnt vmcnt(0)
  v_lshlrev_b32_e64 v14, 7, v14
  buffer_load_dword v13, v14, s[32:35], 0 offen
  s_waitcnt lgkmcnt(0)
  s_barrier
  s_branch L_w2
L_g0:
  s_waitcnt lgkmcnt(0)
  s_mov_b32 s36, s8
  s_and_b32 s37, s9, 0xffff
  s_mov_b32 s38, 105456
  s_mov_b32 s39, 0x20000
  s_add_u32 m0, s95, 41984
  s_add_u32 s81, s95, 70304
  buffer_load_dwordx4 v1, s[36:39], s81 offen lds
  s_add_u32 m0, s95, 46080
  s_add_u32 s81, s95, 74400
  buffer_load_dwordx4 v1, s[36:39], s81 offen lds
  s_add_u32 m0, s95, 50176
  s_add_u32 s81, s95, 78496
  buffer_load_dwordx4 v1, s[36:39], s81 offen lds
  s_add_u32 m0, s95, 54272
  s_add_u32 s81, s95, 82592
  buffer_load_dwordx4 v1, s[36:39], s81 offen lds
  s_add_u32 m0, s95, 58368
  s_add_u32 s81, s95, 86688
  buffer_load_dwordx4 v1, s[36:39], s81 offen lds
  s_add_u32 m0, s95, 62464
  s_add_u32 s81, s95, 90784
  buffer_load_dwordx4 v1, s[36:39], s81 offen lds
  s_add_u32 m0, s95, 66560
  s_add_u32 s81, s95, 94880
  buffer_load_dwordx4 v1, s[36:39], s81 offen lds
  s_add_u32 m0, s95, 70656
  s_add_u32 s81, s95, 98976
  buffer_load_dwordx4 v1, s[36:39], s81 offen lds
  s_cmp_eq_u32 s79, 3
  s_cbranch_scc1 L_st3
  s_add_u32 m0, s95, 74752
  s_add_u32 s81, s95, 103072
  buffer_load_dwordx4 v1, s[36:39], s81 offen lds
L_st3:
  s_mov_b32 s28, s4
  s_and_b32 s29, s5, 0xffff
  s_mov_b32 s30, 425984
  s_mov_b32 s31, 0x20000
  buffer_load_dwordx4 v[16:19], v30, s[28:31], s94 offen
  s_add_u32 s94, s94, 416
  buffer_load_dwordx4 v[104:107], v30, s[28:31], s94 offen
  s_add_u32 s94, s94, 416
  s_mov_b32 s32, s6
  s_and_b32 s33, s7, 0xffff
  s_mov_b32 s34, 12800000
  s_mov_b32 s35, 0x20000
  s_mul_i32 s96, s79, 3072
  s_mul_i32 s97, s79, 2704
  v_lshrrev_b32 v31, 5, v0
  v_mul_u32_u24 v31, 184, v31
  v_sub_u32 v31, v1, v31
  s_add_u32 m0, s96, 85312
  s_add_u32 s81, s97, 35152
  buffer_load_dwordx4 v1, s[36:39], s81 offen lds
  s_lshl_b32 s85, s85, 2
  s_add_u32 s85, s85, 129728
  s_mul_i32 s72, s84, 3
  s_sub_u32 s72, 4, s72
  s_cmp_eq_u32 s26, 85
  s_cselect_b32 s72, s72, 6
  s_add_u32 m0, s96, 86336
  s_add_u32 s81, s97, 36176
  buffer_load_dwordx4 v31, s[36:39], s81 offen lds
  s_lshl_b32 s52, s3, 7
  s_mul_i32 s53, s3, 5280
  s_lshl_b32 s54, s3, 2
  s_lshl_b32 s55, s3, 1
  s_lshl_b32 s82, s3, 12
  s_add_u32 m0, s96, 87360
  s_add_u32 s81, s97, 37016
  buffer_load_dwordx4 v1, s[36:39], s81 offen lds
  s_and_b32 s98, s3, 1
  s_lshr_b32 s99, s3, 1
  s_mul_i32 s68, s99, 3072
  s_lshl_b32 s83, s98, 3
  s_add_u32 s68, s68, s83
  s_add_u32 m0, s96, 97600
  s_add_u32 s81, s97, 45968
  buffer_load_dwordx4 v1, s[36:39], s81 offen lds
  v_add_u32_e64 v59, s68, v1
  s_lshl_b32 s69, s99, 3
  s_lshr_b32 s69, 0x05030200, s69
  s_and_b32 s69, s69, 0xff
  s_lshl_b32 s69, s69, 9
  s_add_u32 m0, s96, 98624
  s_add_u32 s81, s97, 46992
  buffer_load_dwordx4 v31, s[36:39], s81 offen lds
  s_lshl_b32 s70, s98, 2
  s_add_u32 s91, s69, s70
  s_mov_b32 s99, 0x05040100
  s_mov_b32 s100, 0x07060302
  v_mov_b32 v2, 129664
  s_add_u32 m0, s96, 99648
  s_add_u32 s81, s97, 47832
  buffer_load_dwordx4 v1, s[36:39], s81 offen lds
  v_mov_b32 v109, 0
  v_mov_b32 v108, 0
  v_mov_b64 v[32:33], 0
  v_mov_b64 v[34:35], 0
  v_mov_b64 v[36:37], 0
  s_add_u32 m0, s96, 109888
  s_add_u32 s81, s97, 56784
  buffer_load_dwordx4 v1, s[36:39], s81 offen lds
  v_mov_b64 v[38:39], 0
  v_mov_b64 v[40:41], 0
  v_mov_b64 v[42:43], 0
  v_mov_b64 v[44:45], 0
  v_mov_b64 v[46:47], 0
  s_add_u32 m0, s96, 110912
  s_add_u32 s81, s97, 57808
  buffer_load_dwordx4 v31, s[36:39], s81 offen lds
  v_mov_b64 v[48:49], 0
  v_mov_b64 v[50:51], 0
  v_mov_b64 v[52:53], 0
  v_mov_b64 v[54:55], 0
  v_mov_b64 v[56:57], 0
  s_add_u32 m0, s96, 111936
  s_add_u32 s81, s97, 58648
  buffer_load_dwordx4 v1, s[36:39], s81 offen lds
  v_add_u32 v250, 77824, v1
  s_waitcnt vmcnt(19)
  v_add_u32 v251, 125248, v1
  v_lshrrev_b32_e64 v3, 5, v0
  v_lshl_add_u32 v3, v3, 2, v2
  s_cmp_lg_u32 s79, 0
  s_cbranch_scc1 L_st2
  s_add_u32 m0, s96, 122176
  s_add_u32 s81, s97, 67600
  buffer_load_dwordx4 v1, s[36:39], s81 offen lds
  s_add_u32 m0, s96, 123200
  s_add_u32 s81, s97, 68624
  buffer_load_dwordx4 v31, s[36:39], s81 offen lds
  s_add_u32 m0, s96, 124224
  s_add_u32 s81, s97, 69464
  buffer_load_dwordx4 v1, s[36:39], s81 offen lds
L_st2:
  s_add_u32 m0, s95, 6144
  s_add_u32 s81, s95, 0
  buffer_load_dwordx4 v1, s[36:39], s81 offen lds
  s_add_u32 m0, s95, 10240
  s_add_u32 s81, s95, 4096
  buffer_load_dwordx4 v1, s[36:39], s81 offen lds
  s_add_u32 m0, s95, 14336
  s_add_u32 s81, s95, 8192
  buffer_load_dwordx4 v1, s[36:39], s81 offen lds
  s_add_u32 m0, s95, 18432
  s_add_u32 s81, s95, 12288
  buffer_load_dwordx4 v1, s[36:39], s81 offen lds
  s_waitcnt vmcnt(15)
  s_barrier
  ds_read_b128 v[224:227], v250 offset:0
  ds_read_b128 v[228:231], v250 offset:6144
  ds_read_b128 v[232:235], v251 offset:0
  ds_read_b128 v[4:7], v250 offset:3072
  ds_read_b128 v[8:11], v251 offset:2048
  ds_read_b128 v[20:23], v250 offset:1024
  ds_read_b128 v[24:27], v250 offset:2048
  ds_read_b128 v[216:219], v250 offset:4096
  ds_read_b128 v[220:223], v250 offset:5120
  ds_read_b128 v[236:239], v251 offset:1024
  s_add_u32 m0, s95, 22528
  s_add_u32 s81, s95, 16384
  buffer_load_dwordx4 v1, s[36:39], s81 offen lds
  s_add_u32 m0, s95, 26624
  s_add_u32 s81, s95, 20480
  buffer_load_dwordx4 v1, s[36:39], s81 offen lds
  s_add_u32 m0, s95, 30720
  s_add_u32 s81, s95, 24576
  buffer_load_dwordx4 v1, s[36:39], s81 offen lds
  s_add_u32 m0, s95, 34816
  s_add_u32 s81, s95, 28672
  buffer_load_dwordx4 v1, s[36:39], s81 offen lds
  s_cmp_eq_u32 s79, 3
  s_cbranch_scc1 L_st1
  s_add_u32 m0, s95, 38912
  s_add_u32 s81, s95, 32768
  buffer_load_dwordx4 v1, s[36:39], s81 offen lds
L_st1:
  s_waitcnt vmcnt(18)
  v_lshl_add_u32 v16, v16, 7, v29
  v_lshl_add_u32 v17, v17, 7, v29
  v_lshl_add_u32 v18, v18, 7, v29
  v_lshl_add_u32 v19, v19, 7, v29
  s_add_u32 m0, s76, 0
  s_mov_b32 exec_hi, 0xffffff
  buffer_load_dwordx4 v16, s[32:35], 0 offen lds
  s_add_u32 m0, s76, 1056
  s_nop 0
  buffer_load_dwordx4 v17, s[32:35], 0 offen lds
  s_add_u32 m0, s76, 2112
  s_mov_b32 exec_hi, 0xffff
  buffer_load_dwordx4 v18, s[32:35], 0 offen lds
  s_add_u32 m0, s76, 3168
  s_nop 0
  buffer_load_dwordx4 v19, s[32:35], 0 offen lds
  s_mov_b32 exec_hi, -1
  s_waitcnt vmcnt(21)
  v_lshl_add_u32 v104, v104, 7, v29
  v_lshl_add_u32 v105, v105, 7, v29
  v_lshl_add_u32 v106, v106, 7, v29
  v_lshl_add_u32 v107, v107, 7, v29
  s_add_u32 m0, s76, 16256
  s_mov_b32 exec_hi, 0xffffff
  buffer_load_dwordx4 v104, s[32:35], 0 offen lds
  s_add_u32 m0, s76, 17312
  s_nop 0
  buffer_load_dwordx4 v105, s[32:35], 0 offen lds
  s_add_u32 m0, s76, 18368
  s_mov_b32 exec_hi, 0xffff
  buffer_load_dwordx4 v106, s[32:35], 0 offen lds
  s_add_u32 m0, s76, 19424
  s_nop 0
  buffer_load_dwordx4 v107, s[32:35], 0 offen lds
  s_mov_b32 exec_hi, -1
  s_waitcnt lgkmcnt(9)
  v_add_u32 v225, s52, v225
  v_add_u32 v226, s52, v226
  v_add_u32 v227, s52, v227
  s_waitcnt lgkmcnt(8)
  v_add_u32 v228, s54, v228
  v_add_u32 v229, s54, v229
  v_add_u32 v231, s83, v231
  v_add_u32 v230, s91, v230
  s_waitcnt lgkmcnt(7)
  v_mad_u32_u24 v232, v233, s3, v232
  v_add_u32 v234, s55, v234
  v_mad_u32_u24 v233, v233, 8, v232
  v_add_u32 v246, s82, v235
  v_add_u32 v247, 2048, v246
  v_add_u32 v31, 0, v234
  v_and_b32 v31, 3, v31
  v_lshl_add_u32 v244, v31, 4, v232
  v_add_u32 v31, 1, v234
  v_and_b32 v31, 3, v31
  v_lshl_add_u32 v245, v31, 4, v232
  v_add_u32 v245, 1664, v245
  v_add_u32 v31, 0, v234
  v_and_b32 v31, 3, v31
  v_lshl_add_u32 v248, v31, 4, v233
  v_add_u32 v31, 1, v234
  v_and_b32 v31, 3, v31
  v_lshl_add_u32 v249, v31, 4, v233
  v_add_u32 v249, 1664, v249
  s_waitcnt lgkmcnt(5)
  v_add_u32 v10, s76, v10
  v_add_u32 v4, s76, v4
  v_add_u32 v5, s76, v5
  ds_write_b32 v10, v7 offset:2880
  v_add_u32 v11, s53, v11
  s_waitcnt lgkmcnt(5)
  v_add_u32 v20, s53, v20
  v_add_u32 v21, s53, v21
  v_add_u32 v22, s53, v22
  v_add_u32 v23, s53, v23
  s_waitcnt lgkmcnt(4)
  v_add_u32 v24, s53, v24
  v_add_u32 v25, s53, v25
  v_add_u32 v26, s53, v26
  v_add_u32_e64 v27, s53, v27
  s_waitcnt vmcnt(8)
  s_barrier
L_w2:
  ds_read2st64_b32 v[60:61], v228 offset0:0 offset1:6
  ds_read2st64_b32 v[62:63], v228 offset0:12 offset1:18
  ds_read2st64_b32 v[64:65], v228 offset0:24 offset1:30
  ds_read2st64_b32 v[66:67], v228 offset0:36 offset1:42
  ds_read2st64_b32 v[68:69], v228 offset0:96 offset1:102
  ds_read2st64_b32 v[70:71], v229 offset0:108 offset1:114
  ds_read2st64_b32 v[72:73], v229 offset0:120 offset1:126
  ds_read2st64_b32 v[74:75], v229 offset0:132 offset1:138
  s_cmp_ge_u32 s3, 5
  s_cbranch_scc1 L_u0
  v_add_u32 v228, 32, v228
  v_add_u32 v229, 32, v229
  ds_read2st64_b32 v[92:93], v228 offset0:0 offset1:6
  ds_read2st64_b32 v[94:95], v228 offset0:12 offset1:18
  ds_read2st64_b32 v[96:97], v228 offset0:24 offset1:30
  ds_read2st64_b32 v[98:99], v228 offset0:36 offset1:42
  ds_read2st64_b32 v[100:101], v228 offset0:96 offset1:102
  ds_read2st64_b32 v[102:103], v229 offset0:108 offset1:114
  ds_read2st64_b32 v[104:105], v229 offset0:120 offset1:126
  ds_read2st64_b32 v[106:107], v229 offset0:132 offset1:138
  ds_read_b64_tr_b16 v[76:77], v225 offset:0
  ds_read_b64_tr_b16 v[78:79], v225 offset:5408
  ds_read_b64_tr_b16 v[80:81], v226 offset:0
  ds_read_b64_tr_b16 v[82:83], v227 offset:0
  ds_read_b64_tr_b16 v[84:85], v225 offset:64
  ds_read_b64_tr_b16 v[86:87], v225 offset:5472
  ds_read_b64_tr_b16 v[88:89], v226 offset:64
  ds_read_b64_tr_b16 v[90:91], v227 offset:64
  ds_read_b64_tr_b16 v[112:113], v224 offset:0
  ds_read_b64_tr_b16 v[114:115], v224 offset:256
  ds_read_b64_tr_b16 v[116:117], v224 offset:1024
  ds_read_b64_tr_b16 v[118:119], v224 offset:1280
  s_waitcnt lgkmcnt(14)
  v_mfma_f32_16x16x32_bf16 v[108:111], v[60:63], v[60:63], 0
  v_mfma_f32_16x16x32_bf16 v[108:111], v[64:67], v[64:67], v[108:111]
  v_mfma_f32_16x16x32_bf16 v[108:111], v[68:71], v[68:71], v[108:111]
  s_nop 0
  v_mfma_f32_16x16x32_bf16 v[108:111], v[72:75], v[72:75], v[108:111]
  v_perm_b32 v184, v61, v60, s99
  v_perm_b32 v185, v63, v62, s99
  v_perm_b32 v186, v65, v64, s99
  v_perm_b32 v187, v67, v66, s99
  v_perm_b32 v188, v69, v68, s99
  v_perm_b32 v189, v71, v70, s99
  v_perm_b32 v190, v73, v72, s99
  v_perm_b32 v191, v75, v74, s99
  v_mfma_f32_16x16x32_bf16 v[108:111], v[92:95], v[92:95], v[108:111]
  v_mfma_f32_16x16x32_bf16 v[108:111], v[96:99], v[96:99], v[108:111]
  v_mfma_f32_16x16x32_bf16 v[108:111], v[100:103], v[100:103], v[108:111]
  s_waitcnt lgkmcnt(12)
  v_mfma_f32_16x16x32_bf16 v[108:111], v[104:107], v[104:107], v[108:111]
  s_waitcnt lgkmcnt(10)
  v_mfma_f32_16x16x32_bf16 v[28:31], v[76:79], v[76:79], 0
  s_waitcnt lgkmcnt(8)
  v_mfma_f32_16x16x32_bf16 v[28:31], v[80:83], v[80:83], v[28:31]
  s_waitcnt lgkmcnt(6)
  v_mfma_f32_16x16x32_bf16 v[28:31], v[84:87], v[84:87], v[28:31]
  s_nop 0
  s_waitcnt lgkmcnt(4)
  v_mfma_f32_16x16x32_bf16 v[28:31], v[88:91], v[88:91], v[28:31]
  v_perm_b32 v192, v61, v60, s100
  v_perm_b32 v193, v63, v62, s100
  v_perm_b32 v194, v65, v64, s100
  v_perm_b32 v195, v67, v66, s100
  v_perm_b32 v196, v69, v68, s100
  v_perm_b32 v197, v71, v70, s100
  v_perm_b32 v198, v73, v72, s100
  v_perm_b32 v199, v75, v74, s100
  v_max3_f32 v28, v28, v29, 0
  v_perm_b32 v60, v93, v92, s99
  v_perm_b32 v61, v95, v94, s99
  v_max3_f32 v108, v108, v109, 0
  v_perm_b32 v62, v97, v96, s99
  v_max3_f32 v28, v28, v30, v31
  v_perm_b32 v63, v99, v98, s99
  v_max3_f32 v108, v108, v110, v111
  v_perm_b32 v64, v101, v100, s99
  v_perm_b32 v65, v103, v102, s99
  v_permlane32_swap_b32 v28, v108
  v_perm_b32 v66, v105, v104, s99
  v_max_u32_e64 v28, v28, v108
  v_perm_b32 v67, v107, v106, s99
  s_nop 0
  v_max_u32_dpp v28, v28, v28 row_shr:1 row_mask:0xf bank_mask:0xf
  v_perm_b32 v68, v93, v92, s100
  v_perm_b32 v69, v95, v94, s100
  v_max_u32_dpp v28, v28, v28 row_shr:2 row_mask:0xf bank_mask:0xf
  v_perm_b32 v70, v97, v96, s100
  s_nop 0
  v_max_u32_dpp v28, v28, v28 row_shr:4 row_mask:0xf bank_mask:0xf
  v_perm_b32 v71, v99, v98, s100
  s_nop 0
  v_max_u32_dpp v28, v28, v28 row_shr:8 row_mask:0xf bank_mask:0xf
  v_perm_b32 v72, v101, v100, s100
  v_perm_b32 v73, v103, v102, s100
  v_max_u32_dpp v28, v28, v28 row_bcast:15 row_mask:0xa bank_mask:0xf
  v_perm_b32 v74, v105, v104, s100
  s_mov_b32 exec_lo, 0x80000000
  s_mov_b32 exec_hi, 0x80000000
  ds_max_u32 v3, v28 offset:16
  s_mov_b64 exec, -1
  v_perm_b32 v75, v107, v106, s100
  s_branch L_u1
L_u0:
  ds_read_b64_tr_b16 v[76:77], v225 offset:0
  ds_read_b64_tr_b16 v[78:79], v225 offset:5408
  ds_read_b64_tr_b16 v[80:81], v226 offset:0
  ds_read_b64_tr_b16 v[82:83], v227 offset:0
  ds_read_b64_tr_b16 v[84:85], v225 offset:64
  ds_read_b64_tr_b16 v[86:87], v225 offset:5472
  ds_read_b64_tr_b16 v[88:89], v226 offset:64
  ds_read_b64_tr_b16 v[90:91], v227 offset:64
  ds_read_b64_tr_b16 v[92:93], v225 offset:384
  ds_read_b64_tr_b16 v[94:95], v225 offset:5792
  ds_read_b64_tr_b16 v[96:97], v226 offset:384
  ds_read_b64_tr_b16 v[98:99], v227 offset:384
  ds_read_b64_tr_b16 v[100:101], v225 offset:448
  ds_read_b64_tr_b16 v[102:103], v225 offset:5856
  ds_read_b64_tr_b16 v[104:105], v226 offset:448
  ds_read_b64_tr_b16 v[106:107], v227 offset:448
  ds_read_b64_tr_b16 v[112:113], v224 offset:0
  ds_read_b64_tr_b16 v[114:115], v224 offset:256
  ds_read_b64_tr_b16 v[116:117], v224 offset:1024
  ds_read_b64_tr_b16 v[118:119], v224 offset:1280
  s_waitcnt lgkmcnt(14)
  v_mfma_f32_16x16x32_bf16 v[108:111], v[60:63], v[60:63], 0
  v_mfma_f32_16x16x32_bf16 v[108:111], v[64:67], v[64:67], v[108:111]
  s_nop 0
  v_mfma_f32_16x16x32_bf16 v[108:111], v[68:71], v[68:71], v[108:111]
  v_mfma_f32_16x16x32_bf16 v[108:111], v[72:75], v[72:75], v[108:111]
  v_mfma_f32_16x16x32_bf16 v[28:31], v[76:79], v[76:79], 0
  v_mfma_f32_16x16x32_bf16 v[28:31], v[80:83], v[80:83], v[28:31]
  v_mfma_f32_16x16x32_bf16 v[28:31], v[84:87], v[84:87], v[28:31]
  s_waitcnt lgkmcnt(12)
  v_mfma_f32_16x16x32_bf16 v[28:31], v[88:91], v[88:91], v[28:31]
  s_waitcnt lgkmcnt(10)
  v_mfma_f32_16x16x32_bf16 v[28:31], v[92:95], v[92:95], v[28:31]
  s_waitcnt lgkmcnt(8)
  v_mfma_f32_16x16x32_bf16 v[28:31], v[96:99], v[96:99], v[28:31]
  s_waitcnt lgkmcnt(6)
  v_mfma_f32_16x16x32_bf16 v[28:31], v[100:103], v[100:103], v[28:31]
  s_nop 0
  s_waitcnt lgkmcnt(4)
  v_mfma_f32_16x16x32_bf16 v[28:31], v[104:107], v[104:107], v[28:31]
  v_perm_b32 v184, v61, v60, s99
  v_perm_b32 v185, v63, v62, s99
  v_perm_b32 v186, v65, v64, s99
  v_perm_b32 v187, v67, v66, s99
  s_nop 3
  v_max3_f32 v28, v28, v29, 0
  v_perm_b32 v188, v69, v68, s99
  v_max3_f32 v108, v108, v109, 0
  v_perm_b32 v189, v71, v70, s99
  v_max3_f32 v28, v28, v30, v31
  v_perm_b32 v190, v73, v72, s99
  v_max3_f32 v108, v108, v110, v111
  v_perm_b32 v191, v75, v74, s99
  s_nop 0
  v_permlane32_swap_b32 v28, v108
  v_perm_b32 v192, v61, v60, s100
  v_max_u32 v28, v28, v108
  v_perm_b32 v193, v63, v62, s100
  s_nop 0
  v_max_u32_dpp v28, v28, v28 row_shr:1 row_mask:0xf bank_mask:0xf
  v_perm_b32 v194, v65, v64, s100
  s_nop 0
  v_max_u32_dpp v28, v28, v28 row_shr:2 row_mask:0xf bank_mask:0xf
  v_perm_b32 v195, v67, v66, s100
  s_nop 0
  v_max_u32_dpp v28, v28, v28 row_shr:4 row_mask:0xf bank_mask:0xf
  v_perm_b32 v196, v69, v68, s100
  s_nop 0
  v_max_u32_dpp v28, v28, v28 row_shr:8 row_mask:0xf bank_mask:0xf
  v_perm_b32 v197, v71, v70, s100
  s_nop 0
  v_max_u32_dpp v28, v28, v28 row_bcast:15 row_mask:0xa bank_mask:0xf
  v_perm_b32 v198, v73, v72, s100
  s_mov_b32 exec_lo, 0x80000000
  s_mov_b32 exec_hi, 0x80000000
  ds_max_u32 v3, v28 offset:16
  s_mov_b64 exec, -1
  v_perm_b32 v199, v75, v74, s100
  v_add_u32 v248, 12288, v246
  v_add_u32 v249, 12288, v247
  s_cmp_lg_u32 s3, 7
  s_cbranch_scc1 L_u1
  s_mov_b32 exec_lo, 0xfffffff0
  s_mov_b32 exec_hi, 0xfffffff0
  v_mov_b32 v249, 1048576
  s_mov_b64 exec, -1
L_u1:
  s_waitcnt lgkmcnt(0)
  s_barrier
  ds_read_b128 v[108:111], v2 offset:16
  s_mul_i32 s68, s3, 384
  v_lshrrev_b32 v29, 2, v0
  v_mul_u32_u24 v29, 24, v29
  v_add_u32 v29, s68, v29
  v_and_b32 v30, 3, v0
  v_lshlrev_b32 v30, 3, v30
  ds_read_b64 v[224:225], v29 offset:2048
  ds_read_b64 v[226:227], v29 offset:2056
  ds_read_b64 v[228:229], v29 offset:2064
  s_waitcnt lgkmcnt(3)
  v_add_u32 v108, 0x3f800000, v108
  v_add_u32 v109, 0x3f800000, v109
  v_lshrrev_b32 v108, 24, v108
  v_lshrrev_b32_e64 v109, 24, v109
  v_sub_u32 v108, 267, v108
  s_mov_b32 vcc_lo, 0x4000000
  v_min_u32 v108, 167, v108
  s_mov_b32 vcc_hi, 0x4000000
  v_readfirstlane_b32 s74, v108
  v_cndmask_b32 v250, v110, v111, vcc
  v_mul_u32_u24 v108, 0x800080, v108
  v_lshrrev_b32 v250, 23, v250
  v_and_b32 v216, v216, v108
  v_and_b32 v217, v217, v108
  v_and_b32 v218, v218, v108
  v_and_b32 v219, v219, v108
  v_and_b32 v220, v220, v108
  v_and_b32 v221, v221, v108
  v_and_b32 v222, v222, v108
  v_and_b32 v223, v223, v108
  v_mfma_f32_32x32x16_bf16 v[152:167], v[216:219], v[76:79], 0
  v_add_u32_e64 v250, v250, v109
  v_sub_u32 v250, 388, v250
  v_mfma_f32_32x32x16_bf16 v[168:183], v[216:219], v[84:87], 0
  s_movk_i32 s98, 167
  v_med3_i32 v250, v250, 1, s98
  v_mfma_f32_32x32x16_bf16 v[152:167], v[220:223], v[80:83], v[152:167]
  v_subrev_u32 v110, 127, v250
  v_lshlrev_b32 v250, 23, v250
  v_mfma_f32_32x32x16_bf16 v[168:183], v[220:223], v[88:91], v[168:183]
  v_cmp_gt_i32 vcc, 0, v110
  v_mul_u32_u24 v110, 0x800080, v110
  s_cbranch_vccnz L_sdown
  v_add_u32 v112, v112, v110
  v_add_u32 v113, v113, v110
  v_add_u32 v114, v114, v110
  v_add_u32 v115, v115, v110
  v_add_u32 v116, v116, v110
  v_add_u32 v117, v117, v110
  v_add_u32 v118, v118, v110
  v_add_u32 v119, v119, v110
L_scaled:
  v_mfma_f32_32x32x16_bf16 v[120:135], v[184:187], v[112:115], 0
  v_cvt_pk_f16_f32 v152, v152, v153
  v_cvt_pk_f16_f32 v153, v154, v155
  v_cvt_pk_f16_f32 v154, v156, v157
  v_cvt_pk_f16_f32 v155, v158, v159
  ds_write_b128 v246, v[152:155]
  v_xor_b32 v246, 16, v246
  v_mfma_f32_32x32x16_bf16 v[120:135], v[188:191], v[116:119], v[120:135]
  v_cvt_pk_f16_f32 v156, v160, v161
  v_cvt_pk_f16_f32 v157, v162, v163
  v_cvt_pk_f16_f32 v158, v164, v165
  v_cvt_pk_f16_f32 v159, v166, v167
  ds_write_b128 v246, v[156:159]
  v_mfma_f32_32x32x16_bf16 v[136:151], v[192:195], v[112:115], 0
  v_cvt_pk_f16_f32 v168, v168, v169
  v_cvt_pk_f16_f32 v169, v170, v171
  v_cvt_pk_f16_f32 v170, v172, v173
  v_cvt_pk_f16_f32 v171, v174, v175
  ds_write_b128 v247, v[168:171]
  v_xor_b32_e64 v247, 16, v247
  v_mfma_f32_32x32x16_bf16 v[136:151], v[196:199], v[116:119], v[136:151]
  v_cvt_pk_f16_f32 v172, v176, v177
  v_cvt_pk_f16_f32 v173, v178, v179
  v_cvt_pk_f16_f32 v174, v180, v181
  v_cvt_pk_f16_f32 v175, v182, v183
  ds_write_b128 v247, v[172:175]
  s_cmp_ge_u32 s3, 5
  s_cbranch_scc1 L_u2
  v_mfma_f32_32x32x16_bf16 v[184:199], v[60:63], v[112:115], 0
  v_cvt_pk_f16_f32 v120, v120, v121
  v_cvt_pk_f16_f32 v121, v122, v123
  v_cvt_pk_f16_f32 v122, v124, v125
  v_mfma_f32_32x32x16_bf16 v[184:199], v[64:67], v[116:119], v[184:199]
  v_cvt_pk_f16_f32 v123, v126, v127
  ds_write_b128 v244, v[120:123]
  v_xor_b32_e64 v244, 16, v244
  v_mfma_f32_32x32x16_bf16 v[200:215], v[68:71], v[112:115], 0
  v_cvt_pk_f16_f32 v124, v128, v129
  v_cvt_pk_f16_f32 v125, v130, v131
  v_cvt_pk_f16_f32 v126, v132, v133
  v_mfma_f32_32x32x16_bf16 v[200:215], v[72:75], v[116:119], v[200:215]
  v_cvt_pk_f16_f32 v127, v134, v135
  ds_write_b128 v244, v[124:127]
  s_branch L_u3
L_u2:
  v_mfma_f32_32x32x16_bf16 v[184:199], v[216:219], v[92:95], 0
  v_cvt_pk_f16_f32 v120, v120, v121
  v_cvt_pk_f16_f32 v121, v122, v123
  v_cvt_pk_f16_f32 v122, v124, v125
  v_mfma_f32_32x32x16_bf16 v[184:199], v[220:223], v[96:99], v[184:199]
  v_cvt_pk_f16_f32 v123, v126, v127
  ds_write_b128 v244, v[120:123]
  v_xor_b32 v244, 16, v244
  v_mfma_f32_32x32x16_bf16 v[200:215], v[216:219], v[100:103], 0
  v_cvt_pk_f16_f32 v124, v128, v129
  v_cvt_pk_f16_f32 v125, v130, v131
  v_cvt_pk_f16_f32 v126, v132, v133
  v_mfma_f32_32x32x16_bf16 v[200:215], v[220:223], v[104:107], v[200:215]
  v_cvt_pk_f16_f32 v127, v134, v135
  ds_write_b128 v244, v[124:127]
L_u3:
  buffer_load_dwordx4 v[16:19], v6, s[28:31], s94 offen
  s_add_u32 s94, s94, 416
  buffer_load_dwordx4 v[112:115], v6, s[28:31], s94 offen
  s_add_u32 s94, s94, 416
  v_cvt_pk_f16_f32 v136, v136, v137
  s_waitcnt lgkmcnt(8)
  v_xor_b32 v224, v224, v30
  v_cvt_pk_f16_f32 v137, v138, v139
  v_cvt_pk_f16_f32 v138, v140, v141
  v_xor_b32 v232, 32, v224
  v_cvt_pk_f16_f32 v139, v142, v143
  ds_write_b128 v245, v[136:139]
  v_xor_b32 v245, 16, v245
  v_xor_b32 v225, v225, v30
  v_cvt_pk_f16_f32 v140, v144, v145
  v_cvt_pk_f16_f32 v141, v146, v147
  v_cvt_pk_f16_f32 v142, v148, v149
  v_xor_b32 v233, 32, v225
  v_cvt_pk_f16_f32 v143, v150, v151
  ds_write_b128 v245, v[140:143]
  v_cvt_pk_f16_f32 v184, v184, v185
  s_waitcnt lgkmcnt(9)
  v_xor_b32 v226, v226, v30
  v_cvt_pk_f16_f32 v185, v186, v187
  v_cvt_pk_f16_f32 v186, v188, v189
  v_xor_b32_e64 v234, 32, v226
  v_cvt_pk_f16_f32 v187, v190, v191
  ds_write_b128 v248, v[184:187]
  v_xor_b32 v248, 16, v248
  v_xor_b32 v227, v227, v30
  v_cvt_pk_f16_f32 v188, v192, v193
  v_cvt_pk_f16_f32 v189, v194, v195
  v_cvt_pk_f16_f32 v190, v196, v197
  v_xor_b32_e64 v235, 32, v227
  v_cvt_pk_f16_f32 v191, v198, v199
  ds_write_b128 v248, v[188:191]
  v_cvt_pk_f16_f32 v200, v200, v201
  s_waitcnt lgkmcnt(10)
  v_xor_b32 v228, v228, v30
  v_cvt_pk_f16_f32 v201, v202, v203
  v_cvt_pk_f16_f32 v202, v204, v205
  v_xor_b32 v240, 32, v228
  v_cvt_pk_f16_f32 v203, v206, v207
  ds_write_b128 v249, v[200:203]
  v_xor_b32 v249, 16, v249
  v_xor_b32_e64 v229, v229, v30
  v_cvt_pk_f16_f32 v204, v208, v209
  v_cvt_pk_f16_f32 v205, v210, v211
  v_cvt_pk_f16_f32 v206, v212, v213
  v_xor_b32_e64 v241, 32, v229
  v_cvt_pk_f16_f32 v207, v214, v215
  ds_write_b128 v249, v[204:207]
  v_readlane_b32 s0, v250, 0
  v_readlane_b32 s1, v250, 26
  s_sub_u32 s75, 0x7f000000, s0
  s_sub_u32 s1, 0x7f000000, s1
  s_sub_u32 s74, 254, s74
  s_lshl_b32 s74, s74, 23
  s_mov_b32 s92, 0x88888888
  s_mov_b32 s93, 0x88888888
  s_waitcnt lgkmcnt(0)
  s_barrier
  ds_read_b64_tr_b16 v[60:61], v224 offset:0
  ds_read_b64_tr_b16 v[62:63], v225 offset:0
  ds_read_b64_tr_b16 v[64:65], v232 offset:0
  ds_read_b64_tr_b16 v[66:67], v233 offset:0
  ds_read_b64_tr_b16 v[68:69], v224 offset:43328
  ds_read_b64_tr_b16 v[70:71], v225 offset:43328
  ds_read_b64_tr_b16 v[72:73], v232 offset:43328
  ds_read_b64_tr_b16 v[74:75], v233 offset:43328
  ds_read_b64_tr_b16 v[76:77], v226 offset:0
  ds_read_b64_tr_b16 v[78:79], v227 offset:0
  ds_read_b64_tr_b16 v[80:81], v234 offset:0
  ds_read_b64_tr_b16 v[82:83], v235 offset:0
  ds_read_b64_tr_b16 v[84:85], v226 offset:43328
  ds_read_b64_tr_b16 v[86:87], v227 offset:43328
  ds_read_b64_tr_b16 v[88:89], v234 offset:43328
  ds_read_b64_tr_b16 v[90:91], v235 offset:43328
  s_cmp_ge_u32 s3, 6
  s_cbranch_scc1 L_lin
  ds_read_b64_tr_b16 v[92:93], v228 offset:0
  ds_read_b64_tr_b16 v[94:95], v229 offset:0
  ds_read_b64_tr_b16 v[96:97], v240 offset:0
  ds_read_b64_tr_b16 v[98:99], v241 offset:0
  ds_read_b64_tr_b16 v[100:101], v228 offset:43328
  ds_read_b64_tr_b16 v[102:103], v229 offset:43328
  ds_read_b64_tr_b16 v[104:105], v240 offset:43328
  ds_read_b64_tr_b16 v[106:107], v241 offset:43328
  s_waitcnt lgkmcnt(6)
  v_pk_add_f16 v92, v92, v94
  v_pk_add_f16 v93, v93, v95
  ds_write_b64 v59, v[92:93] offset:30720
  s_waitcnt lgkmcnt(5)
  v_pk_add_f16 v96, v96, v98
  v_pk_add_f16 v97, v97, v99
  s_waitcnt lgkmcnt(3)
  v_pk_add_f16 v100, v100, v102
  v_pk_add_f16 v101, v101, v103
  ds_write_b64 v59, v[100:101] offset:32768
  s_waitcnt lgkmcnt(2)
  v_pk_add_f16 v104, v104, v106
  v_pk_add_f16 v105, v105, v107
  v_cndmask_b32 v96, v96, v104, s[92:93]
  v_cndmask_b32 v97, v97, v105, s[92:93]
  ds_write_b64 v59, v[96:97] offset:31744
  ds_write_b32 v230, v104 offset:3072
  ds_write_b32 v230, v105 offset:3088
  s_branch L_p2
L_lin:
  s_and_b32 s98, s3, 1
  s_cselect_b64 vcc, -1, 0
  s_lshl_b32 s99, s98, 5
  v_mov_b32 v31, 0
  v_xor_b32 v236, s99, v236
  v_xor_b32 v237, s99, v237
  v_cndmask_b32 v238, v238, v239, vcc
  ds_read_b64_tr_b16 v[92:93], v236
  ds_read_b64_tr_b16 v[94:95], v237
  ds_read_u16_d16_hi v31, v238
  s_lshl_b32 s98, s98, 10
  v_add_u32 v29, s98, v1
  s_waitcnt lgkmcnt(2)
  v_cvt_f32_f16 v96, v92
  v_cvt_f32_f16_sdwa v97, v92 dst_sel:DWORD dst_unused:UNUSED_PAD src0_sel:WORD_1
  v_mul_f32 v96, s1, v96
  v_mul_f32 v97, s1, v97
  v_mul_f32 v96, s0, v96
  v_mul_f32 v97, s0, v97
  v_cvt_pk_bf16_f32 v92, v96, v97
  v_cvt_f32_f16 v98, v93
  v_cvt_f32_f16_sdwa v99, v93 dst_sel:DWORD dst_unused:UNUSED_PAD src0_sel:WORD_1
  v_mul_f32 v98, s1, v98
  v_mul_f32 v99, s1, v99
  v_mul_f32 v98, s0, v98
  v_mul_f32 v99, s0, v99
  v_cvt_pk_bf16_f32 v93, v98, v99
  s_waitcnt lgkmcnt(1)
  v_cvt_f32_f16 v100, v94
  v_cvt_f32_f16_sdwa v101, v94 dst_sel:DWORD dst_unused:UNUSED_PAD src0_sel:WORD_1
  v_mul_f32 v100, s1, v100
  v_mul_f32 v101, s1, v101
  v_mul_f32 v100, s0, v100
  v_mul_f32 v101, s0, v101
  v_cvt_pk_bf16_f32 v94, v100, v101
  v_cvt_f32_f16_e64 v102, v95
  v_cvt_f32_f16_sdwa v103, v95 dst_sel:DWORD dst_unused:UNUSED_PAD src0_sel:WORD_1
  v_mul_f32 v102, s1, v102
  v_mul_f32 v103, s1, v103
  s_mov_b32 exec_lo, 0
  s_mov_b32 exec_hi, 0xffff
  s_waitcnt lgkmcnt(0)
  v_mov_b32 v102, v31
  s_mov_b64 exec, -1
  v_mul_f32 v102, s0, v102
  v_mul_f32 v103, s0, v103
  v_cvt_pk_bf16_f32 v95, v102, v103
  ds_write_b128 v29, v[92:95] offset:39936
L_p2:
  v_pk_add_f16 v76, v76, v78
  v_pk_add_f16 v77, v77, v79
  ds_write_b64 v59, v[76:77] offset:18432
  v_pk_add_f16 v80, v80, v82
  v_pk_add_f16 v81, v81, v83
  v_pk_add_f16 v84, v84, v86
  v_pk_add_f16 v85, v85, v87
  ds_write_b64 v59, v[84:85] offset:20480
  v_pk_add_f16 v88, v88, v90
  v_pk_add_f16 v89, v89, v91
  v_cndmask_b32 v80, v80, v88, s[92:93]
  v_cndmask_b32 v81, v81, v89, s[92:93]
  ds_write_b64 v59, v[80:81] offset:19456
  ds_write_b32 v230, v88 offset:1024
  ds_write_b32 v230, v89 offset:1040
  v_pk_add_f16 v60, v60, v62
  v_pk_add_f16 v61, v61, v63
  ds_write_b64 v59, v[60:61] offset:6144
  v_pk_add_f16 v64, v64, v66
  v_pk_add_f16 v65, v65, v67
  v_pk_add_f16 v68, v68, v70
  v_pk_add_f16 v69, v69, v71
  ds_write_b64 v59, v[68:69] offset:8192
  v_pk_add_f16 v72, v72, v74
  v_pk_add_f16 v73, v73, v75
  v_cndmask_b32 v64, v64, v72, s[92:93]
  v_cndmask_b32 v65, v65, v73, s[92:93]
  ds_write_b64 v59, v[64:65] offset:7168
  s_cmp_lt_u32 s3, 2
  s_cbranch_scc1 L_p2d
  v_subrev_u32 v230, 1024, v230
  ds_write_b32 v230, v72 offset:0
  ds_write_b32 v230, v73 offset:16
  s_branch L_built
L_p2d:
  ds_write_b64 v231, v[72:73] offset:5120
L_built:
  s_mov_b32 s0, s74
  s_mov_b32 s1, s75
  s_mov_b32 s96, 0x3e000000
  s_mov_b32 s97, 0x43000000
  s_mov_b32 s51, 1
  s_mul_i32 s98, s3, 1536
  s_add_u32 s98, s98, 116736
  s_cmp_lg_u32 s84, 0
  s_cbranch_scc1 L_g1c
  s_sub_u32 s94, s94, 416
  s_waitcnt vmcnt(0)
  ds_read_u16_d16_hi v32, v10 offset:0
  ds_read_u16_d16_hi v33, v10 offset:2
  ds_read_u16_d16_hi v34, v10 offset:2112
  ds_read_u16_d16_hi v35, v10 offset:2114
  ds_read_u16_d16_hi v36, v10 offset:128
  ds_read_u16_d16_hi v37, v10 offset:130
  ds_read_u16_d16_hi v38, v10 offset:2240
  ds_read_u16_d16_hi v39, v10 offset:2242
  ds_read_u16_d16_hi v40, v10 offset:256
  ds_read_u16_d16_hi v41, v10 offset:258
  ds_read_u16_d16_hi v42, v10 offset:2368
  ds_read_u16_d16_hi v43, v10 offset:2370
  ds_read_u16_d16_hi v44, v10 offset:384
  ds_read_u16_d16_hi v45, v10 offset:386
  ds_read_u16_d16_hi v46, v10 offset:2496
  ds_read_u16_d16_hi v47, v10 offset:2498
  ds_read_u16_d16_hi v48, v10 offset:512
  ds_read_u16_d16_hi v49, v10 offset:514
  ds_read_u16_d16_hi v50, v10 offset:2624
  ds_read_u16_d16_hi v51, v10 offset:2626
  ds_read_u16_d16_hi v52, v10 offset:640
  ds_read_u16_d16_hi v53, v10 offset:642
  ds_read_u16_d16_hi v54, v10 offset:2752
  ds_read_u16_d16_hi v55, v10 offset:2754
  ds_read_u16_d16_hi v56, v10 offset:768
  ds_read_u16_d16_hi v57, v10 offset:770
  s_waitcnt lgkmcnt(14)
  v_max3_f32 v58, |v32|, |v33|, 0
  v_cvt_pk_f16_f32 v184, v32, v33
  v_max3_f32 v58, |v34|, |v35|, v58
  v_cvt_pk_f16_f32 v185, v34, v35
  v_max3_f32 v58, |v36|, |v37|, v58
  v_cvt_pk_f16_f32 v186, v36, v37
  v_max3_f32 v58, |v38|, |v39|, v58
  v_cvt_pk_f16_f32 v187, v38, v39
  v_max3_f32 v58, |v40|, |v41|, v58
  v_cvt_pk_f16_f32 v188, v40, v41
  v_max3_f32 v58, |v42|, |v43|, v58
  v_cvt_pk_f16_f32 v189, v42, v43
  s_waitcnt lgkmcnt(12)
  v_max3_f32 v58, |v44|, |v45|, v58
  v_cvt_pk_f16_f32 v190, v44, v45
  s_waitcnt lgkmcnt(10)
  v_max3_f32 v58, |v46|, |v47|, v58
  v_cvt_pk_f16_f32 v191, v46, v47
  s_waitcnt lgkmcnt(8)
  v_max3_f32 v58, |v48|, |v49|, v58
  v_cvt_pk_f16_f32 v192, v48, v49
  s_waitcnt lgkmcnt(6)
  v_max3_f32 v58, |v50|, |v51|, v58
  v_cvt_pk_f16_f32 v193, v50, v51
  s_waitcnt lgkmcnt(4)
  v_max3_f32 v58, |v52|, |v53|, v58
  v_cvt_pk_f16_f32 v194, v52, v53
  s_waitcnt lgkmcnt(2)
  v_max3_f32 v58, |v54|, |v55|, v58
  v_cvt_pk_f16_f32 v195, v54, v55
  s_waitcnt lgkmcnt(0)
  v_max3_f32 v58, |v56|, |v57|, v58
  v_cvt_pk_f16_f32 v196, v56, v57
  s_waitcnt lgkmcnt(0)
  s_barrier
  s_branch L_cin_go
L_g1c:
  s_waitcnt lgkmcnt(0)
  s_barrier
  s_add_u32 s76, s76, -63168
  s_waitcnt vmcnt(1)
  v_lshl_add_u32 v16, v16, 7, v8
  v_lshl_add_u32 v17, v17, 7, v8
  v_lshl_add_u32 v18, v18, 7, v8
  v_lshl_add_u32 v19, v19, 7, v8
  s_add_u32 m0, s76, 0
  s_mov_b32 exec_hi, 0xffffff
  buffer_load_dwordx4 v16, s[32:35], 0 offen lds
  s_add_u32 m0, s76, 1056
  s_nop 0
  buffer_load_dwordx4 v17, s[32:35], 0 offen lds
  s_add_u32 m0, s76, 2112
  s_mov_b32 exec_hi, 0xffff
  buffer_load_dwordx4 v18, s[32:35], 0 offen lds
  s_add_u32 m0, s76, 3168
  s_nop 0
  buffer_load_dwordx4 v19, s[32:35], 0 offen lds
  s_mov_b32 exec_hi, -1
  s_waitcnt vmcnt(4)
  v_lshl_add_u32 v112, v112, 7, v8
  v_lshl_add_u32 v113, v113, 7, v8
  v_lshl_add_u32 v114, v114, 7, v8
  v_lshl_add_u32 v115, v115, 7, v8
  s_add_u32 m0, s76, 16256
  s_mov_b32 exec_hi, 0xffffff
  buffer_load_dwordx4 v112, s[32:35], 0 offen lds
  s_add_u32 m0, s76, 17312
  s_nop 0
  buffer_load_dwordx4 v113, s[32:35], 0 offen lds
  s_add_u32 m0, s76, 18368
  s_mov_b32 exec_hi, 0xffff
  buffer_load_dwordx4 v114, s[32:35], 0 offen lds
  s_add_u32 m0, s76, 19424
  s_nop 0
  buffer_load_dwordx4 v115, s[32:35], 0 offen lds
  s_mov_b32 exec_hi, -1
  buffer_load_dwordx4 v[16:19], v6, s[28:31], s94 offen
  s_add_u32 s94, s94, 416
  v_add_u32 v10, -63168, v10
  v_add_u32 v4, -63168, v4
  v_add_u32 v5, -63168, v5
  ds_write_b32 v10, v7 offset:2880
  ds_write_b32 v10, v7 offset:19136
L_g1d:
  s_waitcnt vmcnt(5)
  ds_read_u16_d16_hi v32, v10 offset:0
  ds_read_u16_d16_hi v33, v10 offset:2
  ds_read_u16_d16_hi v34, v10 offset:2112
  ds_read_u16_d16_hi v35, v10 offset:2114
  ds_read_u16_d16_hi v36, v10 offset:128
  ds_read_u16_d16_hi v37, v10 offset:130
  ds_read_u16_d16_hi v38, v10 offset:2240
  ds_read_u16_d16_hi v39, v10 offset:2242
  ds_read_u16_d16_hi v40, v10 offset:256
  ds_read_u16_d16_hi v41, v10 offset:258
  ds_read_u16_d16_hi v42, v10 offset:2368
  ds_read_u16_d16_hi v43, v10 offset:2370
  ds_read_u16_d16_hi v44, v10 offset:384
  ds_read_u16_d16_hi v45, v10 offset:386
  ds_read_u16_d16_hi v46, v10 offset:2496
  ds_read_u16_d16_hi v47, v10 offset:2498
  ds_read_u16_d16_hi v48, v10 offset:512
  ds_read_u16_d16_hi v49, v10 offset:514
  ds_read_u16_d16_hi v50, v10 offset:2624
  ds_read_u16_d16_hi v51, v10 offset:2626
  ds_read_u16_d16_hi v52, v10 offset:640
  ds_read_u16_d16_hi v53, v10 offset:642
  ds_read_u16_d16_hi v54, v10 offset:2752
  ds_read_u16_d16_hi v55, v10 offset:2754
  ds_read_u16_d16_hi v56, v10 offset:768
  ds_read_u16_d16_hi v57, v10 offset:770
  s_waitcnt lgkmcnt(14)
  v_max3_f32 v58, |v32|, |v33|, 0
  v_cvt_pk_f16_f32 v184, v32, v33
  v_max3_f32 v58, |v34|, |v35|, v58
  v_cvt_pk_f16_f32 v185, v34, v35
  v_max3_f32 v58, |v36|, |v37|, v58
  v_cvt_pk_f16_f32 v186, v36, v37
  v_max3_f32 v58, |v38|, |v39|, v58
  v_cvt_pk_f16_f32 v187, v38, v39
  v_max3_f32 v58, |v40|, |v41|, v58
  v_cvt_pk_f16_f32 v188, v40, v41
  v_max3_f32 v58, |v42|, |v43|, v58
  v_cvt_pk_f16_f32 v189, v42, v43
  s_waitcnt lgkmcnt(12)
  v_max3_f32 v58, |v44|, |v45|, v58
  v_cvt_pk_f16_f32 v190, v44, v45
  s_waitcnt lgkmcnt(10)
  v_max3_f32 v58, |v46|, |v47|, v58
  v_cvt_pk_f16_f32 v191, v46, v47
  s_waitcnt lgkmcnt(8)
  v_max3_f32 v58, |v48|, |v49|, v58
  v_cvt_pk_f16_f32 v192, v48, v49
  s_waitcnt lgkmcnt(6)
  v_max3_f32 v58, |v50|, |v51|, v58
  v_cvt_pk_f16_f32 v193, v50, v51
  s_waitcnt lgkmcnt(4)
  v_max3_f32 v58, |v52|, |v53|, v58
  v_cvt_pk_f16_f32 v194, v52, v53
  s_waitcnt lgkmcnt(2)
  v_max3_f32 v58, |v54|, |v55|, v58
  v_cvt_pk_f16_f32 v195, v54, v55
  s_waitcnt lgkmcnt(0)
  v_max3_f32 v58, |v56|, |v57|, v58
  v_cvt_pk_f16_f32 v196, v56, v57
L_cin_go:
  ds_write_b32 v11, v184 offset:0
  ds_write_b32 v11, v185 offset:160
  ds_write_b32 v11, v186 offset:320
  ds_write_b32 v11, v187 offset:480
  ds_write_b32 v11, v188 offset:640
  ds_write_b32 v11, v189 offset:800
  ds_write_b32 v11, v190 offset:960
  ds_write_b32 v11, v191 offset:1120
  ds_write_b32 v11, v192 offset:1280
  ds_write_b32 v11, v193 offset:1440
  ds_write_b32 v11, v194 offset:1600
  ds_write_b32 v11, v195 offset:1760
  ds_write_b32 v11, v196 offset:1920
  s_mov_b32 s81, 16256
  s_add_u32 s76, s76, 16256
  v_lshlrev_b32 v7, 2, v0
  v_add_u32 v7, s98, v7
L_cin_loop:
  v_cmp_le_f32 s[90:91], s97, v58
  v_cmp_le_f32 vcc, s96, v58
  s_mov_b32 s49, s74
  s_mov_b32 s50, s75
  s_cmp_lg_u64 s[90:91], 0
  s_cbranch_scc1 L_cslow
  s_cbranch_vccz L_cslow
L_cconv:
  s_cmp_lg_u32 s51, 0
  s_cbranch_scc1 L_first
  ds_read_b64_tr_b16 v[60:61], v20 offset:0
  v_mul_f32 v116, v184, v192
  v_mul_f32 v117, v185, v193
  ds_read_b64_tr_b16 v[74:75], v20 offset:32
  v_mul_f32 v118, v186, v194
  ds_read_b64_tr_b16 v[88:89], v20 offset:64
  v_mul_f32 v119, v187, v195
  ds_read_b64_tr_b16 v[102:103], v20 offset:96
  v_fmac_f32_e64 v116, v188, v191
  ds_read_b64_tr_b16 v[66:67], v23 offset:0
  v_fmac_f32 v117, v200, v208
  ds_read_b64_tr_b16 v[80:81], v23 offset:32
  v_fmac_f32 v118, v201, v209
  ds_read_b64_tr_b16 v[94:95], v23 offset:64
  v_fmac_f32 v119, v202, v210
  ds_read_b64_tr_b16 v[108:109], v23 offset:96
  v_fmac_f32 v116, v203, v211
  ds_read_b64_tr_b16 v[68:69], v24 offset:0
  v_fmac_f32_e64 v117, v204, v207
  ds_read_b64_tr_b16 v[82:83], v24 offset:32
  v_fmac_f32 v118, v216, v224
  ds_read_b64_tr_b16 v[96:97], v24 offset:64
  v_fmac_f32 v119, v217, v225
  ds_read_b64_tr_b16 v[110:111], v24 offset:96
  v_fmac_f32 v116, v218, v226
  ds_read_b64_tr_b16 v[124:125], v4 offset:0
  v_fmac_f32 v117, v219, v227
  ds_read_b64_tr_b16 v[126:127], v5 offset:0
  v_fmac_f32 v118, v220, v223
  v_fmac_f32 v119, v232, v240
  ds_read_b64_tr_b16 v[136:137], v4 offset:32
  v_fmac_f32 v116, v233, v241
  ds_read_b64_tr_b16 v[138:139], v5 offset:32
  v_fmac_f32 v117, v234, v242
  ds_read_b64_tr_b16 v[148:149], v4 offset:64
  v_fmac_f32 v118, v235, v243
  ds_read_b64_tr_b16 v[150:151], v5 offset:64
  v_fmac_f32 v119, v236, v239
  ds_read_b64_tr_b16 v[160:161], v4 offset:96
  v_fmac_f32_e64 v116, v189, v196
  ds_read_b64_tr_b16 v[162:163], v5 offset:96
  v_fmac_f32 v117, v189, v197
  ds_read_b128 v[164:167], v1 offset:39936
  v_fmac_f32 v118, v190, v198
  ds_read_b128 v[168:171], v1 offset:40960
  v_fmac_f32 v119, v190, v199
  ds_read_b128 v[172:175], v1 offset:8192
  v_fmac_f32 v116, v205, v212
  ds_read_b128 v[176:179], v1 offset:6144
  v_fmac_f32_e64 v117, v205, v213
  ds_read_b64_tr_b16 v[70:71], v25 offset:0
  v_fmac_f32 v118, v206, v214
  ds_read_b64_tr_b16 v[84:85], v25 offset:32
  v_fmac_f32 v119, v206, v215
  ds_read_b64_tr_b16 v[98:99], v25 offset:64
  v_fmac_f32 v116, v221, v228
  v_fmac_f32 v117, v221, v229
  ds_read_b64_tr_b16 v[112:113], v25 offset:96
  v_fmac_f32 v118, v222, v230
  ds_read_b64_tr_b16 v[72:73], v26 offset:0
  v_fmac_f32 v119, v222, v231
  ds_read_b64_tr_b16 v[86:87], v26 offset:32
  v_fmac_f32 v116, v237, v244
  ds_read_b64_tr_b16 v[100:101], v26 offset:64
  v_fmac_f32 v117, v237, v245
  ds_read_b64_tr_b16 v[114:115], v26 offset:96
  v_fmac_f32 v118, v238, v246
  ds_read_b64_tr_b16 v[62:63], v21 offset:0
  v_fmac_f32 v119, v238, v247
  ds_read_b64_tr_b16 v[76:77], v21 offset:32
  v_add_f32_e64 v116, v116, v117
  ds_read_b64_tr_b16 v[90:91], v21 offset:64
  v_add_f32 v118, v118, v119
  ds_read_b64_tr_b16 v[104:105], v21 offset:96
  v_add_f32 v116, v116, v118
  ds_read_b64_tr_b16 v[64:65], v22 offset:0
  v_mul_f32 v116, s49, v116
  ds_read_b64_tr_b16 v[78:79], v22 offset:32
  v_mul_f32 v116, s50, v116
  ds_read_b64_tr_b16 v[92:93], v22 offset:64
  ds_write_b32 v7, v116
  ds_read_b64_tr_b16 v[106:107], v22 offset:96
  v_add_u32 v7, 256, v7
  s_waitcnt lgkmcnt(14)
  v_pk_mul_f16 v120, v60, v67 op_sel:[0,0] op_sel_hi:[0,1]
  v_pk_mul_f16 v121, v60, v67 op_sel:[1,0] op_sel_hi:[1,1]
  v_pk_mul_f16 v122, v60, v68 op_sel:[0,0] op_sel_hi:[0,1]
  v_pk_mul_f16 v123, v60, v68 op_sel:[1,0] op_sel_hi:[1,1]
  v_pk_mul_f16 v132, v74, v81 op_sel:[0,0] op_sel_hi:[0,1]
  v_pk_mul_f16 v133, v74, v81 op_sel:[1,0] op_sel_hi:[1,1]
  v_pk_mul_f16 v134, v74, v82 op_sel:[0,0] op_sel_hi:[0,1]
  v_pk_mul_f16 v135, v74, v82 op_sel:[1,0] op_sel_hi:[1,1]
  v_pk_mul_f16 v144, v88, v95 op_sel:[0,0] op_sel_hi:[0,1]
  v_pk_mul_f16 v145, v88, v95 op_sel:[1,0] op_sel_hi:[1,1]
  v_pk_mul_f16 v146, v88, v96 op_sel:[0,0] op_sel_hi:[0,1]
  v_pk_mul_f16 v147, v88, v96 op_sel:[1,0] op_sel_hi:[1,1]
  v_pk_mul_f16 v156, v102, v109 op_sel:[0,0] op_sel_hi:[0,1]
  v_pk_mul_f16 v157, v102, v109 op_sel:[1,0] op_sel_hi:[1,1]
  v_pk_mul_f16 v158, v102, v110 op_sel:[0,0] op_sel_hi:[0,1]
  v_pk_mul_f16 v159, v102, v110 op_sel:[1,0] op_sel_hi:[1,1]
  s_waitcnt vmcnt(0)
  v_lshl_add_u32 v16, v16, 7, v8
  v_lshl_add_u32 v17, v17, 7, v8
  v_lshl_add_u32 v18, v18, 7, v8
  v_lshl_add_u32 v19, v19, 7, v8
  s_add_u32 m0, s76, 0
  s_mov_b32 exec_hi, 0xffffff
  buffer_load_dwordx4 v16, s[32:35], 0 offen lds
  s_add_u32 m0, s76, 1056
  s_nop 0
  buffer_load_dwordx4 v17, s[32:35], 0 offen lds
  s_add_u32 m0, s76, 2112
  s_mov_b32 exec_hi, 0xffff
  buffer_load_dwordx4 v18, s[32:35], 0 offen lds
  s_add_u32 m0, s76, 3168
  s_nop 0
  buffer_load_dwordx4 v19, s[32:35], 0 offen lds
  s_mov_b32 exec_hi, -1
  buffer_load_dwordx4 v[16:19], v6, s[28:31], s94 offen
  s_add_u32 s94, s94, 416
L_novm:
  v_add_u32 v10, s81, v10
  v_add_u32 v4, s81, v4
  v_add_u32 v5, s81, v5
  s_sub_u32 s76, s76, s81
  s_sub_u32 s81, 0, s81
  s_mov_b32 s51, 0
  s_waitcnt lgkmcnt(14)
  s_cmp_eq_u32 s84, 0
  s_cbranch_scc1 L_np1
  s_setprio 1
L_np1:
  v_mfma_f32_16x16x32_bf16 v[184:187], v[164:167], v[124:127], 0
  ds_read_b128 v[180:183], v1 offset:7168
  v_pk_mul_f16 v116, v60, v69 op_sel:[0,0] op_sel_hi:[0,1]
  v_mfma_f32_16x16x32_bf16 v[200:203], v[164:167], v[136:139], 0
  v_pk_mul_f16 v117, v60, v69 op_sel:[1,0] op_sel_hi:[1,1]
  v_mfma_f32_16x16x32_bf16 v[216:219], v[164:167], v[148:151], 0
  v_pk_mul_f16 v118, v60, v70 op_sel:[0,0] op_sel_hi:[0,1]
  v_mfma_f32_16x16x32_bf16 v[232:235], v[164:167], v[160:163], 0
  v_pk_mul_f16 v119, v60, v70 op_sel:[1,0] op_sel_hi:[1,1]
  v_mfma_f32_16x16x32_bf16 v[188:191], v[168:171], v[124:127], 0
  ds_read_b128 v[164:167], v1 offset:5120
  v_pk_mul_f16 v128, v74, v83 op_sel:[0,0] op_sel_hi:[0,1]
  v_mfma_f32_16x16x32_bf16 v[204:207], v[168:171], v[136:139], 0
  v_pk_mul_f16 v129, v74, v83 op_sel:[1,0] op_sel_hi:[1,1]
  v_mfma_f32_16x16x32_bf16 v[220:223], v[168:171], v[148:151], 0
  v_pk_mul_f16 v130, v74, v84 op_sel:[0,0] op_sel_hi:[0,1]
  v_mfma_f32_16x16x32_bf16 v[236:239], v[168:171], v[160:163], 0
  v_pk_mul_f16 v131, v74, v84 op_sel:[1,0] op_sel_hi:[1,1]
  v_mfma_f32_16x16x32_f16 v[192:195], v[172:175], v[120:123], 0
  ds_read_b128 v[168:171], v1 offset:11264
  v_pk_mul_f16 v140, v88, v97 op_sel:[0,0] op_sel_hi:[0,1]
  v_mfma_f32_16x16x32_f16 v[208:211], v[172:175], v[132:135], 0
  v_pk_mul_f16 v141, v88, v97 op_sel:[1,0] op_sel_hi:[1,1]
  v_mfma_f32_16x16x32_f16 v[224:227], v[172:175], v[144:147], 0
  s_waitcnt lgkmcnt(14)
  v_pk_mul_f16 v142, v88, v98 op_sel:[0,0] op_sel_hi:[0,1]
  v_mfma_f32_16x16x32_f16 v[240:243], v[172:175], v[156:159], 0
  s_nop 0
  v_pk_mul_f16 v143, v88, v98 op_sel:[1,0] op_sel_hi:[1,1]
  v_mfma_f32_16x16x32_f16 v[184:187], v[176:179], v[120:123], v[184:187]
  ds_read_b128 v[172:175], v1 offset:9216
  v_pk_mul_f16 v152, v102, v111 op_sel:[0,0] op_sel_hi:[0,1]
  v_mfma_f32_16x16x32_f16 v[200:203], v[176:179], v[132:135], v[200:203]
  v_pk_mul_f16 v153, v102, v111 op_sel:[1,0] op_sel_hi:[1,1]
  v_mfma_f32_16x16x32_f16 v[216:219], v[176:179], v[144:147], v[216:219]
  s_setprio 2
  s_waitcnt lgkmcnt(14)
  v_pk_mul_f16 v154, v102, v112 op_sel:[0,0] op_sel_hi:[0,1]
  v_mfma_f32_16x16x32_f16 v[232:235], v[176:179], v[156:159], v[232:235]
  s_nop 0
  s_waitcnt lgkmcnt(3)
  v_pk_mul_f16 v155, v102, v112 op_sel:[1,0] op_sel_hi:[1,1]
  v_mfma_f32_16x16x32_f16 v[188:191], v[180:183], v[120:123], v[188:191]
  ds_read_b128 v[176:179], v1 offset:10240
  v_pk_mul_f16 v124, v61, v68 op_sel:[0,0] op_sel_hi:[0,1]
  v_mfma_f32_16x16x32_f16 v[204:207], v[180:183], v[132:135], v[204:207]
  v_pk_mul_f16 v125, v61, v68 op_sel:[1,0] op_sel_hi:[1,1]
  v_mfma_f32_16x16x32_f16 v[220:223], v[180:183], v[144:147], v[220:223]
  v_pk_mul_f16 v126, v61, v69 op_sel:[0,0] op_sel_hi:[0,1]
  v_mfma_f32_16x16x32_f16 v[236:239], v[180:183], v[156:159], v[236:239]
  s_waitcnt lgkmcnt(3)
  v_pk_mul_f16 v127, v61, v69 op_sel:[1,0] op_sel_hi:[1,1]
  v_mfma_f32_16x16x32_f16 v[196:199], v[164:167], v[120:123], 0
  ds_read_b128 v[180:183], v1 offset:14336
  v_pk_mul_f16 v136, v75, v82 op_sel:[0,0] op_sel_hi:[0,1]
  v_mfma_f32_16x16x32_f16 v[212:215], v[164:167], v[132:135], 0
  v_pk_mul_f16 v120, v60, v71 op_sel:[0,0] op_sel_hi:[0,1]
  v_mfma_f32_16x16x32_f16 v[228:231], v[164:167], v[144:147], 0
  s_nop 0
  v_pk_mul_f16 v121, v60, v71 op_sel:[1,0] op_sel_hi:[1,1]
  v_mfma_f32_16x16x32_f16 v[244:247], v[164:167], v[156:159], 0
  s_waitcnt lgkmcnt(3)
  v_pk_mul_f16 v122, v60, v66 op_sel:[0,1] op_sel_hi:[0,0]
  v_mfma_f32_16x16x32_f16 v[192:195], v[168:171], v[116:119], v[192:195]
  ds_read_b128 v[164:167], v1 offset:12288
  v_pk_mul_f16 v123, v60, v72 op_sel:[0,0] op_sel_hi:[1,0]
  v_mfma_f32_16x16x32_f16 v[208:211], v[168:171], v[128:131], v[208:211]
  s_nop 0
  v_pk_mul_f16 v132, v74, v85 op_sel:[0,0] op_sel_hi:[0,1]
  v_mfma_f32_16x16x32_f16 v[224:227], v[168:171], v[140:143], v[224:227]
  v_pk_mul_f16 v133, v74, v85 op_sel:[1,0] op_sel_hi:[1,1]
  v_mfma_f32_16x16x32_f16 v[240:243], v[168:171], v[152:155], v[240:243]
  s_nop 0
  s_waitcnt lgkmcnt(3)
  v_pk_mul_f16 v134, v74, v80 op_sel:[0,1] op_sel_hi:[0,0]
  v_mfma_f32_16x16x32_f16 v[184:187], v[172:175], v[116:119], v[184:187]
  ds_read_b128 v[168:171], v1 offset:13312
  v_pk_mul_f16 v135, v74, v86 op_sel:[0,0] op_sel_hi:[1,0]
  v_mfma_f32_16x16x32_f16 v[200:203], v[172:175], v[128:131], v[200:203]
  v_pk_mul_f16 v144, v88, v99 op_sel:[0,0] op_sel_hi:[0,1]
  v_mfma_f32_16x16x32_f16 v[216:219], v[172:175], v[140:143], v[216:219]
  v_pk_mul_f16 v145, v88, v99 op_sel:[1,0] op_sel_hi:[1,1]
  v_mfma_f32_16x16x32_f16 v[232:235], v[172:175], v[152:155], v[232:235]
  s_nop 0
  s_waitcnt lgkmcnt(3)
  v_pk_mul_f16 v146, v88, v94 op_sel:[0,1] op_sel_hi:[0,0]
  v_mfma_f32_16x16x32_f16 v[188:191], v[176:179], v[116:119], v[188:191]
  ds_read_b128 v[172:175], v1 offset:0
  v_pk_mul_f16 v147, v88, v100 op_sel:[0,0] op_sel_hi:[1,0]
  v_mfma_f32_16x16x32_f16 v[204:207], v[176:179], v[128:131], v[204:207]
  v_pk_mul_f16 v156, v102, v113 op_sel:[0,0] op_sel_hi:[0,1]
  v_mfma_f32_16x16x32_f16 v[220:223], v[176:179], v[140:143], v[220:223]
  v_pk_mul_f16 v157, v102, v113 op_sel:[1,0] op_sel_hi:[1,1]
  v_mfma_f32_16x16x32_f16 v[236:239], v[176:179], v[152:155], v[236:239]
  s_waitcnt lgkmcnt(3)
  v_pk_mul_f16 v158, v102, v108 op_sel:[0,1] op_sel_hi:[0,0]
  v_mfma_f32_16x16x32_f16 v[192:195], v[180:183], v[120:123], v[192:195]
  ds_read_b128 v[176:179], v1 offset:17408
  v_pk_mul_f16 v159, v102, v114 op_sel:[0,0] op_sel_hi:[1,0]
  v_mfma_f32_16x16x32_f16 v[208:211], v[180:183], v[132:135], v[208:211]
  v_pk_mul_f16 v137, v75, v82 op_sel:[1,0] op_sel_hi:[1,1]
  v_mfma_f32_16x16x32_f16 v[224:227], v[180:183], v[144:147], v[224:227]
  s_nop 0
  v_pk_mul_f16 v138, v75, v83 op_sel:[0,0] op_sel_hi:[0,1]
  v_mfma_f32_16x16x32_f16 v[240:243], v[180:183], v[156:159], v[240:243]
  s_waitcnt lgkmcnt(3)
  v_pk_mul_f16 v139, v75, v83 op_sel:[1,0] op_sel_hi:[1,1]
  v_mfma_f32_16x16x32_f16 v[184:187], v[164:167], v[120:123], v[184:187]
  ds_read_b128 v[180:183], v1 offset:15360
  v_pk_mul_f16 v148, v89, v96 op_sel:[0,0] op_sel_hi:[0,1]
  v_mfma_f32_16x16x32_f16 v[200:203], v[164:167], v[132:135], v[200:203]
  s_nop 0
  v_pk_mul_f16 v149, v89, v96 op_sel:[1,0] op_sel_hi:[1,1]
  v_mfma_f32_16x16x32_f16 v[216:219], v[164:167], v[144:147], v[216:219]
  v_pk_mul_f16 v150, v89, v97 op_sel:[0,0] op_sel_hi:[0,1]
  v_mfma_f32_16x16x32_f16 v[232:235], v[164:167], v[156:159], v[232:235]
  s_nop 0
  s_waitcnt lgkmcnt(3)
  v_pk_mul_f16 v151, v89, v97 op_sel:[1,0] op_sel_hi:[1,1]
  v_mfma_f32_16x16x32_f16 v[188:191], v[168:171], v[120:123], v[188:191]
  ds_read_b128 v[164:167], v1 offset:16384
  v_pk_mul_f16 v160, v103, v110 op_sel:[0,0] op_sel_hi:[0,1]
  v_mfma_f32_16x16x32_f16 v[204:207], v[168:171], v[132:135], v[204:207]
  v_pk_mul_f16 v161, v103, v110 op_sel:[1,0] op_sel_hi:[1,1]
  v_mfma_f32_16x16x32_f16 v[220:223], v[168:171], v[144:147], v[220:223]
  v_pk_mul_f16 v162, v103, v111 op_sel:[0,0] op_sel_hi:[0,1]
  v_mfma_f32_16x16x32_f16 v[236:239], v[168:171], v[156:159], v[236:239]
  s_nop 0
  s_waitcnt lgkmcnt(3)
  v_pk_mul_f16 v163, v103, v111 op_sel:[1,0] op_sel_hi:[1,1]
  v_smfmac_f32_16x16x64_f16 v[196:199], v[172:175], v[116:123], v9
  ds_read_b128 v[168:171], v1 offset:20480
  v_smfmac_f32_16x16x64_f16 v[212:215], v[172:175], v[128:135], v9
  v_pk_mul_f16 v120, v61, v70 op_sel:[0,0] op_sel_hi:[0,1]
  v_smfmac_f32_16x16x64_f16 v[228:231], v[172:175], v[140:147], v9
  v_pk_mul_f16 v121, v61, v70 op_sel:[1,0] op_sel_hi:[1,1]
  v_smfmac_f32_16x16x64_f16 v[244:247], v[172:175], v[152:159], v9
  s_nop 0
  s_waitcnt lgkmcnt(3)
  v_pk_mul_f16 v122, v61, v71 op_sel:[0,0] op_sel_hi:[0,1]
  v_mfma_f32_16x16x32_f16 v[192:195], v[176:179], v[124:127], v[192:195]
  ds_read_b128 v[172:175], v1 offset:18432
  v_pk_mul_f16 v123, v61, v71 op_sel:[1,0] op_sel_hi:[1,1]
  v_mfma_f32_16x16x32_f16 v[208:211], v[176:179], v[136:139], v[208:211]
  v_pk_mul_f16 v132, v75, v84 op_sel:[0,0] op_sel_hi:[0,1]
  v_mfma_f32_16x16x32_f16 v[224:227], v[176:179], v[148:151], v[224:227]
  v_pk_mul_f16 v133, v75, v84 op_sel:[1,0] op_sel_hi:[1,1]
  v_mfma_f32_16x16x32_f16 v[240:243], v[176:179], v[160:163], v[240:243]
  s_waitcnt lgkmcnt(3)
  v_pk_mul_f16 v134, v75, v85 op_sel:[0,0] op_sel_hi:[0,1]
  v_mfma_f32_16x16x32_f16 v[184:187], v[180:183], v[124:127], v[184:187]
  ds_read_b128 v[176:179], v1 offset:19456
  v_pk_mul_f16 v135, v75, v85 op_sel:[1,0] op_sel_hi:[1,1]
  v_mfma_f32_16x16x32_f16 v[200:203], v[180:183], v[136:139], v[200:203]
  s_nop 0
  v_pk_mul_f16 v144, v89, v98 op_sel:[0,0] op_sel_hi:[0,1]
  v_mfma_f32_16x16x32_f16 v[216:219], v[180:183], v[148:151], v[216:219]
  v_pk_mul_f16 v145, v89, v98 op_sel:[1,0] op_sel_hi:[1,1]
  v_mfma_f32_16x16x32_f16 v[232:235], v[180:183], v[160:163], v[232:235]
  s_nop 0
  s_waitcnt lgkmcnt(3)
  v_pk_mul_f16 v146, v89, v99 op_sel:[0,0] op_sel_hi:[0,1]
  v_mfma_f32_16x16x32_f16 v[188:191], v[164:167], v[124:127], v[188:191]
  ds_read_b128 v[180:183], v1 offset:1024
  v_pk_mul_f16 v147, v89, v99 op_sel:[1,0] op_sel_hi:[1,1]
  v_mfma_f32_16x16x32_f16 v[204:207], v[164:167], v[136:139], v[204:207]
  s_waitcnt vmcnt(1)
  ds_read_u16_d16_hi v32, v10 offset:0
  v_pk_mul_f16 v156, v103, v112 op_sel:[0,0] op_sel_hi:[0,1]
  v_mfma_f32_16x16x32_f16 v[220:223], v[164:167], v[148:151], v[220:223]
  ds_read_u16_d16_hi v33, v10 offset:2
  v_pk_mul_f16 v157, v103, v112 op_sel:[1,0] op_sel_hi:[1,1]
  v_mfma_f32_16x16x32_f16 v[236:239], v[164:167], v[160:163], v[236:239]
  s_waitcnt lgkmcnt(5)
  v_pk_mul_f16 v158, v103, v113 op_sel:[0,0] op_sel_hi:[0,1]
  v_mfma_f32_16x16x32_f16 v[192:195], v[168:171], v[120:123], v[192:195]
  ds_read_b128 v[164:167], v1 offset:23552
  v_pk_mul_f16 v159, v103, v113 op_sel:[1,0] op_sel_hi:[1,1]
  v_mfma_f32_16x16x32_f16 v[208:211], v[168:171], v[132:135], v[208:211]
  ds_read_u16_d16_hi v34, v10 offset:2112
  v_pk_mul_f16 v116, v61, v67 op_sel:[0,1] op_sel_hi:[0,0]
  v_mfma_f32_16x16x32_f16 v[224:227], v[168:171], v[144:147], v[224:227]
  ds_read_u16_d16_hi v35, v10 offset:2114
  v_pk_mul_f16 v117, v61, v72 op_sel:[0,0] op_sel_hi:[1,0]
  v_mfma_f32_16x16x32_f16 v[240:243], v[168:171], v[156:159], v[240:243]
  s_nop 0
  s_waitcnt lgkmcnt(7)
  v_pk_mul_f16 v118, v62, v69 op_sel:[0,0] op_sel_hi:[0,1]
  v_mfma_f32_16x16x32_f16 v[184:187], v[172:175], v[120:123], v[184:187]
  ds_read_b128 v[168:171], v1 offset:21504
  v_pk_mul_f16 v119, v62, v69 op_sel:[1,0] op_sel_hi:[1,1]
  v_mfma_f32_16x16x32_f16 v[200:203], v[172:175], v[132:135], v[200:203]
  ds_read_b64_tr_b16 v[60:61], v27 offset:0
  v_pk_mul_f16 v128, v75, v81 op_sel:[0,1] op_sel_hi:[0,0]
  v_mfma_f32_16x16x32_f16 v[216:219], v[172:175], v[144:147], v[216:219]
  ds_read_u16_d16_hi v36, v10 offset:128
  v_pk_mul_f16 v129, v75, v86 op_sel:[0,0] op_sel_hi:[1,0]
  v_mfma_f32_16x16x32_f16 v[232:235], v[172:175], v[156:159], v[232:235]
  s_waitcnt lgkmcnt(9)
  v_pk_mul_f16 v130, v76, v83 op_sel:[0,0] op_sel_hi:[0,1]
  v_pk_mul_f16 v131, v76, v83 op_sel:[1,0] op_sel_hi:[1,1]
  v_mfma_f32_16x16x32_f16 v[188:191], v[176:179], v[120:123], v[188:191]
  ds_read_b128 v[172:175], v1 offset:22528
  v_pk_mul_f16 v140, v89, v95 op_sel:[0,1] op_sel_hi:[0,0]
  v_mfma_f32_16x16x32_f16 v[204:207], v[176:179], v[132:135], v[204:207]
  ds_read_b64_tr_b16 v[74:75], v27 offset:32
  v_pk_mul_f16 v141, v89, v100 op_sel:[0,0] op_sel_hi:[1,0]
  v_mfma_f32_16x16x32_f16 v[220:223], v[176:179], v[144:147], v[220:223]
  ds_read_b64_tr_b16 v[88:89], v27 offset:64
  v_pk_mul_f16 v142, v90, v97 op_sel:[0,0] op_sel_hi:[0,1]
  v_mfma_f32_16x16x32_f16 v[236:239], v[176:179], v[156:159], v[236:239]
  s_waitcnt lgkmcnt(11)
  v_pk_mul_f16 v143, v90, v97 op_sel:[1,0] op_sel_hi:[1,1]
  v_pk_mul_f16 v152, v103, v109 op_sel:[0,1] op_sel_hi:[0,0]
  v_smfmac_f32_16x16x64_f16 v[196:199], v[180:183], v[120:127], v9
  ds_read_b128 v[176:179], v1 offset:26624
  v_pk_mul_f16 v153, v103, v114 op_sel:[0,0] op_sel_hi:[1,0]
  v_smfmac_f32_16x16x64_f16 v[212:215], v[180:183], v[132:139], v9
  ds_read_b64_tr_b16 v[102:103], v27 offset:96
  v_pk_mul_f16 v154, v104, v111 op_sel:[0,0] op_sel_hi:[0,1]
  v_smfmac_f32_16x16x64_f16 v[228:231], v[180:183], v[144:151], v9
  ds_read_u16_d16_hi v37, v10 offset:130
  v_pk_mul_f16 v155, v104, v111 op_sel:[1,0] op_sel_hi:[1,1]
  v_smfmac_f32_16x16x64_f16 v[244:247], v[180:183], v[156:163], v9
  s_waitcnt lgkmcnt(11)
  v_pk_mul_f16 v120, v62, v70 op_sel:[0,0] op_sel_hi:[0,1]
  v_mfma_f32_16x16x32_f16 v[192:195], v[164:167], v[116:119], v[192:195]
  ds_read_b128 v[180:183], v1 offset:24576
  v_pk_mul_f16 v121, v62, v70 op_sel:[1,0] op_sel_hi:[1,1]
  v_mfma_f32_16x16x32_f16 v[208:211], v[164:167], v[128:131], v[208:211]
  ds_read_u16_d16_hi v38, v10 offset:2240
  v_pk_mul_f16 v122, v62, v71 op_sel:[0,0] op_sel_hi:[0,1]
  v_mfma_f32_16x16x32_f16 v[224:227], v[164:167], v[140:143], v[224:227]
  ds_read_u16_d16_hi v39, v10 offset:2242
  v_pk_mul_f16 v123, v62, v71 op_sel:[1,0] op_sel_hi:[1,1]
  v_mfma_f32_16x16x32_f16 v[240:243], v[164:167], v[152:155], v[240:243]
  s_waitcnt lgkmcnt(11)
  v_pk_mul_f16 v132, v76, v84 op_sel:[0,0] op_sel_hi:[0,1]
  v_max3_f32 v58, |v32|, |v33|, 0
  v_mfma_f32_16x16x32_f16 v[184:187], v[168:171], v[116:119], v[184:187]
  ds_read_b128 v[164:167], v1 offset:25600
  v_pk_mul_f16 v133, v76, v84 op_sel:[1,0] op_sel_hi:[1,1]
  v_mfma_f32_16x16x32_f16 v[200:203], v[168:171], v[128:131], v[200:203]
  ds_read_u16_d16_hi v40, v10 offset:256
  v_pk_mul_f16 v134, v76, v85 op_sel:[0,0] op_sel_hi:[0,1]
  v_mfma_f32_16x16x32_f16 v[216:219], v[168:171], v[140:143], v[216:219]
  ds_read_u16_d16_hi v41, v10 offset:258
  v_pk_mul_f16 v135, v76, v85 op_sel:[1,0] op_sel_hi:[1,1]
  v_mfma_f32_16x16x32_f16 v[232:235], v[168:171], v[152:155], v[232:235]
  s_waitcnt lgkmcnt(11)
  v_pk_mul_f16 v144, v90, v98 op_sel:[0,0] op_sel_hi:[0,1]
  v_max3_f32 v58, |v34|, |v35|, v58
  v_mfma_f32_16x16x32_f16 v[188:191], v[172:175], v[116:119], v[188:191]
  ds_read_b128 v[168:171], v1 offset:2048
  v_pk_mul_f16 v145, v90, v98 op_sel:[1,0] op_sel_hi:[1,1]
  v_mfma_f32_16x16x32_f16 v[204:207], v[172:175], v[128:131], v[204:207]
  ds_read_u16_d16_hi v42, v10 offset:2368
  v_pk_mul_f16 v146, v90, v99 op_sel:[0,0] op_sel_hi:[0,1]
  v_mfma_f32_16x16x32_f16 v[220:223], v[172:175], v[140:143], v[220:223]
  ds_read_u16_d16_hi v43, v10 offset:2370
  v_pk_mul_f16 v147, v90, v99 op_sel:[1,0] op_sel_hi:[1,1]
  v_mfma_f32_16x16x32_f16 v[236:239], v[172:175], v[152:155], v[236:239]
  s_waitcnt lgkmcnt(11)
  v_pk_mul_f16 v156, v104, v112 op_sel:[0,0] op_sel_hi:[0,1]
  v_mfma_f32_16x16x32_f16 v[192:195], v[176:179], v[120:123], v[192:195]
  ds_read_b128 v[172:175], v1 offset:29696
  v_pk_mul_f16 v157, v104, v112 op_sel:[1,0] op_sel_hi:[1,1]
  v_mfma_f32_16x16x32_f16 v[208:211], v[176:179], v[132:135], v[208:211]
  ds_read_u16_d16_hi v44, v10 offset:384
  v_pk_mul_f16 v158, v104, v113 op_sel:[0,0] op_sel_hi:[0,1]
  v_mfma_f32_16x16x32_f16 v[224:227], v[176:179], v[144:147], v[224:227]
  ds_read_u16_d16_hi v45, v10 offset:386
  v_pk_mul_f16 v159, v104, v113 op_sel:[1,0] op_sel_hi:[1,1]
  s_nop 1
  v_mfma_f32_16x16x32_f16 v[240:243], v[176:179], v[156:159], v[240:243]
  s_waitcnt lgkmcnt(11)
  v_pk_mul_f16 v124, v62, v68 op_sel:[0,1] op_sel_hi:[0,0]
  v_mfma_f32_16x16x32_f16 v[184:187], v[180:183], v[120:123], v[184:187]
  ds_read_b128 v[176:179], v1 offset:27648
  v_pk_mul_f16 v125, v62, v72 op_sel:[0,0] op_sel_hi:[1,0]
  v_mfma_f32_16x16x32_f16 v[200:203], v[180:183], v[132:135], v[200:203]
  ds_read_u16_d16_hi v46, v10 offset:2496
  v_pk_mul_f16 v126, v63, v70 op_sel:[0,0] op_sel_hi:[0,1]
  v_mfma_f32_16x16x32_f16 v[216:219], v[180:183], v[144:147], v[216:219]
  ds_read_u16_d16_hi v47, v10 offset:2498
  v_pk_mul_f16 v127, v63, v70 op_sel:[1,0] op_sel_hi:[1,1]
  v_mfma_f32_16x16x32_f16 v[232:235], v[180:183], v[156:159], v[232:235]
  s_waitcnt lgkmcnt(11)
  v_pk_mul_f16 v136, v76, v82 op_sel:[0,1] op_sel_hi:[0,0]
  v_pk_mul_f16 v137, v76, v86 op_sel:[0,0] op_sel_hi:[1,0]
  v_mfma_f32_16x16x32_f16 v[188:191], v[164:167], v[120:123], v[188:191]
  ds_read_b128 v[180:183], v1 offset:28672
  v_pk_mul_f16 v138, v77, v84 op_sel:[0,0] op_sel_hi:[0,1]
  v_mfma_f32_16x16x32_f16 v[204:207], v[164:167], v[132:135], v[204:207]
  ds_read_u16_d16_hi v48, v10 offset:512
  v_pk_mul_f16 v139, v77, v84 op_sel:[1,0] op_sel_hi:[1,1]
  v_mfma_f32_16x16x32_f16 v[220:223], v[164:167], v[144:147], v[220:223]
  ds_read_u16_d16_hi v49, v10 offset:514
  v_pk_mul_f16 v148, v90, v96 op_sel:[0,1] op_sel_hi:[0,0]
  v_mfma_f32_16x16x32_f16 v[236:239], v[164:167], v[156:159], v[236:239]
  s_waitcnt lgkmcnt(11)
  v_pk_mul_f16 v149, v90, v100 op_sel:[0,0] op_sel_hi:[1,0]
  v_pk_mul_f16 v150, v91, v98 op_sel:[0,0] op_sel_hi:[0,1]
  v_smfmac_f32_16x16x64_f16 v[196:199], v[168:171], v[116:123], v9
  ds_read_b128 v[164:167], v1 offset:32768
  v_pk_mul_f16 v151, v91, v98 op_sel:[1,0] op_sel_hi:[1,1]
  v_smfmac_f32_16x16x64_f16 v[212:215], v[168:171], v[128:135], v9
  ds_read_u16_d16_hi v50, v10 offset:2624
  v_pk_mul_f16 v160, v104, v110 op_sel:[0,1] op_sel_hi:[0,0]
  v_smfmac_f32_16x16x64_f16 v[228:231], v[168:171], v[140:147], v9
  ds_read_u16_d16_hi v51, v10 offset:2626
  v_pk_mul_f16 v161, v104, v114 op_sel:[0,0] op_sel_hi:[1,0]
  v_smfmac_f32_16x16x64_f16 v[244:247], v[168:171], v[152:159], v9
  s_nop 0
  s_waitcnt lgkmcnt(11)
  v_pk_mul_f16 v162, v105, v112 op_sel:[0,0] op_sel_hi:[0,1]
  v_mfma_f32_16x16x32_f16 v[192:195], v[172:175], v[124:127], v[192:195]
  ds_read_b128 v[168:171], v1 offset:30720
  v_pk_mul_f16 v163, v105, v112 op_sel:[1,0] op_sel_hi:[1,1]
  v_mfma_f32_16x16x32_f16 v[208:211], v[172:175], v[136:139], v[208:211]
  ds_read_u16_d16_hi v52, v10 offset:640
  v_pk_mul_f16 v120, v63, v71 op_sel:[0,0] op_sel_hi:[0,1]
  v_mfma_f32_16x16x32_f16 v[224:227], v[172:175], v[148:151], v[224:227]
  ds_read_u16_d16_hi v53, v10 offset:642
  v_pk_mul_f16 v121, v63, v71 op_sel:[1,0] op_sel_hi:[1,1]
  v_mfma_f32_16x16x32_f16 v[240:243], v[172:175], v[160:163], v[240:243]
  s_waitcnt lgkmcnt(11)
  v_pk_mul_f16 v122, v63, v69 op_sel:[0,1] op_sel_hi:[1,1]
  v_pk_mul_f16 v123, v63, v72 op_sel:[0,0] op_sel_hi:[1,0]
  v_mfma_f32_16x16x32_f16 v[184:187], v[176:179], v[124:127], v[184:187]
  ds_read_b128 v[172:175], v1 offset:31744
  v_pk_mul_f16 v132, v77, v85 op_sel:[0,0] op_sel_hi:[0,1]
  v_mfma_f32_16x16x32_f16 v[200:203], v[176:179], v[136:139], v[200:203]
  ds_read_u16_d16_hi v54, v10 offset:2752
  v_pk_mul_f16 v133, v77, v85 op_sel:[1,0] op_sel_hi:[1,1]
  v_mfma_f32_16x16x32_f16 v[216:219], v[176:179], v[148:151], v[216:219]
  ds_read_u16_d16_hi v55, v10 offset:2754
  v_pk_mul_f16 v134, v77, v83 op_sel:[0,1] op_sel_hi:[1,1]
  v_mfma_f32_16x16x32_f16 v[232:235], v[176:179], v[160:163], v[232:235]
  s_waitcnt lgkmcnt(11)
  v_pk_mul_f16 v135, v77, v86 op_sel:[0,0] op_sel_hi:[1,0]
  v_pk_mul_f16 v144, v91, v99 op_sel:[0,0] op_sel_hi:[0,1]
  v_mfma_f32_16x16x32_f16 v[188:191], v[180:183], v[124:127], v[188:191]
  ds_read_b128 v[176:179], v1 offset:3072
  v_pk_mul_f16 v145, v91, v99 op_sel:[1,0] op_sel_hi:[1,1]
  v_mfma_f32_16x16x32_f16 v[204:207], v[180:183], v[136:139], v[204:207]
  ds_read_u16_d16_hi v56, v10 offset:768
  v_pk_mul_f16 v146, v91, v97 op_sel:[0,1] op_sel_hi:[1,1]
  v_mfma_f32_16x16x32_f16 v[220:223], v[180:183], v[148:151], v[220:223]
  ds_read_u16_d16_hi v57, v10 offset:770
  v_pk_mul_f16 v147, v91, v100 op_sel:[0,0] op_sel_hi:[1,0]
  v_mfma_f32_16x16x32_f16 v[236:239], v[180:183], v[160:163], v[236:239]
  s_waitcnt lgkmcnt(11)
  v_pk_mul_f16 v156, v105, v113 op_sel:[0,0] op_sel_hi:[0,1]
  v_max3_f32 v58, |v36|, |v37|, v58
  v_mfma_f32_16x16x32_f16 v[192:195], v[164:167], v[120:123], v[192:195]
  ds_read_b128 v[180:183], v1 offset:35840
  v_pk_mul_f16 v157, v105, v113 op_sel:[1,0] op_sel_hi:[1,1]
  v_mfma_f32_16x16x32_f16 v[208:211], v[164:167], v[132:135], v[208:211]
  v_pk_mul_f16 v158, v105, v111 op_sel:[0,1] op_sel_hi:[1,1]
  v_max3_f32 v58, |v38|, |v39|, v58
  v_mfma_f32_16x16x32_f16 v[224:227], v[164:167], v[144:147], v[224:227]
  v_pk_mul_f16 v159, v105, v114 op_sel:[0,0] op_sel_hi:[1,0]
  v_max3_f32 v58, |v40|, |v41|, v58
  s_nop 0
  v_mfma_f32_16x16x32_f16 v[240:243], v[164:167], v[156:159], v[240:243]
  s_nop 0
  s_waitcnt lgkmcnt(9)
  v_pk_mul_f16 v116, v64, v71 op_sel:[0,0] op_sel_hi:[0,1]
  v_mfma_f32_16x16x32_f16 v[184:187], v[168:171], v[120:123], v[184:187]
  ds_read_b128 v[164:167], v1 offset:33792
  v_pk_mul_f16 v117, v64, v71 op_sel:[1,0] op_sel_hi:[1,1]
  v_mfma_f32_16x16x32_f16 v[200:203], v[168:171], v[132:135], v[200:203]
  v_pk_mul_f16 v118, v64, v70 op_sel:[0,1] op_sel_hi:[1,1]
  v_max3_f32 v58, |v42|, |v43|, v58
  v_mfma_f32_16x16x32_f16 v[216:219], v[168:171], v[144:147], v[216:219]
  v_pk_mul_f16 v119, v64, v72 op_sel:[0,0] op_sel_hi:[1,0]
  v_pk_mul_f16 v128, v78, v85 op_sel:[0,0] op_sel_hi:[0,1]
  v_mfma_f32_16x16x32_f16 v[232:235], v[168:171], v[156:159], v[232:235]
  s_waitcnt lgkmcnt(7)
  v_pk_mul_f16 v129, v78, v85 op_sel:[1,0] op_sel_hi:[1,1]
  v_pk_mul_f16 v130, v78, v84 op_sel:[0,1] op_sel_hi:[1,1]
  v_mfma_f32_16x16x32_f16 v[188:191], v[172:175], v[120:123], v[188:191]
  ds_read_b128 v[168:171], v1 offset:34816
  v_pk_mul_f16 v131, v78, v86 op_sel:[0,0] op_sel_hi:[1,0]
  v_mfma_f32_16x16x32_f16 v[204:207], v[172:175], v[132:135], v[204:207]
  v_pk_mul_f16 v140, v92, v99 op_sel:[0,0] op_sel_hi:[0,1]
  v_pk_mul_f16 v141, v92, v99 op_sel:[1,0] op_sel_hi:[1,1]
  v_mfma_f32_16x16x32_f16 v[220:223], v[172:175], v[144:147], v[220:223]
  v_pk_mul_f16 v142, v92, v98 op_sel:[0,1] op_sel_hi:[1,1]
  v_pk_mul_f16 v143, v92, v100 op_sel:[0,0] op_sel_hi:[1,0]
  v_mfma_f32_16x16x32_f16 v[236:239], v[172:175], v[156:159], v[236:239]
  s_waitcnt lgkmcnt(5)
  v_pk_mul_f16 v152, v106, v113 op_sel:[0,0] op_sel_hi:[0,1]
  v_smfmac_f32_16x16x64_f16 v[196:199], v[176:179], v[120:127], v9
  ds_read_b128 v[172:175], v1 offset:38912
  v_pk_mul_f16 v153, v106, v113 op_sel:[1,0] op_sel_hi:[1,1]
  v_smfmac_f32_16x16x64_f16 v[212:215], v[176:179], v[132:139], v9
  v_pk_mul_f16 v154, v106, v112 op_sel:[0,1] op_sel_hi:[1,1]
  v_smfmac_f32_16x16x64_f16 v[228:231], v[176:179], v[144:151], v9
  v_pk_mul_f16 v155, v106, v114 op_sel:[0,0] op_sel_hi:[1,0]
  v_smfmac_f32_16x16x64_f16 v[244:247], v[176:179], v[156:163], v9
  s_waitcnt lgkmcnt(3)
  v_pk_mul_f16 v120, v65, v71 op_sel:[0,1] op_sel_hi:[1,1]
  v_mfma_f32_16x16x32_f16 v[192:195], v[180:183], v[116:119], v[192:195]
  ds_read_b128 v[176:179], v1 offset:36864
  v_pk_mul_f16 v121, v65, v72 op_sel:[0,0] op_sel_hi:[1,0]
  v_mfma_f32_16x16x32_f16 v[208:211], v[180:183], v[128:131], v[208:211]
  s_nop 0
  v_pk_mul_f16 v122, v72, v72 op_sel:[0,0] op_sel_hi:[1,1]
  v_max3_f32 v58, |v44|, |v45|, v58
  v_mfma_f32_16x16x32_f16 v[224:227], v[180:183], v[140:143], v[224:227]
  v_pk_mul_f16 v123, v60, v61 op_sel:[0,0] op_sel_hi:[1,1]
  v_max3_f32 v58, |v46|, |v47|, v58
  v_mfma_f32_16x16x32_f16 v[240:243], v[180:183], v[152:155], v[240:243]
  s_nop 0
  s_waitcnt lgkmcnt(3)
  v_pk_mul_f16 v132, v79, v85 op_sel:[0,1] op_sel_hi:[1,1]
  v_mfma_f32_16x16x32_f16 v[184:187], v[164:167], v[116:119], v[184:187]
  ds_read_b128 v[180:183], v1 offset:37888
  v_pk_mul_f16 v133, v79, v86 op_sel:[0,0] op_sel_hi:[1,0]
  v_mfma_f32_16x16x32_f16 v[200:203], v[164:167], v[128:131], v[200:203]
  v_pk_mul_f16 v134, v86, v86 op_sel:[0,0] op_sel_hi:[1,1]
  v_max3_f32 v58, |v48|, |v49|, v58
  v_mfma_f32_16x16x32_f16 v[216:219], v[164:167], v[140:143], v[216:219]
  v_pk_mul_f16 v135, v74, v75 op_sel:[0,0] op_sel_hi:[1,1]
  v_max3_f32 v58, |v50|, |v51|, v58
  v_mfma_f32_16x16x32_f16 v[232:235], v[164:167], v[152:155], v[232:235]
  s_waitcnt lgkmcnt(3)
  v_pk_mul_f16 v144, v93, v99 op_sel:[0,1] op_sel_hi:[1,1]
  v_mfma_f32_16x16x32_f16 v[188:191], v[168:171], v[116:119], v[188:191]
  ds_read_b128 v[164:167], v1 offset:4096
  v_pk_mul_f16 v145, v93, v100 op_sel:[0,0] op_sel_hi:[1,0]
  v_mfma_f32_16x16x32_f16 v[204:207], v[168:171], v[128:131], v[204:207]
  s_nop 0
  v_pk_mul_f16 v146, v100, v100 op_sel:[0,0] op_sel_hi:[1,1]
  v_max3_f32 v58, |v52|, |v53|, v58
  v_mfma_f32_16x16x32_f16 v[220:223], v[168:171], v[140:143], v[220:223]
  v_pk_mul_f16 v147, v88, v89 op_sel:[0,0] op_sel_hi:[1,1]
  v_max3_f32 v58, |v54|, |v55|, v58
  v_mfma_f32_16x16x32_f16 v[236:239], v[168:171], v[152:155], v[236:239]
  s_waitcnt lgkmcnt(3)
  v_pk_mul_f16 v156, v107, v113 op_sel:[0,1] op_sel_hi:[1,1]
  v_mfma_f32_16x16x32_f16 v[192:195], v[172:175], v[120:123], v[192:195]
  s_nop 0
  v_pk_mul_f16 v157, v107, v114 op_sel:[0,0] op_sel_hi:[1,0]
  v_max3_f32 v58, |v56|, |v57|, v58
  v_mfma_f32_16x16x32_f16 v[208:211], v[172:175], v[132:135], v[208:211]
  v_pk_mul_f16 v158, v114, v114 op_sel:[0,0] op_sel_hi:[1,1]
  v_cvt_pk_f16_f32 v62, v32, v33
  v_mfma_f32_16x16x32_f16 v[224:227], v[172:175], v[144:147], v[224:227]
  s_nop 0
  v_pk_mul_f16 v159, v102, v103 op_sel:[0,0] op_sel_hi:[1,1]
  s_nop 1
  v_mfma_f32_16x16x32_f16 v[240:243], v[172:175], v[156:159], v[240:243]
  s_waitcnt lgkmcnt(2)
  v_cvt_pk_f16_f32 v76, v34, v35
  v_cvt_pk_f16_f32 v90, v36, v37
  v_mfma_f32_16x16x32_f16 v[184:187], v[176:179], v[120:123], v[184:187]
  ds_write_b32 v11, v62 offset:0
  v_mfma_f32_16x16x32_f16 v[200:203], v[176:179], v[132:135], v[200:203]
  ds_write_b32 v11, v76 offset:160
  v_mfma_f32_16x16x32_f16 v[216:219], v[176:179], v[144:147], v[216:219]
  ds_write_b32 v11, v90 offset:320
  v_mfma_f32_16x16x32_f16 v[232:235], v[176:179], v[156:159], v[232:235]
  s_waitcnt lgkmcnt(4)
  v_cvt_pk_f16_f32 v104, v38, v39
  v_cvt_pk_f16_f32 v63, v40, v41
  v_mfma_f32_16x16x32_f16 v[188:191], v[180:183], v[120:123], v[188:191]
  ds_write_b32 v11, v104 offset:480
  v_mfma_f32_16x16x32_f16 v[204:207], v[180:183], v[132:135], v[204:207]
  ds_write_b32 v11, v63 offset:640
  v_mfma_f32_16x16x32_f16 v[220:223], v[180:183], v[144:147], v[220:223]
  s_nop 0
  v_cvt_pk_f16_f32 v77, v42, v43
  v_cvt_pk_f16_f32 v91, v44, v45
  v_mfma_f32_16x16x32_f16 v[236:239], v[180:183], v[156:159], v[236:239]
  s_waitcnt lgkmcnt(5)
  v_cvt_pk_f16_f32 v105, v46, v47
  v_cvt_pk_f16_f32 v66, v48, v49
  v_smfmac_f32_16x16x64_f16 v[196:199], v[164:167], v[116:123], v9
  ds_write_b32 v11, v77 offset:800
  v_smfmac_f32_16x16x64_f16 v[212:215], v[164:167], v[128:135], v9
  ds_write_b32 v11, v91 offset:960
  v_smfmac_f32_16x16x64_f16 v[228:231], v[164:167], v[140:147], v9
  ds_write_b32 v11, v105 offset:1120
  v_smfmac_f32_16x16x64_f16 v[244:247], v[164:167], v[152:159], v9
  ds_write_b32 v11, v66 offset:1280
  s_setprio 0
  s_sub_u32 s72, s72, 1
  s_cmp_eq_u32 s72, 0
  s_cbranch_scc1 L_cin_done
  v_cvt_pk_f16_f32 v80, v50, v51
  v_cvt_pk_f16_f32 v94, v52, v53
  v_cvt_pk_f16_f32 v108, v54, v55
  v_cvt_pk_f16_f32 v67, v56, v57
  ds_write_b32 v11, v80 offset:1440
  ds_write_b32 v11, v94 offset:1600
  ds_write_b32 v11, v108 offset:1760
  ds_write_b32 v11, v67 offset:1920
  s_branch L_cin_loop
L_cslow:
  v_max_f32_dpp v58, v58, v58 row_shr:1 row_mask:0xf bank_mask:0xf
  s_nop 1
  v_max_f32_dpp v58, v58, v58 row_shr:2 row_mask:0xf bank_mask:0xf
  s_nop 1
  v_max_f32_dpp v58, v58, v58 row_shr:4 row_mask:0xf bank_mask:0xf
  s_nop 1
  v_max_f32_dpp v58, v58, v58 row_shr:8 row_mask:0xf bank_mask:0xf
  s_nop 1
  v_max_f32_dpp v58, v58, v58 row_bcast:15 row_mask:0xa bank_mask:0xf
  s_nop 1
  v_max_f32_dpp v58, v58, v58 row_bcast:31 row_mask:0xc bank_mask:0xf
  s_nop 0
  v_readlane_b32 s98, v58, 63
  s_mov_b32 s97, 0
  s_lshr_b32 s98, s98, 23
  s_min_u32 s98, s98, 182
  s_lshr_b32 s99, s1, 23
  s_sub_u32 s99, s99, 47
  s_lshr_b32 s99, s99, 1
  s_min_u32 s99, s99, 59
  s_sub_u32 s99, 131, s99
  s_max_u32 s98, s98, s99
  s_sub_u32 s99, 258, s98
  s_lshl_b32 s100, s99, 1
  s_sub_u32 s100, s100, 127
  s_sub_u32 s95, 254, s100
  s_lshl_b32 s95, s95, 23
  v_mov_b32 v60, s95
  v_mul_f32 v61, s0, v60
  v_mul_f32 v60, s1, v60
  v_readfirstlane_b32 s74, v61
  v_readfirstlane_b32 s75, v60
  s_lshl_b32 s99, s99, 23
  s_lshl_b32 s100, s100, 23
  v_mul_f32 v60, s99, v32
  v_mul_f32 v61, s99, v33
  v_mul_f32 v62, s100, v32
  v_mul_f32 v63, s100, v33
  v_cvt_pk_f16_f32 v80, v60, v61
  v_cvt_pk_bf16_f32 v64, v62, v63
  ds_write_b32 v11, v80 offset:0
  ds_write_b32 v10, v64 offset:0
  v_mul_f32 v60, s99, v34
  v_mul_f32 v61, s99, v35
  v_mul_f32 v62, s100, v34
  v_mul_f32 v63, s100, v35
  v_cvt_pk_f16_f32 v81, v60, v61
  v_cvt_pk_bf16_f32 v65, v62, v63
  ds_write_b32 v11, v81 offset:160
  ds_write_b32 v10, v65 offset:2112
  v_mul_f32 v60, s99, v36
  v_mul_f32 v61, s99, v37
  v_mul_f32 v62, s100, v36
  v_mul_f32_e64 v63, s100, v37
  v_cvt_pk_f16_f32 v82, v60, v61
  v_cvt_pk_bf16_f32 v66, v62, v63
  ds_write_b32 v11, v82 offset:320
  ds_write_b32 v10, v66 offset:128
  v_mul_f32 v60, s99, v38
  v_mul_f32 v61, s99, v39
  v_mul_f32 v62, s100, v38
  v_mul_f32 v63, s100, v39
  v_cvt_pk_f16_f32 v83, v60, v61
  v_cvt_pk_bf16_f32 v67, v62, v63
  ds_write_b32 v11, v83 offset:480
  ds_write_b32 v10, v67 offset:2240
  v_mul_f32 v60, s99, v40
  v_mul_f32 v61, s99, v41
  v_mul_f32 v62, s100, v40
  v_mul_f32 v63, s100, v41
  v_cvt_pk_f16_f32 v84, v60, v61
  v_cvt_pk_bf16_f32 v68, v62, v63
  ds_write_b32 v11, v84 offset:640
  ds_write_b32 v10, v68 offset:256
  v_mul_f32 v60, s99, v42
  v_mul_f32 v61, s99, v43
  v_mul_f32 v62, s100, v42
  v_mul_f32 v63, s100, v43
  v_cvt_pk_f16_f32 v85, v60, v61
  v_cvt_pk_bf16_f32 v69, v62, v63
  ds_write_b32 v11, v85 offset:800
  ds_write_b32 v10, v69 offset:2368
  v_mul_f32 v60, s99, v44
  v_mul_f32 v61, s99, v45
  v_mul_f32 v62, s100, v44
  v_mul_f32 v63, s100, v45
  v_cvt_pk_f16_f32 v86, v60, v61
  v_cvt_pk_bf16_f32 v70, v62, v63
  ds_write_b32 v11, v86 offset:960
  ds_write_b32 v10, v70 offset:384
  v_mul_f32 v60, s99, v46
  v_mul_f32 v61, s99, v47
  v_mul_f32 v62, s100, v46
  v_mul_f32 v63, s100, v47
  v_cvt_pk_f16_f32 v87, v60, v61
  v_cvt_pk_bf16_f32 v71, v62, v63
  ds_write_b32 v11, v87 offset:1120
  ds_write_b32 v10, v71 offset:2496
  v_mul_f32 v60, s99, v48
  v_mul_f32 v61, s99, v49
  v_mul_f32 v62, s100, v48
  v_mul_f32 v63, s100, v49
  v_cvt_pk_f16_f32 v88, v60, v61
  v_cvt_pk_bf16_f32 v72, v62, v63
  ds_write_b32 v11, v88 offset:1280
  ds_write_b32 v10, v72 offset:512
  v_mul_f32 v60, s99, v50
  v_mul_f32 v61, s99, v51
  v_mul_f32 v62, s100, v50
  v_mul_f32 v63, s100, v51
  v_cvt_pk_f16_f32 v89, v60, v61
  v_cvt_pk_bf16_f32 v73, v62, v63
  ds_write_b32 v11, v89 offset:1440
  ds_write_b32 v10, v73 offset:2624
  v_mul_f32 v60, s99, v52
  v_mul_f32 v61, s99, v53
  v_mul_f32 v62, s100, v52
  v_mul_f32 v63, s100, v53
  v_cvt_pk_f16_f32 v90, v60, v61
  v_cvt_pk_bf16_f32 v74, v62, v63
  ds_write_b32 v11, v90 offset:1600
  ds_write_b32 v10, v74 offset:640
  v_mul_f32 v60, s99, v54
  v_mul_f32 v61, s99, v55
  v_mul_f32 v62, s100, v54
  v_mul_f32 v63, s100, v55
  v_cvt_pk_f16_f32 v91, v60, v61
  v_cvt_pk_bf16_f32 v75, v62, v63
  ds_write_b32 v11, v91 offset:1760
  ds_write_b32 v10, v75 offset:2752
  v_mul_f32 v60, s99, v56
  v_mul_f32 v61, s99, v57
  v_mul_f32 v62, s100, v56
  v_mul_f32 v63, s100, v57
  v_cvt_pk_f16_f32 v92, v60, v61
  v_cvt_pk_bf16_f32 v76, v62, v63
  ds_write_b32 v11, v92 offset:1920
  ds_write_b32 v10, v76 offset:768
  v_mov_b32 v60, s100
  v_cvt_pk_bf16_f32 v60, v60, v60
  s_mov_b32 exec_hi, 0
  ds_write_b32 v10, v60 offset:2880
  s_mov_b32 exec_hi, -1
  s_waitcnt lgkmcnt(0)
  s_branch L_cconv
L_sdown:
  v_lshlrev_b32 v108, 16, v112
  v_and_b32 v109, 0xffff0000, v112
  v_mul_f32 v108, v108, v250
  v_mul_f32 v109, v109, v250
  v_cvt_pk_bf16_f32 v112, v108, v109
  v_lshlrev_b32 v108, 16, v113
  v_and_b32 v109, 0xffff0000, v113
  v_mul_f32 v108, v108, v250
  v_mul_f32 v109, v109, v250
  v_cvt_pk_bf16_f32 v113, v108, v109
  v_lshlrev_b32 v108, 16, v114
  v_and_b32 v109, 0xffff0000, v114
  v_mul_f32 v108, v108, v250
  v_mul_f32 v109, v109, v250
  v_cvt_pk_bf16_f32 v114, v108, v109
  v_lshlrev_b32_e64 v108, 16, v115
  v_and_b32 v109, 0xffff0000, v115
  v_mul_f32 v108, v108, v250
  v_mul_f32 v109, v109, v250
  v_cvt_pk_bf16_f32 v115, v108, v109
  v_lshlrev_b32 v108, 16, v116
  v_and_b32 v109, 0xffff0000, v116
  v_mul_f32 v108, v108, v250
  v_mul_f32 v109, v109, v250
  v_cvt_pk_bf16_f32 v116, v108, v109
  v_lshlrev_b32 v108, 16, v117
  v_and_b32 v109, 0xffff0000, v117
  v_mul_f32 v108, v108, v250
  v_mul_f32 v109, v109, v250
  v_cvt_pk_bf16_f32 v117, v108, v109
  v_lshlrev_b32 v108, 16, v118
  v_and_b32 v109, 0xffff0000, v118
  v_mul_f32 v108, v108, v250
  v_mul_f32 v109, v109, v250
  v_cvt_pk_bf16_f32 v118, v108, v109
  v_lshlrev_b32 v108, 16, v119
  v_and_b32 v109, 0xffff0000, v119
  v_mul_f32 v108, v108, v250
  v_mul_f32 v109, v109, v250
  v_cvt_pk_bf16_f32 v119, v108, v109
  s_branch L_scaled
L_first:
  ds_read_b64_tr_b16 v[60:61], v20 offset:0
  ds_read_b64_tr_b16 v[74:75], v20 offset:32
  ds_read_b64_tr_b16 v[88:89], v20 offset:64
  ds_read_b64_tr_b16 v[102:103], v20 offset:96
  ds_read_b64_tr_b16 v[66:67], v23 offset:0
  ds_read_b64_tr_b16 v[80:81], v23 offset:32
  ds_read_b64_tr_b16 v[94:95], v23 offset:64
  ds_read_b64_tr_b16 v[108:109], v23 offset:96
  ds_read_b64_tr_b16 v[68:69], v24 offset:0
  ds_read_b64_tr_b16 v[82:83], v24 offset:32
  ds_read_b64_tr_b16 v[96:97], v24 offset:64
  ds_read_b64_tr_b16 v[110:111], v24 offset:96
  ds_read_b64_tr_b16 v[124:125], v4 offset:0
  ds_read_b64_tr_b16 v[126:127], v5 offset:0
  ds_read_b64_tr_b16 v[136:137], v4 offset:32
  ds_read_b64_tr_b16 v[138:139], v5 offset:32
  ds_read_b64_tr_b16 v[148:149], v4 offset:64
  ds_read_b64_tr_b16 v[150:151], v5 offset:64
  ds_read_b64_tr_b16 v[160:161], v4 offset:96
  ds_read_b64_tr_b16 v[162:163], v5 offset:96
  ds_read_b128 v[164:167], v1 offset:39936
  ds_read_b128 v[168:171], v1 offset:40960
  ds_read_b128 v[172:175], v1 offset:8192
  ds_read_b128 v[176:179], v1 offset:6144
  ds_read_b64_tr_b16 v[70:71], v25 offset:0
  ds_read_b64_tr_b16 v[84:85], v25 offset:32
  ds_read_b64_tr_b16 v[98:99], v25 offset:64
  ds_read_b64_tr_b16 v[112:113], v25 offset:96
  ds_read_b64_tr_b16 v[72:73], v26 offset:0
  s_waitcnt lgkmcnt(14)
  v_pk_mul_f16 v120, v60, v67 op_sel:[0,0] op_sel_hi:[0,1]
  v_pk_mul_f16 v121, v60, v67 op_sel:[1,0] op_sel_hi:[1,1]
  ds_read_b64_tr_b16 v[86:87], v26 offset:32
  v_pk_mul_f16 v122, v60, v68 op_sel:[0,0] op_sel_hi:[0,1]
  ds_read_b64_tr_b16 v[100:101], v26 offset:64
  v_pk_mul_f16 v123, v60, v68 op_sel:[1,0] op_sel_hi:[1,1]
  ds_read_b64_tr_b16 v[114:115], v26 offset:96
  v_pk_mul_f16 v132, v74, v81 op_sel:[0,0] op_sel_hi:[0,1]
  v_pk_mul_f16 v133, v74, v81 op_sel:[1,0] op_sel_hi:[1,1]
  ds_read_b64_tr_b16 v[62:63], v21 offset:0
  v_pk_mul_f16 v134, v74, v82 op_sel:[0,0] op_sel_hi:[0,1]
  ds_read_b64_tr_b16 v[76:77], v21 offset:32
  v_pk_mul_f16 v135, v74, v82 op_sel:[1,0] op_sel_hi:[1,1]
  ds_read_b64_tr_b16 v[90:91], v21 offset:64
  v_pk_mul_f16 v144, v88, v95 op_sel:[0,0] op_sel_hi:[0,1]
  v_pk_mul_f16 v145, v88, v95 op_sel:[1,0] op_sel_hi:[1,1]
  ds_read_b64_tr_b16 v[104:105], v21 offset:96
  v_pk_mul_f16 v146, v88, v96 op_sel:[0,0] op_sel_hi:[0,1]
  ds_read_b64_tr_b16 v[64:65], v22 offset:0
  v_pk_mul_f16 v147, v88, v96 op_sel:[1,0] op_sel_hi:[1,1]
  ds_read_b64_tr_b16 v[78:79], v22 offset:32
  v_pk_mul_f16 v156, v102, v109 op_sel:[0,0] op_sel_hi:[0,1]
  v_pk_mul_f16 v157, v102, v109 op_sel:[1,0] op_sel_hi:[1,1]
  ds_read_b64_tr_b16 v[92:93], v22 offset:64
  v_pk_mul_f16 v158, v102, v110 op_sel:[0,0] op_sel_hi:[0,1]
  ds_read_b64_tr_b16 v[106:107], v22 offset:96
  v_pk_mul_f16 v159, v102, v110 op_sel:[1,0] op_sel_hi:[1,1]
  s_branch L_novm
L_end:
  s_endpgm
.p2align 8
L_tables:
.long 0x0, 0x1800, 0x6c80, 0x81a0, 0x8, 0x1808, 0x6c88, 0x81a8
.long 0x10, 0x1810, 0x6c90, 0x81b0, 0x18, 0x1818, 0x6c98, 0x81b8
.long 0x40, 0x1d48, 0x71c8, 0x86e8, 0x48, 0x1d50, 0x71d0, 0x86f0
.long 0x50, 0x1d58, 0x71d8, 0x86f8, 0x58, 0x1d60, 0x71e0, 0x8700
.long 0x80, 0x2290, 0x7710, 0x8c30, 0x88, 0x2298, 0x7718, 0x8c38
.long 0x90, 0x22a0, 0x7720, 0x8c40, 0x98, 0x22a8, 0x7728, 0x8c48
.long 0xc0, 0x27d8, 0x7c58, 0x9178, 0xc8, 0x27e0, 0x7c60, 0x9180
.long 0xd0, 0x27e8, 0x7c68, 0x9188, 0xd8, 0x27f0, 0x7c70, 0x9190
.long 0x20, 0x1820, 0x6ca0, 0x81c0, 0x28, 0x1828, 0x6ca8, 0x81c8
.long 0x30, 0x1830, 0x6cb0, 0x81d0, 0x38, 0x1838, 0x6cb8, 0x81d8
.long 0x60, 0x1d68, 0x71e8, 0x8708, 0x68, 0x1d70, 0x71f0, 0x8710
.long 0x70, 0x1d78, 0x71f8, 0x8718, 0x78, 0x1d80, 0x7200, 0x8720
.long 0xa0, 0x22b0, 0x7730, 0x8c50, 0xa8, 0x22b8, 0x7738, 0x8c58
.long 0xb0, 0x22c0, 0x7740, 0x8c60, 0xb8, 0x22c8, 0x7748, 0x8c68
.long 0xe0, 0x27f8, 0x7c78, 0x9198, 0xe8, 0x2800, 0x7c80, 0x91a0
.long 0xf0, 0x2808, 0x7c88, 0x91a8, 0xf8, 0x2810, 0x7c90, 0x91b0
.long 0x200, 0x4240, 0x96c0, 0x9c08, 0x208, 0x4248, 0x96c8, 0x9c10
.long 0x210, 0x4250, 0x96d0, 0x9c18, 0x218, 0x4258, 0x96d8, 0x9c20
.long 0x240, 0x4788, 0x9c08, 0x9c08, 0x248, 0x4790, 0x9c10, 0x9c10
.long 0x250, 0x4798, 0x9c18, 0x9c18, 0x258, 0x47a0, 0x9c20, 0x9c20
.long 0x280, 0x4cd0, 0x9c08, 0x9c08, 0x288, 0x4cd8, 0x9c10, 0x9c10
.long 0x290, 0x4ce0, 0x9c18, 0x9c18, 0x298, 0x4ce8, 0x9c20, 0x9c20
.long 0x2c0, 0x5218, 0x9c08, 0x9c08, 0x2c8, 0x5220, 0x9c10, 0x9c10
.long 0x2d0, 0x5228, 0x9c18, 0x9c18, 0x2d8, 0x5230, 0x9c20, 0x9c20
.long 0x220, 0x4260, 0x96e0, 0x9c28, 0x228, 0x4268, 0x96e8, 0x9c30
.long 0x230, 0x4270, 0x96f0, 0x9c38, 0x238, 0x4278, 0x96f8, 0x9c40
.long 0x260, 0x47a8, 0x9c28, 0x9c28, 0x268, 0x47b0, 0x9c30, 0x9c30
.long 0x270, 0x47b8, 0x9c38, 0x9c38, 0x278, 0x47c0, 0x9c40, 0x9c40
.long 0x2a0, 0x4cf0, 0x9c28, 0x9c28, 0x2a8, 0x4cf8, 0x9c30, 0x9c30
.long 0x2b0, 0x4d00, 0x9c38, 0x9c38, 0x2b8, 0x4d08, 0x9c40, 0x9c40
.long 0x2e0, 0x5238, 0x9c28, 0x9c28, 0x2e8, 0x5240, 0x9c30, 0x9c30
.long 0x2f0, 0x5248, 0x9c38, 0x9c38, 0x2f8, 0x5250, 0x9c40, 0x9c40
.long 0xaae0, 0xa680, 0xa900, 0xaae0, 0xaae8, 0xa688, 0xa908, 0xaae8
.long 0xaaf0, 0xa690, 0xa910, 0xaaf0, 0xaaf8, 0xa698, 0xa918, 0xaaf8
.long 0xaa40, 0xa860, 0xa9a0, 0xaa40, 0xaa48, 0xa868, 0xa9a8, 0xaa48
.long 0xaa50, 0xa870, 0xa9b0, 0xaa50, 0xaa58, 0xa878, 0xa9b8, 0xaa58
.long 0xa400, 0xa7c0, 0xa540, 0xa400, 0xa408, 0xa7c8, 0xa548, 0xa408
.long 0xa410, 0xa7d0, 0xa550, 0xa410, 0xa418, 0xa7d8, 0xa558, 0xa418
.long 0xa4a0, 0xa720, 0xa5e0, 0xa4a0, 0xa4a8, 0xa728, 0xa5e8, 0xa4a8
.long 0xa4b0, 0xa730, 0xa5f0, 0xa4b0, 0xa4b8, 0xa738, 0xa5f8, 0xa4b8
.long 0xb260, 0xb4e0, 0xb6c0, 0xb260, 0xb268, 0xb4e8, 0xb6c8, 0xb268
.long 0xb270, 0xb4f0, 0xb6d0, 0xb270, 0xb278, 0xb4f8, 0xb6d8, 0xb278
.long 0xb1c0, 0xb300, 0xb760, 0xb1c0, 0xb1c8, 0xb308, 0xb768, 0xb1c8
.long 0xb1d0, 0xb310, 0xb770, 0xb1d0, 0xb1d8, 0xb318, 0xb778, 0xb1d8
.long 0xb580, 0xb440, 0xb080, 0xb580, 0xb588, 0xb448, 0xb088, 0xb588
.long 0xb590, 0xb450, 0xb090, 0xb590, 0xb598, 0xb458, 0xb098, 0xb598
.long 0xb620, 0xb3a0, 0xb120, 0xb620, 0xb628, 0xb3a8, 0xb128, 0xb628
.long 0xb630, 0xb3b0, 0xb130, 0xb630, 0xb638, 0xb3b8, 0xb138, 0xb638
.long 0xa900, 0xa400, 0xaae0, 0xb620, 0xa908, 0xa408, 0xaae8, 0xb628
.long 0xa910, 0xa410, 0xaaf0, 0xb630, 0xa918, 0xa418, 0xaaf8, 0xb638
.long 0xa9a0, 0xa4a0, 0xab80, 0xb800, 0xa9a8, 0xa4a8, 0xab88, 0xb808
.long 0xa9b0, 0xa4b0, 0xab90, 0xb810, 0xa9b8, 0xa4b8, 0xab98, 0xb818
.long 0xaa40, 0xa680, 0xa860, 0xb3a0, 0xaa48, 0xa688, 0xa868, 0xb3a8
.long 0xaa50, 0xa690, 0xa870, 0xb3b0, 0xaa58, 0xa698, 0xa878, 0xb3b8
.long 0xa720, 0xa540, 0xa7c0, 0xb1c0, 0xa728, 0xa548, 0xa7c8, 0xb1c8
.long 0xa730, 0xa550, 0xa7d0, 0xb1d0, 0xa738, 0xa558, 0xa7d8, 0xb1d8
.long 0xa5e0, 0xaae0, 0xa400, 0xb080, 0xa5e8, 0xaae8, 0xa408, 0xb088
.long 0xa5f0, 0xaaf0, 0xa410, 0xb090, 0xa5f8, 0xaaf8, 0xa418, 0xb098
.long 0xa7c0, 0xa540, 0xa720, 0xb760, 0xa7c8, 0xa548, 0xa728, 0xb768
.long 0xa7d0, 0xa550, 0xa730, 0xb770, 0xa7d8, 0xa558, 0xa738, 0xb778
.long 0xa860, 0xa680, 0xaa40, 0xb440, 0xa868, 0xa688, 0xaa48, 0xb448
.long 0xa870, 0xa690, 0xaa50, 0xb450, 0xa878, 0xa698, 0xaa58, 0xb458
.long 0xab80, 0xa4a0, 0xa9a0, 0xb4e0, 0xab88, 0xa4a8, 0xa9a8, 0xb4e8
.long 0xab90, 0xa4b0, 0xa9b0, 0xb4f0, 0xab98, 0xa4b8, 0xa9b8, 0xb4f8
.long 0xa680, 0xa900, 0xab80, 0xa4a0, 0xa688, 0xa908, 0xab88, 0xa4a8
.long 0xa690, 0xa910, 0xab90, 0xa4b0, 0xa698, 0xa918, 0xab98, 0xa4b8
.long 0xa860, 0xa9a0, 0xb1c0, 0xb440, 0xa868, 0xa9a8, 0xb1c8, 0xb448
.long 0xa870, 0xa9b0, 0xb1d0, 0xb450, 0xa878, 0xa9b8, 0xb1d8, 0xb458
.long 0xa7c0, 0xa540, 0xab80, 0xa4a0, 0xa7c8, 0xa548, 0xab88, 0xa4a8
.long 0xa7d0, 0xa550, 0xab90, 0xa4b0, 0xa7d8, 0xa558, 0xab98, 0xa4b8
.long 0xa720, 0xa5e0, 0xb1c0, 0xb440, 0xa728, 0xa5e8, 0xb1c8, 0xb448
.long 0xa730, 0xa5f0, 0xb1d0, 0xb450, 0xa738, 0xa5f8, 0xb1d8, 0xb458
.long 0xb4e0, 0xb6c0, 0xb800, 0xa860, 0xb4e8, 0xb6c8, 0xb808, 0xa868
.long 0xb4f0, 0xb6d0, 0xb810, 0xa870, 0xb4f8, 0xb6d8, 0xb818, 0xa878
.long 0xb300, 0xb760, 0xa540, 0xa900, 0xb308, 0xb768, 0xa548, 0xa908
.long 0xb310, 0xb770, 0xa550, 0xa910, 0xb318, 0xb778, 0xa558, 0xa918
.long 0xb440, 0xb080, 0xb800, 0xa860, 0xb448, 0xb088, 0xb808, 0xa868
.long 0xb450, 0xb090, 0xb810, 0xa870, 0xb458, 0xb098, 0xb818, 0xa878
.long 0xb3a0, 0xb120, 0xa540, 0xa900, 0xb3a8, 0xb128, 0xa548, 0xa908
.long 0xb3b0, 0xb130, 0xa550, 0xa910, 0xb3b8, 0xb138, 0xa558, 0xa918
.long 0xb120, 0xb580, 0xb080, 0xb300, 0xb128, 0xb588, 0xb088, 0xb308
.long 0xb130, 0xb590, 0xb090, 0xb310, 0xb138, 0xb598, 0xb098, 0xb318
.long 0xb6c0, 0xb4e0, 0xaa40, 0xb6c0, 0xb6c8, 0xb4e8, 0xaa48, 0xb6c8
.long 0xb6d0, 0xb4f0, 0xaa50, 0xb6d0, 0xb6d8, 0xb4f8, 0xaa58, 0xb6d8
.long 0xb300, 0xb440, 0xb080, 0xb300, 0xb308, 0xb448, 0xb088, 0xb308
.long 0xb310, 0xb450, 0xb090, 0xb310, 0xb318, 0xb458, 0xb098, 0xb318
.long 0xb260, 0xb760, 0xaa40, 0xb6c0, 0xb268, 0xb768, 0xaa48, 0xb6c8
.long 0xb270, 0xb770, 0xaa50, 0xb6d0, 0xb278, 0xb778, 0xaa58, 0xb6d8
.long 0xb580, 0xb120, 0xb620, 0xa680, 0xb588, 0xb128, 0xb628, 0xa688
.long 0xb590, 0xb130, 0xb630, 0xa690, 0xb598, 0xb138, 0xb638, 0xa698
.long 0xb260, 0xb1c0, 0xa7c0, 0xa680, 0xb268, 0xb1c8, 0xa7c8, 0xa688
.long 0xb270, 0xb1d0, 0xa7d0, 0xa690, 0xb278, 0xb1d8, 0xa7d8, 0xa698
.long 0xb300, 0xb3a0, 0xb620, 0xb300, 0xb308, 0xb3a8, 0xb628, 0xb308
.long 0xb310, 0xb3b0, 0xb630, 0xb310, 0xb318, 0xb3b8, 0xb638, 0xb318
.long 0xb6c0, 0xb800, 0xa7c0, 0xb300, 0xb6c8, 0xb808, 0xa7c8, 0xb308
.long 0xb6d0, 0xb810, 0xa7d0, 0xb310, 0xb6d8, 0xb818, 0xa7d8, 0xb318
.long 0x0, 0x200, 0x0, 0x3f803f80, 0x8, 0x208, 0x0, 0x3f803f80
.long 0x10, 0x210, 0x0, 0x3f803f80, 0x18, 0x218, 0x0, 0x3f803f80
.long 0x420, 0x620, 0x0, 0x3f803f80, 0x428, 0x628, 0x0, 0x3f803f80
.long 0x430, 0x630, 0x0, 0x3f803f80, 0x438, 0x638, 0x0, 0x3f803f80
.long 0x840, 0xa40, 0x10, 0x3f803f80, 0x848, 0xa48, 0x10, 0x3f803f80
.long 0x850, 0xa50, 0x10, 0x3f803f80, 0x858, 0xa58, 0x10, 0x3f803f80
.long 0xc60, 0xe60, 0x10, 0x3f803f80, 0xc68, 0xe68, 0x10, 0x3f803f80
.long 0xc70, 0xe70, 0x10, 0x3f803f80, 0xc78, 0xe78, 0x10, 0x3f803f80
.long 0x80, 0x280, 0x20, 0x3f803f80, 0x88, 0x288, 0x20, 0x3f803f80
.long 0x90, 0x290, 0x20, 0x3f803f80, 0x98, 0x298, 0x20, 0x3f803f80
.long 0x4a0, 0x6a0, 0x20, 0x3f803f80, 0x4a8, 0x6a8, 0x20, 0x3f803f80
.long 0x4b0, 0x6b0, 0x20, 0x3f803f80, 0x4b8, 0x6b8, 0x20, 0x3f803f80
.long 0x8c0, 0xac0, 0x30, 0x3f803f80, 0x8c8, 0xac8, 0x30, 0x3f803f80
.long 0x8d0, 0xad0, 0x30, 0x3f803f80, 0x8d8, 0xad8, 0x30, 0x3f803f80
.long 0xce0, 0xee0, 0x30, 0x3f803f80, 0xce8, 0xee8, 0x30, 0x3f803f80
.long 0xcf0, 0xef0, 0x30, 0x3f803f80, 0xcf8, 0xef8, 0x30, 0x3f803f80
.long 0x100, 0x300, 0x40, 0x0, 0x108, 0x308, 0x40, 0x0
.long 0x110, 0x310, 0x40, 0x0, 0x118, 0x318, 0x40, 0x0
.long 0x520, 0x720, 0x40, 0x0, 0x528, 0x728, 0x40, 0x0
.long 0x530, 0x730, 0x40, 0x0, 0x538, 0x738, 0x40, 0x0
.long 0x940, 0xb40, 0x50, 0x0, 0x948, 0xb48, 0x50, 0x0
.long 0x950, 0xb50, 0x50, 0x0, 0x958, 0xb58, 0x50, 0x0
.long 0xd60, 0xf60, 0x50, 0x0, 0xd68, 0xf68, 0x50, 0x0
.long 0xd70, 0xf70, 0x50, 0x0, 0xd78, 0xf78, 0x50, 0x0
.long 0x180, 0xf60, 0x60, 0x0, 0x188, 0xf68, 0x60, 0x0
.long 0x190, 0xf70, 0x60, 0x0, 0x198, 0xf78, 0x60, 0x0
.long 0x5a0, 0xf60, 0x60, 0x0, 0x5a8, 0xf68, 0x60, 0x0
.long 0x5b0, 0xf70, 0x60, 0x0, 0x5b8, 0xf78, 0x60, 0x0
.long 0x9c0, 0xf60, 0x70, 0x0, 0x9c8, 0xf68, 0x70, 0x0
.long 0x9d0, 0xf70, 0x70, 0x0, 0x9d8, 0xf78, 0x70, 0x0
.long 0xde0, 0xf60, 0x70, 0x0, 0xde8, 0xf68, 0x70, 0x0
.long 0xdf0, 0xf70, 0x70, 0x0, 0xdf8, 0xf78, 0x70, 0x0
.long 0xffff, 0x0, 0x0, 0x0, 0x0, 0x0, 0xffff, 0x0
.long 0x0, 0x0, 0x0, 0x0, 0x0, 0x0, 0x0, 0x0
.long 0x0, 0x0, 0x0, 0x0, 0x0, 0x0, 0x0, 0x0
.long 0x0, 0x0, 0x0, 0x0, 0x0, 0x0, 0x0, 0x0
.long 0xffff0000, 0x0, 0x0, 0x0, 0x0, 0x0, 0xffff0000, 0x0
.long 0x0, 0x0, 0x0, 0x0, 0x0, 0x0, 0x0, 0x0
.long 0x0, 0x0, 0x0, 0x0, 0x0, 0x0, 0x0, 0x0
.long 0x0, 0x0, 0x0, 0x0, 0x0, 0x0, 0x0, 0x0
.long 0x0, 0xffff, 0x0, 0x0, 0x0, 0x0, 0x0, 0xffff
.long 0x0, 0x0, 0x0, 0x0, 0x0, 0x0, 0x0, 0x0
.long 0x0, 0x0, 0x0, 0x0, 0x0, 0x0, 0x0, 0x0
.long 0x0, 0x0, 0x0, 0x0, 0x0, 0x0, 0x0, 0x0
.long 0x0, 0xffff0000, 0x0, 0x0, 0x0, 0x0, 0x0, 0xffff0000
.long 0x0, 0x0, 0x0, 0x0, 0x0, 0x0, 0x0, 0x0
.long 0x0, 0x0, 0x0, 0x0, 0x0, 0x0, 0x0, 0x0
.long 0x0, 0x0, 0x0, 0x0, 0x0, 0x0, 0x0, 0x0
.long 0x0, 0x0, 0x0, 0x0, 0x0, 0x0, 0x0, 0x0
.long 0xffff, 0x0, 0x0, 0x0, 0x0, 0x0, 0xffff, 0x0
.long 0x0, 0x0, 0x0, 0x0, 0x0, 0x0, 0x0, 0x0
.long 0x0, 0x0, 0x0, 0x0, 0x0, 0x0, 0x0, 0x0
.long 0x0, 0x0, 0x0, 0x0, 0x0, 0x0, 0x0, 0x0
.long 0xffff0000, 0x0, 0x0, 0x0, 0x0, 0x0, 0xffff0000, 0x0
.long 0x0, 0x0, 0x0, 0x0, 0x0, 0x0, 0x0, 0x0
.long 0x0, 0x0, 0x0, 0x0, 0x0, 0x0, 0x0, 0x0
.long 0x0, 0x0, 0x0, 0x0, 0x0, 0x0, 0x0, 0x0
.long 0x0, 0xffff, 0x0, 0x0, 0x0, 0x0, 0x0, 0xffff
.long 0x0, 0x0, 0x0, 0x0, 0x0, 0x0, 0x0, 0x0
.long 0x0, 0x0, 0x0, 0x0, 0x0, 0x0, 0x0, 0x0
.long 0x0, 0x0, 0x0, 0x0, 0x0, 0x0, 0x0, 0x0
.long 0x0, 0xffff0000, 0x0, 0x0, 0x0, 0x0, 0x0, 0xffff0000
.long 0x0, 0x0, 0x0, 0x0, 0x0, 0x0, 0x0, 0x0
.long 0x0, 0x0, 0x0, 0x0, 0x0, 0x0, 0x0, 0x0
.long 0x0, 0x0, 0x0, 0x0, 0x0, 0x0, 0x0, 0x0
.long 0x0, 0x0, 0x0, 0x0, 0x0, 0x0, 0x0, 0x0
.long 0x0, 0x0, 0xffff, 0x0, 0x0, 0x0, 0x0, 0x0
.long 0x0, 0x0, 0x0, 0x0, 0xffff, 0x0, 0x0, 0x0
.long 0x0, 0x0, 0x0, 0x0, 0x0, 0x0, 0x0, 0x0
.long 0x0, 0x0, 0x0, 0x0, 0x0, 0x0, 0x0, 0x0
.long 0x0, 0x0, 0xffff0000, 0x0, 0x0, 0x0, 0x0, 0x0
.long 0x0, 0x0, 0x0, 0x0, 0xffff0000, 0x0, 0x0, 0x0
.long 0x0, 0x0, 0x0, 0x0, 0x0, 0x0, 0x0, 0x0
.long 0x0, 0x0, 0x0, 0x0, 0x0, 0x0, 0x0, 0x0
.long 0x0, 0x0, 0x0, 0xffff, 0x0, 0x0, 0x0, 0x0
.long 0x0, 0x0, 0x0, 0x0, 0x0, 0xffff, 0x0, 0x0
.long 0x0, 0x0, 0x0, 0x0, 0x0, 0x0, 0x0, 0x0
.long 0x0, 0x0, 0x0, 0x0, 0x0, 0x0, 0x0, 0x0
.long 0x0, 0x0, 0x0, 0xffff0000, 0x0, 0x0, 0x0, 0x0
.long 0x0, 0x0, 0x0, 0x0, 0x0, 0xffff0000, 0x0, 0x0
.long 0x0, 0x0, 0x0, 0x0, 0x0, 0x0, 0x0, 0x0
.long 0x0, 0x0, 0x0, 0x0, 0x0, 0x0, 0x0, 0x0
.long 0x0, 0x0, 0x0, 0x0, 0xffff, 0x0, 0x0, 0x0
.long 0x0, 0x0, 0x0, 0x0, 0x0, 0x0, 0x0, 0x0
.long 0x0, 0x0, 0x0, 0x0, 0x0, 0x0, 0x0, 0x0
.long 0x0, 0x0, 0x0, 0x0, 0x0, 0x0, 0x0, 0x0
.long 0x0, 0x0, 0x0, 0x0, 0xffff0000, 0x0, 0x0, 0x0
.long 0x0, 0x0, 0x0, 0x0, 0x0, 0x0, 0x0, 0x0
.long 0x0, 0x0, 0x0, 0x0, 0x0, 0x0, 0x0, 0x0
.long 0x0, 0x0, 0x0, 0x0, 0x0, 0x0, 0x0, 0x0
.long 0x0, 0x0, 0x0, 0x0, 0x0, 0x0, 0x0, 0x0
.long 0x0, 0x0, 0x0, 0x0, 0x0, 0x0, 0x0, 0x0
.long 0x0, 0x0, 0x0, 0x0, 0x0, 0x0, 0x0, 0x0
.long 0x0, 0x0, 0x0, 0x0, 0x0, 0x0, 0x0, 0x0
.long 0x0, 0x0, 0x0, 0x0, 0x0, 0x0, 0x0, 0x0
.long 0x0, 0x0, 0x0, 0x0, 0x0, 0x0, 0x0, 0x0
.long 0x14d40, 0x14d40, 0x0, 0x0, 0x14e10, 0x14e10, 0x20, 0x20
.long 0x14ee0, 0x14ee0, 0x100000, 0x100000, 0x14fb0, 0x14fb0, 0x100020, 0x100020
.long 0x15080, 0x15080, 0x40, 0x40, 0x15150, 0x15150, 0x60, 0x60
.long 0x15220, 0x15220, 0x100040, 0x100040, 0x100000, 0x100000, 0x100060, 0x100060
.long 0x14d74, 0x14d74, 0x80, 0x80, 0x14e44, 0x14e44, 0xa0, 0xa0
.long 0x14f14, 0x14f14, 0x100080, 0x100080, 0x14fe4, 0x14fe4, 0x1000a0, 0x1000a0
.long 0x150b4, 0x150b4, 0xc0, 0xc0, 0x15184, 0x15184, 0xe0, 0xe0
.long 0x15254, 0x15254, 0x1000c0, 0x1000c0, 0x100000, 0x100000, 0x1000e0, 0x1000e0
.long 0x14da8, 0x14da8, 0x8, 0x100, 0x14e78, 0x14e78, 0x28, 0x120
.long 0x14f48, 0x14f48, 0x100008, 0x100100, 0x15018, 0x15018, 0x100028, 0x100120
.long 0x150e8, 0x150e8, 0x48, 0x140, 0x151b8, 0x151b8, 0x68, 0x160
.long 0x100000, 0x100000, 0x100048, 0x100140, 0x100000, 0x100000, 0x100068, 0x100160
.long 0x14ddc, 0x14ddc, 0x88, 0x180, 0x14eac, 0x14eac, 0xa8, 0x1a0
.long 0x14f7c, 0x14f7c, 0x100088, 0x100180, 0x1504c, 0x1504c, 0x1000a8, 0x1001a0
.long 0x1511c, 0x1511c, 0xc8, 0x1c0, 0x151ec, 0x151ec, 0xe8, 0x1e0
.long 0x100000, 0x100000, 0x1000c8, 0x1001c0, 0x100000, 0x100000, 0x1000e8, 0x1001e0
.long 0x17d40, 0x114d40, 0x100, 0x200, 0x17e10, 0x114e10, 0x120, 0x220
.long 0x17ee0, 0x114ee0, 0x100100, 0x100200, 0x17fb0, 0x114fb0, 0x100120, 0x100220
.long 0x18080, 0x115080, 0x140, 0x240, 0x18150, 0x115150, 0x160, 0x260
.long 0x18220, 0x115220, 0x100140, 0x100240, 0x103000, 0x200000, 0x100160, 0x100260
.long 0x17d74, 0x114d74, 0x180, 0x280, 0x17e44, 0x114e44, 0x1a0, 0x2a0
.long 0x17f14, 0x114f14, 0x100180, 0x100280, 0x17fe4, 0x114fe4, 0x1001a0, 0x1002a0
.long 0x180b4, 0x1150b4, 0x1c0, 0x2c0, 0x18184, 0x115184, 0x1e0, 0x2e0
.long 0x18254, 0x115254, 0x1001c0, 0x1002c0, 0x103000, 0x200000, 0x1001e0, 0x1002e0
.long 0x17da8, 0x114da8, 0x108, 0x300, 0x17e78, 0x114e78, 0x128, 0x320
.long 0x17f48, 0x114f48, 0x100108, 0x100300, 0x18018, 0x115018, 0x100128, 0x100320
.long 0x180e8, 0x1150e8, 0x148, 0x340, 0x181b8, 0x1151b8, 0x168, 0x360
.long 0x103000, 0x200000, 0x100148, 0x100340, 0x103000, 0x200000, 0x100168, 0x100360
.long 0x17ddc, 0x114ddc, 0x188, 0x380, 0x17eac, 0x114eac, 0x1a8, 0x3a0
.long 0x17f7c, 0x114f7c, 0x100188, 0x100380, 0x1804c, 0x11504c, 0x1001a8, 0x1003a0
.long 0x1811c, 0x11511c, 0x1c8, 0x3c0, 0x181ec, 0x1151ec, 0x1e8, 0x3e0
.long 0x103000, 0x200000, 0x1001c8, 0x1003c0, 0x103000, 0x200000, 0x1001e8, 0x1003e0
.long 0xa400, 0xd00, 0x0, 0x14d40, 0xa440, 0xd00, 0x0, 0x14d80
.long 0xa480, 0xd00, 0x1, 0x14dd0, 0xa4c0, 0xd00, 0x1, 0x14e10
.long 0xa500, 0xd00, 0x2, 0x14e60, 0xa540, 0xd00, 0x2, 0x14ea0
.long 0xa580, 0xd00, 0x3, 0x14ef0, 0xa5c0, 0xd00, 0x3, 0x14f30
.long 0xa600, 0xd00, 0x4, 0x14f40, 0xa640, 0xd00, 0x4, 0x14f80
.long 0xa680, 0xd00, 0x5, 0x14fd0, 0xa6c0, 0xd00, 0x5, 0x15010
.long 0xa700, 0xd00, 0x6, 0x15060, 0xa740, 0xd00, 0x6, 0x150a0
.long 0xa780, 0xd00, 0x7, 0x150f0, 0xa7c0, 0xd00, 0x7, 0x15130
.long 0xa800, 0xd00, 0x8, 0x15140, 0xa840, 0xd00, 0x8, 0x15180
.long 0xa880, 0xd00, 0x9, 0x151d0, 0xa8c0, 0xd00, 0x9, 0x15210
.long 0xa900, 0xd00, 0xa, 0x15260, 0xa940, 0xd00, 0xa, 0x152a0
.long 0xa980, 0xd00, 0xb, 0x152f0, 0xa9c0, 0xd00, 0xb, 0x15330
.long 0xaa00, 0xd00, 0xc, 0x15340, 0xaa40, 0xd00, 0xc, 0x15380
.long 0x1f680, 0x40, 0xd, 0x153d0, 0x100000, 0xd00, 0xd, 0x15410
.long 0x100000, 0xd00, 0xe, 0x15460, 0x100000, 0xd00, 0xe, 0x154a0
.long 0x100000, 0xd00, 0xf, 0x154f0, 0x100000, 0xd00, 0xf, 0x15530
.long 0xa400, 0xd00, 0x2, 0x14d60, 0xa440, 0xd00, 0x2, 0x14da0
.long 0xa480, 0xd00, 0x3, 0x14df0, 0xa4c0, 0xd00, 0x3, 0x14e30
.long 0xa500, 0xd00, 0x4, 0x14e40, 0xa540, 0xd00, 0x4, 0x14e80
.long 0xa580, 0xd00, 0x5, 0x14ed0, 0xa5c0, 0xd00, 0x5, 0x14f10
.long 0xa600, 0xd00, 0x6, 0x14f60, 0xa640, 0xd00, 0x6, 0x14fa0
.long 0xa680, 0xd00, 0x7, 0x14ff0, 0xa6c0, 0xd00, 0x7, 0x15030
.long 0xa700, 0xd00, 0x8, 0x15040, 0xa740, 0xd00, 0x8, 0x15080
.long 0xa780, 0xd00, 0x9, 0x150d0, 0xa7c0, 0xd00, 0x9, 0x15110
.long 0xa800, 0xd00, 0xa, 0x15160, 0xa840, 0xd00, 0xa, 0x151a0
.long 0xa880, 0xd00, 0xb, 0x151f0, 0xa8c0, 0xd00, 0xb, 0x15230
.long 0xa900, 0xd00, 0xc, 0x15240, 0xa940, 0xd00, 0xc, 0x15280
.long 0xa980, 0xd00, 0xd, 0x152d0, 0xa9c0, 0xd00, 0xd, 0x15310
.long 0xaa00, 0xd00, 0xe, 0x15360, 0xaa40, 0xd00, 0xe, 0x153a0
.long 0x1f680, 0x40, 0xf, 0x153f0, 0x100000, 0xd00, 0xf, 0x15430
.long 0x100000, 0xd00, 0x10, 0x15440, 0x100000, 0xd00, 0x10, 0x15480
.long 0x100000, 0xd00, 0x11, 0x154d0, 0x100000, 0xd00, 0x11, 0x15510
.long 0x1f690, 0x1f890, 0x1f9c0, 0x1f9e0, 0x1f698, 0x1f898, 0x1f9c8, 0x1f9e8
.long 0x1f680, 0x1f880, 0x1f9d0, 0x1f9f0, 0x1f688, 0x1f888, 0x1f9d8, 0x100000
.long 0x1fd20, 0x1ff20, 0x1f9c2, 0x1f9e2, 0x1fd28, 0x1ff28, 0x1f9ca, 0x1f9ea
.long 0x1fd30, 0x1ff30, 0x1f9d2, 0x1f9f2, 0x1fd38, 0x1ff38, 0x1f9da, 0x100000
.long 0x1f6f0, 0x1f8f0, 0x1f9c4, 0x1f9e4, 0x1f6f8, 0x1f8f8, 0x1f9cc, 0x1f9ec
.long 0x1f6e0, 0x1f8e0, 0x1f9d4, 0x100000, 0x1f6e8, 0x1f8e8, 0x1f9dc, 0x100000
.long 0x1fd40, 0x1ff40, 0x1f9c6, 0x1f9e6, 0x1fd48, 0x1ff48, 0x1f9ce, 0x1f9ee
.long 0x1fd50, 0x1ff50, 0x1f9d6, 0x100000, 0x1fd58, 0x1ff58, 0x1f9de, 0x100000
.long 0x1f710, 0x1f910, 0x1f9c0, 0x1f9e0, 0x1f718, 0x1f918, 0x1f9c8, 0x1f9e8
.long 0x1f700, 0x1f900, 0x1f9d0, 0x1f9f0, 0x1f708, 0x1f908, 0x1f9d8, 0x100000
.long 0x1fda0, 0x1ffa0, 0x1f9c2, 0x1f9e2, 0x1fda8, 0x1ffa8, 0x1f9ca, 0x1f9ea
.long 0x1fdb0, 0x1ffb0, 0x1f9d2, 0x1f9f2, 0x1fdb8, 0x1ffb8, 0x1f9da, 0x100000
.long 0x1f770, 0x1f970, 0x1f9c4, 0x1f9e4, 0x1f778, 0x1f978, 0x1f9cc, 0x1f9ec
.long 0x1f760, 0x1f960, 0x1f9d4, 0x100000, 0x1f768, 0x1f968, 0x1f9dc, 0x100000
.long 0x1fdc0, 0x1ffc0, 0x1f9c6, 0x1f9e6, 0x1fdc8, 0x1ffc8, 0x1f9ce, 0x1f9ee
.long 0x1fdd0, 0x1ffd0, 0x1f9d6, 0x100000, 0x1fdd8, 0x1ffd8, 0x1f9de, 0x100000
.long 0x1f790, 0x1f990, 0x1f9c0, 0x1f9e0, 0x1f798, 0x1f998, 0x1f9c8, 0x1f9e8
.long 0x1f780, 0x1f980, 0x1f9d0, 0x1f9f0, 0x1f788, 0x1f988, 0x1f9d8, 0x100000
.long 0x1fe20, 0x20020, 0x1f9c2, 0x1f9e2, 0x1fe28, 0x20028, 0x1f9ca, 0x1f9ea
.long 0x1fe30, 0x20030, 0x1f9d2, 0x1f9f2, 0x1fe38, 0x20038, 0x1f9da, 0x100000
.long 0x1f7f0, 0x14d00, 0x1f9c4, 0x1f9e4, 0x1f7f8, 0x14d08, 0x1f9cc, 0x1f9ec
.long 0x1f7e0, 0x14d10, 0x1f9d4, 0x100000, 0x1f7e8, 0x14d18, 0x1f9dc, 0x100000
.long 0x1fe40, 0x14d00, 0x1f9c6, 0x1f9e6, 0x1fe48, 0x14d08, 0x1f9ce, 0x1f9ee
.long 0x1fe50, 0x14d10, 0x1f9d6, 0x100000, 0x1fe58, 0x14d18, 0x1f9de, 0x100000
.long 0x1f810, 0x14d00, 0x1f9c0, 0x1f9e0, 0x1f818, 0x14d08, 0x1f9c8, 0x1f9e8
.long 0x1f800, 0x14d10, 0x1f9d0, 0x1f9f0, 0x1f808, 0x14d18, 0x1f9d8, 0x100000
.long 0x1fea0, 0x14d00, 0x1f9c2, 0x1f9e2, 0x1fea8, 0x14d08, 0x1f9ca, 0x1f9ea
.long 0x1feb0, 0x14d10, 0x1f9d2, 0x1f9f2, 0x1feb8, 0x14d18, 0x1f9da, 0x100000
.long 0x1f870, 0x14d00, 0x1f9c4, 0x1f9e4, 0x1f878, 0x14d08, 0x1f9cc, 0x1f9ec
.long 0x1f860, 0x14d10, 0x1f9d4, 0x100000, 0x1f868, 0x14d18, 0x1f9dc, 0x100000
.long 0x1fec0, 0x14d00, 0x1f9c6, 0x1f9e6, 0x1fec8, 0x14d08, 0x1f9ce, 0x1f9ee
.long 0x1fed0, 0x14d10, 0x1f9d6, 0x100000, 0x1fed8, 0x14d18, 0x1f9de, 0x100000
.long 0x0, 0x4444, 0x0, 0xa400, 0x10, 0xeeee, 0x4, 0xa404
.long 0x20, 0x4444, 0x8, 0xa408, 0x30, 0xeeee, 0xc, 0xa40c
.long 0x40, 0x4444, 0x10, 0xa410, 0x50, 0xeeee, 0x14, 0xa414
.long 0x60, 0x4444, 0x18, 0xa418, 0x70, 0xeeee, 0x1c, 0xa41c
.long 0x0, 0x4444, 0x20, 0xa420, 0x10, 0xeeee, 0x24, 0xa424
.long 0x20, 0x4444, 0x28, 0xa428, 0x30, 0xeeee, 0x2c, 0xa42c
.long 0x40, 0x4444, 0x30, 0xa430, 0x50, 0xeeee, 0x34, 0xa434
.long 0x60, 0x4444, 0x38, 0xa438, 0x70, 0xeeee, 0x3c, 0xa43c
.long 0x0, 0x4444, 0x40, 0xa440, 0x10, 0xeeee, 0x44, 0xa444
.long 0x20, 0x4444, 0x48, 0xa448, 0x30, 0xeeee, 0x4c, 0xa44c
.long 0x40, 0x4444, 0x50, 0xa450, 0x50, 0xeeee, 0x54, 0xa454
.long 0x60, 0x4444, 0x58, 0xa458, 0x70, 0xeeee, 0x5c, 0xa45c
.long 0x0, 0x4444, 0x60, 0xa460, 0x10, 0xeeee, 0x64, 0xa464
.long 0x20, 0x4444, 0x68, 0xa468, 0x30, 0xeeee, 0x6c, 0xa46c
.long 0x40, 0x4444, 0x70, 0xa470, 0x50, 0xeeee, 0x74, 0xa474
.long 0x60, 0x4444, 0x78, 0xa478, 0x70, 0xeeee, 0x7c, 0xa47c
.long 0x0, 0x4444, 0x420, 0xb080, 0x10, 0xeeee, 0x424, 0xb084
.long 0x20, 0x4444, 0x428, 0xb088, 0x30, 0xeeee, 0x42c, 0xb08c
.long 0x40, 0x4444, 0x430, 0xb090, 0x50, 0xeeee, 0x434, 0xb094
.long 0x60, 0x4444, 0x438, 0xb098, 0x70, 0xeeee, 0x43c, 0xb09c
.long 0x0, 0x4444, 0x440, 0xb0a0, 0x10, 0xeeee, 0x444, 0xb0a4
.long 0x20, 0x4444, 0x448, 0xb0a8, 0x30, 0xeeee, 0x44c, 0xb0ac
.long 0x40, 0x4444, 0x450, 0xb0b0, 0x50, 0xeeee, 0x454, 0xb0b4
.long 0x60, 0x4444, 0x458, 0xb0b8, 0x70, 0xeeee, 0x45c, 0xb0bc
.long 0x0, 0x4444, 0x460, 0xb0c0, 0x10, 0xeeee, 0x464, 0xb0c4
.long 0x20, 0x4444, 0x468, 0xb0c8, 0x30, 0xeeee, 0x46c, 0xb0cc
.long 0x40, 0x4444, 0x470, 0xb0d0, 0x50, 0xeeee, 0x474, 0xb0d4
.long 0x60, 0x4444, 0x478, 0xb0d8, 0x70, 0xeeee, 0x47c, 0xb0dc
.long 0x0, 0x4444, 0x480, 0xb0e0, 0x10, 0xeeee, 0x484, 0xb0e4
.long 0x20, 0x4444, 0x488, 0xb0e8, 0x30, 0xeeee, 0x48c, 0xb0ec
.long 0x40, 0x4444, 0x490, 0xb0f0, 0x50, 0xeeee, 0x494, 0xb0f4
.long 0x60, 0x4444, 0x498, 0xb0f8, 0x70, 0xeeee, 0x49c, 0xb0fc
.long 0x1fa28, 0x1f9f4, 0x34, 0x14d00, 0x1fa28, 0x1f9f6, 0x74, 0x14d04
.long 0x1fa28, 0x1f9f8, 0xb4, 0x14d08, 0x1fa28, 0x1f9fa, 0xf4, 0x14d0c
.long 0x1fa28, 0x1f9fc, 0x134, 0x14d10, 0x1fa28, 0x1f9fe, 0x174, 0x14d14
.long 0x1fa28, 0x1fa00, 0x1b4, 0x14d18, 0x1fa28, 0x1fa02, 0x1f4, 0x14d1c
.long 0x1fa28, 0x1fa04, 0x234, 0x14d20, 0x1fa28, 0x1fa06, 0x274, 0x14d24
.long 0x1fa28, 0x1fa08, 0x2b4, 0x14d28, 0x1fa28, 0x1fa0a, 0x2f4, 0x14d2c
.long 0x1fa28, 0x1fa0c, 0x334, 0x14d30, 0x1fa28, 0x1fa0e, 0x374, 0x14d34
.long 0x1fa28, 0x1fa10, 0x3b4, 0x14d38, 0x1fa28, 0x1fa12, 0x3f4, 0x14d3c
.long 0x1fa28, 0x1fa14, 0x434, 0x14d00, 0x1fa28, 0x1fa16, 0x474, 0x14d04
.long 0x1fa28, 0x1fa18, 0x4b4, 0x14d08, 0x1fa28, 0x1fa1a, 0x4f4, 0x14d0c
.long 0x1fa28, 0x1fa1c, 0x534, 0x14d10, 0x1fa28, 0x1fa1e, 0x574, 0x14d14
.long 0x1fa28, 0x1fa20, 0x5b4, 0x14d18, 0x1fa28, 0x1fa22, 0x5f4, 0x14d1c
.long 0x1fa28, 0x1fa24, 0x634, 0x14d20, 0x1fa28, 0x1fa26, 0x674, 0x14d24
.long 0x1fa28, 0x1fa28, 0x6b4, 0x14d28, 0x1fa28, 0x1fa2a, 0x6f4, 0x14d2c
.long 0x1fa28, 0x1fa2c, 0x734, 0x14d30, 0x1fa28, 0x1fa2e, 0x774, 0x14d34
.long 0x1fa28, 0x1fa30, 0x7b4, 0x14d38, 0x1fa28, 0x1fa32, 0x7f4, 0x14d3c
.long 0x1fa38, 0x1fa34, 0x834, 0x14d00, 0x1fa38, 0x1fa36, 0x874, 0x14d04
.long 0x1fa38, 0x1fa38, 0x8b4, 0x14d08, 0x1fa38, 0x1fa3a, 0x8f4, 0x14d0c
.long 0x1fa38, 0x1fa3c, 0x934, 0x14d10, 0x1fa38, 0x1fa3e, 0x974, 0x14d14
.long 0x1fa38, 0x1fa40, 0x9b4, 0x14d18, 0x1fa38, 0x1fa42, 0x9f4, 0x14d1c
.long 0x1fa38, 0x1fa44, 0xa34, 0x14d20, 0x1fa38, 0x1fa46, 0xa74, 0x14d24
.long 0x1fa38, 0x1fa48, 0xab4, 0x14d28, 0x1fa38, 0x1fa4a, 0xaf4, 0x14d2c
.long 0x1fa38, 0x1fa4c, 0xb34, 0x14d30, 0x1fa38, 0x1fa4e, 0xb74, 0x14d34
.long 0x1fa38, 0x1fa50, 0xbb4, 0x14d38, 0x1fa38, 0x1fa52, 0xbf4, 0x14d3c
.long 0x1fa38, 0x1fa54, 0xc34, 0x14d00, 0x1fa38, 0x1fa56, 0xc74, 0x14d04
.long 0x1fa38, 0x1fa58, 0xcb4, 0x14d08, 0x1fa38, 0x1fa5a, 0xcf4, 0x14d0c
.long 0x1fa38, 0x1fa5c, 0xd34, 0x14d10, 0x1fa38, 0x1fa5e, 0xd74, 0x14d14
.long 0x1fa38, 0x1fa60, 0xdb4, 0x14d18, 0x1fa38, 0x1fa62, 0xdf4, 0x14d1c
.long 0x1fa38, 0x1fa64, 0xe34, 0x14d20, 0x1fa38, 0x1fa66, 0xe74, 0x14d24
.long 0x1fa38, 0x1fa68, 0xeb4, 0x14d28, 0x1fa38, 0x1fa6a, 0xef4, 0x14d2c
.long 0x1fa38, 0x1fa6c, 0xf34, 0x14d30, 0x1fa38, 0x1fa6e, 0xf74, 0x14d34
.long 0x1fa38, 0x1fa70, 0xfb4, 0x14d38, 0x1fa38, 0x1fa72, 0xff4, 0x14d3c
.long 0x0, 0x0, 0x0, 0x0, 0x0, 0x0, 0x0, 0x0
.long 0x0, 0x0, 0x0, 0x0, 0x0, 0x0, 0x0, 0x0
.long 0x0, 0x0, 0x0, 0x0, 0x0, 0x0, 0x0, 0x0
.long 0x0, 0x0, 0x0, 0x0, 0x0, 0x0, 0x0, 0x0
.long 0x0, 0x0, 0x0, 0x0, 0x0, 0x0, 0x0, 0x0
.long 0x0, 0x0, 0x0, 0x0, 0x0, 0x0, 0x0, 0x0
.long 0x0, 0x0, 0x0, 0x0, 0x0, 0x0, 0x0, 0x0
.long 0x0, 0x0, 0x0, 0x0, 0x0, 0x0, 0x0, 0x0
.long 0x0, 0x0, 0x0, 0x0, 0x0, 0x0, 0x0, 0x0
.long 0x0, 0x0, 0x0, 0x0, 0x0, 0x0, 0x0, 0x0
.long 0x0, 0x0, 0x0, 0x0, 0x0, 0x0, 0x0, 0x0
.long 0x0, 0x0, 0x0, 0x0, 0x0, 0x0, 0x0, 0x0
.long 0x0, 0x0, 0x0, 0x0, 0x0, 0x0, 0x0, 0x0
.long 0x0, 0x0, 0x0, 0x0, 0x0, 0x0, 0x0, 0x0
.long 0x0, 0x0, 0x0, 0x0, 0x0, 0x0, 0x0, 0x0
.long 0x0, 0x0, 0x0, 0x0, 0x0, 0x0, 0x0, 0x0
.long 0x0, 0x0, 0x0, 0x0, 0x0, 0x0, 0x0, 0x0
.long 0x0, 0x0, 0x0, 0x0, 0x0, 0x0, 0x0, 0x0
.long 0x0, 0x0, 0x0, 0x0, 0x0, 0x0, 0x0, 0x0
.long 0x0, 0x0, 0x0, 0x0, 0x0, 0x0, 0x0, 0x0
.long 0x0, 0x0, 0x0, 0x0, 0x0, 0x0, 0x0, 0x0
.long 0x0, 0x0, 0x0, 0x0, 0x0, 0x0, 0x0, 0x0
.long 0x0, 0x0, 0x0, 0x0, 0x0, 0x0, 0x0, 0x0
.long 0x0, 0x0, 0x0, 0x0, 0x0, 0x0, 0x0, 0x0
.long 0x0, 0x0, 0x0, 0x0, 0x0, 0x0, 0x0, 0x0
.long 0x0, 0x0, 0x0, 0x0, 0x0, 0x0, 0x0, 0x0
.long 0x0, 0x0, 0x0, 0x0, 0x0, 0x0, 0x0, 0x0
.long 0x0, 0x0, 0x0, 0x0, 0x0, 0x0, 0x0, 0x0
.long 0x0, 0x0, 0x0, 0x0, 0x0, 0x0, 0x0, 0x0
.long 0x0, 0x0, 0x0, 0x0, 0x0, 0x0, 0x0, 0x0
.long 0x0, 0x0, 0x0, 0x0, 0x0, 0x0, 0x0, 0x0
.long 0x0, 0x0, 0x0, 0x0, 0x0, 0x0, 0x0, 0x0
.long 0x13320, 0xa9b0, 0xa800, 0x10c00, 0xf320, 0xc120, 0x133b0, 0xb690
.long 0xa890, 0x11920, 0xf3b0, 0xce00, 0x12600, 0xa920, 0xb520, 0x10c90
.long 0xe600, 0xc090, 0x12690, 0xb600, 0xb5b0, 0x119b0, 0xe690, 0xcdb0
.long 0xd5f0, 0x11440, 0x117f0, 0x130d0, 0xf8d0, 0xadf0, 0xd640, 0x12160
.long 0x11840, 0x13df0, 0xf960, 0xbad0, 0xc8d0, 0x113f0, 0x124d0, 0x13160
.long 0xebf0, 0xad60, 0xc960, 0x120d0, 0x12560, 0x13e40, 0xec40, 0xba40
.long 0xefb0, 0x10ed0, 0x117b0, 0x12a40, 0xfa90, 0xdb60, 0xc890, 0x10d60
.long 0x10a90, 0x129f0, 0x13bb0, 0xddf0, 0xf000, 0x11bf0, 0x11520, 0xe960
.long 0xc160, 0xf9b0, 0xc920, 0x11a40, 0x10800, 0xe8d0, 0xc3f0, 0x13a90
.long 0xce40, 0xfa00, 0xfff0, 0xbb20, 0xedb0, 0xdad0, 0xced0, 0x10720
.long 0x10040, 0xc800, 0x14890, 0xde40, 0xf560, 0xfbb0, 0x140d0, 0xbdb0
.long 0xb3f0, 0xec00, 0xf5f0, 0x10890, 0x14160, 0xca90, 0xb760, 0x14720
.long 0x13520, 0xddb0, 0xa520, 0xbe00, 0xf490, 0xe800, 0x13690, 0x10490
.long 0xa5b0, 0xcb20, 0xe7b0, 0x14d00, 0x12800, 0xdd20, 0xb200, 0xbe90
.long 0xf800, 0x14320, 0x129b0, 0x10400, 0xb290, 0xcbb0, 0xeb20, 0x14290
.long 0xd560, 0x10760, 0x112d0, 0xaed0, 0xfb60, 0xeed0, 0xd3f0, 0xe040
.long 0x11360, 0xbbf0, 0xee40, 0x14d00, 0xc840, 0x106d0, 0x11ff0, 0xaf60
.long 0xfed0, 0x149f0, 0xc6d0, 0xdff0, 0x12040, 0xbc40, 0xf1f0, 0x14960
.long 0xbbb0, 0x10cd0, 0xfdb0, 0x12960, 0xd3b0, 0xd9f0, 0x13090, 0x11160
.long 0x13e90, 0x12bf0, 0xbff0, 0xd290, 0xbc00, 0x119f0, 0xfb20, 0xe840
.long 0xac90, 0xd840, 0x13120, 0x11e40, 0x13c00, 0xead0, 0xbe40, 0xabb0
.long 0xcf60, 0x11400, 0x101f0, 0xef20, 0x12e90, 0xdd60, 0xccd0, 0xd320
.long 0x10560, 0x14a00, 0xb640, 0x12d20, 0xf640, 0x115b0, 0x142d0, 0xf1b0
.long 0x121b0, 0xdcd0, 0xf3f0, 0xd490, 0x14640, 0x14c90, 0xb5f0, 0x12000
.long 0x13600, 0xf7b0, 0xa490, 0xb120, 0x10d20, 0xc200, 0x135b0, 0xea90
.long 0xa400, 0x14d00, 0x10db0, 0xcf20, 0x12920, 0xf720, 0xaa00, 0x14000
.long 0x11a00, 0xc290, 0x12890, 0xea00, 0xb720, 0x14090, 0x11a90, 0xcfb0
.long 0xd4d0, 0xfa40, 0x11760, 0x123f0, 0x12cd0, 0xaff0, 0xd440, 0xed60
.long 0x116d0, 0x14d00, 0x12d60, 0xbcd0, 0xc7f0, 0xf9f0, 0x118d0, 0x14ad0
.long 0x139f0, 0xb040, 0xc760, 0xecd0, 0x125f0, 0x14b60, 0x13a40, 0xbd60
.long 0xe290, 0x10e40, 0xc9b0, 0x12760, 0xfe00, 0x13640, 0x10df0, 0xd5b0
.long 0xf090, 0x128d0, 0x13f20, 0x138d0, 0xe320, 0x11b60, 0x12640, 0xafb0
.long 0xfe90, 0x14360, 0x11ad0, 0xd600, 0xe560, 0xad20, 0x13fb0, 0x145f0
.long 0xe000, 0xcd60, 0x10920, 0x102d0, 0xa6d0, 0xebb0, 0xd040, 0x12e00
.long 0xfc00, 0x10240, 0xaa40, 0x14690, 0xe1b0, 0xf440, 0x103f0, 0x12320
.long 0xe7f0, 0xee00, 0xf760, 0x12fb0, 0x144d0, 0x125b0, 0xeb60, 0x14920
.long 0x13720, 0x111b0, 0xdb20, 0xf400, 0x11090, 0x11d20, 0x137b0, 0x11e90
.long 0xda90, 0xe720, 0x11db0, 0x14d00, 0x12a00, 0x11120, 0x10200, 0xf5b0
.long 0x11200, 0x14400, 0x12a90, 0x11e00, 0x101b0, 0xe890, 0x11f20, 0x14490
.long 0xd6d0, 0x12e40, 0x108d0, 0xfc40, 0x13240, 0x13ed0, 0xd760, 0x13b60
.long 0x10840, 0xef60, 0x13f60, 0x14d00, 0xc9f0, 0x12df0, 0xe1f0, 0xfad0
.long 0x132d0, 0x14bf0, 0xca40, 0x13ad0, 0xe160, 0xedf0, 0x13ff0, 0x14c40
.long 0x11690, 0x11040, 0xde90, 0xa640, 0x10b20, 0x136d0, 0x109b0, 0x10ff0
.long 0xa5f0, 0xd1b0, 0x10bb0, 0x143f0, 0x11720, 0x11d60, 0xdf20, 0xb360
.long 0xb000, 0x13360, 0x10a00, 0x11cd0, 0xb2d0, 0xd200, 0xb090, 0x14040
.long 0xcbf0, 0xb920, 0xe400, 0x13560, 0xa560, 0xc490, 0xcc40, 0xc600
.long 0x13840, 0x13200, 0xe640, 0xc720, 0xf2d0, 0xba90, 0xdfb0, 0xc040
.long 0xa8d0, 0x11fb0, 0xf360, 0xc7b0, 0xc360, 0x12db0, 0xe9f0, 0x12200
.long 0x13400, 0xc3b0, 0xdc00, 0x10e00, 0xbfb0, 0xcc00, 0x13490, 0xd090
.long 0xdc90, 0x11b20, 0xcc90, 0x14d00, 0x12720, 0xc320, 0x10320, 0x10fb0
.long 0xc400, 0x14120, 0x127b0, 0xd000, 0x103b0, 0x11c90, 0xd120, 0x141b0
.long 0xd1f0, 0xac40, 0x10ad0, 0x13040, 0xab60, 0xb7f0, 0xd240, 0xb960
.long 0x10b60, 0x13d60, 0xb840, 0x14d00, 0xc4d0, 0xabf0, 0xe3f0, 0x12ed0
.long 0xb0d0, 0x146d0, 0xc560, 0xb8d0, 0xe440, 0x13bf0, 0xbdf0, 0x14760
.long 0xfc90, 0x10f60, 0x11290, 0xa840, 0x13d20, 0x104d0, 0x13db0, 0x111f0
.long 0x105b0, 0xa7f0, 0x13c90, 0xf7f0, 0xfd20, 0x11c40, 0x11320, 0xb560
.long 0xae00, 0xff60, 0x13e00, 0x11ed0, 0x10600, 0xb4d0, 0xadb0, 0xf240
.long 0xcdf0, 0xed20, 0x133f0, 0xbd20, 0x12c40, 0x14bb0, 0xd160, 0x14800
.long 0x13440, 0xca00, 0x11f60, 0x14b20, 0xf4d0, 0xee90, 0xbed0, 0xb890
.long 0x12ad0, 0x12490, 0xf840, 0x149b0, 0xbf60, 0xc5b0, 0x11df0, 0x12400
.long 0x12bb0, 0x13800, 0xd920, 0xc000, 0x14600, 0x14d00, 0x13890, 0x14d00
.long 0xd9b0, 0xcd20, 0xc5f0, 0x14d00, 0x13920, 0x145b0, 0x10000, 0xc1b0
.long 0xb1b0, 0x14d00, 0x12c00, 0x14520, 0x10090, 0xce90, 0xfbf0, 0x14d00
.long 0xc640, 0xd2d0, 0x105f0, 0xae40, 0x14cd0, 0x14d00, 0xd360, 0x14d00
.long 0x10640, 0xbb60, 0xbf20, 0x14d00, 0xd7f0, 0x14840, 0xded0, 0xacd0
.long 0x10290, 0x14d00, 0xcad0, 0x147f0, 0xdf60, 0xb9f0, 0x11000, 0x14d00
.long 0x14a90, 0x11240, 0xf890, 0xa760, 0x14d00, 0xaad0, 0x123b0, 0x110d0
.long 0x139b0, 0xa9f0, 0x14d00, 0x12b20, 0x10c40, 0xae90, 0xf920, 0xb440
.long 0xe0d0, 0x14d00, 0x11960, 0xaf20, 0x13a00, 0xb6d0, 0x131f0, 0x14d00
.long 0x13b20, 0xd0d0, 0x135f0, 0xf120, 0x14d00, 0x12440, 0xac00, 0xcb60
.long 0x13960, 0x14c00, 0xf520, 0x14d00, 0xcff0, 0x12120, 0xc0d0, 0xec90
.long 0xda40, 0xe090, 0xf6d0, 0x12290, 0xc440, 0x147b0, 0x14d00, 0x14d00
.long 0xa600, 0xd800, 0xdbb0, 0x10120, 0x0, 0x0, 0xa7b0, 0xff20
.long 0xda00, 0x14d00, 0x0, 0x0, 0xb320, 0xd890, 0xde00, 0x14200
.long 0x0, 0x0, 0xb490, 0xffb0, 0x10520, 0x143b0, 0x0, 0x0
.long 0x11640, 0x109f0, 0x107f0, 0xe240, 0x0, 0x0, 0x114d0, 0xe2d0
.long 0x10960, 0x14d00, 0x0, 0x0, 0x12360, 0x10a40, 0x10bf0, 0x14a40
.long 0x0, 0x0, 0x121f0, 0xe360, 0xe4d0, 0x148d0, 0x0, 0x0
.long 0xbc90, 0x126d0, 0x12c90, 0xa960, 0x0, 0x0, 0x131b0, 0x12b60
.long 0xb7b0, 0xa4d0, 0x0, 0x0, 0xba00, 0xe5f0, 0xa440, 0xaa90
.long 0x0, 0x0, 0x12f20, 0xea40, 0xb160, 0xab20, 0x0, 0x0
.long 0x10360, 0x11600, 0xd720, 0x134d0, 0x0, 0x0, 0x100d0, 0xd520
.long 0x11800, 0x13760, 0x0, 0x0, 0x14440, 0x11890, 0x137f0, 0x12520
.long 0x0, 0x0, 0x141f0, 0xd7b0, 0xc2d0, 0x12090, 0x0, 0x0
.long 0xa720, 0xf200, 0xf600, 0x10f20, 0x0, 0x0, 0xa690, 0xe520
.long 0xf690, 0x11c00, 0x0, 0x0, 0xb400, 0xf290, 0xe920, 0x10e90
.long 0x0, 0x0, 0xb3b0, 0xe5b0, 0xe9b0, 0x11bb0, 0x0, 0x0
.long 0x115f0, 0xfcd0, 0xfdf0, 0x12ff0, 0x0, 0x0, 0x11560, 0xeff0
.long 0xfe40, 0x13cd0, 0x0, 0x0, 0x122d0, 0xfd60, 0xf0d0, 0x12f60
.long 0x0, 0x0, 0x12240, 0xf040, 0xf160, 0x13c40, 0x0, 0x0
.long 0xe3b0, 0x12840, 0x11490, 0xdc40, 0x0, 0x0, 0x127f0, 0xd690
.long 0x107b0, 0xdbf0, 0x0, 0x0, 0xe120, 0xe760, 0xc240, 0x113b0
.long 0x0, 0x0, 0xe6d0, 0xd400, 0xc1f0, 0x10690, 0x0, 0x0
.long 0xe200, 0x10160, 0xb9b0, 0xd8d0, 0x0, 0x0, 0x10440, 0x13000
.long 0xc690, 0xd960, 0x0, 0x0, 0xe490, 0x14240, 0xb1f0, 0xb800
.long 0x0, 0x0, 0x14560, 0x13290, 0xb240, 0xc520, 0x0, 0x0
.long 0x0, 0x0, 0x0, 0x0, 0x0, 0x0, 0x0, 0x0
.long 0x0, 0x0, 0x0, 0x0, 0x0, 0x0, 0x0, 0x0
.long 0x0, 0x0, 0x0, 0x0, 0x0, 0x0, 0x0, 0x0
.long 0x0, 0x0, 0x0, 0x0, 0x0, 0x0, 0x0, 0x0
.long 0x0, 0x0, 0x0, 0x0, 0x0, 0x0, 0x0, 0x0
.long 0x0, 0x0, 0x0, 0x0, 0x0, 0x0, 0x0, 0x0
.long 0x0, 0x0, 0x0, 0x0, 0x0, 0x0, 0x0, 0x0
.long 0x0, 0x0, 0x0, 0x0, 0x0, 0x0, 0x0, 0x0
.long 0x0, 0x0, 0x0, 0x0, 0x0, 0x0, 0x0, 0x0
.long 0x0, 0x0, 0x0, 0x0, 0x0, 0x0, 0x0, 0x0
.long 0x0, 0x0, 0x0, 0x0, 0x0, 0x0, 0x0, 0x0
.long 0x0, 0x0, 0x0, 0x0, 0x0, 0x0, 0x0, 0x0
.long 0x0, 0x0, 0x0, 0x0, 0x0, 0x0, 0x0, 0x0
.long 0x0, 0x0, 0x0, 0x0, 0x0, 0x0, 0x0, 0x0
.long 0x0, 0x0, 0x0, 0x0, 0x0, 0x0, 0x0, 0x0
.long 0x0, 0x0, 0x0, 0x0, 0x0, 0x0, 0x0, 0x0
.long 0x0, 0x0, 0x0, 0x0, 0x0, 0x0, 0x0, 0x0
.long 0x0, 0x0, 0x0, 0x0, 0x0, 0x0, 0x0, 0x0
.long 0x0, 0x0, 0x0, 0x0, 0x0, 0x0, 0x0, 0x0
.long 0x0, 0x0, 0x0, 0x0, 0x0, 0x0, 0x0, 0x0
.long 0x0, 0x0, 0x0, 0x0, 0x0, 0x0, 0x0, 0x0
.long 0x0, 0x0, 0x0, 0x0, 0x0, 0x0, 0x0, 0x0
.long 0x0, 0x0, 0x0, 0x0, 0x0, 0x0, 0x0, 0x0
.long 0x0, 0x0, 0x0, 0x0, 0x0, 0x0, 0x0, 0x0
.long 0x0, 0x0, 0x0, 0x0, 0x0, 0x0, 0x0, 0x0
.long 0x0, 0x0, 0x0, 0x0, 0x0, 0x0, 0x0, 0x0
.long 0x0, 0x0, 0x0, 0x0, 0x0, 0x0, 0x0, 0x0
.long 0x0, 0x0, 0x0, 0x0, 0x0, 0x0, 0x0, 0x0
.long 0x0, 0x0, 0x0, 0x0, 0x0, 0x0, 0x0, 0x0
.long 0x0, 0x0, 0x0, 0x0, 0x0, 0x0, 0x0, 0x0
.long 0x0, 0x0, 0x0, 0x0, 0x0, 0x0, 0x0, 0x0
.long 0x0, 0x0, 0x0, 0x0, 0x0, 0x0, 0x0, 0x0
.section .rodata,"a"
.p2align 6
.amdhsa_kernel standalone__deep_cross_xdeepfm__recsys_kernel
  .amdhsa_next_free_vgpr 256
  .amdhsa_next_free_sgpr 102
  .amdhsa_accum_offset 256
  .amdhsa_group_segment_fixed_size 0
  .amdhsa_kernarg_size 88
  .amdhsa_user_sgpr_count 2
  .amdhsa_user_sgpr_kernarg_segment_ptr 1
  .amdhsa_system_sgpr_workgroup_id_x 1
  .amdhsa_float_denorm_mode_32 3
.end_amdhsa_kernel
```

```asm
; @launch grid=(256,1,1) block=(512,1,1) lds=163840
.amdgcn_target "amdgcn-amd-amdhsa--gfx950"
.text
.globl standalone__deep_cross_xdeepfm__recsys_kernel
.p2align 8
.type standalone__deep_cross_xdeepfm__recsys_kernel,@function
standalone__deep_cross_xdeepfm__recsys_kernel:
  s_cmp_ge_u32 s2, 256
  s_cbranch_scc1 L_end
  s_load_dwordx16 s[4:19], s[0:1], 0
  s_load_dwordx4 s[20:23], s[0:1], 64
  s_load_dwordx2 s[24:25], s[0:1], 80
  v_lshrrev_b32 v1, 6, v0
  s_getpc_b64 s[92:93]
L_pc:
  s_and_b32 s68, s2, 0xf8
  v_add_u32 v2, s68, v1
  v_and_b32_e64 v3, 32, v0
  v_lshl_add_u32 v2, v3, 3, v2
  v_lshlrev_b32 v2, 7, v2
  v_min_u32 v2, L_end-L_pc, v2
  v_mov_b32 v3, s93
  v_add_co_u32 v2, vcc, s92, v2
  s_nop 1
  v_addc_co_u32 v3, vcc, 0, v3, vcc
  global_load_dword v251, v[2:3], off
  v_and_b32 v0, 63, v0
  v_readfirstlane_b32 s3, v1
  s_and_b32 s68, s2, 7
  s_lshr_b32 s69, s2, 3
  s_xor_b32 s69, s69, 31
  s_and_b32 s80, s2, 0xf8
  s_add_u32 s80, s80, s3
  s_lshl_b32 s80, s80, 0
  s_min_u32 s70, s68, 1
  s_add_u32 s71, s69, s70
  s_cmp_ge_u32 s71, 22
  s_cbranch_scc1 L_cin
  s_mul_i32 s68, s68, 21
  s_add_u32 s68, s68, s71
  s_mul_i32 s26, s68, 5042
  s_lshr_b32 s26, s26, 16
  s_mul_i32 s69, s26, 13
  s_sub_u32 s27, s68, s69
  s_lshl_b32 s77, s27, 8
  s_mul_i32 s71, s26, 320
  v_lshrrev_b32 v116, 4, v0
  v_lshlrev_b32 v11, 4, v0
  s_and_b32 s79, s3, 3
  s_cmp_ge_u32 s3, 4
  s_cbranch_scc1 L_ld
  s_mul_i32 s70, s3, 13
  v_min_u32 v118, 12, v0
  v_add_u32 v118, s70, v118
  v_lshrrev_b32 v117, 1, v118
  v_mul_u32_u24 v117, 96, v117
  v_lshl_add_u32 v118, v118, 2, v117
  s_mul_i32 s78, s27, 25
  s_min_u32 s78, s78, 294
  s_add_u32 s78, s78, s71
  s_mul_i32 s78, s78, 104
  s_lshl_b32 s70, s26, 2
  s_add_u32 s70, s70, s3
  s_add_u32 s70, s70, 64
  s_mul_i32 s70, s70, 3328
  s_add_u32 s70, s70, s77
  s_mov_b32 s81, 173056
  v_lshrrev_b32 v112, 1, v0
  v_mul_lo_u32 v112, s81, v112
  v_and_b32 v117, 1, v0
  v_lshl_add_u32 v112, v117, 7, v112
  v_add_u32 v112, s70, v112
  s_waitcnt lgkmcnt(0)
  s_mov_b32 s28, s4
  s_and_b32 s29, s5, 0xffff
  s_mov_b32 s30, 425984
  s_mov_b32 s31, 0x20000
  buffer_load_dwordx4 v[100:103], v118, s[28:31], s78 offen
  buffer_load_dwordx4 v[104:107], v118, s[28:31], s78 offen offset:16
  s_mov_b32 s32, s6
  s_and_b32 s33, s7, 0xffff
  s_mov_b32 s34, 12800000
  s_mov_b32 s35, 0x20000
  s_mov_b32 s48, s14
  s_and_b32 s49, s15, 0xffff
  s_mov_b32 s50, 3328
  s_mov_b32 s51, 0x20000
  s_mov_b32 m0, 122880
  s_mov_b64 exec, 0xffff
  buffer_load_dwordx4 v11, s[48:51], s77 offen lds
  s_mov_b64 exec, -1
  s_mov_b32 s44, s12
  s_and_b32 s45, s13, 0xffff
  s_mov_b32 s46, 5537792
  s_mov_b32 s47, 0x20000
  s_mov_b64 exec, 255
  buffer_load_dword v209, v112, s[44:47], 0 offen
  s_mov_b64 exec, -1
  s_barrier
  s_branch L_cmp
L_ld:
  s_lshr_b32 s68, s79, 1
  s_mul_i32 s68, s68, 20
  s_and_b32 s69, s79, 1
  s_add_u32 s68, s68, s69
  s_lshl_b32 s76, s68, 10
  s_mul_i32 s78, s71, 104
  s_mul_i32 s68, s68, 832
  s_add_u32 s94, s78, s68
  v_mul_u32_u24 v118, 48, v116
  v_sub_u32_e64 v12, v11, v118
  s_add_u32 s95, s94, 3328
  s_add_u32 s96, s94, 6656
  s_add_u32 s97, s94, 9984
  s_add_u32 s98, s94, 13312
  s_and_b32 s70, s79, 1
  s_lshl_b32 s70, s70, 3
  v_lshlrev_b32 v117, 1, v116
  v_or_b32 v117, s70, v117
  v_xor_b32 v117, v117, v0
  v_and_b32 v117, 15, v117
  v_mul_u32_u24 v4, 3328, v116
  v_lshl_add_u32 v4, v117, 4, v4
  v_add_u32 v5, 13312, v4
  s_mul_i32 s74, s79, 26624
  s_add_u32 s74, s74, s77
  s_lshl_b32 s75, s79, 11
  s_waitcnt lgkmcnt(0)
  s_mov_b32 s28, s4
  s_and_b32 s29, s5, 0xffff
  s_mov_b32 s30, 425984
  s_mov_b32 s31, 0x20000
  buffer_load_dwordx4 v[16:19], v12, s[28:31], s94 offen offset:0
  s_mov_b32 s32, s6
  s_and_b32 s33, s7, 0xffff
  s_mov_b32 s34, 12800000
  s_mov_b32 s35, 0x20000
  s_mov_b32 s44, s12
  s_and_b32 s45, s13, 0xffff
  s_mov_b32 s46, 5537792
  s_mov_b32 s47, 0x20000
  s_add_u32 m0, s75, 131072
  s_nop 0
  buffer_load_dwordx4 v4, s[44:47], s74 offen lds
  s_add_u32 m0, s75, 132096
  s_nop 0
  buffer_load_dwordx4 v5, s[44:47], s74 offen lds
  s_add_u32 s74, s74, 106496
  s_add_u32 m0, s75, 139264
  s_nop 0
  buffer_load_dwordx4 v4, s[44:47], s74 offen lds
  s_add_u32 m0, s75, 140288
  s_nop 0
  buffer_load_dwordx4 v5, s[44:47], s74 offen lds
  s_add_u32 s74, s74, 106496
  s_barrier
  buffer_load_dwordx4 v[20:23], v12, s[28:31], s94 offen offset:1664
  buffer_load_dwordx4 v[24:27], v12, s[28:31], s95 offen offset:0
  buffer_load_dwordx4 v[28:31], v12, s[28:31], s95 offen offset:1664
  buffer_load_dwordx4 v[32:35], v12, s[28:31], s96 offen offset:0
  buffer_load_dwordx4 v[36:39], v12, s[28:31], s96 offen offset:1664
  buffer_load_dwordx4 v[40:43], v12, s[28:31], s97 offen offset:0
  buffer_load_dwordx4 v[44:47], v12, s[28:31], s97 offen offset:1664
  buffer_load_dwordx4 v[48:51], v12, s[28:31], s98 offen offset:0
  buffer_load_dwordx4 v[52:55], v12, s[28:31], s98 offen offset:1664
  s_lshl_b32 s70, s69, 6
  v_and_b32 v118, 7, v0
  v_xor_b32 v118, v118, v116
  v_lshlrev_b32 v118, 4, v118
  v_xor_b32 v2, s70, v118
  v_xor_b32 v3, 64, v2
  s_mov_b32 s72, 0
  s_mul_i32 s70, s79, 13
  s_add_u32 s70, s70, s27
  s_min_u32 s70, s70, 39
  s_lshl_b32 s70, s70, 3
  s_add_u32 s70, s70, s71
  s_mul_i32 s84, s70, 104
  v_lshrrev_b32 v118, 2, v0
  v_min_u32 v118, 7, v118
  v_mul_u32_u24 v118, 104, v118
  v_and_b32 v117, 3, v0
  v_lshl_add_u32 v7, v117, 2, v118
  s_lshl_b32 s70, s26, 2
  s_add_u32 s70, s70, s79
  s_add_u32 s70, s70, 256
  s_mul_i32 s85, s70, 3328
  s_add_u32 s85, s85, s77
  s_mov_b32 s70, 173056
  v_lshrrev_b32 v118, 1, v0
  v_mul_lo_u32 v118, s70, v118
  v_and_b32 v117, 1, v0
  v_lshl_add_u32 v84, v117, 7, v118
  s_mov_b32 s52, s16
  s_and_b32 s53, s17, 0xffff
  s_mov_b32 s54, 3328
  s_mov_b32 s55, 0x20000
  s_mul_i32 s70, s79, 2560
  s_add_u32 s70, s70, L_tail-L_pc
  v_lshlrev_b32 v8, 7, v0
  v_add_u32 v8, s70, v8
  v_mov_b32 v9, s93
  v_add_co_u32 v8, vcc, s92, v8
  s_nop 1
  v_addc_co_u32 v9, vcc, 0, v9, vcc
  s_waitcnt vmcnt(13)
  v_lshlrev_b32 v16, 7, v16
  v_lshlrev_b32 v18, 7, v18
  v_lshlrev_b32 v17, 7, v17
  v_lshlrev_b32 v19, 7, v19
  v_add_u32_dpp v56, v16, v2 row_newbcast:0 row_mask:0xf bank_mask:0x3
  s_nop 1
  v_add_u32_dpp v56, v18, v2 row_newbcast:6 row_mask:0xf bank_mask:0xc
  s_add_u32 m0, s76, 0
  s_nop 0
  buffer_load_dwordx4 v56, s[32:35], 0 offen lds
  s_waitcnt vmcnt(10)
  s_barrier
  s_waitcnt vmcnt(9)
  v_lshlrev_b32 v20, 7, v20
  v_lshlrev_b32 v22, 7, v22
  v_lshlrev_b32 v21, 7, v21
  v_lshlrev_b32 v23, 7, v23
  v_add_u32_dpp v57, v20, v2 row_newbcast:0 row_mask:0xf bank_mask:0x3
  s_nop 1
  v_add_u32_dpp v57, v22, v2 row_newbcast:6 row_mask:0xf bank_mask:0xc
  s_add_u32 m0, s76, 2048
  s_nop 0
  buffer_load_dwordx4 v57, s[32:35], 0 offen lds
  s_waitcnt vmcnt(9)
  v_lshlrev_b32 v24, 7, v24
  v_lshlrev_b32 v26, 7, v26
  v_lshlrev_b32 v25, 7, v25
  v_lshlrev_b32 v27, 7, v27
  v_add_u32_dpp v58, v24, v2 row_newbcast:0 row_mask:0xf bank_mask:0x3
  s_nop 1
  v_add_u32_dpp v58, v26, v2 row_newbcast:6 row_mask:0xf bank_mask:0xc
  s_add_u32 m0, s76, 4096
  s_nop 0
  buffer_load_dwordx4 v58, s[32:35], 0 offen lds
  s_waitcnt vmcnt(9)
  v_lshlrev_b32 v28, 7, v28
  v_lshlrev_b32 v30, 7, v30
  v_lshlrev_b32 v29, 7, v29
  v_lshlrev_b32 v31, 7, v31
  v_add_u32_dpp v59, v28, v2 row_newbcast:0 row_mask:0xf bank_mask:0x3
  s_nop 1
  v_add_u32_dpp v59, v30, v2 row_newbcast:6 row_mask:0xf bank_mask:0xc
  s_add_u32 m0, s76, 6144
  s_nop 0
  buffer_load_dwordx4 v59, s[32:35], 0 offen lds
  s_waitcnt vmcnt(9)
  v_lshlrev_b32 v32, 7, v32
  v_lshlrev_b32 v34, 7, v34
  v_lshlrev_b32 v33, 7, v33
  v_lshlrev_b32 v35, 7, v35
  v_add_u32_dpp v60, v32, v2 row_newbcast:0 row_mask:0xf bank_mask:0x3
  s_nop 1
  v_add_u32_dpp v60, v34, v2 row_newbcast:6 row_mask:0xf bank_mask:0xc
  s_add_u32 m0, s76, 8192
  s_nop 0
  buffer_load_dwordx4 v60, s[32:35], 0 offen lds
  s_waitcnt vmcnt(9)
  v_lshlrev_b32 v36, 7, v36
  v_lshlrev_b32 v38, 7, v38
  v_lshlrev_b32 v37, 7, v37
  v_lshlrev_b32 v39, 7, v39
  v_add_u32_dpp v61, v36, v2 row_newbcast:0 row_mask:0xf bank_mask:0x3
  s_nop 1
  v_add_u32_dpp v61, v38, v2 row_newbcast:6 row_mask:0xf bank_mask:0xc
  s_add_u32 m0, s76, 10240
  s_nop 0
  buffer_load_dwordx4 v61, s[32:35], 0 offen lds
  s_waitcnt vmcnt(9)
  v_lshlrev_b32 v40, 7, v40
  v_lshlrev_b32 v42, 7, v42
  v_lshlrev_b32 v41, 7, v41
  v_lshlrev_b32 v43, 7, v43
  v_add_u32_dpp v62, v40, v2 row_newbcast:0 row_mask:0xf bank_mask:0x3
  s_nop 1
  v_add_u32_dpp v62, v42, v2 row_newbcast:6 row_mask:0xf bank_mask:0xc
  s_add_u32 m0, s76, 12288
  s_nop 0
  buffer_load_dwordx4 v62, s[32:35], 0 offen lds
  s_waitcnt vmcnt(9)
  v_lshlrev_b32 v44, 7, v44
  v_lshlrev_b32 v46, 7, v46
  v_lshlrev_b32 v45, 7, v45
  v_lshlrev_b32_e64 v47, 7, v47
  v_add_u32_dpp v63, v44, v2 row_newbcast:0 row_mask:0xf bank_mask:0x3
  s_nop 1
  v_add_u32_dpp v63, v46, v2 row_newbcast:6 row_mask:0xf bank_mask:0xc
  s_add_u32 m0, s76, 14336
  s_nop 0
  buffer_load_dwordx4 v63, s[32:35], 0 offen lds
  s_waitcnt vmcnt(9)
  v_lshlrev_b32 v48, 7, v48
  v_lshlrev_b32 v50, 7, v50
  v_lshlrev_b32 v49, 7, v49
  v_lshlrev_b32_e64 v51, 7, v51
  v_add_u32_dpp v64, v48, v2 row_newbcast:0 row_mask:0xf bank_mask:0x3
  s_nop 1
  v_add_u32_dpp v64, v50, v2 row_newbcast:6 row_mask:0xf bank_mask:0xc
  s_add_u32 m0, s76, 16384
  s_nop 0
  buffer_load_dwordx4 v64, s[32:35], 0 offen lds
  s_waitcnt vmcnt(9)
  v_lshlrev_b32 v52, 7, v52
  v_lshlrev_b32 v54, 7, v54
  v_lshlrev_b32 v53, 7, v53
  v_lshlrev_b32_e64 v55, 7, v55
  v_add_u32_dpp v65, v52, v2 row_newbcast:0 row_mask:0xf bank_mask:0x3
  s_nop 1
  v_add_u32_dpp v65, v54, v2 row_newbcast:6 row_mask:0xf bank_mask:0xc
  s_add_u32 m0, s76, 18432
  s_nop 0
  buffer_load_dwordx4 v65, s[32:35], 0 offen lds
  v_add_u32_dpp v56, v17, v2 row_newbcast:0 row_mask:0xf bank_mask:0x3
  s_nop 1
  v_add_u32_dpp v56, v19, v2 row_newbcast:6 row_mask:0xf bank_mask:0xc
  s_add_u32 m0, s76, 40960
  s_nop 0
  buffer_load_dwordx4 v56, s[32:35], 0 offen lds
  v_add_u32_dpp v57, v21, v2 row_newbcast:0 row_mask:0xf bank_mask:0x3
  s_nop 1
  v_add_u32_dpp v57, v23, v2 row_newbcast:6 row_mask:0xf bank_mask:0xc
  s_add_u32 m0, s76, 43008
  s_nop 0
  buffer_load_dwordx4 v57, s[32:35], 0 offen lds
  v_add_u32_dpp v58, v25, v2 row_newbcast:0 row_mask:0xf bank_mask:0x3
  s_nop 1
  v_add_u32_dpp v58, v27, v2 row_newbcast:6 row_mask:0xf bank_mask:0xc
  s_add_u32 m0, s76, 45056
  s_nop 0
  buffer_load_dwordx4 v58, s[32:35], 0 offen lds
  v_add_u32_dpp v59, v29, v2 row_newbcast:0 row_mask:0xf bank_mask:0x3
  s_nop 1
  v_add_u32_dpp v59, v31, v2 row_newbcast:6 row_mask:0xf bank_mask:0xc
  s_add_u32 m0, s76, 47104
  s_nop 0
  buffer_load_dwordx4 v59, s[32:35], 0 offen lds
  v_add_u32_dpp v60, v33, v2 row_newbcast:0 row_mask:0xf bank_mask:0x3
  s_nop 1
  v_add_u32_dpp v60, v35, v2 row_newbcast:6 row_mask:0xf bank_mask:0xc
  s_add_u32 m0, s76, 49152
  s_nop 0
  buffer_load_dwordx4 v60, s[32:35], 0 offen lds
  s_waitcnt vmcnt(11)
  s_barrier
  v_add_u32_dpp v61, v37, v2 row_newbcast:0 row_mask:0xf bank_mask:0x3
  s_nop 1
  v_add_u32_dpp v61, v39, v2 row_newbcast:6 row_mask:0xf bank_mask:0xc
  s_add_u32 m0, s76, 51200
  s_nop 0
  buffer_load_dwordx4 v61, s[32:35], 0 offen lds
  v_add_u32_dpp v62, v41, v2 row_newbcast:0 row_mask:0xf bank_mask:0x3
  s_nop 1
  v_add_u32_dpp v62, v43, v2 row_newbcast:6 row_mask:0xf bank_mask:0xc
  s_add_u32 m0, s76, 53248
  s_nop 0
  buffer_load_dwordx4 v62, s[32:35], 0 offen lds
  v_add_u32_dpp v63, v45, v2 row_newbcast:0 row_mask:0xf bank_mask:0x3
  s_nop 1
  v_add_u32_dpp v63, v47, v2 row_newbcast:6 row_mask:0xf bank_mask:0xc
  s_add_u32 m0, s76, 55296
  s_nop 0
  buffer_load_dwordx4 v63, s[32:35], 0 offen lds
  v_add_u32_dpp v64, v49, v2 row_newbcast:0 row_mask:0xf bank_mask:0x3
  s_nop 1
  v_add_u32_dpp v64, v51, v2 row_newbcast:6 row_mask:0xf bank_mask:0xc
  s_add_u32 m0, s76, 57344
  s_nop 0
  buffer_load_dwordx4 v64, s[32:35], 0 offen lds
  v_add_u32_dpp v65, v53, v2 row_newbcast:0 row_mask:0xf bank_mask:0x3
  s_nop 1
  v_add_u32_dpp v65, v55, v2 row_newbcast:6 row_mask:0xf bank_mask:0xc
  s_add_u32 m0, s76, 59392
  s_nop 0
  buffer_load_dwordx4 v65, s[32:35], 0 offen lds
  s_waitcnt vmcnt(10)
  s_barrier
  s_add_u32 m0, s75, 147456
  s_nop 0
  buffer_load_dwordx4 v4, s[44:47], s74 offen lds
  s_add_u32 m0, s75, 148480
  s_nop 0
  buffer_load_dwordx4 v5, s[44:47], s74 offen lds
  s_add_u32 s74, s74, 106496
  s_add_u32 m0, s75, 155648
  s_nop 0
  buffer_load_dwordx4 v4, s[44:47], s74 offen lds
  s_add_u32 m0, s75, 156672
  s_nop 0
  buffer_load_dwordx4 v5, s[44:47], s74 offen lds
  s_add_u32 s74, s74, 106496
  v_add_u32_dpp v56, v18, v2 row_newbcast:0 row_mask:0xf bank_mask:0x3
  v_add_u32_dpp v57, v22, v2 row_newbcast:0 row_mask:0xf bank_mask:0x3
  v_add_u32_dpp v58, v26, v2 row_newbcast:0 row_mask:0xf bank_mask:0x3
  v_add_u32_dpp v59, v30, v2 row_newbcast:0 row_mask:0xf bank_mask:0x3
  v_add_u32_dpp v60, v34, v2 row_newbcast:0 row_mask:0xf bank_mask:0x3
  v_add_u32_dpp v61, v38, v2 row_newbcast:0 row_mask:0xf bank_mask:0x3
  v_add_u32_dpp v62, v42, v2 row_newbcast:0 row_mask:0xf bank_mask:0x3
  v_add_u32_dpp v63, v46, v2 row_newbcast:0 row_mask:0xf bank_mask:0x3
  v_add_u32_dpp v64, v50, v2 row_newbcast:0 row_mask:0xf bank_mask:0x3
  v_add_u32_dpp v65, v54, v2 row_newbcast:0 row_mask:0xf bank_mask:0x3
  v_add_u32_dpp v56, v16, v2 row_newbcast:7 row_mask:0xf bank_mask:0xc
  v_add_u32_dpp v57, v20, v2 row_newbcast:7 row_mask:0xf bank_mask:0xc
  v_add_u32_dpp v58, v24, v2 row_newbcast:7 row_mask:0xf bank_mask:0xc
  v_add_u32_dpp v59, v28, v2 row_newbcast:7 row_mask:0xf bank_mask:0xc
  v_add_u32_dpp v60, v32, v2 row_newbcast:7 row_mask:0xf bank_mask:0xc
  v_add_u32_dpp v61, v36, v2 row_newbcast:7 row_mask:0xf bank_mask:0xc
  v_add_u32_dpp v62, v40, v2 row_newbcast:7 row_mask:0xf bank_mask:0xc
  v_add_u32_dpp v63, v44, v2 row_newbcast:7 row_mask:0xf bank_mask:0xc
  v_add_u32_dpp v64, v48, v2 row_newbcast:7 row_mask:0xf bank_mask:0xc
  v_add_u32_dpp v65, v52, v2 row_newbcast:7 row_mask:0xf bank_mask:0xc
  buffer_load_dword v70, v7, s[28:31], s84 offen offset:24
  buffer_load_dword v71, v7, s[28:31], s84 offen offset:40
  buffer_load_dword v72, v7, s[28:31], s84 offen offset:56
  buffer_load_dword v73, v7, s[28:31], s84 offen offset:72
  buffer_load_dword v74, v7, s[28:31], s84 offen offset:88
  s_add_u32 m0, s76, 81920
  s_nop 0
  buffer_load_dwordx4 v56, s[32:35], 0 offen lds
  s_add_u32 m0, s76, 83968
  s_nop 0
  buffer_load_dwordx4 v57, s[32:35], 0 offen lds
  s_add_u32 m0, s76, 86016
  s_nop 0
  buffer_load_dwordx4 v58, s[32:35], 0 offen lds
  s_add_u32 m0, s76, 88064
  s_nop 0
  buffer_load_dwordx4 v59, s[32:35], 0 offen lds
  s_add_u32 m0, s76, 90112
  s_nop 0
  buffer_load_dwordx4 v60, s[32:35], 0 offen lds
  s_add_u32 m0, s76, 92160
  s_nop 0
  buffer_load_dwordx4 v61, s[32:35], 0 offen lds
  s_add_u32 m0, s76, 94208
  s_nop 0
  buffer_load_dwordx4 v62, s[32:35], 0 offen lds
  s_add_u32 m0, s76, 96256
  s_nop 0
  buffer_load_dwordx4 v63, s[32:35], 0 offen lds
  s_waitcnt vmcnt(13)
  s_barrier
  s_add_u32 m0, s76, 98304
  s_nop 0
  buffer_load_dwordx4 v64, s[32:35], 0 offen lds
  s_add_u32 m0, s76, 100352
  s_nop 0
  buffer_load_dwordx4 v65, s[32:35], 0 offen lds
  v_add_u32_dpp v56, v19, v2 row_newbcast:0 row_mask:0xf bank_mask:0x3
  v_add_u32_dpp v57, v23, v2 row_newbcast:0 row_mask:0xf bank_mask:0x3
  v_add_u32_dpp v58, v27, v2 row_newbcast:0 row_mask:0xf bank_mask:0x3
  v_add_u32_dpp v59, v31, v2 row_newbcast:0 row_mask:0xf bank_mask:0x3
  v_add_u32_dpp v60, v35, v2 row_newbcast:0 row_mask:0xf bank_mask:0x3
  v_add_u32_dpp v61, v39, v2 row_newbcast:0 row_mask:0xf bank_mask:0x3
  v_add_u32_dpp v62, v43, v2 row_newbcast:0 row_mask:0xf bank_mask:0x3
  v_add_u32_dpp v63, v47, v2 row_newbcast:0 row_mask:0xf bank_mask:0x3
  v_add_u32_dpp v64, v51, v2 row_newbcast:0 row_mask:0xf bank_mask:0x3
  v_add_u32_dpp v65, v55, v2 row_newbcast:0 row_mask:0xf bank_mask:0x3
  v_add_u32_dpp v56, v17, v2 row_newbcast:7 row_mask:0xf bank_mask:0xc
  v_add_u32_dpp v57, v21, v2 row_newbcast:7 row_mask:0xf bank_mask:0xc
  v_add_u32_dpp v58, v25, v2 row_newbcast:7 row_mask:0xf bank_mask:0xc
  v_add_u32_dpp v59, v29, v2 row_newbcast:7 row_mask:0xf bank_mask:0xc
  v_add_u32_dpp v60, v33, v2 row_newbcast:7 row_mask:0xf bank_mask:0xc
  v_add_u32_dpp v61, v37, v2 row_newbcast:7 row_mask:0xf bank_mask:0xc
  v_add_u32_dpp v62, v41, v2 row_newbcast:7 row_mask:0xf bank_mask:0xc
  v_add_u32_dpp v63, v45, v2 row_newbcast:7 row_mask:0xf bank_mask:0xc
  v_add_u32_dpp v64, v49, v2 row_newbcast:7 row_mask:0xf bank_mask:0xc
  v_add_u32_dpp v65, v53, v2 row_newbcast:7 row_mask:0xf bank_mask:0xc
  s_setprio 0
  s_branch L_ld_in
L_cmp:
  s_and_b32 s68, s3, 1
  s_lshr_b32 s69, s3, 1
  v_bfe_u32 v117, v0, 2, 2
  v_lshl_add_u32 v118, v116, 3, v117
  v_lshlrev_b32 v118, 8, v118
  v_bfe_u32 v117, v0, 2, 3
  s_lshl_b32 s70, s69, 2
  v_xor_b32 v117, s70, v117
  v_lshl_add_u32 v118, v117, 5, v118
  v_and_b32 v117, 3, v0
  v_lshl_add_u32 v118, v117, 3, v118
  v_add_u32 v1, 131072, v118
  v_xor_b32 v2, 32, v1
  v_xor_b32 v3, 64, v1
  v_xor_b32 v4, 96, v1
  s_lshl_b32 s70, s69, 7
  s_add_u32 s70, s70, 122880
  v_lshlrev_b32 v118, 3, v116
  v_add_u32 v9, s70, v118
  v_and_b32 v118, 15, v0
  v_lshlrev_b32 v118, 7, v118
  v_bfe_u32 v117, v0, 1, 3
  v_xor_b32 v117, v117, v116
  v_lshl_add_u32 v118, v117, 4, v118
  s_mul_i32 s70, s68, 20480
  v_add_u32 v5, s70, v118
  v_xor_b32 v7, 64, v5
  v_add_u32 v6, 81920, v5
  v_add_u32 v8, 81920, v7
  s_mul_i32 s70, s3, 640
  s_add_u32 s70, s70, 123392
  v_and_b32 v118, 15, v0
  v_lshlrev_b32 v118, 2, v118
  v_add_u32 v118, s70, v118
  v_lshrrev_b32 v117, 5, v0
  v_lshl_add_u32 v118, v117, 6, v118
  v_bfe_u32 v117, v0, 4, 1
  v_lshl_add_u32 v10, v117, 7, v118
  s_mov_b32 s72, 0
  v_mov_b32 v12, 0xc0135761
  v_mov_b32 v13, 0xc0135761
  v_mov_b32 v14, 0xbdd2d3e8
  v_mov_b32 v15, 0xbdd2d3e8
  s_waitcnt vmcnt(3)
  v_lshlrev_b32 v100, 7, v100
  buffer_load_dword v200, v100, s[32:35], 0 offen
  v_lshlrev_b32 v102, 7, v102
  buffer_load_dword v202, v102, s[32:35], 0 offen
  s_waitcnt vmcnt(4)
  v_lshlrev_b32_e64 v104, 7, v104
  buffer_load_dword v204, v104, s[32:35], 0 offen
  s_barrier
  ds_read_b64_tr_b16 v[16:17], v1 offset:0
  ds_read_b64_tr_b16 v[18:19], v1 offset:1024
  ds_read_b64_tr_b16 v[32:33], v1 offset:8192
  ds_read_b64_tr_b16 v[34:35], v1 offset:9216
  ds_read_b64_tr_b16 v[20:21], v2 offset:0
  ds_read_b64_tr_b16 v[22:23], v2 offset:1024
  ds_read_b64_tr_b16 v[36:37], v2 offset:8192
  ds_read_b64_tr_b16 v[38:39], v2 offset:9216
  ds_read_b64_tr_b16 v[24:25], v3 offset:0
  ds_read_b64_tr_b16 v[26:27], v3 offset:1024
  ds_read_b64_tr_b16 v[40:41], v3 offset:8192
  ds_read_b64_tr_b16 v[42:43], v3 offset:9216
  ds_read_b64_tr_b16 v[28:29], v4 offset:0
  ds_read_b64_tr_b16 v[30:31], v4 offset:1024
  ds_read_b64_tr_b16 v[44:45], v4 offset:8192
  ds_read_b64_tr_b16 v[46:47], v4 offset:9216
  s_waitcnt vmcnt(4)
  ds_read_b64 v[234:235], v9 offset:0
  ds_read_b64 v[238:239], v9 offset:32
  ds_read_b64 v[242:243], v9 offset:64
  ds_read_b64 v[246:247], v9 offset:96
  s_waitcnt lgkmcnt(3)
  v_lshlrev_b32 v232, 16, v234
  v_and_b32 v233, 0xffff0000, v234
  v_lshlrev_b32 v234, 16, v235
  v_and_b32 v235, 0xffff0000, v235
  s_waitcnt lgkmcnt(2)
  v_lshlrev_b32 v236, 16, v238
  v_and_b32 v237, 0xffff0000, v238
  v_lshlrev_b32 v238, 16, v239
  v_and_b32 v239, 0xffff0000, v239
  s_waitcnt lgkmcnt(1)
  v_lshlrev_b32 v240, 16, v242
  v_and_b32 v241, 0xffff0000, v242
  v_lshlrev_b32 v242, 16, v243
  v_and_b32 v243, 0xffff0000, v243
  s_waitcnt lgkmcnt(0)
  v_lshlrev_b32 v244, 16, v246
  v_and_b32 v245, 0xffff0000, v246
  v_lshlrev_b32 v246, 16, v247
  v_and_b32 v247, 0xffff0000, v247
  v_mov_b64 v[216:217], v[232:233]
  v_mov_b64 v[218:219], v[234:235]
  v_mov_b64 v[220:221], v[236:237]
  v_mov_b64 v[222:223], v[238:239]
  v_mov_b64 v[224:225], v[240:241]
  v_mov_b64 v[226:227], v[242:243]
  v_mov_b64 v[228:229], v[244:245]
  v_mov_b64 v[230:231], v[246:247]
  s_waitcnt lgkmcnt(0)
  s_setprio 1
  s_barrier
  ds_read_b128 v[48:51], v5 offset:0
  ds_read_b128 v[52:55], v7 offset:0
  ds_read_b128 v[56:59], v5 offset:2048
  ds_read_b128 v[60:63], v7 offset:2048
  ds_read_b128 v[64:67], v5 offset:4096
  ds_read_b128 v[68:71], v7 offset:4096
  ds_read_b128 v[72:75], v5 offset:6144
  ds_read_b128 v[76:79], v7 offset:6144
  s_waitcnt lgkmcnt(7)
  v_mfma_f32_16x16x32_bf16 v[88:91], v[16:19], v[48:51], v[232:235]
  s_waitcnt lgkmcnt(4)
  v_mfma_f32_16x16x32_bf16 v[88:91], v[32:35], v[52:55], v[88:91]
  v_mfma_f32_16x16x32_bf16 v[104:107], v[32:35], v[60:63], v[232:235]
  v_mfma_f32_16x16x32_bf16 v[104:107], v[16:19], v[56:59], v[104:107]
  v_mfma_f32_16x16x32_bf16 v[108:111], v[20:23], v[56:59], v[236:239]
  v_mfma_f32_16x16x32_bf16 v[108:111], v[36:39], v[60:63], v[108:111]
  v_mfma_f32_16x16x32_bf16 v[92:95], v[36:39], v[52:55], v[236:239]
  v_mfma_f32_16x16x32_bf16 v[92:95], v[20:23], v[48:51], v[92:95]
  v_mfma_f32_16x16x32_bf16 v[96:99], v[24:27], v[48:51], v[240:243]
  v_xor_b32 v1, 16384, v1
  v_mfma_f32_16x16x32_bf16 v[96:99], v[40:43], v[52:55], v[96:99]
  v_xor_b32 v2, 16384, v2
  v_mfma_f32_16x16x32_bf16 v[112:115], v[40:43], v[60:63], v[240:243]
  v_xor_b32 v3, 16384, v3
  v_mfma_f32_16x16x32_bf16 v[112:115], v[24:27], v[56:59], v[112:115]
  v_xor_b32 v4, 16384, v4
  v_mfma_f32_16x16x32_bf16 v[116:119], v[28:31], v[56:59], v[244:247]
  v_mfma_f32_16x16x32_bf16 v[116:119], v[44:47], v[60:63], v[116:119]
  v_mfma_f32_16x16x32_bf16 v[100:103], v[44:47], v[52:55], v[244:247]
  s_waitcnt lgkmcnt(2)
  v_mfma_f32_16x16x32_bf16 v[100:103], v[28:31], v[48:51], v[100:103]
  v_mfma_f32_16x16x32_bf16 v[120:123], v[16:19], v[64:67], v[232:235]
  s_barrier
  s_waitcnt lgkmcnt(0)
  v_mfma_f32_16x16x32_bf16 v[120:123], v[32:35], v[68:71], v[120:123]
  ds_read_b128 v[80:83], v5 offset:8192
  v_mfma_f32_16x16x32_bf16 v[136:139], v[32:35], v[76:79], v[232:235]
  s_nop 0
  ds_read_b128 v[84:87], v7 offset:8192
  v_mfma_f32_16x16x32_bf16 v[136:139], v[16:19], v[72:75], v[136:139]
  ds_read_b128 v[48:51], v5 offset:10240
  v_mfma_f32_16x16x32_bf16 v[140:143], v[20:23], v[72:75], v[236:239]
  ds_read_b128 v[52:55], v7 offset:10240
  v_mfma_f32_16x16x32_bf16 v[140:143], v[36:39], v[76:79], v[140:143]
  ds_read_b128 v[56:59], v5 offset:12288
  v_mfma_f32_16x16x32_bf16 v[124:127], v[36:39], v[68:71], v[236:239]
  ds_read_b128 v[60:63], v7 offset:12288
  v_mfma_f32_16x16x32_bf16 v[124:127], v[20:23], v[64:67], v[124:127]
  v_mfma_f32_16x16x32_bf16 v[128:131], v[24:27], v[64:67], v[240:243]
  v_mfma_f32_16x16x32_bf16 v[128:131], v[40:43], v[68:71], v[128:131]
  v_mfma_f32_16x16x32_bf16 v[144:147], v[40:43], v[76:79], v[240:243]
  v_mfma_f32_16x16x32_bf16 v[144:147], v[24:27], v[72:75], v[144:147]
  v_mfma_f32_16x16x32_bf16 v[148:151], v[28:31], v[72:75], v[244:247]
  ds_read_b128 v[72:75], v5 offset:16384
  v_mfma_f32_16x16x32_bf16 v[148:151], v[44:47], v[76:79], v[148:151]
  ds_read_b128 v[76:79], v7 offset:16384
  v_mfma_f32_16x16x32_bf16 v[132:135], v[44:47], v[68:71], v[244:247]
  ds_read_b128 v[68:71], v7 offset:14336
  s_waitcnt lgkmcnt(7)
  v_mfma_f32_16x16x32_bf16 v[132:135], v[28:31], v[64:67], v[132:135]
  ds_read_b128 v[64:67], v5 offset:14336
  v_mfma_f32_16x16x32_bf16 v[152:155], v[16:19], v[80:83], v[232:235]
  s_waitcnt lgkmcnt(6)
  v_mfma_f32_16x16x32_bf16 v[152:155], v[32:35], v[84:87], v[152:155]
  v_mfma_f32_16x16x32_bf16 v[168:171], v[32:35], v[52:55], v[232:235]
  v_mfma_f32_16x16x32_bf16 v[168:171], v[16:19], v[48:51], v[168:171]
  v_mfma_f32_16x16x32_bf16 v[172:175], v[20:23], v[48:51], v[236:239]
  v_mfma_f32_16x16x32_bf16 v[172:175], v[36:39], v[52:55], v[172:175]
  v_mfma_f32_16x16x32_bf16 v[156:159], v[36:39], v[84:87], v[236:239]
  v_mfma_f32_16x16x32_bf16 v[156:159], v[20:23], v[80:83], v[156:159]
  v_mfma_f32_16x16x32_bf16 v[160:163], v[24:27], v[80:83], v[240:243]
  v_mfma_f32_16x16x32_bf16 v[160:163], v[40:43], v[84:87], v[160:163]
  v_mfma_f32_16x16x32_bf16 v[176:179], v[40:43], v[52:55], v[240:243]
  v_mfma_f32_16x16x32_bf16 v[176:179], v[24:27], v[48:51], v[176:179]
  v_mfma_f32_16x16x32_bf16 v[180:183], v[28:31], v[48:51], v[244:247]
  v_mfma_f32_16x16x32_bf16 v[180:183], v[44:47], v[52:55], v[180:183]
  v_mfma_f32_16x16x32_bf16 v[164:167], v[44:47], v[84:87], v[244:247]
  ds_read_b128 v[84:87], v7 offset:18432
  s_waitcnt lgkmcnt(5)
  v_mfma_f32_16x16x32_bf16 v[164:167], v[28:31], v[80:83], v[164:167]
  s_nop 0
  ds_read_b128 v[80:83], v5 offset:18432
  v_mfma_f32_16x16x32_bf16 v[184:187], v[16:19], v[56:59], v[232:235]
  s_waitcnt lgkmcnt(2)
  v_mfma_f32_16x16x32_bf16 v[184:187], v[32:35], v[60:63], v[184:187]
  s_waitcnt vmcnt(1)
  v_mfma_f32_16x16x32_bf16 v[200:203], v[32:35], v[68:71], v[232:235]
  v_mfma_f32_16x16x32_bf16 v[200:203], v[16:19], v[64:67], v[200:203]
  s_waitcnt vmcnt(0)
  v_mfma_f32_16x16x32_bf16 v[204:207], v[20:23], v[64:67], v[236:239]
  s_nop 0
  v_mfma_f32_16x16x32_bf16 v[204:207], v[36:39], v[68:71], v[204:207]
  s_waitcnt lgkmcnt(0)
  s_barrier
  v_mfma_f32_16x16x32_bf16 v[188:191], v[36:39], v[60:63], v[236:239]
  ds_read_b128 v[48:51], v5 offset:40960
  v_mfma_f32_16x16x32_bf16 v[188:191], v[20:23], v[56:59], v[188:191]
  ds_read_b128 v[52:55], v7 offset:40960
  v_mfma_f32_16x16x32_bf16 v[192:195], v[24:27], v[56:59], v[240:243]
  v_mfma_f32_16x16x32_bf16 v[192:195], v[40:43], v[60:63], v[192:195]
  v_mfma_f32_16x16x32_bf16 v[208:211], v[40:43], v[68:71], v[240:243]
  v_mfma_f32_16x16x32_bf16 v[208:211], v[24:27], v[64:67], v[208:211]
  v_mfma_f32_16x16x32_bf16 v[212:215], v[28:31], v[64:67], v[244:247]
  ds_read_b128 v[64:67], v5 offset:45056
  v_mfma_f32_16x16x32_bf16 v[212:215], v[44:47], v[68:71], v[212:215]
  ds_read_b128 v[68:71], v7 offset:45056
  v_mfma_f32_16x16x32_bf16 v[196:199], v[44:47], v[60:63], v[244:247]
  ds_read_b128 v[60:63], v7 offset:43008
  v_mfma_f32_16x16x32_bf16 v[196:199], v[28:31], v[56:59], v[196:199]
  ds_read_b128 v[56:59], v5 offset:43008
  v_mfma_f32_16x16x32_bf16 v[216:219], v[32:35], v[76:79], v[216:219]
  v_mfma_f32_16x16x32_bf16 v[216:219], v[16:19], v[72:75], v[216:219]
  v_mfma_f32_16x16x32_bf16 v[232:235], v[16:19], v[80:83], v[232:235]
  ds_read_b64_tr_b16 v[16:17], v1 offset:0
  v_mfma_f32_16x16x32_bf16 v[232:235], v[32:35], v[84:87], v[232:235]
  ds_read_b64_tr_b16 v[18:19], v1 offset:1024
  v_mfma_f32_16x16x32_bf16 v[236:239], v[36:39], v[84:87], v[236:239]
  ds_read_b64_tr_b16 v[32:33], v1 offset:8192
  v_mfma_f32_16x16x32_bf16 v[236:239], v[20:23], v[80:83], v[236:239]
  ds_read_b64_tr_b16 v[34:35], v1 offset:9216
  v_mfma_f32_16x16x32_bf16 v[220:223], v[20:23], v[72:75], v[220:223]
  ds_read_b64_tr_b16 v[20:21], v2 offset:0
  v_mfma_f32_16x16x32_bf16 v[220:223], v[36:39], v[76:79], v[220:223]
  ds_read_b64_tr_b16 v[22:23], v2 offset:1024
  v_mfma_f32_16x16x32_bf16 v[224:227], v[40:43], v[76:79], v[224:227]
  ds_read_b64_tr_b16 v[36:37], v2 offset:8192
  v_mfma_f32_16x16x32_bf16 v[224:227], v[24:27], v[72:75], v[224:227]
  ds_read_b64_tr_b16 v[38:39], v2 offset:9216
  v_mfma_f32_16x16x32_bf16 v[240:243], v[24:27], v[80:83], v[240:243]
  ds_read_b64_tr_b16 v[24:25], v3 offset:0
  v_mfma_f32_16x16x32_bf16 v[240:243], v[40:43], v[84:87], v[240:243]
  ds_read_b64_tr_b16 v[26:27], v3 offset:1024
  v_mfma_f32_16x16x32_bf16 v[244:247], v[44:47], v[84:87], v[244:247]
  ds_read_b64_tr_b16 v[40:41], v3 offset:8192
  v_mfma_f32_16x16x32_bf16 v[244:247], v[28:31], v[80:83], v[244:247]
  s_nop 0
  ds_read_b64_tr_b16 v[42:43], v3 offset:9216
  v_mfma_f32_16x16x32_bf16 v[228:231], v[28:31], v[72:75], v[228:231]
  ds_read_b64_tr_b16 v[28:29], v4 offset:0
  s_waitcnt lgkmcnt(9)
  v_mfma_f32_16x16x32_bf16 v[228:231], v[44:47], v[76:79], v[228:231]
  ds_read_b64_tr_b16 v[30:31], v4 offset:1024
L_dnn_loop0:
  v_mfma_f32_16x16x32_bf16 v[88:91], v[16:19], v[48:51], v[88:91]
  ds_read_b64_tr_b16 v[44:45], v4 offset:8192
  v_mfma_f32_16x16x32_bf16 v[88:91], v[32:35], v[52:55], v[88:91]
  s_nop 0
  ds_read_b64_tr_b16 v[46:47], v4 offset:9216
  v_mfma_f32_16x16x32_bf16 v[104:107], v[32:35], v[60:63], v[104:107]
  ds_read_b128 v[72:75], v5 offset:47104
  s_waitcnt lgkmcnt(9)
  v_mfma_f32_16x16x32_bf16 v[104:107], v[16:19], v[56:59], v[104:107]
  ds_read_b128 v[76:79], v7 offset:47104
  v_mfma_f32_16x16x32_bf16 v[108:111], v[20:23], v[56:59], v[108:111]
  ds_read_b128 v[80:83], v5 offset:49152
  v_mfma_f32_16x16x32_bf16 v[108:111], v[36:39], v[60:63], v[108:111]
  ds_read_b128 v[84:87], v7 offset:49152
  v_mfma_f32_16x16x32_bf16 v[92:95], v[36:39], v[52:55], v[92:95]
  s_nop 0
  s_waitcnt lgkmcnt(8)
  v_mfma_f32_16x16x32_bf16 v[92:95], v[20:23], v[48:51], v[92:95]
  v_mfma_f32_16x16x32_bf16 v[96:99], v[24:27], v[48:51], v[96:99]
  v_xor_b32 v1, 16384, v1
  v_mfma_f32_16x16x32_bf16 v[96:99], v[40:43], v[52:55], v[96:99]
  v_xor_b32 v2, 16384, v2
  v_mfma_f32_16x16x32_bf16 v[112:115], v[40:43], v[60:63], v[112:115]
  s_nop 0
  v_xor_b32 v3, 16384, v3
  s_waitcnt lgkmcnt(4)
  v_mfma_f32_16x16x32_bf16 v[112:115], v[24:27], v[56:59], v[112:115]
  v_xor_b32 v4, 16384, v4
  v_mfma_f32_16x16x32_bf16 v[116:119], v[28:31], v[56:59], v[116:119]
  ds_read_b128 v[56:59], v5 offset:53248
  v_mfma_f32_16x16x32_bf16 v[116:119], v[44:47], v[60:63], v[116:119]
  ds_read_b128 v[60:63], v7 offset:53248
  v_mfma_f32_16x16x32_bf16 v[100:103], v[44:47], v[52:55], v[100:103]
  ds_read_b128 v[52:55], v7 offset:51200
  v_mfma_f32_16x16x32_bf16 v[100:103], v[28:31], v[48:51], v[100:103]
  ds_read_b128 v[48:51], v5 offset:51200
  v_mfma_f32_16x16x32_bf16 v[120:123], v[16:19], v[64:67], v[120:123]
  s_waitcnt lgkmcnt(6)
  v_mfma_f32_16x16x32_bf16 v[120:123], v[32:35], v[68:71], v[120:123]
  v_mfma_f32_16x16x32_bf16 v[136:139], v[32:35], v[76:79], v[136:139]
  v_mfma_f32_16x16x32_bf16 v[136:139], v[16:19], v[72:75], v[136:139]
  v_mfma_f32_16x16x32_bf16 v[140:143], v[20:23], v[72:75], v[140:143]
  s_nop 0
  v_mfma_f32_16x16x32_bf16 v[140:143], v[36:39], v[76:79], v[140:143]
  v_mfma_f32_16x16x32_bf16 v[124:127], v[36:39], v[68:71], v[124:127]
  v_mfma_f32_16x16x32_bf16 v[124:127], v[20:23], v[64:67], v[124:127]
  v_mfma_f32_16x16x32_bf16 v[128:131], v[24:27], v[64:67], v[128:131]
  v_mfma_f32_16x16x32_bf16 v[128:131], v[40:43], v[68:71], v[128:131]
  v_mfma_f32_16x16x32_bf16 v[144:147], v[40:43], v[76:79], v[144:147]
  v_mfma_f32_16x16x32_bf16 v[144:147], v[24:27], v[72:75], v[144:147]
  v_mfma_f32_16x16x32_bf16 v[148:151], v[28:31], v[72:75], v[148:151]
  ds_read_b128 v[72:75], v5 offset:57344
  v_mfma_f32_16x16x32_bf16 v[148:151], v[44:47], v[76:79], v[148:151]
  ds_read_b128 v[76:79], v7 offset:57344
  v_mfma_f32_16x16x32_bf16 v[132:135], v[44:47], v[68:71], v[132:135]
  ds_read_b128 v[68:71], v7 offset:55296
  s_waitcnt lgkmcnt(7)
  v_mfma_f32_16x16x32_bf16 v[132:135], v[28:31], v[64:67], v[132:135]
  s_nop 0
  ds_read_b128 v[64:67], v5 offset:55296
  v_mfma_f32_16x16x32_bf16 v[152:155], v[16:19], v[80:83], v[152:155]
  s_waitcnt lgkmcnt(4)
  v_mfma_f32_16x16x32_bf16 v[152:155], v[32:35], v[84:87], v[152:155]
  v_mfma_f32_16x16x32_bf16 v[168:171], v[32:35], v[52:55], v[168:171]
  v_mfma_f32_16x16x32_bf16 v[168:171], v[16:19], v[48:51], v[168:171]
  v_mfma_f32_16x16x32_bf16 v[172:175], v[20:23], v[48:51], v[172:175]
  v_mfma_f32_16x16x32_bf16 v[172:175], v[36:39], v[52:55], v[172:175]
  v_mfma_f32_16x16x32_bf16 v[156:159], v[36:39], v[84:87], v[156:159]
  s_nop 0
  v_mfma_f32_16x16x32_bf16 v[156:159], v[20:23], v[80:83], v[156:159]
  v_mfma_f32_16x16x32_bf16 v[160:163], v[24:27], v[80:83], v[160:163]
  v_mfma_f32_16x16x32_bf16 v[160:163], v[40:43], v[84:87], v[160:163]
  v_mfma_f32_16x16x32_bf16 v[176:179], v[40:43], v[52:55], v[176:179]
  v_mfma_f32_16x16x32_bf16 v[176:179], v[24:27], v[48:51], v[176:179]
  v_mfma_f32_16x16x32_bf16 v[180:183], v[28:31], v[48:51], v[180:183]
  v_mfma_f32_16x16x32_bf16 v[180:183], v[44:47], v[52:55], v[180:183]
  v_mfma_f32_16x16x32_bf16 v[164:167], v[44:47], v[84:87], v[164:167]
  ds_read_b128 v[84:87], v7 offset:59392
  v_mfma_f32_16x16x32_bf16 v[164:167], v[28:31], v[80:83], v[164:167]
  ds_read_b128 v[80:83], v5 offset:59392
  v_mfma_f32_16x16x32_bf16 v[184:187], v[16:19], v[56:59], v[184:187]
  s_waitcnt lgkmcnt(2)
  v_mfma_f32_16x16x32_bf16 v[184:187], v[32:35], v[60:63], v[184:187]
  v_mfma_f32_16x16x32_bf16 v[200:203], v[32:35], v[68:71], v[200:203]
  v_mfma_f32_16x16x32_bf16 v[200:203], v[16:19], v[64:67], v[200:203]
  s_nop 0
  v_mfma_f32_16x16x32_bf16 v[204:207], v[20:23], v[64:67], v[204:207]
  v_mfma_f32_16x16x32_bf16 v[204:207], v[36:39], v[68:71], v[204:207]
  s_waitcnt lgkmcnt(0)
  s_barrier
  v_mfma_f32_16x16x32_bf16 v[188:191], v[36:39], v[60:63], v[188:191]
  ds_read_b128 v[48:51], v6 offset:0
  v_mfma_f32_16x16x32_bf16 v[188:191], v[20:23], v[56:59], v[188:191]
  ds_read_b128 v[52:55], v8 offset:0
  v_mfma_f32_16x16x32_bf16 v[192:195], v[24:27], v[56:59], v[192:195]
  v_mfma_f32_16x16x32_bf16 v[192:195], v[40:43], v[60:63], v[192:195]
  v_mfma_f32_16x16x32_bf16 v[208:211], v[40:43], v[68:71], v[208:211]
  v_mfma_f32_16x16x32_bf16 v[208:211], v[24:27], v[64:67], v[208:211]
  v_mfma_f32_16x16x32_bf16 v[212:215], v[28:31], v[64:67], v[212:215]
  ds_read_b128 v[64:67], v6 offset:4096
  v_mfma_f32_16x16x32_bf16 v[212:215], v[44:47], v[68:71], v[212:215]
  ds_read_b128 v[68:71], v8 offset:4096
  v_mfma_f32_16x16x32_bf16 v[196:199], v[44:47], v[60:63], v[196:199]
  ds_read_b128 v[60:63], v8 offset:2048
  v_mfma_f32_16x16x32_bf16 v[196:199], v[28:31], v[56:59], v[196:199]
  ds_read_b128 v[56:59], v6 offset:2048
  v_mfma_f32_16x16x32_bf16 v[216:219], v[32:35], v[76:79], v[216:219]
  v_mfma_f32_16x16x32_bf16 v[216:219], v[16:19], v[72:75], v[216:219]
  v_mfma_f32_16x16x32_bf16 v[232:235], v[16:19], v[80:83], v[232:235]
  ds_read_b64_tr_b16 v[16:17], v1 offset:0
  v_mfma_f32_16x16x32_bf16 v[232:235], v[32:35], v[84:87], v[232:235]
  ds_read_b64_tr_b16 v[18:19], v1 offset:1024
  v_mfma_f32_16x16x32_bf16 v[236:239], v[36:39], v[84:87], v[236:239]
  ds_read_b64_tr_b16 v[32:33], v1 offset:8192
  v_mfma_f32_16x16x32_bf16 v[236:239], v[20:23], v[80:83], v[236:239]
  ds_read_b64_tr_b16 v[34:35], v1 offset:9216
  v_mfma_f32_16x16x32_bf16 v[220:223], v[20:23], v[72:75], v[220:223]
  ds_read_b64_tr_b16 v[20:21], v2 offset:0
  v_mfma_f32_16x16x32_bf16 v[220:223], v[36:39], v[76:79], v[220:223]
  ds_read_b64_tr_b16 v[22:23], v2 offset:1024
  v_mfma_f32_16x16x32_bf16 v[224:227], v[40:43], v[76:79], v[224:227]
  ds_read_b64_tr_b16 v[36:37], v2 offset:8192
  v_mfma_f32_16x16x32_bf16 v[224:227], v[24:27], v[72:75], v[224:227]
  ds_read_b64_tr_b16 v[38:39], v2 offset:9216
  v_mfma_f32_16x16x32_bf16 v[240:243], v[24:27], v[80:83], v[240:243]
  ds_read_b64_tr_b16 v[24:25], v3 offset:0
  v_mfma_f32_16x16x32_bf16 v[240:243], v[40:43], v[84:87], v[240:243]
  ds_read_b64_tr_b16 v[26:27], v3 offset:1024
  v_mfma_f32_16x16x32_bf16 v[244:247], v[44:47], v[84:87], v[244:247]
  ds_read_b64_tr_b16 v[40:41], v3 offset:8192
  v_mfma_f32_16x16x32_bf16 v[244:247], v[28:31], v[80:83], v[244:247]
  s_nop 0
  ds_read_b64_tr_b16 v[42:43], v3 offset:9216
  v_mfma_f32_16x16x32_bf16 v[228:231], v[28:31], v[72:75], v[228:231]
  ds_read_b64_tr_b16 v[28:29], v4 offset:0
  s_waitcnt lgkmcnt(9)
  v_mfma_f32_16x16x32_bf16 v[228:231], v[44:47], v[76:79], v[228:231]
  ds_read_b64_tr_b16 v[30:31], v4 offset:1024
  v_mfma_f32_16x16x32_bf16 v[88:91], v[16:19], v[48:51], v[88:91]
  ds_read_b64_tr_b16 v[44:45], v4 offset:8192
  v_mfma_f32_16x16x32_bf16 v[88:91], v[32:35], v[52:55], v[88:91]
  ds_read_b64_tr_b16 v[46:47], v4 offset:9216
  v_mfma_f32_16x16x32_bf16 v[104:107], v[32:35], v[60:63], v[104:107]
  ds_read_b128 v[72:75], v6 offset:6144
  s_waitcnt lgkmcnt(9)
  v_mfma_f32_16x16x32_bf16 v[104:107], v[16:19], v[56:59], v[104:107]
  ds_read_b128 v[76:79], v8 offset:6144
  v_mfma_f32_16x16x32_bf16 v[108:111], v[20:23], v[56:59], v[108:111]
  ds_read_b128 v[80:83], v6 offset:8192
  v_mfma_f32_16x16x32_bf16 v[108:111], v[36:39], v[60:63], v[108:111]
  ds_read_b128 v[84:87], v8 offset:8192
  v_mfma_f32_16x16x32_bf16 v[92:95], v[36:39], v[52:55], v[92:95]
  s_waitcnt lgkmcnt(8)
  v_mfma_f32_16x16x32_bf16 v[92:95], v[20:23], v[48:51], v[92:95]
  v_mfma_f32_16x16x32_bf16 v[96:99], v[24:27], v[48:51], v[96:99]
  v_xor_b32 v1, 16384, v1
  v_mfma_f32_16x16x32_bf16 v[96:99], v[40:43], v[52:55], v[96:99]
  v_xor_b32 v2, 16384, v2
  v_mfma_f32_16x16x32_bf16 v[112:115], v[40:43], v[60:63], v[112:115]
  s_nop 0
  v_xor_b32 v3, 16384, v3
  s_waitcnt lgkmcnt(4)
  v_mfma_f32_16x16x32_bf16 v[112:115], v[24:27], v[56:59], v[112:115]
  v_xor_b32 v4, 16384, v4
  v_mfma_f32_16x16x32_bf16 v[116:119], v[28:31], v[56:59], v[116:119]
  ds_read_b128 v[56:59], v6 offset:12288
  v_mfma_f32_16x16x32_bf16 v[116:119], v[44:47], v[60:63], v[116:119]
  ds_read_b128 v[60:63], v8 offset:12288
  v_mfma_f32_16x16x32_bf16 v[100:103], v[44:47], v[52:55], v[100:103]
  ds_read_b128 v[52:55], v8 offset:10240
  v_mfma_f32_16x16x32_bf16 v[100:103], v[28:31], v[48:51], v[100:103]
  ds_read_b128 v[48:51], v6 offset:10240
  v_mfma_f32_16x16x32_bf16 v[120:123], v[16:19], v[64:67], v[120:123]
  s_waitcnt lgkmcnt(6)
  v_mfma_f32_16x16x32_bf16 v[120:123], v[32:35], v[68:71], v[120:123]
  v_mfma_f32_16x16x32_bf16 v[136:139], v[32:35], v[76:79], v[136:139]
  v_mfma_f32_16x16x32_bf16 v[136:139], v[16:19], v[72:75], v[136:139]
  v_mfma_f32_16x16x32_bf16 v[140:143], v[20:23], v[72:75], v[140:143]
  s_nop 0
  v_mfma_f32_16x16x32_bf16 v[140:143], v[36:39], v[76:79], v[140:143]
  v_mfma_f32_16x16x32_bf16 v[124:127], v[36:39], v[68:71], v[124:127]
  v_mfma_f32_16x16x32_bf16 v[124:127], v[20:23], v[64:67], v[124:127]
  v_mfma_f32_16x16x32_bf16 v[128:131], v[24:27], v[64:67], v[128:131]
  v_mfma_f32_16x16x32_bf16 v[128:131], v[40:43], v[68:71], v[128:131]
  v_mfma_f32_16x16x32_bf16 v[144:147], v[40:43], v[76:79], v[144:147]
  v_mfma_f32_16x16x32_bf16 v[144:147], v[24:27], v[72:75], v[144:147]
  v_mfma_f32_16x16x32_bf16 v[148:151], v[28:31], v[72:75], v[148:151]
  ds_read_b128 v[72:75], v6 offset:16384
  v_mfma_f32_16x16x32_bf16 v[148:151], v[44:47], v[76:79], v[148:151]
  ds_read_b128 v[76:79], v8 offset:16384
  v_mfma_f32_16x16x32_bf16 v[132:135], v[44:47], v[68:71], v[132:135]
  ds_read_b128 v[68:71], v8 offset:14336
  s_waitcnt lgkmcnt(7)
  v_mfma_f32_16x16x32_bf16 v[132:135], v[28:31], v[64:67], v[132:135]
  s_nop 0
  ds_read_b128 v[64:67], v6 offset:14336
  v_mfma_f32_16x16x32_bf16 v[152:155], v[16:19], v[80:83], v[152:155]
  s_waitcnt lgkmcnt(4)
  v_mfma_f32_16x16x32_bf16 v[152:155], v[32:35], v[84:87], v[152:155]
  v_mfma_f32_16x16x32_bf16 v[168:171], v[32:35], v[52:55], v[168:171]
  v_mfma_f32_16x16x32_bf16 v[168:171], v[16:19], v[48:51], v[168:171]
  v_mfma_f32_16x16x32_bf16 v[172:175], v[20:23], v[48:51], v[172:175]
  v_mfma_f32_16x16x32_bf16 v[172:175], v[36:39], v[52:55], v[172:175]
  v_mfma_f32_16x16x32_bf16 v[156:159], v[36:39], v[84:87], v[156:159]
  s_nop 0
  v_mfma_f32_16x16x32_bf16 v[156:159], v[20:23], v[80:83], v[156:159]
  v_mfma_f32_16x16x32_bf16 v[160:163], v[24:27], v[80:83], v[160:163]
  v_mfma_f32_16x16x32_bf16 v[160:163], v[40:43], v[84:87], v[160:163]
  v_mfma_f32_16x16x32_bf16 v[176:179], v[40:43], v[52:55], v[176:179]
  v_mfma_f32_16x16x32_bf16 v[176:179], v[24:27], v[48:51], v[176:179]
  v_mfma_f32_16x16x32_bf16 v[180:183], v[28:31], v[48:51], v[180:183]
  v_mfma_f32_16x16x32_bf16 v[180:183], v[44:47], v[52:55], v[180:183]
  v_mfma_f32_16x16x32_bf16 v[164:167], v[44:47], v[84:87], v[164:167]
  ds_read_b128 v[84:87], v8 offset:18432
  v_mfma_f32_16x16x32_bf16 v[164:167], v[28:31], v[80:83], v[164:167]
  ds_read_b128 v[80:83], v6 offset:18432
  v_mfma_f32_16x16x32_bf16 v[184:187], v[16:19], v[56:59], v[184:187]
  s_waitcnt lgkmcnt(2)
  v_mfma_f32_16x16x32_bf16 v[184:187], v[32:35], v[60:63], v[184:187]
  v_mfma_f32_16x16x32_bf16 v[200:203], v[32:35], v[68:71], v[200:203]
  v_mfma_f32_16x16x32_bf16 v[200:203], v[16:19], v[64:67], v[200:203]
  s_nop 0
  v_mfma_f32_16x16x32_bf16 v[204:207], v[20:23], v[64:67], v[204:207]
  v_mfma_f32_16x16x32_bf16 v[204:207], v[36:39], v[68:71], v[204:207]
  s_waitcnt lgkmcnt(0)
  s_barrier
  v_mfma_f32_16x16x32_bf16 v[188:191], v[36:39], v[60:63], v[188:191]
  ds_read_b128 v[48:51], v5 offset:0
  v_mfma_f32_16x16x32_bf16 v[188:191], v[20:23], v[56:59], v[188:191]
  ds_read_b128 v[52:55], v7 offset:0
  v_mfma_f32_16x16x32_bf16 v[192:195], v[24:27], v[56:59], v[192:195]
  v_mfma_f32_16x16x32_bf16 v[192:195], v[40:43], v[60:63], v[192:195]
  v_mfma_f32_16x16x32_bf16 v[208:211], v[40:43], v[68:71], v[208:211]
  v_mfma_f32_16x16x32_bf16 v[208:211], v[24:27], v[64:67], v[208:211]
  v_mfma_f32_16x16x32_bf16 v[212:215], v[28:31], v[64:67], v[212:215]
  ds_read_b128 v[64:67], v5 offset:4096
  v_mfma_f32_16x16x32_bf16 v[212:215], v[44:47], v[68:71], v[212:215]
  ds_read_b128 v[68:71], v7 offset:4096
  v_mfma_f32_16x16x32_bf16 v[196:199], v[44:47], v[60:63], v[196:199]
  ds_read_b128 v[60:63], v7 offset:2048
  v_mfma_f32_16x16x32_bf16 v[196:199], v[28:31], v[56:59], v[196:199]
  ds_read_b128 v[56:59], v5 offset:2048
  v_mfma_f32_16x16x32_bf16 v[216:219], v[32:35], v[76:79], v[216:219]
  v_mfma_f32_16x16x32_bf16 v[216:219], v[16:19], v[72:75], v[216:219]
  v_mfma_f32_16x16x32_bf16 v[232:235], v[16:19], v[80:83], v[232:235]
  ds_read_b64_tr_b16 v[16:17], v1 offset:0
  v_mfma_f32_16x16x32_bf16 v[232:235], v[32:35], v[84:87], v[232:235]
  ds_read_b64_tr_b16 v[18:19], v1 offset:1024
  v_mfma_f32_16x16x32_bf16 v[236:239], v[36:39], v[84:87], v[236:239]
  ds_read_b64_tr_b16 v[32:33], v1 offset:8192
  v_mfma_f32_16x16x32_bf16 v[236:239], v[20:23], v[80:83], v[236:239]
  ds_read_b64_tr_b16 v[34:35], v1 offset:9216
  v_mfma_f32_16x16x32_bf16 v[220:223], v[20:23], v[72:75], v[220:223]
  ds_read_b64_tr_b16 v[20:21], v2 offset:0
  v_mfma_f32_16x16x32_bf16 v[220:223], v[36:39], v[76:79], v[220:223]
  ds_read_b64_tr_b16 v[22:23], v2 offset:1024
  v_mfma_f32_16x16x32_bf16 v[224:227], v[40:43], v[76:79], v[224:227]
  ds_read_b64_tr_b16 v[36:37], v2 offset:8192
  v_mfma_f32_16x16x32_bf16 v[224:227], v[24:27], v[72:75], v[224:227]
  ds_read_b64_tr_b16 v[38:39], v2 offset:9216
  v_mfma_f32_16x16x32_bf16 v[240:243], v[24:27], v[80:83], v[240:243]
  ds_read_b64_tr_b16 v[24:25], v3 offset:0
  v_mfma_f32_16x16x32_bf16 v[240:243], v[40:43], v[84:87], v[240:243]
  ds_read_b64_tr_b16 v[26:27], v3 offset:1024
  v_mfma_f32_16x16x32_bf16 v[244:247], v[44:47], v[84:87], v[244:247]
  ds_read_b64_tr_b16 v[40:41], v3 offset:8192
  v_mfma_f32_16x16x32_bf16 v[244:247], v[28:31], v[80:83], v[244:247]
  s_nop 0
  ds_read_b64_tr_b16 v[42:43], v3 offset:9216
  v_mfma_f32_16x16x32_bf16 v[228:231], v[28:31], v[72:75], v[228:231]
  ds_read_b64_tr_b16 v[28:29], v4 offset:0
  s_waitcnt lgkmcnt(9)
  v_mfma_f32_16x16x32_bf16 v[228:231], v[44:47], v[76:79], v[228:231]
  ds_read_b64_tr_b16 v[30:31], v4 offset:1024
  v_mfma_f32_16x16x32_bf16 v[88:91], v[16:19], v[48:51], v[88:91]
  ds_read_b64_tr_b16 v[44:45], v4 offset:8192
  v_mfma_f32_16x16x32_bf16 v[88:91], v[32:35], v[52:55], v[88:91]
  ds_read_b64_tr_b16 v[46:47], v4 offset:9216
  v_mfma_f32_16x16x32_bf16 v[104:107], v[32:35], v[60:63], v[104:107]
  ds_read_b128 v[72:75], v5 offset:6144
  s_waitcnt lgkmcnt(9)
  v_mfma_f32_16x16x32_bf16 v[104:107], v[16:19], v[56:59], v[104:107]
  ds_read_b128 v[76:79], v7 offset:6144
  v_mfma_f32_16x16x32_bf16 v[108:111], v[20:23], v[56:59], v[108:111]
  ds_read_b128 v[80:83], v5 offset:8192
  v_mfma_f32_16x16x32_bf16 v[108:111], v[36:39], v[60:63], v[108:111]
  ds_read_b128 v[84:87], v7 offset:8192
  v_mfma_f32_16x16x32_bf16 v[92:95], v[36:39], v[52:55], v[92:95]
  s_waitcnt lgkmcnt(8)
  v_mfma_f32_16x16x32_bf16 v[92:95], v[20:23], v[48:51], v[92:95]
  v_mfma_f32_16x16x32_bf16 v[96:99], v[24:27], v[48:51], v[96:99]
  v_xor_b32 v1, 16384, v1
  v_mfma_f32_16x16x32_bf16 v[96:99], v[40:43], v[52:55], v[96:99]
  v_xor_b32 v2, 16384, v2
  v_mfma_f32_16x16x32_bf16 v[112:115], v[40:43], v[60:63], v[112:115]
  s_nop 0
  v_xor_b32 v3, 16384, v3
  s_waitcnt lgkmcnt(4)
  v_mfma_f32_16x16x32_bf16 v[112:115], v[24:27], v[56:59], v[112:115]
  v_xor_b32 v4, 16384, v4
  v_mfma_f32_16x16x32_bf16 v[116:119], v[28:31], v[56:59], v[116:119]
  ds_read_b128 v[56:59], v5 offset:12288
  v_mfma_f32_16x16x32_bf16 v[116:119], v[44:47], v[60:63], v[116:119]
  ds_read_b128 v[60:63], v7 offset:12288
  v_mfma_f32_16x16x32_bf16 v[100:103], v[44:47], v[52:55], v[100:103]
  ds_read_b128 v[52:55], v7 offset:10240
  v_mfma_f32_16x16x32_bf16 v[100:103], v[28:31], v[48:51], v[100:103]
  ds_read_b128 v[48:51], v5 offset:10240
  v_mfma_f32_16x16x32_bf16 v[120:123], v[16:19], v[64:67], v[120:123]
  s_waitcnt lgkmcnt(6)
  v_mfma_f32_16x16x32_bf16 v[120:123], v[32:35], v[68:71], v[120:123]
  v_mfma_f32_16x16x32_bf16 v[136:139], v[32:35], v[76:79], v[136:139]
  v_mfma_f32_16x16x32_bf16 v[136:139], v[16:19], v[72:75], v[136:139]
  v_mfma_f32_16x16x32_bf16 v[140:143], v[20:23], v[72:75], v[140:143]
  s_nop 0
  v_mfma_f32_16x16x32_bf16 v[140:143], v[36:39], v[76:79], v[140:143]
  v_mfma_f32_16x16x32_bf16 v[124:127], v[36:39], v[68:71], v[124:127]
  v_mfma_f32_16x16x32_bf16 v[124:127], v[20:23], v[64:67], v[124:127]
  v_mfma_f32_16x16x32_bf16 v[128:131], v[24:27], v[64:67], v[128:131]
  v_mfma_f32_16x16x32_bf16 v[128:131], v[40:43], v[68:71], v[128:131]
  v_mfma_f32_16x16x32_bf16 v[144:147], v[40:43], v[76:79], v[144:147]
  v_mfma_f32_16x16x32_bf16 v[144:147], v[24:27], v[72:75], v[144:147]
  v_mfma_f32_16x16x32_bf16 v[148:151], v[28:31], v[72:75], v[148:151]
  ds_read_b128 v[72:75], v5 offset:16384
  v_mfma_f32_16x16x32_bf16 v[148:151], v[44:47], v[76:79], v[148:151]
  ds_read_b128 v[76:79], v7 offset:16384
  v_mfma_f32_16x16x32_bf16 v[132:135], v[44:47], v[68:71], v[132:135]
  ds_read_b128 v[68:71], v7 offset:14336
  s_waitcnt lgkmcnt(7)
  v_mfma_f32_16x16x32_bf16 v[132:135], v[28:31], v[64:67], v[132:135]
  s_nop 0
  ds_read_b128 v[64:67], v5 offset:14336
  v_mfma_f32_16x16x32_bf16 v[152:155], v[16:19], v[80:83], v[152:155]
  s_waitcnt lgkmcnt(4)
  v_mfma_f32_16x16x32_bf16 v[152:155], v[32:35], v[84:87], v[152:155]
  v_mfma_f32_16x16x32_bf16 v[168:171], v[32:35], v[52:55], v[168:171]
  v_mfma_f32_16x16x32_bf16 v[168:171], v[16:19], v[48:51], v[168:171]
  v_mfma_f32_16x16x32_bf16 v[172:175], v[20:23], v[48:51], v[172:175]
  v_mfma_f32_16x16x32_bf16 v[172:175], v[36:39], v[52:55], v[172:175]
  v_mfma_f32_16x16x32_bf16 v[156:159], v[36:39], v[84:87], v[156:159]
  s_nop 0
  v_mfma_f32_16x16x32_bf16 v[156:159], v[20:23], v[80:83], v[156:159]
  v_mfma_f32_16x16x32_bf16 v[160:163], v[24:27], v[80:83], v[160:163]
  v_mfma_f32_16x16x32_bf16 v[160:163], v[40:43], v[84:87], v[160:163]
  v_mfma_f32_16x16x32_bf16 v[176:179], v[40:43], v[52:55], v[176:179]
  v_mfma_f32_16x16x32_bf16 v[176:179], v[24:27], v[48:51], v[176:179]
  v_mfma_f32_16x16x32_bf16 v[180:183], v[28:31], v[48:51], v[180:183]
  v_mfma_f32_16x16x32_bf16 v[180:183], v[44:47], v[52:55], v[180:183]
  v_mfma_f32_16x16x32_bf16 v[164:167], v[44:47], v[84:87], v[164:167]
  ds_read_b128 v[84:87], v7 offset:18432
  v_mfma_f32_16x16x32_bf16 v[164:167], v[28:31], v[80:83], v[164:167]
  ds_read_b128 v[80:83], v5 offset:18432
  v_mfma_f32_16x16x32_bf16 v[184:187], v[16:19], v[56:59], v[184:187]
  s_waitcnt lgkmcnt(2)
  s_add_u32 s72, s72, 1
  s_cmp_lt_u32 s72, 8
  v_mfma_f32_16x16x32_bf16 v[184:187], v[32:35], v[60:63], v[184:187]
  v_mfma_f32_16x16x32_bf16 v[200:203], v[32:35], v[68:71], v[200:203]
  s_nop 0
  v_mfma_f32_16x16x32_bf16 v[200:203], v[16:19], v[64:67], v[200:203]
  v_mfma_f32_16x16x32_bf16 v[204:207], v[20:23], v[64:67], v[204:207]
  v_mfma_f32_16x16x32_bf16 v[204:207], v[36:39], v[68:71], v[204:207]
  s_waitcnt lgkmcnt(0)
  s_barrier
  v_mfma_f32_16x16x32_bf16 v[188:191], v[36:39], v[60:63], v[188:191]
  ds_read_b128 v[48:51], v5 offset:40960
  v_mfma_f32_16x16x32_bf16 v[188:191], v[20:23], v[56:59], v[188:191]
  ds_read_b128 v[52:55], v7 offset:40960
  v_mfma_f32_16x16x32_bf16 v[192:195], v[24:27], v[56:59], v[192:195]
  v_mfma_f32_16x16x32_bf16 v[192:195], v[40:43], v[60:63], v[192:195]
  v_mfma_f32_16x16x32_bf16 v[208:211], v[40:43], v[68:71], v[208:211]
  v_mfma_f32_16x16x32_bf16 v[208:211], v[24:27], v[64:67], v[208:211]
  v_mfma_f32_16x16x32_bf16 v[212:215], v[28:31], v[64:67], v[212:215]
  ds_read_b128 v[64:67], v5 offset:45056
  v_mfma_f32_16x16x32_bf16 v[212:215], v[44:47], v[68:71], v[212:215]
  ds_read_b128 v[68:71], v7 offset:45056
  v_mfma_f32_16x16x32_bf16 v[196:199], v[44:47], v[60:63], v[196:199]
  ds_read_b128 v[60:63], v7 offset:43008
  v_mfma_f32_16x16x32_bf16 v[196:199], v[28:31], v[56:59], v[196:199]
  ds_read_b128 v[56:59], v5 offset:43008
  v_mfma_f32_16x16x32_bf16 v[216:219], v[32:35], v[76:79], v[216:219]
  v_mfma_f32_16x16x32_bf16 v[216:219], v[16:19], v[72:75], v[216:219]
  v_mfma_f32_16x16x32_bf16 v[232:235], v[16:19], v[80:83], v[232:235]
  ds_read_b64_tr_b16 v[16:17], v1 offset:0
  v_mfma_f32_16x16x32_bf16 v[232:235], v[32:35], v[84:87], v[232:235]
  ds_read_b64_tr_b16 v[18:19], v1 offset:1024
  v_mfma_f32_16x16x32_bf16 v[236:239], v[36:39], v[84:87], v[236:239]
  ds_read_b64_tr_b16 v[32:33], v1 offset:8192
  v_mfma_f32_16x16x32_bf16 v[236:239], v[20:23], v[80:83], v[236:239]
  ds_read_b64_tr_b16 v[34:35], v1 offset:9216
  v_mfma_f32_16x16x32_bf16 v[220:223], v[20:23], v[72:75], v[220:223]
  ds_read_b64_tr_b16 v[20:21], v2 offset:0
  v_mfma_f32_16x16x32_bf16 v[220:223], v[36:39], v[76:79], v[220:223]
  ds_read_b64_tr_b16 v[22:23], v2 offset:1024
  v_mfma_f32_16x16x32_bf16 v[224:227], v[40:43], v[76:79], v[224:227]
  ds_read_b64_tr_b16 v[36:37], v2 offset:8192
  v_mfma_f32_16x16x32_bf16 v[224:227], v[24:27], v[72:75], v[224:227]
  ds_read_b64_tr_b16 v[38:39], v2 offset:9216
  v_mfma_f32_16x16x32_bf16 v[240:243], v[24:27], v[80:83], v[240:243]
  ds_read_b64_tr_b16 v[24:25], v3 offset:0
  v_mfma_f32_16x16x32_bf16 v[240:243], v[40:43], v[84:87], v[240:243]
  ds_read_b64_tr_b16 v[26:27], v3 offset:1024
  v_mfma_f32_16x16x32_bf16 v[244:247], v[44:47], v[84:87], v[244:247]
  ds_read_b64_tr_b16 v[40:41], v3 offset:8192
  v_mfma_f32_16x16x32_bf16 v[244:247], v[28:31], v[80:83], v[244:247]
  ds_read_b64_tr_b16 v[42:43], v3 offset:9216
  v_mfma_f32_16x16x32_bf16 v[228:231], v[28:31], v[72:75], v[228:231]
  ds_read_b64_tr_b16 v[28:29], v4 offset:0
  s_waitcnt lgkmcnt(9)
  v_mfma_f32_16x16x32_bf16 v[228:231], v[44:47], v[76:79], v[228:231]
  ds_read_b64_tr_b16 v[30:31], v4 offset:1024
  s_cbranch_scc1 L_dnn_loop0
L_tail:
  v_mfma_f32_16x16x32_bf16 v[88:91], v[16:19], v[48:51], v[88:91]
  ds_read_b64_tr_b16 v[44:45], v4 offset:8192
  v_mfma_f32_16x16x32_bf16 v[88:91], v[32:35], v[52:55], v[88:91]
  ds_read_b64_tr_b16 v[46:47], v4 offset:9216
  v_mfma_f32_16x16x32_bf16 v[104:107], v[32:35], v[60:63], v[104:107]
  ds_read_b128 v[72:75], v5 offset:47104
  s_waitcnt lgkmcnt(9)
  v_mfma_f32_16x16x32_bf16 v[104:107], v[16:19], v[56:59], v[104:107]
  ds_read_b128 v[76:79], v7 offset:47104
  v_mfma_f32_16x16x32_bf16 v[108:111], v[20:23], v[56:59], v[108:111]
  ds_read_b128 v[80:83], v5 offset:49152
  v_mfma_f32_16x16x32_bf16 v[108:111], v[36:39], v[60:63], v[108:111]
  ds_read_b128 v[84:87], v7 offset:49152
  v_mul_f32 v11, v88, v88
  v_mfma_f32_16x16x32_bf16 v[92:95], v[36:39], v[52:55], v[92:95]
  s_waitcnt lgkmcnt(8)
  v_mul_f32 v248, v89, v89
  v_mul_f32 v249, v90, v90
  v_mfma_f32_16x16x32_bf16 v[92:95], v[20:23], v[48:51], v[92:95]
  v_mul_f32 v250, v91, v91
  v_fma_f32 v11, v11, v14, v12
  v_mfma_f32_16x16x32_bf16 v[96:99], v[24:27], v[48:51], v[96:99]
  v_fma_f32 v248, v248, v14, v12
  v_fma_f32 v249, v249, v14, v12
  v_mfma_f32_16x16x32_bf16 v[96:99], v[40:43], v[52:55], v[96:99]
  v_fma_f32 v250, v250, v14, v12
  v_mul_f32 v11, v11, v88
  v_mfma_f32_16x16x32_bf16 v[112:115], v[40:43], v[60:63], v[112:115]
  s_waitcnt lgkmcnt(4)
  v_mul_f32 v248, v248, v89
  v_mul_f32 v249, v249, v90
  v_mfma_f32_16x16x32_bf16 v[112:115], v[24:27], v[56:59], v[112:115]
  v_mul_f32_e64 v250, v250, v91
  v_mfma_f32_16x16x32_bf16 v[116:119], v[28:31], v[56:59], v[116:119]
  ds_read_b128 v[56:59], v5 offset:53248
  v_mfma_f32_16x16x32_bf16 v[116:119], v[44:47], v[60:63], v[116:119]
  ds_read_b128 v[60:63], v7 offset:53248
  v_mfma_f32_16x16x32_bf16 v[100:103], v[44:47], v[52:55], v[100:103]
  ds_read_b128 v[52:55], v7 offset:51200
  v_mfma_f32_16x16x32_bf16 v[100:103], v[28:31], v[48:51], v[100:103]
  ds_read_b128 v[48:51], v5 offset:51200
  v_mfma_f32_16x16x32_bf16 v[120:123], v[16:19], v[64:67], v[120:123]
  s_waitcnt lgkmcnt(6)
  v_exp_f32 v11, v11
  v_mfma_f32_16x16x32_bf16 v[120:123], v[32:35], v[68:71], v[120:123]
  v_exp_f32 v248, v248
  v_mfma_f32_16x16x32_bf16 v[136:139], v[32:35], v[76:79], v[136:139]
  v_exp_f32 v249, v249
  v_mfma_f32_16x16x32_bf16 v[136:139], v[16:19], v[72:75], v[136:139]
  v_exp_f32 v250, v250
  v_mfma_f32_16x16x32_bf16 v[140:143], v[20:23], v[72:75], v[140:143]
  v_add_f32 v11, 1.0, v11
  v_add_f32_e64 v248, 1.0, v248
  v_mfma_f32_16x16x32_bf16 v[140:143], v[36:39], v[76:79], v[140:143]
  v_add_f32 v249, 1.0, v249
  v_add_f32 v250, 1.0, v250
  v_mfma_f32_16x16x32_bf16 v[124:127], v[36:39], v[68:71], v[124:127]
  v_rcp_f32 v11, v11
  v_mfma_f32_16x16x32_bf16 v[124:127], v[20:23], v[64:67], v[124:127]
  v_rcp_f32 v248, v248
  v_mfma_f32_16x16x32_bf16 v[128:131], v[24:27], v[64:67], v[128:131]
  v_rcp_f32 v249, v249
  v_mfma_f32_16x16x32_bf16 v[128:131], v[40:43], v[68:71], v[128:131]
  v_rcp_f32 v250, v250
  v_mfma_f32_16x16x32_bf16 v[144:147], v[40:43], v[76:79], v[144:147]
  v_mul_f32 v88, v88, v11
  v_mul_f32 v89, v89, v248
  v_mfma_f32_16x16x32_bf16 v[144:147], v[24:27], v[72:75], v[144:147]
  v_mul_f32 v90, v90, v249
  v_mul_f32 v91, v91, v250
  v_mfma_f32_16x16x32_bf16 v[148:151], v[28:31], v[72:75], v[148:151]
  ds_read_b128 v[72:75], v5 offset:57344
  v_mul_f32_e64 v11, v92, v92
  v_mfma_f32_16x16x32_bf16 v[148:151], v[44:47], v[76:79], v[148:151]
  ds_read_b128 v[76:79], v7 offset:57344
  v_mul_f32 v248, v93, v93
  v_mfma_f32_16x16x32_bf16 v[132:135], v[44:47], v[68:71], v[132:135]
  ds_read_b128 v[68:71], v7 offset:55296
  s_waitcnt lgkmcnt(7)
  v_mul_f32 v249, v94, v94
  v_mfma_f32_16x16x32_bf16 v[132:135], v[28:31], v[64:67], v[132:135]
  ds_read_b128 v[64:67], v5 offset:55296
  v_mul_f32 v250, v95, v95
  v_mfma_f32_16x16x32_bf16 v[152:155], v[16:19], v[80:83], v[152:155]
  s_waitcnt lgkmcnt(4)
  v_fma_f32 v11, v11, v14, v12
  v_fma_f32 v248, v248, v14, v12
  v_mfma_f32_16x16x32_bf16 v[152:155], v[32:35], v[84:87], v[152:155]
  v_fma_f32 v249, v249, v14, v12
  v_fma_f32 v250, v250, v14, v12
  v_mfma_f32_16x16x32_bf16 v[168:171], v[32:35], v[52:55], v[168:171]
  v_mul_f32 v11, v11, v92
  v_mul_f32_e64 v248, v248, v93
  v_mfma_f32_16x16x32_bf16 v[168:171], v[16:19], v[48:51], v[168:171]
  v_mul_f32 v249, v249, v94
  v_mul_f32 v250, v250, v95
  v_mfma_f32_16x16x32_bf16 v[172:175], v[20:23], v[48:51], v[172:175]
  v_exp_f32 v11, v11
  v_mfma_f32_16x16x32_bf16 v[172:175], v[36:39], v[52:55], v[172:175]
  v_exp_f32 v248, v248
  v_mfma_f32_16x16x32_bf16 v[156:159], v[36:39], v[84:87], v[156:159]
  v_exp_f32 v249, v249
  v_mfma_f32_16x16x32_bf16 v[156:159], v[20:23], v[80:83], v[156:159]
  v_exp_f32 v250, v250
  v_mfma_f32_16x16x32_bf16 v[160:163], v[24:27], v[80:83], v[160:163]
  v_add_f32 v11, 1.0, v11
  v_add_f32 v248, 1.0, v248
  v_mfma_f32_16x16x32_bf16 v[160:163], v[40:43], v[84:87], v[160:163]
  v_add_f32 v249, 1.0, v249
  v_add_f32 v250, 1.0, v250
  v_mfma_f32_16x16x32_bf16 v[176:179], v[40:43], v[52:55], v[176:179]
  v_rcp_f32 v11, v11
  v_mfma_f32_16x16x32_bf16 v[176:179], v[24:27], v[48:51], v[176:179]
  v_rcp_f32 v248, v248
  v_mfma_f32_16x16x32_bf16 v[180:183], v[28:31], v[48:51], v[180:183]
  v_rcp_f32 v249, v249
  v_mfma_f32_16x16x32_bf16 v[180:183], v[44:47], v[52:55], v[180:183]
  v_rcp_f32 v250, v250
  v_mfma_f32_16x16x32_bf16 v[164:167], v[44:47], v[84:87], v[164:167]
  ds_read_b128 v[84:87], v7 offset:59392
  v_mul_f32 v92, v92, v11
  v_mfma_f32_16x16x32_bf16 v[164:167], v[28:31], v[80:83], v[164:167]
  ds_read_b128 v[80:83], v5 offset:59392
  v_mul_f32 v93, v93, v248
  v_mfma_f32_16x16x32_bf16 v[184:187], v[16:19], v[56:59], v[184:187]
  s_waitcnt lgkmcnt(2)
  v_mul_f32 v94, v94, v249
  v_mul_f32 v95, v95, v250
  v_mfma_f32_16x16x32_bf16 v[184:187], v[32:35], v[60:63], v[184:187]
  v_mul_f32 v11, v96, v96
  v_mul_f32 v248, v97, v97
  v_mfma_f32_16x16x32_bf16 v[200:203], v[32:35], v[68:71], v[200:203]
  v_mul_f32 v249, v98, v98
  v_mul_f32_e64 v250, v99, v99
  v_mfma_f32_16x16x32_bf16 v[200:203], v[16:19], v[64:67], v[200:203]
  v_fma_f32 v11, v11, v14, v12
  v_fma_f32 v248, v248, v14, v12
  v_mfma_f32_16x16x32_bf16 v[204:207], v[20:23], v[64:67], v[204:207]
  v_fma_f32 v249, v249, v14, v12
  v_fma_f32 v250, v250, v14, v12
  v_mfma_f32_16x16x32_bf16 v[204:207], v[36:39], v[68:71], v[204:207]
  v_mul_f32 v11, v11, v96
  v_mul_f32 v248, v248, v97
  v_mfma_f32_16x16x32_bf16 v[188:191], v[36:39], v[60:63], v[188:191]
  v_mul_f32 v249, v249, v98
  v_mul_f32 v250, v250, v99
  v_mfma_f32_16x16x32_bf16 v[188:191], v[20:23], v[56:59], v[188:191]
  v_exp_f32 v11, v11
  v_mfma_f32_16x16x32_bf16 v[192:195], v[24:27], v[56:59], v[192:195]
  v_exp_f32 v248, v248
  v_mfma_f32_16x16x32_bf16 v[192:195], v[40:43], v[60:63], v[192:195]
  v_exp_f32 v249, v249
  v_mfma_f32_16x16x32_bf16 v[208:211], v[40:43], v[68:71], v[208:211]
  v_exp_f32 v250, v250
  v_mfma_f32_16x16x32_bf16 v[208:211], v[24:27], v[64:67], v[208:211]
  v_add_f32 v11, 1.0, v11
  v_add_f32 v248, 1.0, v248
  v_mfma_f32_16x16x32_bf16 v[212:215], v[28:31], v[64:67], v[212:215]
  v_add_f32 v249, 1.0, v249
  v_add_f32 v250, 1.0, v250
  v_mfma_f32_16x16x32_bf16 v[212:215], v[44:47], v[68:71], v[212:215]
  v_rcp_f32 v11, v11
  v_mfma_f32_16x16x32_bf16 v[196:199], v[44:47], v[60:63], v[196:199]
  v_rcp_f32 v248, v248
  v_mfma_f32_16x16x32_bf16 v[196:199], v[28:31], v[56:59], v[196:199]
  v_rcp_f32 v249, v249
  v_mfma_f32_16x16x32_bf16 v[216:219], v[32:35], v[76:79], v[216:219]
  s_waitcnt lgkmcnt(0)
  v_rcp_f32 v250, v250
  v_mfma_f32_16x16x32_bf16 v[216:219], v[16:19], v[72:75], v[216:219]
  v_mul_f32 v96, v96, v11
  v_mul_f32 v97, v97, v248
  v_mfma_f32_16x16x32_bf16 v[232:235], v[16:19], v[80:83], v[232:235]
  v_mul_f32 v98, v98, v249
  v_mul_f32 v99, v99, v250
  v_mfma_f32_16x16x32_bf16 v[232:235], v[32:35], v[84:87], v[232:235]
  v_mul_f32 v11, v100, v100
  v_mul_f32 v248, v101, v101
  v_mfma_f32_16x16x32_bf16 v[236:239], v[36:39], v[84:87], v[236:239]
  v_mul_f32 v249, v102, v102
  v_mul_f32 v250, v103, v103
  v_mfma_f32_16x16x32_bf16 v[236:239], v[20:23], v[80:83], v[236:239]
  v_fma_f32 v11, v11, v14, v12
  v_fma_f32 v248, v248, v14, v12
  v_mfma_f32_16x16x32_bf16 v[220:223], v[20:23], v[72:75], v[220:223]
  v_fma_f32 v249, v249, v14, v12
  v_fma_f32 v250, v250, v14, v12
  v_mfma_f32_16x16x32_bf16 v[220:223], v[36:39], v[76:79], v[220:223]
  v_mul_f32 v11, v11, v100
  v_mul_f32 v248, v248, v101
  v_mfma_f32_16x16x32_bf16 v[224:227], v[40:43], v[76:79], v[224:227]
  v_mul_f32 v249, v249, v102
  v_mul_f32 v250, v250, v103
  v_mfma_f32_16x16x32_bf16 v[224:227], v[24:27], v[72:75], v[224:227]
  v_exp_f32 v11, v11
  v_mfma_f32_16x16x32_bf16 v[240:243], v[24:27], v[80:83], v[240:243]
  v_exp_f32 v248, v248
  v_mfma_f32_16x16x32_bf16 v[240:243], v[40:43], v[84:87], v[240:243]
  v_exp_f32 v249, v249
  v_mfma_f32_16x16x32_bf16 v[244:247], v[44:47], v[84:87], v[244:247]
  v_exp_f32 v250, v250
  v_mfma_f32_16x16x32_bf16 v[244:247], v[28:31], v[80:83], v[244:247]
  v_add_f32 v11, 1.0, v11
  v_add_f32 v248, 1.0, v248
  v_mfma_f32_16x16x32_bf16 v[228:231], v[28:31], v[72:75], v[228:231]
  v_add_f32 v249, 1.0, v249
  v_add_f32 v250, 1.0, v250
  v_mfma_f32_16x16x32_bf16 v[228:231], v[44:47], v[76:79], v[228:231]
  v_rcp_f32 v11, v11
  v_rcp_f32 v248, v248
  v_rcp_f32 v249, v249
  v_rcp_f32 v250, v250
  v_mul_f32 v100, v100, v11
  v_mul_f32 v101, v101, v248
  v_mul_f32 v102, v102, v249
  v_mul_f32 v103, v103, v250
  ds_read_b64 v[18:19], v9 offset:256
  ds_read_b64 v[22:23], v9 offset:288
  ds_read_b64 v[26:27], v9 offset:320
  ds_read_b64 v[30:31], v9 offset:352
  v_mov_b32 v248, 1.0
  v_mov_b32_e64 v249, 1.0
L_epi:
  v_mov_b32 v84, 0xc1c00000
  v_mov_b32 v85, 0xc1c00000
  v_mov_b32 v86, 0x4b800000
  v_mov_b32 v87, 0x4b800000
  v_pk_mul_f32 v[52:53], v[104:105], v[104:105]
  v_pk_mul_f32 v[56:57], v[106:107], v[106:107]
  v_pk_mul_f32 v[60:61], v[108:109], v[108:109]
  v_pk_mul_f32 v[64:65], v[110:111], v[110:111]
  v_pk_mul_f32 v[68:69], v[120:121], v[120:121]
  v_pk_mul_f32 v[72:73], v[122:123], v[122:123]
  v_pk_mul_f32 v[76:77], v[124:125], v[124:125]
  v_pk_mul_f32 v[80:81], v[126:127], v[126:127]
  v_pk_fma_f32 v[52:53], v[52:53], v[14:15], v[12:13]
  v_pk_fma_f32 v[56:57], v[56:57], v[14:15], v[12:13]
  v_pk_fma_f32 v[60:61], v[60:61], v[14:15], v[12:13]
  v_pk_fma_f32 v[64:65], v[64:65], v[14:15], v[12:13]
  v_pk_fma_f32 v[68:69], v[68:69], v[14:15], v[12:13]
  v_pk_fma_f32 v[72:73], v[72:73], v[14:15], v[12:13]
  v_pk_fma_f32 v[76:77], v[76:77], v[14:15], v[12:13]
  v_pk_fma_f32 v[80:81], v[80:81], v[14:15], v[12:13]
  v_pk_fma_f32 v[52:53], v[52:53], v[104:105], v[84:85]
  v_pk_fma_f32 v[56:57], v[56:57], v[106:107], v[84:85]
  v_pk_fma_f32 v[60:61], v[60:61], v[108:109], v[84:85]
  v_pk_fma_f32 v[64:65], v[64:65], v[110:111], v[84:85]
  v_pk_fma_f32 v[68:69], v[68:69], v[120:121], v[84:85]
  v_pk_fma_f32 v[72:73], v[72:73], v[122:123], v[84:85]
  v_pk_fma_f32 v[76:77], v[76:77], v[124:125], v[84:85]
  v_pk_fma_f32 v[80:81], v[80:81], v[126:127], v[84:85]
  v_exp_f32 v52, v52 clamp
  v_exp_f32 v53, v53 clamp
  v_exp_f32 v56, v56 clamp
  v_exp_f32 v57, v57 clamp
  v_exp_f32 v60, v60 clamp
  v_exp_f32 v61, v61 clamp
  v_exp_f32 v64, v64 clamp
  v_exp_f32 v65, v65 clamp
  v_exp_f32 v68, v68 clamp
  v_exp_f32 v69, v69 clamp
  v_exp_f32 v72, v72 clamp
  v_exp_f32 v73, v73 clamp
  v_exp_f32 v76, v76 clamp
  v_exp_f32 v77, v77 clamp
  v_exp_f32 v80, v80 clamp
  v_exp_f32 v81, v81 clamp
  s_waitcnt lgkmcnt(3)
  v_lshlrev_b32 v16, 16, v18
  v_and_b32 v17, 0xffff0000, v18
  v_lshlrev_b32 v18, 16, v19
  v_and_b32 v19, 0xffff0000, v19
  s_waitcnt lgkmcnt(2)
  v_lshlrev_b32_e64 v20, 16, v22
  v_and_b32 v21, 0xffff0000, v22
  v_lshlrev_b32 v22, 16, v23
  v_and_b32 v23, 0xffff0000, v23
  s_waitcnt lgkmcnt(1)
  v_lshlrev_b32 v24, 16, v26
  v_and_b32 v25, 0xffff0000, v26
  v_lshlrev_b32 v26, 16, v27
  v_and_b32 v27, 0xffff0000, v27
  s_waitcnt lgkmcnt(0)
  v_lshlrev_b32 v28, 16, v30
  v_and_b32 v29, 0xffff0000, v30
  v_lshlrev_b32_e64 v30, 16, v31
  v_and_b32 v31, 0xffff0000, v31
  v_pk_mul_f32 v[54:55], v[104:105], v[16:17]
  v_pk_mul_f32 v[58:59], v[106:107], v[18:19]
  v_pk_mul_f32 v[62:63], v[108:109], v[20:21]
  v_pk_mul_f32 v[66:67], v[110:111], v[22:23]
  v_pk_mul_f32 v[70:71], v[120:121], v[16:17]
  v_pk_mul_f32 v[74:75], v[122:123], v[18:19]
  v_pk_mul_f32 v[78:79], v[124:125], v[20:21]
  v_pk_mul_f32 v[82:83], v[126:127], v[22:23]
  v_pk_fma_f32 v[52:53], v[52:53], v[86:87], v[248:249]
  v_pk_fma_f32 v[56:57], v[56:57], v[86:87], v[248:249]
  v_pk_fma_f32 v[60:61], v[60:61], v[86:87], v[248:249]
  v_pk_fma_f32 v[64:65], v[64:65], v[86:87], v[248:249]
  v_pk_fma_f32 v[68:69], v[68:69], v[86:87], v[248:249]
  v_pk_fma_f32 v[72:73], v[72:73], v[86:87], v[248:249]
  v_pk_fma_f32 v[76:77], v[76:77], v[86:87], v[248:249]
  v_pk_fma_f32 v[80:81], v[80:81], v[86:87], v[248:249]
  v_pk_mul_f32 v[54:55], v[54:55], v[56:57]
  v_pk_mul_f32 v[62:63], v[62:63], v[64:65]
  v_pk_mul_f32 v[70:71], v[70:71], v[72:73]
  v_pk_mul_f32 v[78:79], v[78:79], v[80:81]
  v_pk_fma_f32 v[54:55], v[58:59], v[52:53], v[54:55]
  v_pk_fma_f32 v[62:63], v[66:67], v[60:61], v[62:63]
  v_pk_fma_f32 v[70:71], v[74:75], v[68:69], v[70:71]
  v_pk_fma_f32 v[78:79], v[82:83], v[76:77], v[78:79]
  v_pk_mul_f32 v[52:53], v[52:53], v[56:57]
  v_pk_mul_f32 v[60:61], v[60:61], v[64:65]
  v_pk_mul_f32 v[68:69], v[68:69], v[72:73]
  v_pk_mul_f32 v[76:77], v[76:77], v[80:81]
  v_pk_mul_f32 v[54:55], v[54:55], v[60:61]
  v_pk_mul_f32 v[70:71], v[70:71], v[76:77]
  v_pk_fma_f32 v[54:55], v[62:63], v[52:53], v[54:55]
  v_pk_fma_f32 v[70:71], v[78:79], v[68:69], v[70:71]
  v_pk_mul_f32 v[52:53], v[52:53], v[60:61]
  v_pk_mul_f32 v[68:69], v[68:69], v[76:77]
  v_rcp_f32 v52, v52
  v_rcp_f32 v53, v53
  v_rcp_f32 v68, v68
  v_rcp_f32 v69, v69
  v_pk_mul_f32 v[34:35], v[52:53], v[54:55]
  v_pk_mul_f32 v[36:37], v[68:69], v[70:71]
  v_pk_mul_f32 v[52:53], v[112:113], v[112:113]
  v_pk_mul_f32 v[56:57], v[114:115], v[114:115]
  v_pk_mul_f32 v[60:61], v[116:117], v[116:117]
  v_pk_mul_f32 v[64:65], v[118:119], v[118:119]
  v_pk_mul_f32 v[68:69], v[128:129], v[128:129]
  v_pk_mul_f32 v[72:73], v[130:131], v[130:131]
  v_pk_mul_f32 v[76:77], v[132:133], v[132:133]
  v_pk_mul_f32 v[80:81], v[134:135], v[134:135]
  v_pk_fma_f32 v[52:53], v[52:53], v[14:15], v[12:13]
  v_pk_fma_f32 v[56:57], v[56:57], v[14:15], v[12:13]
  v_pk_fma_f32 v[60:61], v[60:61], v[14:15], v[12:13]
  v_pk_fma_f32 v[64:65], v[64:65], v[14:15], v[12:13]
  v_pk_fma_f32 v[68:69], v[68:69], v[14:15], v[12:13]
  v_pk_fma_f32 v[72:73], v[72:73], v[14:15], v[12:13]
  v_pk_fma_f32 v[76:77], v[76:77], v[14:15], v[12:13]
  v_pk_fma_f32 v[80:81], v[80:81], v[14:15], v[12:13]
  v_pk_fma_f32 v[52:53], v[52:53], v[112:113], v[84:85]
  v_pk_fma_f32 v[56:57], v[56:57], v[114:115], v[84:85]
  v_pk_fma_f32 v[60:61], v[60:61], v[116:117], v[84:85]
  v_pk_fma_f32 v[64:65], v[64:65], v[118:119], v[84:85]
  v_pk_fma_f32 v[68:69], v[68:69], v[128:129], v[84:85]
  v_pk_fma_f32 v[72:73], v[72:73], v[130:131], v[84:85]
  v_pk_fma_f32 v[76:77], v[76:77], v[132:133], v[84:85]
  v_pk_fma_f32 v[80:81], v[80:81], v[134:135], v[84:85]
  v_exp_f32 v52, v52 clamp
  v_exp_f32 v53, v53 clamp
  v_exp_f32 v56, v56 clamp
  v_exp_f32 v57, v57 clamp
  v_exp_f32 v60, v60 clamp
  v_exp_f32 v61, v61 clamp
  v_exp_f32 v64, v64 clamp
  v_exp_f32 v65, v65 clamp
  v_exp_f32 v68, v68 clamp
  v_exp_f32 v69, v69 clamp
  v_exp_f32 v72, v72 clamp
  v_exp_f32 v73, v73 clamp
  v_exp_f32 v76, v76 clamp
  v_exp_f32 v77, v77 clamp
  v_exp_f32 v80, v80 clamp
  v_exp_f32 v81, v81 clamp
  v_pk_mul_f32 v[54:55], v[112:113], v[24:25]
  v_pk_mul_f32 v[58:59], v[114:115], v[26:27]
  v_pk_mul_f32 v[62:63], v[116:117], v[28:29]
  v_pk_mul_f32 v[66:67], v[118:119], v[30:31]
  v_pk_mul_f32 v[70:71], v[128:129], v[24:25]
  v_pk_mul_f32 v[74:75], v[130:131], v[26:27]
  v_pk_mul_f32 v[78:79], v[132:133], v[28:29]
  v_pk_mul_f32 v[82:83], v[134:135], v[30:31]
  v_pk_fma_f32 v[52:53], v[52:53], v[86:87], v[248:249]
  v_pk_fma_f32 v[56:57], v[56:57], v[86:87], v[248:249]
  v_pk_fma_f32 v[60:61], v[60:61], v[86:87], v[248:249]
  v_pk_fma_f32 v[64:65], v[64:65], v[86:87], v[248:249]
  v_pk_fma_f32 v[68:69], v[68:69], v[86:87], v[248:249]
  v_pk_fma_f32 v[72:73], v[72:73], v[86:87], v[248:249]
  v_pk_fma_f32 v[76:77], v[76:77], v[86:87], v[248:249]
  v_pk_fma_f32 v[80:81], v[80:81], v[86:87], v[248:249]
  v_pk_mul_f32 v[54:55], v[54:55], v[56:57]
  v_pk_mul_f32 v[62:63], v[62:63], v[64:65]
  v_pk_mul_f32 v[70:71], v[70:71], v[72:73]
  v_pk_mul_f32 v[78:79], v[78:79], v[80:81]
  v_pk_fma_f32 v[54:55], v[58:59], v[52:53], v[54:55]
  v_pk_fma_f32 v[62:63], v[66:67], v[60:61], v[62:63]
  v_pk_fma_f32 v[70:71], v[74:75], v[68:69], v[70:71]
  v_pk_fma_f32 v[78:79], v[82:83], v[76:77], v[78:79]
  v_pk_mul_f32 v[52:53], v[52:53], v[56:57]
  v_pk_mul_f32 v[60:61], v[60:61], v[64:65]
  v_pk_mul_f32 v[68:69], v[68:69], v[72:73]
  v_pk_mul_f32 v[76:77], v[76:77], v[80:81]
  v_pk_mul_f32 v[54:55], v[54:55], v[60:61]
  v_pk_mul_f32 v[70:71], v[70:71], v[76:77]
  v_pk_fma_f32 v[54:55], v[62:63], v[52:53], v[54:55]
  v_pk_fma_f32 v[70:71], v[78:79], v[68:69], v[70:71]
  v_pk_mul_f32 v[52:53], v[52:53], v[60:61]
  v_pk_mul_f32 v[68:69], v[68:69], v[76:77]
  v_rcp_f32 v52, v52
  v_rcp_f32 v53, v53
  v_rcp_f32 v68, v68
  v_rcp_f32 v69, v69
  v_pk_fma_f32 v[34:35], v[52:53], v[54:55], v[34:35]
  v_pk_fma_f32 v[36:37], v[68:69], v[70:71], v[36:37]
  v_pk_mul_f32 v[52:53], v[136:137], v[136:137]
  v_pk_mul_f32 v[56:57], v[138:139], v[138:139]
  v_pk_mul_f32 v[60:61], v[140:141], v[140:141]
  v_pk_mul_f32 v[64:65], v[142:143], v[142:143]
  v_pk_mul_f32 v[68:69], v[152:153], v[152:153]
  v_pk_mul_f32 v[72:73], v[154:155], v[154:155]
  v_pk_mul_f32 v[76:77], v[156:157], v[156:157]
  v_pk_mul_f32 v[80:81], v[158:159], v[158:159]
  v_pk_fma_f32 v[52:53], v[52:53], v[14:15], v[12:13]
  v_pk_fma_f32 v[56:57], v[56:57], v[14:15], v[12:13]
  v_pk_fma_f32 v[60:61], v[60:61], v[14:15], v[12:13]
  v_pk_fma_f32 v[64:65], v[64:65], v[14:15], v[12:13]
  v_pk_fma_f32 v[68:69], v[68:69], v[14:15], v[12:13]
  v_pk_fma_f32 v[72:73], v[72:73], v[14:15], v[12:13]
  v_pk_fma_f32 v[76:77], v[76:77], v[14:15], v[12:13]
  v_pk_fma_f32 v[80:81], v[80:81], v[14:15], v[12:13]
  v_pk_fma_f32 v[52:53], v[52:53], v[136:137], v[84:85]
  v_pk_fma_f32 v[56:57], v[56:57], v[138:139], v[84:85]
  v_pk_fma_f32 v[60:61], v[60:61], v[140:141], v[84:85]
  v_pk_fma_f32 v[64:65], v[64:65], v[142:143], v[84:85]
  v_pk_fma_f32 v[68:69], v[68:69], v[152:153], v[84:85]
  v_pk_fma_f32 v[72:73], v[72:73], v[154:155], v[84:85]
  v_pk_fma_f32 v[76:77], v[76:77], v[156:157], v[84:85]
  v_pk_fma_f32 v[80:81], v[80:81], v[158:159], v[84:85]
  v_exp_f32 v52, v52 clamp
  v_exp_f32 v53, v53 clamp
  v_exp_f32 v56, v56 clamp
  v_exp_f32 v57, v57 clamp
  v_exp_f32 v60, v60 clamp
  v_exp_f32 v61, v61 clamp
  v_exp_f32 v64, v64 clamp
  v_exp_f32 v65, v65 clamp
  v_exp_f32 v68, v68 clamp
  v_exp_f32 v69, v69 clamp
  v_exp_f32 v72, v72 clamp
  v_exp_f32 v73, v73 clamp
  v_exp_f32 v76, v76 clamp
  v_exp_f32 v77, v77 clamp
  v_exp_f32 v80, v80 clamp
  v_exp_f32 v81, v81 clamp
  v_pk_mul_f32 v[54:55], v[136:137], v[16:17]
  v_pk_mul_f32 v[58:59], v[138:139], v[18:19]
  v_pk_mul_f32 v[62:63], v[140:141], v[20:21]
  v_pk_mul_f32 v[66:67], v[142:143], v[22:23]
  v_pk_mul_f32 v[70:71], v[152:153], v[16:17]
  v_pk_mul_f32 v[74:75], v[154:155], v[18:19]
  v_pk_mul_f32 v[78:79], v[156:157], v[20:21]
  v_pk_mul_f32 v[82:83], v[158:159], v[22:23]
  v_pk_fma_f32 v[52:53], v[52:53], v[86:87], v[248:249]
  v_pk_fma_f32 v[56:57], v[56:57], v[86:87], v[248:249]
  v_pk_fma_f32 v[60:61], v[60:61], v[86:87], v[248:249]
  v_pk_fma_f32 v[64:65], v[64:65], v[86:87], v[248:249]
  v_pk_fma_f32 v[68:69], v[68:69], v[86:87], v[248:249]
  v_pk_fma_f32 v[72:73], v[72:73], v[86:87], v[248:249]
  v_pk_fma_f32 v[76:77], v[76:77], v[86:87], v[248:249]
  v_pk_fma_f32 v[80:81], v[80:81], v[86:87], v[248:249]
  v_pk_mul_f32 v[54:55], v[54:55], v[56:57]
  v_pk_mul_f32 v[62:63], v[62:63], v[64:65]
  v_pk_mul_f32 v[70:71], v[70:71], v[72:73]
  v_pk_mul_f32 v[78:79], v[78:79], v[80:81]
  v_pk_fma_f32 v[54:55], v[58:59], v[52:53], v[54:55]
  v_pk_fma_f32 v[62:63], v[66:67], v[60:61], v[62:63]
  v_pk_fma_f32 v[70:71], v[74:75], v[68:69], v[70:71]
  v_pk_fma_f32 v[78:79], v[82:83], v[76:77], v[78:79]
  v_pk_mul_f32 v[52:53], v[52:53], v[56:57]
  v_pk_mul_f32 v[60:61], v[60:61], v[64:65]
  v_pk_mul_f32 v[68:69], v[68:69], v[72:73]
  v_pk_mul_f32 v[76:77], v[76:77], v[80:81]
  v_pk_mul_f32 v[54:55], v[54:55], v[60:61]
  v_pk_mul_f32 v[70:71], v[70:71], v[76:77]
  v_pk_fma_f32 v[54:55], v[62:63], v[52:53], v[54:55]
  v_pk_fma_f32 v[70:71], v[78:79], v[68:69], v[70:71]
  v_pk_mul_f32 v[52:53], v[52:53], v[60:61]
  v_pk_mul_f32 v[68:69], v[68:69], v[76:77]
  v_rcp_f32 v52, v52
  v_rcp_f32 v53, v53
  v_rcp_f32 v68, v68
  v_rcp_f32 v69, v69
  v_pk_mul_f32 v[38:39], v[52:53], v[54:55]
  v_pk_mul_f32 v[40:41], v[68:69], v[70:71]
  v_pk_mul_f32 v[52:53], v[144:145], v[144:145]
  v_pk_mul_f32 v[56:57], v[146:147], v[146:147]
  v_pk_mul_f32 v[60:61], v[148:149], v[148:149]
  v_pk_mul_f32 v[64:65], v[150:151], v[150:151]
  v_pk_mul_f32 v[68:69], v[160:161], v[160:161]
  v_pk_mul_f32 v[72:73], v[162:163], v[162:163]
  v_pk_mul_f32 v[76:77], v[164:165], v[164:165]
  v_pk_mul_f32 v[80:81], v[166:167], v[166:167]
  v_pk_fma_f32 v[52:53], v[52:53], v[14:15], v[12:13]
  v_pk_fma_f32 v[56:57], v[56:57], v[14:15], v[12:13]
  v_pk_fma_f32 v[60:61], v[60:61], v[14:15], v[12:13]
  v_pk_fma_f32 v[64:65], v[64:65], v[14:15], v[12:13]
  v_pk_fma_f32 v[68:69], v[68:69], v[14:15], v[12:13]
  v_pk_fma_f32 v[72:73], v[72:73], v[14:15], v[12:13]
  v_pk_fma_f32 v[76:77], v[76:77], v[14:15], v[12:13]
  v_pk_fma_f32 v[80:81], v[80:81], v[14:15], v[12:13]
  v_pk_fma_f32 v[52:53], v[52:53], v[144:145], v[84:85]
  v_pk_fma_f32 v[56:57], v[56:57], v[146:147], v[84:85]
  v_pk_fma_f32 v[60:61], v[60:61], v[148:149], v[84:85]
  v_pk_fma_f32 v[64:65], v[64:65], v[150:151], v[84:85]
  v_pk_fma_f32 v[68:69], v[68:69], v[160:161], v[84:85]
  v_pk_fma_f32 v[72:73], v[72:73], v[162:163], v[84:85]
  v_pk_fma_f32 v[76:77], v[76:77], v[164:165], v[84:85]
  v_pk_fma_f32 v[80:81], v[80:81], v[166:167], v[84:85]
  v_exp_f32 v52, v52 clamp
  v_exp_f32 v53, v53 clamp
  v_exp_f32 v56, v56 clamp
  v_exp_f32 v57, v57 clamp
  v_exp_f32 v60, v60 clamp
  v_exp_f32 v61, v61 clamp
  v_exp_f32 v64, v64 clamp
  v_exp_f32 v65, v65 clamp
  v_exp_f32 v68, v68 clamp
  v_exp_f32 v69, v69 clamp
  v_exp_f32 v72, v72 clamp
  v_exp_f32 v73, v73 clamp
  v_exp_f32 v76, v76 clamp
  v_exp_f32 v77, v77 clamp
  v_exp_f32 v80, v80 clamp
  v_exp_f32 v81, v81 clamp
  v_pk_mul_f32 v[54:55], v[144:145], v[24:25]
  v_pk_mul_f32 v[58:59], v[146:147], v[26:27]
  v_pk_mul_f32 v[62:63], v[148:149], v[28:29]
  v_pk_mul_f32 v[66:67], v[150:151], v[30:31]
  v_pk_mul_f32 v[70:71], v[160:161], v[24:25]
  v_pk_mul_f32 v[74:75], v[162:163], v[26:27]
  v_pk_mul_f32 v[78:79], v[164:165], v[28:29]
  v_pk_mul_f32 v[82:83], v[166:167], v[30:31]
  v_pk_fma_f32 v[52:53], v[52:53], v[86:87], v[248:249]
  v_pk_fma_f32 v[56:57], v[56:57], v[86:87], v[248:249]
  v_pk_fma_f32 v[60:61], v[60:61], v[86:87], v[248:249]
  v_pk_fma_f32 v[64:65], v[64:65], v[86:87], v[248:249]
  v_pk_fma_f32 v[68:69], v[68:69], v[86:87], v[248:249]
  v_pk_fma_f32 v[72:73], v[72:73], v[86:87], v[248:249]
  v_pk_fma_f32 v[76:77], v[76:77], v[86:87], v[248:249]
  v_pk_fma_f32 v[80:81], v[80:81], v[86:87], v[248:249]
  v_pk_mul_f32 v[54:55], v[54:55], v[56:57]
  v_pk_mul_f32 v[62:63], v[62:63], v[64:65]
  v_pk_mul_f32 v[70:71], v[70:71], v[72:73]
  v_pk_mul_f32 v[78:79], v[78:79], v[80:81]
  v_pk_fma_f32 v[54:55], v[58:59], v[52:53], v[54:55]
  v_pk_fma_f32 v[62:63], v[66:67], v[60:61], v[62:63]
  v_pk_fma_f32 v[70:71], v[74:75], v[68:69], v[70:71]
  v_pk_fma_f32 v[78:79], v[82:83], v[76:77], v[78:79]
  v_pk_mul_f32 v[52:53], v[52:53], v[56:57]
  v_pk_mul_f32 v[60:61], v[60:61], v[64:65]
  v_pk_mul_f32 v[68:69], v[68:69], v[72:73]
  v_pk_mul_f32 v[76:77], v[76:77], v[80:81]
  v_pk_mul_f32 v[54:55], v[54:55], v[60:61]
  v_pk_mul_f32 v[70:71], v[70:71], v[76:77]
  v_pk_fma_f32 v[54:55], v[62:63], v[52:53], v[54:55]
  v_pk_fma_f32 v[70:71], v[78:79], v[68:69], v[70:71]
  v_pk_mul_f32 v[52:53], v[52:53], v[60:61]
  v_pk_mul_f32 v[68:69], v[68:69], v[76:77]
  v_rcp_f32 v52, v52
  v_rcp_f32 v53, v53
  v_rcp_f32 v68, v68
  v_rcp_f32 v69, v69
  v_pk_fma_f32 v[38:39], v[52:53], v[54:55], v[38:39]
  v_pk_fma_f32 v[40:41], v[68:69], v[70:71], v[40:41]
  v_pk_mul_f32 v[52:53], v[168:169], v[168:169]
  v_pk_mul_f32 v[56:57], v[170:171], v[170:171]
  v_pk_mul_f32 v[60:61], v[172:173], v[172:173]
  v_pk_mul_f32 v[64:65], v[174:175], v[174:175]
  v_pk_mul_f32 v[68:69], v[184:185], v[184:185]
  v_pk_mul_f32 v[72:73], v[186:187], v[186:187]
  v_pk_mul_f32 v[76:77], v[188:189], v[188:189]
  v_pk_mul_f32 v[80:81], v[190:191], v[190:191]
  v_pk_fma_f32 v[52:53], v[52:53], v[14:15], v[12:13]
  v_pk_fma_f32 v[56:57], v[56:57], v[14:15], v[12:13]
  v_pk_fma_f32 v[60:61], v[60:61], v[14:15], v[12:13]
  v_pk_fma_f32 v[64:65], v[64:65], v[14:15], v[12:13]
  v_pk_fma_f32 v[68:69], v[68:69], v[14:15], v[12:13]
  v_pk_fma_f32 v[72:73], v[72:73], v[14:15], v[12:13]
  v_pk_fma_f32 v[76:77], v[76:77], v[14:15], v[12:13]
  v_pk_fma_f32 v[80:81], v[80:81], v[14:15], v[12:13]
  v_pk_fma_f32 v[52:53], v[52:53], v[168:169], v[84:85]
  v_pk_fma_f32 v[56:57], v[56:57], v[170:171], v[84:85]
  v_pk_fma_f32 v[60:61], v[60:61], v[172:173], v[84:85]
  v_pk_fma_f32 v[64:65], v[64:65], v[174:175], v[84:85]
  v_pk_fma_f32 v[68:69], v[68:69], v[184:185], v[84:85]
  v_pk_fma_f32 v[72:73], v[72:73], v[186:187], v[84:85]
  v_pk_fma_f32 v[76:77], v[76:77], v[188:189], v[84:85]
  v_pk_fma_f32 v[80:81], v[80:81], v[190:191], v[84:85]
  v_exp_f32 v52, v52 clamp
  v_exp_f32 v53, v53 clamp
  v_exp_f32 v56, v56 clamp
  v_exp_f32 v57, v57 clamp
  v_exp_f32 v60, v60 clamp
  v_exp_f32 v61, v61 clamp
  v_exp_f32 v64, v64 clamp
  v_exp_f32 v65, v65 clamp
  v_exp_f32 v68, v68 clamp
  v_exp_f32 v69, v69 clamp
  v_exp_f32 v72, v72 clamp
  v_exp_f32 v73, v73 clamp
  v_exp_f32 v76, v76 clamp
  v_exp_f32 v77, v77 clamp
  v_exp_f32 v80, v80 clamp
  v_exp_f32 v81, v81 clamp
  v_pk_mul_f32 v[54:55], v[168:169], v[16:17]
  v_pk_mul_f32 v[58:59], v[170:171], v[18:19]
  v_pk_mul_f32 v[62:63], v[172:173], v[20:21]
  v_pk_mul_f32 v[66:67], v[174:175], v[22:23]
  v_pk_mul_f32 v[70:71], v[184:185], v[16:17]
  v_pk_mul_f32 v[74:75], v[186:187], v[18:19]
  v_pk_mul_f32 v[78:79], v[188:189], v[20:21]
  v_pk_mul_f32 v[82:83], v[190:191], v[22:23]
  v_pk_fma_f32 v[52:53], v[52:53], v[86:87], v[248:249]
  v_pk_fma_f32 v[56:57], v[56:57], v[86:87], v[248:249]
  v_pk_fma_f32 v[60:61], v[60:61], v[86:87], v[248:249]
  v_pk_fma_f32 v[64:65], v[64:65], v[86:87], v[248:249]
  v_pk_fma_f32 v[68:69], v[68:69], v[86:87], v[248:249]
  v_pk_fma_f32 v[72:73], v[72:73], v[86:87], v[248:249]
  v_pk_fma_f32 v[76:77], v[76:77], v[86:87], v[248:249]
  v_pk_fma_f32 v[80:81], v[80:81], v[86:87], v[248:249]
  v_pk_mul_f32 v[54:55], v[54:55], v[56:57]
  v_pk_mul_f32 v[62:63], v[62:63], v[64:65]
  v_pk_mul_f32 v[70:71], v[70:71], v[72:73]
  v_pk_mul_f32 v[78:79], v[78:79], v[80:81]
  v_pk_fma_f32 v[54:55], v[58:59], v[52:53], v[54:55]
  v_pk_fma_f32 v[62:63], v[66:67], v[60:61], v[62:63]
  v_pk_fma_f32 v[70:71], v[74:75], v[68:69], v[70:71]
  v_pk_fma_f32 v[78:79], v[82:83], v[76:77], v[78:79]
  v_pk_mul_f32 v[52:53], v[52:53], v[56:57]
  v_pk_mul_f32 v[60:61], v[60:61], v[64:65]
  v_pk_mul_f32 v[68:69], v[68:69], v[72:73]
  v_pk_mul_f32 v[76:77], v[76:77], v[80:81]
  v_pk_mul_f32 v[54:55], v[54:55], v[60:61]
  v_pk_mul_f32 v[70:71], v[70:71], v[76:77]
  v_pk_fma_f32 v[54:55], v[62:63], v[52:53], v[54:55]
  v_pk_fma_f32 v[70:71], v[78:79], v[68:69], v[70:71]
  v_pk_mul_f32 v[52:53], v[52:53], v[60:61]
  v_pk_mul_f32 v[68:69], v[68:69], v[76:77]
  v_rcp_f32 v52, v52
  v_rcp_f32 v53, v53
  v_rcp_f32 v68, v68
  v_rcp_f32 v69, v69
  v_pk_mul_f32 v[42:43], v[52:53], v[54:55]
  v_pk_mul_f32 v[44:45], v[68:69], v[70:71]
  v_pk_mul_f32 v[52:53], v[176:177], v[176:177]
  v_pk_mul_f32 v[56:57], v[178:179], v[178:179]
  v_pk_mul_f32 v[60:61], v[180:181], v[180:181]
  v_pk_mul_f32 v[64:65], v[182:183], v[182:183]
  v_pk_mul_f32 v[68:69], v[192:193], v[192:193]
  v_pk_mul_f32 v[72:73], v[194:195], v[194:195]
  v_pk_mul_f32 v[76:77], v[196:197], v[196:197]
  v_pk_mul_f32 v[80:81], v[198:199], v[198:199]
  v_pk_fma_f32 v[52:53], v[52:53], v[14:15], v[12:13]
  v_pk_fma_f32 v[56:57], v[56:57], v[14:15], v[12:13]
  v_pk_fma_f32 v[60:61], v[60:61], v[14:15], v[12:13]
  v_pk_fma_f32 v[64:65], v[64:65], v[14:15], v[12:13]
  v_pk_fma_f32 v[68:69], v[68:69], v[14:15], v[12:13]
  v_pk_fma_f32 v[72:73], v[72:73], v[14:15], v[12:13]
  v_pk_fma_f32 v[76:77], v[76:77], v[14:15], v[12:13]
  v_pk_fma_f32 v[80:81], v[80:81], v[14:15], v[12:13]
  v_pk_fma_f32 v[52:53], v[52:53], v[176:177], v[84:85]
  v_pk_fma_f32 v[56:57], v[56:57], v[178:179], v[84:85]
  v_pk_fma_f32 v[60:61], v[60:61], v[180:181], v[84:85]
  v_pk_fma_f32 v[64:65], v[64:65], v[182:183], v[84:85]
  v_pk_fma_f32 v[68:69], v[68:69], v[192:193], v[84:85]
  v_pk_fma_f32 v[72:73], v[72:73], v[194:195], v[84:85]
  v_pk_fma_f32 v[76:77], v[76:77], v[196:197], v[84:85]
  v_pk_fma_f32 v[80:81], v[80:81], v[198:199], v[84:85]
  v_exp_f32 v52, v52 clamp
  v_exp_f32 v53, v53 clamp
  v_exp_f32 v56, v56 clamp
  v_exp_f32 v57, v57 clamp
  v_exp_f32 v60, v60 clamp
  v_exp_f32 v61, v61 clamp
  v_exp_f32 v64, v64 clamp
  v_exp_f32 v65, v65 clamp
  v_exp_f32 v68, v68 clamp
  v_exp_f32 v69, v69 clamp
  v_exp_f32 v72, v72 clamp
  v_exp_f32 v73, v73 clamp
  v_exp_f32 v76, v76 clamp
  v_exp_f32 v77, v77 clamp
  v_exp_f32 v80, v80 clamp
  v_exp_f32 v81, v81 clamp
  v_pk_mul_f32 v[54:55], v[176:177], v[24:25]
  v_pk_mul_f32 v[58:59], v[178:179], v[26:27]
  v_pk_mul_f32 v[62:63], v[180:181], v[28:29]
  v_pk_mul_f32 v[66:67], v[182:183], v[30:31]
  v_pk_mul_f32 v[70:71], v[192:193], v[24:25]
  v_pk_mul_f32 v[74:75], v[194:195], v[26:27]
  v_pk_mul_f32 v[78:79], v[196:197], v[28:29]
  v_pk_mul_f32 v[82:83], v[198:199], v[30:31]
  v_pk_fma_f32 v[52:53], v[52:53], v[86:87], v[248:249]
  v_pk_fma_f32 v[56:57], v[56:57], v[86:87], v[248:249]
  v_pk_fma_f32 v[60:61], v[60:61], v[86:87], v[248:249]
  v_pk_fma_f32 v[64:65], v[64:65], v[86:87], v[248:249]
  v_pk_fma_f32 v[68:69], v[68:69], v[86:87], v[248:249]
  v_pk_fma_f32 v[72:73], v[72:73], v[86:87], v[248:249]
  v_pk_fma_f32 v[76:77], v[76:77], v[86:87], v[248:249]
  v_pk_fma_f32 v[80:81], v[80:81], v[86:87], v[248:249]
  v_pk_mul_f32 v[54:55], v[54:55], v[56:57]
  v_pk_mul_f32 v[62:63], v[62:63], v[64:65]
  v_pk_mul_f32 v[70:71], v[70:71], v[72:73]
  v_pk_mul_f32 v[78:79], v[78:79], v[80:81]
  v_pk_fma_f32 v[54:55], v[58:59], v[52:53], v[54:55]
  v_pk_fma_f32 v[62:63], v[66:67], v[60:61], v[62:63]
  v_pk_fma_f32 v[70:71], v[74:75], v[68:69], v[70:71]
  v_pk_fma_f32 v[78:79], v[82:83], v[76:77], v[78:79]
  v_pk_mul_f32 v[52:53], v[52:53], v[56:57]
  v_pk_mul_f32 v[60:61], v[60:61], v[64:65]
  v_pk_mul_f32 v[68:69], v[68:69], v[72:73]
  v_pk_mul_f32 v[76:77], v[76:77], v[80:81]
  v_pk_mul_f32 v[54:55], v[54:55], v[60:61]
  v_pk_mul_f32 v[70:71], v[70:71], v[76:77]
  v_pk_fma_f32 v[54:55], v[62:63], v[52:53], v[54:55]
  v_pk_fma_f32 v[70:71], v[78:79], v[68:69], v[70:71]
  v_pk_mul_f32 v[52:53], v[52:53], v[60:61]
  v_pk_mul_f32 v[68:69], v[68:69], v[76:77]
  v_rcp_f32 v52, v52
  v_rcp_f32 v53, v53
  v_rcp_f32 v68, v68
  v_rcp_f32 v69, v69
  v_pk_fma_f32 v[42:43], v[52:53], v[54:55], v[42:43]
  v_pk_fma_f32 v[44:45], v[68:69], v[70:71], v[44:45]
  v_pk_mul_f32 v[52:53], v[200:201], v[200:201]
  v_pk_mul_f32 v[56:57], v[202:203], v[202:203]
  v_pk_mul_f32 v[60:61], v[204:205], v[204:205]
  v_pk_mul_f32 v[64:65], v[206:207], v[206:207]
  v_pk_mul_f32 v[68:69], v[216:217], v[216:217]
  v_pk_mul_f32 v[72:73], v[218:219], v[218:219]
  v_pk_mul_f32 v[76:77], v[220:221], v[220:221]
  v_pk_mul_f32 v[80:81], v[222:223], v[222:223]
  v_pk_fma_f32 v[52:53], v[52:53], v[14:15], v[12:13]
  v_pk_fma_f32 v[56:57], v[56:57], v[14:15], v[12:13]
  v_pk_fma_f32 v[60:61], v[60:61], v[14:15], v[12:13]
  v_pk_fma_f32 v[64:65], v[64:65], v[14:15], v[12:13]
  v_pk_fma_f32 v[68:69], v[68:69], v[14:15], v[12:13]
  v_pk_fma_f32 v[72:73], v[72:73], v[14:15], v[12:13]
  v_pk_fma_f32 v[76:77], v[76:77], v[14:15], v[12:13]
  v_pk_fma_f32 v[80:81], v[80:81], v[14:15], v[12:13]
  v_pk_fma_f32 v[52:53], v[52:53], v[200:201], v[84:85]
  v_pk_fma_f32 v[56:57], v[56:57], v[202:203], v[84:85]
  v_pk_fma_f32 v[60:61], v[60:61], v[204:205], v[84:85]
  v_pk_fma_f32 v[64:65], v[64:65], v[206:207], v[84:85]
  v_pk_fma_f32 v[68:69], v[68:69], v[216:217], v[84:85]
  v_pk_fma_f32 v[72:73], v[72:73], v[218:219], v[84:85]
  v_pk_fma_f32 v[76:77], v[76:77], v[220:221], v[84:85]
  v_pk_fma_f32 v[80:81], v[80:81], v[222:223], v[84:85]
  v_exp_f32 v52, v52 clamp
  v_exp_f32 v53, v53 clamp
  v_exp_f32 v56, v56 clamp
  v_exp_f32 v57, v57 clamp
  v_exp_f32 v60, v60 clamp
  v_exp_f32 v61, v61 clamp
  v_exp_f32 v64, v64 clamp
  v_exp_f32 v65, v65 clamp
  v_exp_f32 v68, v68 clamp
  v_exp_f32 v69, v69 clamp
  v_exp_f32 v72, v72 clamp
  v_exp_f32 v73, v73 clamp
  v_exp_f32 v76, v76 clamp
  v_exp_f32 v77, v77 clamp
  v_exp_f32 v80, v80 clamp
  v_exp_f32 v81, v81 clamp
  v_pk_mul_f32 v[54:55], v[200:201], v[16:17]
  v_pk_mul_f32 v[58:59], v[202:203], v[18:19]
  v_pk_mul_f32 v[62:63], v[204:205], v[20:21]
  v_pk_mul_f32 v[66:67], v[206:207], v[22:23]
  v_pk_mul_f32 v[70:71], v[216:217], v[16:17]
  v_pk_mul_f32 v[74:75], v[218:219], v[18:19]
  v_pk_mul_f32 v[78:79], v[220:221], v[20:21]
  v_pk_mul_f32 v[82:83], v[222:223], v[22:23]
  v_pk_fma_f32 v[52:53], v[52:53], v[86:87], v[248:249]
  v_pk_fma_f32 v[56:57], v[56:57], v[86:87], v[248:249]
  v_pk_fma_f32 v[60:61], v[60:61], v[86:87], v[248:249]
  v_pk_fma_f32 v[64:65], v[64:65], v[86:87], v[248:249]
  v_pk_fma_f32 v[68:69], v[68:69], v[86:87], v[248:249]
  v_pk_fma_f32 v[72:73], v[72:73], v[86:87], v[248:249]
  v_pk_fma_f32 v[76:77], v[76:77], v[86:87], v[248:249]
  v_pk_fma_f32 v[80:81], v[80:81], v[86:87], v[248:249]
  v_pk_mul_f32 v[54:55], v[54:55], v[56:57]
  v_pk_mul_f32 v[62:63], v[62:63], v[64:65]
  v_pk_mul_f32 v[70:71], v[70:71], v[72:73]
  v_pk_mul_f32 v[78:79], v[78:79], v[80:81]
  v_pk_fma_f32 v[54:55], v[58:59], v[52:53], v[54:55]
  v_pk_fma_f32 v[62:63], v[66:67], v[60:61], v[62:63]
  v_pk_fma_f32 v[70:71], v[74:75], v[68:69], v[70:71]
  v_pk_fma_f32 v[78:79], v[82:83], v[76:77], v[78:79]
  v_pk_mul_f32 v[52:53], v[52:53], v[56:57]
  v_pk_mul_f32 v[60:61], v[60:61], v[64:65]
  v_pk_mul_f32 v[68:69], v[68:69], v[72:73]
  v_pk_mul_f32 v[76:77], v[76:77], v[80:81]
  v_pk_mul_f32 v[54:55], v[54:55], v[60:61]
  v_pk_mul_f32 v[70:71], v[70:71], v[76:77]
  v_pk_fma_f32 v[54:55], v[62:63], v[52:53], v[54:55]
  v_pk_fma_f32 v[70:71], v[78:79], v[68:69], v[70:71]
  v_pk_mul_f32 v[52:53], v[52:53], v[60:61]
  v_pk_mul_f32 v[68:69], v[68:69], v[76:77]
  v_rcp_f32 v52, v52
  v_rcp_f32 v53, v53
  v_rcp_f32 v68, v68
  v_rcp_f32 v69, v69
  v_pk_mul_f32 v[46:47], v[52:53], v[54:55]
  v_pk_mul_f32 v[48:49], v[68:69], v[70:71]
  v_pk_mul_f32 v[52:53], v[208:209], v[208:209]
  v_pk_mul_f32 v[56:57], v[210:211], v[210:211]
  v_pk_mul_f32 v[60:61], v[212:213], v[212:213]
  v_pk_mul_f32 v[64:65], v[214:215], v[214:215]
  v_pk_mul_f32 v[68:69], v[224:225], v[224:225]
  v_pk_mul_f32 v[72:73], v[226:227], v[226:227]
  v_pk_mul_f32 v[76:77], v[228:229], v[228:229]
  v_pk_mul_f32 v[80:81], v[230:231], v[230:231]
  v_pk_fma_f32 v[52:53], v[52:53], v[14:15], v[12:13]
  v_pk_fma_f32 v[56:57], v[56:57], v[14:15], v[12:13]
  v_pk_fma_f32 v[60:61], v[60:61], v[14:15], v[12:13]
  v_pk_fma_f32 v[64:65], v[64:65], v[14:15], v[12:13]
  v_pk_fma_f32 v[68:69], v[68:69], v[14:15], v[12:13]
  v_pk_fma_f32 v[72:73], v[72:73], v[14:15], v[12:13]
  v_pk_fma_f32 v[76:77], v[76:77], v[14:15], v[12:13]
  v_pk_fma_f32 v[80:81], v[80:81], v[14:15], v[12:13]
  v_pk_fma_f32 v[52:53], v[52:53], v[208:209], v[84:85]
  v_pk_fma_f32 v[56:57], v[56:57], v[210:211], v[84:85]
  v_pk_fma_f32 v[60:61], v[60:61], v[212:213], v[84:85]
  v_pk_fma_f32 v[64:65], v[64:65], v[214:215], v[84:85]
  v_pk_fma_f32 v[68:69], v[68:69], v[224:225], v[84:85]
  v_pk_fma_f32 v[72:73], v[72:73], v[226:227], v[84:85]
  v_pk_fma_f32 v[76:77], v[76:77], v[228:229], v[84:85]
  v_pk_fma_f32 v[80:81], v[80:81], v[230:231], v[84:85]
  v_exp_f32 v52, v52 clamp
  v_exp_f32 v53, v53 clamp
  v_exp_f32 v56, v56 clamp
  v_exp_f32 v57, v57 clamp
  v_exp_f32 v60, v60 clamp
  v_exp_f32 v61, v61 clamp
  v_exp_f32 v64, v64 clamp
  v_exp_f32 v65, v65 clamp
  v_exp_f32 v68, v68 clamp
  v_exp_f32 v69, v69 clamp
  v_exp_f32 v72, v72 clamp
  v_exp_f32 v73, v73 clamp
  v_exp_f32 v76, v76 clamp
  v_exp_f32 v77, v77 clamp
  v_exp_f32 v80, v80 clamp
  v_exp_f32 v81, v81 clamp
  v_pk_mul_f32 v[54:55], v[208:209], v[24:25]
  v_pk_mul_f32 v[58:59], v[210:211], v[26:27]
  v_pk_mul_f32 v[62:63], v[212:213], v[28:29]
  v_pk_mul_f32 v[66:67], v[214:215], v[30:31]
  v_pk_mul_f32 v[70:71], v[224:225], v[24:25]
  v_pk_mul_f32 v[74:75], v[226:227], v[26:27]
  v_pk_mul_f32 v[78:79], v[228:229], v[28:29]
  v_pk_mul_f32 v[82:83], v[230:231], v[30:31]
  v_pk_fma_f32 v[52:53], v[52:53], v[86:87], v[248:249]
  v_pk_fma_f32 v[56:57], v[56:57], v[86:87], v[248:249]
  v_pk_fma_f32 v[60:61], v[60:61], v[86:87], v[248:249]
  v_pk_fma_f32 v[64:65], v[64:65], v[86:87], v[248:249]
  v_pk_fma_f32 v[68:69], v[68:69], v[86:87], v[248:249]
  v_pk_fma_f32 v[72:73], v[72:73], v[86:87], v[248:249]
  v_pk_fma_f32 v[76:77], v[76:77], v[86:87], v[248:249]
  v_pk_fma_f32 v[80:81], v[80:81], v[86:87], v[248:249]
  v_pk_mul_f32 v[54:55], v[54:55], v[56:57]
  v_pk_mul_f32 v[62:63], v[62:63], v[64:65]
  v_pk_mul_f32 v[70:71], v[70:71], v[72:73]
  v_pk_mul_f32 v[78:79], v[78:79], v[80:81]
  v_pk_fma_f32 v[54:55], v[58:59], v[52:53], v[54:55]
  v_pk_fma_f32 v[62:63], v[66:67], v[60:61], v[62:63]
  v_pk_fma_f32 v[70:71], v[74:75], v[68:69], v[70:71]
  v_pk_fma_f32 v[78:79], v[82:83], v[76:77], v[78:79]
  v_pk_mul_f32 v[52:53], v[52:53], v[56:57]
  v_pk_mul_f32 v[60:61], v[60:61], v[64:65]
  v_pk_mul_f32 v[68:69], v[68:69], v[72:73]
  v_pk_mul_f32 v[76:77], v[76:77], v[80:81]
  v_pk_mul_f32 v[54:55], v[54:55], v[60:61]
  v_pk_mul_f32 v[70:71], v[70:71], v[76:77]
  v_pk_fma_f32 v[54:55], v[62:63], v[52:53], v[54:55]
  v_pk_fma_f32 v[70:71], v[78:79], v[68:69], v[70:71]
  v_pk_mul_f32 v[52:53], v[52:53], v[60:61]
  v_pk_mul_f32 v[68:69], v[68:69], v[76:77]
  v_rcp_f32 v52, v52
  v_rcp_f32 v53, v53
  v_rcp_f32 v68, v68
  v_rcp_f32 v69, v69
  v_pk_fma_f32 v[46:47], v[52:53], v[54:55], v[46:47]
  v_pk_fma_f32 v[48:49], v[68:69], v[70:71], v[48:49]
  v_pk_mul_f32 v[52:53], v[232:233], v[232:233]
  v_pk_mul_f32 v[56:57], v[234:235], v[234:235]
  v_pk_mul_f32 v[60:61], v[236:237], v[236:237]
  v_pk_mul_f32 v[64:65], v[238:239], v[238:239]
  v_pk_mul_f32 v[68:69], v[240:241], v[240:241]
  v_pk_mul_f32 v[72:73], v[242:243], v[242:243]
  v_pk_mul_f32 v[76:77], v[244:245], v[244:245]
  v_pk_mul_f32 v[80:81], v[246:247], v[246:247]
  v_pk_fma_f32 v[52:53], v[52:53], v[14:15], v[12:13]
  v_pk_fma_f32 v[56:57], v[56:57], v[14:15], v[12:13]
  v_pk_fma_f32 v[60:61], v[60:61], v[14:15], v[12:13]
  v_pk_fma_f32 v[64:65], v[64:65], v[14:15], v[12:13]
  v_pk_fma_f32 v[68:69], v[68:69], v[14:15], v[12:13]
  v_pk_fma_f32 v[72:73], v[72:73], v[14:15], v[12:13]
  v_pk_fma_f32 v[76:77], v[76:77], v[14:15], v[12:13]
  v_pk_fma_f32 v[80:81], v[80:81], v[14:15], v[12:13]
  v_pk_fma_f32 v[52:53], v[52:53], v[232:233], v[84:85]
  v_pk_fma_f32 v[56:57], v[56:57], v[234:235], v[84:85]
  v_pk_fma_f32 v[60:61], v[60:61], v[236:237], v[84:85]
  v_pk_fma_f32 v[64:65], v[64:65], v[238:239], v[84:85]
  v_pk_fma_f32 v[68:69], v[68:69], v[240:241], v[84:85]
  v_pk_fma_f32 v[72:73], v[72:73], v[242:243], v[84:85]
  v_pk_fma_f32 v[76:77], v[76:77], v[244:245], v[84:85]
  v_pk_fma_f32 v[80:81], v[80:81], v[246:247], v[84:85]
  v_exp_f32 v52, v52 clamp
  v_exp_f32 v53, v53 clamp
  v_exp_f32 v56, v56 clamp
  v_exp_f32 v57, v57 clamp
  v_exp_f32 v60, v60 clamp
  v_exp_f32 v61, v61 clamp
  v_exp_f32 v64, v64 clamp
  v_exp_f32 v65, v65 clamp
  v_exp_f32 v68, v68 clamp
  v_exp_f32 v69, v69 clamp
  v_exp_f32 v72, v72 clamp
  v_exp_f32 v73, v73 clamp
  v_exp_f32 v76, v76 clamp
  v_exp_f32 v77, v77 clamp
  v_exp_f32 v80, v80 clamp
  v_exp_f32 v81, v81 clamp
  v_pk_mul_f32 v[54:55], v[232:233], v[16:17]
  v_pk_mul_f32 v[58:59], v[234:235], v[18:19]
  v_pk_mul_f32 v[62:63], v[236:237], v[20:21]
  v_pk_mul_f32 v[66:67], v[238:239], v[22:23]
  v_pk_mul_f32 v[70:71], v[240:241], v[24:25]
  v_pk_mul_f32 v[74:75], v[242:243], v[26:27]
  v_pk_mul_f32 v[78:79], v[244:245], v[28:29]
  v_pk_mul_f32 v[82:83], v[246:247], v[30:31]
  v_pk_fma_f32 v[52:53], v[52:53], v[86:87], v[248:249]
  v_pk_fma_f32 v[56:57], v[56:57], v[86:87], v[248:249]
  v_pk_fma_f32 v[60:61], v[60:61], v[86:87], v[248:249]
  v_pk_fma_f32 v[64:65], v[64:65], v[86:87], v[248:249]
  v_pk_fma_f32 v[68:69], v[68:69], v[86:87], v[248:249]
  v_pk_fma_f32 v[72:73], v[72:73], v[86:87], v[248:249]
  v_pk_fma_f32 v[76:77], v[76:77], v[86:87], v[248:249]
  v_pk_fma_f32 v[80:81], v[80:81], v[86:87], v[248:249]
  v_pk_mul_f32 v[54:55], v[54:55], v[56:57]
  v_pk_mul_f32 v[62:63], v[62:63], v[64:65]
  v_pk_mul_f32 v[70:71], v[70:71], v[72:73]
  v_pk_mul_f32 v[78:79], v[78:79], v[80:81]
  v_pk_fma_f32 v[54:55], v[58:59], v[52:53], v[54:55]
  v_pk_fma_f32 v[62:63], v[66:67], v[60:61], v[62:63]
  v_pk_fma_f32 v[70:71], v[74:75], v[68:69], v[70:71]
  v_pk_fma_f32 v[78:79], v[82:83], v[76:77], v[78:79]
  v_pk_mul_f32 v[52:53], v[52:53], v[56:57]
  v_pk_mul_f32 v[60:61], v[60:61], v[64:65]
  v_pk_mul_f32 v[68:69], v[68:69], v[72:73]
  v_pk_mul_f32 v[76:77], v[76:77], v[80:81]
  v_pk_mul_f32 v[54:55], v[54:55], v[60:61]
  v_pk_mul_f32 v[70:71], v[70:71], v[76:77]
  v_pk_fma_f32 v[54:55], v[62:63], v[52:53], v[54:55]
  v_pk_fma_f32 v[70:71], v[78:79], v[68:69], v[70:71]
  v_pk_mul_f32 v[52:53], v[52:53], v[60:61]
  v_pk_mul_f32 v[68:69], v[68:69], v[76:77]
  v_rcp_f32 v52, v52
  v_rcp_f32 v53, v53
  v_rcp_f32 v68, v68
  v_rcp_f32 v69, v69
  v_pk_mul_f32 v[50:51], v[52:53], v[54:55]
  v_pk_fma_f32 v[50:51], v[68:69], v[70:71], v[50:51]
  v_pk_mul_f32 v[32:33], v[88:89], v[16:17]
  v_pk_fma_f32 v[32:33], v[90:91], v[18:19], v[32:33]
  v_pk_fma_f32 v[32:33], v[92:93], v[20:21], v[32:33]
  v_pk_fma_f32 v[32:33], v[94:95], v[22:23], v[32:33]
  v_pk_fma_f32 v[32:33], v[96:97], v[24:25], v[32:33]
  v_pk_fma_f32 v[32:33], v[98:99], v[26:27], v[32:33]
  v_pk_fma_f32 v[32:33], v[100:101], v[28:29], v[32:33]
  v_pk_fma_f32 v[32:33], v[102:103], v[30:31], v[32:33]
  v_add_f32 v32, v32, v33
  v_add_f32 v34, v34, v35
  v_add_f32 v36, v36, v37
  v_add_f32 v38, v38, v39
  v_add_f32 v40, v40, v41
  v_add_f32 v42, v42, v43
  v_add_f32 v44, v44, v45
  v_add_f32 v46, v46, v47
  v_add_f32 v48, v48, v49
  v_add_f32 v50, v50, v51
  v_permlane32_swap_b32 v32, v34
  v_permlane32_swap_b32 v36, v38
  v_permlane32_swap_b32 v40, v42
  v_permlane32_swap_b32 v44, v46
  v_permlane32_swap_b32 v48, v50
  v_add_f32 v48, v48, v50
  v_add_f32 v32, v32, v34
  v_add_f32 v36, v36, v38
  v_add_f32 v40, v40, v42
  v_add_f32 v44, v44, v46
  v_mov_b32 v50, v48
  v_permlane16_swap_b32 v32, v36
  v_permlane16_swap_b32 v40, v44
  v_permlane16_swap_b32 v48, v50
  v_add_f32 v32, v32, v36
  v_add_f32 v40, v40, v44
  v_add_f32_e64 v48, v48, v50
  ds_write_b32 v10, v32
  ds_write_b32 v10, v40 offset:256
  s_mov_b32 exec_lo, 0xffff
  s_mov_b32 exec_hi, 0xffff
  ds_write_b32 v10, v48 offset:512
  s_mov_b64 exec, -1
  s_waitcnt lgkmcnt(0)
  s_barrier
  s_endpgm
L_ld_tail0:
  s_waitcnt vmcnt(0)
L_ld_tail:
  s_barrier
  s_mov_b32 s60, s24
  s_and_b32 s61, s25, 0xffff
  s_mov_b32 s62, 268435456
  s_mov_b32 s63, 0x20000
  s_mov_b32 s56, s20
  s_and_b32 s57, s21, 0xffff
  s_mov_b32 s58, 8192
  s_mov_b32 s59, 0x20000
  s_mov_b32 s64, s22
  s_and_b32 s65, s23, 0xffff
  s_mov_b32 s66, 256
  s_mov_b32 s67, 0x20000
  s_load_dword s80, s[18:19], 0
  v_mov_b32 v100, 0
  s_mov_b64 exec, 1
  s_mov_b32 s81, 0x80000
  buffer_load_dword v101, v100, s[60:63], s81 offen
  buffer_load_dword v102, v100, s[56:59], 0 offen
  s_mov_b64 exec, -1
  s_mov_b64 exec, 1
  buffer_load_dword v250, v100, s[64:67], 0 offen offset:240 sc1
  s_mov_b64 exec, -1
  s_cmp_lg_u32 s3, 4
  s_cbranch_scc1 L_end
  v_lshlrev_b32 v3, 4, v0
  v_lshlrev_b32 v4, 2, v0
  v_add_u32 v1, 123392, v3
  v_add_u32 v2, 124416, v4
  v_add_u32 v4, 1024, v4
  v_mov_b32 v5, 32
  v_mov_b32 v7, s26
  s_mul_i32 s68, s26, 1280
  s_mul_i32 s69, s27, 16640
  s_add_u32 s69, s69, s68
  s_setprio 3
  v_mov_b32 v64, -1
  v_mov_b32 v65, -1
  v_mov_b32 v66, -1
  v_mov_b32 v67, -1
  buffer_store_dwordx4 v[64:67], v3, s[60:63], s69 offen sc1
  buffer_store_dword v64, v4, s[60:63], s69 offen sc1
  s_waitcnt vmcnt(0)
  s_barrier
  ds_read_b128 v[64:67], v1
  ds_read_b128 v[72:75], v1 offset:1280
  ds_read2st64_b32 v[68:69], v2 offset0:0 offset1:5
  s_waitcnt lgkmcnt(0)
  v_pk_add_f32 v[64:65], v[64:65], v[72:73]
  v_pk_add_f32 v[66:67], v[66:67], v[74:75]
  v_add_f32 v68, v68, v69
  v_min_u32 v64, -2, v64
  v_min_u32 v65, -2, v65
  v_min_u32 v66, -2, v66
  v_min_u32 v67, -2, v67
  v_min_u32_e64 v68, -2, v68
  buffer_store_dwordx4 v[64:67], v3, s[60:63], s69 offen sc1
  buffer_store_dword v68, v4, s[60:63], s69 offen sc1
  s_mov_b64 exec, 1
L_pub:
  v_lshlrev_b32 v6, 4, v7
  v_mov_b32 v13, v5
  buffer_atomic_add v5, v6, s[64:67], 0 offen sc0
  v_cmp_eq_u32 vcc, 12, v7
  v_mov_b32 v8, 436
  v_mov_b32 v9, 434
  v_cndmask_b32 v8, v8, v9, vcc
  v_sub_u32_e64 v8, v8, v13
  s_waitcnt vmcnt(0) lgkmcnt(0)
  v_cmp_eq_u32 s[82:83], v5, v8
  s_mov_b64 exec, -1
  s_lshl_b32 s80, s80, 16
  v_lshrrev_b32 v1, 1, v3
  v_lshrrev_b32_e64 v2, 1, v4
L_fin:
  s_cmp_eq_u32 s82, 0
  s_cbranch_scc1 L_done
  s_ff1_i32_b32 s70, s82
  s_bitset0_b32 s82, s70
  v_readlane_b32 s71, v7, s70
  s_waitcnt vmcnt(0)
L_again:
  s_mul_i32 s68, s71, 1280
  buffer_load_dwordx4 v[64:67], v3, s[60:63], s68 offen sc1
  buffer_load_dword v68, v4, s[60:63], s68 offen sc1
  s_add_u32 s68, s68, 16640
  buffer_load_dwordx4 v[72:75], v3, s[60:63], s68 offen sc1
  buffer_load_dword v76, v4, s[60:63], s68 offen sc1
  s_add_u32 s68, s68, 16640
  buffer_load_dwordx4 v[80:83], v3, s[60:63], s68 offen sc1
  buffer_load_dword v84, v4, s[60:63], s68 offen sc1
  s_add_u32 s68, s68, 16640
  buffer_load_dwordx4 v[88:91], v3, s[60:63], s68 offen sc1
  buffer_load_dword v92, v4, s[60:63], s68 offen sc1
  s_add_u32 s68, s68, 16640
  buffer_load_dwordx4 v[96:99], v3, s[60:63], s68 offen sc1
  buffer_load_dword v100, v4, s[60:63], s68 offen sc1
  s_add_u32 s68, s68, 16640
  buffer_load_dwordx4 v[104:107], v3, s[60:63], s68 offen sc1
  buffer_load_dword v108, v4, s[60:63], s68 offen sc1
  s_add_u32 s68, s68, 16640
  buffer_load_dwordx4 v[112:115], v3, s[60:63], s68 offen sc1
  buffer_load_dword v116, v4, s[60:63], s68 offen sc1
  s_add_u32 s68, s68, 16640
  buffer_load_dwordx4 v[120:123], v3, s[60:63], s68 offen sc1
  buffer_load_dword v124, v4, s[60:63], s68 offen sc1
  s_add_u32 s68, s68, 16640
  buffer_load_dwordx4 v[128:131], v3, s[60:63], s68 offen sc1
  buffer_load_dword v132, v4, s[60:63], s68 offen sc1
  s_add_u32 s68, s68, 16640
  buffer_load_dwordx4 v[136:139], v3, s[60:63], s68 offen sc1
  buffer_load_dword v140, v4, s[60:63], s68 offen sc1
  s_add_u32 s68, s68, 16640
  buffer_load_dwordx4 v[144:147], v3, s[60:63], s68 offen sc1
  buffer_load_dword v148, v4, s[60:63], s68 offen sc1
  s_add_u32 s68, s68, 16640
  buffer_load_dwordx4 v[152:155], v3, s[60:63], s68 offen sc1
  buffer_load_dword v156, v4, s[60:63], s68 offen sc1
  s_add_u32 s68, s68, 16640
  buffer_load_dwordx4 v[160:163], v3, s[60:63], s68 offen sc1
  buffer_load_dword v164, v4, s[60:63], s68 offen sc1
  s_add_u32 s68, s68, 16640
  buffer_load_dwordx4 v[168:171], v3, s[60:63], s68 offen sc1
  buffer_load_dword v172, v4, s[60:63], s68 offen sc1
  s_add_u32 s68, s68, 16640
L_sum:
  s_waitcnt vmcnt(25)
  v_pk_add_f32 v[56:57], v[64:65], v[72:73]
  v_pk_add_f32 v[58:59], v[66:67], v[74:75]
  s_waitcnt vmcnt(24)
  v_add_f32 v60, v68, v76
  s_waitcnt vmcnt(23)
  v_pk_add_f32 v[56:57], v[56:57], v[80:81]
  v_pk_add_f32 v[58:59], v[58:59], v[82:83]
  s_waitcnt vmcnt(22)
  v_add_f32 v60, v60, v84
  s_waitcnt vmcnt(21)
  v_pk_add_f32 v[56:57], v[56:57], v[88:89]
  v_pk_add_f32 v[58:59], v[58:59], v[90:91]
  s_waitcnt vmcnt(20)
  v_add_f32 v60, v60, v92
  s_waitcnt vmcnt(19)
  v_pk_add_f32 v[56:57], v[56:57], v[96:97]
  v_pk_add_f32 v[58:59], v[58:59], v[98:99]
  s_waitcnt vmcnt(18)
  v_add_f32 v60, v60, v100
  s_waitcnt vmcnt(17)
  v_pk_add_f32 v[56:57], v[56:57], v[104:105]
  v_pk_add_f32 v[58:59], v[58:59], v[106:107]
  s_waitcnt vmcnt(16)
  v_add_f32 v60, v60, v108
  s_waitcnt vmcnt(15)
  v_pk_add_f32 v[56:57], v[56:57], v[112:113]
  v_pk_add_f32 v[58:59], v[58:59], v[114:115]
  s_waitcnt vmcnt(14)
  v_add_f32_e64 v60, v60, v116
  s_waitcnt vmcnt(13)
  v_pk_add_f32 v[56:57], v[56:57], v[120:121]
  v_pk_add_f32 v[58:59], v[58:59], v[122:123]
  s_waitcnt vmcnt(12)
  v_add_f32 v60, v60, v124
  s_waitcnt vmcnt(11)
  v_pk_add_f32 v[56:57], v[56:57], v[128:129]
  v_pk_add_f32 v[58:59], v[58:59], v[130:131]
  s_waitcnt vmcnt(10)
  v_add_f32 v60, v60, v132
  s_waitcnt vmcnt(9)
  v_pk_add_f32 v[56:57], v[56:57], v[136:137]
  v_pk_add_f32 v[58:59], v[58:59], v[138:139]
  s_waitcnt vmcnt(8)
  v_add_f32 v60, v60, v140
  s_waitcnt vmcnt(7)
  v_pk_add_f32 v[56:57], v[56:57], v[144:145]
  v_pk_add_f32 v[58:59], v[58:59], v[146:147]
  s_waitcnt vmcnt(6)
  v_add_f32 v60, v60, v148
  s_waitcnt vmcnt(5)
  v_pk_add_f32 v[56:57], v[56:57], v[152:153]
  v_pk_add_f32 v[58:59], v[58:59], v[154:155]
  s_waitcnt vmcnt(4)
  v_add_f32 v60, v60, v156
  s_waitcnt vmcnt(3)
  v_pk_add_f32 v[56:57], v[56:57], v[160:161]
  v_pk_add_f32 v[58:59], v[58:59], v[162:163]
  s_waitcnt vmcnt(2)
  v_add_f32 v60, v60, v164
  s_waitcnt vmcnt(1)
  v_pk_add_f32 v[56:57], v[56:57], v[168:169]
  v_pk_add_f32 v[58:59], v[58:59], v[170:171]
  s_waitcnt vmcnt(0)
  v_add_f32 v60, v60, v172
  v_cmp_u_f32 vcc, v56, v57
  v_cmp_u_f32 s[92:93], v58, v59
  s_nop 0
  s_or_b64 s[92:93], s[92:93], vcc
  v_cmp_u_f32 vcc, v60, v60
  s_nop 0
  s_or_b64 vcc, s[92:93], vcc
  s_cbranch_vccnz L_chk
L_ok:
  s_mul_i32 s71, s71, 640
  v_add_f32 v56, s80, v56
  v_add_f32 v57, s80, v57
  v_add_f32 v58, s80, v58
  v_add_f32 v59, s80, v59
  v_add_f32 v60, s80, v60
  v_cvt_pk_bf16_f32 v10, v56, v57
  v_cvt_pk_bf16_f32 v11, v58, v59
  v_cvt_pk_bf16_f32 v12, v60, v60
  buffer_store_dwordx2 v[10:11], v1, s[56:59], s71 offen
  buffer_store_short v12, v2, s[56:59], s71 offen
  s_branch L_fin
L_chk:
  v_mov_b32 v14, 0
  v_mov_b32_e64 v15, 0
  v_max3_u32 v14, v14, v64, v65
  v_max3_u32 v14, v14, v66, v67
  v_max_u32 v15, v15, v68
  v_max3_u32 v14, v14, v72, v73
  v_max3_u32 v14, v14, v74, v75
  v_max_u32 v15, v15, v76
  v_max3_u32 v14, v14, v80, v81
  v_max3_u32 v14, v14, v82, v83
  v_max_u32_e64 v15, v15, v84
  v_max3_u32 v14, v14, v88, v89
  v_max3_u32 v14, v14, v90, v91
  v_max_u32 v15, v15, v92
  v_max3_u32 v14, v14, v96, v97
  v_max3_u32 v14, v14, v98, v99
  v_max_u32 v15, v15, v100
  v_max3_u32 v14, v14, v104, v105
  v_max3_u32 v14, v14, v106, v107
  v_max_u32_e64 v15, v15, v108
  v_max3_u32 v14, v14, v112, v113
  v_max3_u32 v14, v14, v114, v115
  v_max_u32 v15, v15, v116
  v_max3_u32 v14, v14, v120, v121
  v_max3_u32 v14, v14, v122, v123
  v_max_u32 v15, v15, v124
  v_max3_u32 v14, v14, v128, v129
  v_max3_u32 v14, v14, v130, v131
  v_max_u32_e64 v15, v15, v132
  v_max3_u32 v14, v14, v136, v137
  v_max3_u32 v14, v14, v138, v139
  v_max_u32 v15, v15, v140
  v_max3_u32 v14, v14, v144, v145
  v_max3_u32 v14, v14, v146, v147
  v_max_u32 v15, v15, v148
  v_max3_u32 v14, v14, v152, v153
  v_max3_u32 v14, v14, v154, v155
  v_max_u32_e64 v15, v15, v156
  v_max3_u32 v14, v14, v160, v161
  v_max3_u32 v14, v14, v162, v163
  v_max_u32 v15, v15, v164
  v_max3_u32 v14, v14, v168, v169
  v_max3_u32 v14, v14, v170, v171
  v_max_u32 v15, v15, v172
  s_cmp_eq_u32 s71, 12
  s_cselect_b32 s68, 0, -1
  v_and_b32 v15, s68, v15
  v_max_u32 v14, v14, v15
  v_cmp_eq_u32 vcc, -1, v14
  s_cbranch_vccnz L_again
  s_branch L_ok
L_done:
  s_endpgm
L_cin_done:
  s_mul_i32 s98, s3, 1536
  s_add_u32 s98, s98, 116736
  v_lshlrev_b32 v120, 5, v0
  v_add_u32 v120, s98, v120
  ds_read_b128 v[60:63], v120
  ds_read_b128 v[64:67], v120 offset:16
  v_mul_f32 v116, v184, v192
  v_mul_f32 v117, v185, v193
  v_mul_f32 v118, v186, v194
  v_mul_f32 v119, v187, v195
  v_fmac_f32 v116, v188, v191
  v_fmac_f32 v117, v200, v208
  v_fmac_f32 v118, v201, v209
  v_fmac_f32 v119, v202, v210
  v_fmac_f32 v116, v203, v211
  v_fmac_f32 v117, v204, v207
  v_fmac_f32 v118, v216, v224
  v_fmac_f32 v119, v217, v225
  v_fmac_f32 v116, v218, v226
  v_fmac_f32 v117, v219, v227
  v_fmac_f32 v118, v220, v223
  v_fmac_f32 v119, v232, v240
  v_fmac_f32 v116, v233, v241
  v_fmac_f32 v117, v234, v242
  v_fmac_f32 v118, v235, v243
  v_fmac_f32 v119, v236, v239
  v_fmac_f32 v116, v189, v196
  v_fmac_f32 v117, v189, v197
  v_fmac_f32 v118, v190, v198
  v_fmac_f32 v119, v190, v199
  v_fmac_f32 v116, v205, v212
  v_fmac_f32 v117, v205, v213
  v_fmac_f32 v118, v206, v214
  v_fmac_f32 v119, v206, v215
  v_fmac_f32 v116, v221, v228
  v_fmac_f32 v117, v221, v229
  v_fmac_f32 v118, v222, v230
  v_fmac_f32 v119, v222, v231
  v_fmac_f32 v116, v237, v244
  v_fmac_f32 v117, v237, v245
  v_fmac_f32 v118, v238, v246
  v_fmac_f32 v119, v238, v247
  v_add_f32 v116, v116, v117
  v_add_f32 v118, v118, v119
  v_add_f32 v116, v116, v118
  v_mul_f32 v116, s74, v116
  v_mul_f32 v116, s75, v116
  s_nop 1
  v_add_f32_dpp v116, v116, v116 row_shr:1 row_mask:0xf bank_mask:0xf
  v_subrev_u32 v122, s98, v7
  v_lshrrev_b32 v122, 8, v122
  v_lshrrev_b32 v121, 3, v0
  v_add_f32_dpp v116, v116, v116 row_shr:2 row_mask:0xf bank_mask:0xf
  v_cmp_gt_u32 vcc, v122, v121
  v_min_u32 v121, v121, v122
  v_lshlrev_b32 v121, 4, v121
  v_add_f32_dpp v116, v116, v116 row_shr:4 row_mask:0xf bank_mask:0xf
  v_add_u32 v121, s85, v121
  s_waitcnt lgkmcnt(1)
  v_add_f32 v60, v60, v61
  v_add_f32 v62, v62, v63
  v_add_f32_dpp v116, v116, v116 row_shr:8 row_mask:0xf bank_mask:0xf
  s_waitcnt lgkmcnt(0)
  v_add_f32 v64, v64, v65
  v_add_f32 v66, v66, v67
  v_add_f32 v60, v60, v62
  v_add_f32_dpp v116, v116, v116 row_bcast:15 row_mask:0xa bank_mask:0xf
  v_add_f32 v64, v64, v66
  v_add_f32_e64 v60, v60, v64
  s_nop 1
  v_add_f32_dpp v60, v60, v60 quad_perm:[1,0,3,2] row_mask:0xf bank_mask:0xf
  v_add_f32_dpp v116, v116, v116 row_bcast:31 row_mask:0xc bank_mask:0xf
  s_nop 0
  v_add_f32_dpp v60, v60, v60 quad_perm:[2,3,0,1] row_mask:0xf bank_mask:0xf
  s_nop 1
  v_add_f32_dpp v60, v60, v60 row_half_mirror row_mask:0xf bank_mask:0xf
  v_cndmask_b32 v60, v116, v60, vcc
  s_bitset1_b32 vcc_hi, 31
  s_mov_b64 exec, vcc
  ds_write_b32 v121, v60
  s_mov_b64 exec, -1
  s_cmp_eq_u32 s3, 0
  s_cbranch_scc1 L_cpub
  s_waitcnt lgkmcnt(0)
  s_barrier
  s_endpgm
L_cpub:
  s_load_dword s80, s[18:19], 0
  s_mov_b32 s60, s24
  s_and_b32 s61, s25, 0xffff
  s_mov_b32 s62, 268435456
  s_mov_b32 s63, 0x20000
  s_mov_b32 s56, s20
  s_and_b32 s57, s21, 0xffff
  s_mov_b32 s58, 8192
  s_mov_b32 s59, 0x20000
  s_mov_b32 s64, s22
  s_and_b32 s65, s23, 0xffff
  s_mov_b32 s66, 256
  s_mov_b32 s67, 0x20000
  v_lshlrev_b32_e64 v6, 2, v0
  v_add_u32 v2, 129728, v6
  v_add_u32 v4, 1024, v6
  s_mul_i32 s69, s26, 192
  s_add_u32 s69, s69, 216320
  v_mov_b32 v13, -1
  s_mov_b32 exec_hi, 0xffff
  buffer_store_dword v13, v6, s[60:63], s69 offen sc1
  s_mov_b64 exec, 1
  buffer_load_dword v250, v6, s[56:59], 0 offen
  buffer_load_dword v251, v6, s[64:67], 0 offen offset:240 sc1
  s_mov_b64 exec, -1
  s_mul_i32 s68, s26, 3
  s_mul_i32 s70, s68, 3277
  s_lshr_b32 s70, s70, 16
  v_add_u32 v7, s70, v0
  s_mul_i32 s70, s70, 20
  s_add_u32 s70, s70, 20
  s_sub_u32 s70, s70, s68
  s_min_u32 s70, s70, 3
  s_sub_u32 s68, 3, s70
  v_mov_b32 v5, s68
  v_writelane_b32 v5, s70, 0
  s_cmp_eq_u32 s68, 0
  s_cselect_b32 s68, 1, 3
  v_lshlrev_b32 v3, 4, v0
  s_mov_b32 exec_hi, 0xffff
  s_waitcnt vmcnt(0) lgkmcnt(0)
  s_barrier
  ds_read_b32 v64, v2
  s_waitcnt lgkmcnt(0)
  v_min_u32_e64 v64, -2, v64
  buffer_store_dword v64, v6, s[60:63], s69 offen sc1
  s_mov_b32 exec_lo, s68
  s_mov_b32 exec_hi, 0
  s_branch L_pub
L_dnn_loop1:
  s_barrier
L_ld_in:
  s_add_u32 m0, s75, 131072
  s_nop 0
  buffer_load_dwordx4 v4, s[44:47], s74 offen lds
  s_add_u32 m0, s75, 132096
  s_nop 0
  buffer_load_dwordx4 v5, s[44:47], s74 offen lds
  s_add_u32 s74, s74, 106496
  s_add_u32 m0, s75, 139264
  s_nop 0
  buffer_load_dwordx4 v4, s[44:47], s74 offen lds
  s_add_u32 m0, s75, 140288
  s_nop 0
  buffer_load_dwordx4 v5, s[44:47], s74 offen lds
  s_add_u32 s74, s74, 106496
  s_add_u32 m0, s76, 0
  s_nop 0
  buffer_load_dwordx4 v56, s[32:35], 0 offen lds
  s_add_u32 m0, s76, 2048
  v_add_u32_dpp v56, v16, v2 row_newbcast:1 row_mask:0xf bank_mask:0x3
  buffer_load_dwordx4 v57, s[32:35], 0 offen lds
  s_nop 0
  v_add_u32_dpp v56, v18, v2 row_newbcast:7 row_mask:0xf bank_mask:0xc
  s_add_u32 m0, s76, 4096
  v_add_u32_dpp v57, v20, v2 row_newbcast:1 row_mask:0xf bank_mask:0x3
  buffer_load_dwordx4 v58, s[32:35], 0 offen lds
  s_nop 0
  v_add_u32_dpp v57, v22, v2 row_newbcast:7 row_mask:0xf bank_mask:0xc
  s_add_u32 m0, s76, 6144
  v_add_u32_dpp v58, v24, v2 row_newbcast:1 row_mask:0xf bank_mask:0x3
  buffer_load_dwordx4 v59, s[32:35], 0 offen lds
  s_nop 0
  v_add_u32_dpp v58, v26, v2 row_newbcast:7 row_mask:0xf bank_mask:0xc
  s_add_u32 m0, s76, 8192
  v_add_u32_dpp v59, v28, v2 row_newbcast:1 row_mask:0xf bank_mask:0x3
  buffer_load_dwordx4 v60, s[32:35], 0 offen lds
  s_nop 0
  v_add_u32_dpp v59, v30, v2 row_newbcast:7 row_mask:0xf bank_mask:0xc
  s_add_u32 m0, s76, 10240
  v_add_u32_dpp v60, v32, v2 row_newbcast:1 row_mask:0xf bank_mask:0x3
  buffer_load_dwordx4 v61, s[32:35], 0 offen lds
  s_nop 0
  v_add_u32_dpp v60, v34, v2 row_newbcast:7 row_mask:0xf bank_mask:0xc
  s_add_u32 m0, s76, 12288
  v_add_u32_dpp v61, v36, v2 row_newbcast:1 row_mask:0xf bank_mask:0x3
  buffer_load_dwordx4 v62, s[32:35], 0 offen lds
  s_nop 0
  v_add_u32_dpp v61, v38, v2 row_newbcast:7 row_mask:0xf bank_mask:0xc
  s_add_u32 m0, s76, 14336
  v_add_u32_dpp v62, v40, v2 row_newbcast:1 row_mask:0xf bank_mask:0x3
  buffer_load_dwordx4 v63, s[32:35], 0 offen lds
  s_nop 0
  v_add_u32_dpp v62, v42, v2 row_newbcast:7 row_mask:0xf bank_mask:0xc
  s_add_u32 m0, s76, 16384
  v_add_u32_dpp v63, v44, v2 row_newbcast:1 row_mask:0xf bank_mask:0x3
  buffer_load_dwordx4 v64, s[32:35], 0 offen lds
  s_nop 0
  v_add_u32_dpp v63, v46, v2 row_newbcast:7 row_mask:0xf bank_mask:0xc
  s_add_u32 m0, s76, 18432
  v_add_u32_dpp v64, v48, v2 row_newbcast:1 row_mask:0xf bank_mask:0x3
  buffer_load_dwordx4 v65, s[32:35], 0 offen lds
  s_nop 0
  v_add_u32_dpp v64, v50, v2 row_newbcast:7 row_mask:0xf bank_mask:0xc
  v_add_u32_dpp v65, v52, v2 row_newbcast:1 row_mask:0xf bank_mask:0x3
  s_nop 1
  v_add_u32_dpp v65, v54, v2 row_newbcast:7 row_mask:0xf bank_mask:0xc
  s_mov_b64 exec, 0x3ff
  buffer_load_dword v103, v84, s[44:47], s85 offen
  s_mov_b64 exec, -1
  s_add_u32 s85, s85, 865280
  s_waitcnt vmcnt(11)
  s_barrier
  s_add_u32 m0, s75, 147456
  s_nop 0
  buffer_load_dwordx4 v4, s[44:47], s74 offen lds
  s_add_u32 m0, s75, 148480
  s_nop 0
  buffer_load_dwordx4 v5, s[44:47], s74 offen lds
  s_add_u32 s74, s74, 106496
  s_add_u32 m0, s75, 155648
  s_nop 0
  buffer_load_dwordx4 v4, s[44:47], s74 offen lds
  s_add_u32 m0, s75, 156672
  s_nop 0
  buffer_load_dwordx4 v5, s[44:47], s74 offen lds
  s_add_u32 s74, s74, 106496
  s_add_u32 m0, s76, 40960
  s_nop 0
  buffer_load_dwordx4 v56, s[32:35], 0 offen lds
  s_add_u32 m0, s76, 43008
  v_add_u32_dpp v56, v17, v2 row_newbcast:1 row_mask:0xf bank_mask:0x3
  buffer_load_dwordx4 v57, s[32:35], 0 offen lds
  s_nop 0
  v_add_u32_dpp v56, v19, v2 row_newbcast:7 row_mask:0xf bank_mask:0xc
  s_add_u32 m0, s76, 45056
  v_add_u32_dpp v57, v21, v2 row_newbcast:1 row_mask:0xf bank_mask:0x3
  buffer_load_dwordx4 v58, s[32:35], 0 offen lds
  s_nop 0
  v_add_u32_dpp v57, v23, v2 row_newbcast:7 row_mask:0xf bank_mask:0xc
  s_add_u32 m0, s76, 47104
  v_add_u32_dpp v58, v25, v2 row_newbcast:1 row_mask:0xf bank_mask:0x3
  buffer_load_dwordx4 v59, s[32:35], 0 offen lds
  s_nop 0
  v_add_u32_dpp v58, v27, v2 row_newbcast:7 row_mask:0xf bank_mask:0xc
  s_add_u32 m0, s76, 49152
  v_add_u32_dpp v59, v29, v2 row_newbcast:1 row_mask:0xf bank_mask:0x3
  buffer_load_dwordx4 v60, s[32:35], 0 offen lds
  s_nop 0
  v_add_u32_dpp v59, v31, v2 row_newbcast:7 row_mask:0xf bank_mask:0xc
  s_add_u32 m0, s76, 51200
  v_add_u32_dpp v60, v33, v2 row_newbcast:1 row_mask:0xf bank_mask:0x3
  buffer_load_dwordx4 v61, s[32:35], 0 offen lds
  s_nop 0
  v_add_u32_dpp v60, v35, v2 row_newbcast:7 row_mask:0xf bank_mask:0xc
  s_add_u32 m0, s76, 53248
  v_add_u32_dpp v61, v37, v2 row_newbcast:1 row_mask:0xf bank_mask:0x3
  buffer_load_dwordx4 v62, s[32:35], 0 offen lds
  s_nop 0
  v_add_u32_dpp v61, v39, v2 row_newbcast:7 row_mask:0xf bank_mask:0xc
  s_add_u32 m0, s76, 55296
  v_add_u32_dpp v62, v41, v2 row_newbcast:1 row_mask:0xf bank_mask:0x3
  buffer_load_dwordx4 v63, s[32:35], 0 offen lds
  s_nop 0
  v_add_u32_dpp v62, v43, v2 row_newbcast:7 row_mask:0xf bank_mask:0xc
  s_add_u32 m0, s76, 57344
  v_add_u32_dpp v63, v45, v2 row_newbcast:1 row_mask:0xf bank_mask:0x3
  buffer_load_dwordx4 v64, s[32:35], 0 offen lds
  s_nop 0
  v_add_u32_dpp v63, v47, v2 row_newbcast:7 row_mask:0xf bank_mask:0xc
  s_add_u32 m0, s76, 59392
  v_add_u32_dpp v64, v49, v2 row_newbcast:1 row_mask:0xf bank_mask:0x3
  buffer_load_dwordx4 v65, s[32:35], 0 offen lds
  s_nop 0
  v_add_u32_dpp v64, v51, v2 row_newbcast:7 row_mask:0xf bank_mask:0xc
  v_add_u32_dpp v65, v53, v2 row_newbcast:1 row_mask:0xf bank_mask:0x3
  s_nop 1
  v_add_u32_dpp v65, v55, v2 row_newbcast:7 row_mask:0xf bank_mask:0xc
  v_lshlrev_b32 v101, 7, v70
  s_mov_b32 exec_lo, 0xffffffff
  s_mov_b32 exec_hi, 0x0
  buffer_load_dword v102, v101, s[32:35], 0 offen
  s_mov_b64 exec, -1
  v_mov_b32 v70, v71
  v_mov_b32 v71, v72
  v_mov_b32 v72, v73
  v_mov_b32_e64 v73, v74
  v_mov_b32 v74, 0xffffff
  s_waitcnt vmcnt(11)
  s_barrier
  s_add_u32 m0, s75, 131072
  s_nop 0
  buffer_load_dwordx4 v4, s[44:47], s74 offen lds
  s_add_u32 m0, s75, 132096
  s_nop 0
  buffer_load_dwordx4 v5, s[44:47], s74 offen lds
  s_add_u32 s74, s74, 106496
  s_add_u32 m0, s75, 139264
  s_nop 0
  buffer_load_dwordx4 v4, s[44:47], s74 offen lds
  s_add_u32 m0, s75, 140288
  s_nop 0
  buffer_load_dwordx4 v5, s[44:47], s74 offen lds
  s_add_u32 s74, s74, 106496
  s_add_u32 m0, s76, 81920
  s_nop 0
  buffer_load_dwordx4 v56, s[32:35], 0 offen lds
  s_add_u32 m0, s76, 83968
  v_add_u32_dpp v56, v18, v2 row_newbcast:1 row_mask:0xf bank_mask:0x3
  buffer_load_dwordx4 v57, s[32:35], 0 offen lds
  s_nop 0
  v_add_u32_dpp v56, v16, v2 row_newbcast:8 row_mask:0xf bank_mask:0xc
  s_add_u32 m0, s76, 86016
  v_add_u32_dpp v57, v22, v2 row_newbcast:1 row_mask:0xf bank_mask:0x3
  buffer_load_dwordx4 v58, s[32:35], 0 offen lds
  s_nop 0
  v_add_u32_dpp v57, v20, v2 row_newbcast:8 row_mask:0xf bank_mask:0xc
  s_add_u32 m0, s76, 88064
  v_add_u32_dpp v58, v26, v2 row_newbcast:1 row_mask:0xf bank_mask:0x3
  buffer_load_dwordx4 v59, s[32:35], 0 offen lds
  s_nop 0
  v_add_u32_dpp v58, v24, v2 row_newbcast:8 row_mask:0xf bank_mask:0xc
  s_add_u32 m0, s76, 90112
  v_add_u32_dpp v59, v30, v2 row_newbcast:1 row_mask:0xf bank_mask:0x3
  buffer_load_dwordx4 v60, s[32:35], 0 offen lds
  s_nop 0
  v_add_u32_dpp v59, v28, v2 row_newbcast:8 row_mask:0xf bank_mask:0xc
  s_add_u32 m0, s76, 92160
  v_add_u32_dpp v60, v34, v2 row_newbcast:1 row_mask:0xf bank_mask:0x3
  buffer_load_dwordx4 v61, s[32:35], 0 offen lds
  s_nop 0
  v_add_u32_dpp v60, v32, v2 row_newbcast:8 row_mask:0xf bank_mask:0xc
  s_add_u32 m0, s76, 94208
  v_add_u32_dpp v61, v38, v2 row_newbcast:1 row_mask:0xf bank_mask:0x3
  buffer_load_dwordx4 v62, s[32:35], 0 offen lds
  s_nop 0
  v_add_u32_dpp v61, v36, v2 row_newbcast:8 row_mask:0xf bank_mask:0xc
  s_add_u32 m0, s76, 96256
  v_add_u32_dpp v62, v42, v2 row_newbcast:1 row_mask:0xf bank_mask:0x3
  buffer_load_dwordx4 v63, s[32:35], 0 offen lds
  s_nop 0
  v_add_u32_dpp v62, v40, v2 row_newbcast:8 row_mask:0xf bank_mask:0xc
  s_add_u32 m0, s76, 98304
  v_add_u32_dpp v63, v46, v2 row_newbcast:1 row_mask:0xf bank_mask:0x3
  buffer_load_dwordx4 v64, s[32:35], 0 offen lds
  s_nop 0
  v_add_u32_dpp v63, v44, v2 row_newbcast:8 row_mask:0xf bank_mask:0xc
  s_add_u32 m0, s76, 100352
  v_add_u32_dpp v64, v50, v2 row_newbcast:1 row_mask:0xf bank_mask:0x3
  buffer_load_dwordx4 v65, s[32:35], 0 offen lds
  s_nop 0
  v_add_u32_dpp v64, v48, v2 row_newbcast:8 row_mask:0xf bank_mask:0xc
  v_add_u32_dpp v65, v54, v2 row_newbcast:1 row_mask:0xf bank_mask:0x3
  s_nop 1
  v_add_u32_dpp v65, v52, v2 row_newbcast:8 row_mask:0xf bank_mask:0xc
  s_waitcnt vmcnt(10)
  s_barrier
  s_add_u32 m0, s75, 147456
  s_nop 0
  buffer_load_dwordx4 v4, s[44:47], s74 offen lds
  s_add_u32 m0, s75, 148480
  s_nop 0
  buffer_load_dwordx4 v5, s[44:47], s74 offen lds
  s_add_u32 s74, s74, 106496
  s_add_u32 m0, s75, 155648
  s_nop 0
  buffer_load_dwordx4 v4, s[44:47], s74 offen lds
  s_add_u32 m0, s75, 156672
  s_nop 0
  buffer_load_dwordx4 v5, s[44:47], s74 offen lds
  s_add_u32 s74, s74, 106496
  s_add_u32 m0, s76, 0
  s_nop 0
  buffer_load_dwordx4 v56, s[32:35], 0 offen lds
  s_add_u32 m0, s76, 2048
  v_add_u32_dpp v56, v19, v2 row_newbcast:1 row_mask:0xf bank_mask:0x3
  buffer_load_dwordx4 v57, s[32:35], 0 offen lds
  s_nop 0
  v_add_u32_dpp v56, v17, v2 row_newbcast:8 row_mask:0xf bank_mask:0xc
  s_add_u32 m0, s76, 4096
  v_add_u32_dpp v57, v23, v2 row_newbcast:1 row_mask:0xf bank_mask:0x3
  buffer_load_dwordx4 v58, s[32:35], 0 offen lds
  s_nop 0
  v_add_u32_dpp v57, v21, v2 row_newbcast:8 row_mask:0xf bank_mask:0xc
  s_add_u32 m0, s76, 6144
  v_add_u32_dpp v58, v27, v2 row_newbcast:1 row_mask:0xf bank_mask:0x3
  buffer_load_dwordx4 v59, s[32:35], 0 offen lds
  s_nop 0
  v_add_u32_dpp v58, v25, v2 row_newbcast:8 row_mask:0xf bank_mask:0xc
  s_add_u32 m0, s76, 8192
  v_add_u32_dpp v59, v31, v2 row_newbcast:1 row_mask:0xf bank_mask:0x3
  buffer_load_dwordx4 v60, s[32:35], 0 offen lds
  s_nop 0
  v_add_u32_dpp v59, v29, v2 row_newbcast:8 row_mask:0xf bank_mask:0xc
  s_add_u32 m0, s76, 10240
  v_add_u32_dpp v60, v35, v2 row_newbcast:1 row_mask:0xf bank_mask:0x3
  buffer_load_dwordx4 v61, s[32:35], 0 offen lds
  s_nop 0
  v_add_u32_dpp v60, v33, v2 row_newbcast:8 row_mask:0xf bank_mask:0xc
  s_add_u32 m0, s76, 12288
  v_add_u32_dpp v61, v39, v2 row_newbcast:1 row_mask:0xf bank_mask:0x3
  buffer_load_dwordx4 v62, s[32:35], 0 offen lds
  s_nop 0
  v_add_u32_dpp v61, v37, v2 row_newbcast:8 row_mask:0xf bank_mask:0xc
  s_add_u32 m0, s76, 14336
  v_add_u32_dpp v62, v43, v2 row_newbcast:1 row_mask:0xf bank_mask:0x3
  buffer_load_dwordx4 v63, s[32:35], 0 offen lds
  s_nop 0
  v_add_u32_dpp v62, v41, v2 row_newbcast:8 row_mask:0xf bank_mask:0xc
  s_add_u32 m0, s76, 16384
  v_add_u32_dpp v63, v47, v2 row_newbcast:1 row_mask:0xf bank_mask:0x3
  buffer_load_dwordx4 v64, s[32:35], 0 offen lds
  s_nop 0
  v_add_u32_dpp v63, v45, v2 row_newbcast:8 row_mask:0xf bank_mask:0xc
  s_add_u32 m0, s76, 18432
  v_add_u32_dpp v64, v51, v2 row_newbcast:1 row_mask:0xf bank_mask:0x3
  buffer_load_dwordx4 v65, s[32:35], 0 offen lds
  s_nop 0
  v_add_u32_dpp v64, v49, v2 row_newbcast:8 row_mask:0xf bank_mask:0xc
  v_add_u32_dpp v65, v55, v2 row_newbcast:1 row_mask:0xf bank_mask:0x3
  s_nop 1
  v_add_u32_dpp v65, v53, v2 row_newbcast:8 row_mask:0xf bank_mask:0xc
  s_waitcnt vmcnt(10)
  s_barrier
  s_add_u32 m0, s75, 131072
  s_nop 0
  buffer_load_dwordx4 v4, s[44:47], s74 offen lds
  s_add_u32 m0, s75, 132096
  s_nop 0
  buffer_load_dwordx4 v5, s[44:47], s74 offen lds
  s_add_u32 s74, s74, 106496
  s_add_u32 m0, s75, 139264
  s_nop 0
  buffer_load_dwordx4 v4, s[44:47], s74 offen lds
  s_add_u32 m0, s75, 140288
  s_nop 0
  buffer_load_dwordx4 v5, s[44:47], s74 offen lds
  s_add_u32 s74, s74, 106496
  s_add_u32 m0, s76, 40960
  s_nop 0
  buffer_load_dwordx4 v56, s[32:35], 0 offen lds
  s_add_u32 m0, s76, 43008
  v_add_u32_dpp v56, v16, v2 row_newbcast:2 row_mask:0xf bank_mask:0x3
  buffer_load_dwordx4 v57, s[32:35], 0 offen lds
  s_nop 0
  v_add_u32_dpp v56, v18, v2 row_newbcast:8 row_mask:0xf bank_mask:0xc
  s_add_u32 m0, s76, 45056
  v_add_u32_dpp v57, v20, v2 row_newbcast:2 row_mask:0xf bank_mask:0x3
  buffer_load_dwordx4 v58, s[32:35], 0 offen lds
  s_nop 0
  v_add_u32_dpp v57, v22, v2 row_newbcast:8 row_mask:0xf bank_mask:0xc
  s_add_u32 m0, s76, 47104
  v_add_u32_dpp v58, v24, v2 row_newbcast:2 row_mask:0xf bank_mask:0x3
  buffer_load_dwordx4 v59, s[32:35], 0 offen lds
  s_nop 0
  v_add_u32_dpp v58, v26, v2 row_newbcast:8 row_mask:0xf bank_mask:0xc
  s_add_u32 m0, s76, 49152
  v_add_u32_dpp v59, v28, v2 row_newbcast:2 row_mask:0xf bank_mask:0x3
  buffer_load_dwordx4 v60, s[32:35], 0 offen lds
  s_nop 0
  v_add_u32_dpp v59, v30, v2 row_newbcast:8 row_mask:0xf bank_mask:0xc
  s_add_u32 m0, s76, 51200
  v_add_u32_dpp v60, v32, v2 row_newbcast:2 row_mask:0xf bank_mask:0x3
  buffer_load_dwordx4 v61, s[32:35], 0 offen lds
  s_nop 0
  v_add_u32_dpp v60, v34, v2 row_newbcast:8 row_mask:0xf bank_mask:0xc
  s_add_u32 m0, s76, 53248
  v_add_u32_dpp v61, v36, v2 row_newbcast:2 row_mask:0xf bank_mask:0x3
  buffer_load_dwordx4 v62, s[32:35], 0 offen lds
  s_nop 0
  v_add_u32_dpp v61, v38, v2 row_newbcast:8 row_mask:0xf bank_mask:0xc
  s_add_u32 m0, s76, 55296
  v_add_u32_dpp v62, v40, v2 row_newbcast:2 row_mask:0xf bank_mask:0x3
  buffer_load_dwordx4 v63, s[32:35], 0 offen lds
  s_nop 0
  v_add_u32_dpp v62, v42, v2 row_newbcast:8 row_mask:0xf bank_mask:0xc
  s_add_u32 m0, s76, 57344
  v_add_u32_dpp v63, v44, v2 row_newbcast:2 row_mask:0xf bank_mask:0x3
  buffer_load_dwordx4 v64, s[32:35], 0 offen lds
  s_nop 0
  v_add_u32_dpp v63, v46, v2 row_newbcast:8 row_mask:0xf bank_mask:0xc
  s_add_u32 m0, s76, 59392
  v_add_u32_dpp v64, v48, v2 row_newbcast:2 row_mask:0xf bank_mask:0x3
  buffer_load_dwordx4 v65, s[32:35], 0 offen lds
  s_nop 0
  v_add_u32_dpp v64, v50, v2 row_newbcast:8 row_mask:0xf bank_mask:0xc
  v_add_u32_dpp v65, v52, v2 row_newbcast:2 row_mask:0xf bank_mask:0x3
  s_nop 1
  v_add_u32_dpp v65, v54, v2 row_newbcast:8 row_mask:0xf bank_mask:0xc
  s_mov_b64 exec, 0x3ff
  buffer_load_dword v103, v84, s[44:47], s85 offen
  s_mov_b64 exec, -1
  s_add_u32 s85, s85, 865280
  s_waitcnt vmcnt(11)
  s_barrier
  s_add_u32 m0, s75, 147456
  s_nop 0
  buffer_load_dwordx4 v4, s[44:47], s74 offen lds
  s_add_u32 m0, s75, 148480
  s_nop 0
  buffer_load_dwordx4 v5, s[44:47], s74 offen lds
  s_add_u32 s74, s74, 106496
  s_add_u32 m0, s75, 155648
  s_nop 0
  buffer_load_dwordx4 v4, s[44:47], s74 offen lds
  s_add_u32 m0, s75, 156672
  s_nop 0
  buffer_load_dwordx4 v5, s[44:47], s74 offen lds
  s_add_u32 s74, s74, 106496
  s_add_u32 m0, s76, 81920
  s_nop 0
  buffer_load_dwordx4 v56, s[32:35], 0 offen lds
  s_add_u32 m0, s76, 83968
  v_add_u32_dpp v56, v17, v2 row_newbcast:2 row_mask:0xf bank_mask:0x3
  buffer_load_dwordx4 v57, s[32:35], 0 offen lds
  s_nop 0
  v_add_u32_dpp v56, v19, v2 row_newbcast:8 row_mask:0xf bank_mask:0xc
  s_add_u32 m0, s76, 86016
  v_add_u32_dpp v57, v21, v2 row_newbcast:2 row_mask:0xf bank_mask:0x3
  buffer_load_dwordx4 v58, s[32:35], 0 offen lds
  s_nop 0
  v_add_u32_dpp v57, v23, v2 row_newbcast:8 row_mask:0xf bank_mask:0xc
  s_add_u32 m0, s76, 88064
  v_add_u32_dpp v58, v25, v2 row_newbcast:2 row_mask:0xf bank_mask:0x3
  buffer_load_dwordx4 v59, s[32:35], 0 offen lds
  s_nop 0
  v_add_u32_dpp v58, v27, v2 row_newbcast:8 row_mask:0xf bank_mask:0xc
  s_add_u32 m0, s76, 90112
  v_add_u32_dpp v59, v29, v2 row_newbcast:2 row_mask:0xf bank_mask:0x3
  buffer_load_dwordx4 v60, s[32:35], 0 offen lds
  s_nop 0
  v_add_u32_dpp v59, v31, v2 row_newbcast:8 row_mask:0xf bank_mask:0xc
  s_add_u32 m0, s76, 92160
  v_add_u32_dpp v60, v33, v2 row_newbcast:2 row_mask:0xf bank_mask:0x3
  buffer_load_dwordx4 v61, s[32:35], 0 offen lds
  s_nop 0
  v_add_u32_dpp v60, v35, v2 row_newbcast:8 row_mask:0xf bank_mask:0xc
  s_add_u32 m0, s76, 94208
  v_add_u32_dpp v61, v37, v2 row_newbcast:2 row_mask:0xf bank_mask:0x3
  buffer_load_dwordx4 v62, s[32:35], 0 offen lds
  s_nop 0
  v_add_u32_dpp v61, v39, v2 row_newbcast:8 row_mask:0xf bank_mask:0xc
  s_add_u32 m0, s76, 96256
  v_add_u32_dpp v62, v41, v2 row_newbcast:2 row_mask:0xf bank_mask:0x3
  buffer_load_dwordx4 v63, s[32:35], 0 offen lds
  s_nop 0
  v_add_u32_dpp v62, v43, v2 row_newbcast:8 row_mask:0xf bank_mask:0xc
  s_add_u32 m0, s76, 98304
  v_add_u32_dpp v63, v45, v2 row_newbcast:2 row_mask:0xf bank_mask:0x3
  buffer_load_dwordx4 v64, s[32:35], 0 offen lds
  s_nop 0
  v_add_u32_dpp v63, v47, v2 row_newbcast:8 row_mask:0xf bank_mask:0xc
  s_add_u32 m0, s76, 100352
  v_add_u32_dpp v64, v49, v2 row_newbcast:2 row_mask:0xf bank_mask:0x3
  buffer_load_dwordx4 v65, s[32:35], 0 offen lds
  s_nop 0
  v_add_u32_dpp v64, v51, v2 row_newbcast:8 row_mask:0xf bank_mask:0xc
  v_add_u32_dpp v65, v53, v2 row_newbcast:2 row_mask:0xf bank_mask:0x3
  s_nop 1
  v_add_u32_dpp v65, v55, v2 row_newbcast:8 row_mask:0xf bank_mask:0xc
  v_lshlrev_b32 v101, 7, v70
  s_mov_b32 exec_lo, 0xffffffff
  s_mov_b32 exec_hi, 0x0
  buffer_load_dword v102, v101, s[32:35], 0 offen
  s_mov_b64 exec, -1
  v_mov_b32 v70, v71
  v_mov_b32 v71, v72
  v_mov_b32 v72, v73
  v_mov_b32_e64 v73, v74
  v_mov_b32 v74, 0xffffff
  s_waitcnt vmcnt(11)
  s_barrier
  s_add_u32 m0, s75, 131072
  s_nop 0
  buffer_load_dwordx4 v4, s[44:47], s74 offen lds
  s_add_u32 m0, s75, 132096
  s_nop 0
  buffer_load_dwordx4 v5, s[44:47], s74 offen lds
  s_add_u32 s74, s74, 106496
  s_add_u32 m0, s75, 139264
  s_nop 0
  buffer_load_dwordx4 v4, s[44:47], s74 offen lds
  s_add_u32 m0, s75, 140288
  s_nop 0
  buffer_load_dwordx4 v5, s[44:47], s74 offen lds
  s_add_u32 s74, s74, 106496
  s_add_u32 m0, s76, 0
  s_nop 0
  buffer_load_dwordx4 v56, s[32:35], 0 offen lds
  s_add_u32 m0, s76, 2048
  v_add_u32_dpp v56, v18, v2 row_newbcast:2 row_mask:0xf bank_mask:0x3
  buffer_load_dwordx4 v57, s[32:35], 0 offen lds
  s_nop 0
  v_add_u32_dpp v56, v16, v2 row_newbcast:9 row_mask:0xf bank_mask:0xc
  s_add_u32 m0, s76, 4096
  v_add_u32_dpp v57, v22, v2 row_newbcast:2 row_mask:0xf bank_mask:0x3
  buffer_load_dwordx4 v58, s[32:35], 0 offen lds
  s_nop 0
  v_add_u32_dpp v57, v20, v2 row_newbcast:9 row_mask:0xf bank_mask:0xc
  s_add_u32 m0, s76, 6144
  v_add_u32_dpp v58, v26, v2 row_newbcast:2 row_mask:0xf bank_mask:0x3
  buffer_load_dwordx4 v59, s[32:35], 0 offen lds
  s_nop 0
  v_add_u32_dpp v58, v24, v2 row_newbcast:9 row_mask:0xf bank_mask:0xc
  s_add_u32 m0, s76, 8192
  v_add_u32_dpp v59, v30, v2 row_newbcast:2 row_mask:0xf bank_mask:0x3
  buffer_load_dwordx4 v60, s[32:35], 0 offen lds
  s_nop 0
  v_add_u32_dpp v59, v28, v2 row_newbcast:9 row_mask:0xf bank_mask:0xc
  s_add_u32 m0, s76, 10240
  v_add_u32_dpp v60, v34, v2 row_newbcast:2 row_mask:0xf bank_mask:0x3
  buffer_load_dwordx4 v61, s[32:35], 0 offen lds
  s_nop 0
  v_add_u32_dpp v60, v32, v2 row_newbcast:9 row_mask:0xf bank_mask:0xc
  s_add_u32 m0, s76, 12288
  v_add_u32_dpp v61, v38, v2 row_newbcast:2 row_mask:0xf bank_mask:0x3
  buffer_load_dwordx4 v62, s[32:35], 0 offen lds
  s_nop 0
  v_add_u32_dpp v61, v36, v2 row_newbcast:9 row_mask:0xf bank_mask:0xc
  s_add_u32 m0, s76, 14336
  v_add_u32_dpp v62, v42, v2 row_newbcast:2 row_mask:0xf bank_mask:0x3
  buffer_load_dwordx4 v63, s[32:35], 0 offen lds
  s_nop 0
  v_add_u32_dpp v62, v40, v2 row_newbcast:9 row_mask:0xf bank_mask:0xc
  s_add_u32 m0, s76, 16384
  v_add_u32_dpp v63, v46, v2 row_newbcast:2 row_mask:0xf bank_mask:0x3
  buffer_load_dwordx4 v64, s[32:35], 0 offen lds
  s_nop 0
  v_add_u32_dpp v63, v44, v2 row_newbcast:9 row_mask:0xf bank_mask:0xc
  s_add_u32 m0, s76, 18432
  v_add_u32_dpp v64, v50, v2 row_newbcast:2 row_mask:0xf bank_mask:0x3
  buffer_load_dwordx4 v65, s[32:35], 0 offen lds
  s_nop 0
  v_add_u32_dpp v64, v48, v2 row_newbcast:9 row_mask:0xf bank_mask:0xc
  v_add_u32_dpp v65, v54, v2 row_newbcast:2 row_mask:0xf bank_mask:0x3
  s_nop 1
  v_add_u32_dpp v65, v52, v2 row_newbcast:9 row_mask:0xf bank_mask:0xc
  s_waitcnt vmcnt(10)
  s_barrier
  s_add_u32 m0, s75, 147456
  s_nop 0
  buffer_load_dwordx4 v4, s[44:47], s74 offen lds
  s_add_u32 m0, s75, 148480
  s_nop 0
  buffer_load_dwordx4 v5, s[44:47], s74 offen lds
  s_add_u32 s74, s74, 106496
  s_add_u32 m0, s75, 155648
  s_nop 0
  buffer_load_dwordx4 v4, s[44:47], s74 offen lds
  s_add_u32 m0, s75, 156672
  s_nop 0
  buffer_load_dwordx4 v5, s[44:47], s74 offen lds
  s_add_u32 s74, s74, 106496
  s_add_u32 m0, s76, 40960
  s_nop 0
  buffer_load_dwordx4 v56, s[32:35], 0 offen lds
  s_add_u32 m0, s76, 43008
  v_add_u32_dpp v56, v19, v2 row_newbcast:2 row_mask:0xf bank_mask:0x3
  buffer_load_dwordx4 v57, s[32:35], 0 offen lds
  s_nop 0
  v_add_u32_dpp v56, v17, v2 row_newbcast:9 row_mask:0xf bank_mask:0xc
  s_add_u32 m0, s76, 45056
  v_add_u32_dpp v57, v23, v2 row_newbcast:2 row_mask:0xf bank_mask:0x3
  buffer_load_dwordx4 v58, s[32:35], 0 offen lds
  s_nop 0
  v_add_u32_dpp v57, v21, v2 row_newbcast:9 row_mask:0xf bank_mask:0xc
  s_add_u32 m0, s76, 47104
  v_add_u32_dpp v58, v27, v2 row_newbcast:2 row_mask:0xf bank_mask:0x3
  buffer_load_dwordx4 v59, s[32:35], 0 offen lds
  s_nop 0
  v_add_u32_dpp v58, v25, v2 row_newbcast:9 row_mask:0xf bank_mask:0xc
  s_add_u32 m0, s76, 49152
  v_add_u32_dpp v59, v31, v2 row_newbcast:2 row_mask:0xf bank_mask:0x3
  buffer_load_dwordx4 v60, s[32:35], 0 offen lds
  s_nop 0
  v_add_u32_dpp v59, v29, v2 row_newbcast:9 row_mask:0xf bank_mask:0xc
  s_add_u32 m0, s76, 51200
  v_add_u32_dpp v60, v35, v2 row_newbcast:2 row_mask:0xf bank_mask:0x3
  buffer_load_dwordx4 v61, s[32:35], 0 offen lds
  s_nop 0
  v_add_u32_dpp v60, v33, v2 row_newbcast:9 row_mask:0xf bank_mask:0xc
  s_add_u32 m0, s76, 53248
  v_add_u32_dpp v61, v39, v2 row_newbcast:2 row_mask:0xf bank_mask:0x3
  buffer_load_dwordx4 v62, s[32:35], 0 offen lds
  s_nop 0
  v_add_u32_dpp v61, v37, v2 row_newbcast:9 row_mask:0xf bank_mask:0xc
  s_add_u32 m0, s76, 55296
  v_add_u32_dpp v62, v43, v2 row_newbcast:2 row_mask:0xf bank_mask:0x3
  buffer_load_dwordx4 v63, s[32:35], 0 offen lds
  s_nop 0
  v_add_u32_dpp v62, v41, v2 row_newbcast:9 row_mask:0xf bank_mask:0xc
  s_add_u32 m0, s76, 57344
  v_add_u32_dpp v63, v47, v2 row_newbcast:2 row_mask:0xf bank_mask:0x3
  buffer_load_dwordx4 v64, s[32:35], 0 offen lds
  s_nop 0
  v_add_u32_dpp v63, v45, v2 row_newbcast:9 row_mask:0xf bank_mask:0xc
  s_add_u32 m0, s76, 59392
  v_add_u32_dpp v64, v51, v2 row_newbcast:2 row_mask:0xf bank_mask:0x3
  buffer_load_dwordx4 v65, s[32:35], 0 offen lds
  s_nop 0
  v_add_u32_dpp v64, v49, v2 row_newbcast:9 row_mask:0xf bank_mask:0xc
  v_add_u32_dpp v65, v55, v2 row_newbcast:2 row_mask:0xf bank_mask:0x3
  s_nop 1
  v_add_u32_dpp v65, v53, v2 row_newbcast:9 row_mask:0xf bank_mask:0xc
  s_waitcnt vmcnt(10)
  s_cmp_lg_u32 s72, 1
  s_cbranch_scc1 L_nolpf
  s_mov_b64 exec, 1048575
  global_load_dword v10, v[8:9], off
  s_mov_b64 exec, -1
  s_mov_b32 m0, 123136
  s_mov_b64 exec, 0xffff
  buffer_load_dwordx4 v11, s[52:55], s77 offen lds
  s_mov_b64 exec, -1
L_nolpf:
  s_barrier
  s_add_u32 m0, s75, 131072
  s_nop 0
  buffer_load_dwordx4 v4, s[44:47], s74 offen lds
  s_add_u32 m0, s75, 132096
  s_nop 0
  buffer_load_dwordx4 v5, s[44:47], s74 offen lds
  s_add_u32 s74, s74, 106496
  s_add_u32 m0, s75, 139264
  s_nop 0
  buffer_load_dwordx4 v4, s[44:47], s74 offen lds
  s_add_u32 m0, s75, 140288
  s_nop 0
  buffer_load_dwordx4 v5, s[44:47], s74 offen lds
  s_add_u32 s74, s74, 106496
  s_add_u32 m0, s76, 81920
  s_nop 0
  buffer_load_dwordx4 v56, s[32:35], 0 offen lds
  s_add_u32 m0, s76, 83968
  v_add_u32_dpp v56, v16, v2 row_newbcast:3 row_mask:0xf bank_mask:0x3
  buffer_load_dwordx4 v57, s[32:35], 0 offen lds
  s_nop 0
  v_add_u32_dpp v56, v18, v2 row_newbcast:9 row_mask:0xf bank_mask:0xc
  s_add_u32 m0, s76, 86016
  v_add_u32_dpp v57, v20, v2 row_newbcast:3 row_mask:0xf bank_mask:0x3
  buffer_load_dwordx4 v58, s[32:35], 0 offen lds
  s_nop 0
  v_add_u32_dpp v57, v22, v2 row_newbcast:9 row_mask:0xf bank_mask:0xc
  s_add_u32 m0, s76, 88064
  v_add_u32_dpp v58, v24, v2 row_newbcast:3 row_mask:0xf bank_mask:0x3
  buffer_load_dwordx4 v59, s[32:35], 0 offen lds
  s_nop 0
  v_add_u32_dpp v58, v26, v2 row_newbcast:9 row_mask:0xf bank_mask:0xc
  s_add_u32 m0, s76, 90112
  v_add_u32_dpp v59, v28, v2 row_newbcast:3 row_mask:0xf bank_mask:0x3
  buffer_load_dwordx4 v60, s[32:35], 0 offen lds
  s_nop 0
  v_add_u32_dpp v59, v30, v2 row_newbcast:9 row_mask:0xf bank_mask:0xc
  s_add_u32 m0, s76, 92160
  v_add_u32_dpp v60, v32, v2 row_newbcast:3 row_mask:0xf bank_mask:0x3
  buffer_load_dwordx4 v61, s[32:35], 0 offen lds
  s_nop 0
  v_add_u32_dpp v60, v34, v2 row_newbcast:9 row_mask:0xf bank_mask:0xc
  s_add_u32 m0, s76, 94208
  v_add_u32_dpp v61, v36, v2 row_newbcast:3 row_mask:0xf bank_mask:0x3
  buffer_load_dwordx4 v62, s[32:35], 0 offen lds
  s_nop 0
  v_add_u32_dpp v61, v38, v2 row_newbcast:9 row_mask:0xf bank_mask:0xc
  s_add_u32 m0, s76, 96256
  v_add_u32_dpp v62, v40, v2 row_newbcast:3 row_mask:0xf bank_mask:0x3
  buffer_load_dwordx4 v63, s[32:35], 0 offen lds
  s_nop 0
  v_add_u32_dpp v62, v42, v2 row_newbcast:9 row_mask:0xf bank_mask:0xc
  s_add_u32 m0, s76, 98304
  v_add_u32_dpp v63, v44, v2 row_newbcast:3 row_mask:0xf bank_mask:0x3
  buffer_load_dwordx4 v64, s[32:35], 0 offen lds
  s_nop 0
  v_add_u32_dpp v63, v46, v2 row_newbcast:9 row_mask:0xf bank_mask:0xc
  s_add_u32 m0, s76, 100352
  v_add_u32_dpp v64, v48, v2 row_newbcast:3 row_mask:0xf bank_mask:0x3
  buffer_load_dwordx4 v65, s[32:35], 0 offen lds
  s_nop 0
  v_add_u32_dpp v64, v50, v2 row_newbcast:9 row_mask:0xf bank_mask:0xc
  v_add_u32_dpp v65, v52, v2 row_newbcast:3 row_mask:0xf bank_mask:0x3
  s_nop 1
  v_add_u32_dpp v65, v54, v2 row_newbcast:9 row_mask:0xf bank_mask:0xc
  s_mov_b64 exec, 0x3ff
  buffer_load_dword v103, v84, s[44:47], s85 offen
  s_mov_b64 exec, -1
  s_add_u32 s85, s85, 865280
  s_waitcnt vmcnt(11)
  s_barrier
  s_add_u32 m0, s75, 147456
  s_nop 0
  buffer_load_dwordx4 v4, s[44:47], s74 offen lds
  s_add_u32 m0, s75, 148480
  s_nop 0
  buffer_load_dwordx4 v5, s[44:47], s74 offen lds
  s_add_u32 s74, s74, 106496
  s_add_u32 m0, s75, 155648
  s_nop 0
  buffer_load_dwordx4 v4, s[44:47], s74 offen lds
  s_add_u32 m0, s75, 156672
  s_nop 0
  buffer_load_dwordx4 v5, s[44:47], s74 offen lds
  s_add_u32 s74, s74, 106496
  s_add_u32 m0, s76, 0
  s_nop 0
  buffer_load_dwordx4 v56, s[32:35], 0 offen lds
  s_add_u32 m0, s76, 2048
  v_add_u32_dpp v56, v17, v2 row_newbcast:3 row_mask:0xf bank_mask:0x3
  buffer_load_dwordx4 v57, s[32:35], 0 offen lds
  s_nop 0
  v_add_u32_dpp v56, v19, v2 row_newbcast:9 row_mask:0xf bank_mask:0xc
  s_add_u32 m0, s76, 4096
  v_add_u32_dpp v57, v21, v2 row_newbcast:3 row_mask:0xf bank_mask:0x3
  buffer_load_dwordx4 v58, s[32:35], 0 offen lds
  s_nop 0
  v_add_u32_dpp v57, v23, v2 row_newbcast:9 row_mask:0xf bank_mask:0xc
  s_add_u32 m0, s76, 6144
  v_add_u32_dpp v58, v25, v2 row_newbcast:3 row_mask:0xf bank_mask:0x3
  buffer_load_dwordx4 v59, s[32:35], 0 offen lds
  s_nop 0
  v_add_u32_dpp v58, v27, v2 row_newbcast:9 row_mask:0xf bank_mask:0xc
  s_add_u32 m0, s76, 8192
  v_add_u32_dpp v59, v29, v2 row_newbcast:3 row_mask:0xf bank_mask:0x3
  buffer_load_dwordx4 v60, s[32:35], 0 offen lds
  s_nop 0
  v_add_u32_dpp v59, v31, v2 row_newbcast:9 row_mask:0xf bank_mask:0xc
  s_add_u32 m0, s76, 10240
  v_add_u32_dpp v60, v33, v2 row_newbcast:3 row_mask:0xf bank_mask:0x3
  buffer_load_dwordx4 v61, s[32:35], 0 offen lds
  s_nop 0
  v_add_u32_dpp v60, v35, v2 row_newbcast:9 row_mask:0xf bank_mask:0xc
  s_add_u32 m0, s76, 12288
  v_add_u32_dpp v61, v37, v2 row_newbcast:3 row_mask:0xf bank_mask:0x3
  buffer_load_dwordx4 v62, s[32:35], 0 offen lds
  s_nop 0
  v_add_u32_dpp v61, v39, v2 row_newbcast:9 row_mask:0xf bank_mask:0xc
  s_add_u32 m0, s76, 14336
  v_add_u32_dpp v62, v41, v2 row_newbcast:3 row_mask:0xf bank_mask:0x3
  buffer_load_dwordx4 v63, s[32:35], 0 offen lds
  s_nop 0
  v_add_u32_dpp v62, v43, v2 row_newbcast:9 row_mask:0xf bank_mask:0xc
  s_add_u32 m0, s76, 16384
  v_add_u32_dpp v63, v45, v2 row_newbcast:3 row_mask:0xf bank_mask:0x3
  buffer_load_dwordx4 v64, s[32:35], 0 offen lds
  s_nop 0
  v_add_u32_dpp v63, v47, v2 row_newbcast:9 row_mask:0xf bank_mask:0xc
  s_add_u32 m0, s76, 18432
  v_add_u32_dpp v64, v49, v2 row_newbcast:3 row_mask:0xf bank_mask:0x3
  buffer_load_dwordx4 v65, s[32:35], 0 offen lds
  s_nop 0
  v_add_u32_dpp v64, v51, v2 row_newbcast:9 row_mask:0xf bank_mask:0xc
  v_add_u32_dpp v65, v53, v2 row_newbcast:3 row_mask:0xf bank_mask:0x3
  s_nop 1
  v_add_u32_dpp v65, v55, v2 row_newbcast:9 row_mask:0xf bank_mask:0xc
  v_lshlrev_b32 v101, 7, v70
  s_mov_b32 exec_lo, 0xffffffff
  s_mov_b32 exec_hi, 0x0
  buffer_load_dword v102, v101, s[32:35], 0 offen
  s_mov_b64 exec, -1
  v_mov_b32 v70, v71
  v_mov_b32 v71, v72
  v_mov_b32 v72, v73
  v_mov_b32_e64 v73, v74
  v_mov_b32 v74, 0xffffff
  s_waitcnt vmcnt(11)
  s_barrier
  s_add_u32 m0, s75, 131072
  s_nop 0
  buffer_load_dwordx4 v4, s[44:47], s74 offen lds
  s_add_u32 m0, s75, 132096
  s_nop 0
  buffer_load_dwordx4 v5, s[44:47], s74 offen lds
  s_add_u32 s74, s74, 106496
  s_add_u32 m0, s75, 139264
  s_nop 0
  buffer_load_dwordx4 v4, s[44:47], s74 offen lds
  s_add_u32 m0, s75, 140288
  s_nop 0
  buffer_load_dwordx4 v5, s[44:47], s74 offen lds
  s_add_u32 s74, s74, 106496
  s_add_u32 m0, s76, 40960
  s_nop 0
  buffer_load_dwordx4 v56, s[32:35], 0 offen lds
  s_add_u32 m0, s76, 43008
  v_add_u32_dpp v56, v18, v2 row_newbcast:3 row_mask:0xf bank_mask:0x3
  buffer_load_dwordx4 v57, s[32:35], 0 offen lds
  s_nop 0
  v_add_u32_dpp v56, v16, v2 row_newbcast:10 row_mask:0xf bank_mask:0xc
  s_add_u32 m0, s76, 45056
  v_add_u32_dpp v57, v22, v2 row_newbcast:3 row_mask:0xf bank_mask:0x3
  buffer_load_dwordx4 v58, s[32:35], 0 offen lds
  s_nop 0
  v_add_u32_dpp v57, v20, v2 row_newbcast:10 row_mask:0xf bank_mask:0xc
  s_add_u32 m0, s76, 47104
  v_add_u32_dpp v58, v26, v2 row_newbcast:3 row_mask:0xf bank_mask:0x3
  buffer_load_dwordx4 v59, s[32:35], 0 offen lds
  s_nop 0
  v_add_u32_dpp v58, v24, v2 row_newbcast:10 row_mask:0xf bank_mask:0xc
  s_add_u32 m0, s76, 49152
  v_add_u32_dpp v59, v30, v2 row_newbcast:3 row_mask:0xf bank_mask:0x3
  buffer_load_dwordx4 v60, s[32:35], 0 offen lds
  s_nop 0
  v_add_u32_dpp v59, v28, v2 row_newbcast:10 row_mask:0xf bank_mask:0xc
  s_add_u32 m0, s76, 51200
  v_add_u32_dpp v60, v34, v2 row_newbcast:3 row_mask:0xf bank_mask:0x3
  buffer_load_dwordx4 v61, s[32:35], 0 offen lds
  s_nop 0
  v_add_u32_dpp v60, v32, v2 row_newbcast:10 row_mask:0xf bank_mask:0xc
  s_add_u32 m0, s76, 53248
  v_add_u32_dpp v61, v38, v2 row_newbcast:3 row_mask:0xf bank_mask:0x3
  buffer_load_dwordx4 v62, s[32:35], 0 offen lds
  s_nop 0
  v_add_u32_dpp v61, v36, v2 row_newbcast:10 row_mask:0xf bank_mask:0xc
  s_add_u32 m0, s76, 55296
  v_add_u32_dpp v62, v42, v2 row_newbcast:3 row_mask:0xf bank_mask:0x3
  buffer_load_dwordx4 v63, s[32:35], 0 offen lds
  s_nop 0
  v_add_u32_dpp v62, v40, v2 row_newbcast:10 row_mask:0xf bank_mask:0xc
  s_add_u32 m0, s76, 57344
  v_add_u32_dpp v63, v46, v2 row_newbcast:3 row_mask:0xf bank_mask:0x3
  buffer_load_dwordx4 v64, s[32:35], 0 offen lds
  s_nop 0
  v_add_u32_dpp v63, v44, v2 row_newbcast:10 row_mask:0xf bank_mask:0xc
  s_add_u32 m0, s76, 59392
  v_add_u32_dpp v64, v50, v2 row_newbcast:3 row_mask:0xf bank_mask:0x3
  buffer_load_dwordx4 v65, s[32:35], 0 offen lds
  s_nop 0
  v_add_u32_dpp v64, v48, v2 row_newbcast:10 row_mask:0xf bank_mask:0xc
  v_add_u32_dpp v65, v54, v2 row_newbcast:3 row_mask:0xf bank_mask:0x3
  s_nop 1
  v_add_u32_dpp v65, v52, v2 row_newbcast:10 row_mask:0xf bank_mask:0xc
  v_mov_b32_dpp v16, v16 row_shl:3 row_mask:0xf bank_mask:0xf
  v_mov_b32_dpp v18, v18 row_shl:3 row_mask:0xf bank_mask:0xf
  v_mov_b32_dpp v20, v20 row_shl:3 row_mask:0xf bank_mask:0xf
  v_mov_b32_dpp v22, v22 row_shl:3 row_mask:0xf bank_mask:0xf
  v_mov_b32_dpp v24, v24 row_shl:3 row_mask:0xf bank_mask:0xf
  v_mov_b32_dpp v26, v26 row_shl:3 row_mask:0xf bank_mask:0xf
  v_mov_b32_dpp v28, v28 row_shl:3 row_mask:0xf bank_mask:0xf
  v_mov_b32_dpp v30, v30 row_shl:3 row_mask:0xf bank_mask:0xf
  v_mov_b32_dpp v32, v32 row_shl:3 row_mask:0xf bank_mask:0xf
  v_mov_b32_dpp v34, v34 row_shl:3 row_mask:0xf bank_mask:0xf
  v_mov_b32_dpp v36, v36 row_shl:3 row_mask:0xf bank_mask:0xf
  v_mov_b32_dpp v38, v38 row_shl:3 row_mask:0xf bank_mask:0xf
  v_mov_b32_dpp v40, v40 row_shl:3 row_mask:0xf bank_mask:0xf
  v_mov_b32_dpp v42, v42 row_shl:3 row_mask:0xf bank_mask:0xf
  v_mov_b32_dpp v44, v44 row_shl:3 row_mask:0xf bank_mask:0xf
  v_mov_b32_dpp v46, v46 row_shl:3 row_mask:0xf bank_mask:0xf
  v_mov_b32_dpp v48, v48 row_shl:3 row_mask:0xf bank_mask:0xf
  v_mov_b32_dpp v50, v50 row_shl:3 row_mask:0xf bank_mask:0xf
  v_mov_b32_dpp v52, v52 row_shl:3 row_mask:0xf bank_mask:0xf
  v_mov_b32_dpp v54, v54 row_shl:3 row_mask:0xf bank_mask:0xf
  s_waitcnt vmcnt(10)
  s_barrier
  s_add_u32 m0, s75, 147456
  s_nop 0
  buffer_load_dwordx4 v4, s[44:47], s74 offen lds
  s_add_u32 m0, s75, 148480
  s_nop 0
  buffer_load_dwordx4 v5, s[44:47], s74 offen lds
  s_add_u32 s74, s74, 106496
  s_add_u32 m0, s75, 155648
  s_nop 0
  buffer_load_dwordx4 v4, s[44:47], s74 offen lds
  s_add_u32 m0, s75, 156672
  s_nop 0
  buffer_load_dwordx4 v5, s[44:47], s74 offen lds
  s_add_u32 s74, s74, 106496
  s_cmp_eq_u32 s72, 1
  s_cbranch_scc1 L_ld_tail0
  s_add_u32 m0, s76, 81920
  s_nop 0
  buffer_load_dwordx4 v56, s[32:35], 0 offen lds
  s_add_u32 m0, s76, 83968
  v_add_u32_dpp v56, v19, v2 row_newbcast:3 row_mask:0xf bank_mask:0x3
  buffer_load_dwordx4 v57, s[32:35], 0 offen lds
  s_nop 0
  v_add_u32_dpp v56, v17, v2 row_newbcast:10 row_mask:0xf bank_mask:0xc
  s_add_u32 m0, s76, 86016
  v_add_u32_dpp v57, v23, v2 row_newbcast:3 row_mask:0xf bank_mask:0x3
  buffer_load_dwordx4 v58, s[32:35], 0 offen lds
  s_nop 0
  v_add_u32_dpp v57, v21, v2 row_newbcast:10 row_mask:0xf bank_mask:0xc
  s_add_u32 m0, s76, 88064
  v_add_u32_dpp v58, v27, v2 row_newbcast:3 row_mask:0xf bank_mask:0x3
  buffer_load_dwordx4 v59, s[32:35], 0 offen lds
  s_nop 0
  v_add_u32_dpp v58, v25, v2 row_newbcast:10 row_mask:0xf bank_mask:0xc
  s_add_u32 m0, s76, 90112
  v_add_u32_dpp v59, v31, v2 row_newbcast:3 row_mask:0xf bank_mask:0x3
  buffer_load_dwordx4 v60, s[32:35], 0 offen lds
  s_nop 0
  v_add_u32_dpp v59, v29, v2 row_newbcast:10 row_mask:0xf bank_mask:0xc
  s_add_u32 m0, s76, 92160
  v_add_u32_dpp v60, v35, v2 row_newbcast:3 row_mask:0xf bank_mask:0x3
  buffer_load_dwordx4 v61, s[32:35], 0 offen lds
  s_nop 0
  v_add_u32_dpp v60, v33, v2 row_newbcast:10 row_mask:0xf bank_mask:0xc
  s_add_u32 m0, s76, 94208
  v_add_u32_dpp v61, v39, v2 row_newbcast:3 row_mask:0xf bank_mask:0x3
  buffer_load_dwordx4 v62, s[32:35], 0 offen lds
  s_nop 0
  v_add_u32_dpp v61, v37, v2 row_newbcast:10 row_mask:0xf bank_mask:0xc
  s_add_u32 m0, s76, 96256
  v_add_u32_dpp v62, v43, v2 row_newbcast:3 row_mask:0xf bank_mask:0x3
  buffer_load_dwordx4 v63, s[32:35], 0 offen lds
  s_nop 0
  v_add_u32_dpp v62, v41, v2 row_newbcast:10 row_mask:0xf bank_mask:0xc
  s_add_u32 m0, s76, 98304
  v_add_u32_dpp v63, v47, v2 row_newbcast:3 row_mask:0xf bank_mask:0x3
  buffer_load_dwordx4 v64, s[32:35], 0 offen lds
  s_nop 0
  v_add_u32_dpp v63, v45, v2 row_newbcast:10 row_mask:0xf bank_mask:0xc
  s_add_u32 m0, s76, 100352
  v_add_u32_dpp v64, v51, v2 row_newbcast:3 row_mask:0xf bank_mask:0x3
  buffer_load_dwordx4 v65, s[32:35], 0 offen lds
  s_nop 0
  v_add_u32_dpp v64, v49, v2 row_newbcast:10 row_mask:0xf bank_mask:0xc
  v_add_u32_dpp v65, v55, v2 row_newbcast:3 row_mask:0xf bank_mask:0x3
  s_nop 1
  v_add_u32_dpp v65, v53, v2 row_newbcast:10 row_mask:0xf bank_mask:0xc
  v_mov_b32_dpp v17, v17 row_shl:3 row_mask:0xf bank_mask:0xf
  v_mov_b32_dpp v19, v19 row_shl:3 row_mask:0xf bank_mask:0xf
  v_mov_b32_dpp v21, v21 row_shl:3 row_mask:0xf bank_mask:0xf
  v_mov_b32_dpp v23, v23 row_shl:3 row_mask:0xf bank_mask:0xf
  v_mov_b32_dpp v25, v25 row_shl:3 row_mask:0xf bank_mask:0xf
  v_mov_b32_dpp v27, v27 row_shl:3 row_mask:0xf bank_mask:0xf
  v_mov_b32_dpp v29, v29 row_shl:3 row_mask:0xf bank_mask:0xf
  v_mov_b32_dpp v31, v31 row_shl:3 row_mask:0xf bank_mask:0xf
  v_mov_b32_dpp v33, v33 row_shl:3 row_mask:0xf bank_mask:0xf
  v_mov_b32_dpp v35, v35 row_shl:3 row_mask:0xf bank_mask:0xf
  v_mov_b32_dpp v37, v37 row_shl:3 row_mask:0xf bank_mask:0xf
  v_mov_b32_dpp v39, v39 row_shl:3 row_mask:0xf bank_mask:0xf
  v_mov_b32_dpp v41, v41 row_shl:3 row_mask:0xf bank_mask:0xf
  v_mov_b32_dpp v43, v43 row_shl:3 row_mask:0xf bank_mask:0xf
  v_mov_b32_dpp v45, v45 row_shl:3 row_mask:0xf bank_mask:0xf
  v_mov_b32_dpp v47, v47 row_shl:3 row_mask:0xf bank_mask:0xf
  v_mov_b32_dpp v49, v49 row_shl:3 row_mask:0xf bank_mask:0xf
  v_mov_b32_dpp v51, v51 row_shl:3 row_mask:0xf bank_mask:0xf
  v_mov_b32_dpp v53, v53 row_shl:3 row_mask:0xf bank_mask:0xf
  v_mov_b32_dpp v55, v55 row_shl:3 row_mask:0xf bank_mask:0xf
  s_add_u32 s72, s72, 1
  s_cmp_lt_u32 s72, 2
  s_waitcnt vmcnt(10)
  s_cbranch_scc1 L_dnn_loop1
  s_branch L_ld_tail
L_cin:
  v_lshlrev_b32 v1, 4, v0
  s_and_b32 s79, s3, 3
  s_lshr_b32 s84, s3, 2
  s_lshl_b32 s95, s79, 10
  s_mul_i32 s26, s68, 11
  s_add_u32 s26, s26, s69
  s_sub_u32 s26, s26, 22
  s_cmp_eq_u32 s26, 86
  s_cbranch_scc1 L_end
  s_cmp_eq_u32 s84, 0
  s_cbranch_scc1 L_sc
  s_setprio 2
  v_add_u32 v2, L_tables-L_pc+4096, v1
  v_mov_b32_e64 v3, s93
  v_add_co_u32 v2, vcc, s92, v2
  s_nop 1
  v_addc_co_u32 v3, vcc, 0, v3, vcc
  v_add_co_u32 v32, vcc, s95, v2
  s_nop 1
  v_addc_co_u32 v33, vcc, 0, v3, vcc
  global_load_dwordx4 v[224:227], v[2:3], off offset:-4096
  v_add_co_u32 v2, vcc, 0x1800, v2
  s_nop 1
  v_addc_co_u32 v3, vcc, 0, v3, vcc
  global_load_dwordx4 v[240:243], v[2:3], off
  s_cmp_lt_u32 s79, 3
  s_mov_b32 s70, 122176
  s_cselect_b32 s70, 81920, s70
  s_add_u32 m0, s95, 81920
  s_nop 0
  global_load_lds_dwordx4 v[32:33], off offset:-4096
  s_add_u32 m0, s95, s70
  s_nop 0
  global_load_lds_dwordx4 v[32:33], off offset:0
  v_add_co_u32 v32, vcc, 0x2000, v32
  s_nop 1
  v_addc_co_u32 v33, vcc, 0, v33, vcc
  s_add_u32 m0, s95, 2048
  s_nop 0
  global_load_lds_dwordx4 v[32:33], off offset:0
  s_add_u32 m0, s95, 130368
  s_cmp_ge_u32 s79, 2
  s_cbranch_scc1 L_sc
  global_load_lds_dwordx4 v[32:33], off offset:-4096
L_sc:
  s_mul_i32 s85, s84, 20
  s_add_u32 s85, s85, s3
  s_mul_i32 s94, s26, 48
  s_add_u32 s94, s94, s85
  s_mul_i32 s94, s94, 104
  v_lshrrev_b32 v30, 3, v0
  v_lshlrev_b32_e64 v30, 4, v30
  v_and_b32 v29, 0x70, v1
  s_mul_i32 s76, s3, 4064
  s_add_u32 s76, s76, 131136
  s_cmp_eq_u32 s84, 0
  s_cbranch_scc1 L_g0
  s_sub_u32 s68, s71, 22
  s_min_u32 s68, s68, 9
  s_lshl_b32 s68, s68, 2
  s_add_u32 s68, s68, s79
  s_lshl_b32 s68, s68, 7
  v_mul_u32_u24 v31, 5120, v0
  s_waitcnt lgkmcnt(0)
  s_mov_b32 s36, s8
  s_and_b32 s37, s9, 0xffff
  s_mov_b32 s38, 105456
  s_mov_b32 s39, 0x20000
  buffer_load_dword v107, v31, s[36:39], s68 offen
  s_waitcnt lgkmcnt(0)
  s_mov_b32 s40, s10
  s_and_b32 s41, s11, 0xffff
  s_mov_b32 s42, 156
  s_mov_b32 s43, 0x20000
  s_mov_b32 m0, 129472
  s_mov_b64 exec, 0x7ff
  buffer_load_dwordx4 v1, s[40:43], 0 offen lds
  s_mov_b64 exec, -1
  s_barrier
  s_lshl_b32 s85, s85, 2
  s_add_u32 s85, s85, 129728
  s_mul_i32 s72, s84, 3
  s_sub_u32 s72, 4, s72
  s_cmp_eq_u32 s26, 85
  s_cselect_b32 s72, s72, 6
  s_lshl_b32 s52, s3, 7
  s_mul_i32 s53, s3, 5280
  s_lshl_b32 s54, s3, 2
  s_lshl_b32 s55, s3, 1
  s_lshl_b32 s82, s3, 12
  s_and_b32 s98, s3, 1
  s_lshr_b32 s99, s3, 1
  s_mul_i32 s68, s99, 3072
  s_lshl_b32 s83, s98, 3
  s_add_u32 s68, s68, s83
  v_add_u32 v59, s68, v1
  s_lshl_b32 s69, s99, 3
  s_lshr_b32 s69, 0x05030200, s69
  s_and_b32 s69, s69, 0xff
  s_lshl_b32 s69, s69, 9
  s_lshl_b32 s70, s98, 2
  s_add_u32 s91, s69, s70
  s_mov_b32 s99, 0x05040100
  s_mov_b32 s100, 0x07060302
  v_mov_b32 v2, 129664
  v_mov_b32 v109, 0
  v_mov_b32 v108, 0
  v_mov_b64 v[32:33], 0
  v_mov_b64 v[34:35], 0
  v_mov_b64 v[36:37], 0
  v_mov_b64 v[38:39], 0
  v_mov_b64 v[40:41], 0
  v_mov_b64 v[42:43], 0
  v_mov_b64 v[44:45], 0
  v_mov_b64 v[46:47], 0
  v_mov_b64 v[48:49], 0
  v_mov_b64 v[50:51], 0
  v_mov_b64 v[52:53], 0
  v_mov_b64 v[54:55], 0
  v_mov_b64 v[56:57], 0
  v_add_u32 v250, 77824, v1
  s_waitcnt vmcnt(7)
  v_add_u32 v251, 125248, v1
  v_lshrrev_b32 v3, 5, v0
  v_lshl_add_u32 v3, v3, 2, v2
  s_mov_b32 s28, s4
  s_and_b32 s29, s5, 0xffff
  s_mov_b32 s30, 425984
  s_mov_b32 s31, 0x20000
  s_mov_b32 s32, s6
  s_and_b32 s33, s7, 0xffff
  s_mov_b32 s34, 12800000
  s_mov_b32 s35, 0x20000
  v_and_b32 v13, 31, v0
  v_min_u32 v13, 25, v13
  v_lshrrev_b32 v14, 5, v0
  v_mul_u32_u24 v14, 416, v14
  v_lshl_add_u32 v13, v13, 2, v14
  buffer_load_dword v14, v13, s[28:31], s94 offen
  ds_write_b128 v2, v[32:35] offset:16
  s_lshl_b32 s68, s79, 6
  v_add_u32 v29, s68, v0
  v_mul_u32_u24 v30, 2521, v29
  v_lshrrev_b32 v30, 16, v30
  v_mul_u32_u24 v30, 12, v30
  v_lshl_add_u32 v28, v29, 1, v30
  v_add_u32 v29, 256, v29
  v_mul_u32_u24 v30, 2521, v29
  v_lshrrev_b32 v30, 16, v30
  v_mul_u32_u24 v30, 12, v30
  v_lshl_add_u32 v58, v29, 1, v30
  v_add_u32 v29, 256, v29
  v_mul_u32_u24 v30, 2521, v29
  v_lshrrev_b32 v30, 16, v30
  v_mul_u32_u24 v30, 12, v30
  v_lshl_add_u32 v111, v29, 1, v30
  v_cmp_gt_u32 vcc, 676, v29
  s_nop 0
  s_mov_b64 s[92:93], vcc
  v_lshlrev_b32 v29, 3, v0
  s_mov_b32 exec_hi, 0xffff
  ds_write_b64 v29, v[32:33] offset:1664
  s_mov_b32 exec_hi, -1
  s_waitcnt vmcnt(6)
  ds_write_b32 v243, v32
  ds_write_b32 v243, v32 offset:43328
  s_waitcnt vmcnt(1)
  ds_read_b64 v[112:113], v240 offset:0
  ds_read_b64 v[114:115], v240 offset:8
  ds_read_b64 v[116:117], v240 offset:32
  ds_read_b64 v[118:119], v240 offset:40
  ds_read_u16 v110, v241
  s_mov_b64 exec, 0x3ffffff
  s_waitcnt lgkmcnt(0)
  ds_write_b16 v242, v110
  v_lshlrev_b32 v109, 17, v110
  v_lshrrev_b32 v109, 1, v109
  s_mov_b64 exec, -1
  v_add_u32 v225, s52, v225
  v_add_u32 v226, s52, v226
  v_add_u32_e64 v227, s52, v227
  s_waitcnt lgkmcnt(0)
  s_barrier
  ds_read_b64_tr_b16 v[60:61], v225 offset:35328
  ds_read_b64_tr_b16 v[62:63], v225 offset:40736
  ds_read_b64_tr_b16 v[64:65], v226 offset:35328
  ds_read_b64_tr_b16 v[66:67], v227 offset:35328
  ds_read_b64_tr_b16 v[68:69], v225 offset:35392
  ds_read_b64_tr_b16 v[70:71], v225 offset:40800
  ds_read_b64_tr_b16 v[72:73], v226 offset:35392
  ds_read_b64_tr_b16 v[74:75], v227 offset:35392
  ds_read_b64_tr_b16 v[76:77], v225 offset:35840
  ds_read_b64_tr_b16 v[78:79], v225 offset:41248
  ds_read_b64_tr_b16 v[80:81], v226 offset:35840
  ds_read_b64_tr_b16 v[82:83], v227 offset:35840
  ds_read_b64_tr_b16 v[84:85], v225 offset:35904
  ds_read_b64_tr_b16 v[86:87], v225 offset:41312
  ds_read_b64_tr_b16 v[88:89], v226 offset:35904
  ds_read_b64_tr_b16 v[90:91], v227 offset:35904
  s_waitcnt lgkmcnt(14)
  v_mfma_f32_32x32x16_bf16 v[120:135], v[112:115], v[60:63], 0
  s_waitcnt lgkmcnt(12)
  v_mfma_f32_32x32x16_bf16 v[120:135], v[116:119], v[64:67], v[120:135]
  ds_read_b64_tr_b16 v[92:93], v225 offset:36352
  ds_read_b64_tr_b16 v[94:95], v225 offset:41760
  ds_read_b64_tr_b16 v[96:97], v226 offset:36352
  ds_read_b64_tr_b16 v[98:99], v227 offset:36352
  s_waitcnt lgkmcnt(14)
  v_mfma_f32_32x32x16_bf16 v[136:151], v[112:115], v[68:71], 0
  s_waitcnt lgkmcnt(12)
  v_mfma_f32_32x32x16_bf16 v[136:151], v[116:119], v[72:75], v[136:151]
  ds_read_b64_tr_b16 v[100:101], v225 offset:36416
  ds_read_b64_tr_b16 v[102:103], v225 offset:41824
  ds_read_b64_tr_b16 v[104:105], v226 offset:36416
  ds_read_b64_tr_b16 v[106:107], v227 offset:36416
  s_waitcnt lgkmcnt(14)
  v_mfma_f32_32x32x16_bf16 v[152:167], v[112:115], v[76:79], 0
  s_waitcnt lgkmcnt(12)
  v_mfma_f32_32x32x16_bf16 v[152:167], v[116:119], v[80:83], v[152:167]
  s_waitcnt lgkmcnt(10)
  v_mfma_f32_32x32x16_bf16 v[168:183], v[112:115], v[84:87], 0
  s_waitcnt lgkmcnt(8)
  v_mfma_f32_32x32x16_bf16 v[168:183], v[116:119], v[88:91], v[168:183]
  ds_read_b128 v[228:231], v250 offset:6144
  ds_read_b128 v[232:235], v251 offset:0
  ds_read_b128 v[4:7], v250 offset:3072
  ds_read_b128 v[8:11], v251 offset:2048
  ds_read_b128 v[20:23], v250 offset:1024
  ds_read_b128 v[24:27], v250 offset:2048
  ds_read_b128 v[216:219], v250 offset:4096
  ds_read_b128 v[220:223], v250 offset:5120
  ds_read_b128 v[236:239], v251 offset:1024
  s_waitcnt lgkmcnt(14)
  v_mfma_f32_32x32x16_bf16 v[184:199], v[112:115], v[92:95], 0
  s_waitcnt lgkmcnt(13)
  v_mfma_f32_32x32x16_bf16 v[184:199], v[116:119], v[96:99], v[184:199]
  s_waitcnt lgkmcnt(11)
  v_mfma_f32_32x32x16_bf16 v[200:215], v[112:115], v[100:103], 0
  s_waitcnt lgkmcnt(9)
  v_mfma_f32_32x32x16_bf16 v[200:215], v[116:119], v[104:107], v[200:215]
  s_waitcnt lgkmcnt(8)
  v_add_u32 v228, s54, v228
  v_add_u32 v229, s54, v229
  v_add_u32 v231, s83, v231
  v_add_u32 v230, s91, v230
  s_waitcnt lgkmcnt(7)
  v_mad_u32_u24 v232, v233, s3, v232
  v_add_u32 v234, s55, v234
  v_mad_u32_u24 v233, v233, 8, v232
  v_add_u32 v246, s82, v235
  v_add_u32 v247, 2048, v246
  v_add_u32 v31, 0, v234
  v_and_b32 v31, 3, v31
  v_lshl_add_u32 v244, v31, 4, v232
  v_add_u32 v31, 1, v234
  v_and_b32 v31, 3, v31
  v_lshl_add_u32 v245, v31, 4, v232
  v_add_u32 v245, 1664, v245
  v_add_u32 v31, 0, v234
  v_and_b32 v31, 3, v31
  v_lshl_add_u32 v248, v31, 4, v233
  v_add_u32 v31, 1, v234
  v_and_b32 v31, 3, v31
  v_lshl_add_u32 v249, v31, 4, v233
  v_add_u32 v249, 1664, v249
  s_waitcnt lgkmcnt(5)
  v_add_u32 v10, s76, v10
  v_add_u32 v4, s76, v4
  v_add_u32 v5, s76, v5
  ds_write_b32 v10, v7 offset:2880
  v_add_u32 v11, s53, v11
  s_waitcnt lgkmcnt(5)
  v_add_u32 v20, s53, v20
  v_add_u32 v21, s53, v21
  v_add_u32 v22, s53, v22
  v_add_u32 v23, s53, v23
  s_waitcnt lgkmcnt(4)
  v_add_u32 v24, s53, v24
  v_add_u32 v25, s53, v25
  v_add_u32 v26, s53, v26
  v_add_u32 v27, s53, v27
  s_mov_b32 exec_lo, 0
  v_mov_b32 v120, v136
  s_mov_b32 exec_lo, -1
  v_cvt_pk_bf16_f32 v60, 0, v120
  ds_write_b16_d16_hi v28, v60
  v_max_f32 v108, |v60|, v108
  s_mov_b32 exec_lo, 0
  v_mov_b32_e64 v152, v168
  s_mov_b32 exec_lo, -1
  v_cvt_pk_bf16_f32 v61, 0, v152
  ds_write_b16_d16_hi v58, v61
  v_max_f32 v108, |v61|, v108
  s_mov_b32 exec_lo, 0
  v_mov_b32 v184, v200
  s_mov_b32 exec_lo, -1
  v_cvt_pk_bf16_f32 v62, 0, v184
  s_mov_b64 exec, s[92:93]
  ds_write_b16_d16_hi v111, v62
  v_max_f32 v108, |v62|, v108
  s_mov_b64 exec, -1
  s_nop 0
  v_permlane32_swap_b32 v108, v109
  v_max_u32_e64 v108, v108, v109
  s_nop 1
  v_max_u32_dpp v108, v108, v108 row_shr:1 row_mask:0xf bank_mask:0xf
  s_nop 1
  v_max_u32_dpp v108, v108, v108 row_shr:2 row_mask:0xf bank_mask:0xf
  s_nop 1
  v_max_u32_dpp v108, v108, v108 row_shr:4 row_mask:0xf bank_mask:0xf
  s_nop 1
  v_max_u32_dpp v108, v108, v108 row_shr:8 row_mask:0xf bank_mask:0xf
  s_nop 1
  v_max_u32_dpp v108, v108, v108 row_bcast:15 row_mask:0xa bank_mask:0xf
  s_mov_b32 exec_lo, 0x80000000
  s_mov_b32 exec_hi, 0x80000000
  ds_max_u32 v3, v108 offset:24
  s_mov_b64 exec, -1
  s_setprio 0
  s_waitcnt vmcnt(0)
  v_lshlrev_b32 v14, 7, v14
  buffer_load_dword v13, v14, s[32:35], 0 offen
  s_waitcnt lgkmcnt(0)
  s_barrier
  s_branch L_w2
L_g0:
  s_waitcnt lgkmcnt(0)
  s_mov_b32 s36, s8
  s_and_b32 s37, s9, 0xffff
  s_mov_b32 s38, 105456
  s_mov_b32 s39, 0x20000
  s_barrier
  s_add_u32 m0, s95, 41984
  s_add_u32 s81, s95, 70304
  buffer_load_dwordx4 v1, s[36:39], s81 offen lds
  s_add_u32 m0, s95, 46080
  s_add_u32 s81, s95, 74400
  buffer_load_dwordx4 v1, s[36:39], s81 offen lds
  s_add_u32 m0, s95, 50176
  s_add_u32 s81, s95, 78496
  buffer_load_dwordx4 v1, s[36:39], s81 offen lds
  s_add_u32 m0, s95, 54272
  s_add_u32 s81, s95, 82592
  buffer_load_dwordx4 v1, s[36:39], s81 offen lds
  s_add_u32 m0, s95, 58368
  s_add_u32 s81, s95, 86688
  buffer_load_dwordx4 v1, s[36:39], s81 offen lds
  s_add_u32 m0, s95, 62464
  s_add_u32 s81, s95, 90784
  buffer_load_dwordx4 v1, s[36:39], s81 offen lds
  s_add_u32 m0, s95, 66560
  s_add_u32 s81, s95, 94880
  buffer_load_dwordx4 v1, s[36:39], s81 offen lds
  s_add_u32 m0, s95, 70656
  s_add_u32 s81, s95, 98976
  buffer_load_dwordx4 v1, s[36:39], s81 offen lds
  s_cmp_eq_u32 s79, 3
  s_cbranch_scc1 L_st3
  s_add_u32 m0, s95, 74752
  s_add_u32 s81, s95, 103072
  buffer_load_dwordx4 v1, s[36:39], s81 offen lds
L_st3:
  s_mov_b32 s28, s4
  s_and_b32 s29, s5, 0xffff
  s_mov_b32 s30, 425984
  s_mov_b32 s31, 0x20000
  buffer_load_dwordx4 v[16:19], v30, s[28:31], s94 offen
  s_add_u32 s94, s94, 416
  buffer_load_dwordx4 v[104:107], v30, s[28:31], s94 offen
  s_add_u32 s94, s94, 416
  s_mov_b32 s32, s6
  s_and_b32 s33, s7, 0xffff
  s_mov_b32 s34, 12800000
  s_mov_b32 s35, 0x20000
  s_mul_i32 s96, s79, 3072
  s_mul_i32 s97, s79, 2704
  v_lshrrev_b32 v31, 5, v0
  v_mul_u32_u24 v31, 184, v31
  v_sub_u32 v31, v1, v31
  s_add_u32 m0, s96, 85312
  s_add_u32 s81, s97, 35152
  buffer_load_dwordx4 v1, s[36:39], s81 offen lds
  s_lshl_b32 s85, s85, 2
  s_add_u32 s85, s85, 129728
  s_mul_i32 s72, s84, 3
  s_sub_u32 s72, 4, s72
  s_cmp_eq_u32 s26, 85
  s_cselect_b32 s72, s72, 6
  s_add_u32 m0, s96, 86336
  s_add_u32 s81, s97, 36176
  buffer_load_dwordx4 v31, s[36:39], s81 offen lds
  s_lshl_b32 s52, s3, 7
  s_mul_i32 s53, s3, 5280
  s_lshl_b32 s54, s3, 2
  s_lshl_b32 s55, s3, 1
  s_lshl_b32 s82, s3, 12
  s_add_u32 m0, s96, 87360
  s_add_u32 s81, s97, 37016
  buffer_load_dwordx4 v1, s[36:39], s81 offen lds
  s_and_b32 s98, s3, 1
  s_lshr_b32 s99, s3, 1
  s_mul_i32 s68, s99, 3072
  s_lshl_b32 s83, s98, 3
  s_add_u32 s68, s68, s83
  s_add_u32 m0, s96, 97600
  s_add_u32 s81, s97, 45968
  buffer_load_dwordx4 v1, s[36:39], s81 offen lds
  v_add_u32 v59, s68, v1
  s_lshl_b32 s69, s99, 3
  s_lshr_b32 s69, 0x05030200, s69
  s_and_b32 s69, s69, 0xff
  s_lshl_b32 s69, s69, 9
  s_add_u32 m0, s96, 98624
  s_add_u32 s81, s97, 46992
  buffer_load_dwordx4 v31, s[36:39], s81 offen lds
  s_lshl_b32 s70, s98, 2
  s_add_u32 s91, s69, s70
  s_mov_b32 s99, 0x05040100
  s_mov_b32 s100, 0x07060302
  v_mov_b32 v2, 129664
  s_add_u32 m0, s96, 99648
  s_add_u32 s81, s97, 47832
  buffer_load_dwordx4 v1, s[36:39], s81 offen lds
  v_mov_b32 v109, 0
  v_mov_b32 v108, 0
  v_mov_b64 v[32:33], 0
  v_mov_b64 v[34:35], 0
  v_mov_b64 v[36:37], 0
  s_add_u32 m0, s96, 109888
  s_add_u32 s81, s97, 56784
  buffer_load_dwordx4 v1, s[36:39], s81 offen lds
  v_mov_b64 v[38:39], 0
  v_mov_b64 v[40:41], 0
  v_mov_b64 v[42:43], 0
  v_mov_b64 v[44:45], 0
  v_mov_b64 v[46:47], 0
  s_add_u32 m0, s96, 110912
  s_add_u32 s81, s97, 57808
  buffer_load_dwordx4 v31, s[36:39], s81 offen lds
  v_mov_b64 v[48:49], 0
  v_mov_b64 v[50:51], 0
  v_mov_b64 v[52:53], 0
  v_mov_b64 v[54:55], 0
  v_mov_b64 v[56:57], 0
  s_add_u32 m0, s96, 111936
  s_add_u32 s81, s97, 58648
  buffer_load_dwordx4 v1, s[36:39], s81 offen lds
  v_add_u32 v250, 77824, v1
  s_waitcnt vmcnt(19)
  v_add_u32 v251, 125248, v1
  v_lshrrev_b32 v3, 5, v0
  v_lshl_add_u32 v3, v3, 2, v2
  s_cmp_lg_u32 s79, 0
  s_cbranch_scc1 L_st2
  s_add_u32 m0, s96, 122176
  s_add_u32 s81, s97, 67600
  buffer_load_dwordx4 v1, s[36:39], s81 offen lds
  s_add_u32 m0, s96, 123200
  s_add_u32 s81, s97, 68624
  buffer_load_dwordx4 v31, s[36:39], s81 offen lds
  s_add_u32 m0, s96, 124224
  s_add_u32 s81, s97, 69464
  buffer_load_dwordx4 v1, s[36:39], s81 offen lds
L_st2:
  s_add_u32 m0, s95, 6144
  s_add_u32 s81, s95, 0
  buffer_load_dwordx4 v1, s[36:39], s81 offen lds
  s_add_u32 m0, s95, 10240
  s_add_u32 s81, s95, 4096
  buffer_load_dwordx4 v1, s[36:39], s81 offen lds
  s_add_u32 m0, s95, 14336
  s_add_u32 s81, s95, 8192
  buffer_load_dwordx4 v1, s[36:39], s81 offen lds
  s_add_u32 m0, s95, 18432
  s_add_u32 s81, s95, 12288
  buffer_load_dwordx4 v1, s[36:39], s81 offen lds
  s_waitcnt vmcnt(15)
  s_barrier
  ds_read_b128 v[224:227], v250 offset:0
  ds_read_b128 v[228:231], v250 offset:6144
  ds_read_b128 v[232:235], v251 offset:0
  ds_read_b128 v[4:7], v250 offset:3072
  ds_read_b128 v[8:11], v251 offset:2048
  ds_read_b128 v[20:23], v250 offset:1024
  ds_read_b128 v[24:27], v250 offset:2048
  ds_read_b128 v[216:219], v250 offset:4096
  ds_read_b128 v[220:223], v250 offset:5120
  ds_read_b128 v[236:239], v251 offset:1024
  s_add_u32 m0, s95, 22528
  s_add_u32 s81, s95, 16384
  buffer_load_dwordx4 v1, s[36:39], s81 offen lds
  s_add_u32 m0, s95, 26624
  s_add_u32 s81, s95, 20480
  buffer_load_dwordx4 v1, s[36:39], s81 offen lds
  s_add_u32 m0, s95, 30720
  s_add_u32 s81, s95, 24576
  buffer_load_dwordx4 v1, s[36:39], s81 offen lds
  s_add_u32 m0, s95, 34816
  s_add_u32 s81, s95, 28672
  buffer_load_dwordx4 v1, s[36:39], s81 offen lds
  s_cmp_eq_u32 s79, 3
  s_cbranch_scc1 L_st1
  s_add_u32 m0, s95, 38912
  s_add_u32 s81, s95, 32768
  buffer_load_dwordx4 v1, s[36:39], s81 offen lds
L_st1:
  s_waitcnt vmcnt(18)
  v_lshl_add_u32 v16, v16, 7, v29
  v_lshl_add_u32 v17, v17, 7, v29
  v_lshl_add_u32 v18, v18, 7, v29
  v_lshl_add_u32 v19, v19, 7, v29
  s_add_u32 m0, s76, 0
  s_mov_b32 exec_hi, 0xffffff
  buffer_load_dwordx4 v16, s[32:35], 0 offen lds
  s_add_u32 m0, s76, 1056
  s_nop 0
  buffer_load_dwordx4 v17, s[32:35], 0 offen lds
  s_add_u32 m0, s76, 2112
  s_mov_b32 exec_hi, 0xffff
  buffer_load_dwordx4 v18, s[32:35], 0 offen lds
  s_add_u32 m0, s76, 3168
  s_nop 0
  buffer_load_dwordx4 v19, s[32:35], 0 offen lds
  s_mov_b32 exec_hi, -1
  s_waitcnt vmcnt(21)
  v_lshl_add_u32 v104, v104, 7, v29
  v_lshl_add_u32 v105, v105, 7, v29
  v_lshl_add_u32 v106, v106, 7, v29
  v_lshl_add_u32 v107, v107, 7, v29
  s_add_u32 m0, s76, 16256
  s_mov_b32 exec_hi, 0xffffff
  buffer_load_dwordx4 v104, s[32:35], 0 offen lds
  s_add_u32 m0, s76, 17312
  s_nop 0
  buffer_load_dwordx4 v105, s[32:35], 0 offen lds
  s_add_u32 m0, s76, 18368
  s_mov_b32 exec_hi, 0xffff
  buffer_load_dwordx4 v106, s[32:35], 0 offen lds
  s_add_u32 m0, s76, 19424
  s_nop 0
  buffer_load_dwordx4 v107, s[32:35], 0 offen lds
  s_mov_b32 exec_hi, -1
  s_waitcnt lgkmcnt(9)
  v_add_u32 v225, s52, v225
  v_add_u32 v226, s52, v226
  v_add_u32 v227, s52, v227
  s_waitcnt lgkmcnt(8)
  v_add_u32 v228, s54, v228
  v_add_u32 v229, s54, v229
  v_add_u32 v231, s83, v231
  v_add_u32 v230, s91, v230
  s_waitcnt lgkmcnt(7)
  v_mad_u32_u24 v232, v233, s3, v232
  v_add_u32 v234, s55, v234
  v_mad_u32_u24 v233, v233, 8, v232
  v_add_u32 v246, s82, v235
  v_add_u32 v247, 2048, v246
  v_add_u32 v31, 0, v234
  v_and_b32 v31, 3, v31
  v_lshl_add_u32 v244, v31, 4, v232
  v_add_u32 v31, 1, v234
  v_and_b32 v31, 3, v31
  v_lshl_add_u32 v245, v31, 4, v232
  v_add_u32 v245, 1664, v245
  v_add_u32 v31, 0, v234
  v_and_b32 v31, 3, v31
  v_lshl_add_u32 v248, v31, 4, v233
  v_add_u32 v31, 1, v234
  v_and_b32 v31, 3, v31
  v_lshl_add_u32 v249, v31, 4, v233
  v_add_u32 v249, 1664, v249
  s_waitcnt lgkmcnt(5)
  v_add_u32 v10, s76, v10
  v_add_u32 v4, s76, v4
  v_add_u32 v5, s76, v5
  ds_write_b32 v10, v7 offset:2880
  v_add_u32 v11, s53, v11
  s_waitcnt lgkmcnt(5)
  v_add_u32 v20, s53, v20
  v_add_u32 v21, s53, v21
  v_add_u32 v22, s53, v22
  v_add_u32 v23, s53, v23
  s_waitcnt lgkmcnt(4)
  v_add_u32 v24, s53, v24
  v_add_u32 v25, s53, v25
  v_add_u32 v26, s53, v26
  v_add_u32_e64 v27, s53, v27
  s_waitcnt vmcnt(8)
  s_barrier
L_w2:
  ds_read2st64_b32 v[60:61], v228 offset0:0 offset1:6
  ds_read2st64_b32 v[62:63], v228 offset0:12 offset1:18
  ds_read2st64_b32 v[64:65], v228 offset0:24 offset1:30
  ds_read2st64_b32 v[66:67], v228 offset0:36 offset1:42
  ds_read2st64_b32 v[68:69], v228 offset0:96 offset1:102
  ds_read2st64_b32 v[70:71], v229 offset0:108 offset1:114
  ds_read2st64_b32 v[72:73], v229 offset0:120 offset1:126
  ds_read2st64_b32 v[74:75], v229 offset0:132 offset1:138
  s_cmp_ge_u32 s3, 5
  s_cbranch_scc1 L_u0
  v_add_u32 v228, 32, v228
  v_add_u32 v229, 32, v229
  ds_read2st64_b32 v[92:93], v228 offset0:0 offset1:6
  ds_read2st64_b32 v[94:95], v228 offset0:12 offset1:18
  ds_read2st64_b32 v[96:97], v228 offset0:24 offset1:30
  ds_read2st64_b32 v[98:99], v228 offset0:36 offset1:42
  ds_read2st64_b32 v[100:101], v228 offset0:96 offset1:102
  ds_read2st64_b32 v[102:103], v229 offset0:108 offset1:114
  ds_read2st64_b32 v[104:105], v229 offset0:120 offset1:126
  ds_read2st64_b32 v[106:107], v229 offset0:132 offset1:138
  ds_read_b64_tr_b16 v[76:77], v225 offset:0
  ds_read_b64_tr_b16 v[78:79], v225 offset:5408
  ds_read_b64_tr_b16 v[80:81], v226 offset:0
  ds_read_b64_tr_b16 v[82:83], v227 offset:0
  ds_read_b64_tr_b16 v[84:85], v225 offset:64
  ds_read_b64_tr_b16 v[86:87], v225 offset:5472
  ds_read_b64_tr_b16 v[88:89], v226 offset:64
  ds_read_b64_tr_b16 v[90:91], v227 offset:64
  ds_read_b64_tr_b16 v[112:113], v224 offset:0
  ds_read_b64_tr_b16 v[114:115], v224 offset:256
  ds_read_b64_tr_b16 v[116:117], v224 offset:1024
  ds_read_b64_tr_b16 v[118:119], v224 offset:1280
  s_waitcnt lgkmcnt(14)
  v_mfma_f32_16x16x32_bf16 v[108:111], v[60:63], v[60:63], 0
  v_mfma_f32_16x16x32_bf16 v[108:111], v[64:67], v[64:67], v[108:111]
  v_mfma_f32_16x16x32_bf16 v[108:111], v[68:71], v[68:71], v[108:111]
  s_nop 0
  v_mfma_f32_16x16x32_bf16 v[108:111], v[72:75], v[72:75], v[108:111]
  v_perm_b32 v184, v61, v60, s99
  v_perm_b32 v185, v63, v62, s99
  v_perm_b32 v186, v65, v64, s99
  v_perm_b32 v187, v67, v66, s99
  v_perm_b32 v188, v69, v68, s99
  v_perm_b32 v189, v71, v70, s99
  v_perm_b32 v190, v73, v72, s99
  v_perm_b32 v191, v75, v74, s99
  v_mfma_f32_16x16x32_bf16 v[108:111], v[92:95], v[92:95], v[108:111]
  v_mfma_f32_16x16x32_bf16 v[108:111], v[96:99], v[96:99], v[108:111]
  v_mfma_f32_16x16x32_bf16 v[108:111], v[100:103], v[100:103], v[108:111]
  s_waitcnt lgkmcnt(12)
  v_mfma_f32_16x16x32_bf16 v[108:111], v[104:107], v[104:107], v[108:111]
  s_waitcnt lgkmcnt(10)
  v_mfma_f32_16x16x32_bf16 v[28:31], v[76:79], v[76:79], 0
  s_waitcnt lgkmcnt(8)
  v_mfma_f32_16x16x32_bf16 v[28:31], v[80:83], v[80:83], v[28:31]
  s_waitcnt lgkmcnt(6)
  v_mfma_f32_16x16x32_bf16 v[28:31], v[84:87], v[84:87], v[28:31]
  s_nop 0
  s_waitcnt lgkmcnt(4)
  v_mfma_f32_16x16x32_bf16 v[28:31], v[88:91], v[88:91], v[28:31]
  v_perm_b32 v192, v61, v60, s100
  v_perm_b32 v193, v63, v62, s100
  v_perm_b32 v194, v65, v64, s100
  v_perm_b32 v195, v67, v66, s100
  v_perm_b32 v196, v69, v68, s100
  v_perm_b32 v197, v71, v70, s100
  v_perm_b32 v198, v73, v72, s100
  v_perm_b32 v199, v75, v74, s100
  v_max3_f32 v28, v28, v29, 0
  v_perm_b32 v60, v93, v92, s99
  v_perm_b32 v61, v95, v94, s99
  v_max3_f32 v108, v108, v109, 0
  v_perm_b32 v62, v97, v96, s99
  v_max3_f32 v28, v28, v30, v31
  v_perm_b32 v63, v99, v98, s99
  v_max3_f32 v108, v108, v110, v111
  v_perm_b32 v64, v101, v100, s99
  v_perm_b32 v65, v103, v102, s99
  v_permlane32_swap_b32 v28, v108
  v_perm_b32 v66, v105, v104, s99
  v_max_u32 v28, v28, v108
  v_perm_b32 v67, v107, v106, s99
  s_nop 0
  v_max_u32_dpp v28, v28, v28 row_shr:1 row_mask:0xf bank_mask:0xf
  v_perm_b32 v68, v93, v92, s100
  v_perm_b32 v69, v95, v94, s100
  v_max_u32_dpp v28, v28, v28 row_shr:2 row_mask:0xf bank_mask:0xf
  v_perm_b32 v70, v97, v96, s100
  s_nop 0
  v_max_u32_dpp v28, v28, v28 row_shr:4 row_mask:0xf bank_mask:0xf
  v_perm_b32 v71, v99, v98, s100
  s_nop 0
  v_max_u32_dpp v28, v28, v28 row_shr:8 row_mask:0xf bank_mask:0xf
  v_perm_b32 v72, v101, v100, s100
  v_perm_b32 v73, v103, v102, s100
  v_max_u32_dpp v28, v28, v28 row_bcast:15 row_mask:0xa bank_mask:0xf
  v_perm_b32 v74, v105, v104, s100
  s_mov_b32 exec_lo, 0x80000000
  s_mov_b32 exec_hi, 0x80000000
  ds_max_u32 v3, v28 offset:16
  s_mov_b64 exec, -1
  v_perm_b32 v75, v107, v106, s100
  s_branch L_u1
L_u0:
  ds_read_b64_tr_b16 v[76:77], v225 offset:0
  ds_read_b64_tr_b16 v[78:79], v225 offset:5408
  ds_read_b64_tr_b16 v[80:81], v226 offset:0
  ds_read_b64_tr_b16 v[82:83], v227 offset:0
  ds_read_b64_tr_b16 v[84:85], v225 offset:64
  ds_read_b64_tr_b16 v[86:87], v225 offset:5472
  ds_read_b64_tr_b16 v[88:89], v226 offset:64
  ds_read_b64_tr_b16 v[90:91], v227 offset:64
  ds_read_b64_tr_b16 v[92:93], v225 offset:384
  ds_read_b64_tr_b16 v[94:95], v225 offset:5792
  ds_read_b64_tr_b16 v[96:97], v226 offset:384
  ds_read_b64_tr_b16 v[98:99], v227 offset:384
  ds_read_b64_tr_b16 v[100:101], v225 offset:448
  ds_read_b64_tr_b16 v[102:103], v225 offset:5856
  ds_read_b64_tr_b16 v[104:105], v226 offset:448
  ds_read_b64_tr_b16 v[106:107], v227 offset:448
  ds_read_b64_tr_b16 v[112:113], v224 offset:0
  ds_read_b64_tr_b16 v[114:115], v224 offset:256
  ds_read_b64_tr_b16 v[116:117], v224 offset:1024
  ds_read_b64_tr_b16 v[118:119], v224 offset:1280
  s_waitcnt lgkmcnt(14)
  v_mfma_f32_16x16x32_bf16 v[108:111], v[60:63], v[60:63], 0
  v_mfma_f32_16x16x32_bf16 v[108:111], v[64:67], v[64:67], v[108:111]
  v_mfma_f32_16x16x32_bf16 v[108:111], v[68:71], v[68:71], v[108:111]
  v_mfma_f32_16x16x32_bf16 v[108:111], v[72:75], v[72:75], v[108:111]
  v_mfma_f32_16x16x32_bf16 v[28:31], v[76:79], v[76:79], 0
  v_mfma_f32_16x16x32_bf16 v[28:31], v[80:83], v[80:83], v[28:31]
  v_mfma_f32_16x16x32_bf16 v[28:31], v[84:87], v[84:87], v[28:31]
  s_waitcnt lgkmcnt(12)
  v_mfma_f32_16x16x32_bf16 v[28:31], v[88:91], v[88:91], v[28:31]
  s_waitcnt lgkmcnt(10)
  v_mfma_f32_16x16x32_bf16 v[28:31], v[92:95], v[92:95], v[28:31]
  s_waitcnt lgkmcnt(8)
  v_mfma_f32_16x16x32_bf16 v[28:31], v[96:99], v[96:99], v[28:31]
  s_waitcnt lgkmcnt(6)
  v_mfma_f32_16x16x32_bf16 v[28:31], v[100:103], v[100:103], v[28:31]
  s_nop 0
  s_waitcnt lgkmcnt(4)
  v_mfma_f32_16x16x32_bf16 v[28:31], v[104:107], v[104:107], v[28:31]
  v_perm_b32 v184, v61, v60, s99
  v_perm_b32 v185, v63, v62, s99
  v_perm_b32 v186, v65, v64, s99
  v_perm_b32 v187, v67, v66, s99
  s_nop 3
  v_max3_f32 v28, v28, v29, 0
  v_perm_b32 v188, v69, v68, s99
  v_max3_f32 v108, v108, v109, 0
  v_perm_b32 v189, v71, v70, s99
  v_max3_f32 v28, v28, v30, v31
  v_perm_b32 v190, v73, v72, s99
  v_max3_f32 v108, v108, v110, v111
  v_perm_b32 v191, v75, v74, s99
  s_nop 0
  v_permlane32_swap_b32 v28, v108
  v_perm_b32 v192, v61, v60, s100
  v_max_u32_e64 v28, v28, v108
  v_perm_b32 v193, v63, v62, s100
  s_nop 0
  v_max_u32_dpp v28, v28, v28 row_shr:1 row_mask:0xf bank_mask:0xf
  v_perm_b32 v194, v65, v64, s100
  s_nop 0
  v_max_u32_dpp v28, v28, v28 row_shr:2 row_mask:0xf bank_mask:0xf
  v_perm_b32 v195, v67, v66, s100
  s_nop 0
  v_max_u32_dpp v28, v28, v28 row_shr:4 row_mask:0xf bank_mask:0xf
  v_perm_b32 v196, v69, v68, s100
  s_nop 0
  v_max_u32_dpp v28, v28, v28 row_shr:8 row_mask:0xf bank_mask:0xf
  v_perm_b32 v197, v71, v70, s100
  s_nop 0
  v_max_u32_dpp v28, v28, v28 row_bcast:15 row_mask:0xa bank_mask:0xf
  v_perm_b32 v198, v73, v72, s100
  s_mov_b32 exec_lo, 0x80000000
  s_mov_b32 exec_hi, 0x80000000
  ds_max_u32 v3, v28 offset:16
  s_mov_b64 exec, -1
  v_perm_b32 v199, v75, v74, s100
  v_add_u32 v248, 12288, v246
  v_add_u32 v249, 12288, v247
  s_cmp_lg_u32 s3, 7
  s_cbranch_scc1 L_u1
  s_mov_b32 exec_lo, 0xfffffff0
  s_mov_b32 exec_hi, 0xfffffff0
  v_mov_b32 v249, 1048576
  s_mov_b64 exec, -1
L_u1:
  s_waitcnt lgkmcnt(0)
  s_barrier
  ds_read_b128 v[108:111], v2 offset:16
  s_mul_i32 s68, s3, 384
  v_lshrrev_b32 v29, 2, v0
  v_mul_u32_u24 v29, 24, v29
  v_add_u32 v29, s68, v29
  v_and_b32 v30, 3, v0
  v_lshlrev_b32 v30, 3, v30
  ds_read_b64 v[224:225], v29 offset:2048
  ds_read_b64 v[226:227], v29 offset:2056
  ds_read_b64 v[228:229], v29 offset:2064
  s_waitcnt lgkmcnt(3)
  v_add_u32 v108, 0x3f800000, v108
  v_add_u32 v109, 0x3f800000, v109
  v_lshrrev_b32 v108, 24, v108
  v_lshrrev_b32 v109, 24, v109
  v_sub_u32 v108, 267, v108
  s_mov_b32 vcc_lo, 0x4000000
  v_min_u32 v108, 167, v108
  s_mov_b32 vcc_hi, 0x4000000
  v_readfirstlane_b32 s74, v108
  v_cndmask_b32 v250, v110, v111, vcc
  v_mul_u32_u24 v108, 0x800080, v108
  v_lshrrev_b32 v250, 23, v250
  v_and_b32 v216, v216, v108
  v_and_b32 v217, v217, v108
  v_and_b32 v218, v218, v108
  v_and_b32 v219, v219, v108
  v_and_b32 v220, v220, v108
  v_and_b32 v221, v221, v108
  v_and_b32 v222, v222, v108
  v_and_b32 v223, v223, v108
  v_mfma_f32_32x32x16_bf16 v[152:167], v[216:219], v[76:79], 0
  v_add_u32_e64 v250, v250, v109
  v_sub_u32 v250, 388, v250
  v_mfma_f32_32x32x16_bf16 v[168:183], v[216:219], v[84:87], 0
  s_movk_i32 s98, 167
  v_med3_i32 v250, v250, 1, s98
  v_mfma_f32_32x32x16_bf16 v[152:167], v[220:223], v[80:83], v[152:167]
  v_subrev_u32 v110, 127, v250
  v_lshlrev_b32 v250, 23, v250
  v_mfma_f32_32x32x16_bf16 v[168:183], v[220:223], v[88:91], v[168:183]
  v_cmp_gt_i32 vcc, 0, v110
  v_mul_u32_u24 v110, 0x800080, v110
  s_cbranch_vccnz L_sdown
  v_add_u32 v112, v112, v110
  v_add_u32 v113, v113, v110
  v_add_u32 v114, v114, v110
  v_add_u32 v115, v115, v110
  v_add_u32 v116, v116, v110
  v_add_u32 v117, v117, v110
  v_add_u32 v118, v118, v110
  v_add_u32 v119, v119, v110
L_scaled:
  v_mfma_f32_32x32x16_bf16 v[120:135], v[184:187], v[112:115], 0
  v_cvt_pk_f16_f32 v152, v152, v153
  v_cvt_pk_f16_f32 v153, v154, v155
  v_cvt_pk_f16_f32 v154, v156, v157
  v_cvt_pk_f16_f32 v155, v158, v159
  ds_write_b128 v246, v[152:155]
  v_xor_b32 v246, 16, v246
  v_mfma_f32_32x32x16_bf16 v[120:135], v[188:191], v[116:119], v[120:135]
  v_cvt_pk_f16_f32 v156, v160, v161
  v_cvt_pk_f16_f32 v157, v162, v163
  v_cvt_pk_f16_f32 v158, v164, v165
  v_cvt_pk_f16_f32 v159, v166, v167
  ds_write_b128 v246, v[156:159]
  v_mfma_f32_32x32x16_bf16 v[136:151], v[192:195], v[112:115], 0
  v_cvt_pk_f16_f32 v168, v168, v169
  v_cvt_pk_f16_f32 v169, v170, v171
  v_cvt_pk_f16_f32 v170, v172, v173
  v_cvt_pk_f16_f32 v171, v174, v175
  ds_write_b128 v247, v[168:171]
  v_xor_b32_e64 v247, 16, v247
  v_mfma_f32_32x32x16_bf16 v[136:151], v[196:199], v[116:119], v[136:151]
  v_cvt_pk_f16_f32 v172, v176, v177
  v_cvt_pk_f16_f32 v173, v178, v179
  v_cvt_pk_f16_f32 v174, v180, v181
  v_cvt_pk_f16_f32 v175, v182, v183
  ds_write_b128 v247, v[172:175]
  s_cmp_ge_u32 s3, 5
  s_cbranch_scc1 L_u2
  v_mfma_f32_32x32x16_bf16 v[184:199], v[60:63], v[112:115], 0
  v_cvt_pk_f16_f32 v120, v120, v121
  v_cvt_pk_f16_f32 v121, v122, v123
  v_cvt_pk_f16_f32 v122, v124, v125
  v_mfma_f32_32x32x16_bf16 v[184:199], v[64:67], v[116:119], v[184:199]
  v_cvt_pk_f16_f32 v123, v126, v127
  ds_write_b128 v244, v[120:123]
  v_xor_b32_e64 v244, 16, v244
  v_mfma_f32_32x32x16_bf16 v[200:215], v[68:71], v[112:115], 0
  v_cvt_pk_f16_f32 v124, v128, v129
  v_cvt_pk_f16_f32 v125, v130, v131
  v_cvt_pk_f16_f32 v126, v132, v133
  v_mfma_f32_32x32x16_bf16 v[200:215], v[72:75], v[116:119], v[200:215]
  v_cvt_pk_f16_f32 v127, v134, v135
  ds_write_b128 v244, v[124:127]
  s_branch L_u3
L_u2:
  v_mfma_f32_32x32x16_bf16 v[184:199], v[216:219], v[92:95], 0
  v_cvt_pk_f16_f32 v120, v120, v121
  v_cvt_pk_f16_f32 v121, v122, v123
  v_cvt_pk_f16_f32 v122, v124, v125
  v_mfma_f32_32x32x16_bf16 v[184:199], v[220:223], v[96:99], v[184:199]
  v_cvt_pk_f16_f32 v123, v126, v127
  ds_write_b128 v244, v[120:123]
  v_xor_b32 v244, 16, v244
  v_mfma_f32_32x32x16_bf16 v[200:215], v[216:219], v[100:103], 0
  v_cvt_pk_f16_f32 v124, v128, v129
  v_cvt_pk_f16_f32 v125, v130, v131
  v_cvt_pk_f16_f32 v126, v132, v133
  v_mfma_f32_32x32x16_bf16 v[200:215], v[220:223], v[104:107], v[200:215]
  v_cvt_pk_f16_f32 v127, v134, v135
  ds_write_b128 v244, v[124:127]
L_u3:
  buffer_load_dwordx4 v[16:19], v6, s[28:31], s94 offen
  s_add_u32 s94, s94, 416
  buffer_load_dwordx4 v[112:115], v6, s[28:31], s94 offen
  s_add_u32 s94, s94, 416
  v_cvt_pk_f16_f32 v136, v136, v137
  s_waitcnt lgkmcnt(8)
  v_xor_b32 v224, v224, v30
  v_cvt_pk_f16_f32 v137, v138, v139
  v_cvt_pk_f16_f32 v138, v140, v141
  v_xor_b32 v232, 32, v224
  v_cvt_pk_f16_f32 v139, v142, v143
  ds_write_b128 v245, v[136:139]
  v_xor_b32 v245, 16, v245
  v_xor_b32_e64 v225, v225, v30
  v_cvt_pk_f16_f32 v140, v144, v145
  v_cvt_pk_f16_f32 v141, v146, v147
  v_cvt_pk_f16_f32 v142, v148, v149
  v_xor_b32 v233, 32, v225
  v_cvt_pk_f16_f32 v143, v150, v151
  ds_write_b128 v245, v[140:143]
  v_cvt_pk_f16_f32 v184, v184, v185
  s_waitcnt lgkmcnt(9)
  v_xor_b32 v226, v226, v30
  v_cvt_pk_f16_f32 v185, v186, v187
  v_cvt_pk_f16_f32 v186, v188, v189
  v_xor_b32 v234, 32, v226
  v_cvt_pk_f16_f32 v187, v190, v191
  ds_write_b128 v248, v[184:187]
  v_xor_b32 v248, 16, v248
  v_xor_b32 v227, v227, v30
  v_cvt_pk_f16_f32 v188, v192, v193
  v_cvt_pk_f16_f32 v189, v194, v195
  v_cvt_pk_f16_f32 v190, v196, v197
  v_xor_b32_e64 v235, 32, v227
  v_cvt_pk_f16_f32 v191, v198, v199
  ds_write_b128 v248, v[188:191]
  v_cvt_pk_f16_f32 v200, v200, v201
  s_waitcnt lgkmcnt(10)
  v_xor_b32 v228, v228, v30
  v_cvt_pk_f16_f32 v201, v202, v203
  v_cvt_pk_f16_f32 v202, v204, v205
  v_xor_b32 v240, 32, v228
  v_cvt_pk_f16_f32 v203, v206, v207
  ds_write_b128 v249, v[200:203]
  v_xor_b32 v249, 16, v249
  v_xor_b32 v229, v229, v30
  v_cvt_pk_f16_f32 v204, v208, v209
  v_cvt_pk_f16_f32 v205, v210, v211
  v_cvt_pk_f16_f32 v206, v212, v213
  v_xor_b32 v241, 32, v229
  v_cvt_pk_f16_f32 v207, v214, v215
  ds_write_b128 v249, v[204:207]
  v_readlane_b32 s0, v250, 0
  v_readlane_b32 s1, v250, 26
  s_sub_u32 s75, 0x7f000000, s0
  s_sub_u32 s1, 0x7f000000, s1
  s_sub_u32 s74, 254, s74
  s_lshl_b32 s74, s74, 23
  s_mov_b32 s92, 0x88888888
  s_mov_b32 s93, 0x88888888
  s_waitcnt lgkmcnt(0)
  s_barrier
  ds_read_b64_tr_b16 v[60:61], v224 offset:0
  ds_read_b64_tr_b16 v[62:63], v225 offset:0
  ds_read_b64_tr_b16 v[64:65], v232 offset:0
  ds_read_b64_tr_b16 v[66:67], v233 offset:0
  ds_read_b64_tr_b16 v[68:69], v224 offset:43328
  ds_read_b64_tr_b16 v[70:71], v225 offset:43328
  ds_read_b64_tr_b16 v[72:73], v232 offset:43328
  ds_read_b64_tr_b16 v[74:75], v233 offset:43328
  ds_read_b64_tr_b16 v[76:77], v226 offset:0
  ds_read_b64_tr_b16 v[78:79], v227 offset:0
  ds_read_b64_tr_b16 v[80:81], v234 offset:0
  ds_read_b64_tr_b16 v[82:83], v235 offset:0
  ds_read_b64_tr_b16 v[84:85], v226 offset:43328
  ds_read_b64_tr_b16 v[86:87], v227 offset:43328
  ds_read_b64_tr_b16 v[88:89], v234 offset:43328
  ds_read_b64_tr_b16 v[90:91], v235 offset:43328
  s_cmp_ge_u32 s3, 6
  s_cbranch_scc1 L_lin
  ds_read_b64_tr_b16 v[92:93], v228 offset:0
  ds_read_b64_tr_b16 v[94:95], v229 offset:0
  ds_read_b64_tr_b16 v[96:97], v240 offset:0
  ds_read_b64_tr_b16 v[98:99], v241 offset:0
  ds_read_b64_tr_b16 v[100:101], v228 offset:43328
  ds_read_b64_tr_b16 v[102:103], v229 offset:43328
  ds_read_b64_tr_b16 v[104:105], v240 offset:43328
  ds_read_b64_tr_b16 v[106:107], v241 offset:43328
  s_waitcnt lgkmcnt(6)
  v_pk_add_f16 v92, v92, v94
  v_pk_add_f16 v93, v93, v95
  ds_write_b64 v59, v[92:93] offset:30720
  s_waitcnt lgkmcnt(5)
  v_pk_add_f16 v96, v96, v98
  v_pk_add_f16 v97, v97, v99
  s_waitcnt lgkmcnt(3)
  v_pk_add_f16 v100, v100, v102
  v_pk_add_f16 v101, v101, v103
  ds_write_b64 v59, v[100:101] offset:32768
  s_waitcnt lgkmcnt(2)
  v_pk_add_f16 v104, v104, v106
  v_pk_add_f16 v105, v105, v107
  v_cndmask_b32 v96, v96, v104, s[92:93]
  v_cndmask_b32 v97, v97, v105, s[92:93]
  ds_write_b64 v59, v[96:97] offset:31744
  ds_write_b32 v230, v104 offset:3072
  ds_write_b32 v230, v105 offset:3088
  s_branch L_p2
L_lin:
  s_and_b32 s98, s3, 1
  s_cselect_b64 vcc, -1, 0
  s_lshl_b32 s99, s98, 5
  v_mov_b32 v31, 0
  v_xor_b32 v236, s99, v236
  v_xor_b32 v237, s99, v237
  v_cndmask_b32 v238, v238, v239, vcc
  ds_read_b64_tr_b16 v[92:93], v236
  ds_read_b64_tr_b16 v[94:95], v237
  ds_read_u16_d16_hi v31, v238
  s_lshl_b32 s98, s98, 10
  v_add_u32 v29, s98, v1
  s_waitcnt lgkmcnt(2)
  v_cvt_f32_f16 v96, v92
  v_cvt_f32_f16_sdwa v97, v92 dst_sel:DWORD dst_unused:UNUSED_PAD src0_sel:WORD_1
  v_mul_f32 v96, s1, v96
  v_mul_f32 v97, s1, v97
  v_mul_f32 v96, s0, v96
  v_mul_f32 v97, s0, v97
  v_cvt_pk_bf16_f32 v92, v96, v97
  v_cvt_f32_f16 v98, v93
  v_cvt_f32_f16_sdwa v99, v93 dst_sel:DWORD dst_unused:UNUSED_PAD src0_sel:WORD_1
  v_mul_f32 v98, s1, v98
  v_mul_f32 v99, s1, v99
  v_mul_f32 v98, s0, v98
  v_mul_f32 v99, s0, v99
  v_cvt_pk_bf16_f32 v93, v98, v99
  s_waitcnt lgkmcnt(1)
  v_cvt_f32_f16 v100, v94
  v_cvt_f32_f16_sdwa v101, v94 dst_sel:DWORD dst_unused:UNUSED_PAD src0_sel:WORD_1
  v_mul_f32 v100, s1, v100
  v_mul_f32 v101, s1, v101
  v_mul_f32 v100, s0, v100
  v_mul_f32 v101, s0, v101
  v_cvt_pk_bf16_f32 v94, v100, v101
  v_cvt_f32_f16_e64 v102, v95
  v_cvt_f32_f16_sdwa v103, v95 dst_sel:DWORD dst_unused:UNUSED_PAD src0_sel:WORD_1
  v_mul_f32 v102, s1, v102
  v_mul_f32 v103, s1, v103
  s_mov_b32 exec_lo, 0
  s_mov_b32 exec_hi, 0xffff
  s_waitcnt lgkmcnt(0)
  v_mov_b32 v102, v31
  s_mov_b64 exec, -1
  v_mul_f32 v102, s0, v102
  v_mul_f32 v103, s0, v103
  v_cvt_pk_bf16_f32 v95, v102, v103
  ds_write_b128 v29, v[92:95] offset:39936
L_p2:
  v_pk_add_f16 v76, v76, v78
  v_pk_add_f16 v77, v77, v79
  ds_write_b64 v59, v[76:77] offset:18432
  v_pk_add_f16 v80, v80, v82
  v_pk_add_f16 v81, v81, v83
  v_pk_add_f16 v84, v84, v86
  v_pk_add_f16 v85, v85, v87
  ds_write_b64 v59, v[84:85] offset:20480
  v_pk_add_f16 v88, v88, v90
  v_pk_add_f16 v89, v89, v91
  v_cndmask_b32 v80, v80, v88, s[92:93]
  v_cndmask_b32 v81, v81, v89, s[92:93]
  ds_write_b64 v59, v[80:81] offset:19456
  ds_write_b32 v230, v88 offset:1024
  ds_write_b32 v230, v89 offset:1040
  v_pk_add_f16 v60, v60, v62
  v_pk_add_f16 v61, v61, v63
  ds_write_b64 v59, v[60:61] offset:6144
  v_pk_add_f16 v64, v64, v66
  v_pk_add_f16 v65, v65, v67
  v_pk_add_f16 v68, v68, v70
  v_pk_add_f16 v69, v69, v71
  ds_write_b64 v59, v[68:69] offset:8192
  v_pk_add_f16 v72, v72, v74
  v_pk_add_f16 v73, v73, v75
  v_cndmask_b32 v64, v64, v72, s[92:93]
  v_cndmask_b32 v65, v65, v73, s[92:93]
  ds_write_b64 v59, v[64:65] offset:7168
  s_cmp_lt_u32 s3, 2
  s_cbranch_scc1 L_p2d
  v_subrev_u32 v230, 1024, v230
  ds_write_b32 v230, v72 offset:0
  ds_write_b32 v230, v73 offset:16
  s_branch L_built
L_p2d:
  ds_write_b64 v231, v[72:73] offset:5120
L_built:
  s_mov_b32 s0, s74
  s_mov_b32 s1, s75
  s_mov_b32 s96, 0x3e000000
  s_mov_b32 s97, 0x43000000
  s_mov_b32 s51, 1
  s_mul_i32 s98, s3, 1536
  s_add_u32 s98, s98, 116736
  s_cmp_lg_u32 s84, 0
  s_cbranch_scc1 L_g1c
  s_sub_u32 s94, s94, 416
  s_waitcnt vmcnt(0)
  ds_read_u16_d16_hi v32, v10 offset:0
  ds_read_u16_d16_hi v33, v10 offset:2
  ds_read_u16_d16_hi v34, v10 offset:2112
  ds_read_u16_d16_hi v35, v10 offset:2114
  ds_read_u16_d16_hi v36, v10 offset:128
  ds_read_u16_d16_hi v37, v10 offset:130
  ds_read_u16_d16_hi v38, v10 offset:2240
  ds_read_u16_d16_hi v39, v10 offset:2242
  ds_read_u16_d16_hi v40, v10 offset:256
  ds_read_u16_d16_hi v41, v10 offset:258
  ds_read_u16_d16_hi v42, v10 offset:2368
  ds_read_u16_d16_hi v43, v10 offset:2370
  ds_read_u16_d16_hi v44, v10 offset:384
  ds_read_u16_d16_hi v45, v10 offset:386
  ds_read_u16_d16_hi v46, v10 offset:2496
  ds_read_u16_d16_hi v47, v10 offset:2498
  ds_read_u16_d16_hi v48, v10 offset:512
  ds_read_u16_d16_hi v49, v10 offset:514
  ds_read_u16_d16_hi v50, v10 offset:2624
  ds_read_u16_d16_hi v51, v10 offset:2626
  ds_read_u16_d16_hi v52, v10 offset:640
  ds_read_u16_d16_hi v53, v10 offset:642
  ds_read_u16_d16_hi v54, v10 offset:2752
  ds_read_u16_d16_hi v55, v10 offset:2754
  ds_read_u16_d16_hi v56, v10 offset:768
  ds_read_u16_d16_hi v57, v10 offset:770
  s_waitcnt lgkmcnt(14)
  v_max3_f32 v58, |v32|, |v33|, 0
  v_cvt_pk_f16_f32 v184, v32, v33
  v_max3_f32 v58, |v34|, |v35|, v58
  v_cvt_pk_f16_f32 v185, v34, v35
  v_max3_f32 v58, |v36|, |v37|, v58
  v_cvt_pk_f16_f32 v186, v36, v37
  v_max3_f32 v58, |v38|, |v39|, v58
  v_cvt_pk_f16_f32 v187, v38, v39
  v_max3_f32 v58, |v40|, |v41|, v58
  v_cvt_pk_f16_f32 v188, v40, v41
  v_max3_f32 v58, |v42|, |v43|, v58
  v_cvt_pk_f16_f32 v189, v42, v43
  s_waitcnt lgkmcnt(12)
  v_max3_f32 v58, |v44|, |v45|, v58
  v_cvt_pk_f16_f32 v190, v44, v45
  s_waitcnt lgkmcnt(10)
  v_max3_f32 v58, |v46|, |v47|, v58
  v_cvt_pk_f16_f32 v191, v46, v47
  s_waitcnt lgkmcnt(8)
  v_max3_f32 v58, |v48|, |v49|, v58
  v_cvt_pk_f16_f32 v192, v48, v49
  s_waitcnt lgkmcnt(6)
  v_max3_f32 v58, |v50|, |v51|, v58
  v_cvt_pk_f16_f32 v193, v50, v51
  s_waitcnt lgkmcnt(4)
  v_max3_f32 v58, |v52|, |v53|, v58
  v_cvt_pk_f16_f32 v194, v52, v53
  s_waitcnt lgkmcnt(2)
  v_max3_f32 v58, |v54|, |v55|, v58
  v_cvt_pk_f16_f32 v195, v54, v55
  s_waitcnt lgkmcnt(0)
  v_max3_f32 v58, |v56|, |v57|, v58
  v_cvt_pk_f16_f32 v196, v56, v57
  s_waitcnt lgkmcnt(0)
  s_barrier
  s_branch L_cin_go
L_g1c:
  s_waitcnt lgkmcnt(0)
  s_barrier
  s_add_u32 s76, s76, -63168
  s_waitcnt vmcnt(1)
  v_lshl_add_u32 v16, v16, 7, v8
  v_lshl_add_u32 v17, v17, 7, v8
  v_lshl_add_u32 v18, v18, 7, v8
  v_lshl_add_u32 v19, v19, 7, v8
  s_add_u32 m0, s76, 0
  s_mov_b32 exec_hi, 0xffffff
  buffer_load_dwordx4 v16, s[32:35], 0 offen lds
  s_add_u32 m0, s76, 1056
  s_nop 0
  buffer_load_dwordx4 v17, s[32:35], 0 offen lds
  s_add_u32 m0, s76, 2112
  s_mov_b32 exec_hi, 0xffff
  buffer_load_dwordx4 v18, s[32:35], 0 offen lds
  s_add_u32 m0, s76, 3168
  s_nop 0
  buffer_load_dwordx4 v19, s[32:35], 0 offen lds
  s_mov_b32 exec_hi, -1
  s_waitcnt vmcnt(4)
  v_lshl_add_u32 v112, v112, 7, v8
  v_lshl_add_u32 v113, v113, 7, v8
  v_lshl_add_u32 v114, v114, 7, v8
  v_lshl_add_u32 v115, v115, 7, v8
  s_add_u32 m0, s76, 16256
  s_mov_b32 exec_hi, 0xffffff
  buffer_load_dwordx4 v112, s[32:35], 0 offen lds
  s_add_u32 m0, s76, 17312
  s_nop 0
  buffer_load_dwordx4 v113, s[32:35], 0 offen lds
  s_add_u32 m0, s76, 18368
  s_mov_b32 exec_hi, 0xffff
  buffer_load_dwordx4 v114, s[32:35], 0 offen lds
  s_add_u32 m0, s76, 19424
  s_nop 0
  buffer_load_dwordx4 v115, s[32:35], 0 offen lds
  s_mov_b32 exec_hi, -1
  buffer_load_dwordx4 v[16:19], v6, s[28:31], s94 offen
  s_add_u32 s94, s94, 416
  v_add_u32 v10, -63168, v10
  v_add_u32 v4, -63168, v4
  v_add_u32 v5, -63168, v5
  ds_write_b32 v10, v7 offset:2880
  ds_write_b32 v10, v7 offset:19136
L_g1d:
  s_waitcnt vmcnt(5)
  ds_read_u16_d16_hi v32, v10 offset:0
  ds_read_u16_d16_hi v33, v10 offset:2
  ds_read_u16_d16_hi v34, v10 offset:2112
  ds_read_u16_d16_hi v35, v10 offset:2114
  ds_read_u16_d16_hi v36, v10 offset:128
  ds_read_u16_d16_hi v37, v10 offset:130
  ds_read_u16_d16_hi v38, v10 offset:2240
  ds_read_u16_d16_hi v39, v10 offset:2242
  ds_read_u16_d16_hi v40, v10 offset:256
  ds_read_u16_d16_hi v41, v10 offset:258
  ds_read_u16_d16_hi v42, v10 offset:2368
  ds_read_u16_d16_hi v43, v10 offset:2370
  ds_read_u16_d16_hi v44, v10 offset:384
  ds_read_u16_d16_hi v45, v10 offset:386
  ds_read_u16_d16_hi v46, v10 offset:2496
  ds_read_u16_d16_hi v47, v10 offset:2498
  ds_read_u16_d16_hi v48, v10 offset:512
  ds_read_u16_d16_hi v49, v10 offset:514
  ds_read_u16_d16_hi v50, v10 offset:2624
  ds_read_u16_d16_hi v51, v10 offset:2626
  ds_read_u16_d16_hi v52, v10 offset:640
  ds_read_u16_d16_hi v53, v10 offset:642
  ds_read_u16_d16_hi v54, v10 offset:2752
  ds_read_u16_d16_hi v55, v10 offset:2754
  ds_read_u16_d16_hi v56, v10 offset:768
  ds_read_u16_d16_hi v57, v10 offset:770
  s_waitcnt lgkmcnt(14)
  v_max3_f32 v58, |v32|, |v33|, 0
  v_cvt_pk_f16_f32 v184, v32, v33
  v_max3_f32 v58, |v34|, |v35|, v58
  v_cvt_pk_f16_f32 v185, v34, v35
  v_max3_f32 v58, |v36|, |v37|, v58
  v_cvt_pk_f16_f32 v186, v36, v37
  v_max3_f32 v58, |v38|, |v39|, v58
  v_cvt_pk_f16_f32 v187, v38, v39
  v_max3_f32 v58, |v40|, |v41|, v58
  v_cvt_pk_f16_f32 v188, v40, v41
  v_max3_f32 v58, |v42|, |v43|, v58
  v_cvt_pk_f16_f32 v189, v42, v43
  s_waitcnt lgkmcnt(12)
  v_max3_f32 v58, |v44|, |v45|, v58
  v_cvt_pk_f16_f32 v190, v44, v45
  s_waitcnt lgkmcnt(10)
  v_max3_f32 v58, |v46|, |v47|, v58
  v_cvt_pk_f16_f32 v191, v46, v47
  s_waitcnt lgkmcnt(8)
  v_max3_f32 v58, |v48|, |v49|, v58
  v_cvt_pk_f16_f32 v192, v48, v49
  s_waitcnt lgkmcnt(6)
  v_max3_f32 v58, |v50|, |v51|, v58
  v_cvt_pk_f16_f32 v193, v50, v51
  s_waitcnt lgkmcnt(4)
  v_max3_f32 v58, |v52|, |v53|, v58
  v_cvt_pk_f16_f32 v194, v52, v53
  s_waitcnt lgkmcnt(2)
  v_max3_f32 v58, |v54|, |v55|, v58
  v_cvt_pk_f16_f32 v195, v54, v55
  s_waitcnt lgkmcnt(0)
  v_max3_f32 v58, |v56|, |v57|, v58
  v_cvt_pk_f16_f32 v196, v56, v57
L_cin_go:
  ds_write_b32 v11, v184 offset:0
  ds_write_b32 v11, v185 offset:160
  ds_write_b32 v11, v186 offset:320
  ds_write_b32 v11, v187 offset:480
  ds_write_b32 v11, v188 offset:640
  ds_write_b32 v11, v189 offset:800
  ds_write_b32 v11, v190 offset:960
  ds_write_b32 v11, v191 offset:1120
  ds_write_b32 v11, v192 offset:1280
  ds_write_b32 v11, v193 offset:1440
  ds_write_b32 v11, v194 offset:1600
  ds_write_b32 v11, v195 offset:1760
  ds_write_b32 v11, v196 offset:1920
  s_mov_b32 s81, 16256
  s_add_u32 s76, s76, 16256
  v_lshlrev_b32 v7, 2, v0
  v_add_u32 v7, s98, v7
L_cin_loop:
  v_cmp_le_f32 s[90:91], s97, v58
  v_cmp_le_f32 vcc, s96, v58
  s_mov_b32 s49, s74
  s_mov_b32 s50, s75
  s_cmp_lg_u64 s[90:91], 0
  s_cbranch_scc1 L_cslow
  s_cbranch_vccz L_cslow
L_cconv:
  s_cmp_lg_u32 s51, 0
  s_cbranch_scc1 L_first
  ds_read_b64_tr_b16 v[60:61], v20 offset:0
  v_mul_f32 v116, v184, v192
  v_mul_f32 v117, v185, v193
  ds_read_b64_tr_b16 v[74:75], v20 offset:32
  v_mul_f32 v118, v186, v194
  ds_read_b64_tr_b16 v[88:89], v20 offset:64
  v_mul_f32 v119, v187, v195
  ds_read_b64_tr_b16 v[102:103], v20 offset:96
  v_fmac_f32_e64 v116, v188, v191
  ds_read_b64_tr_b16 v[66:67], v23 offset:0
  v_fmac_f32 v117, v200, v208
  ds_read_b64_tr_b16 v[80:81], v23 offset:32
  v_fmac_f32 v118, v201, v209
  ds_read_b64_tr_b16 v[94:95], v23 offset:64
  v_fmac_f32 v119, v202, v210
  ds_read_b64_tr_b16 v[108:109], v23 offset:96
  v_fmac_f32 v116, v203, v211
  ds_read_b64_tr_b16 v[68:69], v24 offset:0
  v_fmac_f32_e64 v117, v204, v207
  ds_read_b64_tr_b16 v[82:83], v24 offset:32
  v_fmac_f32 v118, v216, v224
  ds_read_b64_tr_b16 v[96:97], v24 offset:64
  v_fmac_f32 v119, v217, v225
  ds_read_b64_tr_b16 v[110:111], v24 offset:96
  v_fmac_f32 v116, v218, v226
  ds_read_b64_tr_b16 v[124:125], v4 offset:0
  v_fmac_f32 v117, v219, v227
  ds_read_b64_tr_b16 v[126:127], v5 offset:0
  v_fmac_f32 v118, v220, v223
  v_fmac_f32 v119, v232, v240
  ds_read_b64_tr_b16 v[136:137], v4 offset:32
  v_fmac_f32 v116, v233, v241
  ds_read_b64_tr_b16 v[138:139], v5 offset:32
  v_fmac_f32 v117, v234, v242
  ds_read_b64_tr_b16 v[148:149], v4 offset:64
  v_fmac_f32 v118, v235, v243
  ds_read_b64_tr_b16 v[150:151], v5 offset:64
  v_fmac_f32 v119, v236, v239
  ds_read_b64_tr_b16 v[160:161], v4 offset:96
  v_fmac_f32_e64 v116, v189, v196
  ds_read_b64_tr_b16 v[162:163], v5 offset:96
  v_fmac_f32 v117, v189, v197
  ds_read_b128 v[164:167], v1 offset:39936
  v_fmac_f32 v118, v190, v198
  ds_read_b128 v[168:171], v1 offset:40960
  v_fmac_f32 v119, v190, v199
  ds_read_b128 v[172:175], v1 offset:8192
  v_fmac_f32 v116, v205, v212
  ds_read_b128 v[176:179], v1 offset:6144
  v_fmac_f32_e64 v117, v205, v213
  ds_read_b64_tr_b16 v[70:71], v25 offset:0
  v_fmac_f32 v118, v206, v214
  ds_read_b64_tr_b16 v[84:85], v25 offset:32
  v_fmac_f32 v119, v206, v215
  ds_read_b64_tr_b16 v[98:99], v25 offset:64
  v_fmac_f32 v116, v221, v228
  v_fmac_f32 v117, v221, v229
  ds_read_b64_tr_b16 v[112:113], v25 offset:96
  v_fmac_f32 v118, v222, v230
  ds_read_b64_tr_b16 v[72:73], v26 offset:0
  v_fmac_f32 v119, v222, v231
  ds_read_b64_tr_b16 v[86:87], v26 offset:32
  v_fmac_f32 v116, v237, v244
  ds_read_b64_tr_b16 v[100:101], v26 offset:64
  v_fmac_f32 v117, v237, v245
  ds_read_b64_tr_b16 v[114:115], v26 offset:96
  v_fmac_f32 v118, v238, v246
  ds_read_b64_tr_b16 v[62:63], v21 offset:0
  v_fmac_f32 v119, v238, v247
  ds_read_b64_tr_b16 v[76:77], v21 offset:32
  v_add_f32_e64 v116, v116, v117
  ds_read_b64_tr_b16 v[90:91], v21 offset:64
  v_add_f32 v118, v118, v119
  ds_read_b64_tr_b16 v[104:105], v21 offset:96
  v_add_f32 v116, v116, v118
  ds_read_b64_tr_b16 v[64:65], v22 offset:0
  v_mul_f32 v116, s49, v116
  ds_read_b64_tr_b16 v[78:79], v22 offset:32
  v_mul_f32 v116, s50, v116
  ds_read_b64_tr_b16 v[92:93], v22 offset:64
  ds_write_b32 v7, v116
  ds_read_b64_tr_b16 v[106:107], v22 offset:96
  v_add_u32 v7, 256, v7
  s_waitcnt lgkmcnt(14)
  v_pk_mul_f16 v120, v60, v67 op_sel:[0,0] op_sel_hi:[0,1]
  v_pk_mul_f16 v121, v60, v67 op_sel:[1,0] op_sel_hi:[1,1]
  v_pk_mul_f16 v122, v60, v68 op_sel:[0,0] op_sel_hi:[0,1]
  v_pk_mul_f16 v123, v60, v68 op_sel:[1,0] op_sel_hi:[1,1]
  v_pk_mul_f16 v132, v74, v81 op_sel:[0,0] op_sel_hi:[0,1]
  v_pk_mul_f16 v133, v74, v81 op_sel:[1,0] op_sel_hi:[1,1]
  v_pk_mul_f16 v134, v74, v82 op_sel:[0,0] op_sel_hi:[0,1]
  v_pk_mul_f16 v135, v74, v82 op_sel:[1,0] op_sel_hi:[1,1]
  v_pk_mul_f16 v144, v88, v95 op_sel:[0,0] op_sel_hi:[0,1]
  v_pk_mul_f16 v145, v88, v95 op_sel:[1,0] op_sel_hi:[1,1]
  v_pk_mul_f16 v146, v88, v96 op_sel:[0,0] op_sel_hi:[0,1]
  v_pk_mul_f16 v147, v88, v96 op_sel:[1,0] op_sel_hi:[1,1]
  v_pk_mul_f16 v156, v102, v109 op_sel:[0,0] op_sel_hi:[0,1]
  v_pk_mul_f16 v157, v102, v109 op_sel:[1,0] op_sel_hi:[1,1]
  v_pk_mul_f16 v158, v102, v110 op_sel:[0,0] op_sel_hi:[0,1]
  v_pk_mul_f16 v159, v102, v110 op_sel:[1,0] op_sel_hi:[1,1]
  s_waitcnt vmcnt(0)
  v_lshl_add_u32 v16, v16, 7, v8
  v_lshl_add_u32 v17, v17, 7, v8
  v_lshl_add_u32 v18, v18, 7, v8
  v_lshl_add_u32 v19, v19, 7, v8
  s_add_u32 m0, s76, 0
  s_mov_b32 exec_hi, 0xffffff
  buffer_load_dwordx4 v16, s[32:35], 0 offen lds
  s_add_u32 m0, s76, 1056
  s_nop 0
  buffer_load_dwordx4 v17, s[32:35], 0 offen lds
  s_add_u32 m0, s76, 2112
  s_mov_b32 exec_hi, 0xffff
  buffer_load_dwordx4 v18, s[32:35], 0 offen lds
  s_add_u32 m0, s76, 3168
  s_nop 0
  buffer_load_dwordx4 v19, s[32:35], 0 offen lds
  s_mov_b32 exec_hi, -1
  buffer_load_dwordx4 v[16:19], v6, s[28:31], s94 offen
  s_add_u32 s94, s94, 416
L_novm:
  v_add_u32 v10, s81, v10
  v_add_u32 v4, s81, v4
  v_add_u32 v5, s81, v5
  s_sub_u32 s76, s76, s81
  s_sub_u32 s81, 0, s81
  s_mov_b32 s51, 0
  s_waitcnt lgkmcnt(14)
  s_cmp_eq_u32 s84, 0
  s_cbranch_scc1 L_np1
  s_setprio 1
L_np1:
  v_mfma_f32_16x16x32_bf16 v[184:187], v[164:167], v[124:127], 0
  ds_read_b128 v[180:183], v1 offset:7168
  v_pk_mul_f16 v116, v60, v69 op_sel:[0,0] op_sel_hi:[0,1]
  v_mfma_f32_16x16x32_bf16 v[200:203], v[164:167], v[136:139], 0
  v_pk_mul_f16 v117, v60, v69 op_sel:[1,0] op_sel_hi:[1,1]
  v_mfma_f32_16x16x32_bf16 v[216:219], v[164:167], v[148:151], 0
  v_pk_mul_f16 v118, v60, v70 op_sel:[0,0] op_sel_hi:[0,1]
  v_mfma_f32_16x16x32_bf16 v[232:235], v[164:167], v[160:163], 0
  v_pk_mul_f16 v119, v60, v70 op_sel:[1,0] op_sel_hi:[1,1]
  v_mfma_f32_16x16x32_bf16 v[188:191], v[168:171], v[124:127], 0
  ds_read_b128 v[164:167], v1 offset:5120
  v_pk_mul_f16 v128, v74, v83 op_sel:[0,0] op_sel_hi:[0,1]
  v_mfma_f32_16x16x32_bf16 v[204:207], v[168:171], v[136:139], 0
  v_pk_mul_f16 v129, v74, v83 op_sel:[1,0] op_sel_hi:[1,1]
  v_mfma_f32_16x16x32_bf16 v[220:223], v[168:171], v[148:151], 0
  v_pk_mul_f16 v130, v74, v84 op_sel:[0,0] op_sel_hi:[0,1]
  v_mfma_f32_16x16x32_bf16 v[236:239], v[168:171], v[160:163], 0
  v_pk_mul_f16 v131, v74, v84 op_sel:[1,0] op_sel_hi:[1,1]
  v_mfma_f32_16x16x32_f16 v[192:195], v[172:175], v[120:123], 0
  ds_read_b128 v[168:171], v1 offset:11264
  v_pk_mul_f16 v140, v88, v97 op_sel:[0,0] op_sel_hi:[0,1]
  v_mfma_f32_16x16x32_f16 v[208:211], v[172:175], v[132:135], 0
  v_pk_mul_f16 v141, v88, v97 op_sel:[1,0] op_sel_hi:[1,1]
  v_mfma_f32_16x16x32_f16 v[224:227], v[172:175], v[144:147], 0
  s_waitcnt lgkmcnt(14)
  v_pk_mul_f16 v142, v88, v98 op_sel:[0,0] op_sel_hi:[0,1]
  v_mfma_f32_16x16x32_f16 v[240:243], v[172:175], v[156:159], 0
  s_nop 0
  v_pk_mul_f16 v143, v88, v98 op_sel:[1,0] op_sel_hi:[1,1]
  v_mfma_f32_16x16x32_f16 v[184:187], v[176:179], v[120:123], v[184:187]
  ds_read_b128 v[172:175], v1 offset:9216
  v_pk_mul_f16 v152, v102, v111 op_sel:[0,0] op_sel_hi:[0,1]
  v_mfma_f32_16x16x32_f16 v[200:203], v[176:179], v[132:135], v[200:203]
  v_pk_mul_f16 v153, v102, v111 op_sel:[1,0] op_sel_hi:[1,1]
  v_mfma_f32_16x16x32_f16 v[216:219], v[176:179], v[144:147], v[216:219]
  s_waitcnt lgkmcnt(14)
  v_pk_mul_f16 v154, v102, v112 op_sel:[0,0] op_sel_hi:[0,1]
  v_mfma_f32_16x16x32_f16 v[232:235], v[176:179], v[156:159], v[232:235]
  s_waitcnt lgkmcnt(3)
  v_pk_mul_f16 v155, v102, v112 op_sel:[1,0] op_sel_hi:[1,1]
  v_mfma_f32_16x16x32_f16 v[188:191], v[180:183], v[120:123], v[188:191]
  ds_read_b128 v[176:179], v1 offset:10240
  v_pk_mul_f16 v124, v61, v68 op_sel:[0,0] op_sel_hi:[0,1]
  v_mfma_f32_16x16x32_f16 v[204:207], v[180:183], v[132:135], v[204:207]
  v_pk_mul_f16 v125, v61, v68 op_sel:[1,0] op_sel_hi:[1,1]
  v_mfma_f32_16x16x32_f16 v[220:223], v[180:183], v[144:147], v[220:223]
  v_pk_mul_f16 v126, v61, v69 op_sel:[0,0] op_sel_hi:[0,1]
  v_mfma_f32_16x16x32_f16 v[236:239], v[180:183], v[156:159], v[236:239]
  s_nop 0
  s_waitcnt lgkmcnt(3)
  v_pk_mul_f16 v127, v61, v69 op_sel:[1,0] op_sel_hi:[1,1]
  v_mfma_f32_16x16x32_f16 v[196:199], v[164:167], v[120:123], 0
  ds_read_b128 v[180:183], v1 offset:14336
  v_pk_mul_f16 v136, v75, v82 op_sel:[0,0] op_sel_hi:[0,1]
  v_mfma_f32_16x16x32_f16 v[212:215], v[164:167], v[132:135], 0
  v_pk_mul_f16 v120, v60, v71 op_sel:[0,0] op_sel_hi:[0,1]
  v_mfma_f32_16x16x32_f16 v[228:231], v[164:167], v[144:147], 0
  v_pk_mul_f16 v121, v60, v71 op_sel:[1,0] op_sel_hi:[1,1]
  v_mfma_f32_16x16x32_f16 v[244:247], v[164:167], v[156:159], 0
  s_waitcnt lgkmcnt(3)
  v_pk_mul_f16 v122, v60, v66 op_sel:[0,1] op_sel_hi:[0,0]
  v_mfma_f32_16x16x32_f16 v[192:195], v[168:171], v[116:119], v[192:195]
  ds_read_b128 v[164:167], v1 offset:12288
  v_pk_mul_f16 v123, v60, v72 op_sel:[0,0] op_sel_hi:[1,0]
  v_mfma_f32_16x16x32_f16 v[208:211], v[168:171], v[128:131], v[208:211]
  s_nop 0
  v_pk_mul_f16 v132, v74, v85 op_sel:[0,0] op_sel_hi:[0,1]
  v_mfma_f32_16x16x32_f16 v[224:227], v[168:171], v[140:143], v[224:227]
  v_pk_mul_f16 v133, v74, v85 op_sel:[1,0] op_sel_hi:[1,1]
  v_mfma_f32_16x16x32_f16 v[240:243], v[168:171], v[152:155], v[240:243]
  s_nop 0
  s_waitcnt lgkmcnt(3)
  v_pk_mul_f16 v134, v74, v80 op_sel:[0,1] op_sel_hi:[0,0]
  v_mfma_f32_16x16x32_f16 v[184:187], v[172:175], v[116:119], v[184:187]
  ds_read_b128 v[168:171], v1 offset:13312
  v_pk_mul_f16 v135, v74, v86 op_sel:[0,0] op_sel_hi:[1,0]
  v_mfma_f32_16x16x32_f16 v[200:203], v[172:175], v[128:131], v[200:203]
  v_pk_mul_f16 v144, v88, v99 op_sel:[0,0] op_sel_hi:[0,1]
  v_mfma_f32_16x16x32_f16 v[216:219], v[172:175], v[140:143], v[216:219]
  s_setprio 2
  v_pk_mul_f16 v145, v88, v99 op_sel:[1,0] op_sel_hi:[1,1]
  v_mfma_f32_16x16x32_f16 v[232:235], v[172:175], v[152:155], v[232:235]
  s_waitcnt lgkmcnt(3)
  v_pk_mul_f16 v146, v88, v94 op_sel:[0,1] op_sel_hi:[0,0]
  v_mfma_f32_16x16x32_f16 v[188:191], v[176:179], v[116:119], v[188:191]
  ds_read_b128 v[172:175], v1 offset:0
  v_pk_mul_f16 v147, v88, v100 op_sel:[0,0] op_sel_hi:[1,0]
  v_mfma_f32_16x16x32_f16 v[204:207], v[176:179], v[128:131], v[204:207]
  v_pk_mul_f16 v156, v102, v113 op_sel:[0,0] op_sel_hi:[0,1]
  v_mfma_f32_16x16x32_f16 v[220:223], v[176:179], v[140:143], v[220:223]
  v_pk_mul_f16 v157, v102, v113 op_sel:[1,0] op_sel_hi:[1,1]
  v_mfma_f32_16x16x32_f16 v[236:239], v[176:179], v[152:155], v[236:239]
  s_nop 0
  s_waitcnt lgkmcnt(3)
  v_pk_mul_f16 v158, v102, v108 op_sel:[0,1] op_sel_hi:[0,0]
  v_mfma_f32_16x16x32_f16 v[192:195], v[180:183], v[120:123], v[192:195]
  ds_read_b128 v[176:179], v1 offset:17408
  v_pk_mul_f16 v159, v102, v114 op_sel:[0,0] op_sel_hi:[1,0]
  v_mfma_f32_16x16x32_f16 v[208:211], v[180:183], v[132:135], v[208:211]
  v_pk_mul_f16 v137, v75, v82 op_sel:[1,0] op_sel_hi:[1,1]
  v_mfma_f32_16x16x32_f16 v[224:227], v[180:183], v[144:147], v[224:227]
  v_pk_mul_f16 v138, v75, v83 op_sel:[0,0] op_sel_hi:[0,1]
  v_mfma_f32_16x16x32_f16 v[240:243], v[180:183], v[156:159], v[240:243]
  s_waitcnt lgkmcnt(3)
  v_pk_mul_f16 v139, v75, v83 op_sel:[1,0] op_sel_hi:[1,1]
  v_mfma_f32_16x16x32_f16 v[184:187], v[164:167], v[120:123], v[184:187]
  ds_read_b128 v[180:183], v1 offset:15360
  v_pk_mul_f16 v148, v89, v96 op_sel:[0,0] op_sel_hi:[0,1]
  v_mfma_f32_16x16x32_f16 v[200:203], v[164:167], v[132:135], v[200:203]
  s_nop 0
  v_pk_mul_f16 v149, v89, v96 op_sel:[1,0] op_sel_hi:[1,1]
  v_mfma_f32_16x16x32_f16 v[216:219], v[164:167], v[144:147], v[216:219]
  v_pk_mul_f16 v150, v89, v97 op_sel:[0,0] op_sel_hi:[0,1]
  v_mfma_f32_16x16x32_f16 v[232:235], v[164:167], v[156:159], v[232:235]
  s_nop 0
  s_waitcnt lgkmcnt(3)
  v_pk_mul_f16 v151, v89, v97 op_sel:[1,0] op_sel_hi:[1,1]
  v_mfma_f32_16x16x32_f16 v[188:191], v[168:171], v[120:123], v[188:191]
  ds_read_b128 v[164:167], v1 offset:16384
  v_pk_mul_f16 v160, v103, v110 op_sel:[0,0] op_sel_hi:[0,1]
  v_mfma_f32_16x16x32_f16 v[204:207], v[168:171], v[132:135], v[204:207]
  v_pk_mul_f16 v161, v103, v110 op_sel:[1,0] op_sel_hi:[1,1]
  v_mfma_f32_16x16x32_f16 v[220:223], v[168:171], v[144:147], v[220:223]
  v_pk_mul_f16 v162, v103, v111 op_sel:[0,0] op_sel_hi:[0,1]
  v_mfma_f32_16x16x32_f16 v[236:239], v[168:171], v[156:159], v[236:239]
  s_waitcnt lgkmcnt(3)
  v_pk_mul_f16 v163, v103, v111 op_sel:[1,0] op_sel_hi:[1,1]
  v_smfmac_f32_16x16x64_f16 v[196:199], v[172:175], v[116:123], v9
  s_nop 0
  ds_read_b128 v[168:171], v1 offset:20480
  v_smfmac_f32_16x16x64_f16 v[212:215], v[172:175], v[128:135], v9
  v_pk_mul_f16 v120, v61, v70 op_sel:[0,0] op_sel_hi:[0,1]
  v_smfmac_f32_16x16x64_f16 v[228:231], v[172:175], v[140:147], v9
  v_pk_mul_f16 v121, v61, v70 op_sel:[1,0] op_sel_hi:[1,1]
  v_smfmac_f32_16x16x64_f16 v[244:247], v[172:175], v[152:159], v9
  s_nop 0
  s_waitcnt lgkmcnt(3)
  v_pk_mul_f16 v122, v61, v71 op_sel:[0,0] op_sel_hi:[0,1]
  v_mfma_f32_16x16x32_f16 v[192:195], v[176:179], v[124:127], v[192:195]
  ds_read_b128 v[172:175], v1 offset:18432
  v_pk_mul_f16 v123, v61, v71 op_sel:[1,0] op_sel_hi:[1,1]
  v_mfma_f32_16x16x32_f16 v[208:211], v[176:179], v[136:139], v[208:211]
  v_pk_mul_f16 v132, v75, v84 op_sel:[0,0] op_sel_hi:[0,1]
  v_mfma_f32_16x16x32_f16 v[224:227], v[176:179], v[148:151], v[224:227]
  v_pk_mul_f16 v133, v75, v84 op_sel:[1,0] op_sel_hi:[1,1]
  v_mfma_f32_16x16x32_f16 v[240:243], v[176:179], v[160:163], v[240:243]
  s_waitcnt lgkmcnt(3)
  v_pk_mul_f16 v134, v75, v85 op_sel:[0,0] op_sel_hi:[0,1]
  v_mfma_f32_16x16x32_f16 v[184:187], v[180:183], v[124:127], v[184:187]
  ds_read_b128 v[176:179], v1 offset:19456
  v_pk_mul_f16 v135, v75, v85 op_sel:[1,0] op_sel_hi:[1,1]
  v_mfma_f32_16x16x32_f16 v[200:203], v[180:183], v[136:139], v[200:203]
  v_pk_mul_f16 v144, v89, v98 op_sel:[0,0] op_sel_hi:[0,1]
  v_mfma_f32_16x16x32_f16 v[216:219], v[180:183], v[148:151], v[216:219]
  s_nop 0
  v_pk_mul_f16 v145, v89, v98 op_sel:[1,0] op_sel_hi:[1,1]
  v_mfma_f32_16x16x32_f16 v[232:235], v[180:183], v[160:163], v[232:235]
  s_waitcnt lgkmcnt(3)
  v_pk_mul_f16 v146, v89, v99 op_sel:[0,0] op_sel_hi:[0,1]
  v_mfma_f32_16x16x32_f16 v[188:191], v[164:167], v[124:127], v[188:191]
  ds_read_b128 v[180:183], v1 offset:1024
  v_pk_mul_f16 v147, v89, v99 op_sel:[1,0] op_sel_hi:[1,1]
  v_mfma_f32_16x16x32_f16 v[204:207], v[164:167], v[136:139], v[204:207]
  s_waitcnt vmcnt(1)
  ds_read_u16_d16_hi v32, v10 offset:0
  v_pk_mul_f16 v156, v103, v112 op_sel:[0,0] op_sel_hi:[0,1]
  v_mfma_f32_16x16x32_f16 v[220:223], v[164:167], v[148:151], v[220:223]
  ds_read_u16_d16_hi v33, v10 offset:2
  v_pk_mul_f16 v157, v103, v112 op_sel:[1,0] op_sel_hi:[1,1]
  v_mfma_f32_16x16x32_f16 v[236:239], v[164:167], v[160:163], v[236:239]
  s_nop 0
  s_waitcnt lgkmcnt(5)
  v_pk_mul_f16 v158, v103, v113 op_sel:[0,0] op_sel_hi:[0,1]
  v_mfma_f32_16x16x32_f16 v[192:195], v[168:171], v[120:123], v[192:195]
  ds_read_b128 v[164:167], v1 offset:23552
  v_pk_mul_f16 v159, v103, v113 op_sel:[1,0] op_sel_hi:[1,1]
  v_mfma_f32_16x16x32_f16 v[208:211], v[168:171], v[132:135], v[208:211]
  ds_read_u16_d16_hi v34, v10 offset:2112
  v_pk_mul_f16 v116, v61, v67 op_sel:[0,1] op_sel_hi:[0,0]
  v_mfma_f32_16x16x32_f16 v[224:227], v[168:171], v[144:147], v[224:227]
  ds_read_u16_d16_hi v35, v10 offset:2114
  v_pk_mul_f16 v117, v61, v72 op_sel:[0,0] op_sel_hi:[1,0]
  v_mfma_f32_16x16x32_f16 v[240:243], v[168:171], v[156:159], v[240:243]
  s_nop 0
  s_waitcnt lgkmcnt(7)
  v_pk_mul_f16 v118, v62, v69 op_sel:[0,0] op_sel_hi:[0,1]
  v_mfma_f32_16x16x32_f16 v[184:187], v[172:175], v[120:123], v[184:187]
  ds_read_b128 v[168:171], v1 offset:21504
  v_pk_mul_f16 v119, v62, v69 op_sel:[1,0] op_sel_hi:[1,1]
  v_mfma_f32_16x16x32_f16 v[200:203], v[172:175], v[132:135], v[200:203]
  ds_read_b64_tr_b16 v[60:61], v27 offset:0
  v_pk_mul_f16 v128, v75, v81 op_sel:[0,1] op_sel_hi:[0,0]
  v_mfma_f32_16x16x32_f16 v[216:219], v[172:175], v[144:147], v[216:219]
  ds_read_u16_d16_hi v36, v10 offset:128
  v_pk_mul_f16 v129, v75, v86 op_sel:[0,0] op_sel_hi:[1,0]
  v_mfma_f32_16x16x32_f16 v[232:235], v[172:175], v[156:159], v[232:235]
  s_waitcnt lgkmcnt(9)
  v_pk_mul_f16 v130, v76, v83 op_sel:[0,0] op_sel_hi:[0,1]
  v_pk_mul_f16 v131, v76, v83 op_sel:[1,0] op_sel_hi:[1,1]
  v_mfma_f32_16x16x32_f16 v[188:191], v[176:179], v[120:123], v[188:191]
  ds_read_b128 v[172:175], v1 offset:22528
  v_pk_mul_f16 v140, v89, v95 op_sel:[0,1] op_sel_hi:[0,0]
  v_mfma_f32_16x16x32_f16 v[204:207], v[176:179], v[132:135], v[204:207]
  ds_read_b64_tr_b16 v[74:75], v27 offset:32
  v_pk_mul_f16 v141, v89, v100 op_sel:[0,0] op_sel_hi:[1,0]
  v_mfma_f32_16x16x32_f16 v[220:223], v[176:179], v[144:147], v[220:223]
  ds_read_b64_tr_b16 v[88:89], v27 offset:64
  v_pk_mul_f16 v142, v90, v97 op_sel:[0,0] op_sel_hi:[0,1]
  v_mfma_f32_16x16x32_f16 v[236:239], v[176:179], v[156:159], v[236:239]
  s_waitcnt lgkmcnt(11)
  v_pk_mul_f16 v143, v90, v97 op_sel:[1,0] op_sel_hi:[1,1]
  v_pk_mul_f16 v152, v103, v109 op_sel:[0,1] op_sel_hi:[0,0]
  v_smfmac_f32_16x16x64_f16 v[196:199], v[180:183], v[120:127], v9
  ds_read_b128 v[176:179], v1 offset:26624
  v_pk_mul_f16 v153, v103, v114 op_sel:[0,0] op_sel_hi:[1,0]
  v_smfmac_f32_16x16x64_f16 v[212:215], v[180:183], v[132:139], v9
  ds_read_b64_tr_b16 v[102:103], v27 offset:96
  v_pk_mul_f16 v154, v104, v111 op_sel:[0,0] op_sel_hi:[0,1]
  v_smfmac_f32_16x16x64_f16 v[228:231], v[180:183], v[144:151], v9
  ds_read_u16_d16_hi v37, v10 offset:130
  v_pk_mul_f16 v155, v104, v111 op_sel:[1,0] op_sel_hi:[1,1]
  v_smfmac_f32_16x16x64_f16 v[244:247], v[180:183], v[156:163], v9
  s_nop 0
  s_waitcnt lgkmcnt(11)
  v_pk_mul_f16 v120, v62, v70 op_sel:[0,0] op_sel_hi:[0,1]
  v_mfma_f32_16x16x32_f16 v[192:195], v[164:167], v[116:119], v[192:195]
  ds_read_b128 v[180:183], v1 offset:24576
  v_pk_mul_f16 v121, v62, v70 op_sel:[1,0] op_sel_hi:[1,1]
  v_mfma_f32_16x16x32_f16 v[208:211], v[164:167], v[128:131], v[208:211]
  ds_read_u16_d16_hi v38, v10 offset:2240
  v_pk_mul_f16 v122, v62, v71 op_sel:[0,0] op_sel_hi:[0,1]
  v_mfma_f32_16x16x32_f16 v[224:227], v[164:167], v[140:143], v[224:227]
  ds_read_u16_d16_hi v39, v10 offset:2242
  v_pk_mul_f16 v123, v62, v71 op_sel:[1,0] op_sel_hi:[1,1]
  v_mfma_f32_16x16x32_f16 v[240:243], v[164:167], v[152:155], v[240:243]
  s_waitcnt lgkmcnt(11)
  v_pk_mul_f16 v132, v76, v84 op_sel:[0,0] op_sel_hi:[0,1]
  v_max3_f32 v58, |v32|, |v33|, 0
  v_mfma_f32_16x16x32_f16 v[184:187], v[168:171], v[116:119], v[184:187]
  ds_read_b128 v[164:167], v1 offset:25600
  v_pk_mul_f16 v133, v76, v84 op_sel:[1,0] op_sel_hi:[1,1]
  v_mfma_f32_16x16x32_f16 v[200:203], v[168:171], v[128:131], v[200:203]
  ds_read_u16_d16_hi v40, v10 offset:256
  v_pk_mul_f16 v134, v76, v85 op_sel:[0,0] op_sel_hi:[0,1]
  v_mfma_f32_16x16x32_f16 v[216:219], v[168:171], v[140:143], v[216:219]
  ds_read_u16_d16_hi v41, v10 offset:258
  v_pk_mul_f16 v135, v76, v85 op_sel:[1,0] op_sel_hi:[1,1]
  v_mfma_f32_16x16x32_f16 v[232:235], v[168:171], v[152:155], v[232:235]
  s_waitcnt lgkmcnt(11)
  v_pk_mul_f16 v144, v90, v98 op_sel:[0,0] op_sel_hi:[0,1]
  v_max3_f32 v58, |v34|, |v35|, v58
  v_mfma_f32_16x16x32_f16 v[188:191], v[172:175], v[116:119], v[188:191]
  ds_read_b128 v[168:171], v1 offset:2048
  v_pk_mul_f16 v145, v90, v98 op_sel:[1,0] op_sel_hi:[1,1]
  v_mfma_f32_16x16x32_f16 v[204:207], v[172:175], v[128:131], v[204:207]
  ds_read_u16_d16_hi v42, v10 offset:2368
  v_pk_mul_f16 v146, v90, v99 op_sel:[0,0] op_sel_hi:[0,1]
  v_mfma_f32_16x16x32_f16 v[220:223], v[172:175], v[140:143], v[220:223]
  ds_read_u16_d16_hi v43, v10 offset:2370
  v_pk_mul_f16 v147, v90, v99 op_sel:[1,0] op_sel_hi:[1,1]
  v_mfma_f32_16x16x32_f16 v[236:239], v[172:175], v[152:155], v[236:239]
  s_nop 0
  s_waitcnt lgkmcnt(11)
  v_pk_mul_f16 v156, v104, v112 op_sel:[0,0] op_sel_hi:[0,1]
  v_mfma_f32_16x16x32_f16 v[192:195], v[176:179], v[120:123], v[192:195]
  ds_read_b128 v[172:175], v1 offset:29696
  v_pk_mul_f16 v157, v104, v112 op_sel:[1,0] op_sel_hi:[1,1]
  v_mfma_f32_16x16x32_f16 v[208:211], v[176:179], v[132:135], v[208:211]
  ds_read_u16_d16_hi v44, v10 offset:384
  v_pk_mul_f16 v158, v104, v113 op_sel:[0,0] op_sel_hi:[0,1]
  v_mfma_f32_16x16x32_f16 v[224:227], v[176:179], v[144:147], v[224:227]
  ds_read_u16_d16_hi v45, v10 offset:386
  v_pk_mul_f16 v159, v104, v113 op_sel:[1,0] op_sel_hi:[1,1]
  s_nop 1
  v_mfma_f32_16x16x32_f16 v[240:243], v[176:179], v[156:159], v[240:243]
  s_waitcnt lgkmcnt(11)
  v_pk_mul_f16 v124, v62, v68 op_sel:[0,1] op_sel_hi:[0,0]
  v_mfma_f32_16x16x32_f16 v[184:187], v[180:183], v[120:123], v[184:187]
  ds_read_b128 v[176:179], v1 offset:27648
  v_pk_mul_f16 v125, v62, v72 op_sel:[0,0] op_sel_hi:[1,0]
  v_mfma_f32_16x16x32_f16 v[200:203], v[180:183], v[132:135], v[200:203]
  ds_read_u16_d16_hi v46, v10 offset:2496
  v_pk_mul_f16 v126, v63, v70 op_sel:[0,0] op_sel_hi:[0,1]
  v_mfma_f32_16x16x32_f16 v[216:219], v[180:183], v[144:147], v[216:219]
  ds_read_u16_d16_hi v47, v10 offset:2498
  v_pk_mul_f16 v127, v63, v70 op_sel:[1,0] op_sel_hi:[1,1]
  v_mfma_f32_16x16x32_f16 v[232:235], v[180:183], v[156:159], v[232:235]
  s_waitcnt lgkmcnt(11)
  v_pk_mul_f16 v136, v76, v82 op_sel:[0,1] op_sel_hi:[0,0]
  v_pk_mul_f16 v137, v76, v86 op_sel:[0,0] op_sel_hi:[1,0]
  v_mfma_f32_16x16x32_f16 v[188:191], v[164:167], v[120:123], v[188:191]
  ds_read_b128 v[180:183], v1 offset:28672
  v_pk_mul_f16 v138, v77, v84 op_sel:[0,0] op_sel_hi:[0,1]
  v_mfma_f32_16x16x32_f16 v[204:207], v[164:167], v[132:135], v[204:207]
  ds_read_u16_d16_hi v48, v10 offset:512
  v_pk_mul_f16 v139, v77, v84 op_sel:[1,0] op_sel_hi:[1,1]
  v_mfma_f32_16x16x32_f16 v[220:223], v[164:167], v[144:147], v[220:223]
  ds_read_u16_d16_hi v49, v10 offset:514
  v_pk_mul_f16 v148, v90, v96 op_sel:[0,1] op_sel_hi:[0,0]
  v_mfma_f32_16x16x32_f16 v[236:239], v[164:167], v[156:159], v[236:239]
  s_waitcnt lgkmcnt(11)
  v_pk_mul_f16 v149, v90, v100 op_sel:[0,0] op_sel_hi:[1,0]
  v_pk_mul_f16 v150, v91, v98 op_sel:[0,0] op_sel_hi:[0,1]
  v_smfmac_f32_16x16x64_f16 v[196:199], v[168:171], v[116:123], v9
  ds_read_b128 v[164:167], v1 offset:32768
  v_pk_mul_f16 v151, v91, v98 op_sel:[1,0] op_sel_hi:[1,1]
  v_smfmac_f32_16x16x64_f16 v[212:215], v[168:171], v[128:135], v9
  ds_read_u16_d16_hi v50, v10 offset:2624
  v_pk_mul_f16 v160, v104, v110 op_sel:[0,1] op_sel_hi:[0,0]
  v_smfmac_f32_16x16x64_f16 v[228:231], v[168:171], v[140:147], v9
  ds_read_u16_d16_hi v51, v10 offset:2626
  v_pk_mul_f16 v161, v104, v114 op_sel:[0,0] op_sel_hi:[1,0]
  v_smfmac_f32_16x16x64_f16 v[244:247], v[168:171], v[152:159], v9
  s_nop 0
  s_waitcnt lgkmcnt(11)
  v_pk_mul_f16 v162, v105, v112 op_sel:[0,0] op_sel_hi:[0,1]
  v_mfma_f32_16x16x32_f16 v[192:195], v[172:175], v[124:127], v[192:195]
  ds_read_b128 v[168:171], v1 offset:30720
  v_pk_mul_f16 v163, v105, v112 op_sel:[1,0] op_sel_hi:[1,1]
  v_mfma_f32_16x16x32_f16 v[208:211], v[172:175], v[136:139], v[208:211]
  ds_read_u16_d16_hi v52, v10 offset:640
  v_pk_mul_f16 v120, v63, v71 op_sel:[0,0] op_sel_hi:[0,1]
  v_mfma_f32_16x16x32_f16 v[224:227], v[172:175], v[148:151], v[224:227]
  ds_read_u16_d16_hi v53, v10 offset:642
  v_pk_mul_f16 v121, v63, v71 op_sel:[1,0] op_sel_hi:[1,1]
  v_mfma_f32_16x16x32_f16 v[240:243], v[172:175], v[160:163], v[240:243]
  s_waitcnt lgkmcnt(11)
  v_pk_mul_f16 v122, v63, v69 op_sel:[0,1] op_sel_hi:[1,1]
  v_pk_mul_f16 v123, v63, v72 op_sel:[0,0] op_sel_hi:[1,0]
  v_mfma_f32_16x16x32_f16 v[184:187], v[176:179], v[124:127], v[184:187]
  ds_read_b128 v[172:175], v1 offset:31744
  v_pk_mul_f16 v132, v77, v85 op_sel:[0,0] op_sel_hi:[0,1]
  v_mfma_f32_16x16x32_f16 v[200:203], v[176:179], v[136:139], v[200:203]
  ds_read_u16_d16_hi v54, v10 offset:2752
  v_pk_mul_f16 v133, v77, v85 op_sel:[1,0] op_sel_hi:[1,1]
  v_mfma_f32_16x16x32_f16 v[216:219], v[176:179], v[148:151], v[216:219]
  ds_read_u16_d16_hi v55, v10 offset:2754
  v_pk_mul_f16 v134, v77, v83 op_sel:[0,1] op_sel_hi:[1,1]
  v_mfma_f32_16x16x32_f16 v[232:235], v[176:179], v[160:163], v[232:235]
  s_waitcnt lgkmcnt(11)
  v_pk_mul_f16 v135, v77, v86 op_sel:[0,0] op_sel_hi:[1,0]
  v_pk_mul_f16 v144, v91, v99 op_sel:[0,0] op_sel_hi:[0,1]
  v_mfma_f32_16x16x32_f16 v[188:191], v[180:183], v[124:127], v[188:191]
  ds_read_b128 v[176:179], v1 offset:3072
  v_pk_mul_f16 v145, v91, v99 op_sel:[1,0] op_sel_hi:[1,1]
  v_mfma_f32_16x16x32_f16 v[204:207], v[180:183], v[136:139], v[204:207]
  ds_read_u16_d16_hi v56, v10 offset:768
  v_pk_mul_f16 v146, v91, v97 op_sel:[0,1] op_sel_hi:[1,1]
  v_mfma_f32_16x16x32_f16 v[220:223], v[180:183], v[148:151], v[220:223]
  ds_read_u16_d16_hi v57, v10 offset:770
  v_pk_mul_f16 v147, v91, v100 op_sel:[0,0] op_sel_hi:[1,0]
  v_mfma_f32_16x16x32_f16 v[236:239], v[180:183], v[160:163], v[236:239]
  s_waitcnt lgkmcnt(11)
  v_pk_mul_f16 v156, v105, v113 op_sel:[0,0] op_sel_hi:[0,1]
  v_max3_f32 v58, |v36|, |v37|, v58
  v_mfma_f32_16x16x32_f16 v[192:195], v[164:167], v[120:123], v[192:195]
  ds_read_b128 v[180:183], v1 offset:35840
  v_pk_mul_f16 v157, v105, v113 op_sel:[1,0] op_sel_hi:[1,1]
  v_mfma_f32_16x16x32_f16 v[208:211], v[164:167], v[132:135], v[208:211]
  v_pk_mul_f16 v158, v105, v111 op_sel:[0,1] op_sel_hi:[1,1]
  v_max3_f32 v58, |v38|, |v39|, v58
  v_mfma_f32_16x16x32_f16 v[224:227], v[164:167], v[144:147], v[224:227]
  v_pk_mul_f16 v159, v105, v114 op_sel:[0,0] op_sel_hi:[1,0]
  v_max3_f32 v58, |v40|, |v41|, v58
  s_nop 0
  v_mfma_f32_16x16x32_f16 v[240:243], v[164:167], v[156:159], v[240:243]
  s_nop 0
  s_waitcnt lgkmcnt(9)
  v_pk_mul_f16 v116, v64, v71 op_sel:[0,0] op_sel_hi:[0,1]
  v_mfma_f32_16x16x32_f16 v[184:187], v[168:171], v[120:123], v[184:187]
  ds_read_b128 v[164:167], v1 offset:33792
  v_pk_mul_f16 v117, v64, v71 op_sel:[1,0] op_sel_hi:[1,1]
  v_mfma_f32_16x16x32_f16 v[200:203], v[168:171], v[132:135], v[200:203]
  v_pk_mul_f16 v118, v64, v70 op_sel:[0,1] op_sel_hi:[1,1]
  v_max3_f32 v58, |v42|, |v43|, v58
  v_mfma_f32_16x16x32_f16 v[216:219], v[168:171], v[144:147], v[216:219]
  v_pk_mul_f16 v119, v64, v72 op_sel:[0,0] op_sel_hi:[1,0]
  v_pk_mul_f16 v128, v78, v85 op_sel:[0,0] op_sel_hi:[0,1]
  v_mfma_f32_16x16x32_f16 v[232:235], v[168:171], v[156:159], v[232:235]
  s_waitcnt lgkmcnt(7)
  v_pk_mul_f16 v129, v78, v85 op_sel:[1,0] op_sel_hi:[1,1]
  v_pk_mul_f16 v130, v78, v84 op_sel:[0,1] op_sel_hi:[1,1]
  v_mfma_f32_16x16x32_f16 v[188:191], v[172:175], v[120:123], v[188:191]
  ds_read_b128 v[168:171], v1 offset:34816
  v_pk_mul_f16 v131, v78, v86 op_sel:[0,0] op_sel_hi:[1,0]
  v_mfma_f32_16x16x32_f16 v[204:207], v[172:175], v[132:135], v[204:207]
  v_pk_mul_f16 v140, v92, v99 op_sel:[0,0] op_sel_hi:[0,1]
  v_pk_mul_f16 v141, v92, v99 op_sel:[1,0] op_sel_hi:[1,1]
  v_mfma_f32_16x16x32_f16 v[220:223], v[172:175], v[144:147], v[220:223]
  v_pk_mul_f16 v142, v92, v98 op_sel:[0,1] op_sel_hi:[1,1]
  v_pk_mul_f16 v143, v92, v100 op_sel:[0,0] op_sel_hi:[1,0]
  v_mfma_f32_16x16x32_f16 v[236:239], v[172:175], v[156:159], v[236:239]
  s_waitcnt lgkmcnt(5)
  v_pk_mul_f16 v152, v106, v113 op_sel:[0,0] op_sel_hi:[0,1]
  v_smfmac_f32_16x16x64_f16 v[196:199], v[176:179], v[120:127], v9
  ds_read_b128 v[172:175], v1 offset:38912
  v_pk_mul_f16 v153, v106, v113 op_sel:[1,0] op_sel_hi:[1,1]
  v_smfmac_f32_16x16x64_f16 v[212:215], v[176:179], v[132:139], v9
  v_pk_mul_f16 v154, v106, v112 op_sel:[0,1] op_sel_hi:[1,1]
  v_smfmac_f32_16x16x64_f16 v[228:231], v[176:179], v[144:151], v9
  v_pk_mul_f16 v155, v106, v114 op_sel:[0,0] op_sel_hi:[1,0]
  v_smfmac_f32_16x16x64_f16 v[244:247], v[176:179], v[156:163], v9
  s_waitcnt lgkmcnt(3)
  v_pk_mul_f16 v120, v65, v71 op_sel:[0,1] op_sel_hi:[1,1]
  v_mfma_f32_16x16x32_f16 v[192:195], v[180:183], v[116:119], v[192:195]
  ds_read_b128 v[176:179], v1 offset:36864
  v_pk_mul_f16 v121, v65, v72 op_sel:[0,0] op_sel_hi:[1,0]
  v_mfma_f32_16x16x32_f16 v[208:211], v[180:183], v[128:131], v[208:211]
  s_nop 0
  v_pk_mul_f16 v122, v72, v72 op_sel:[0,0] op_sel_hi:[1,1]
  v_max3_f32 v58, |v44|, |v45|, v58
  v_mfma_f32_16x16x32_f16 v[224:227], v[180:183], v[140:143], v[224:227]
  v_pk_mul_f16 v123, v60, v61 op_sel:[0,0] op_sel_hi:[1,1]
  v_max3_f32 v58, |v46|, |v47|, v58
  v_mfma_f32_16x16x32_f16 v[240:243], v[180:183], v[152:155], v[240:243]
  s_nop 0
  s_waitcnt lgkmcnt(3)
  v_pk_mul_f16 v132, v79, v85 op_sel:[0,1] op_sel_hi:[1,1]
  v_mfma_f32_16x16x32_f16 v[184:187], v[164:167], v[116:119], v[184:187]
  ds_read_b128 v[180:183], v1 offset:37888
  v_pk_mul_f16 v133, v79, v86 op_sel:[0,0] op_sel_hi:[1,0]
  v_mfma_f32_16x16x32_f16 v[200:203], v[164:167], v[128:131], v[200:203]
  v_pk_mul_f16 v134, v86, v86 op_sel:[0,0] op_sel_hi:[1,1]
  v_max3_f32 v58, |v48|, |v49|, v58
  v_mfma_f32_16x16x32_f16 v[216:219], v[164:167], v[140:143], v[216:219]
  v_pk_mul_f16 v135, v74, v75 op_sel:[0,0] op_sel_hi:[1,1]
  v_max3_f32 v58, |v50|, |v51|, v58
  v_mfma_f32_16x16x32_f16 v[232:235], v[164:167], v[152:155], v[232:235]
  s_waitcnt lgkmcnt(3)
  v_pk_mul_f16 v144, v93, v99 op_sel:[0,1] op_sel_hi:[1,1]
  v_mfma_f32_16x16x32_f16 v[188:191], v[168:171], v[116:119], v[188:191]
  ds_read_b128 v[164:167], v1 offset:4096
  v_pk_mul_f16 v145, v93, v100 op_sel:[0,0] op_sel_hi:[1,0]
  v_mfma_f32_16x16x32_f16 v[204:207], v[168:171], v[128:131], v[204:207]
  s_nop 0
  v_pk_mul_f16 v146, v100, v100 op_sel:[0,0] op_sel_hi:[1,1]
  v_max3_f32 v58, |v52|, |v53|, v58
  v_mfma_f32_16x16x32_f16 v[220:223], v[168:171], v[140:143], v[220:223]
  v_pk_mul_f16 v147, v88, v89 op_sel:[0,0] op_sel_hi:[1,1]
  v_max3_f32 v58, |v54|, |v55|, v58
  v_mfma_f32_16x16x32_f16 v[236:239], v[168:171], v[152:155], v[236:239]
  s_waitcnt lgkmcnt(3)
  v_pk_mul_f16 v156, v107, v113 op_sel:[0,1] op_sel_hi:[1,1]
  v_mfma_f32_16x16x32_f16 v[192:195], v[172:175], v[120:123], v[192:195]
  s_nop 0
  v_pk_mul_f16 v157, v107, v114 op_sel:[0,0] op_sel_hi:[1,0]
  v_max3_f32 v58, |v56|, |v57|, v58
  v_mfma_f32_16x16x32_f16 v[208:211], v[172:175], v[132:135], v[208:211]
  v_pk_mul_f16 v158, v114, v114 op_sel:[0,0] op_sel_hi:[1,1]
  v_cvt_pk_f16_f32 v62, v32, v33
  v_mfma_f32_16x16x32_f16 v[224:227], v[172:175], v[144:147], v[224:227]
  s_nop 0
  v_pk_mul_f16 v159, v102, v103 op_sel:[0,0] op_sel_hi:[1,1]
  s_nop 1
  v_mfma_f32_16x16x32_f16 v[240:243], v[172:175], v[156:159], v[240:243]
  s_waitcnt lgkmcnt(2)
  v_cvt_pk_f16_f32 v76, v34, v35
  v_cvt_pk_f16_f32 v90, v36, v37
  v_mfma_f32_16x16x32_f16 v[184:187], v[176:179], v[120:123], v[184:187]
  ds_write_b32 v11, v62 offset:0
  v_mfma_f32_16x16x32_f16 v[200:203], v[176:179], v[132:135], v[200:203]
  ds_write_b32 v11, v76 offset:160
  v_mfma_f32_16x16x32_f16 v[216:219], v[176:179], v[144:147], v[216:219]
  ds_write_b32 v11, v90 offset:320
  v_mfma_f32_16x16x32_f16 v[232:235], v[176:179], v[156:159], v[232:235]
  s_waitcnt lgkmcnt(4)
  v_cvt_pk_f16_f32 v104, v38, v39
  v_cvt_pk_f16_f32 v63, v40, v41
  v_mfma_f32_16x16x32_f16 v[188:191], v[180:183], v[120:123], v[188:191]
  ds_write_b32 v11, v104 offset:480
  v_mfma_f32_16x16x32_f16 v[204:207], v[180:183], v[132:135], v[204:207]
  ds_write_b32 v11, v63 offset:640
  v_mfma_f32_16x16x32_f16 v[220:223], v[180:183], v[144:147], v[220:223]
  s_nop 0
  v_cvt_pk_f16_f32 v77, v42, v43
  v_cvt_pk_f16_f32 v91, v44, v45
  v_mfma_f32_16x16x32_f16 v[236:239], v[180:183], v[156:159], v[236:239]
  s_waitcnt lgkmcnt(5)
  v_cvt_pk_f16_f32 v105, v46, v47
  v_cvt_pk_f16_f32 v66, v48, v49
  v_smfmac_f32_16x16x64_f16 v[196:199], v[164:167], v[116:123], v9
  ds_write_b32 v11, v77 offset:800
  v_smfmac_f32_16x16x64_f16 v[212:215], v[164:167], v[128:135], v9
  ds_write_b32 v11, v91 offset:960
  v_smfmac_f32_16x16x64_f16 v[228:231], v[164:167], v[140:147], v9
  ds_write_b32 v11, v105 offset:1120
  v_smfmac_f32_16x16x64_f16 v[244:247], v[164:167], v[152:159], v9
  ds_write_b32 v11, v66 offset:1280
  s_setprio 0
  s_sub_u32 s72, s72, 1
  s_cmp_eq_u32 s72, 0
  s_cbranch_scc1 L_cin_done
  v_cvt_pk_f16_f32 v80, v50, v51
  v_cvt_pk_f16_f32 v94, v52, v53
  v_cvt_pk_f16_f32 v108, v54, v55
  v_cvt_pk_f16_f32 v67, v56, v57
  ds_write_b32 v11, v80 offset:1440
  ds_write_b32 v11, v94 offset:1600
  ds_write_b32 v11, v108 offset:1760
  ds_write_b32 v11, v67 offset:1920
  s_branch L_cin_loop
L_cslow:
  v_max_f32_dpp v58, v58, v58 row_shr:1 row_mask:0xf bank_mask:0xf
  s_nop 1
  v_max_f32_dpp v58, v58, v58 row_shr:2 row_mask:0xf bank_mask:0xf
  s_nop 1
  v_max_f32_dpp v58, v58, v58 row_shr:4 row_mask:0xf bank_mask:0xf
  s_nop 1
  v_max_f32_dpp v58, v58, v58 row_shr:8 row_mask:0xf bank_mask:0xf
  s_nop 1
  v_max_f32_dpp v58, v58, v58 row_bcast:15 row_mask:0xa bank_mask:0xf
  s_nop 1
  v_max_f32_dpp v58, v58, v58 row_bcast:31 row_mask:0xc bank_mask:0xf
  s_nop 0
  v_readlane_b32 s98, v58, 63
  s_mov_b32 s97, 0
  s_lshr_b32 s98, s98, 23
  s_min_u32 s98, s98, 182
  s_lshr_b32 s99, s1, 23
  s_sub_u32 s99, s99, 47
  s_lshr_b32 s99, s99, 1
  s_min_u32 s99, s99, 59
  s_sub_u32 s99, 131, s99
  s_max_u32 s98, s98, s99
  s_sub_u32 s99, 258, s98
  s_lshl_b32 s100, s99, 1
  s_sub_u32 s100, s100, 127
  s_sub_u32 s95, 254, s100
  s_lshl_b32 s95, s95, 23
  v_mov_b32 v60, s95
  v_mul_f32 v61, s0, v60
  v_mul_f32 v60, s1, v60
  v_readfirstlane_b32 s74, v61
  v_readfirstlane_b32 s75, v60
  s_lshl_b32 s99, s99, 23
  s_lshl_b32 s100, s100, 23
  v_mul_f32 v60, s99, v32
  v_mul_f32 v61, s99, v33
  v_mul_f32 v62, s100, v32
  v_mul_f32 v63, s100, v33
  v_cvt_pk_f16_f32 v80, v60, v61
  v_cvt_pk_bf16_f32 v64, v62, v63
  ds_write_b32 v11, v80 offset:0
  ds_write_b32 v10, v64 offset:0
  v_mul_f32 v60, s99, v34
  v_mul_f32 v61, s99, v35
  v_mul_f32 v62, s100, v34
  v_mul_f32 v63, s100, v35
  v_cvt_pk_f16_f32 v81, v60, v61
  v_cvt_pk_bf16_f32 v65, v62, v63
  ds_write_b32 v11, v81 offset:160
  ds_write_b32 v10, v65 offset:2112
  v_mul_f32 v60, s99, v36
  v_mul_f32 v61, s99, v37
  v_mul_f32 v62, s100, v36
  v_mul_f32_e64 v63, s100, v37
  v_cvt_pk_f16_f32 v82, v60, v61
  v_cvt_pk_bf16_f32 v66, v62, v63
  ds_write_b32 v11, v82 offset:320
  ds_write_b32 v10, v66 offset:128
  v_mul_f32 v60, s99, v38
  v_mul_f32 v61, s99, v39
  v_mul_f32 v62, s100, v38
  v_mul_f32 v63, s100, v39
  v_cvt_pk_f16_f32 v83, v60, v61
  v_cvt_pk_bf16_f32 v67, v62, v63
  ds_write_b32 v11, v83 offset:480
  ds_write_b32 v10, v67 offset:2240
  v_mul_f32 v60, s99, v40
  v_mul_f32 v61, s99, v41
  v_mul_f32 v62, s100, v40
  v_mul_f32 v63, s100, v41
  v_cvt_pk_f16_f32 v84, v60, v61
  v_cvt_pk_bf16_f32 v68, v62, v63
  ds_write_b32 v11, v84 offset:640
  ds_write_b32 v10, v68 offset:256
  v_mul_f32 v60, s99, v42
  v_mul_f32 v61, s99, v43
  v_mul_f32 v62, s100, v42
  v_mul_f32 v63, s100, v43
  v_cvt_pk_f16_f32 v85, v60, v61
  v_cvt_pk_bf16_f32 v69, v62, v63
  ds_write_b32 v11, v85 offset:800
  ds_write_b32 v10, v69 offset:2368
  v_mul_f32 v60, s99, v44
  v_mul_f32 v61, s99, v45
  v_mul_f32 v62, s100, v44
  v_mul_f32 v63, s100, v45
  v_cvt_pk_f16_f32 v86, v60, v61
  v_cvt_pk_bf16_f32 v70, v62, v63
  ds_write_b32 v11, v86 offset:960
  ds_write_b32 v10, v70 offset:384
  v_mul_f32 v60, s99, v46
  v_mul_f32 v61, s99, v47
  v_mul_f32 v62, s100, v46
  v_mul_f32 v63, s100, v47
  v_cvt_pk_f16_f32 v87, v60, v61
  v_cvt_pk_bf16_f32 v71, v62, v63
  ds_write_b32 v11, v87 offset:1120
  ds_write_b32 v10, v71 offset:2496
  v_mul_f32 v60, s99, v48
  v_mul_f32 v61, s99, v49
  v_mul_f32 v62, s100, v48
  v_mul_f32 v63, s100, v49
  v_cvt_pk_f16_f32 v88, v60, v61
  v_cvt_pk_bf16_f32 v72, v62, v63
  ds_write_b32 v11, v88 offset:1280
  ds_write_b32 v10, v72 offset:512
  v_mul_f32 v60, s99, v50
  v_mul_f32 v61, s99, v51
  v_mul_f32 v62, s100, v50
  v_mul_f32 v63, s100, v51
  v_cvt_pk_f16_f32 v89, v60, v61
  v_cvt_pk_bf16_f32 v73, v62, v63
  ds_write_b32 v11, v89 offset:1440
  ds_write_b32 v10, v73 offset:2624
  v_mul_f32 v60, s99, v52
  v_mul_f32 v61, s99, v53
  v_mul_f32 v62, s100, v52
  v_mul_f32 v63, s100, v53
  v_cvt_pk_f16_f32 v90, v60, v61
  v_cvt_pk_bf16_f32 v74, v62, v63
  ds_write_b32 v11, v90 offset:1600
  ds_write_b32 v10, v74 offset:640
  v_mul_f32 v60, s99, v54
  v_mul_f32 v61, s99, v55
  v_mul_f32 v62, s100, v54
  v_mul_f32 v63, s100, v55
  v_cvt_pk_f16_f32 v91, v60, v61
  v_cvt_pk_bf16_f32 v75, v62, v63
  ds_write_b32 v11, v91 offset:1760
  ds_write_b32 v10, v75 offset:2752
  v_mul_f32 v60, s99, v56
  v_mul_f32 v61, s99, v57
  v_mul_f32 v62, s100, v56
  v_mul_f32 v63, s100, v57
  v_cvt_pk_f16_f32 v92, v60, v61
  v_cvt_pk_bf16_f32 v76, v62, v63
  ds_write_b32 v11, v92 offset:1920
  ds_write_b32 v10, v76 offset:768
  v_mov_b32 v60, s100
  v_cvt_pk_bf16_f32 v60, v60, v60
  s_mov_b32 exec_hi, 0
  ds_write_b32 v10, v60 offset:2880
  s_mov_b32 exec_hi, -1
  s_waitcnt lgkmcnt(0)
  s_branch L_cconv
L_sdown:
  v_lshlrev_b32 v108, 16, v112
  v_and_b32 v109, 0xffff0000, v112
  v_mul_f32 v108, v108, v250
  v_mul_f32 v109, v109, v250
  v_cvt_pk_bf16_f32 v112, v108, v109
  v_lshlrev_b32 v108, 16, v113
  v_and_b32 v109, 0xffff0000, v113
  v_mul_f32 v108, v108, v250
  v_mul_f32 v109, v109, v250
  v_cvt_pk_bf16_f32 v113, v108, v109
  v_lshlrev_b32 v108, 16, v114
  v_and_b32 v109, 0xffff0000, v114
  v_mul_f32 v108, v108, v250
  v_mul_f32 v109, v109, v250
  v_cvt_pk_bf16_f32 v114, v108, v109
  v_lshlrev_b32_e64 v108, 16, v115
  v_and_b32 v109, 0xffff0000, v115
  v_mul_f32 v108, v108, v250
  v_mul_f32 v109, v109, v250
  v_cvt_pk_bf16_f32 v115, v108, v109
  v_lshlrev_b32 v108, 16, v116
  v_and_b32 v109, 0xffff0000, v116
  v_mul_f32 v108, v108, v250
  v_mul_f32 v109, v109, v250
  v_cvt_pk_bf16_f32 v116, v108, v109
  v_lshlrev_b32 v108, 16, v117
  v_and_b32 v109, 0xffff0000, v117
  v_mul_f32 v108, v108, v250
  v_mul_f32 v109, v109, v250
  v_cvt_pk_bf16_f32 v117, v108, v109
  v_lshlrev_b32 v108, 16, v118
  v_and_b32 v109, 0xffff0000, v118
  v_mul_f32 v108, v108, v250
  v_mul_f32 v109, v109, v250
  v_cvt_pk_bf16_f32 v118, v108, v109
  v_lshlrev_b32 v108, 16, v119
  v_and_b32 v109, 0xffff0000, v119
  v_mul_f32 v108, v108, v250
  v_mul_f32 v109, v109, v250
  v_cvt_pk_bf16_f32 v119, v108, v109
  s_branch L_scaled
L_first:
  ds_read_b64_tr_b16 v[60:61], v20 offset:0
  ds_read_b64_tr_b16 v[74:75], v20 offset:32
  ds_read_b64_tr_b16 v[88:89], v20 offset:64
  ds_read_b64_tr_b16 v[102:103], v20 offset:96
  ds_read_b64_tr_b16 v[66:67], v23 offset:0
  ds_read_b64_tr_b16 v[80:81], v23 offset:32
  ds_read_b64_tr_b16 v[94:95], v23 offset:64
  ds_read_b64_tr_b16 v[108:109], v23 offset:96
  ds_read_b64_tr_b16 v[68:69], v24 offset:0
  ds_read_b64_tr_b16 v[82:83], v24 offset:32
  ds_read_b64_tr_b16 v[96:97], v24 offset:64
  ds_read_b64_tr_b16 v[110:111], v24 offset:96
  ds_read_b64_tr_b16 v[124:125], v4 offset:0
  ds_read_b64_tr_b16 v[126:127], v5 offset:0
  ds_read_b64_tr_b16 v[136:137], v4 offset:32
  ds_read_b64_tr_b16 v[138:139], v5 offset:32
  ds_read_b64_tr_b16 v[148:149], v4 offset:64
  ds_read_b64_tr_b16 v[150:151], v5 offset:64
  ds_read_b64_tr_b16 v[160:161], v4 offset:96
  ds_read_b64_tr_b16 v[162:163], v5 offset:96
  ds_read_b128 v[164:167], v1 offset:39936
  ds_read_b128 v[168:171], v1 offset:40960
  ds_read_b128 v[172:175], v1 offset:8192
  ds_read_b128 v[176:179], v1 offset:6144
  ds_read_b64_tr_b16 v[70:71], v25 offset:0
  ds_read_b64_tr_b16 v[84:85], v25 offset:32
  ds_read_b64_tr_b16 v[98:99], v25 offset:64
  ds_read_b64_tr_b16 v[112:113], v25 offset:96
  ds_read_b64_tr_b16 v[72:73], v26 offset:0
  s_waitcnt lgkmcnt(14)
  v_pk_mul_f16 v120, v60, v67 op_sel:[0,0] op_sel_hi:[0,1]
  v_pk_mul_f16 v121, v60, v67 op_sel:[1,0] op_sel_hi:[1,1]
  ds_read_b64_tr_b16 v[86:87], v26 offset:32
  v_pk_mul_f16 v122, v60, v68 op_sel:[0,0] op_sel_hi:[0,1]
  ds_read_b64_tr_b16 v[100:101], v26 offset:64
  v_pk_mul_f16 v123, v60, v68 op_sel:[1,0] op_sel_hi:[1,1]
  ds_read_b64_tr_b16 v[114:115], v26 offset:96
  v_pk_mul_f16 v132, v74, v81 op_sel:[0,0] op_sel_hi:[0,1]
  v_pk_mul_f16 v133, v74, v81 op_sel:[1,0] op_sel_hi:[1,1]
  ds_read_b64_tr_b16 v[62:63], v21 offset:0
  v_pk_mul_f16 v134, v74, v82 op_sel:[0,0] op_sel_hi:[0,1]
  ds_read_b64_tr_b16 v[76:77], v21 offset:32
  v_pk_mul_f16 v135, v74, v82 op_sel:[1,0] op_sel_hi:[1,1]
  ds_read_b64_tr_b16 v[90:91], v21 offset:64
  v_pk_mul_f16 v144, v88, v95 op_sel:[0,0] op_sel_hi:[0,1]
  v_pk_mul_f16 v145, v88, v95 op_sel:[1,0] op_sel_hi:[1,1]
  ds_read_b64_tr_b16 v[104:105], v21 offset:96
  v_pk_mul_f16 v146, v88, v96 op_sel:[0,0] op_sel_hi:[0,1]
  ds_read_b64_tr_b16 v[64:65], v22 offset:0
  v_pk_mul_f16 v147, v88, v96 op_sel:[1,0] op_sel_hi:[1,1]
  ds_read_b64_tr_b16 v[78:79], v22 offset:32
  v_pk_mul_f16 v156, v102, v109 op_sel:[0,0] op_sel_hi:[0,1]
  v_pk_mul_f16 v157, v102, v109 op_sel:[1,0] op_sel_hi:[1,1]
  ds_read_b64_tr_b16 v[92:93], v22 offset:64
  v_pk_mul_f16 v158, v102, v110 op_sel:[0,0] op_sel_hi:[0,1]
  ds_read_b64_tr_b16 v[106:107], v22 offset:96
  v_pk_mul_f16 v159, v102, v110 op_sel:[1,0] op_sel_hi:[1,1]
  s_branch L_novm
L_end:
  s_endpgm
.p2align 8
L_tables:
.long 0x0, 0x1800, 0x6c80, 0x81a0, 0x8, 0x1808, 0x6c88, 0x81a8
.long 0x10, 0x1810, 0x6c90, 0x81b0, 0x18, 0x1818, 0x6c98, 0x81b8
.long 0x40, 0x1d48, 0x71c8, 0x86e8, 0x48, 0x1d50, 0x71d0, 0x86f0
.long 0x50, 0x1d58, 0x71d8, 0x86f8, 0x58, 0x1d60, 0x71e0, 0x8700
.long 0x80, 0x2290, 0x7710, 0x8c30, 0x88, 0x2298, 0x7718, 0x8c38
.long 0x90, 0x22a0, 0x7720, 0x8c40, 0x98, 0x22a8, 0x7728, 0x8c48
.long 0xc0, 0x27d8, 0x7c58, 0x9178, 0xc8, 0x27e0, 0x7c60, 0x9180
.long 0xd0, 0x27e8, 0x7c68, 0x9188, 0xd8, 0x27f0, 0x7c70, 0x9190
.long 0x20, 0x1820, 0x6ca0, 0x81c0, 0x28, 0x1828, 0x6ca8, 0x81c8
.long 0x30, 0x1830, 0x6cb0, 0x81d0, 0x38, 0x1838, 0x6cb8, 0x81d8
.long 0x60, 0x1d68, 0x71e8, 0x8708, 0x68, 0x1d70, 0x71f0, 0x8710
.long 0x70, 0x1d78, 0x71f8, 0x8718, 0x78, 0x1d80, 0x7200, 0x8720
.long 0xa0, 0x22b0, 0x7730, 0x8c50, 0xa8, 0x22b8, 0x7738, 0x8c58
.long 0xb0, 0x22c0, 0x7740, 0x8c60, 0xb8, 0x22c8, 0x7748, 0x8c68
.long 0xe0, 0x27f8, 0x7c78, 0x9198, 0xe8, 0x2800, 0x7c80, 0x91a0
.long 0xf0, 0x2808, 0x7c88, 0x91a8, 0xf8, 0x2810, 0x7c90, 0x91b0
.long 0x200, 0x4240, 0x96c0, 0x9c08, 0x208, 0x4248, 0x96c8, 0x9c10
.long 0x210, 0x4250, 0x96d0, 0x9c18, 0x218, 0x4258, 0x96d8, 0x9c20
.long 0x240, 0x4788, 0x9c08, 0x9c08, 0x248, 0x4790, 0x9c10, 0x9c10
.long 0x250, 0x4798, 0x9c18, 0x9c18, 0x258, 0x47a0, 0x9c20, 0x9c20
.long 0x280, 0x4cd0, 0x9c08, 0x9c08, 0x288, 0x4cd8, 0x9c10, 0x9c10
.long 0x290, 0x4ce0, 0x9c18, 0x9c18, 0x298, 0x4ce8, 0x9c20, 0x9c20
.long 0x2c0, 0x5218, 0x9c08, 0x9c08, 0x2c8, 0x5220, 0x9c10, 0x9c10
.long 0x2d0, 0x5228, 0x9c18, 0x9c18, 0x2d8, 0x5230, 0x9c20, 0x9c20
.long 0x220, 0x4260, 0x96e0, 0x9c28, 0x228, 0x4268, 0x96e8, 0x9c30
.long 0x230, 0x4270, 0x96f0, 0x9c38, 0x238, 0x4278, 0x96f8, 0x9c40
.long 0x260, 0x47a8, 0x9c28, 0x9c28, 0x268, 0x47b0, 0x9c30, 0x9c30
.long 0x270, 0x47b8, 0x9c38, 0x9c38, 0x278, 0x47c0, 0x9c40, 0x9c40
.long 0x2a0, 0x4cf0, 0x9c28, 0x9c28, 0x2a8, 0x4cf8, 0x9c30, 0x9c30
.long 0x2b0, 0x4d00, 0x9c38, 0x9c38, 0x2b8, 0x4d08, 0x9c40, 0x9c40
.long 0x2e0, 0x5238, 0x9c28, 0x9c28, 0x2e8, 0x5240, 0x9c30, 0x9c30
.long 0x2f0, 0x5248, 0x9c38, 0x9c38, 0x2f8, 0x5250, 0x9c40, 0x9c40
.long 0xaae0, 0xa680, 0xa900, 0xaae0, 0xaae8, 0xa688, 0xa908, 0xaae8
.long 0xaaf0, 0xa690, 0xa910, 0xaaf0, 0xaaf8, 0xa698, 0xa918, 0xaaf8
.long 0xaa40, 0xa860, 0xa9a0, 0xaa40, 0xaa48, 0xa868, 0xa9a8, 0xaa48
.long 0xaa50, 0xa870, 0xa9b0, 0xaa50, 0xaa58, 0xa878, 0xa9b8, 0xaa58
.long 0xa400, 0xa7c0, 0xa540, 0xa400, 0xa408, 0xa7c8, 0xa548, 0xa408
.long 0xa410, 0xa7d0, 0xa550, 0xa410, 0xa418, 0xa7d8, 0xa558, 0xa418
.long 0xa4a0, 0xa720, 0xa5e0, 0xa4a0, 0xa4a8, 0xa728, 0xa5e8, 0xa4a8
.long 0xa4b0, 0xa730, 0xa5f0, 0xa4b0, 0xa4b8, 0xa738, 0xa5f8, 0xa4b8
.long 0xb260, 0xb4e0, 0xb6c0, 0xb260, 0xb268, 0xb4e8, 0xb6c8, 0xb268
.long 0xb270, 0xb4f0, 0xb6d0, 0xb270, 0xb278, 0xb4f8, 0xb6d8, 0xb278
.long 0xb1c0, 0xb300, 0xb760, 0xb1c0, 0xb1c8, 0xb308, 0xb768, 0xb1c8
.long 0xb1d0, 0xb310, 0xb770, 0xb1d0, 0xb1d8, 0xb318, 0xb778, 0xb1d8
.long 0xb580, 0xb440, 0xb080, 0xb580, 0xb588, 0xb448, 0xb088, 0xb588
.long 0xb590, 0xb450, 0xb090, 0xb590, 0xb598, 0xb458, 0xb098, 0xb598
.long 0xb620, 0xb3a0, 0xb120, 0xb620, 0xb628, 0xb3a8, 0xb128, 0xb628
.long 0xb630, 0xb3b0, 0xb130, 0xb630, 0xb638, 0xb3b8, 0xb138, 0xb638
.long 0xa900, 0xa400, 0xaae0, 0xb620, 0xa908, 0xa408, 0xaae8, 0xb628
.long 0xa910, 0xa410, 0xaaf0, 0xb630, 0xa918, 0xa418, 0xaaf8, 0xb638
.long 0xa9a0, 0xa4a0, 0xab80, 0xb800, 0xa9a8, 0xa4a8, 0xab88, 0xb808
.long 0xa9b0, 0xa4b0, 0xab90, 0xb810, 0xa9b8, 0xa4b8, 0xab98, 0xb818
.long 0xaa40, 0xa680, 0xa860, 0xb3a0, 0xaa48, 0xa688, 0xa868, 0xb3a8
.long 0xaa50, 0xa690, 0xa870, 0xb3b0, 0xaa58, 0xa698, 0xa878, 0xb3b8
.long 0xa720, 0xa540, 0xa7c0, 0xb1c0, 0xa728, 0xa548, 0xa7c8, 0xb1c8
.long 0xa730, 0xa550, 0xa7d0, 0xb1d0, 0xa738, 0xa558, 0xa7d8, 0xb1d8
.long 0xa5e0, 0xaae0, 0xa400, 0xb080, 0xa5e8, 0xaae8, 0xa408, 0xb088
.long 0xa5f0, 0xaaf0, 0xa410, 0xb090, 0xa5f8, 0xaaf8, 0xa418, 0xb098
.long 0xa7c0, 0xa540, 0xa720, 0xb760, 0xa7c8, 0xa548, 0xa728, 0xb768
.long 0xa7d0, 0xa550, 0xa730, 0xb770, 0xa7d8, 0xa558, 0xa738, 0xb778
.long 0xa860, 0xa680, 0xaa40, 0xb440, 0xa868, 0xa688, 0xaa48, 0xb448
.long 0xa870, 0xa690, 0xaa50, 0xb450, 0xa878, 0xa698, 0xaa58, 0xb458
.long 0xab80, 0xa4a0, 0xa9a0, 0xb4e0, 0xab88, 0xa4a8, 0xa9a8, 0xb4e8
.long 0xab90, 0xa4b0, 0xa9b0, 0xb4f0, 0xab98, 0xa4b8, 0xa9b8, 0xb4f8
.long 0xa680, 0xa900, 0xab80, 0xa4a0, 0xa688, 0xa908, 0xab88, 0xa4a8
.long 0xa690, 0xa910, 0xab90, 0xa4b0, 0xa698, 0xa918, 0xab98, 0xa4b8
.long 0xa860, 0xa9a0, 0xb1c0, 0xb440, 0xa868, 0xa9a8, 0xb1c8, 0xb448
.long 0xa870, 0xa9b0, 0xb1d0, 0xb450, 0xa878, 0xa9b8, 0xb1d8, 0xb458
.long 0xa7c0, 0xa540, 0xab80, 0xa4a0, 0xa7c8, 0xa548, 0xab88, 0xa4a8
.long 0xa7d0, 0xa550, 0xab90, 0xa4b0, 0xa7d8, 0xa558, 0xab98, 0xa4b8
.long 0xa720, 0xa5e0, 0xb1c0, 0xb440, 0xa728, 0xa5e8, 0xb1c8, 0xb448
.long 0xa730, 0xa5f0, 0xb1d0, 0xb450, 0xa738, 0xa5f8, 0xb1d8, 0xb458
.long 0xb4e0, 0xb6c0, 0xb800, 0xa860, 0xb4e8, 0xb6c8, 0xb808, 0xa868
.long 0xb4f0, 0xb6d0, 0xb810, 0xa870, 0xb4f8, 0xb6d8, 0xb818, 0xa878
.long 0xb300, 0xb760, 0xa540, 0xa900, 0xb308, 0xb768, 0xa548, 0xa908
.long 0xb310, 0xb770, 0xa550, 0xa910, 0xb318, 0xb778, 0xa558, 0xa918
.long 0xb440, 0xb080, 0xb800, 0xa860, 0xb448, 0xb088, 0xb808, 0xa868
.long 0xb450, 0xb090, 0xb810, 0xa870, 0xb458, 0xb098, 0xb818, 0xa878
.long 0xb3a0, 0xb120, 0xa540, 0xa900, 0xb3a8, 0xb128, 0xa548, 0xa908
.long 0xb3b0, 0xb130, 0xa550, 0xa910, 0xb3b8, 0xb138, 0xa558, 0xa918
.long 0xb120, 0xb580, 0xb080, 0xb300, 0xb128, 0xb588, 0xb088, 0xb308
.long 0xb130, 0xb590, 0xb090, 0xb310, 0xb138, 0xb598, 0xb098, 0xb318
.long 0xb6c0, 0xb4e0, 0xaa40, 0xb6c0, 0xb6c8, 0xb4e8, 0xaa48, 0xb6c8
.long 0xb6d0, 0xb4f0, 0xaa50, 0xb6d0, 0xb6d8, 0xb4f8, 0xaa58, 0xb6d8
.long 0xb300, 0xb440, 0xb080, 0xb300, 0xb308, 0xb448, 0xb088, 0xb308
.long 0xb310, 0xb450, 0xb090, 0xb310, 0xb318, 0xb458, 0xb098, 0xb318
.long 0xb260, 0xb760, 0xaa40, 0xb6c0, 0xb268, 0xb768, 0xaa48, 0xb6c8
.long 0xb270, 0xb770, 0xaa50, 0xb6d0, 0xb278, 0xb778, 0xaa58, 0xb6d8
.long 0xb580, 0xb120, 0xb620, 0xa680, 0xb588, 0xb128, 0xb628, 0xa688
.long 0xb590, 0xb130, 0xb630, 0xa690, 0xb598, 0xb138, 0xb638, 0xa698
.long 0xb260, 0xb1c0, 0xa7c0, 0xa680, 0xb268, 0xb1c8, 0xa7c8, 0xa688
.long 0xb270, 0xb1d0, 0xa7d0, 0xa690, 0xb278, 0xb1d8, 0xa7d8, 0xa698
.long 0xb300, 0xb3a0, 0xb620, 0xb300, 0xb308, 0xb3a8, 0xb628, 0xb308
.long 0xb310, 0xb3b0, 0xb630, 0xb310, 0xb318, 0xb3b8, 0xb638, 0xb318
.long 0xb6c0, 0xb800, 0xa7c0, 0xb300, 0xb6c8, 0xb808, 0xa7c8, 0xb308
.long 0xb6d0, 0xb810, 0xa7d0, 0xb310, 0xb6d8, 0xb818, 0xa7d8, 0xb318
.long 0x0, 0x200, 0x0, 0x3f803f80, 0x8, 0x208, 0x0, 0x3f803f80
.long 0x10, 0x210, 0x0, 0x3f803f80, 0x18, 0x218, 0x0, 0x3f803f80
.long 0x420, 0x620, 0x0, 0x3f803f80, 0x428, 0x628, 0x0, 0x3f803f80
.long 0x430, 0x630, 0x0, 0x3f803f80, 0x438, 0x638, 0x0, 0x3f803f80
.long 0x840, 0xa40, 0x10, 0x3f803f80, 0x848, 0xa48, 0x10, 0x3f803f80
.long 0x850, 0xa50, 0x10, 0x3f803f80, 0x858, 0xa58, 0x10, 0x3f803f80
.long 0xc60, 0xe60, 0x10, 0x3f803f80, 0xc68, 0xe68, 0x10, 0x3f803f80
.long 0xc70, 0xe70, 0x10, 0x3f803f80, 0xc78, 0xe78, 0x10, 0x3f803f80
.long 0x80, 0x280, 0x20, 0x3f803f80, 0x88, 0x288, 0x20, 0x3f803f80
.long 0x90, 0x290, 0x20, 0x3f803f80, 0x98, 0x298, 0x20, 0x3f803f80
.long 0x4a0, 0x6a0, 0x20, 0x3f803f80, 0x4a8, 0x6a8, 0x20, 0x3f803f80
.long 0x4b0, 0x6b0, 0x20, 0x3f803f80, 0x4b8, 0x6b8, 0x20, 0x3f803f80
.long 0x8c0, 0xac0, 0x30, 0x3f803f80, 0x8c8, 0xac8, 0x30, 0x3f803f80
.long 0x8d0, 0xad0, 0x30, 0x3f803f80, 0x8d8, 0xad8, 0x30, 0x3f803f80
.long 0xce0, 0xee0, 0x30, 0x3f803f80, 0xce8, 0xee8, 0x30, 0x3f803f80
.long 0xcf0, 0xef0, 0x30, 0x3f803f80, 0xcf8, 0xef8, 0x30, 0x3f803f80
.long 0x100, 0x300, 0x40, 0x0, 0x108, 0x308, 0x40, 0x0
.long 0x110, 0x310, 0x40, 0x0, 0x118, 0x318, 0x40, 0x0
.long 0x520, 0x720, 0x40, 0x0, 0x528, 0x728, 0x40, 0x0
.long 0x530, 0x730, 0x40, 0x0, 0x538, 0x738, 0x40, 0x0
.long 0x940, 0xb40, 0x50, 0x0, 0x948, 0xb48, 0x50, 0x0
.long 0x950, 0xb50, 0x50, 0x0, 0x958, 0xb58, 0x50, 0x0
.long 0xd60, 0xf60, 0x50, 0x0, 0xd68, 0xf68, 0x50, 0x0
.long 0xd70, 0xf70, 0x50, 0x0, 0xd78, 0xf78, 0x50, 0x0
.long 0x180, 0xf60, 0x60, 0x0, 0x188, 0xf68, 0x60, 0x0
.long 0x190, 0xf70, 0x60, 0x0, 0x198, 0xf78, 0x60, 0x0
.long 0x5a0, 0xf60, 0x60, 0x0, 0x5a8, 0xf68, 0x60, 0x0
.long 0x5b0, 0xf70, 0x60, 0x0, 0x5b8, 0xf78, 0x60, 0x0
.long 0x9c0, 0xf60, 0x70, 0x0, 0x9c8, 0xf68, 0x70, 0x0
.long 0x9d0, 0xf70, 0x70, 0x0, 0x9d8, 0xf78, 0x70, 0x0
.long 0xde0, 0xf60, 0x70, 0x0, 0xde8, 0xf68, 0x70, 0x0
.long 0xdf0, 0xf70, 0x70, 0x0, 0xdf8, 0xf78, 0x70, 0x0
.long 0xffff, 0x0, 0x0, 0x0, 0x0, 0x0, 0xffff, 0x0
.long 0x0, 0x0, 0x0, 0x0, 0x0, 0x0, 0x0, 0x0
.long 0x0, 0x0, 0x0, 0x0, 0x0, 0x0, 0x0, 0x0
.long 0x0, 0x0, 0x0, 0x0, 0x0, 0x0, 0x0, 0x0
.long 0xffff0000, 0x0, 0x0, 0x0, 0x0, 0x0, 0xffff0000, 0x0
.long 0x0, 0x0, 0x0, 0x0, 0x0, 0x0, 0x0, 0x0
.long 0x0, 0x0, 0x0, 0x0, 0x0, 0x0, 0x0, 0x0
.long 0x0, 0x0, 0x0, 0x0, 0x0, 0x0, 0x0, 0x0
.long 0x0, 0xffff, 0x0, 0x0, 0x0, 0x0, 0x0, 0xffff
.long 0x0, 0x0, 0x0, 0x0, 0x0, 0x0, 0x0, 0x0
.long 0x0, 0x0, 0x0, 0x0, 0x0, 0x0, 0x0, 0x0
.long 0x0, 0x0, 0x0, 0x0, 0x0, 0x0, 0x0, 0x0
.long 0x0, 0xffff0000, 0x0, 0x0, 0x0, 0x0, 0x0, 0xffff0000
.long 0x0, 0x0, 0x0, 0x0, 0x0, 0x0, 0x0, 0x0
.long 0x0, 0x0, 0x0, 0x0, 0x0, 0x0, 0x0, 0x0
.long 0x0, 0x0, 0x0, 0x0, 0x0, 0x0, 0x0, 0x0
.long 0x0, 0x0, 0x0, 0x0, 0x0, 0x0, 0x0, 0x0
.long 0xffff, 0x0, 0x0, 0x0, 0x0, 0x0, 0xffff, 0x0
.long 0x0, 0x0, 0x0, 0x0, 0x0, 0x0, 0x0, 0x0
.long 0x0, 0x0, 0x0, 0x0, 0x0, 0x0, 0x0, 0x0
.long 0x0, 0x0, 0x0, 0x0, 0x0, 0x0, 0x0, 0x0
.long 0xffff0000, 0x0, 0x0, 0x0, 0x0, 0x0, 0xffff0000, 0x0
.long 0x0, 0x0, 0x0, 0x0, 0x0, 0x0, 0x0, 0x0
.long 0x0, 0x0, 0x0, 0x0, 0x0, 0x0, 0x0, 0x0
.long 0x0, 0x0, 0x0, 0x0, 0x0, 0x0, 0x0, 0x0
.long 0x0, 0xffff, 0x0, 0x0, 0x0, 0x0, 0x0, 0xffff
.long 0x0, 0x0, 0x0, 0x0, 0x0, 0x0, 0x0, 0x0
.long 0x0, 0x0, 0x0, 0x0, 0x0, 0x0, 0x0, 0x0
.long 0x0, 0x0, 0x0, 0x0, 0x0, 0x0, 0x0, 0x0
.long 0x0, 0xffff0000, 0x0, 0x0, 0x0, 0x0, 0x0, 0xffff0000
.long 0x0, 0x0, 0x0, 0x0, 0x0, 0x0, 0x0, 0x0
.long 0x0, 0x0, 0x0, 0x0, 0x0, 0x0, 0x0, 0x0
.long 0x0, 0x0, 0x0, 0x0, 0x0, 0x0, 0x0, 0x0
.long 0x0, 0x0, 0x0, 0x0, 0x0, 0x0, 0x0, 0x0
.long 0x0, 0x0, 0xffff, 0x0, 0x0, 0x0, 0x0, 0x0
.long 0x0, 0x0, 0x0, 0x0, 0xffff, 0x0, 0x0, 0x0
.long 0x0, 0x0, 0x0, 0x0, 0x0, 0x0, 0x0, 0x0
.long 0x0, 0x0, 0x0, 0x0, 0x0, 0x0, 0x0, 0x0
.long 0x0, 0x0, 0xffff0000, 0x0, 0x0, 0x0, 0x0, 0x0
.long 0x0, 0x0, 0x0, 0x0, 0xffff0000, 0x0, 0x0, 0x0
.long 0x0, 0x0, 0x0, 0x0, 0x0, 0x0, 0x0, 0x0
.long 0x0, 0x0, 0x0, 0x0, 0x0, 0x0, 0x0, 0x0
.long 0x0, 0x0, 0x0, 0xffff, 0x0, 0x0, 0x0, 0x0
.long 0x0, 0x0, 0x0, 0x0, 0x0, 0xffff, 0x0, 0x0
.long 0x0, 0x0, 0x0, 0x0, 0x0, 0x0, 0x0, 0x0
.long 0x0, 0x0, 0x0, 0x0, 0x0, 0x0, 0x0, 0x0
.long 0x0, 0x0, 0x0, 0xffff0000, 0x0, 0x0, 0x0, 0x0
.long 0x0, 0x0, 0x0, 0x0, 0x0, 0xffff0000, 0x0, 0x0
.long 0x0, 0x0, 0x0, 0x0, 0x0, 0x0, 0x0, 0x0
.long 0x0, 0x0, 0x0, 0x0, 0x0, 0x0, 0x0, 0x0
.long 0x0, 0x0, 0x0, 0x0, 0xffff, 0x0, 0x0, 0x0
.long 0x0, 0x0, 0x0, 0x0, 0x0, 0x0, 0x0, 0x0
.long 0x0, 0x0, 0x0, 0x0, 0x0, 0x0, 0x0, 0x0
.long 0x0, 0x0, 0x0, 0x0, 0x0, 0x0, 0x0, 0x0
.long 0x0, 0x0, 0x0, 0x0, 0xffff0000, 0x0, 0x0, 0x0
.long 0x0, 0x0, 0x0, 0x0, 0x0, 0x0, 0x0, 0x0
.long 0x0, 0x0, 0x0, 0x0, 0x0, 0x0, 0x0, 0x0
.long 0x0, 0x0, 0x0, 0x0, 0x0, 0x0, 0x0, 0x0
.long 0x0, 0x0, 0x0, 0x0, 0x0, 0x0, 0x0, 0x0
.long 0x0, 0x0, 0x0, 0x0, 0x0, 0x0, 0x0, 0x0
.long 0x0, 0x0, 0x0, 0x0, 0x0, 0x0, 0x0, 0x0
.long 0x0, 0x0, 0x0, 0x0, 0x0, 0x0, 0x0, 0x0
.long 0x0, 0x0, 0x0, 0x0, 0x0, 0x0, 0x0, 0x0
.long 0x0, 0x0, 0x0, 0x0, 0x0, 0x0, 0x0, 0x0
.long 0x14d40, 0x14d40, 0x0, 0x0, 0x14e10, 0x14e10, 0x20, 0x20
.long 0x14ee0, 0x14ee0, 0x100000, 0x100000, 0x14fb0, 0x14fb0, 0x100020, 0x100020
.long 0x15080, 0x15080, 0x40, 0x40, 0x15150, 0x15150, 0x60, 0x60
.long 0x15220, 0x15220, 0x100040, 0x100040, 0x100000, 0x100000, 0x100060, 0x100060
.long 0x14d74, 0x14d74, 0x80, 0x80, 0x14e44, 0x14e44, 0xa0, 0xa0
.long 0x14f14, 0x14f14, 0x100080, 0x100080, 0x14fe4, 0x14fe4, 0x1000a0, 0x1000a0
.long 0x150b4, 0x150b4, 0xc0, 0xc0, 0x15184, 0x15184, 0xe0, 0xe0
.long 0x15254, 0x15254, 0x1000c0, 0x1000c0, 0x100000, 0x100000, 0x1000e0, 0x1000e0
.long 0x14da8, 0x14da8, 0x8, 0x100, 0x14e78, 0x14e78, 0x28, 0x120
.long 0x14f48, 0x14f48, 0x100008, 0x100100, 0x15018, 0x15018, 0x100028, 0x100120
.long 0x150e8, 0x150e8, 0x48, 0x140, 0x151b8, 0x151b8, 0x68, 0x160
.long 0x100000, 0x100000, 0x100048, 0x100140, 0x100000, 0x100000, 0x100068, 0x100160
.long 0x14ddc, 0x14ddc, 0x88, 0x180, 0x14eac, 0x14eac, 0xa8, 0x1a0
.long 0x14f7c, 0x14f7c, 0x100088, 0x100180, 0x1504c, 0x1504c, 0x1000a8, 0x1001a0
.long 0x1511c, 0x1511c, 0xc8, 0x1c0, 0x151ec, 0x151ec, 0xe8, 0x1e0
.long 0x100000, 0x100000, 0x1000c8, 0x1001c0, 0x100000, 0x100000, 0x1000e8, 0x1001e0
.long 0x17d40, 0x114d40, 0x100, 0x200, 0x17e10, 0x114e10, 0x120, 0x220
.long 0x17ee0, 0x114ee0, 0x100100, 0x100200, 0x17fb0, 0x114fb0, 0x100120, 0x100220
.long 0x18080, 0x115080, 0x140, 0x240, 0x18150, 0x115150, 0x160, 0x260
.long 0x18220, 0x115220, 0x100140, 0x100240, 0x103000, 0x200000, 0x100160, 0x100260
.long 0x17d74, 0x114d74, 0x180, 0x280, 0x17e44, 0x114e44, 0x1a0, 0x2a0
.long 0x17f14, 0x114f14, 0x100180, 0x100280, 0x17fe4, 0x114fe4, 0x1001a0, 0x1002a0
.long 0x180b4, 0x1150b4, 0x1c0, 0x2c0, 0x18184, 0x115184, 0x1e0, 0x2e0
.long 0x18254, 0x115254, 0x1001c0, 0x1002c0, 0x103000, 0x200000, 0x1001e0, 0x1002e0
.long 0x17da8, 0x114da8, 0x108, 0x300, 0x17e78, 0x114e78, 0x128, 0x320
.long 0x17f48, 0x114f48, 0x100108, 0x100300, 0x18018, 0x115018, 0x100128, 0x100320
.long 0x180e8, 0x1150e8, 0x148, 0x340, 0x181b8, 0x1151b8, 0x168, 0x360
.long 0x103000, 0x200000, 0x100148, 0x100340, 0x103000, 0x200000, 0x100168, 0x100360
.long 0x17ddc, 0x114ddc, 0x188, 0x380, 0x17eac, 0x114eac, 0x1a8, 0x3a0
.long 0x17f7c, 0x114f7c, 0x100188, 0x100380, 0x1804c, 0x11504c, 0x1001a8, 0x1003a0
.long 0x1811c, 0x11511c, 0x1c8, 0x3c0, 0x181ec, 0x1151ec, 0x1e8, 0x3e0
.long 0x103000, 0x200000, 0x1001c8, 0x1003c0, 0x103000, 0x200000, 0x1001e8, 0x1003e0
.long 0xa400, 0xd00, 0x0, 0x14d40, 0xa440, 0xd00, 0x0, 0x14d80
.long 0xa480, 0xd00, 0x1, 0x14dd0, 0xa4c0, 0xd00, 0x1, 0x14e10
.long 0xa500, 0xd00, 0x2, 0x14e60, 0xa540, 0xd00, 0x2, 0x14ea0
.long 0xa580, 0xd00, 0x3, 0x14ef0, 0xa5c0, 0xd00, 0x3, 0x14f30
.long 0xa600, 0xd00, 0x4, 0x14f40, 0xa640, 0xd00, 0x4, 0x14f80
.long 0xa680, 0xd00, 0x5, 0x14fd0, 0xa6c0, 0xd00, 0x5, 0x15010
.long 0xa700, 0xd00, 0x6, 0x15060, 0xa740, 0xd00, 0x6, 0x150a0
.long 0xa780, 0xd00, 0x7, 0x150f0, 0xa7c0, 0xd00, 0x7, 0x15130
.long 0xa800, 0xd00, 0x8, 0x15140, 0xa840, 0xd00, 0x8, 0x15180
.long 0xa880, 0xd00, 0x9, 0x151d0, 0xa8c0, 0xd00, 0x9, 0x15210
.long 0xa900, 0xd00, 0xa, 0x15260, 0xa940, 0xd00, 0xa, 0x152a0
.long 0xa980, 0xd00, 0xb, 0x152f0, 0xa9c0, 0xd00, 0xb, 0x15330
.long 0xaa00, 0xd00, 0xc, 0x15340, 0xaa40, 0xd00, 0xc, 0x15380
.long 0x1f680, 0x40, 0xd, 0x153d0, 0x100000, 0xd00, 0xd, 0x15410
.long 0x100000, 0xd00, 0xe, 0x15460, 0x100000, 0xd00, 0xe, 0x154a0
.long 0x100000, 0xd00, 0xf, 0x154f0, 0x100000, 0xd00, 0xf, 0x15530
.long 0xa400, 0xd00, 0x2, 0x14d60, 0xa440, 0xd00, 0x2, 0x14da0
.long 0xa480, 0xd00, 0x3, 0x14df0, 0xa4c0, 0xd00, 0x3, 0x14e30
.long 0xa500, 0xd00, 0x4, 0x14e40, 0xa540, 0xd00, 0x4, 0x14e80
.long 0xa580, 0xd00, 0x5, 0x14ed0, 0xa5c0, 0xd00, 0x5, 0x14f10
.long 0xa600, 0xd00, 0x6, 0x14f60, 0xa640, 0xd00, 0x6, 0x14fa0
.long 0xa680, 0xd00, 0x7, 0x14ff0, 0xa6c0, 0xd00, 0x7, 0x15030
.long 0xa700, 0xd00, 0x8, 0x15040, 0xa740, 0xd00, 0x8, 0x15080
.long 0xa780, 0xd00, 0x9, 0x150d0, 0xa7c0, 0xd00, 0x9, 0x15110
.long 0xa800, 0xd00, 0xa, 0x15160, 0xa840, 0xd00, 0xa, 0x151a0
.long 0xa880, 0xd00, 0xb, 0x151f0, 0xa8c0, 0xd00, 0xb, 0x15230
.long 0xa900, 0xd00, 0xc, 0x15240, 0xa940, 0xd00, 0xc, 0x15280
.long 0xa980, 0xd00, 0xd, 0x152d0, 0xa9c0, 0xd00, 0xd, 0x15310
.long 0xaa00, 0xd00, 0xe, 0x15360, 0xaa40, 0xd00, 0xe, 0x153a0
.long 0x1f680, 0x40, 0xf, 0x153f0, 0x100000, 0xd00, 0xf, 0x15430
.long 0x100000, 0xd00, 0x10, 0x15440, 0x100000, 0xd00, 0x10, 0x15480
.long 0x100000, 0xd00, 0x11, 0x154d0, 0x100000, 0xd00, 0x11, 0x15510
.long 0x1f690, 0x1f890, 0x1f9c0, 0x1f9e0, 0x1f698, 0x1f898, 0x1f9c8, 0x1f9e8
.long 0x1f680, 0x1f880, 0x1f9d0, 0x1f9f0, 0x1f688, 0x1f888, 0x1f9d8, 0x100000
.long 0x1fd20, 0x1ff20, 0x1f9c2, 0x1f9e2, 0x1fd28, 0x1ff28, 0x1f9ca, 0x1f9ea
.long 0x1fd30, 0x1ff30, 0x1f9d2, 0x1f9f2, 0x1fd38, 0x1ff38, 0x1f9da, 0x100000
.long 0x1f6f0, 0x1f8f0, 0x1f9c4, 0x1f9e4, 0x1f6f8, 0x1f8f8, 0x1f9cc, 0x1f9ec
.long 0x1f6e0, 0x1f8e0, 0x1f9d4, 0x100000, 0x1f6e8, 0x1f8e8, 0x1f9dc, 0x100000
.long 0x1fd40, 0x1ff40, 0x1f9c6, 0x1f9e6, 0x1fd48, 0x1ff48, 0x1f9ce, 0x1f9ee
.long 0x1fd50, 0x1ff50, 0x1f9d6, 0x100000, 0x1fd58, 0x1ff58, 0x1f9de, 0x100000
.long 0x1f710, 0x1f910, 0x1f9c0, 0x1f9e0, 0x1f718, 0x1f918, 0x1f9c8, 0x1f9e8
.long 0x1f700, 0x1f900, 0x1f9d0, 0x1f9f0, 0x1f708, 0x1f908, 0x1f9d8, 0x100000
.long 0x1fda0, 0x1ffa0, 0x1f9c2, 0x1f9e2, 0x1fda8, 0x1ffa8, 0x1f9ca, 0x1f9ea
.long 0x1fdb0, 0x1ffb0, 0x1f9d2, 0x1f9f2, 0x1fdb8, 0x1ffb8, 0x1f9da, 0x100000
.long 0x1f770, 0x1f970, 0x1f9c4, 0x1f9e4, 0x1f778, 0x1f978, 0x1f9cc, 0x1f9ec
.long 0x1f760, 0x1f960, 0x1f9d4, 0x100000, 0x1f768, 0x1f968, 0x1f9dc, 0x100000
.long 0x1fdc0, 0x1ffc0, 0x1f9c6, 0x1f9e6, 0x1fdc8, 0x1ffc8, 0x1f9ce, 0x1f9ee
.long 0x1fdd0, 0x1ffd0, 0x1f9d6, 0x100000, 0x1fdd8, 0x1ffd8, 0x1f9de, 0x100000
.long 0x1f790, 0x1f990, 0x1f9c0, 0x1f9e0, 0x1f798, 0x1f998, 0x1f9c8, 0x1f9e8
.long 0x1f780, 0x1f980, 0x1f9d0, 0x1f9f0, 0x1f788, 0x1f988, 0x1f9d8, 0x100000
.long 0x1fe20, 0x20020, 0x1f9c2, 0x1f9e2, 0x1fe28, 0x20028, 0x1f9ca, 0x1f9ea
.long 0x1fe30, 0x20030, 0x1f9d2, 0x1f9f2, 0x1fe38, 0x20038, 0x1f9da, 0x100000
.long 0x1f7f0, 0x14d00, 0x1f9c4, 0x1f9e4, 0x1f7f8, 0x14d08, 0x1f9cc, 0x1f9ec
.long 0x1f7e0, 0x14d10, 0x1f9d4, 0x100000, 0x1f7e8, 0x14d18, 0x1f9dc, 0x100000
.long 0x1fe40, 0x14d00, 0x1f9c6, 0x1f9e6, 0x1fe48, 0x14d08, 0x1f9ce, 0x1f9ee
.long 0x1fe50, 0x14d10, 0x1f9d6, 0x100000, 0x1fe58, 0x14d18, 0x1f9de, 0x100000
.long 0x1f810, 0x14d00, 0x1f9c0, 0x1f9e0, 0x1f818, 0x14d08, 0x1f9c8, 0x1f9e8
.long 0x1f800, 0x14d10, 0x1f9d0, 0x1f9f0, 0x1f808, 0x14d18, 0x1f9d8, 0x100000
.long 0x1fea0, 0x14d00, 0x1f9c2, 0x1f9e2, 0x1fea8, 0x14d08, 0x1f9ca, 0x1f9ea
.long 0x1feb0, 0x14d10, 0x1f9d2, 0x1f9f2, 0x1feb8, 0x14d18, 0x1f9da, 0x100000
.long 0x1f870, 0x14d00, 0x1f9c4, 0x1f9e4, 0x1f878, 0x14d08, 0x1f9cc, 0x1f9ec
.long 0x1f860, 0x14d10, 0x1f9d4, 0x100000, 0x1f868, 0x14d18, 0x1f9dc, 0x100000
.long 0x1fec0, 0x14d00, 0x1f9c6, 0x1f9e6, 0x1fec8, 0x14d08, 0x1f9ce, 0x1f9ee
.long 0x1fed0, 0x14d10, 0x1f9d6, 0x100000, 0x1fed8, 0x14d18, 0x1f9de, 0x100000
.long 0x0, 0x4444, 0x0, 0xa400, 0x10, 0xeeee, 0x4, 0xa404
.long 0x20, 0x4444, 0x8, 0xa408, 0x30, 0xeeee, 0xc, 0xa40c
.long 0x40, 0x4444, 0x10, 0xa410, 0x50, 0xeeee, 0x14, 0xa414
.long 0x60, 0x4444, 0x18, 0xa418, 0x70, 0xeeee, 0x1c, 0xa41c
.long 0x0, 0x4444, 0x20, 0xa420, 0x10, 0xeeee, 0x24, 0xa424
.long 0x20, 0x4444, 0x28, 0xa428, 0x30, 0xeeee, 0x2c, 0xa42c
.long 0x40, 0x4444, 0x30, 0xa430, 0x50, 0xeeee, 0x34, 0xa434
.long 0x60, 0x4444, 0x38, 0xa438, 0x70, 0xeeee, 0x3c, 0xa43c
.long 0x0, 0x4444, 0x40, 0xa440, 0x10, 0xeeee, 0x44, 0xa444
.long 0x20, 0x4444, 0x48, 0xa448, 0x30, 0xeeee, 0x4c, 0xa44c
.long 0x40, 0x4444, 0x50, 0xa450, 0x50, 0xeeee, 0x54, 0xa454
.long 0x60, 0x4444, 0x58, 0xa458, 0x70, 0xeeee, 0x5c, 0xa45c
.long 0x0, 0x4444, 0x60, 0xa460, 0x10, 0xeeee, 0x64, 0xa464
.long 0x20, 0x4444, 0x68, 0xa468, 0x30, 0xeeee, 0x6c, 0xa46c
.long 0x40, 0x4444, 0x70, 0xa470, 0x50, 0xeeee, 0x74, 0xa474
.long 0x60, 0x4444, 0x78, 0xa478, 0x70, 0xeeee, 0x7c, 0xa47c
.long 0x0, 0x4444, 0x420, 0xb080, 0x10, 0xeeee, 0x424, 0xb084
.long 0x20, 0x4444, 0x428, 0xb088, 0x30, 0xeeee, 0x42c, 0xb08c
.long 0x40, 0x4444, 0x430, 0xb090, 0x50, 0xeeee, 0x434, 0xb094
.long 0x60, 0x4444, 0x438, 0xb098, 0x70, 0xeeee, 0x43c, 0xb09c
.long 0x0, 0x4444, 0x440, 0xb0a0, 0x10, 0xeeee, 0x444, 0xb0a4
.long 0x20, 0x4444, 0x448, 0xb0a8, 0x30, 0xeeee, 0x44c, 0xb0ac
.long 0x40, 0x4444, 0x450, 0xb0b0, 0x50, 0xeeee, 0x454, 0xb0b4
.long 0x60, 0x4444, 0x458, 0xb0b8, 0x70, 0xeeee, 0x45c, 0xb0bc
.long 0x0, 0x4444, 0x460, 0xb0c0, 0x10, 0xeeee, 0x464, 0xb0c4
.long 0x20, 0x4444, 0x468, 0xb0c8, 0x30, 0xeeee, 0x46c, 0xb0cc
.long 0x40, 0x4444, 0x470, 0xb0d0, 0x50, 0xeeee, 0x474, 0xb0d4
.long 0x60, 0x4444, 0x478, 0xb0d8, 0x70, 0xeeee, 0x47c, 0xb0dc
.long 0x0, 0x4444, 0x480, 0xb0e0, 0x10, 0xeeee, 0x484, 0xb0e4
.long 0x20, 0x4444, 0x488, 0xb0e8, 0x30, 0xeeee, 0x48c, 0xb0ec
.long 0x40, 0x4444, 0x490, 0xb0f0, 0x50, 0xeeee, 0x494, 0xb0f4
.long 0x60, 0x4444, 0x498, 0xb0f8, 0x70, 0xeeee, 0x49c, 0xb0fc
.long 0x1fa28, 0x1f9f4, 0x34, 0x14d00, 0x1fa28, 0x1f9f6, 0x74, 0x14d04
.long 0x1fa28, 0x1f9f8, 0xb4, 0x14d08, 0x1fa28, 0x1f9fa, 0xf4, 0x14d0c
.long 0x1fa28, 0x1f9fc, 0x134, 0x14d10, 0x1fa28, 0x1f9fe, 0x174, 0x14d14
.long 0x1fa28, 0x1fa00, 0x1b4, 0x14d18, 0x1fa28, 0x1fa02, 0x1f4, 0x14d1c
.long 0x1fa28, 0x1fa04, 0x234, 0x14d20, 0x1fa28, 0x1fa06, 0x274, 0x14d24
.long 0x1fa28, 0x1fa08, 0x2b4, 0x14d28, 0x1fa28, 0x1fa0a, 0x2f4, 0x14d2c
.long 0x1fa28, 0x1fa0c, 0x334, 0x14d30, 0x1fa28, 0x1fa0e, 0x374, 0x14d34
.long 0x1fa28, 0x1fa10, 0x3b4, 0x14d38, 0x1fa28, 0x1fa12, 0x3f4, 0x14d3c
.long 0x1fa28, 0x1fa14, 0x434, 0x14d00, 0x1fa28, 0x1fa16, 0x474, 0x14d04
.long 0x1fa28, 0x1fa18, 0x4b4, 0x14d08, 0x1fa28, 0x1fa1a, 0x4f4, 0x14d0c
.long 0x1fa28, 0x1fa1c, 0x534, 0x14d10, 0x1fa28, 0x1fa1e, 0x574, 0x14d14
.long 0x1fa28, 0x1fa20, 0x5b4, 0x14d18, 0x1fa28, 0x1fa22, 0x5f4, 0x14d1c
.long 0x1fa28, 0x1fa24, 0x634, 0x14d20, 0x1fa28, 0x1fa26, 0x674, 0x14d24
.long 0x1fa28, 0x1fa28, 0x6b4, 0x14d28, 0x1fa28, 0x1fa2a, 0x6f4, 0x14d2c
.long 0x1fa28, 0x1fa2c, 0x734, 0x14d30, 0x1fa28, 0x1fa2e, 0x774, 0x14d34
.long 0x1fa28, 0x1fa30, 0x7b4, 0x14d38, 0x1fa28, 0x1fa32, 0x7f4, 0x14d3c
.long 0x1fa38, 0x1fa34, 0x834, 0x14d00, 0x1fa38, 0x1fa36, 0x874, 0x14d04
.long 0x1fa38, 0x1fa38, 0x8b4, 0x14d08, 0x1fa38, 0x1fa3a, 0x8f4, 0x14d0c
.long 0x1fa38, 0x1fa3c, 0x934, 0x14d10, 0x1fa38, 0x1fa3e, 0x974, 0x14d14
.long 0x1fa38, 0x1fa40, 0x9b4, 0x14d18, 0x1fa38, 0x1fa42, 0x9f4, 0x14d1c
.long 0x1fa38, 0x1fa44, 0xa34, 0x14d20, 0x1fa38, 0x1fa46, 0xa74, 0x14d24
.long 0x1fa38, 0x1fa48, 0xab4, 0x14d28, 0x1fa38, 0x1fa4a, 0xaf4, 0x14d2c
.long 0x1fa38, 0x1fa4c, 0xb34, 0x14d30, 0x1fa38, 0x1fa4e, 0xb74, 0x14d34
.long 0x1fa38, 0x1fa50, 0xbb4, 0x14d38, 0x1fa38, 0x1fa52, 0xbf4, 0x14d3c
.long 0x1fa38, 0x1fa54, 0xc34, 0x14d00, 0x1fa38, 0x1fa56, 0xc74, 0x14d04
.long 0x1fa38, 0x1fa58, 0xcb4, 0x14d08, 0x1fa38, 0x1fa5a, 0xcf4, 0x14d0c
.long 0x1fa38, 0x1fa5c, 0xd34, 0x14d10, 0x1fa38, 0x1fa5e, 0xd74, 0x14d14
.long 0x1fa38, 0x1fa60, 0xdb4, 0x14d18, 0x1fa38, 0x1fa62, 0xdf4, 0x14d1c
.long 0x1fa38, 0x1fa64, 0xe34, 0x14d20, 0x1fa38, 0x1fa66, 0xe74, 0x14d24
.long 0x1fa38, 0x1fa68, 0xeb4, 0x14d28, 0x1fa38, 0x1fa6a, 0xef4, 0x14d2c
.long 0x1fa38, 0x1fa6c, 0xf34, 0x14d30, 0x1fa38, 0x1fa6e, 0xf74, 0x14d34
.long 0x1fa38, 0x1fa70, 0xfb4, 0x14d38, 0x1fa38, 0x1fa72, 0xff4, 0x14d3c
.long 0x0, 0x0, 0x0, 0x0, 0x0, 0x0, 0x0, 0x0
.long 0x0, 0x0, 0x0, 0x0, 0x0, 0x0, 0x0, 0x0
.long 0x0, 0x0, 0x0, 0x0, 0x0, 0x0, 0x0, 0x0
.long 0x0, 0x0, 0x0, 0x0, 0x0, 0x0, 0x0, 0x0
.long 0x0, 0x0, 0x0, 0x0, 0x0, 0x0, 0x0, 0x0
.long 0x0, 0x0, 0x0, 0x0, 0x0, 0x0, 0x0, 0x0
.long 0x0, 0x0, 0x0, 0x0, 0x0, 0x0, 0x0, 0x0
.long 0x0, 0x0, 0x0, 0x0, 0x0, 0x0, 0x0, 0x0
.long 0x0, 0x0, 0x0, 0x0, 0x0, 0x0, 0x0, 0x0
.long 0x0, 0x0, 0x0, 0x0, 0x0, 0x0, 0x0, 0x0
.long 0x0, 0x0, 0x0, 0x0, 0x0, 0x0, 0x0, 0x0
.long 0x0, 0x0, 0x0, 0x0, 0x0, 0x0, 0x0, 0x0
.long 0x0, 0x0, 0x0, 0x0, 0x0, 0x0, 0x0, 0x0
.long 0x0, 0x0, 0x0, 0x0, 0x0, 0x0, 0x0, 0x0
.long 0x0, 0x0, 0x0, 0x0, 0x0, 0x0, 0x0, 0x0
.long 0x0, 0x0, 0x0, 0x0, 0x0, 0x0, 0x0, 0x0
.long 0x0, 0x0, 0x0, 0x0, 0x0, 0x0, 0x0, 0x0
.long 0x0, 0x0, 0x0, 0x0, 0x0, 0x0, 0x0, 0x0
.long 0x0, 0x0, 0x0, 0x0, 0x0, 0x0, 0x0, 0x0
.long 0x0, 0x0, 0x0, 0x0, 0x0, 0x0, 0x0, 0x0
.long 0x0, 0x0, 0x0, 0x0, 0x0, 0x0, 0x0, 0x0
.long 0x0, 0x0, 0x0, 0x0, 0x0, 0x0, 0x0, 0x0
.long 0x0, 0x0, 0x0, 0x0, 0x0, 0x0, 0x0, 0x0
.long 0x0, 0x0, 0x0, 0x0, 0x0, 0x0, 0x0, 0x0
.long 0x0, 0x0, 0x0, 0x0, 0x0, 0x0, 0x0, 0x0
.long 0x0, 0x0, 0x0, 0x0, 0x0, 0x0, 0x0, 0x0
.long 0x0, 0x0, 0x0, 0x0, 0x0, 0x0, 0x0, 0x0
.long 0x0, 0x0, 0x0, 0x0, 0x0, 0x0, 0x0, 0x0
.long 0x0, 0x0, 0x0, 0x0, 0x0, 0x0, 0x0, 0x0
.long 0x0, 0x0, 0x0, 0x0, 0x0, 0x0, 0x0, 0x0
.long 0x0, 0x0, 0x0, 0x0, 0x0, 0x0, 0x0, 0x0
.long 0x0, 0x0, 0x0, 0x0, 0x0, 0x0, 0x0, 0x0
.long 0x13320, 0xa9b0, 0xa800, 0x10c00, 0xf320, 0xc120, 0x133b0, 0xb690
.long 0xa890, 0x11920, 0xf3b0, 0xce00, 0x12600, 0xa920, 0xb520, 0x10c90
.long 0xe600, 0xc090, 0x12690, 0xb600, 0xb5b0, 0x119b0, 0xe690, 0xcdb0
.long 0xd5f0, 0x11440, 0x117f0, 0x130d0, 0xf8d0, 0xadf0, 0xd640, 0x12160
.long 0x11840, 0x13df0, 0xf960, 0xbad0, 0xc8d0, 0x113f0, 0x124d0, 0x13160
.long 0xebf0, 0xad60, 0xc960, 0x120d0, 0x12560, 0x13e40, 0xec40, 0xba40
.long 0xefb0, 0x10ed0, 0x117b0, 0x12a40, 0xfa90, 0xdb60, 0xc890, 0x10d60
.long 0x10a90, 0x129f0, 0x13bb0, 0xddf0, 0xf000, 0x11bf0, 0x11520, 0xe960
.long 0xc160, 0xf9b0, 0xc920, 0x11a40, 0x10800, 0xe8d0, 0xc3f0, 0x13a90
.long 0xce40, 0xfa00, 0xfff0, 0xbb20, 0xedb0, 0xdad0, 0xced0, 0x10720
.long 0x10040, 0xc800, 0x14890, 0xde40, 0xf560, 0xfbb0, 0x140d0, 0xbdb0
.long 0xb3f0, 0xec00, 0xf5f0, 0x10890, 0x14160, 0xca90, 0xb760, 0x14720
.long 0x13520, 0xddb0, 0xa520, 0xbe00, 0xf490, 0xe800, 0x13690, 0x10490
.long 0xa5b0, 0xcb20, 0xe7b0, 0x14d00, 0x12800, 0xdd20, 0xb200, 0xbe90
.long 0xf800, 0x14320, 0x129b0, 0x10400, 0xb290, 0xcbb0, 0xeb20, 0x14290
.long 0xd560, 0x10760, 0x112d0, 0xaed0, 0xfb60, 0xeed0, 0xd3f0, 0xe040
.long 0x11360, 0xbbf0, 0xee40, 0x14d00, 0xc840, 0x106d0, 0x11ff0, 0xaf60
.long 0xfed0, 0x149f0, 0xc6d0, 0xdff0, 0x12040, 0xbc40, 0xf1f0, 0x14960
.long 0xbbb0, 0x10cd0, 0xfdb0, 0x12960, 0xd3b0, 0xd9f0, 0x13090, 0x11160
.long 0x13e90, 0x12bf0, 0xbff0, 0xd290, 0xbc00, 0x119f0, 0xfb20, 0xe840
.long 0xac90, 0xd840, 0x13120, 0x11e40, 0x13c00, 0xead0, 0xbe40, 0xabb0
.long 0xcf60, 0x11400, 0x101f0, 0xef20, 0x12e90, 0xdd60, 0xccd0, 0xd320
.long 0x10560, 0x14a00, 0xb640, 0x12d20, 0xf640, 0x115b0, 0x142d0, 0xf1b0
.long 0x121b0, 0xdcd0, 0xf3f0, 0xd490, 0x14640, 0x14c90, 0xb5f0, 0x12000
.long 0x13600, 0xf7b0, 0xa490, 0xb120, 0x10d20, 0xc200, 0x135b0, 0xea90
.long 0xa400, 0x14d00, 0x10db0, 0xcf20, 0x12920, 0xf720, 0xaa00, 0x14000
.long 0x11a00, 0xc290, 0x12890, 0xea00, 0xb720, 0x14090, 0x11a90, 0xcfb0
.long 0xd4d0, 0xfa40, 0x11760, 0x123f0, 0x12cd0, 0xaff0, 0xd440, 0xed60
.long 0x116d0, 0x14d00, 0x12d60, 0xbcd0, 0xc7f0, 0xf9f0, 0x118d0, 0x14ad0
.long 0x139f0, 0xb040, 0xc760, 0xecd0, 0x125f0, 0x14b60, 0x13a40, 0xbd60
.long 0xe290, 0x10e40, 0xc9b0, 0x12760, 0xfe00, 0x13640, 0x10df0, 0xd5b0
.long 0xf090, 0x128d0, 0x13f20, 0x138d0, 0xe320, 0x11b60, 0x12640, 0xafb0
.long 0xfe90, 0x14360, 0x11ad0, 0xd600, 0xe560, 0xad20, 0x13fb0, 0x145f0
.long 0xe000, 0xcd60, 0x10920, 0x102d0, 0xa6d0, 0xebb0, 0xd040, 0x12e00
.long 0xfc00, 0x10240, 0xaa40, 0x14690, 0xe1b0, 0xf440, 0x103f0, 0x12320
.long 0xe7f0, 0xee00, 0xf760, 0x12fb0, 0x144d0, 0x125b0, 0xeb60, 0x14920
.long 0x13720, 0x111b0, 0xdb20, 0xf400, 0x11090, 0x11d20, 0x137b0, 0x11e90
.long 0xda90, 0xe720, 0x11db0, 0x14d00, 0x12a00, 0x11120, 0x10200, 0xf5b0
.long 0x11200, 0x14400, 0x12a90, 0x11e00, 0x101b0, 0xe890, 0x11f20, 0x14490
.long 0xd6d0, 0x12e40, 0x108d0, 0xfc40, 0x13240, 0x13ed0, 0xd760, 0x13b60
.long 0x10840, 0xef60, 0x13f60, 0x14d00, 0xc9f0, 0x12df0, 0xe1f0, 0xfad0
.long 0x132d0, 0x14bf0, 0xca40, 0x13ad0, 0xe160, 0xedf0, 0x13ff0, 0x14c40
.long 0x11690, 0x11040, 0xde90, 0xa640, 0x10b20, 0x136d0, 0x109b0, 0x10ff0
.long 0xa5f0, 0xd1b0, 0x10bb0, 0x143f0, 0x11720, 0x11d60, 0xdf20, 0xb360
.long 0xb000, 0x13360, 0x10a00, 0x11cd0, 0xb2d0, 0xd200, 0xb090, 0x14040
.long 0xcbf0, 0xb920, 0xe400, 0x13560, 0xa560, 0xc490, 0xcc40, 0xc600
.long 0x13840, 0x13200, 0xe640, 0xc720, 0xf2d0, 0xba90, 0xdfb0, 0xc040
.long 0xa8d0, 0x11fb0, 0xf360, 0xc7b0, 0xc360, 0x12db0, 0xe9f0, 0x12200
.long 0x13400, 0xc3b0, 0xdc00, 0x10e00, 0xbfb0, 0xcc00, 0x13490, 0xd090
.long 0xdc90, 0x11b20, 0xcc90, 0x14d00, 0x12720, 0xc320, 0x10320, 0x10fb0
.long 0xc400, 0x14120, 0x127b0, 0xd000, 0x103b0, 0x11c90, 0xd120, 0x141b0
.long 0xd1f0, 0xac40, 0x10ad0, 0x13040, 0xab60, 0xb7f0, 0xd240, 0xb960
.long 0x10b60, 0x13d60, 0xb840, 0x14d00, 0xc4d0, 0xabf0, 0xe3f0, 0x12ed0
.long 0xb0d0, 0x146d0, 0xc560, 0xb8d0, 0xe440, 0x13bf0, 0xbdf0, 0x14760
.long 0xfc90, 0x10f60, 0x11290, 0xa840, 0x13d20, 0x104d0, 0x13db0, 0x111f0
.long 0x105b0, 0xa7f0, 0x13c90, 0xf7f0, 0xfd20, 0x11c40, 0x11320, 0xb560
.long 0xae00, 0xff60, 0x13e00, 0x11ed0, 0x10600, 0xb4d0, 0xadb0, 0xf240
.long 0xcdf0, 0xed20, 0x133f0, 0xbd20, 0x12c40, 0x14bb0, 0xd160, 0x14800
.long 0x13440, 0xca00, 0x11f60, 0x14b20, 0xf4d0, 0xee90, 0xbed0, 0xb890
.long 0x12ad0, 0x12490, 0xf840, 0x149b0, 0xbf60, 0xc5b0, 0x11df0, 0x12400
.long 0x12bb0, 0x13800, 0xd920, 0xc000, 0x14600, 0x14d00, 0x13890, 0x14d00
.long 0xd9b0, 0xcd20, 0xc5f0, 0x14d00, 0x13920, 0x145b0, 0x10000, 0xc1b0
.long 0xb1b0, 0x14d00, 0x12c00, 0x14520, 0x10090, 0xce90, 0xfbf0, 0x14d00
.long 0xc640, 0xd2d0, 0x105f0, 0xae40, 0x14cd0, 0x14d00, 0xd360, 0x14d00
.long 0x10640, 0xbb60, 0xbf20, 0x14d00, 0xd7f0, 0x14840, 0xded0, 0xacd0
.long 0x10290, 0x14d00, 0xcad0, 0x147f0, 0xdf60, 0xb9f0, 0x11000, 0x14d00
.long 0x14a90, 0x11240, 0xf890, 0xa760, 0x14d00, 0xaad0, 0x123b0, 0x110d0
.long 0x139b0, 0xa9f0, 0x14d00, 0x12b20, 0x10c40, 0xae90, 0xf920, 0xb440
.long 0xe0d0, 0x14d00, 0x11960, 0xaf20, 0x13a00, 0xb6d0, 0x131f0, 0x14d00
.long 0x13b20, 0xd0d0, 0x135f0, 0xf120, 0x14d00, 0x12440, 0xac00, 0xcb60
.long 0x13960, 0x14c00, 0xf520, 0x14d00, 0xcff0, 0x12120, 0xc0d0, 0xec90
.long 0xda40, 0xe090, 0xf6d0, 0x12290, 0xc440, 0x147b0, 0x14d00, 0x14d00
.long 0xa600, 0xd800, 0xdbb0, 0x10120, 0x0, 0x0, 0xa7b0, 0xff20
.long 0xda00, 0x14d00, 0x0, 0x0, 0xb320, 0xd890, 0xde00, 0x14200
.long 0x0, 0x0, 0xb490, 0xffb0, 0x10520, 0x143b0, 0x0, 0x0
.long 0x11640, 0x109f0, 0x107f0, 0xe240, 0x0, 0x0, 0x114d0, 0xe2d0
.long 0x10960, 0x14d00, 0x0, 0x0, 0x12360, 0x10a40, 0x10bf0, 0x14a40
.long 0x0, 0x0, 0x121f0, 0xe360, 0xe4d0, 0x148d0, 0x0, 0x0
.long 0xbc90, 0x126d0, 0x12c90, 0xa960, 0x0, 0x0, 0x131b0, 0x12b60
.long 0xb7b0, 0xa4d0, 0x0, 0x0, 0xba00, 0xe5f0, 0xa440, 0xaa90
.long 0x0, 0x0, 0x12f20, 0xea40, 0xb160, 0xab20, 0x0, 0x0
.long 0x10360, 0x11600, 0xd720, 0x134d0, 0x0, 0x0, 0x100d0, 0xd520
.long 0x11800, 0x13760, 0x0, 0x0, 0x14440, 0x11890, 0x137f0, 0x12520
.long 0x0, 0x0, 0x141f0, 0xd7b0, 0xc2d0, 0x12090, 0x0, 0x0
.long 0xa720, 0xf200, 0xf600, 0x10f20, 0x0, 0x0, 0xa690, 0xe520
.long 0xf690, 0x11c00, 0x0, 0x0, 0xb400, 0xf290, 0xe920, 0x10e90
.long 0x0, 0x0, 0xb3b0, 0xe5b0, 0xe9b0, 0x11bb0, 0x0, 0x0
.long 0x115f0, 0xfcd0, 0xfdf0, 0x12ff0, 0x0, 0x0, 0x11560, 0xeff0
.long 0xfe40, 0x13cd0, 0x0, 0x0, 0x122d0, 0xfd60, 0xf0d0, 0x12f60
.long 0x0, 0x0, 0x12240, 0xf040, 0xf160, 0x13c40, 0x0, 0x0
.long 0xe3b0, 0x12840, 0x11490, 0xdc40, 0x0, 0x0, 0x127f0, 0xd690
.long 0x107b0, 0xdbf0, 0x0, 0x0, 0xe120, 0xe760, 0xc240, 0x113b0
.long 0x0, 0x0, 0xe6d0, 0xd400, 0xc1f0, 0x10690, 0x0, 0x0
.long 0xe200, 0x10160, 0xb9b0, 0xd8d0, 0x0, 0x0, 0x10440, 0x13000
.long 0xc690, 0xd960, 0x0, 0x0, 0xe490, 0x14240, 0xb1f0, 0xb800
.long 0x0, 0x0, 0x14560, 0x13290, 0xb240, 0xc520, 0x0, 0x0
.long 0x0, 0x0, 0x0, 0x0, 0x0, 0x0, 0x0, 0x0
.long 0x0, 0x0, 0x0, 0x0, 0x0, 0x0, 0x0, 0x0
.long 0x0, 0x0, 0x0, 0x0, 0x0, 0x0, 0x0, 0x0
.long 0x0, 0x0, 0x0, 0x0, 0x0, 0x0, 0x0, 0x0
.long 0x0, 0x0, 0x0, 0x0, 0x0, 0x0, 0x0, 0x0
.long 0x0, 0x0, 0x0, 0x0, 0x0, 0x0, 0x0, 0x0
.long 0x0, 0x0, 0x0, 0x0, 0x0, 0x0, 0x0, 0x0
.long 0x0, 0x0, 0x0, 0x0, 0x0, 0x0, 0x0, 0x0
.long 0x0, 0x0, 0x0, 0x0, 0x0, 0x0, 0x0, 0x0
.long 0x0, 0x0, 0x0, 0x0, 0x0, 0x0, 0x0, 0x0
.long 0x0, 0x0, 0x0, 0x0, 0x0, 0x0, 0x0, 0x0
.long 0x0, 0x0, 0x0, 0x0, 0x0, 0x0, 0x0, 0x0
.long 0x0, 0x0, 0x0, 0x0, 0x0, 0x0, 0x0, 0x0
.long 0x0, 0x0, 0x0, 0x0, 0x0, 0x0, 0x0, 0x0
.long 0x0, 0x0, 0x0, 0x0, 0x0, 0x0, 0x0, 0x0
.long 0x0, 0x0, 0x0, 0x0, 0x0, 0x0, 0x0, 0x0
.long 0x0, 0x0, 0x0, 0x0, 0x0, 0x0, 0x0, 0x0
.long 0x0, 0x0, 0x0, 0x0, 0x0, 0x0, 0x0, 0x0
.long 0x0, 0x0, 0x0, 0x0, 0x0, 0x0, 0x0, 0x0
.long 0x0, 0x0, 0x0, 0x0, 0x0, 0x0, 0x0, 0x0
.long 0x0, 0x0, 0x0, 0x0, 0x0, 0x0, 0x0, 0x0
.long 0x0, 0x0, 0x0, 0x0, 0x0, 0x0, 0x0, 0x0
.long 0x0, 0x0, 0x0, 0x0, 0x0, 0x0, 0x0, 0x0
.long 0x0, 0x0, 0x0, 0x0, 0x0, 0x0, 0x0, 0x0
.long 0x0, 0x0, 0x0, 0x0, 0x0, 0x0, 0x0, 0x0
.long 0x0, 0x0, 0x0, 0x0, 0x0, 0x0, 0x0, 0x0
.long 0x0, 0x0, 0x0, 0x0, 0x0, 0x0, 0x0, 0x0
.long 0x0, 0x0, 0x0, 0x0, 0x0, 0x0, 0x0, 0x0
.long 0x0, 0x0, 0x0, 0x0, 0x0, 0x0, 0x0, 0x0
.long 0x0, 0x0, 0x0, 0x0, 0x0, 0x0, 0x0, 0x0
.long 0x0, 0x0, 0x0, 0x0, 0x0, 0x0, 0x0, 0x0
.long 0x0, 0x0, 0x0, 0x0, 0x0, 0x0, 0x0, 0x0
.section .rodata,"a"
.p2align 6
.amdhsa_kernel standalone__deep_cross_xdeepfm__recsys_kernel
  .amdhsa_next_free_vgpr 256
  .amdhsa_next_free_sgpr 102
  .amdhsa_accum_offset 256
  .amdhsa_group_segment_fixed_size 0
  .amdhsa_kernarg_size 88
  .amdhsa_user_sgpr_count 2
  .amdhsa_user_sgpr_kernarg_segment_ptr 1
  .amdhsa_system_sgpr_workgroup_id_x 1
  .amdhsa_float_denorm_mode_32 3
.end_amdhsa_kernel
```

```asm
; @launch grid=(256,1,1) block=(512,1,1) lds=163840
.amdgcn_target "amdgcn-amd-amdhsa--gfx950"
.text
.globl standalone__deep_cross_xdeepfm__recsys_kernel
.p2align 8
.type standalone__deep_cross_xdeepfm__recsys_kernel,@function
standalone__deep_cross_xdeepfm__recsys_kernel:
  s_cmp_ge_u32 s2, 256
  s_cbranch_scc1 L_end
  s_load_dwordx16 s[4:19], s[0:1], 0
  s_load_dwordx4 s[20:23], s[0:1], 64
  s_load_dwordx2 s[24:25], s[0:1], 80
  v_lshrrev_b32 v1, 6, v0
  s_getpc_b64 s[92:93]
L_pc:
  s_and_b32 s68, s2, 0xf8
  v_add_u32 v2, s68, v1
  v_and_b32_e64 v3, 32, v0
  v_lshl_add_u32 v2, v3, 3, v2
  v_lshlrev_b32 v2, 7, v2
  v_min_u32 v2, L_end-L_pc, v2
  v_mov_b32 v3, s93
  v_add_co_u32 v2, vcc, s92, v2
  s_nop 1
  v_addc_co_u32 v3, vcc, 0, v3, vcc
  global_load_dword v251, v[2:3], off
  v_and_b32 v0, 63, v0
  v_readfirstlane_b32 s3, v1
  s_and_b32 s68, s2, 7
  s_lshr_b32 s69, s2, 3
  s_xor_b32 s69, s69, 31
  s_and_b32 s80, s2, 0xf8
  s_add_u32 s80, s80, s3
  s_lshl_b32 s80, s80, 0
  s_min_u32 s70, s68, 1
  s_add_u32 s71, s69, s70
  s_cmp_ge_u32 s71, 22
  s_cbranch_scc1 L_cin
  s_mul_i32 s68, s68, 21
  s_add_u32 s68, s68, s71
  s_mul_i32 s26, s68, 5042
  s_lshr_b32 s26, s26, 16
  s_mul_i32 s69, s26, 13
  s_sub_u32 s27, s68, s69
  s_lshl_b32 s77, s27, 8
  s_mul_i32 s71, s26, 320
  v_lshrrev_b32 v116, 4, v0
  v_lshlrev_b32 v11, 4, v0
  s_and_b32 s79, s3, 3
  s_cmp_ge_u32 s3, 4
  s_cbranch_scc1 L_ld
  s_mul_i32 s70, s3, 13
  v_min_u32 v118, 12, v0
  v_add_u32 v118, s70, v118
  v_lshrrev_b32 v117, 1, v118
  v_mul_u32_u24 v117, 96, v117
  v_lshl_add_u32 v118, v118, 2, v117
  s_mul_i32 s78, s27, 25
  s_min_u32 s78, s78, 294
  s_add_u32 s78, s78, s71
  s_mul_i32 s78, s78, 104
  s_lshl_b32 s70, s26, 2
  s_add_u32 s70, s70, s3
  s_add_u32 s70, s70, 64
  s_mul_i32 s70, s70, 3328
  s_add_u32 s70, s70, s77
  s_mov_b32 s81, 173056
  v_lshrrev_b32 v112, 1, v0
  v_mul_lo_u32 v112, s81, v112
  v_and_b32 v117, 1, v0
  v_lshl_add_u32 v112, v117, 7, v112
  v_add_u32 v112, s70, v112
  s_waitcnt lgkmcnt(0)
  s_mov_b32 s28, s4
  s_and_b32 s29, s5, 0xffff
  s_mov_b32 s30, 425984
  s_mov_b32 s31, 0x20000
  buffer_load_dwordx4 v[100:103], v118, s[28:31], s78 offen
  buffer_load_dwordx4 v[104:107], v118, s[28:31], s78 offen offset:16
  s_mov_b32 s32, s6
  s_and_b32 s33, s7, 0xffff
  s_mov_b32 s34, 12800000
  s_mov_b32 s35, 0x20000
  s_mov_b32 s48, s14
  s_and_b32 s49, s15, 0xffff
  s_mov_b32 s50, 3328
  s_mov_b32 s51, 0x20000
  s_mov_b32 m0, 122880
  s_mov_b64 exec, 0xffff
  buffer_load_dwordx4 v11, s[48:51], s77 offen lds
  s_mov_b64 exec, -1
  s_mov_b32 s44, s12
  s_and_b32 s45, s13, 0xffff
  s_mov_b32 s46, 5537792
  s_mov_b32 s47, 0x20000
  s_mov_b64 exec, 255
  buffer_load_dword v209, v112, s[44:47], 0 offen
  s_mov_b64 exec, -1
  s_barrier
  s_branch L_cmp
L_ld:
  s_lshr_b32 s68, s79, 1
  s_mul_i32 s68, s68, 20
  s_and_b32 s69, s79, 1
  s_add_u32 s68, s68, s69
  s_lshl_b32 s76, s68, 10
  s_mul_i32 s78, s71, 104
  s_mul_i32 s68, s68, 832
  s_add_u32 s94, s78, s68
  v_mul_u32_u24 v118, 48, v116
  v_sub_u32_e64 v12, v11, v118
  s_add_u32 s95, s94, 3328
  s_add_u32 s96, s94, 6656
  s_add_u32 s97, s94, 9984
  s_add_u32 s98, s94, 13312
  s_and_b32 s70, s79, 1
  s_lshl_b32 s70, s70, 3
  v_lshlrev_b32 v117, 1, v116
  v_or_b32 v117, s70, v117
  v_xor_b32 v117, v117, v0
  v_and_b32 v117, 15, v117
  v_mul_u32_u24 v4, 3328, v116
  v_lshl_add_u32 v4, v117, 4, v4
  v_add_u32 v5, 13312, v4
  s_mul_i32 s74, s79, 26624
  s_add_u32 s74, s74, s77
  s_lshl_b32 s75, s79, 11
  s_waitcnt lgkmcnt(0)
  s_mov_b32 s28, s4
  s_and_b32 s29, s5, 0xffff
  s_mov_b32 s30, 425984
  s_mov_b32 s31, 0x20000
  buffer_load_dwordx4 v[16:19], v12, s[28:31], s94 offen offset:0
  s_mov_b32 s32, s6
  s_and_b32 s33, s7, 0xffff
  s_mov_b32 s34, 12800000
  s_mov_b32 s35, 0x20000
  s_mov_b32 s44, s12
  s_and_b32 s45, s13, 0xffff
  s_mov_b32 s46, 5537792
  s_mov_b32 s47, 0x20000
  s_add_u32 m0, s75, 131072
  s_nop 0
  buffer_load_dwordx4 v4, s[44:47], s74 offen lds
  s_add_u32 m0, s75, 132096
  s_nop 0
  buffer_load_dwordx4 v5, s[44:47], s74 offen lds
  s_add_u32 s74, s74, 106496
  s_add_u32 m0, s75, 139264
  s_nop 0
  buffer_load_dwordx4 v4, s[44:47], s74 offen lds
  s_add_u32 m0, s75, 140288
  s_nop 0
  buffer_load_dwordx4 v5, s[44:47], s74 offen lds
  s_add_u32 s74, s74, 106496
  s_barrier
  buffer_load_dwordx4 v[20:23], v12, s[28:31], s94 offen offset:1664
  buffer_load_dwordx4 v[24:27], v12, s[28:31], s95 offen offset:0
  buffer_load_dwordx4 v[28:31], v12, s[28:31], s95 offen offset:1664
  buffer_load_dwordx4 v[32:35], v12, s[28:31], s96 offen offset:0
  buffer_load_dwordx4 v[36:39], v12, s[28:31], s96 offen offset:1664
  buffer_load_dwordx4 v[40:43], v12, s[28:31], s97 offen offset:0
  buffer_load_dwordx4 v[44:47], v12, s[28:31], s97 offen offset:1664
  buffer_load_dwordx4 v[48:51], v12, s[28:31], s98 offen offset:0
  buffer_load_dwordx4 v[52:55], v12, s[28:31], s98 offen offset:1664
  s_lshl_b32 s70, s69, 6
  v_and_b32 v118, 7, v0
  v_xor_b32 v118, v118, v116
  v_lshlrev_b32 v118, 4, v118
  v_xor_b32 v2, s70, v118
  v_xor_b32 v3, 64, v2
  s_mov_b32 s72, 0
  s_mul_i32 s70, s79, 13
  s_add_u32 s70, s70, s27
  s_min_u32 s70, s70, 39
  s_lshl_b32 s70, s70, 3
  s_add_u32 s70, s70, s71
  s_mul_i32 s84, s70, 104
  v_lshrrev_b32 v118, 2, v0
  v_min_u32 v118, 7, v118
  v_mul_u32_u24 v118, 104, v118
  v_and_b32 v117, 3, v0
  v_lshl_add_u32 v7, v117, 2, v118
  s_lshl_b32 s70, s26, 2
  s_add_u32 s70, s70, s79
  s_add_u32 s70, s70, 256
  s_mul_i32 s85, s70, 3328
  s_add_u32 s85, s85, s77
  s_mov_b32 s70, 173056
  v_lshrrev_b32 v118, 1, v0
  v_mul_lo_u32 v118, s70, v118
  v_and_b32 v117, 1, v0
  v_lshl_add_u32 v84, v117, 7, v118
  s_mov_b32 s52, s16
  s_and_b32 s53, s17, 0xffff
  s_mov_b32 s54, 3328
  s_mov_b32 s55, 0x20000
  s_mul_i32 s70, s79, 2560
  s_add_u32 s70, s70, L_tail-L_pc
  v_lshlrev_b32 v8, 7, v0
  v_add_u32 v8, s70, v8
  v_mov_b32 v9, s93
  v_add_co_u32 v8, vcc, s92, v8
  s_nop 1
  v_addc_co_u32 v9, vcc, 0, v9, vcc
  s_waitcnt vmcnt(13)
  v_lshlrev_b32 v16, 7, v16
  v_lshlrev_b32 v18, 7, v18
  v_lshlrev_b32 v17, 7, v17
  v_lshlrev_b32 v19, 7, v19
  v_add_u32_dpp v56, v16, v2 row_newbcast:0 row_mask:0xf bank_mask:0x3
  s_nop 1
  v_add_u32_dpp v56, v18, v2 row_newbcast:6 row_mask:0xf bank_mask:0xc
  s_add_u32 m0, s76, 0
  s_nop 0
  buffer_load_dwordx4 v56, s[32:35], 0 offen lds
  s_waitcnt vmcnt(10)
  s_barrier
  s_waitcnt vmcnt(9)
  v_lshlrev_b32 v20, 7, v20
  v_lshlrev_b32 v22, 7, v22
  v_lshlrev_b32 v21, 7, v21
  v_lshlrev_b32 v23, 7, v23
  v_add_u32_dpp v57, v20, v2 row_newbcast:0 row_mask:0xf bank_mask:0x3
  s_nop 1
  v_add_u32_dpp v57, v22, v2 row_newbcast:6 row_mask:0xf bank_mask:0xc
  s_add_u32 m0, s76, 2048
  s_nop 0
  buffer_load_dwordx4 v57, s[32:35], 0 offen lds
  s_waitcnt vmcnt(9)
  v_lshlrev_b32 v24, 7, v24
  v_lshlrev_b32 v26, 7, v26
  v_lshlrev_b32 v25, 7, v25
  v_lshlrev_b32 v27, 7, v27
  v_add_u32_dpp v58, v24, v2 row_newbcast:0 row_mask:0xf bank_mask:0x3
  s_nop 1
  v_add_u32_dpp v58, v26, v2 row_newbcast:6 row_mask:0xf bank_mask:0xc
  s_add_u32 m0, s76, 4096
  s_nop 0
  buffer_load_dwordx4 v58, s[32:35], 0 offen lds
  s_waitcnt vmcnt(9)
  v_lshlrev_b32 v28, 7, v28
  v_lshlrev_b32 v30, 7, v30
  v_lshlrev_b32 v29, 7, v29
  v_lshlrev_b32 v31, 7, v31
  v_add_u32_dpp v59, v28, v2 row_newbcast:0 row_mask:0xf bank_mask:0x3
  s_nop 1
  v_add_u32_dpp v59, v30, v2 row_newbcast:6 row_mask:0xf bank_mask:0xc
  s_add_u32 m0, s76, 6144
  s_nop 0
  buffer_load_dwordx4 v59, s[32:35], 0 offen lds
  s_waitcnt vmcnt(9)
  v_lshlrev_b32 v32, 7, v32
  v_lshlrev_b32 v34, 7, v34
  v_lshlrev_b32 v33, 7, v33
  v_lshlrev_b32 v35, 7, v35
  v_add_u32_dpp v60, v32, v2 row_newbcast:0 row_mask:0xf bank_mask:0x3
  s_nop 1
  v_add_u32_dpp v60, v34, v2 row_newbcast:6 row_mask:0xf bank_mask:0xc
  s_add_u32 m0, s76, 8192
  s_nop 0
  buffer_load_dwordx4 v60, s[32:35], 0 offen lds
  s_waitcnt vmcnt(9)
  v_lshlrev_b32 v36, 7, v36
  v_lshlrev_b32 v38, 7, v38
  v_lshlrev_b32 v37, 7, v37
  v_lshlrev_b32 v39, 7, v39
  v_add_u32_dpp v61, v36, v2 row_newbcast:0 row_mask:0xf bank_mask:0x3
  s_nop 1
  v_add_u32_dpp v61, v38, v2 row_newbcast:6 row_mask:0xf bank_mask:0xc
  s_add_u32 m0, s76, 10240
  s_nop 0
  buffer_load_dwordx4 v61, s[32:35], 0 offen lds
  s_waitcnt vmcnt(9)
  v_lshlrev_b32 v40, 7, v40
  v_lshlrev_b32 v42, 7, v42
  v_lshlrev_b32 v41, 7, v41
  v_lshlrev_b32 v43, 7, v43
  v_add_u32_dpp v62, v40, v2 row_newbcast:0 row_mask:0xf bank_mask:0x3
  s_nop 1
  v_add_u32_dpp v62, v42, v2 row_newbcast:6 row_mask:0xf bank_mask:0xc
  s_add_u32 m0, s76, 12288
  s_nop 0
  buffer_load_dwordx4 v62, s[32:35], 0 offen lds
  s_waitcnt vmcnt(9)
  v_lshlrev_b32 v44, 7, v44
  v_lshlrev_b32 v46, 7, v46
  v_lshlrev_b32 v45, 7, v45
  v_lshlrev_b32_e64 v47, 7, v47
  v_add_u32_dpp v63, v44, v2 row_newbcast:0 row_mask:0xf bank_mask:0x3
  s_nop 1
  v_add_u32_dpp v63, v46, v2 row_newbcast:6 row_mask:0xf bank_mask:0xc
  s_add_u32 m0, s76, 14336
  s_nop 0
  buffer_load_dwordx4 v63, s[32:35], 0 offen lds
  s_waitcnt vmcnt(9)
  v_lshlrev_b32 v48, 7, v48
  v_lshlrev_b32 v50, 7, v50
  v_lshlrev_b32 v49, 7, v49
  v_lshlrev_b32_e64 v51, 7, v51
  v_add_u32_dpp v64, v48, v2 row_newbcast:0 row_mask:0xf bank_mask:0x3
  s_nop 1
  v_add_u32_dpp v64, v50, v2 row_newbcast:6 row_mask:0xf bank_mask:0xc
  s_add_u32 m0, s76, 16384
  s_nop 0
  buffer_load_dwordx4 v64, s[32:35], 0 offen lds
  s_waitcnt vmcnt(9)
  v_lshlrev_b32 v52, 7, v52
  v_lshlrev_b32 v54, 7, v54
  v_lshlrev_b32 v53, 7, v53
  v_lshlrev_b32_e64 v55, 7, v55
  v_add_u32_dpp v65, v52, v2 row_newbcast:0 row_mask:0xf bank_mask:0x3
  s_nop 1
  v_add_u32_dpp v65, v54, v2 row_newbcast:6 row_mask:0xf bank_mask:0xc
  s_add_u32 m0, s76, 18432
  s_nop 0
  buffer_load_dwordx4 v65, s[32:35], 0 offen lds
  v_add_u32_dpp v56, v17, v2 row_newbcast:0 row_mask:0xf bank_mask:0x3
  s_nop 1
  v_add_u32_dpp v56, v19, v2 row_newbcast:6 row_mask:0xf bank_mask:0xc
  s_add_u32 m0, s76, 40960
  s_nop 0
  buffer_load_dwordx4 v56, s[32:35], 0 offen lds
  v_add_u32_dpp v57, v21, v2 row_newbcast:0 row_mask:0xf bank_mask:0x3
  s_nop 1
  v_add_u32_dpp v57, v23, v2 row_newbcast:6 row_mask:0xf bank_mask:0xc
  s_add_u32 m0, s76, 43008
  s_nop 0
  buffer_load_dwordx4 v57, s[32:35], 0 offen lds
  v_add_u32_dpp v58, v25, v2 row_newbcast:0 row_mask:0xf bank_mask:0x3
  s_nop 1
  v_add_u32_dpp v58, v27, v2 row_newbcast:6 row_mask:0xf bank_mask:0xc
  s_add_u32 m0, s76, 45056
  s_nop 0
  buffer_load_dwordx4 v58, s[32:35], 0 offen lds
  v_add_u32_dpp v59, v29, v2 row_newbcast:0 row_mask:0xf bank_mask:0x3
  s_nop 1
  v_add_u32_dpp v59, v31, v2 row_newbcast:6 row_mask:0xf bank_mask:0xc
  s_add_u32 m0, s76, 47104
  s_nop 0
  buffer_load_dwordx4 v59, s[32:35], 0 offen lds
  v_add_u32_dpp v60, v33, v2 row_newbcast:0 row_mask:0xf bank_mask:0x3
  s_nop 1
  v_add_u32_dpp v60, v35, v2 row_newbcast:6 row_mask:0xf bank_mask:0xc
  s_add_u32 m0, s76, 49152
  s_nop 0
  buffer_load_dwordx4 v60, s[32:35], 0 offen lds
  s_waitcnt vmcnt(11)
  s_barrier
  v_add_u32_dpp v61, v37, v2 row_newbcast:0 row_mask:0xf bank_mask:0x3
  s_nop 1
  v_add_u32_dpp v61, v39, v2 row_newbcast:6 row_mask:0xf bank_mask:0xc
  s_add_u32 m0, s76, 51200
  s_nop 0
  buffer_load_dwordx4 v61, s[32:35], 0 offen lds
  v_add_u32_dpp v62, v41, v2 row_newbcast:0 row_mask:0xf bank_mask:0x3
  s_nop 1
  v_add_u32_dpp v62, v43, v2 row_newbcast:6 row_mask:0xf bank_mask:0xc
  s_add_u32 m0, s76, 53248
  s_nop 0
  buffer_load_dwordx4 v62, s[32:35], 0 offen lds
  v_add_u32_dpp v63, v45, v2 row_newbcast:0 row_mask:0xf bank_mask:0x3
  s_nop 1
  v_add_u32_dpp v63, v47, v2 row_newbcast:6 row_mask:0xf bank_mask:0xc
  s_add_u32 m0, s76, 55296
  s_nop 0
  buffer_load_dwordx4 v63, s[32:35], 0 offen lds
  v_add_u32_dpp v64, v49, v2 row_newbcast:0 row_mask:0xf bank_mask:0x3
  s_nop 1
  v_add_u32_dpp v64, v51, v2 row_newbcast:6 row_mask:0xf bank_mask:0xc
  s_add_u32 m0, s76, 57344
  s_nop 0
  buffer_load_dwordx4 v64, s[32:35], 0 offen lds
  v_add_u32_dpp v65, v53, v2 row_newbcast:0 row_mask:0xf bank_mask:0x3
  s_nop 1
  v_add_u32_dpp v65, v55, v2 row_newbcast:6 row_mask:0xf bank_mask:0xc
  s_add_u32 m0, s76, 59392
  s_nop 0
  buffer_load_dwordx4 v65, s[32:35], 0 offen lds
  s_waitcnt vmcnt(10)
  s_barrier
  s_add_u32 m0, s75, 147456
  s_nop 0
  buffer_load_dwordx4 v4, s[44:47], s74 offen lds
  s_add_u32 m0, s75, 148480
  s_nop 0
  buffer_load_dwordx4 v5, s[44:47], s74 offen lds
  s_add_u32 s74, s74, 106496
  s_add_u32 m0, s75, 155648
  s_nop 0
  buffer_load_dwordx4 v4, s[44:47], s74 offen lds
  s_add_u32 m0, s75, 156672
  s_nop 0
  buffer_load_dwordx4 v5, s[44:47], s74 offen lds
  s_add_u32 s74, s74, 106496
  v_add_u32_dpp v56, v18, v2 row_newbcast:0 row_mask:0xf bank_mask:0x3
  v_add_u32_dpp v57, v22, v2 row_newbcast:0 row_mask:0xf bank_mask:0x3
  v_add_u32_dpp v58, v26, v2 row_newbcast:0 row_mask:0xf bank_mask:0x3
  v_add_u32_dpp v59, v30, v2 row_newbcast:0 row_mask:0xf bank_mask:0x3
  v_add_u32_dpp v60, v34, v2 row_newbcast:0 row_mask:0xf bank_mask:0x3
  v_add_u32_dpp v61, v38, v2 row_newbcast:0 row_mask:0xf bank_mask:0x3
  v_add_u32_dpp v62, v42, v2 row_newbcast:0 row_mask:0xf bank_mask:0x3
  v_add_u32_dpp v63, v46, v2 row_newbcast:0 row_mask:0xf bank_mask:0x3
  v_add_u32_dpp v64, v50, v2 row_newbcast:0 row_mask:0xf bank_mask:0x3
  v_add_u32_dpp v65, v54, v2 row_newbcast:0 row_mask:0xf bank_mask:0x3
  v_add_u32_dpp v56, v16, v2 row_newbcast:7 row_mask:0xf bank_mask:0xc
  v_add_u32_dpp v57, v20, v2 row_newbcast:7 row_mask:0xf bank_mask:0xc
  v_add_u32_dpp v58, v24, v2 row_newbcast:7 row_mask:0xf bank_mask:0xc
  v_add_u32_dpp v59, v28, v2 row_newbcast:7 row_mask:0xf bank_mask:0xc
  v_add_u32_dpp v60, v32, v2 row_newbcast:7 row_mask:0xf bank_mask:0xc
  v_add_u32_dpp v61, v36, v2 row_newbcast:7 row_mask:0xf bank_mask:0xc
  v_add_u32_dpp v62, v40, v2 row_newbcast:7 row_mask:0xf bank_mask:0xc
  v_add_u32_dpp v63, v44, v2 row_newbcast:7 row_mask:0xf bank_mask:0xc
  v_add_u32_dpp v64, v48, v2 row_newbcast:7 row_mask:0xf bank_mask:0xc
  v_add_u32_dpp v65, v52, v2 row_newbcast:7 row_mask:0xf bank_mask:0xc
  buffer_load_dword v70, v7, s[28:31], s84 offen offset:24
  buffer_load_dword v71, v7, s[28:31], s84 offen offset:40
  buffer_load_dword v72, v7, s[28:31], s84 offen offset:56
  buffer_load_dword v73, v7, s[28:31], s84 offen offset:72
  buffer_load_dword v74, v7, s[28:31], s84 offen offset:88
  s_add_u32 m0, s76, 81920
  s_nop 0
  buffer_load_dwordx4 v56, s[32:35], 0 offen lds
  s_add_u32 m0, s76, 83968
  s_nop 0
  buffer_load_dwordx4 v57, s[32:35], 0 offen lds
  s_add_u32 m0, s76, 86016
  s_nop 0
  buffer_load_dwordx4 v58, s[32:35], 0 offen lds
  s_add_u32 m0, s76, 88064
  s_nop 0
  buffer_load_dwordx4 v59, s[32:35], 0 offen lds
  s_add_u32 m0, s76, 90112
  s_nop 0
  buffer_load_dwordx4 v60, s[32:35], 0 offen lds
  s_add_u32 m0, s76, 92160
  s_nop 0
  buffer_load_dwordx4 v61, s[32:35], 0 offen lds
  s_add_u32 m0, s76, 94208
  s_nop 0
  buffer_load_dwordx4 v62, s[32:35], 0 offen lds
  s_add_u32 m0, s76, 96256
  s_nop 0
  buffer_load_dwordx4 v63, s[32:35], 0 offen lds
  s_waitcnt vmcnt(13)
  s_barrier
  s_add_u32 m0, s76, 98304
  s_nop 0
  buffer_load_dwordx4 v64, s[32:35], 0 offen lds
  s_add_u32 m0, s76, 100352
  s_nop 0
  buffer_load_dwordx4 v65, s[32:35], 0 offen lds
  v_add_u32_dpp v56, v19, v2 row_newbcast:0 row_mask:0xf bank_mask:0x3
  v_add_u32_dpp v57, v23, v2 row_newbcast:0 row_mask:0xf bank_mask:0x3
  v_add_u32_dpp v58, v27, v2 row_newbcast:0 row_mask:0xf bank_mask:0x3
  v_add_u32_dpp v59, v31, v2 row_newbcast:0 row_mask:0xf bank_mask:0x3
  v_add_u32_dpp v60, v35, v2 row_newbcast:0 row_mask:0xf bank_mask:0x3
  v_add_u32_dpp v61, v39, v2 row_newbcast:0 row_mask:0xf bank_mask:0x3
  v_add_u32_dpp v62, v43, v2 row_newbcast:0 row_mask:0xf bank_mask:0x3
  v_add_u32_dpp v63, v47, v2 row_newbcast:0 row_mask:0xf bank_mask:0x3
  v_add_u32_dpp v64, v51, v2 row_newbcast:0 row_mask:0xf bank_mask:0x3
  v_add_u32_dpp v65, v55, v2 row_newbcast:0 row_mask:0xf bank_mask:0x3
  v_add_u32_dpp v56, v17, v2 row_newbcast:7 row_mask:0xf bank_mask:0xc
  v_add_u32_dpp v57, v21, v2 row_newbcast:7 row_mask:0xf bank_mask:0xc
  v_add_u32_dpp v58, v25, v2 row_newbcast:7 row_mask:0xf bank_mask:0xc
  v_add_u32_dpp v59, v29, v2 row_newbcast:7 row_mask:0xf bank_mask:0xc
  v_add_u32_dpp v60, v33, v2 row_newbcast:7 row_mask:0xf bank_mask:0xc
  v_add_u32_dpp v61, v37, v2 row_newbcast:7 row_mask:0xf bank_mask:0xc
  v_add_u32_dpp v62, v41, v2 row_newbcast:7 row_mask:0xf bank_mask:0xc
  v_add_u32_dpp v63, v45, v2 row_newbcast:7 row_mask:0xf bank_mask:0xc
  v_add_u32_dpp v64, v49, v2 row_newbcast:7 row_mask:0xf bank_mask:0xc
  v_add_u32_dpp v65, v53, v2 row_newbcast:7 row_mask:0xf bank_mask:0xc
  s_setprio 0
  s_branch L_ld_in
L_cmp:
  s_and_b32 s68, s3, 1
  s_lshr_b32 s69, s3, 1
  v_bfe_u32 v117, v0, 2, 2
  v_lshl_add_u32 v118, v116, 3, v117
  v_lshlrev_b32 v118, 8, v118
  v_bfe_u32 v117, v0, 2, 3
  s_lshl_b32 s70, s69, 2
  v_xor_b32 v117, s70, v117
  v_lshl_add_u32 v118, v117, 5, v118
  v_and_b32 v117, 3, v0
  v_lshl_add_u32 v118, v117, 3, v118
  v_add_u32 v1, 131072, v118
  v_xor_b32 v2, 32, v1
  v_xor_b32 v3, 64, v1
  v_xor_b32 v4, 96, v1
  s_lshl_b32 s70, s69, 7
  s_add_u32 s70, s70, 122880
  v_lshlrev_b32 v118, 3, v116
  v_add_u32 v9, s70, v118
  v_and_b32 v118, 15, v0
  v_lshlrev_b32 v118, 7, v118
  v_bfe_u32 v117, v0, 1, 3
  v_xor_b32 v117, v117, v116
  v_lshl_add_u32 v118, v117, 4, v118
  s_mul_i32 s70, s68, 20480
  v_add_u32 v5, s70, v118
  v_xor_b32 v7, 64, v5
  v_add_u32 v6, 81920, v5
  v_add_u32 v8, 81920, v7
  s_mul_i32 s70, s3, 640
  s_add_u32 s70, s70, 123392
  v_and_b32 v118, 15, v0
  v_lshlrev_b32 v118, 2, v118
  v_add_u32 v118, s70, v118
  v_lshrrev_b32 v117, 5, v0
  v_lshl_add_u32 v118, v117, 6, v118
  v_bfe_u32 v117, v0, 4, 1
  v_lshl_add_u32 v10, v117, 7, v118
  s_mov_b32 s72, 0
  v_mov_b32 v12, 0xc0135761
  v_mov_b32 v13, 0xc0135761
  v_mov_b32 v14, 0xbdd2d3e8
  v_mov_b32 v15, 0xbdd2d3e8
  s_waitcnt vmcnt(3)
  v_lshlrev_b32 v100, 7, v100
  buffer_load_dword v200, v100, s[32:35], 0 offen
  v_lshlrev_b32 v102, 7, v102
  buffer_load_dword v202, v102, s[32:35], 0 offen
  s_waitcnt vmcnt(4)
  v_lshlrev_b32_e64 v104, 7, v104
  buffer_load_dword v204, v104, s[32:35], 0 offen
  s_barrier
  ds_read_b64_tr_b16 v[16:17], v1 offset:0
  ds_read_b64_tr_b16 v[18:19], v1 offset:1024
  ds_read_b64_tr_b16 v[32:33], v1 offset:8192
  ds_read_b64_tr_b16 v[34:35], v1 offset:9216
  ds_read_b64_tr_b16 v[20:21], v2 offset:0
  ds_read_b64_tr_b16 v[22:23], v2 offset:1024
  ds_read_b64_tr_b16 v[36:37], v2 offset:8192
  ds_read_b64_tr_b16 v[38:39], v2 offset:9216
  ds_read_b64_tr_b16 v[24:25], v3 offset:0
  ds_read_b64_tr_b16 v[26:27], v3 offset:1024
  ds_read_b64_tr_b16 v[40:41], v3 offset:8192
  ds_read_b64_tr_b16 v[42:43], v3 offset:9216
  ds_read_b64_tr_b16 v[28:29], v4 offset:0
  ds_read_b64_tr_b16 v[30:31], v4 offset:1024
  ds_read_b64_tr_b16 v[44:45], v4 offset:8192
  ds_read_b64_tr_b16 v[46:47], v4 offset:9216
  s_waitcnt vmcnt(4)
  ds_read_b64 v[234:235], v9 offset:0
  ds_read_b64 v[238:239], v9 offset:32
  ds_read_b64 v[242:243], v9 offset:64
  ds_read_b64 v[246:247], v9 offset:96
  s_waitcnt lgkmcnt(3)
  v_lshlrev_b32 v232, 16, v234
  v_and_b32 v233, 0xffff0000, v234
  v_lshlrev_b32 v234, 16, v235
  v_and_b32 v235, 0xffff0000, v235
  s_waitcnt lgkmcnt(2)
  v_lshlrev_b32 v236, 16, v238
  v_and_b32 v237, 0xffff0000, v238
  v_lshlrev_b32 v238, 16, v239
  v_and_b32 v239, 0xffff0000, v239
  s_waitcnt lgkmcnt(1)
  v_lshlrev_b32 v240, 16, v242
  v_and_b32 v241, 0xffff0000, v242
  v_lshlrev_b32 v242, 16, v243
  v_and_b32 v243, 0xffff0000, v243
  s_waitcnt lgkmcnt(0)
  v_lshlrev_b32 v244, 16, v246
  v_and_b32 v245, 0xffff0000, v246
  v_lshlrev_b32 v246, 16, v247
  v_and_b32 v247, 0xffff0000, v247
  v_mov_b64 v[216:217], v[232:233]
  v_mov_b64 v[218:219], v[234:235]
  v_mov_b64 v[220:221], v[236:237]
  v_mov_b64 v[222:223], v[238:239]
  v_mov_b64 v[224:225], v[240:241]
  v_mov_b64 v[226:227], v[242:243]
  v_mov_b64 v[228:229], v[244:245]
  v_mov_b64 v[230:231], v[246:247]
  s_waitcnt lgkmcnt(0)
  s_setprio 1
  s_barrier
  ds_read_b128 v[48:51], v5 offset:0
  ds_read_b128 v[52:55], v7 offset:0
  ds_read_b128 v[56:59], v5 offset:2048
  ds_read_b128 v[60:63], v7 offset:2048
  ds_read_b128 v[64:67], v5 offset:4096
  ds_read_b128 v[68:71], v7 offset:4096
  ds_read_b128 v[72:75], v5 offset:6144
  ds_read_b128 v[76:79], v7 offset:6144
  s_waitcnt lgkmcnt(7)
  v_mfma_f32_16x16x32_bf16 v[88:91], v[16:19], v[48:51], v[232:235]
  s_waitcnt lgkmcnt(4)
  v_mfma_f32_16x16x32_bf16 v[88:91], v[32:35], v[52:55], v[88:91]
  v_mfma_f32_16x16x32_bf16 v[104:107], v[32:35], v[60:63], v[232:235]
  v_mfma_f32_16x16x32_bf16 v[104:107], v[16:19], v[56:59], v[104:107]
  v_mfma_f32_16x16x32_bf16 v[108:111], v[20:23], v[56:59], v[236:239]
  v_mfma_f32_16x16x32_bf16 v[108:111], v[36:39], v[60:63], v[108:111]
  v_mfma_f32_16x16x32_bf16 v[92:95], v[36:39], v[52:55], v[236:239]
  v_mfma_f32_16x16x32_bf16 v[92:95], v[20:23], v[48:51], v[92:95]
  v_mfma_f32_16x16x32_bf16 v[96:99], v[24:27], v[48:51], v[240:243]
  v_xor_b32 v1, 16384, v1
  v_mfma_f32_16x16x32_bf16 v[96:99], v[40:43], v[52:55], v[96:99]
  v_xor_b32 v2, 16384, v2
  v_mfma_f32_16x16x32_bf16 v[112:115], v[40:43], v[60:63], v[240:243]
  v_xor_b32 v3, 16384, v3
  v_mfma_f32_16x16x32_bf16 v[112:115], v[24:27], v[56:59], v[112:115]
  v_xor_b32 v4, 16384, v4
  v_mfma_f32_16x16x32_bf16 v[116:119], v[28:31], v[56:59], v[244:247]
  v_mfma_f32_16x16x32_bf16 v[116:119], v[44:47], v[60:63], v[116:119]
  v_mfma_f32_16x16x32_bf16 v[100:103], v[44:47], v[52:55], v[244:247]
  s_waitcnt lgkmcnt(2)
  v_mfma_f32_16x16x32_bf16 v[100:103], v[28:31], v[48:51], v[100:103]
  v_mfma_f32_16x16x32_bf16 v[120:123], v[16:19], v[64:67], v[232:235]
  s_barrier
  s_waitcnt lgkmcnt(0)
  v_mfma_f32_16x16x32_bf16 v[120:123], v[32:35], v[68:71], v[120:123]
  ds_read_b128 v[80:83], v5 offset:8192
  v_mfma_f32_16x16x32_bf16 v[136:139], v[32:35], v[76:79], v[232:235]
  s_nop 0
  ds_read_b128 v[84:87], v7 offset:8192
  v_mfma_f32_16x16x32_bf16 v[136:139], v[16:19], v[72:75], v[136:139]
  ds_read_b128 v[48:51], v5 offset:10240
  v_mfma_f32_16x16x32_bf16 v[140:143], v[20:23], v[72:75], v[236:239]
  ds_read_b128 v[52:55], v7 offset:10240
  v_mfma_f32_16x16x32_bf16 v[140:143], v[36:39], v[76:79], v[140:143]
  ds_read_b128 v[56:59], v5 offset:12288
  v_mfma_f32_16x16x32_bf16 v[124:127], v[36:39], v[68:71], v[236:239]
  ds_read_b128 v[60:63], v7 offset:12288
  v_mfma_f32_16x16x32_bf16 v[124:127], v[20:23], v[64:67], v[124:127]
  v_mfma_f32_16x16x32_bf16 v[128:131], v[24:27], v[64:67], v[240:243]
  v_mfma_f32_16x16x32_bf16 v[128:131], v[40:43], v[68:71], v[128:131]
  v_mfma_f32_16x16x32_bf16 v[144:147], v[40:43], v[76:79], v[240:243]
  v_mfma_f32_16x16x32_bf16 v[144:147], v[24:27], v[72:75], v[144:147]
  v_mfma_f32_16x16x32_bf16 v[148:151], v[28:31], v[72:75], v[244:247]
  ds_read_b128 v[72:75], v5 offset:16384
  v_mfma_f32_16x16x32_bf16 v[148:151], v[44:47], v[76:79], v[148:151]
  ds_read_b128 v[76:79], v7 offset:16384
  v_mfma_f32_16x16x32_bf16 v[132:135], v[44:47], v[68:71], v[244:247]
  ds_read_b128 v[68:71], v7 offset:14336
  s_waitcnt lgkmcnt(7)
  v_mfma_f32_16x16x32_bf16 v[132:135], v[28:31], v[64:67], v[132:135]
  ds_read_b128 v[64:67], v5 offset:14336
  v_mfma_f32_16x16x32_bf16 v[152:155], v[16:19], v[80:83], v[232:235]
  s_waitcnt lgkmcnt(6)
  v_mfma_f32_16x16x32_bf16 v[152:155], v[32:35], v[84:87], v[152:155]
  v_mfma_f32_16x16x32_bf16 v[168:171], v[32:35], v[52:55], v[232:235]
  v_mfma_f32_16x16x32_bf16 v[168:171], v[16:19], v[48:51], v[168:171]
  v_mfma_f32_16x16x32_bf16 v[172:175], v[20:23], v[48:51], v[236:239]
  v_mfma_f32_16x16x32_bf16 v[172:175], v[36:39], v[52:55], v[172:175]
  v_mfma_f32_16x16x32_bf16 v[156:159], v[36:39], v[84:87], v[236:239]
  v_mfma_f32_16x16x32_bf16 v[156:159], v[20:23], v[80:83], v[156:159]
  v_mfma_f32_16x16x32_bf16 v[160:163], v[24:27], v[80:83], v[240:243]
  v_mfma_f32_16x16x32_bf16 v[160:163], v[40:43], v[84:87], v[160:163]
  v_mfma_f32_16x16x32_bf16 v[176:179], v[40:43], v[52:55], v[240:243]
  v_mfma_f32_16x16x32_bf16 v[176:179], v[24:27], v[48:51], v[176:179]
  v_mfma_f32_16x16x32_bf16 v[180:183], v[28:31], v[48:51], v[244:247]
  v_mfma_f32_16x16x32_bf16 v[180:183], v[44:47], v[52:55], v[180:183]
  v_mfma_f32_16x16x32_bf16 v[164:167], v[44:47], v[84:87], v[244:247]
  ds_read_b128 v[84:87], v7 offset:18432
  s_waitcnt lgkmcnt(5)
  v_mfma_f32_16x16x32_bf16 v[164:167], v[28:31], v[80:83], v[164:167]
  s_nop 0
  ds_read_b128 v[80:83], v5 offset:18432
  v_mfma_f32_16x16x32_bf16 v[184:187], v[16:19], v[56:59], v[232:235]
  s_waitcnt lgkmcnt(2)
  v_mfma_f32_16x16x32_bf16 v[184:187], v[32:35], v[60:63], v[184:187]
  s_waitcnt vmcnt(1)
  v_mfma_f32_16x16x32_bf16 v[200:203], v[32:35], v[68:71], v[232:235]
  v_mfma_f32_16x16x32_bf16 v[200:203], v[16:19], v[64:67], v[200:203]
  s_waitcnt vmcnt(0)
  v_mfma_f32_16x16x32_bf16 v[204:207], v[20:23], v[64:67], v[236:239]
  s_nop 0
  v_mfma_f32_16x16x32_bf16 v[204:207], v[36:39], v[68:71], v[204:207]
  s_waitcnt lgkmcnt(0)
  s_barrier
  v_mfma_f32_16x16x32_bf16 v[188:191], v[36:39], v[60:63], v[236:239]
  ds_read_b128 v[48:51], v5 offset:40960
  v_mfma_f32_16x16x32_bf16 v[188:191], v[20:23], v[56:59], v[188:191]
  ds_read_b128 v[52:55], v7 offset:40960
  v_mfma_f32_16x16x32_bf16 v[192:195], v[24:27], v[56:59], v[240:243]
  v_mfma_f32_16x16x32_bf16 v[192:195], v[40:43], v[60:63], v[192:195]
  v_mfma_f32_16x16x32_bf16 v[208:211], v[40:43], v[68:71], v[240:243]
  v_mfma_f32_16x16x32_bf16 v[208:211], v[24:27], v[64:67], v[208:211]
  v_mfma_f32_16x16x32_bf16 v[212:215], v[28:31], v[64:67], v[244:247]
  ds_read_b128 v[64:67], v5 offset:45056
  v_mfma_f32_16x16x32_bf16 v[212:215], v[44:47], v[68:71], v[212:215]
  ds_read_b128 v[68:71], v7 offset:45056
  v_mfma_f32_16x16x32_bf16 v[196:199], v[44:47], v[60:63], v[244:247]
  ds_read_b128 v[60:63], v7 offset:43008
  v_mfma_f32_16x16x32_bf16 v[196:199], v[28:31], v[56:59], v[196:199]
  ds_read_b128 v[56:59], v5 offset:43008
  v_mfma_f32_16x16x32_bf16 v[216:219], v[32:35], v[76:79], v[216:219]
  v_mfma_f32_16x16x32_bf16 v[216:219], v[16:19], v[72:75], v[216:219]
  v_mfma_f32_16x16x32_bf16 v[232:235], v[16:19], v[80:83], v[232:235]
  ds_read_b64_tr_b16 v[16:17], v1 offset:0
  v_mfma_f32_16x16x32_bf16 v[232:235], v[32:35], v[84:87], v[232:235]
  ds_read_b64_tr_b16 v[18:19], v1 offset:1024
  v_mfma_f32_16x16x32_bf16 v[236:239], v[36:39], v[84:87], v[236:239]
  ds_read_b64_tr_b16 v[32:33], v1 offset:8192
  v_mfma_f32_16x16x32_bf16 v[236:239], v[20:23], v[80:83], v[236:239]
  ds_read_b64_tr_b16 v[34:35], v1 offset:9216
  v_mfma_f32_16x16x32_bf16 v[220:223], v[20:23], v[72:75], v[220:223]
  ds_read_b64_tr_b16 v[20:21], v2 offset:0
  v_mfma_f32_16x16x32_bf16 v[220:223], v[36:39], v[76:79], v[220:223]
  ds_read_b64_tr_b16 v[22:23], v2 offset:1024
  v_mfma_f32_16x16x32_bf16 v[224:227], v[40:43], v[76:79], v[224:227]
  ds_read_b64_tr_b16 v[36:37], v2 offset:8192
  v_mfma_f32_16x16x32_bf16 v[224:227], v[24:27], v[72:75], v[224:227]
  ds_read_b64_tr_b16 v[38:39], v2 offset:9216
  v_mfma_f32_16x16x32_bf16 v[240:243], v[24:27], v[80:83], v[240:243]
  ds_read_b64_tr_b16 v[24:25], v3 offset:0
  v_mfma_f32_16x16x32_bf16 v[240:243], v[40:43], v[84:87], v[240:243]
  ds_read_b64_tr_b16 v[26:27], v3 offset:1024
  v_mfma_f32_16x16x32_bf16 v[244:247], v[44:47], v[84:87], v[244:247]
  ds_read_b64_tr_b16 v[40:41], v3 offset:8192
  v_mfma_f32_16x16x32_bf16 v[244:247], v[28:31], v[80:83], v[244:247]
  s_nop 0
  ds_read_b64_tr_b16 v[42:43], v3 offset:9216
  v_mfma_f32_16x16x32_bf16 v[228:231], v[28:31], v[72:75], v[228:231]
  ds_read_b64_tr_b16 v[28:29], v4 offset:0
  s_waitcnt lgkmcnt(9)
  v_mfma_f32_16x16x32_bf16 v[228:231], v[44:47], v[76:79], v[228:231]
  ds_read_b64_tr_b16 v[30:31], v4 offset:1024
L_dnn_loop0:
  v_mfma_f32_16x16x32_bf16 v[88:91], v[16:19], v[48:51], v[88:91]
  ds_read_b64_tr_b16 v[44:45], v4 offset:8192
  v_mfma_f32_16x16x32_bf16 v[88:91], v[32:35], v[52:55], v[88:91]
  s_nop 0
  ds_read_b64_tr_b16 v[46:47], v4 offset:9216
  v_mfma_f32_16x16x32_bf16 v[104:107], v[32:35], v[60:63], v[104:107]
  ds_read_b128 v[72:75], v5 offset:47104
  s_waitcnt lgkmcnt(9)
  v_mfma_f32_16x16x32_bf16 v[104:107], v[16:19], v[56:59], v[104:107]
  ds_read_b128 v[76:79], v7 offset:47104
  v_mfma_f32_16x16x32_bf16 v[108:111], v[20:23], v[56:59], v[108:111]
  ds_read_b128 v[80:83], v5 offset:49152
  v_mfma_f32_16x16x32_bf16 v[108:111], v[36:39], v[60:63], v[108:111]
  ds_read_b128 v[84:87], v7 offset:49152
  v_mfma_f32_16x16x32_bf16 v[92:95], v[36:39], v[52:55], v[92:95]
  s_nop 0
  s_waitcnt lgkmcnt(8)
  v_mfma_f32_16x16x32_bf16 v[92:95], v[20:23], v[48:51], v[92:95]
  v_mfma_f32_16x16x32_bf16 v[96:99], v[24:27], v[48:51], v[96:99]
  v_xor_b32 v1, 16384, v1
  v_mfma_f32_16x16x32_bf16 v[96:99], v[40:43], v[52:55], v[96:99]
  v_xor_b32 v2, 16384, v2
  v_mfma_f32_16x16x32_bf16 v[112:115], v[40:43], v[60:63], v[112:115]
  s_nop 0
  v_xor_b32 v3, 16384, v3
  s_waitcnt lgkmcnt(4)
  v_mfma_f32_16x16x32_bf16 v[112:115], v[24:27], v[56:59], v[112:115]
  v_xor_b32 v4, 16384, v4
  v_mfma_f32_16x16x32_bf16 v[116:119], v[28:31], v[56:59], v[116:119]
  ds_read_b128 v[56:59], v5 offset:53248
  v_mfma_f32_16x16x32_bf16 v[116:119], v[44:47], v[60:63], v[116:119]
  ds_read_b128 v[60:63], v7 offset:53248
  v_mfma_f32_16x16x32_bf16 v[100:103], v[44:47], v[52:55], v[100:103]
  ds_read_b128 v[52:55], v7 offset:51200
  v_mfma_f32_16x16x32_bf16 v[100:103], v[28:31], v[48:51], v[100:103]
  ds_read_b128 v[48:51], v5 offset:51200
  v_mfma_f32_16x16x32_bf16 v[120:123], v[16:19], v[64:67], v[120:123]
  s_waitcnt lgkmcnt(6)
  v_mfma_f32_16x16x32_bf16 v[120:123], v[32:35], v[68:71], v[120:123]
  v_mfma_f32_16x16x32_bf16 v[136:139], v[32:35], v[76:79], v[136:139]
  v_mfma_f32_16x16x32_bf16 v[136:139], v[16:19], v[72:75], v[136:139]
  v_mfma_f32_16x16x32_bf16 v[140:143], v[20:23], v[72:75], v[140:143]
  s_nop 0
  v_mfma_f32_16x16x32_bf16 v[140:143], v[36:39], v[76:79], v[140:143]
  v_mfma_f32_16x16x32_bf16 v[124:127], v[36:39], v[68:71], v[124:127]
  v_mfma_f32_16x16x32_bf16 v[124:127], v[20:23], v[64:67], v[124:127]
  v_mfma_f32_16x16x32_bf16 v[128:131], v[24:27], v[64:67], v[128:131]
  v_mfma_f32_16x16x32_bf16 v[128:131], v[40:43], v[68:71], v[128:131]
  v_mfma_f32_16x16x32_bf16 v[144:147], v[40:43], v[76:79], v[144:147]
  v_mfma_f32_16x16x32_bf16 v[144:147], v[24:27], v[72:75], v[144:147]
  v_mfma_f32_16x16x32_bf16 v[148:151], v[28:31], v[72:75], v[148:151]
  ds_read_b128 v[72:75], v5 offset:57344
  v_mfma_f32_16x16x32_bf16 v[148:151], v[44:47], v[76:79], v[148:151]
  ds_read_b128 v[76:79], v7 offset:57344
  v_mfma_f32_16x16x32_bf16 v[132:135], v[44:47], v[68:71], v[132:135]
  ds_read_b128 v[68:71], v7 offset:55296
  s_waitcnt lgkmcnt(7)
  v_mfma_f32_16x16x32_bf16 v[132:135], v[28:31], v[64:67], v[132:135]
  s_nop 0
  ds_read_b128 v[64:67], v5 offset:55296
  v_mfma_f32_16x16x32_bf16 v[152:155], v[16:19], v[80:83], v[152:155]
  s_waitcnt lgkmcnt(4)
  v_mfma_f32_16x16x32_bf16 v[152:155], v[32:35], v[84:87], v[152:155]
  v_mfma_f32_16x16x32_bf16 v[168:171], v[32:35], v[52:55], v[168:171]
  v_mfma_f32_16x16x32_bf16 v[168:171], v[16:19], v[48:51], v[168:171]
  v_mfma_f32_16x16x32_bf16 v[172:175], v[20:23], v[48:51], v[172:175]
  v_mfma_f32_16x16x32_bf16 v[172:175], v[36:39], v[52:55], v[172:175]
  v_mfma_f32_16x16x32_bf16 v[156:159], v[36:39], v[84:87], v[156:159]
  s_nop 0
  v_mfma_f32_16x16x32_bf16 v[156:159], v[20:23], v[80:83], v[156:159]
  v_mfma_f32_16x16x32_bf16 v[160:163], v[24:27], v[80:83], v[160:163]
  v_mfma_f32_16x16x32_bf16 v[160:163], v[40:43], v[84:87], v[160:163]
  v_mfma_f32_16x16x32_bf16 v[176:179], v[40:43], v[52:55], v[176:179]
  v_mfma_f32_16x16x32_bf16 v[176:179], v[24:27], v[48:51], v[176:179]
  v_mfma_f32_16x16x32_bf16 v[180:183], v[28:31], v[48:51], v[180:183]
  v_mfma_f32_16x16x32_bf16 v[180:183], v[44:47], v[52:55], v[180:183]
  v_mfma_f32_16x16x32_bf16 v[164:167], v[44:47], v[84:87], v[164:167]
  ds_read_b128 v[84:87], v7 offset:59392
  v_mfma_f32_16x16x32_bf16 v[164:167], v[28:31], v[80:83], v[164:167]
  ds_read_b128 v[80:83], v5 offset:59392
  v_mfma_f32_16x16x32_bf16 v[184:187], v[16:19], v[56:59], v[184:187]
  s_waitcnt lgkmcnt(2)
  v_mfma_f32_16x16x32_bf16 v[184:187], v[32:35], v[60:63], v[184:187]
  v_mfma_f32_16x16x32_bf16 v[200:203], v[32:35], v[68:71], v[200:203]
  v_mfma_f32_16x16x32_bf16 v[200:203], v[16:19], v[64:67], v[200:203]
  s_nop 0
  v_mfma_f32_16x16x32_bf16 v[204:207], v[20:23], v[64:67], v[204:207]
  v_mfma_f32_16x16x32_bf16 v[204:207], v[36:39], v[68:71], v[204:207]
  s_waitcnt lgkmcnt(0)
  s_barrier
  v_mfma_f32_16x16x32_bf16 v[188:191], v[36:39], v[60:63], v[188:191]
  ds_read_b128 v[48:51], v6 offset:0
  v_mfma_f32_16x16x32_bf16 v[188:191], v[20:23], v[56:59], v[188:191]
  ds_read_b128 v[52:55], v8 offset:0
  v_mfma_f32_16x16x32_bf16 v[192:195], v[24:27], v[56:59], v[192:195]
  v_mfma_f32_16x16x32_bf16 v[192:195], v[40:43], v[60:63], v[192:195]
  v_mfma_f32_16x16x32_bf16 v[208:211], v[40:43], v[68:71], v[208:211]
  v_mfma_f32_16x16x32_bf16 v[208:211], v[24:27], v[64:67], v[208:211]
  v_mfma_f32_16x16x32_bf16 v[212:215], v[28:31], v[64:67], v[212:215]
  ds_read_b128 v[64:67], v6 offset:4096
  v_mfma_f32_16x16x32_bf16 v[212:215], v[44:47], v[68:71], v[212:215]
  ds_read_b128 v[68:71], v8 offset:4096
  v_mfma_f32_16x16x32_bf16 v[196:199], v[44:47], v[60:63], v[196:199]
  ds_read_b128 v[60:63], v8 offset:2048
  v_mfma_f32_16x16x32_bf16 v[196:199], v[28:31], v[56:59], v[196:199]
  ds_read_b128 v[56:59], v6 offset:2048
  v_mfma_f32_16x16x32_bf16 v[216:219], v[32:35], v[76:79], v[216:219]
  v_mfma_f32_16x16x32_bf16 v[216:219], v[16:19], v[72:75], v[216:219]
  v_mfma_f32_16x16x32_bf16 v[232:235], v[16:19], v[80:83], v[232:235]
  ds_read_b64_tr_b16 v[16:17], v1 offset:0
  v_mfma_f32_16x16x32_bf16 v[232:235], v[32:35], v[84:87], v[232:235]
  ds_read_b64_tr_b16 v[18:19], v1 offset:1024
  v_mfma_f32_16x16x32_bf16 v[236:239], v[36:39], v[84:87], v[236:239]
  ds_read_b64_tr_b16 v[32:33], v1 offset:8192
  v_mfma_f32_16x16x32_bf16 v[236:239], v[20:23], v[80:83], v[236:239]
  ds_read_b64_tr_b16 v[34:35], v1 offset:9216
  v_mfma_f32_16x16x32_bf16 v[220:223], v[20:23], v[72:75], v[220:223]
  ds_read_b64_tr_b16 v[20:21], v2 offset:0
  v_mfma_f32_16x16x32_bf16 v[220:223], v[36:39], v[76:79], v[220:223]
  ds_read_b64_tr_b16 v[22:23], v2 offset:1024
  v_mfma_f32_16x16x32_bf16 v[224:227], v[40:43], v[76:79], v[224:227]
  ds_read_b64_tr_b16 v[36:37], v2 offset:8192
  v_mfma_f32_16x16x32_bf16 v[224:227], v[24:27], v[72:75], v[224:227]
  ds_read_b64_tr_b16 v[38:39], v2 offset:9216
  v_mfma_f32_16x16x32_bf16 v[240:243], v[24:27], v[80:83], v[240:243]
  ds_read_b64_tr_b16 v[24:25], v3 offset:0
  v_mfma_f32_16x16x32_bf16 v[240:243], v[40:43], v[84:87], v[240:243]
  ds_read_b64_tr_b16 v[26:27], v3 offset:1024
  v_mfma_f32_16x16x32_bf16 v[244:247], v[44:47], v[84:87], v[244:247]
  ds_read_b64_tr_b16 v[40:41], v3 offset:8192
  v_mfma_f32_16x16x32_bf16 v[244:247], v[28:31], v[80:83], v[244:247]
  s_nop 0
  ds_read_b64_tr_b16 v[42:43], v3 offset:9216
  v_mfma_f32_16x16x32_bf16 v[228:231], v[28:31], v[72:75], v[228:231]
  ds_read_b64_tr_b16 v[28:29], v4 offset:0
  s_waitcnt lgkmcnt(9)
  v_mfma_f32_16x16x32_bf16 v[228:231], v[44:47], v[76:79], v[228:231]
  ds_read_b64_tr_b16 v[30:31], v4 offset:1024
  v_mfma_f32_16x16x32_bf16 v[88:91], v[16:19], v[48:51], v[88:91]
  ds_read_b64_tr_b16 v[44:45], v4 offset:8192
  v_mfma_f32_16x16x32_bf16 v[88:91], v[32:35], v[52:55], v[88:91]
  ds_read_b64_tr_b16 v[46:47], v4 offset:9216
  v_mfma_f32_16x16x32_bf16 v[104:107], v[32:35], v[60:63], v[104:107]
  ds_read_b128 v[72:75], v6 offset:6144
  s_waitcnt lgkmcnt(9)
  v_mfma_f32_16x16x32_bf16 v[104:107], v[16:19], v[56:59], v[104:107]
  ds_read_b128 v[76:79], v8 offset:6144
  v_mfma_f32_16x16x32_bf16 v[108:111], v[20:23], v[56:59], v[108:111]
  ds_read_b128 v[80:83], v6 offset:8192
  v_mfma_f32_16x16x32_bf16 v[108:111], v[36:39], v[60:63], v[108:111]
  ds_read_b128 v[84:87], v8 offset:8192
  v_mfma_f32_16x16x32_bf16 v[92:95], v[36:39], v[52:55], v[92:95]
  s_waitcnt lgkmcnt(8)
  v_mfma_f32_16x16x32_bf16 v[92:95], v[20:23], v[48:51], v[92:95]
  v_mfma_f32_16x16x32_bf16 v[96:99], v[24:27], v[48:51], v[96:99]
  v_xor_b32 v1, 16384, v1
  v_mfma_f32_16x16x32_bf16 v[96:99], v[40:43], v[52:55], v[96:99]
  v_xor_b32 v2, 16384, v2
  v_mfma_f32_16x16x32_bf16 v[112:115], v[40:43], v[60:63], v[112:115]
  s_nop 0
  v_xor_b32 v3, 16384, v3
  s_waitcnt lgkmcnt(4)
  v_mfma_f32_16x16x32_bf16 v[112:115], v[24:27], v[56:59], v[112:115]
  v_xor_b32 v4, 16384, v4
  v_mfma_f32_16x16x32_bf16 v[116:119], v[28:31], v[56:59], v[116:119]
  ds_read_b128 v[56:59], v6 offset:12288
  v_mfma_f32_16x16x32_bf16 v[116:119], v[44:47], v[60:63], v[116:119]
  ds_read_b128 v[60:63], v8 offset:12288
  v_mfma_f32_16x16x32_bf16 v[100:103], v[44:47], v[52:55], v[100:103]
  ds_read_b128 v[52:55], v8 offset:10240
  v_mfma_f32_16x16x32_bf16 v[100:103], v[28:31], v[48:51], v[100:103]
  ds_read_b128 v[48:51], v6 offset:10240
  v_mfma_f32_16x16x32_bf16 v[120:123], v[16:19], v[64:67], v[120:123]
  s_waitcnt lgkmcnt(6)
  v_mfma_f32_16x16x32_bf16 v[120:123], v[32:35], v[68:71], v[120:123]
  v_mfma_f32_16x16x32_bf16 v[136:139], v[32:35], v[76:79], v[136:139]
  v_mfma_f32_16x16x32_bf16 v[136:139], v[16:19], v[72:75], v[136:139]
  v_mfma_f32_16x16x32_bf16 v[140:143], v[20:23], v[72:75], v[140:143]
  s_nop 0
  v_mfma_f32_16x16x32_bf16 v[140:143], v[36:39], v[76:79], v[140:143]
  v_mfma_f32_16x16x32_bf16 v[124:127], v[36:39], v[68:71], v[124:127]
  v_mfma_f32_16x16x32_bf16 v[124:127], v[20:23], v[64:67], v[124:127]
  v_mfma_f32_16x16x32_bf16 v[128:131], v[24:27], v[64:67], v[128:131]
  v_mfma_f32_16x16x32_bf16 v[128:131], v[40:43], v[68:71], v[128:131]
  v_mfma_f32_16x16x32_bf16 v[144:147], v[40:43], v[76:79], v[144:147]
  v_mfma_f32_16x16x32_bf16 v[144:147], v[24:27], v[72:75], v[144:147]
  v_mfma_f32_16x16x32_bf16 v[148:151], v[28:31], v[72:75], v[148:151]
  ds_read_b128 v[72:75], v6 offset:16384
  v_mfma_f32_16x16x32_bf16 v[148:151], v[44:47], v[76:79], v[148:151]
  ds_read_b128 v[76:79], v8 offset:16384
  v_mfma_f32_16x16x32_bf16 v[132:135], v[44:47], v[68:71], v[132:135]
  ds_read_b128 v[68:71], v8 offset:14336
  s_waitcnt lgkmcnt(7)
  v_mfma_f32_16x16x32_bf16 v[132:135], v[28:31], v[64:67], v[132:135]
  s_nop 0
  ds_read_b128 v[64:67], v6 offset:14336
  v_mfma_f32_16x16x32_bf16 v[152:155], v[16:19], v[80:83], v[152:155]
  s_waitcnt lgkmcnt(4)
  v_mfma_f32_16x16x32_bf16 v[152:155], v[32:35], v[84:87], v[152:155]
  v_mfma_f32_16x16x32_bf16 v[168:171], v[32:35], v[52:55], v[168:171]
  v_mfma_f32_16x16x32_bf16 v[168:171], v[16:19], v[48:51], v[168:171]
  v_mfma_f32_16x16x32_bf16 v[172:175], v[20:23], v[48:51], v[172:175]
  v_mfma_f32_16x16x32_bf16 v[172:175], v[36:39], v[52:55], v[172:175]
  v_mfma_f32_16x16x32_bf16 v[156:159], v[36:39], v[84:87], v[156:159]
  s_nop 0
  v_mfma_f32_16x16x32_bf16 v[156:159], v[20:23], v[80:83], v[156:159]
  v_mfma_f32_16x16x32_bf16 v[160:163], v[24:27], v[80:83], v[160:163]
  v_mfma_f32_16x16x32_bf16 v[160:163], v[40:43], v[84:87], v[160:163]
  v_mfma_f32_16x16x32_bf16 v[176:179], v[40:43], v[52:55], v[176:179]
  v_mfma_f32_16x16x32_bf16 v[176:179], v[24:27], v[48:51], v[176:179]
  v_mfma_f32_16x16x32_bf16 v[180:183], v[28:31], v[48:51], v[180:183]
  v_mfma_f32_16x16x32_bf16 v[180:183], v[44:47], v[52:55], v[180:183]
  v_mfma_f32_16x16x32_bf16 v[164:167], v[44:47], v[84:87], v[164:167]
  ds_read_b128 v[84:87], v8 offset:18432
  v_mfma_f32_16x16x32_bf16 v[164:167], v[28:31], v[80:83], v[164:167]
  ds_read_b128 v[80:83], v6 offset:18432
  v_mfma_f32_16x16x32_bf16 v[184:187], v[16:19], v[56:59], v[184:187]
  s_waitcnt lgkmcnt(2)
  v_mfma_f32_16x16x32_bf16 v[184:187], v[32:35], v[60:63], v[184:187]
  v_mfma_f32_16x16x32_bf16 v[200:203], v[32:35], v[68:71], v[200:203]
  v_mfma_f32_16x16x32_bf16 v[200:203], v[16:19], v[64:67], v[200:203]
  s_nop 0
  v_mfma_f32_16x16x32_bf16 v[204:207], v[20:23], v[64:67], v[204:207]
  v_mfma_f32_16x16x32_bf16 v[204:207], v[36:39], v[68:71], v[204:207]
  s_waitcnt lgkmcnt(0)
  s_barrier
  v_mfma_f32_16x16x32_bf16 v[188:191], v[36:39], v[60:63], v[188:191]
  ds_read_b128 v[48:51], v5 offset:0
  v_mfma_f32_16x16x32_bf16 v[188:191], v[20:23], v[56:59], v[188:191]
  ds_read_b128 v[52:55], v7 offset:0
  v_mfma_f32_16x16x32_bf16 v[192:195], v[24:27], v[56:59], v[192:195]
  v_mfma_f32_16x16x32_bf16 v[192:195], v[40:43], v[60:63], v[192:195]
  v_mfma_f32_16x16x32_bf16 v[208:211], v[40:43], v[68:71], v[208:211]
  v_mfma_f32_16x16x32_bf16 v[208:211], v[24:27], v[64:67], v[208:211]
  v_mfma_f32_16x16x32_bf16 v[212:215], v[28:31], v[64:67], v[212:215]
  ds_read_b128 v[64:67], v5 offset:4096
  v_mfma_f32_16x16x32_bf16 v[212:215], v[44:47], v[68:71], v[212:215]
  ds_read_b128 v[68:71], v7 offset:4096
  v_mfma_f32_16x16x32_bf16 v[196:199], v[44:47], v[60:63], v[196:199]
  ds_read_b128 v[60:63], v7 offset:2048
  v_mfma_f32_16x16x32_bf16 v[196:199], v[28:31], v[56:59], v[196:199]
  ds_read_b128 v[56:59], v5 offset:2048
  v_mfma_f32_16x16x32_bf16 v[216:219], v[32:35], v[76:79], v[216:219]
  v_mfma_f32_16x16x32_bf16 v[216:219], v[16:19], v[72:75], v[216:219]
  v_mfma_f32_16x16x32_bf16 v[232:235], v[16:19], v[80:83], v[232:235]
  ds_read_b64_tr_b16 v[16:17], v1 offset:0
  v_mfma_f32_16x16x32_bf16 v[232:235], v[32:35], v[84:87], v[232:235]
  ds_read_b64_tr_b16 v[18:19], v1 offset:1024
  v_mfma_f32_16x16x32_bf16 v[236:239], v[36:39], v[84:87], v[236:239]
  ds_read_b64_tr_b16 v[32:33], v1 offset:8192
  v_mfma_f32_16x16x32_bf16 v[236:239], v[20:23], v[80:83], v[236:239]
  ds_read_b64_tr_b16 v[34:35], v1 offset:9216
  v_mfma_f32_16x16x32_bf16 v[220:223], v[20:23], v[72:75], v[220:223]
  ds_read_b64_tr_b16 v[20:21], v2 offset:0
  v_mfma_f32_16x16x32_bf16 v[220:223], v[36:39], v[76:79], v[220:223]
  ds_read_b64_tr_b16 v[22:23], v2 offset:1024
  v_mfma_f32_16x16x32_bf16 v[224:227], v[40:43], v[76:79], v[224:227]
  ds_read_b64_tr_b16 v[36:37], v2 offset:8192
  v_mfma_f32_16x16x32_bf16 v[224:227], v[24:27], v[72:75], v[224:227]
  ds_read_b64_tr_b16 v[38:39], v2 offset:9216
  v_mfma_f32_16x16x32_bf16 v[240:243], v[24:27], v[80:83], v[240:243]
  ds_read_b64_tr_b16 v[24:25], v3 offset:0
  v_mfma_f32_16x16x32_bf16 v[240:243], v[40:43], v[84:87], v[240:243]
  ds_read_b64_tr_b16 v[26:27], v3 offset:1024
  v_mfma_f32_16x16x32_bf16 v[244:247], v[44:47], v[84:87], v[244:247]
  ds_read_b64_tr_b16 v[40:41], v3 offset:8192
  v_mfma_f32_16x16x32_bf16 v[244:247], v[28:31], v[80:83], v[244:247]
  s_nop 0
  ds_read_b64_tr_b16 v[42:43], v3 offset:9216
  v_mfma_f32_16x16x32_bf16 v[228:231], v[28:31], v[72:75], v[228:231]
  ds_read_b64_tr_b16 v[28:29], v4 offset:0
  s_waitcnt lgkmcnt(9)
  v_mfma_f32_16x16x32_bf16 v[228:231], v[44:47], v[76:79], v[228:231]
  ds_read_b64_tr_b16 v[30:31], v4 offset:1024
  v_mfma_f32_16x16x32_bf16 v[88:91], v[16:19], v[48:51], v[88:91]
  ds_read_b64_tr_b16 v[44:45], v4 offset:8192
  v_mfma_f32_16x16x32_bf16 v[88:91], v[32:35], v[52:55], v[88:91]
  ds_read_b64_tr_b16 v[46:47], v4 offset:9216
  v_mfma_f32_16x16x32_bf16 v[104:107], v[32:35], v[60:63], v[104:107]
  ds_read_b128 v[72:75], v5 offset:6144
  s_waitcnt lgkmcnt(9)
  v_mfma_f32_16x16x32_bf16 v[104:107], v[16:19], v[56:59], v[104:107]
  ds_read_b128 v[76:79], v7 offset:6144
  v_mfma_f32_16x16x32_bf16 v[108:111], v[20:23], v[56:59], v[108:111]
  ds_read_b128 v[80:83], v5 offset:8192
  v_mfma_f32_16x16x32_bf16 v[108:111], v[36:39], v[60:63], v[108:111]
  ds_read_b128 v[84:87], v7 offset:8192
  v_mfma_f32_16x16x32_bf16 v[92:95], v[36:39], v[52:55], v[92:95]
  s_waitcnt lgkmcnt(8)
  v_mfma_f32_16x16x32_bf16 v[92:95], v[20:23], v[48:51], v[92:95]
  v_mfma_f32_16x16x32_bf16 v[96:99], v[24:27], v[48:51], v[96:99]
  v_xor_b32 v1, 16384, v1
  v_mfma_f32_16x16x32_bf16 v[96:99], v[40:43], v[52:55], v[96:99]
  v_xor_b32 v2, 16384, v2
  v_mfma_f32_16x16x32_bf16 v[112:115], v[40:43], v[60:63], v[112:115]
  s_nop 0
  v_xor_b32 v3, 16384, v3
  s_waitcnt lgkmcnt(4)
  v_mfma_f32_16x16x32_bf16 v[112:115], v[24:27], v[56:59], v[112:115]
  v_xor_b32 v4, 16384, v4
  v_mfma_f32_16x16x32_bf16 v[116:119], v[28:31], v[56:59], v[116:119]
  ds_read_b128 v[56:59], v5 offset:12288
  v_mfma_f32_16x16x32_bf16 v[116:119], v[44:47], v[60:63], v[116:119]
  ds_read_b128 v[60:63], v7 offset:12288
  v_mfma_f32_16x16x32_bf16 v[100:103], v[44:47], v[52:55], v[100:103]
  ds_read_b128 v[52:55], v7 offset:10240
  v_mfma_f32_16x16x32_bf16 v[100:103], v[28:31], v[48:51], v[100:103]
  ds_read_b128 v[48:51], v5 offset:10240
  v_mfma_f32_16x16x32_bf16 v[120:123], v[16:19], v[64:67], v[120:123]
  s_waitcnt lgkmcnt(6)
  v_mfma_f32_16x16x32_bf16 v[120:123], v[32:35], v[68:71], v[120:123]
  v_mfma_f32_16x16x32_bf16 v[136:139], v[32:35], v[76:79], v[136:139]
  v_mfma_f32_16x16x32_bf16 v[136:139], v[16:19], v[72:75], v[136:139]
  v_mfma_f32_16x16x32_bf16 v[140:143], v[20:23], v[72:75], v[140:143]
  s_nop 0
  v_mfma_f32_16x16x32_bf16 v[140:143], v[36:39], v[76:79], v[140:143]
  v_mfma_f32_16x16x32_bf16 v[124:127], v[36:39], v[68:71], v[124:127]
  v_mfma_f32_16x16x32_bf16 v[124:127], v[20:23], v[64:67], v[124:127]
  v_mfma_f32_16x16x32_bf16 v[128:131], v[24:27], v[64:67], v[128:131]
  v_mfma_f32_16x16x32_bf16 v[128:131], v[40:43], v[68:71], v[128:131]
  v_mfma_f32_16x16x32_bf16 v[144:147], v[40:43], v[76:79], v[144:147]
  v_mfma_f32_16x16x32_bf16 v[144:147], v[24:27], v[72:75], v[144:147]
  v_mfma_f32_16x16x32_bf16 v[148:151], v[28:31], v[72:75], v[148:151]
  ds_read_b128 v[72:75], v5 offset:16384
  v_mfma_f32_16x16x32_bf16 v[148:151], v[44:47], v[76:79], v[148:151]
  ds_read_b128 v[76:79], v7 offset:16384
  v_mfma_f32_16x16x32_bf16 v[132:135], v[44:47], v[68:71], v[132:135]
  ds_read_b128 v[68:71], v7 offset:14336
  s_waitcnt lgkmcnt(7)
  v_mfma_f32_16x16x32_bf16 v[132:135], v[28:31], v[64:67], v[132:135]
  s_nop 0
  ds_read_b128 v[64:67], v5 offset:14336
  v_mfma_f32_16x16x32_bf16 v[152:155], v[16:19], v[80:83], v[152:155]
  s_waitcnt lgkmcnt(4)
  v_mfma_f32_16x16x32_bf16 v[152:155], v[32:35], v[84:87], v[152:155]
  v_mfma_f32_16x16x32_bf16 v[168:171], v[32:35], v[52:55], v[168:171]
  v_mfma_f32_16x16x32_bf16 v[168:171], v[16:19], v[48:51], v[168:171]
  v_mfma_f32_16x16x32_bf16 v[172:175], v[20:23], v[48:51], v[172:175]
  v_mfma_f32_16x16x32_bf16 v[172:175], v[36:39], v[52:55], v[172:175]
  v_mfma_f32_16x16x32_bf16 v[156:159], v[36:39], v[84:87], v[156:159]
  s_nop 0
  v_mfma_f32_16x16x32_bf16 v[156:159], v[20:23], v[80:83], v[156:159]
  v_mfma_f32_16x16x32_bf16 v[160:163], v[24:27], v[80:83], v[160:163]
  v_mfma_f32_16x16x32_bf16 v[160:163], v[40:43], v[84:87], v[160:163]
  v_mfma_f32_16x16x32_bf16 v[176:179], v[40:43], v[52:55], v[176:179]
  v_mfma_f32_16x16x32_bf16 v[176:179], v[24:27], v[48:51], v[176:179]
  v_mfma_f32_16x16x32_bf16 v[180:183], v[28:31], v[48:51], v[180:183]
  v_mfma_f32_16x16x32_bf16 v[180:183], v[44:47], v[52:55], v[180:183]
  v_mfma_f32_16x16x32_bf16 v[164:167], v[44:47], v[84:87], v[164:167]
  ds_read_b128 v[84:87], v7 offset:18432
  v_mfma_f32_16x16x32_bf16 v[164:167], v[28:31], v[80:83], v[164:167]
  ds_read_b128 v[80:83], v5 offset:18432
  v_mfma_f32_16x16x32_bf16 v[184:187], v[16:19], v[56:59], v[184:187]
  s_waitcnt lgkmcnt(2)
  s_add_u32 s72, s72, 1
  s_cmp_lt_u32 s72, 8
  v_mfma_f32_16x16x32_bf16 v[184:187], v[32:35], v[60:63], v[184:187]
  v_mfma_f32_16x16x32_bf16 v[200:203], v[32:35], v[68:71], v[200:203]
  s_nop 0
  v_mfma_f32_16x16x32_bf16 v[200:203], v[16:19], v[64:67], v[200:203]
  v_mfma_f32_16x16x32_bf16 v[204:207], v[20:23], v[64:67], v[204:207]
  v_mfma_f32_16x16x32_bf16 v[204:207], v[36:39], v[68:71], v[204:207]
  s_waitcnt lgkmcnt(0)
  s_barrier
  v_mfma_f32_16x16x32_bf16 v[188:191], v[36:39], v[60:63], v[188:191]
  ds_read_b128 v[48:51], v5 offset:40960
  v_mfma_f32_16x16x32_bf16 v[188:191], v[20:23], v[56:59], v[188:191]
  ds_read_b128 v[52:55], v7 offset:40960
  v_mfma_f32_16x16x32_bf16 v[192:195], v[24:27], v[56:59], v[192:195]
  v_mfma_f32_16x16x32_bf16 v[192:195], v[40:43], v[60:63], v[192:195]
  v_mfma_f32_16x16x32_bf16 v[208:211], v[40:43], v[68:71], v[208:211]
  v_mfma_f32_16x16x32_bf16 v[208:211], v[24:27], v[64:67], v[208:211]
  v_mfma_f32_16x16x32_bf16 v[212:215], v[28:31], v[64:67], v[212:215]
  ds_read_b128 v[64:67], v5 offset:45056
  v_mfma_f32_16x16x32_bf16 v[212:215], v[44:47], v[68:71], v[212:215]
  ds_read_b128 v[68:71], v7 offset:45056
  v_mfma_f32_16x16x32_bf16 v[196:199], v[44:47], v[60:63], v[196:199]
  ds_read_b128 v[60:63], v7 offset:43008
  v_mfma_f32_16x16x32_bf16 v[196:199], v[28:31], v[56:59], v[196:199]
  ds_read_b128 v[56:59], v5 offset:43008
  v_mfma_f32_16x16x32_bf16 v[216:219], v[32:35], v[76:79], v[216:219]
  v_mfma_f32_16x16x32_bf16 v[216:219], v[16:19], v[72:75], v[216:219]
  v_mfma_f32_16x16x32_bf16 v[232:235], v[16:19], v[80:83], v[232:235]
  ds_read_b64_tr_b16 v[16:17], v1 offset:0
  v_mfma_f32_16x16x32_bf16 v[232:235], v[32:35], v[84:87], v[232:235]
  ds_read_b64_tr_b16 v[18:19], v1 offset:1024
  v_mfma_f32_16x16x32_bf16 v[236:239], v[36:39], v[84:87], v[236:239]
  ds_read_b64_tr_b16 v[32:33], v1 offset:8192
  v_mfma_f32_16x16x32_bf16 v[236:239], v[20:23], v[80:83], v[236:239]
  ds_read_b64_tr_b16 v[34:35], v1 offset:9216
  v_mfma_f32_16x16x32_bf16 v[220:223], v[20:23], v[72:75], v[220:223]
  ds_read_b64_tr_b16 v[20:21], v2 offset:0
  v_mfma_f32_16x16x32_bf16 v[220:223], v[36:39], v[76:79], v[220:223]
  ds_read_b64_tr_b16 v[22:23], v2 offset:1024
  v_mfma_f32_16x16x32_bf16 v[224:227], v[40:43], v[76:79], v[224:227]
  ds_read_b64_tr_b16 v[36:37], v2 offset:8192
  v_mfma_f32_16x16x32_bf16 v[224:227], v[24:27], v[72:75], v[224:227]
  ds_read_b64_tr_b16 v[38:39], v2 offset:9216
  v_mfma_f32_16x16x32_bf16 v[240:243], v[24:27], v[80:83], v[240:243]
  ds_read_b64_tr_b16 v[24:25], v3 offset:0
  v_mfma_f32_16x16x32_bf16 v[240:243], v[40:43], v[84:87], v[240:243]
  ds_read_b64_tr_b16 v[26:27], v3 offset:1024
  v_mfma_f32_16x16x32_bf16 v[244:247], v[44:47], v[84:87], v[244:247]
  ds_read_b64_tr_b16 v[40:41], v3 offset:8192
  v_mfma_f32_16x16x32_bf16 v[244:247], v[28:31], v[80:83], v[244:247]
  ds_read_b64_tr_b16 v[42:43], v3 offset:9216
  v_mfma_f32_16x16x32_bf16 v[228:231], v[28:31], v[72:75], v[228:231]
  ds_read_b64_tr_b16 v[28:29], v4 offset:0
  s_waitcnt lgkmcnt(9)
  v_mfma_f32_16x16x32_bf16 v[228:231], v[44:47], v[76:79], v[228:231]
  ds_read_b64_tr_b16 v[30:31], v4 offset:1024
  s_cbranch_scc1 L_dnn_loop0
L_tail:
  v_mfma_f32_16x16x32_bf16 v[88:91], v[16:19], v[48:51], v[88:91]
  ds_read_b64_tr_b16 v[44:45], v4 offset:8192
  v_mfma_f32_16x16x32_bf16 v[88:91], v[32:35], v[52:55], v[88:91]
  ds_read_b64_tr_b16 v[46:47], v4 offset:9216
  v_mfma_f32_16x16x32_bf16 v[104:107], v[32:35], v[60:63], v[104:107]
  ds_read_b128 v[72:75], v5 offset:47104
  s_waitcnt lgkmcnt(9)
  v_mfma_f32_16x16x32_bf16 v[104:107], v[16:19], v[56:59], v[104:107]
  ds_read_b128 v[76:79], v7 offset:47104
  v_mfma_f32_16x16x32_bf16 v[108:111], v[20:23], v[56:59], v[108:111]
  ds_read_b128 v[80:83], v5 offset:49152
  v_mfma_f32_16x16x32_bf16 v[108:111], v[36:39], v[60:63], v[108:111]
  ds_read_b128 v[84:87], v7 offset:49152
  v_mul_f32 v11, v88, v88
  v_mfma_f32_16x16x32_bf16 v[92:95], v[36:39], v[52:55], v[92:95]
  s_waitcnt lgkmcnt(8)
  v_mul_f32 v248, v89, v89
  v_mul_f32 v249, v90, v90
  v_mfma_f32_16x16x32_bf16 v[92:95], v[20:23], v[48:51], v[92:95]
  v_mul_f32 v250, v91, v91
  v_fma_f32 v11, v11, v14, v12
  v_mfma_f32_16x16x32_bf16 v[96:99], v[24:27], v[48:51], v[96:99]
  v_fma_f32 v248, v248, v14, v12
  v_fma_f32 v249, v249, v14, v12
  v_mfma_f32_16x16x32_bf16 v[96:99], v[40:43], v[52:55], v[96:99]
  v_fma_f32 v250, v250, v14, v12
  v_mul_f32 v11, v11, v88
  v_mfma_f32_16x16x32_bf16 v[112:115], v[40:43], v[60:63], v[112:115]
  s_waitcnt lgkmcnt(4)
  v_mul_f32 v248, v248, v89
  v_mul_f32 v249, v249, v90
  v_mfma_f32_16x16x32_bf16 v[112:115], v[24:27], v[56:59], v[112:115]
  v_mul_f32_e64 v250, v250, v91
  v_mfma_f32_16x16x32_bf16 v[116:119], v[28:31], v[56:59], v[116:119]
  ds_read_b128 v[56:59], v5 offset:53248
  v_mfma_f32_16x16x32_bf16 v[116:119], v[44:47], v[60:63], v[116:119]
  ds_read_b128 v[60:63], v7 offset:53248
  v_mfma_f32_16x16x32_bf16 v[100:103], v[44:47], v[52:55], v[100:103]
  ds_read_b128 v[52:55], v7 offset:51200
  v_mfma_f32_16x16x32_bf16 v[100:103], v[28:31], v[48:51], v[100:103]
  ds_read_b128 v[48:51], v5 offset:51200
  v_mfma_f32_16x16x32_bf16 v[120:123], v[16:19], v[64:67], v[120:123]
  s_waitcnt lgkmcnt(6)
  v_exp_f32 v11, v11
  v_mfma_f32_16x16x32_bf16 v[120:123], v[32:35], v[68:71], v[120:123]
  v_exp_f32 v248, v248
  v_mfma_f32_16x16x32_bf16 v[136:139], v[32:35], v[76:79], v[136:139]
  v_exp_f32 v249, v249
  v_mfma_f32_16x16x32_bf16 v[136:139], v[16:19], v[72:75], v[136:139]
  v_exp_f32 v250, v250
  v_mfma_f32_16x16x32_bf16 v[140:143], v[20:23], v[72:75], v[140:143]
  v_add_f32 v11, 1.0, v11
  v_add_f32_e64 v248, 1.0, v248
  v_mfma_f32_16x16x32_bf16 v[140:143], v[36:39], v[76:79], v[140:143]
  v_add_f32 v249, 1.0, v249
  v_add_f32 v250, 1.0, v250
  v_mfma_f32_16x16x32_bf16 v[124:127], v[36:39], v[68:71], v[124:127]
  v_rcp_f32 v11, v11
  v_mfma_f32_16x16x32_bf16 v[124:127], v[20:23], v[64:67], v[124:127]
  v_rcp_f32 v248, v248
  v_mfma_f32_16x16x32_bf16 v[128:131], v[24:27], v[64:67], v[128:131]
  v_rcp_f32 v249, v249
  v_mfma_f32_16x16x32_bf16 v[128:131], v[40:43], v[68:71], v[128:131]
  v_rcp_f32 v250, v250
  v_mfma_f32_16x16x32_bf16 v[144:147], v[40:43], v[76:79], v[144:147]
  v_mul_f32 v88, v88, v11
  v_mul_f32 v89, v89, v248
  v_mfma_f32_16x16x32_bf16 v[144:147], v[24:27], v[72:75], v[144:147]
  v_mul_f32 v90, v90, v249
  v_mul_f32 v91, v91, v250
  v_mfma_f32_16x16x32_bf16 v[148:151], v[28:31], v[72:75], v[148:151]
  ds_read_b128 v[72:75], v5 offset:57344
  v_mul_f32_e64 v11, v92, v92
  v_mfma_f32_16x16x32_bf16 v[148:151], v[44:47], v[76:79], v[148:151]
  ds_read_b128 v[76:79], v7 offset:57344
  v_mul_f32 v248, v93, v93
  v_mfma_f32_16x16x32_bf16 v[132:135], v[44:47], v[68:71], v[132:135]
  ds_read_b128 v[68:71], v7 offset:55296
  s_waitcnt lgkmcnt(7)
  v_mul_f32 v249, v94, v94
  v_mfma_f32_16x16x32_bf16 v[132:135], v[28:31], v[64:67], v[132:135]
  ds_read_b128 v[64:67], v5 offset:55296
  v_mul_f32 v250, v95, v95
  v_mfma_f32_16x16x32_bf16 v[152:155], v[16:19], v[80:83], v[152:155]
  s_waitcnt lgkmcnt(4)
  v_fma_f32 v11, v11, v14, v12
  v_fma_f32 v248, v248, v14, v12
  v_mfma_f32_16x16x32_bf16 v[152:155], v[32:35], v[84:87], v[152:155]
  v_fma_f32 v249, v249, v14, v12
  v_fma_f32 v250, v250, v14, v12
  v_mfma_f32_16x16x32_bf16 v[168:171], v[32:35], v[52:55], v[168:171]
  v_mul_f32 v11, v11, v92
  v_mul_f32_e64 v248, v248, v93
  v_mfma_f32_16x16x32_bf16 v[168:171], v[16:19], v[48:51], v[168:171]
  v_mul_f32 v249, v249, v94
  v_mul_f32 v250, v250, v95
  v_mfma_f32_16x16x32_bf16 v[172:175], v[20:23], v[48:51], v[172:175]
  v_exp_f32 v11, v11
  v_mfma_f32_16x16x32_bf16 v[172:175], v[36:39], v[52:55], v[172:175]
  v_exp_f32 v248, v248
  v_mfma_f32_16x16x32_bf16 v[156:159], v[36:39], v[84:87], v[156:159]
  v_exp_f32 v249, v249
  v_mfma_f32_16x16x32_bf16 v[156:159], v[20:23], v[80:83], v[156:159]
  v_exp_f32 v250, v250
  v_mfma_f32_16x16x32_bf16 v[160:163], v[24:27], v[80:83], v[160:163]
  v_add_f32 v11, 1.0, v11
  v_add_f32 v248, 1.0, v248
  v_mfma_f32_16x16x32_bf16 v[160:163], v[40:43], v[84:87], v[160:163]
  v_add_f32 v249, 1.0, v249
  v_add_f32 v250, 1.0, v250
  v_mfma_f32_16x16x32_bf16 v[176:179], v[40:43], v[52:55], v[176:179]
  v_rcp_f32 v11, v11
  v_mfma_f32_16x16x32_bf16 v[176:179], v[24:27], v[48:51], v[176:179]
  v_rcp_f32 v248, v248
  v_mfma_f32_16x16x32_bf16 v[180:183], v[28:31], v[48:51], v[180:183]
  v_rcp_f32 v249, v249
  v_mfma_f32_16x16x32_bf16 v[180:183], v[44:47], v[52:55], v[180:183]
  v_rcp_f32 v250, v250
  v_mfma_f32_16x16x32_bf16 v[164:167], v[44:47], v[84:87], v[164:167]
  ds_read_b128 v[84:87], v7 offset:59392
  v_mul_f32 v92, v92, v11
  v_mfma_f32_16x16x32_bf16 v[164:167], v[28:31], v[80:83], v[164:167]
  ds_read_b128 v[80:83], v5 offset:59392
  v_mul_f32 v93, v93, v248
  v_mfma_f32_16x16x32_bf16 v[184:187], v[16:19], v[56:59], v[184:187]
  s_waitcnt lgkmcnt(2)
  v_mul_f32 v94, v94, v249
  v_mul_f32 v95, v95, v250
  v_mfma_f32_16x16x32_bf16 v[184:187], v[32:35], v[60:63], v[184:187]
  v_mul_f32 v11, v96, v96
  v_mul_f32 v248, v97, v97
  v_mfma_f32_16x16x32_bf16 v[200:203], v[32:35], v[68:71], v[200:203]
  v_mul_f32 v249, v98, v98
  v_mul_f32_e64 v250, v99, v99
  v_mfma_f32_16x16x32_bf16 v[200:203], v[16:19], v[64:67], v[200:203]
  v_fma_f32 v11, v11, v14, v12
  v_fma_f32 v248, v248, v14, v12
  v_mfma_f32_16x16x32_bf16 v[204:207], v[20:23], v[64:67], v[204:207]
  v_fma_f32 v249, v249, v14, v12
  v_fma_f32 v250, v250, v14, v12
  v_mfma_f32_16x16x32_bf16 v[204:207], v[36:39], v[68:71], v[204:207]
  v_mul_f32 v11, v11, v96
  v_mul_f32 v248, v248, v97
  v_mfma_f32_16x16x32_bf16 v[188:191], v[36:39], v[60:63], v[188:191]
  v_mul_f32 v249, v249, v98
  v_mul_f32 v250, v250, v99
  v_mfma_f32_16x16x32_bf16 v[188:191], v[20:23], v[56:59], v[188:191]
  v_exp_f32 v11, v11
  v_mfma_f32_16x16x32_bf16 v[192:195], v[24:27], v[56:59], v[192:195]
  v_exp_f32 v248, v248
  v_mfma_f32_16x16x32_bf16 v[192:195], v[40:43], v[60:63], v[192:195]
  v_exp_f32 v249, v249
  v_mfma_f32_16x16x32_bf16 v[208:211], v[40:43], v[68:71], v[208:211]
  v_exp_f32 v250, v250
  v_mfma_f32_16x16x32_bf16 v[208:211], v[24:27], v[64:67], v[208:211]
  v_add_f32 v11, 1.0, v11
  v_add_f32 v248, 1.0, v248
  v_mfma_f32_16x16x32_bf16 v[212:215], v[28:31], v[64:67], v[212:215]
  v_add_f32 v249, 1.0, v249
  v_add_f32 v250, 1.0, v250
  v_mfma_f32_16x16x32_bf16 v[212:215], v[44:47], v[68:71], v[212:215]
  v_rcp_f32 v11, v11
  v_mfma_f32_16x16x32_bf16 v[196:199], v[44:47], v[60:63], v[196:199]
  v_rcp_f32 v248, v248
  v_mfma_f32_16x16x32_bf16 v[196:199], v[28:31], v[56:59], v[196:199]
  v_rcp_f32 v249, v249
  v_mfma_f32_16x16x32_bf16 v[216:219], v[32:35], v[76:79], v[216:219]
  s_waitcnt lgkmcnt(0)
  v_rcp_f32 v250, v250
  v_mfma_f32_16x16x32_bf16 v[216:219], v[16:19], v[72:75], v[216:219]
  v_mul_f32 v96, v96, v11
  v_mul_f32 v97, v97, v248
  v_mfma_f32_16x16x32_bf16 v[232:235], v[16:19], v[80:83], v[232:235]
  v_mul_f32 v98, v98, v249
  v_mul_f32 v99, v99, v250
  v_mfma_f32_16x16x32_bf16 v[232:235], v[32:35], v[84:87], v[232:235]
  v_mul_f32 v11, v100, v100
  v_mul_f32 v248, v101, v101
  v_mfma_f32_16x16x32_bf16 v[236:239], v[36:39], v[84:87], v[236:239]
  v_mul_f32 v249, v102, v102
  v_mul_f32 v250, v103, v103
  v_mfma_f32_16x16x32_bf16 v[236:239], v[20:23], v[80:83], v[236:239]
  v_fma_f32 v11, v11, v14, v12
  v_fma_f32 v248, v248, v14, v12
  v_mfma_f32_16x16x32_bf16 v[220:223], v[20:23], v[72:75], v[220:223]
  v_fma_f32 v249, v249, v14, v12
  v_fma_f32 v250, v250, v14, v12
  v_mfma_f32_16x16x32_bf16 v[220:223], v[36:39], v[76:79], v[220:223]
  v_mul_f32 v11, v11, v100
  v_mul_f32 v248, v248, v101
  v_mfma_f32_16x16x32_bf16 v[224:227], v[40:43], v[76:79], v[224:227]
  v_mul_f32 v249, v249, v102
  v_mul_f32 v250, v250, v103
  v_mfma_f32_16x16x32_bf16 v[224:227], v[24:27], v[72:75], v[224:227]
  v_exp_f32 v11, v11
  v_mfma_f32_16x16x32_bf16 v[240:243], v[24:27], v[80:83], v[240:243]
  v_exp_f32 v248, v248
  v_mfma_f32_16x16x32_bf16 v[240:243], v[40:43], v[84:87], v[240:243]
  v_exp_f32 v249, v249
  v_mfma_f32_16x16x32_bf16 v[244:247], v[44:47], v[84:87], v[244:247]
  v_exp_f32 v250, v250
  v_mfma_f32_16x16x32_bf16 v[244:247], v[28:31], v[80:83], v[244:247]
  v_add_f32 v11, 1.0, v11
  v_add_f32 v248, 1.0, v248
  v_mfma_f32_16x16x32_bf16 v[228:231], v[28:31], v[72:75], v[228:231]
  v_add_f32 v249, 1.0, v249
  v_add_f32 v250, 1.0, v250
  v_mfma_f32_16x16x32_bf16 v[228:231], v[44:47], v[76:79], v[228:231]
  v_rcp_f32 v11, v11
  v_rcp_f32 v248, v248
  v_rcp_f32 v249, v249
  v_rcp_f32 v250, v250
  v_mul_f32 v100, v100, v11
  v_mul_f32 v101, v101, v248
  v_mul_f32 v102, v102, v249
  v_mul_f32 v103, v103, v250
  ds_read_b64 v[18:19], v9 offset:256
  ds_read_b64 v[22:23], v9 offset:288
  ds_read_b64 v[26:27], v9 offset:320
  ds_read_b64 v[30:31], v9 offset:352
  v_mov_b32 v248, 1.0
  v_mov_b32_e64 v249, 1.0
L_epi:
  v_mov_b32 v84, 0xc1c00000
  v_mov_b32 v85, 0xc1c00000
  v_mov_b32 v86, 0x4b800000
  v_mov_b32 v87, 0x4b800000
  v_pk_mul_f32 v[52:53], v[104:105], v[104:105]
  v_pk_mul_f32 v[56:57], v[106:107], v[106:107]
  v_pk_mul_f32 v[60:61], v[108:109], v[108:109]
  v_pk_mul_f32 v[64:65], v[110:111], v[110:111]
  v_pk_mul_f32 v[68:69], v[120:121], v[120:121]
  v_pk_mul_f32 v[72:73], v[122:123], v[122:123]
  v_pk_mul_f32 v[76:77], v[124:125], v[124:125]
  v_pk_mul_f32 v[80:81], v[126:127], v[126:127]
  v_pk_fma_f32 v[52:53], v[52:53], v[14:15], v[12:13]
  v_pk_fma_f32 v[56:57], v[56:57], v[14:15], v[12:13]
  v_pk_fma_f32 v[60:61], v[60:61], v[14:15], v[12:13]
  v_pk_fma_f32 v[64:65], v[64:65], v[14:15], v[12:13]
  v_pk_fma_f32 v[68:69], v[68:69], v[14:15], v[12:13]
  v_pk_fma_f32 v[72:73], v[72:73], v[14:15], v[12:13]
  v_pk_fma_f32 v[76:77], v[76:77], v[14:15], v[12:13]
  v_pk_fma_f32 v[80:81], v[80:81], v[14:15], v[12:13]
  v_pk_fma_f32 v[52:53], v[52:53], v[104:105], v[84:85]
  v_pk_fma_f32 v[56:57], v[56:57], v[106:107], v[84:85]
  v_pk_fma_f32 v[60:61], v[60:61], v[108:109], v[84:85]
  v_pk_fma_f32 v[64:65], v[64:65], v[110:111], v[84:85]
  v_pk_fma_f32 v[68:69], v[68:69], v[120:121], v[84:85]
  v_pk_fma_f32 v[72:73], v[72:73], v[122:123], v[84:85]
  v_pk_fma_f32 v[76:77], v[76:77], v[124:125], v[84:85]
  v_pk_fma_f32 v[80:81], v[80:81], v[126:127], v[84:85]
  v_exp_f32 v52, v52 clamp
  v_exp_f32 v53, v53 clamp
  v_exp_f32 v56, v56 clamp
  v_exp_f32 v57, v57 clamp
  v_exp_f32 v60, v60 clamp
  v_exp_f32 v61, v61 clamp
  v_exp_f32 v64, v64 clamp
  v_exp_f32 v65, v65 clamp
  v_exp_f32 v68, v68 clamp
  v_exp_f32 v69, v69 clamp
  v_exp_f32 v72, v72 clamp
  v_exp_f32 v73, v73 clamp
  v_exp_f32 v76, v76 clamp
  v_exp_f32 v77, v77 clamp
  v_exp_f32 v80, v80 clamp
  v_exp_f32 v81, v81 clamp
  s_waitcnt lgkmcnt(3)
  v_lshlrev_b32 v16, 16, v18
  v_and_b32 v17, 0xffff0000, v18
  v_lshlrev_b32 v18, 16, v19
  v_and_b32 v19, 0xffff0000, v19
  s_waitcnt lgkmcnt(2)
  v_lshlrev_b32_e64 v20, 16, v22
  v_and_b32 v21, 0xffff0000, v22
  v_lshlrev_b32 v22, 16, v23
  v_and_b32 v23, 0xffff0000, v23
  s_waitcnt lgkmcnt(1)
  v_lshlrev_b32 v24, 16, v26
  v_and_b32 v25, 0xffff0000, v26
  v_lshlrev_b32 v26, 16, v27
  v_and_b32 v27, 0xffff0000, v27
  s_waitcnt lgkmcnt(0)
  v_lshlrev_b32 v28, 16, v30
  v_and_b32 v29, 0xffff0000, v30
  v_lshlrev_b32_e64 v30, 16, v31
  v_and_b32 v31, 0xffff0000, v31
  v_pk_mul_f32 v[54:55], v[104:105], v[16:17]
  v_pk_mul_f32 v[58:59], v[106:107], v[18:19]
  v_pk_mul_f32 v[62:63], v[108:109], v[20:21]
  v_pk_mul_f32 v[66:67], v[110:111], v[22:23]
  v_pk_mul_f32 v[70:71], v[120:121], v[16:17]
  v_pk_mul_f32 v[74:75], v[122:123], v[18:19]
  v_pk_mul_f32 v[78:79], v[124:125], v[20:21]
  v_pk_mul_f32 v[82:83], v[126:127], v[22:23]
  v_pk_fma_f32 v[52:53], v[52:53], v[86:87], v[248:249]
  v_pk_fma_f32 v[56:57], v[56:57], v[86:87], v[248:249]
  v_pk_fma_f32 v[60:61], v[60:61], v[86:87], v[248:249]
  v_pk_fma_f32 v[64:65], v[64:65], v[86:87], v[248:249]
  v_pk_fma_f32 v[68:69], v[68:69], v[86:87], v[248:249]
  v_pk_fma_f32 v[72:73], v[72:73], v[86:87], v[248:249]
  v_pk_fma_f32 v[76:77], v[76:77], v[86:87], v[248:249]
  v_pk_fma_f32 v[80:81], v[80:81], v[86:87], v[248:249]
  v_pk_mul_f32 v[54:55], v[54:55], v[56:57]
  v_pk_mul_f32 v[62:63], v[62:63], v[64:65]
  v_pk_mul_f32 v[70:71], v[70:71], v[72:73]
  v_pk_mul_f32 v[78:79], v[78:79], v[80:81]
  v_pk_fma_f32 v[54:55], v[58:59], v[52:53], v[54:55]
  v_pk_fma_f32 v[62:63], v[66:67], v[60:61], v[62:63]
  v_pk_fma_f32 v[70:71], v[74:75], v[68:69], v[70:71]
  v_pk_fma_f32 v[78:79], v[82:83], v[76:77], v[78:79]
  v_pk_mul_f32 v[52:53], v[52:53], v[56:57]
  v_pk_mul_f32 v[60:61], v[60:61], v[64:65]
  v_pk_mul_f32 v[68:69], v[68:69], v[72:73]
  v_pk_mul_f32 v[76:77], v[76:77], v[80:81]
  v_pk_mul_f32 v[54:55], v[54:55], v[60:61]
  v_pk_mul_f32 v[70:71], v[70:71], v[76:77]
  v_pk_fma_f32 v[54:55], v[62:63], v[52:53], v[54:55]
  v_pk_fma_f32 v[70:71], v[78:79], v[68:69], v[70:71]
  v_pk_mul_f32 v[52:53], v[52:53], v[60:61]
  v_pk_mul_f32 v[68:69], v[68:69], v[76:77]
  v_rcp_f32 v52, v52
  v_rcp_f32 v53, v53
  v_rcp_f32 v68, v68
  v_rcp_f32 v69, v69
  v_pk_mul_f32 v[34:35], v[52:53], v[54:55]
  v_pk_mul_f32 v[36:37], v[68:69], v[70:71]
  v_pk_mul_f32 v[52:53], v[112:113], v[112:113]
  v_pk_mul_f32 v[56:57], v[114:115], v[114:115]
  v_pk_mul_f32 v[60:61], v[116:117], v[116:117]
  v_pk_mul_f32 v[64:65], v[118:119], v[118:119]
  v_pk_mul_f32 v[68:69], v[128:129], v[128:129]
  v_pk_mul_f32 v[72:73], v[130:131], v[130:131]
  v_pk_mul_f32 v[76:77], v[132:133], v[132:133]
  v_pk_mul_f32 v[80:81], v[134:135], v[134:135]
  v_pk_fma_f32 v[52:53], v[52:53], v[14:15], v[12:13]
  v_pk_fma_f32 v[56:57], v[56:57], v[14:15], v[12:13]
  v_pk_fma_f32 v[60:61], v[60:61], v[14:15], v[12:13]
  v_pk_fma_f32 v[64:65], v[64:65], v[14:15], v[12:13]
  v_pk_fma_f32 v[68:69], v[68:69], v[14:15], v[12:13]
  v_pk_fma_f32 v[72:73], v[72:73], v[14:15], v[12:13]
  v_pk_fma_f32 v[76:77], v[76:77], v[14:15], v[12:13]
  v_pk_fma_f32 v[80:81], v[80:81], v[14:15], v[12:13]
  v_pk_fma_f32 v[52:53], v[52:53], v[112:113], v[84:85]
  v_pk_fma_f32 v[56:57], v[56:57], v[114:115], v[84:85]
  v_pk_fma_f32 v[60:61], v[60:61], v[116:117], v[84:85]
  v_pk_fma_f32 v[64:65], v[64:65], v[118:119], v[84:85]
  v_pk_fma_f32 v[68:69], v[68:69], v[128:129], v[84:85]
  v_pk_fma_f32 v[72:73], v[72:73], v[130:131], v[84:85]
  v_pk_fma_f32 v[76:77], v[76:77], v[132:133], v[84:85]
  v_pk_fma_f32 v[80:81], v[80:81], v[134:135], v[84:85]
  v_exp_f32 v52, v52 clamp
  v_exp_f32 v53, v53 clamp
  v_exp_f32 v56, v56 clamp
  v_exp_f32 v57, v57 clamp
  v_exp_f32 v60, v60 clamp
  v_exp_f32 v61, v61 clamp
  v_exp_f32 v64, v64 clamp
  v_exp_f32 v65, v65 clamp
  v_exp_f32 v68, v68 clamp
  v_exp_f32 v69, v69 clamp
  v_exp_f32 v72, v72 clamp
  v_exp_f32 v73, v73 clamp
  v_exp_f32 v76, v76 clamp
  v_exp_f32 v77, v77 clamp
  v_exp_f32 v80, v80 clamp
  v_exp_f32 v81, v81 clamp
  v_pk_mul_f32 v[54:55], v[112:113], v[24:25]
  v_pk_mul_f32 v[58:59], v[114:115], v[26:27]
  v_pk_mul_f32 v[62:63], v[116:117], v[28:29]
  v_pk_mul_f32 v[66:67], v[118:119], v[30:31]
  v_pk_mul_f32 v[70:71], v[128:129], v[24:25]
  v_pk_mul_f32 v[74:75], v[130:131], v[26:27]
  v_pk_mul_f32 v[78:79], v[132:133], v[28:29]
  v_pk_mul_f32 v[82:83], v[134:135], v[30:31]
  v_pk_fma_f32 v[52:53], v[52:53], v[86:87], v[248:249]
  v_pk_fma_f32 v[56:57], v[56:57], v[86:87], v[248:249]
  v_pk_fma_f32 v[60:61], v[60:61], v[86:87], v[248:249]
  v_pk_fma_f32 v[64:65], v[64:65], v[86:87], v[248:249]
  v_pk_fma_f32 v[68:69], v[68:69], v[86:87], v[248:249]
  v_pk_fma_f32 v[72:73], v[72:73], v[86:87], v[248:249]
  v_pk_fma_f32 v[76:77], v[76:77], v[86:87], v[248:249]
  v_pk_fma_f32 v[80:81], v[80:81], v[86:87], v[248:249]
  v_pk_mul_f32 v[54:55], v[54:55], v[56:57]
  v_pk_mul_f32 v[62:63], v[62:63], v[64:65]
  v_pk_mul_f32 v[70:71], v[70:71], v[72:73]
  v_pk_mul_f32 v[78:79], v[78:79], v[80:81]
  v_pk_fma_f32 v[54:55], v[58:59], v[52:53], v[54:55]
  v_pk_fma_f32 v[62:63], v[66:67], v[60:61], v[62:63]
  v_pk_fma_f32 v[70:71], v[74:75], v[68:69], v[70:71]
  v_pk_fma_f32 v[78:79], v[82:83], v[76:77], v[78:79]
  v_pk_mul_f32 v[52:53], v[52:53], v[56:57]
  v_pk_mul_f32 v[60:61], v[60:61], v[64:65]
  v_pk_mul_f32 v[68:69], v[68:69], v[72:73]
  v_pk_mul_f32 v[76:77], v[76:77], v[80:81]
  v_pk_mul_f32 v[54:55], v[54:55], v[60:61]
  v_pk_mul_f32 v[70:71], v[70:71], v[76:77]
  v_pk_fma_f32 v[54:55], v[62:63], v[52:53], v[54:55]
  v_pk_fma_f32 v[70:71], v[78:79], v[68:69], v[70:71]
  v_pk_mul_f32 v[52:53], v[52:53], v[60:61]
  v_pk_mul_f32 v[68:69], v[68:69], v[76:77]
  v_rcp_f32 v52, v52
  v_rcp_f32 v53, v53
  v_rcp_f32 v68, v68
  v_rcp_f32 v69, v69
  v_pk_fma_f32 v[34:35], v[52:53], v[54:55], v[34:35]
  v_pk_fma_f32 v[36:37], v[68:69], v[70:71], v[36:37]
  v_pk_mul_f32 v[52:53], v[136:137], v[136:137]
  v_pk_mul_f32 v[56:57], v[138:139], v[138:139]
  v_pk_mul_f32 v[60:61], v[140:141], v[140:141]
  v_pk_mul_f32 v[64:65], v[142:143], v[142:143]
  v_pk_mul_f32 v[68:69], v[152:153], v[152:153]
  v_pk_mul_f32 v[72:73], v[154:155], v[154:155]
  v_pk_mul_f32 v[76:77], v[156:157], v[156:157]
  v_pk_mul_f32 v[80:81], v[158:159], v[158:159]
  v_pk_fma_f32 v[52:53], v[52:53], v[14:15], v[12:13]
  v_pk_fma_f32 v[56:57], v[56:57], v[14:15], v[12:13]
  v_pk_fma_f32 v[60:61], v[60:61], v[14:15], v[12:13]
  v_pk_fma_f32 v[64:65], v[64:65], v[14:15], v[12:13]
  v_pk_fma_f32 v[68:69], v[68:69], v[14:15], v[12:13]
  v_pk_fma_f32 v[72:73], v[72:73], v[14:15], v[12:13]
  v_pk_fma_f32 v[76:77], v[76:77], v[14:15], v[12:13]
  v_pk_fma_f32 v[80:81], v[80:81], v[14:15], v[12:13]
  v_pk_fma_f32 v[52:53], v[52:53], v[136:137], v[84:85]
  v_pk_fma_f32 v[56:57], v[56:57], v[138:139], v[84:85]
  v_pk_fma_f32 v[60:61], v[60:61], v[140:141], v[84:85]
  v_pk_fma_f32 v[64:65], v[64:65], v[142:143], v[84:85]
  v_pk_fma_f32 v[68:69], v[68:69], v[152:153], v[84:85]
  v_pk_fma_f32 v[72:73], v[72:73], v[154:155], v[84:85]
  v_pk_fma_f32 v[76:77], v[76:77], v[156:157], v[84:85]
  v_pk_fma_f32 v[80:81], v[80:81], v[158:159], v[84:85]
  v_exp_f32 v52, v52 clamp
  v_exp_f32 v53, v53 clamp
  v_exp_f32 v56, v56 clamp
  v_exp_f32 v57, v57 clamp
  v_exp_f32 v60, v60 clamp
  v_exp_f32 v61, v61 clamp
  v_exp_f32 v64, v64 clamp
  v_exp_f32 v65, v65 clamp
  v_exp_f32 v68, v68 clamp
  v_exp_f32 v69, v69 clamp
  v_exp_f32 v72, v72 clamp
  v_exp_f32 v73, v73 clamp
  v_exp_f32 v76, v76 clamp
  v_exp_f32 v77, v77 clamp
  v_exp_f32 v80, v80 clamp
  v_exp_f32 v81, v81 clamp
  v_pk_mul_f32 v[54:55], v[136:137], v[16:17]
  v_pk_mul_f32 v[58:59], v[138:139], v[18:19]
  v_pk_mul_f32 v[62:63], v[140:141], v[20:21]
  v_pk_mul_f32 v[66:67], v[142:143], v[22:23]
  v_pk_mul_f32 v[70:71], v[152:153], v[16:17]
  v_pk_mul_f32 v[74:75], v[154:155], v[18:19]
  v_pk_mul_f32 v[78:79], v[156:157], v[20:21]
  v_pk_mul_f32 v[82:83], v[158:159], v[22:23]
  v_pk_fma_f32 v[52:53], v[52:53], v[86:87], v[248:249]
  v_pk_fma_f32 v[56:57], v[56:57], v[86:87], v[248:249]
  v_pk_fma_f32 v[60:61], v[60:61], v[86:87], v[248:249]
  v_pk_fma_f32 v[64:65], v[64:65], v[86:87], v[248:249]
  v_pk_fma_f32 v[68:69], v[68:69], v[86:87], v[248:249]
  v_pk_fma_f32 v[72:73], v[72:73], v[86:87], v[248:249]
  v_pk_fma_f32 v[76:77], v[76:77], v[86:87], v[248:249]
  v_pk_fma_f32 v[80:81], v[80:81], v[86:87], v[248:249]
  v_pk_mul_f32 v[54:55], v[54:55], v[56:57]
  v_pk_mul_f32 v[62:63], v[62:63], v[64:65]
  v_pk_mul_f32 v[70:71], v[70:71], v[72:73]
  v_pk_mul_f32 v[78:79], v[78:79], v[80:81]
  v_pk_fma_f32 v[54:55], v[58:59], v[52:53], v[54:55]
  v_pk_fma_f32 v[62:63], v[66:67], v[60:61], v[62:63]
  v_pk_fma_f32 v[70:71], v[74:75], v[68:69], v[70:71]
  v_pk_fma_f32 v[78:79], v[82:83], v[76:77], v[78:79]
  v_pk_mul_f32 v[52:53], v[52:53], v[56:57]
  v_pk_mul_f32 v[60:61], v[60:61], v[64:65]
  v_pk_mul_f32 v[68:69], v[68:69], v[72:73]
  v_pk_mul_f32 v[76:77], v[76:77], v[80:81]
  v_pk_mul_f32 v[54:55], v[54:55], v[60:61]
  v_pk_mul_f32 v[70:71], v[70:71], v[76:77]
  v_pk_fma_f32 v[54:55], v[62:63], v[52:53], v[54:55]
  v_pk_fma_f32 v[70:71], v[78:79], v[68:69], v[70:71]
  v_pk_mul_f32 v[52:53], v[52:53], v[60:61]
  v_pk_mul_f32 v[68:69], v[68:69], v[76:77]
  v_rcp_f32 v52, v52
  v_rcp_f32 v53, v53
  v_rcp_f32 v68, v68
  v_rcp_f32 v69, v69
  v_pk_mul_f32 v[38:39], v[52:53], v[54:55]
  v_pk_mul_f32 v[40:41], v[68:69], v[70:71]
  v_pk_mul_f32 v[52:53], v[144:145], v[144:145]
  v_pk_mul_f32 v[56:57], v[146:147], v[146:147]
  v_pk_mul_f32 v[60:61], v[148:149], v[148:149]
  v_pk_mul_f32 v[64:65], v[150:151], v[150:151]
  v_pk_mul_f32 v[68:69], v[160:161], v[160:161]
  v_pk_mul_f32 v[72:73], v[162:163], v[162:163]
  v_pk_mul_f32 v[76:77], v[164:165], v[164:165]
  v_pk_mul_f32 v[80:81], v[166:167], v[166:167]
  v_pk_fma_f32 v[52:53], v[52:53], v[14:15], v[12:13]
  v_pk_fma_f32 v[56:57], v[56:57], v[14:15], v[12:13]
  v_pk_fma_f32 v[60:61], v[60:61], v[14:15], v[12:13]
  v_pk_fma_f32 v[64:65], v[64:65], v[14:15], v[12:13]
  v_pk_fma_f32 v[68:69], v[68:69], v[14:15], v[12:13]
  v_pk_fma_f32 v[72:73], v[72:73], v[14:15], v[12:13]
  v_pk_fma_f32 v[76:77], v[76:77], v[14:15], v[12:13]
  v_pk_fma_f32 v[80:81], v[80:81], v[14:15], v[12:13]
  v_pk_fma_f32 v[52:53], v[52:53], v[144:145], v[84:85]
  v_pk_fma_f32 v[56:57], v[56:57], v[146:147], v[84:85]
  v_pk_fma_f32 v[60:61], v[60:61], v[148:149], v[84:85]
  v_pk_fma_f32 v[64:65], v[64:65], v[150:151], v[84:85]
  v_pk_fma_f32 v[68:69], v[68:69], v[160:161], v[84:85]
  v_pk_fma_f32 v[72:73], v[72:73], v[162:163], v[84:85]
  v_pk_fma_f32 v[76:77], v[76:77], v[164:165], v[84:85]
  v_pk_fma_f32 v[80:81], v[80:81], v[166:167], v[84:85]
  v_exp_f32 v52, v52 clamp
  v_exp_f32 v53, v53 clamp
  v_exp_f32 v56, v56 clamp
  v_exp_f32 v57, v57 clamp
  v_exp_f32 v60, v60 clamp
  v_exp_f32 v61, v61 clamp
  v_exp_f32 v64, v64 clamp
  v_exp_f32 v65, v65 clamp
  v_exp_f32 v68, v68 clamp
  v_exp_f32 v69, v69 clamp
  v_exp_f32 v72, v72 clamp
  v_exp_f32 v73, v73 clamp
  v_exp_f32 v76, v76 clamp
  v_exp_f32 v77, v77 clamp
  v_exp_f32 v80, v80 clamp
  v_exp_f32 v81, v81 clamp
  v_pk_mul_f32 v[54:55], v[144:145], v[24:25]
  v_pk_mul_f32 v[58:59], v[146:147], v[26:27]
  v_pk_mul_f32 v[62:63], v[148:149], v[28:29]
  v_pk_mul_f32 v[66:67], v[150:151], v[30:31]
  v_pk_mul_f32 v[70:71], v[160:161], v[24:25]
  v_pk_mul_f32 v[74:75], v[162:163], v[26:27]
  v_pk_mul_f32 v[78:79], v[164:165], v[28:29]
  v_pk_mul_f32 v[82:83], v[166:167], v[30:31]
  v_pk_fma_f32 v[52:53], v[52:53], v[86:87], v[248:249]
  v_pk_fma_f32 v[56:57], v[56:57], v[86:87], v[248:249]
  v_pk_fma_f32 v[60:61], v[60:61], v[86:87], v[248:249]
  v_pk_fma_f32 v[64:65], v[64:65], v[86:87], v[248:249]
  v_pk_fma_f32 v[68:69], v[68:69], v[86:87], v[248:249]
  v_pk_fma_f32 v[72:73], v[72:73], v[86:87], v[248:249]
  v_pk_fma_f32 v[76:77], v[76:77], v[86:87], v[248:249]
  v_pk_fma_f32 v[80:81], v[80:81], v[86:87], v[248:249]
  v_pk_mul_f32 v[54:55], v[54:55], v[56:57]
  v_pk_mul_f32 v[62:63], v[62:63], v[64:65]
  v_pk_mul_f32 v[70:71], v[70:71], v[72:73]
  v_pk_mul_f32 v[78:79], v[78:79], v[80:81]
  v_pk_fma_f32 v[54:55], v[58:59], v[52:53], v[54:55]
  v_pk_fma_f32 v[62:63], v[66:67], v[60:61], v[62:63]
  v_pk_fma_f32 v[70:71], v[74:75], v[68:69], v[70:71]
  v_pk_fma_f32 v[78:79], v[82:83], v[76:77], v[78:79]
  v_pk_mul_f32 v[52:53], v[52:53], v[56:57]
  v_pk_mul_f32 v[60:61], v[60:61], v[64:65]
  v_pk_mul_f32 v[68:69], v[68:69], v[72:73]
  v_pk_mul_f32 v[76:77], v[76:77], v[80:81]
  v_pk_mul_f32 v[54:55], v[54:55], v[60:61]
  v_pk_mul_f32 v[70:71], v[70:71], v[76:77]
  v_pk_fma_f32 v[54:55], v[62:63], v[52:53], v[54:55]
  v_pk_fma_f32 v[70:71], v[78:79], v[68:69], v[70:71]
  v_pk_mul_f32 v[52:53], v[52:53], v[60:61]
  v_pk_mul_f32 v[68:69], v[68:69], v[76:77]
  v_rcp_f32 v52, v52
  v_rcp_f32 v53, v53
  v_rcp_f32 v68, v68
  v_rcp_f32 v69, v69
  v_pk_fma_f32 v[38:39], v[52:53], v[54:55], v[38:39]
  v_pk_fma_f32 v[40:41], v[68:69], v[70:71], v[40:41]
  v_pk_mul_f32 v[52:53], v[168:169], v[168:169]
  v_pk_mul_f32 v[56:57], v[170:171], v[170:171]
  v_pk_mul_f32 v[60:61], v[172:173], v[172:173]
  v_pk_mul_f32 v[64:65], v[174:175], v[174:175]
  v_pk_mul_f32 v[68:69], v[184:185], v[184:185]
  v_pk_mul_f32 v[72:73], v[186:187], v[186:187]
  v_pk_mul_f32 v[76:77], v[188:189], v[188:189]
  v_pk_mul_f32 v[80:81], v[190:191], v[190:191]
  v_pk_fma_f32 v[52:53], v[52:53], v[14:15], v[12:13]
  v_pk_fma_f32 v[56:57], v[56:57], v[14:15], v[12:13]
  v_pk_fma_f32 v[60:61], v[60:61], v[14:15], v[12:13]
  v_pk_fma_f32 v[64:65], v[64:65], v[14:15], v[12:13]
  v_pk_fma_f32 v[68:69], v[68:69], v[14:15], v[12:13]
  v_pk_fma_f32 v[72:73], v[72:73], v[14:15], v[12:13]
  v_pk_fma_f32 v[76:77], v[76:77], v[14:15], v[12:13]
  v_pk_fma_f32 v[80:81], v[80:81], v[14:15], v[12:13]
  v_pk_fma_f32 v[52:53], v[52:53], v[168:169], v[84:85]
  v_pk_fma_f32 v[56:57], v[56:57], v[170:171], v[84:85]
  v_pk_fma_f32 v[60:61], v[60:61], v[172:173], v[84:85]
  v_pk_fma_f32 v[64:65], v[64:65], v[174:175], v[84:85]
  v_pk_fma_f32 v[68:69], v[68:69], v[184:185], v[84:85]
  v_pk_fma_f32 v[72:73], v[72:73], v[186:187], v[84:85]
  v_pk_fma_f32 v[76:77], v[76:77], v[188:189], v[84:85]
  v_pk_fma_f32 v[80:81], v[80:81], v[190:191], v[84:85]
  v_exp_f32 v52, v52 clamp
  v_exp_f32 v53, v53 clamp
  v_exp_f32 v56, v56 clamp
  v_exp_f32 v57, v57 clamp
  v_exp_f32 v60, v60 clamp
  v_exp_f32 v61, v61 clamp
  v_exp_f32 v64, v64 clamp
  v_exp_f32 v65, v65 clamp
  v_exp_f32 v68, v68 clamp
  v_exp_f32 v69, v69 clamp
  v_exp_f32 v72, v72 clamp
  v_exp_f32 v73, v73 clamp
  v_exp_f32 v76, v76 clamp
  v_exp_f32 v77, v77 clamp
  v_exp_f32 v80, v80 clamp
  v_exp_f32 v81, v81 clamp
  v_pk_mul_f32 v[54:55], v[168:169], v[16:17]
  v_pk_mul_f32 v[58:59], v[170:171], v[18:19]
  v_pk_mul_f32 v[62:63], v[172:173], v[20:21]
  v_pk_mul_f32 v[66:67], v[174:175], v[22:23]
  v_pk_mul_f32 v[70:71], v[184:185], v[16:17]
  v_pk_mul_f32 v[74:75], v[186:187], v[18:19]
  v_pk_mul_f32 v[78:79], v[188:189], v[20:21]
  v_pk_mul_f32 v[82:83], v[190:191], v[22:23]
  v_pk_fma_f32 v[52:53], v[52:53], v[86:87], v[248:249]
  v_pk_fma_f32 v[56:57], v[56:57], v[86:87], v[248:249]
  v_pk_fma_f32 v[60:61], v[60:61], v[86:87], v[248:249]
  v_pk_fma_f32 v[64:65], v[64:65], v[86:87], v[248:249]
  v_pk_fma_f32 v[68:69], v[68:69], v[86:87], v[248:249]
  v_pk_fma_f32 v[72:73], v[72:73], v[86:87], v[248:249]
  v_pk_fma_f32 v[76:77], v[76:77], v[86:87], v[248:249]
  v_pk_fma_f32 v[80:81], v[80:81], v[86:87], v[248:249]
  v_pk_mul_f32 v[54:55], v[54:55], v[56:57]
  v_pk_mul_f32 v[62:63], v[62:63], v[64:65]
  v_pk_mul_f32 v[70:71], v[70:71], v[72:73]
  v_pk_mul_f32 v[78:79], v[78:79], v[80:81]
  v_pk_fma_f32 v[54:55], v[58:59], v[52:53], v[54:55]
  v_pk_fma_f32 v[62:63], v[66:67], v[60:61], v[62:63]
  v_pk_fma_f32 v[70:71], v[74:75], v[68:69], v[70:71]
  v_pk_fma_f32 v[78:79], v[82:83], v[76:77], v[78:79]
  v_pk_mul_f32 v[52:53], v[52:53], v[56:57]
  v_pk_mul_f32 v[60:61], v[60:61], v[64:65]
  v_pk_mul_f32 v[68:69], v[68:69], v[72:73]
  v_pk_mul_f32 v[76:77], v[76:77], v[80:81]
  v_pk_mul_f32 v[54:55], v[54:55], v[60:61]
  v_pk_mul_f32 v[70:71], v[70:71], v[76:77]
  v_pk_fma_f32 v[54:55], v[62:63], v[52:53], v[54:55]
  v_pk_fma_f32 v[70:71], v[78:79], v[68:69], v[70:71]
  v_pk_mul_f32 v[52:53], v[52:53], v[60:61]
  v_pk_mul_f32 v[68:69], v[68:69], v[76:77]
  v_rcp_f32 v52, v52
  v_rcp_f32 v53, v53
  v_rcp_f32 v68, v68
  v_rcp_f32 v69, v69
  v_pk_mul_f32 v[42:43], v[52:53], v[54:55]
  v_pk_mul_f32 v[44:45], v[68:69], v[70:71]
  v_pk_mul_f32 v[52:53], v[176:177], v[176:177]
  v_pk_mul_f32 v[56:57], v[178:179], v[178:179]
  v_pk_mul_f32 v[60:61], v[180:181], v[180:181]
  v_pk_mul_f32 v[64:65], v[182:183], v[182:183]
  v_pk_mul_f32 v[68:69], v[192:193], v[192:193]
  v_pk_mul_f32 v[72:73], v[194:195], v[194:195]
  v_pk_mul_f32 v[76:77], v[196:197], v[196:197]
  v_pk_mul_f32 v[80:81], v[198:199], v[198:199]
  v_pk_fma_f32 v[52:53], v[52:53], v[14:15], v[12:13]
  v_pk_fma_f32 v[56:57], v[56:57], v[14:15], v[12:13]
  v_pk_fma_f32 v[60:61], v[60:61], v[14:15], v[12:13]
  v_pk_fma_f32 v[64:65], v[64:65], v[14:15], v[12:13]
  v_pk_fma_f32 v[68:69], v[68:69], v[14:15], v[12:13]
  v_pk_fma_f32 v[72:73], v[72:73], v[14:15], v[12:13]
  v_pk_fma_f32 v[76:77], v[76:77], v[14:15], v[12:13]
  v_pk_fma_f32 v[80:81], v[80:81], v[14:15], v[12:13]
  v_pk_fma_f32 v[52:53], v[52:53], v[176:177], v[84:85]
  v_pk_fma_f32 v[56:57], v[56:57], v[178:179], v[84:85]
  v_pk_fma_f32 v[60:61], v[60:61], v[180:181], v[84:85]
  v_pk_fma_f32 v[64:65], v[64:65], v[182:183], v[84:85]
  v_pk_fma_f32 v[68:69], v[68:69], v[192:193], v[84:85]
  v_pk_fma_f32 v[72:73], v[72:73], v[194:195], v[84:85]
  v_pk_fma_f32 v[76:77], v[76:77], v[196:197], v[84:85]
  v_pk_fma_f32 v[80:81], v[80:81], v[198:199], v[84:85]
  v_exp_f32 v52, v52 clamp
  v_exp_f32 v53, v53 clamp
  v_exp_f32 v56, v56 clamp
  v_exp_f32 v57, v57 clamp
  v_exp_f32 v60, v60 clamp
  v_exp_f32 v61, v61 clamp
  v_exp_f32 v64, v64 clamp
  v_exp_f32 v65, v65 clamp
  v_exp_f32 v68, v68 clamp
  v_exp_f32 v69, v69 clamp
  v_exp_f32 v72, v72 clamp
  v_exp_f32 v73, v73 clamp
  v_exp_f32 v76, v76 clamp
  v_exp_f32 v77, v77 clamp
  v_exp_f32 v80, v80 clamp
  v_exp_f32 v81, v81 clamp
  v_pk_mul_f32 v[54:55], v[176:177], v[24:25]
  v_pk_mul_f32 v[58:59], v[178:179], v[26:27]
  v_pk_mul_f32 v[62:63], v[180:181], v[28:29]
  v_pk_mul_f32 v[66:67], v[182:183], v[30:31]
  v_pk_mul_f32 v[70:71], v[192:193], v[24:25]
  v_pk_mul_f32 v[74:75], v[194:195], v[26:27]
  v_pk_mul_f32 v[78:79], v[196:197], v[28:29]
  v_pk_mul_f32 v[82:83], v[198:199], v[30:31]
  v_pk_fma_f32 v[52:53], v[52:53], v[86:87], v[248:249]
  v_pk_fma_f32 v[56:57], v[56:57], v[86:87], v[248:249]
  v_pk_fma_f32 v[60:61], v[60:61], v[86:87], v[248:249]
  v_pk_fma_f32 v[64:65], v[64:65], v[86:87], v[248:249]
  v_pk_fma_f32 v[68:69], v[68:69], v[86:87], v[248:249]
  v_pk_fma_f32 v[72:73], v[72:73], v[86:87], v[248:249]
  v_pk_fma_f32 v[76:77], v[76:77], v[86:87], v[248:249]
  v_pk_fma_f32 v[80:81], v[80:81], v[86:87], v[248:249]
  v_pk_mul_f32 v[54:55], v[54:55], v[56:57]
  v_pk_mul_f32 v[62:63], v[62:63], v[64:65]
  v_pk_mul_f32 v[70:71], v[70:71], v[72:73]
  v_pk_mul_f32 v[78:79], v[78:79], v[80:81]
  v_pk_fma_f32 v[54:55], v[58:59], v[52:53], v[54:55]
  v_pk_fma_f32 v[62:63], v[66:67], v[60:61], v[62:63]
  v_pk_fma_f32 v[70:71], v[74:75], v[68:69], v[70:71]
  v_pk_fma_f32 v[78:79], v[82:83], v[76:77], v[78:79]
  v_pk_mul_f32 v[52:53], v[52:53], v[56:57]
  v_pk_mul_f32 v[60:61], v[60:61], v[64:65]
  v_pk_mul_f32 v[68:69], v[68:69], v[72:73]
  v_pk_mul_f32 v[76:77], v[76:77], v[80:81]
  v_pk_mul_f32 v[54:55], v[54:55], v[60:61]
  v_pk_mul_f32 v[70:71], v[70:71], v[76:77]
  v_pk_fma_f32 v[54:55], v[62:63], v[52:53], v[54:55]
  v_pk_fma_f32 v[70:71], v[78:79], v[68:69], v[70:71]
  v_pk_mul_f32 v[52:53], v[52:53], v[60:61]
  v_pk_mul_f32 v[68:69], v[68:69], v[76:77]
  v_rcp_f32 v52, v52
  v_rcp_f32 v53, v53
  v_rcp_f32 v68, v68
  v_rcp_f32 v69, v69
  v_pk_fma_f32 v[42:43], v[52:53], v[54:55], v[42:43]
  v_pk_fma_f32 v[44:45], v[68:69], v[70:71], v[44:45]
  v_pk_mul_f32 v[52:53], v[200:201], v[200:201]
  v_pk_mul_f32 v[56:57], v[202:203], v[202:203]
  v_pk_mul_f32 v[60:61], v[204:205], v[204:205]
  v_pk_mul_f32 v[64:65], v[206:207], v[206:207]
  v_pk_mul_f32 v[68:69], v[216:217], v[216:217]
  v_pk_mul_f32 v[72:73], v[218:219], v[218:219]
  v_pk_mul_f32 v[76:77], v[220:221], v[220:221]
  v_pk_mul_f32 v[80:81], v[222:223], v[222:223]
  v_pk_fma_f32 v[52:53], v[52:53], v[14:15], v[12:13]
  v_pk_fma_f32 v[56:57], v[56:57], v[14:15], v[12:13]
  v_pk_fma_f32 v[60:61], v[60:61], v[14:15], v[12:13]
  v_pk_fma_f32 v[64:65], v[64:65], v[14:15], v[12:13]
  v_pk_fma_f32 v[68:69], v[68:69], v[14:15], v[12:13]
  v_pk_fma_f32 v[72:73], v[72:73], v[14:15], v[12:13]
  v_pk_fma_f32 v[76:77], v[76:77], v[14:15], v[12:13]
  v_pk_fma_f32 v[80:81], v[80:81], v[14:15], v[12:13]
  v_pk_fma_f32 v[52:53], v[52:53], v[200:201], v[84:85]
  v_pk_fma_f32 v[56:57], v[56:57], v[202:203], v[84:85]
  v_pk_fma_f32 v[60:61], v[60:61], v[204:205], v[84:85]
  v_pk_fma_f32 v[64:65], v[64:65], v[206:207], v[84:85]
  v_pk_fma_f32 v[68:69], v[68:69], v[216:217], v[84:85]
  v_pk_fma_f32 v[72:73], v[72:73], v[218:219], v[84:85]
  v_pk_fma_f32 v[76:77], v[76:77], v[220:221], v[84:85]
  v_pk_fma_f32 v[80:81], v[80:81], v[222:223], v[84:85]
  v_exp_f32 v52, v52 clamp
  v_exp_f32 v53, v53 clamp
  v_exp_f32 v56, v56 clamp
  v_exp_f32 v57, v57 clamp
  v_exp_f32 v60, v60 clamp
  v_exp_f32 v61, v61 clamp
  v_exp_f32 v64, v64 clamp
  v_exp_f32 v65, v65 clamp
  v_exp_f32 v68, v68 clamp
  v_exp_f32 v69, v69 clamp
  v_exp_f32 v72, v72 clamp
  v_exp_f32 v73, v73 clamp
  v_exp_f32 v76, v76 clamp
  v_exp_f32 v77, v77 clamp
  v_exp_f32 v80, v80 clamp
  v_exp_f32 v81, v81 clamp
  v_pk_mul_f32 v[54:55], v[200:201], v[16:17]
  v_pk_mul_f32 v[58:59], v[202:203], v[18:19]
  v_pk_mul_f32 v[62:63], v[204:205], v[20:21]
  v_pk_mul_f32 v[66:67], v[206:207], v[22:23]
  v_pk_mul_f32 v[70:71], v[216:217], v[16:17]
  v_pk_mul_f32 v[74:75], v[218:219], v[18:19]
  v_pk_mul_f32 v[78:79], v[220:221], v[20:21]
  v_pk_mul_f32 v[82:83], v[222:223], v[22:23]
  v_pk_fma_f32 v[52:53], v[52:53], v[86:87], v[248:249]
  v_pk_fma_f32 v[56:57], v[56:57], v[86:87], v[248:249]
  v_pk_fma_f32 v[60:61], v[60:61], v[86:87], v[248:249]
  v_pk_fma_f32 v[64:65], v[64:65], v[86:87], v[248:249]
  v_pk_fma_f32 v[68:69], v[68:69], v[86:87], v[248:249]
  v_pk_fma_f32 v[72:73], v[72:73], v[86:87], v[248:249]
  v_pk_fma_f32 v[76:77], v[76:77], v[86:87], v[248:249]
  v_pk_fma_f32 v[80:81], v[80:81], v[86:87], v[248:249]
  v_pk_mul_f32 v[54:55], v[54:55], v[56:57]
  v_pk_mul_f32 v[62:63], v[62:63], v[64:65]
  v_pk_mul_f32 v[70:71], v[70:71], v[72:73]
  v_pk_mul_f32 v[78:79], v[78:79], v[80:81]
  v_pk_fma_f32 v[54:55], v[58:59], v[52:53], v[54:55]
  v_pk_fma_f32 v[62:63], v[66:67], v[60:61], v[62:63]
  v_pk_fma_f32 v[70:71], v[74:75], v[68:69], v[70:71]
  v_pk_fma_f32 v[78:79], v[82:83], v[76:77], v[78:79]
  v_pk_mul_f32 v[52:53], v[52:53], v[56:57]
  v_pk_mul_f32 v[60:61], v[60:61], v[64:65]
  v_pk_mul_f32 v[68:69], v[68:69], v[72:73]
  v_pk_mul_f32 v[76:77], v[76:77], v[80:81]
  v_pk_mul_f32 v[54:55], v[54:55], v[60:61]
  v_pk_mul_f32 v[70:71], v[70:71], v[76:77]
  v_pk_fma_f32 v[54:55], v[62:63], v[52:53], v[54:55]
  v_pk_fma_f32 v[70:71], v[78:79], v[68:69], v[70:71]
  v_pk_mul_f32 v[52:53], v[52:53], v[60:61]
  v_pk_mul_f32 v[68:69], v[68:69], v[76:77]
  v_rcp_f32 v52, v52
  v_rcp_f32 v53, v53
  v_rcp_f32 v68, v68
  v_rcp_f32 v69, v69
  v_pk_mul_f32 v[46:47], v[52:53], v[54:55]
  v_pk_mul_f32 v[48:49], v[68:69], v[70:71]
  v_pk_mul_f32 v[52:53], v[208:209], v[208:209]
  v_pk_mul_f32 v[56:57], v[210:211], v[210:211]
  v_pk_mul_f32 v[60:61], v[212:213], v[212:213]
  v_pk_mul_f32 v[64:65], v[214:215], v[214:215]
  v_pk_mul_f32 v[68:69], v[224:225], v[224:225]
  v_pk_mul_f32 v[72:73], v[226:227], v[226:227]
  v_pk_mul_f32 v[76:77], v[228:229], v[228:229]
  v_pk_mul_f32 v[80:81], v[230:231], v[230:231]
  v_pk_fma_f32 v[52:53], v[52:53], v[14:15], v[12:13]
  v_pk_fma_f32 v[56:57], v[56:57], v[14:15], v[12:13]
  v_pk_fma_f32 v[60:61], v[60:61], v[14:15], v[12:13]
  v_pk_fma_f32 v[64:65], v[64:65], v[14:15], v[12:13]
  v_pk_fma_f32 v[68:69], v[68:69], v[14:15], v[12:13]
  v_pk_fma_f32 v[72:73], v[72:73], v[14:15], v[12:13]
  v_pk_fma_f32 v[76:77], v[76:77], v[14:15], v[12:13]
  v_pk_fma_f32 v[80:81], v[80:81], v[14:15], v[12:13]
  v_pk_fma_f32 v[52:53], v[52:53], v[208:209], v[84:85]
  v_pk_fma_f32 v[56:57], v[56:57], v[210:211], v[84:85]
  v_pk_fma_f32 v[60:61], v[60:61], v[212:213], v[84:85]
  v_pk_fma_f32 v[64:65], v[64:65], v[214:215], v[84:85]
  v_pk_fma_f32 v[68:69], v[68:69], v[224:225], v[84:85]
  v_pk_fma_f32 v[72:73], v[72:73], v[226:227], v[84:85]
  v_pk_fma_f32 v[76:77], v[76:77], v[228:229], v[84:85]
  v_pk_fma_f32 v[80:81], v[80:81], v[230:231], v[84:85]
  v_exp_f32 v52, v52 clamp
  v_exp_f32 v53, v53 clamp
  v_exp_f32 v56, v56 clamp
  v_exp_f32 v57, v57 clamp
  v_exp_f32 v60, v60 clamp
  v_exp_f32 v61, v61 clamp
  v_exp_f32 v64, v64 clamp
  v_exp_f32 v65, v65 clamp
  v_exp_f32 v68, v68 clamp
  v_exp_f32 v69, v69 clamp
  v_exp_f32 v72, v72 clamp
  v_exp_f32 v73, v73 clamp
  v_exp_f32 v76, v76 clamp
  v_exp_f32 v77, v77 clamp
  v_exp_f32 v80, v80 clamp
  v_exp_f32 v81, v81 clamp
  v_pk_mul_f32 v[54:55], v[208:209], v[24:25]
  v_pk_mul_f32 v[58:59], v[210:211], v[26:27]
  v_pk_mul_f32 v[62:63], v[212:213], v[28:29]
  v_pk_mul_f32 v[66:67], v[214:215], v[30:31]
  v_pk_mul_f32 v[70:71], v[224:225], v[24:25]
  v_pk_mul_f32 v[74:75], v[226:227], v[26:27]
  v_pk_mul_f32 v[78:79], v[228:229], v[28:29]
  v_pk_mul_f32 v[82:83], v[230:231], v[30:31]
  v_pk_fma_f32 v[52:53], v[52:53], v[86:87], v[248:249]
  v_pk_fma_f32 v[56:57], v[56:57], v[86:87], v[248:249]
  v_pk_fma_f32 v[60:61], v[60:61], v[86:87], v[248:249]
  v_pk_fma_f32 v[64:65], v[64:65], v[86:87], v[248:249]
  v_pk_fma_f32 v[68:69], v[68:69], v[86:87], v[248:249]
  v_pk_fma_f32 v[72:73], v[72:73], v[86:87], v[248:249]
  v_pk_fma_f32 v[76:77], v[76:77], v[86:87], v[248:249]
  v_pk_fma_f32 v[80:81], v[80:81], v[86:87], v[248:249]
  v_pk_mul_f32 v[54:55], v[54:55], v[56:57]
  v_pk_mul_f32 v[62:63], v[62:63], v[64:65]
  v_pk_mul_f32 v[70:71], v[70:71], v[72:73]
  v_pk_mul_f32 v[78:79], v[78:79], v[80:81]
  v_pk_fma_f32 v[54:55], v[58:59], v[52:53], v[54:55]
  v_pk_fma_f32 v[62:63], v[66:67], v[60:61], v[62:63]
  v_pk_fma_f32 v[70:71], v[74:75], v[68:69], v[70:71]
  v_pk_fma_f32 v[78:79], v[82:83], v[76:77], v[78:79]
  v_pk_mul_f32 v[52:53], v[52:53], v[56:57]
  v_pk_mul_f32 v[60:61], v[60:61], v[64:65]
  v_pk_mul_f32 v[68:69], v[68:69], v[72:73]
  v_pk_mul_f32 v[76:77], v[76:77], v[80:81]
  v_pk_mul_f32 v[54:55], v[54:55], v[60:61]
  v_pk_mul_f32 v[70:71], v[70:71], v[76:77]
  v_pk_fma_f32 v[54:55], v[62:63], v[52:53], v[54:55]
  v_pk_fma_f32 v[70:71], v[78:79], v[68:69], v[70:71]
  v_pk_mul_f32 v[52:53], v[52:53], v[60:61]
  v_pk_mul_f32 v[68:69], v[68:69], v[76:77]
  v_rcp_f32 v52, v52
  v_rcp_f32 v53, v53
  v_rcp_f32 v68, v68
  v_rcp_f32 v69, v69
  v_pk_fma_f32 v[46:47], v[52:53], v[54:55], v[46:47]
  v_pk_fma_f32 v[48:49], v[68:69], v[70:71], v[48:49]
  v_pk_mul_f32 v[52:53], v[232:233], v[232:233]
  v_pk_mul_f32 v[56:57], v[234:235], v[234:235]
  v_pk_mul_f32 v[60:61], v[236:237], v[236:237]
  v_pk_mul_f32 v[64:65], v[238:239], v[238:239]
  v_pk_mul_f32 v[68:69], v[240:241], v[240:241]
  v_pk_mul_f32 v[72:73], v[242:243], v[242:243]
  v_pk_mul_f32 v[76:77], v[244:245], v[244:245]
  v_pk_mul_f32 v[80:81], v[246:247], v[246:247]
  v_pk_fma_f32 v[52:53], v[52:53], v[14:15], v[12:13]
  v_pk_fma_f32 v[56:57], v[56:57], v[14:15], v[12:13]
  v_pk_fma_f32 v[60:61], v[60:61], v[14:15], v[12:13]
  v_pk_fma_f32 v[64:65], v[64:65], v[14:15], v[12:13]
  v_pk_fma_f32 v[68:69], v[68:69], v[14:15], v[12:13]
  v_pk_fma_f32 v[72:73], v[72:73], v[14:15], v[12:13]
  v_pk_fma_f32 v[76:77], v[76:77], v[14:15], v[12:13]
  v_pk_fma_f32 v[80:81], v[80:81], v[14:15], v[12:13]
  v_pk_fma_f32 v[52:53], v[52:53], v[232:233], v[84:85]
  v_pk_fma_f32 v[56:57], v[56:57], v[234:235], v[84:85]
  v_pk_fma_f32 v[60:61], v[60:61], v[236:237], v[84:85]
  v_pk_fma_f32 v[64:65], v[64:65], v[238:239], v[84:85]
  v_pk_fma_f32 v[68:69], v[68:69], v[240:241], v[84:85]
  v_pk_fma_f32 v[72:73], v[72:73], v[242:243], v[84:85]
  v_pk_fma_f32 v[76:77], v[76:77], v[244:245], v[84:85]
  v_pk_fma_f32 v[80:81], v[80:81], v[246:247], v[84:85]
  v_exp_f32 v52, v52 clamp
  v_exp_f32 v53, v53 clamp
  v_exp_f32 v56, v56 clamp
  v_exp_f32 v57, v57 clamp
  v_exp_f32 v60, v60 clamp
  v_exp_f32 v61, v61 clamp
  v_exp_f32 v64, v64 clamp
  v_exp_f32 v65, v65 clamp
  v_exp_f32 v68, v68 clamp
  v_exp_f32 v69, v69 clamp
  v_exp_f32 v72, v72 clamp
  v_exp_f32 v73, v73 clamp
  v_exp_f32 v76, v76 clamp
  v_exp_f32 v77, v77 clamp
  v_exp_f32 v80, v80 clamp
  v_exp_f32 v81, v81 clamp
  v_pk_mul_f32 v[54:55], v[232:233], v[16:17]
  v_pk_mul_f32 v[58:59], v[234:235], v[18:19]
  v_pk_mul_f32 v[62:63], v[236:237], v[20:21]
  v_pk_mul_f32 v[66:67], v[238:239], v[22:23]
  v_pk_mul_f32 v[70:71], v[240:241], v[24:25]
  v_pk_mul_f32 v[74:75], v[242:243], v[26:27]
  v_pk_mul_f32 v[78:79], v[244:245], v[28:29]
  v_pk_mul_f32 v[82:83], v[246:247], v[30:31]
  v_pk_fma_f32 v[52:53], v[52:53], v[86:87], v[248:249]
  v_pk_fma_f32 v[56:57], v[56:57], v[86:87], v[248:249]
  v_pk_fma_f32 v[60:61], v[60:61], v[86:87], v[248:249]
  v_pk_fma_f32 v[64:65], v[64:65], v[86:87], v[248:249]
  v_pk_fma_f32 v[68:69], v[68:69], v[86:87], v[248:249]
  v_pk_fma_f32 v[72:73], v[72:73], v[86:87], v[248:249]
  v_pk_fma_f32 v[76:77], v[76:77], v[86:87], v[248:249]
  v_pk_fma_f32 v[80:81], v[80:81], v[86:87], v[248:249]
  v_pk_mul_f32 v[54:55], v[54:55], v[56:57]
  v_pk_mul_f32 v[62:63], v[62:63], v[64:65]
  v_pk_mul_f32 v[70:71], v[70:71], v[72:73]
  v_pk_mul_f32 v[78:79], v[78:79], v[80:81]
  v_pk_fma_f32 v[54:55], v[58:59], v[52:53], v[54:55]
  v_pk_fma_f32 v[62:63], v[66:67], v[60:61], v[62:63]
  v_pk_fma_f32 v[70:71], v[74:75], v[68:69], v[70:71]
  v_pk_fma_f32 v[78:79], v[82:83], v[76:77], v[78:79]
  v_pk_mul_f32 v[52:53], v[52:53], v[56:57]
  v_pk_mul_f32 v[60:61], v[60:61], v[64:65]
  v_pk_mul_f32 v[68:69], v[68:69], v[72:73]
  v_pk_mul_f32 v[76:77], v[76:77], v[80:81]
  v_pk_mul_f32 v[54:55], v[54:55], v[60:61]
  v_pk_mul_f32 v[70:71], v[70:71], v[76:77]
  v_pk_fma_f32 v[54:55], v[62:63], v[52:53], v[54:55]
  v_pk_fma_f32 v[70:71], v[78:79], v[68:69], v[70:71]
  v_pk_mul_f32 v[52:53], v[52:53], v[60:61]
  v_pk_mul_f32 v[68:69], v[68:69], v[76:77]
  v_rcp_f32 v52, v52
  v_rcp_f32 v53, v53
  v_rcp_f32 v68, v68
  v_rcp_f32 v69, v69
  v_pk_mul_f32 v[50:51], v[52:53], v[54:55]
  v_pk_fma_f32 v[50:51], v[68:69], v[70:71], v[50:51]
  v_pk_mul_f32 v[32:33], v[88:89], v[16:17]
  v_pk_fma_f32 v[32:33], v[90:91], v[18:19], v[32:33]
  v_pk_fma_f32 v[32:33], v[92:93], v[20:21], v[32:33]
  v_pk_fma_f32 v[32:33], v[94:95], v[22:23], v[32:33]
  v_pk_fma_f32 v[32:33], v[96:97], v[24:25], v[32:33]
  v_pk_fma_f32 v[32:33], v[98:99], v[26:27], v[32:33]
  v_pk_fma_f32 v[32:33], v[100:101], v[28:29], v[32:33]
  v_pk_fma_f32 v[32:33], v[102:103], v[30:31], v[32:33]
  v_add_f32 v32, v32, v33
  v_add_f32 v34, v34, v35
  v_add_f32 v36, v36, v37
  v_add_f32 v38, v38, v39
  v_add_f32 v40, v40, v41
  v_add_f32 v42, v42, v43
  v_add_f32 v44, v44, v45
  v_add_f32 v46, v46, v47
  v_add_f32 v48, v48, v49
  v_add_f32 v50, v50, v51
  v_permlane32_swap_b32 v32, v34
  v_permlane32_swap_b32 v36, v38
  v_permlane32_swap_b32 v40, v42
  v_permlane32_swap_b32 v44, v46
  v_permlane32_swap_b32 v48, v50
  v_add_f32 v48, v48, v50
  v_add_f32 v32, v32, v34
  v_add_f32 v36, v36, v38
  v_add_f32 v40, v40, v42
  v_add_f32 v44, v44, v46
  v_mov_b32 v50, v48
  v_permlane16_swap_b32 v32, v36
  v_permlane16_swap_b32 v40, v44
  v_permlane16_swap_b32 v48, v50
  v_add_f32 v32, v32, v36
  v_add_f32 v40, v40, v44
  v_add_f32_e64 v48, v48, v50
  ds_write_b32 v10, v32
  ds_write_b32 v10, v40 offset:256
  s_mov_b32 exec_lo, 0xffff
  s_mov_b32 exec_hi, 0xffff
  ds_write_b32 v10, v48 offset:512
  s_mov_b64 exec, -1
  s_waitcnt lgkmcnt(0)
  s_barrier
  s_endpgm
L_ld_tail0:
  s_waitcnt vmcnt(0)
L_ld_tail:
  s_barrier
  s_mov_b32 s60, s24
  s_and_b32 s61, s25, 0xffff
  s_mov_b32 s62, 268435456
  s_mov_b32 s63, 0x20000
  s_mov_b32 s56, s20
  s_and_b32 s57, s21, 0xffff
  s_mov_b32 s58, 8192
  s_mov_b32 s59, 0x20000
  s_mov_b32 s64, s22
  s_and_b32 s65, s23, 0xffff
  s_mov_b32 s66, 256
  s_mov_b32 s67, 0x20000
  s_load_dword s80, s[18:19], 0
  v_mov_b32 v100, 0
  s_mov_b64 exec, 1
  s_mov_b32 s81, 0x80000
  buffer_load_dword v101, v100, s[60:63], s81 offen
  buffer_load_dword v102, v100, s[56:59], 0 offen
  s_mov_b64 exec, -1
  s_mov_b64 exec, 1
  buffer_load_dword v250, v100, s[64:67], 0 offen offset:240 sc1
  s_mov_b64 exec, -1
  s_cmp_lg_u32 s3, 4
  s_cbranch_scc1 L_end
  v_lshlrev_b32 v3, 4, v0
  v_lshlrev_b32 v4, 2, v0
  v_add_u32 v1, 123392, v3
  v_add_u32 v2, 124416, v4
  v_add_u32 v4, 1024, v4
  v_mov_b32 v5, 32
  v_mov_b32 v7, s26
  s_mul_i32 s68, s26, 1280
  s_mul_i32 s69, s27, 16640
  s_add_u32 s69, s69, s68
  s_setprio 3
  v_mov_b32 v64, -1
  v_mov_b32 v65, -1
  v_mov_b32 v66, -1
  v_mov_b32 v67, -1
  buffer_store_dwordx4 v[64:67], v3, s[60:63], s69 offen sc1
  buffer_store_dword v64, v4, s[60:63], s69 offen sc1
  s_waitcnt vmcnt(0)
  s_barrier
  ds_read_b128 v[64:67], v1
  ds_read_b128 v[72:75], v1 offset:1280
  ds_read2st64_b32 v[68:69], v2 offset0:0 offset1:5
  s_waitcnt lgkmcnt(0)
  v_pk_add_f32 v[64:65], v[64:65], v[72:73]
  v_pk_add_f32 v[66:67], v[66:67], v[74:75]
  v_add_f32 v68, v68, v69
  v_min_u32 v64, -2, v64
  v_min_u32 v65, -2, v65
  v_min_u32 v66, -2, v66
  v_min_u32 v67, -2, v67
  v_min_u32_e64 v68, -2, v68
  buffer_store_dwordx4 v[64:67], v3, s[60:63], s69 offen sc1
  buffer_store_dword v68, v4, s[60:63], s69 offen sc1
  s_mov_b64 exec, 1
L_pub:
  v_lshlrev_b32 v6, 4, v7
  v_mov_b32 v13, v5
  buffer_atomic_add v5, v6, s[64:67], 0 offen sc0
  v_cmp_eq_u32 vcc, 12, v7
  v_mov_b32 v8, 436
  v_mov_b32 v9, 434
  v_cndmask_b32 v8, v8, v9, vcc
  v_sub_u32_e64 v8, v8, v13
  s_waitcnt vmcnt(0) lgkmcnt(0)
  v_cmp_eq_u32 s[82:83], v5, v8
  s_mov_b64 exec, -1
  s_lshl_b32 s80, s80, 16
  v_lshrrev_b32 v1, 1, v3
  v_lshrrev_b32_e64 v2, 1, v4
L_fin:
  s_cmp_eq_u32 s82, 0
  s_cbranch_scc1 L_done
  s_ff1_i32_b32 s70, s82
  s_bitset0_b32 s82, s70
  v_readlane_b32 s71, v7, s70
  s_waitcnt vmcnt(0)
L_again:
  s_mul_i32 s68, s71, 1280
  buffer_load_dwordx4 v[64:67], v3, s[60:63], s68 offen sc1
  buffer_load_dword v68, v4, s[60:63], s68 offen sc1
  s_add_u32 s68, s68, 16640
  buffer_load_dwordx4 v[72:75], v3, s[60:63], s68 offen sc1
  buffer_load_dword v76, v4, s[60:63], s68 offen sc1
  s_add_u32 s68, s68, 16640
  buffer_load_dwordx4 v[80:83], v3, s[60:63], s68 offen sc1
  buffer_load_dword v84, v4, s[60:63], s68 offen sc1
  s_add_u32 s68, s68, 16640
  buffer_load_dwordx4 v[88:91], v3, s[60:63], s68 offen sc1
  buffer_load_dword v92, v4, s[60:63], s68 offen sc1
  s_add_u32 s68, s68, 16640
  buffer_load_dwordx4 v[96:99], v3, s[60:63], s68 offen sc1
  buffer_load_dword v100, v4, s[60:63], s68 offen sc1
  s_add_u32 s68, s68, 16640
  buffer_load_dwordx4 v[104:107], v3, s[60:63], s68 offen sc1
  buffer_load_dword v108, v4, s[60:63], s68 offen sc1
  s_add_u32 s68, s68, 16640
  buffer_load_dwordx4 v[112:115], v3, s[60:63], s68 offen sc1
  buffer_load_dword v116, v4, s[60:63], s68 offen sc1
  s_add_u32 s68, s68, 16640
  buffer_load_dwordx4 v[120:123], v3, s[60:63], s68 offen sc1
  buffer_load_dword v124, v4, s[60:63], s68 offen sc1
  s_add_u32 s68, s68, 16640
  buffer_load_dwordx4 v[128:131], v3, s[60:63], s68 offen sc1
  buffer_load_dword v132, v4, s[60:63], s68 offen sc1
  s_add_u32 s68, s68, 16640
  buffer_load_dwordx4 v[136:139], v3, s[60:63], s68 offen sc1
  buffer_load_dword v140, v4, s[60:63], s68 offen sc1
  s_add_u32 s68, s68, 16640
  buffer_load_dwordx4 v[144:147], v3, s[60:63], s68 offen sc1
  buffer_load_dword v148, v4, s[60:63], s68 offen sc1
  s_add_u32 s68, s68, 16640
  buffer_load_dwordx4 v[152:155], v3, s[60:63], s68 offen sc1
  buffer_load_dword v156, v4, s[60:63], s68 offen sc1
  s_add_u32 s68, s68, 16640
  buffer_load_dwordx4 v[160:163], v3, s[60:63], s68 offen sc1
  buffer_load_dword v164, v4, s[60:63], s68 offen sc1
  s_add_u32 s68, s68, 16640
  buffer_load_dwordx4 v[168:171], v3, s[60:63], s68 offen sc1
  buffer_load_dword v172, v4, s[60:63], s68 offen sc1
  s_add_u32 s68, s68, 16640
L_sum:
  s_waitcnt vmcnt(25)
  v_pk_add_f32 v[56:57], v[64:65], v[72:73]
  v_pk_add_f32 v[58:59], v[66:67], v[74:75]
  s_waitcnt vmcnt(24)
  v_add_f32 v60, v68, v76
  s_waitcnt vmcnt(23)
  v_pk_add_f32 v[56:57], v[56:57], v[80:81]
  v_pk_add_f32 v[58:59], v[58:59], v[82:83]
  s_waitcnt vmcnt(22)
  v_add_f32 v60, v60, v84
  s_waitcnt vmcnt(21)
  v_pk_add_f32 v[56:57], v[56:57], v[88:89]
  v_pk_add_f32 v[58:59], v[58:59], v[90:91]
  s_waitcnt vmcnt(20)
  v_add_f32 v60, v60, v92
  s_waitcnt vmcnt(19)
  v_pk_add_f32 v[56:57], v[56:57], v[96:97]
  v_pk_add_f32 v[58:59], v[58:59], v[98:99]
  s_waitcnt vmcnt(18)
  v_add_f32 v60, v60, v100
  s_waitcnt vmcnt(17)
  v_pk_add_f32 v[56:57], v[56:57], v[104:105]
  v_pk_add_f32 v[58:59], v[58:59], v[106:107]
  s_waitcnt vmcnt(16)
  v_add_f32 v60, v60, v108
  s_waitcnt vmcnt(15)
  v_pk_add_f32 v[56:57], v[56:57], v[112:113]
  v_pk_add_f32 v[58:59], v[58:59], v[114:115]
  s_waitcnt vmcnt(14)
  v_add_f32_e64 v60, v60, v116
  s_waitcnt vmcnt(13)
  v_pk_add_f32 v[56:57], v[56:57], v[120:121]
  v_pk_add_f32 v[58:59], v[58:59], v[122:123]
  s_waitcnt vmcnt(12)
  v_add_f32 v60, v60, v124
  s_waitcnt vmcnt(11)
  v_pk_add_f32 v[56:57], v[56:57], v[128:129]
  v_pk_add_f32 v[58:59], v[58:59], v[130:131]
  s_waitcnt vmcnt(10)
  v_add_f32 v60, v60, v132
  s_waitcnt vmcnt(9)
  v_pk_add_f32 v[56:57], v[56:57], v[136:137]
  v_pk_add_f32 v[58:59], v[58:59], v[138:139]
  s_waitcnt vmcnt(8)
  v_add_f32 v60, v60, v140
  s_waitcnt vmcnt(7)
  v_pk_add_f32 v[56:57], v[56:57], v[144:145]
  v_pk_add_f32 v[58:59], v[58:59], v[146:147]
  s_waitcnt vmcnt(6)
  v_add_f32 v60, v60, v148
  s_waitcnt vmcnt(5)
  v_pk_add_f32 v[56:57], v[56:57], v[152:153]
  v_pk_add_f32 v[58:59], v[58:59], v[154:155]
  s_waitcnt vmcnt(4)
  v_add_f32 v60, v60, v156
  s_waitcnt vmcnt(3)
  v_pk_add_f32 v[56:57], v[56:57], v[160:161]
  v_pk_add_f32 v[58:59], v[58:59], v[162:163]
  s_waitcnt vmcnt(2)
  v_add_f32 v60, v60, v164
  s_waitcnt vmcnt(1)
  v_pk_add_f32 v[56:57], v[56:57], v[168:169]
  v_pk_add_f32 v[58:59], v[58:59], v[170:171]
  s_waitcnt vmcnt(0)
  v_add_f32 v60, v60, v172
  v_cmp_u_f32 vcc, v56, v57
  v_cmp_u_f32 s[92:93], v58, v59
  s_nop 0
  s_or_b64 s[92:93], s[92:93], vcc
  v_cmp_u_f32 vcc, v60, v60
  s_nop 0
  s_or_b64 vcc, s[92:93], vcc
  s_cbranch_vccnz L_chk
L_ok:
  s_mul_i32 s71, s71, 640
  v_add_f32 v56, s80, v56
  v_add_f32 v57, s80, v57
  v_add_f32 v58, s80, v58
  v_add_f32 v59, s80, v59
  v_add_f32 v60, s80, v60
  v_cvt_pk_bf16_f32 v10, v56, v57
  v_cvt_pk_bf16_f32 v11, v58, v59
  v_cvt_pk_bf16_f32 v12, v60, v60
  buffer_store_dwordx2 v[10:11], v1, s[56:59], s71 offen
  buffer_store_short v12, v2, s[56:59], s71 offen
  s_branch L_fin
L_chk:
  v_mov_b32 v14, 0
  v_mov_b32_e64 v15, 0
  v_max3_u32 v14, v14, v64, v65
  v_max3_u32 v14, v14, v66, v67
  v_max_u32 v15, v15, v68
  v_max3_u32 v14, v14, v72, v73
  v_max3_u32 v14, v14, v74, v75
  v_max_u32 v15, v15, v76
  v_max3_u32 v14, v14, v80, v81
  v_max3_u32 v14, v14, v82, v83
  v_max_u32_e64 v15, v15, v84
  v_max3_u32 v14, v14, v88, v89
  v_max3_u32 v14, v14, v90, v91
  v_max_u32 v15, v15, v92
  v_max3_u32 v14, v14, v96, v97
  v_max3_u32 v14, v14, v98, v99
  v_max_u32 v15, v15, v100
  v_max3_u32 v14, v14, v104, v105
  v_max3_u32 v14, v14, v106, v107
  v_max_u32_e64 v15, v15, v108
  v_max3_u32 v14, v14, v112, v113
  v_max3_u32 v14, v14, v114, v115
  v_max_u32 v15, v15, v116
  v_max3_u32 v14, v14, v120, v121
  v_max3_u32 v14, v14, v122, v123
  v_max_u32 v15, v15, v124
  v_max3_u32 v14, v14, v128, v129
  v_max3_u32 v14, v14, v130, v131
  v_max_u32_e64 v15, v15, v132
  v_max3_u32 v14, v14, v136, v137
  v_max3_u32 v14, v14, v138, v139
  v_max_u32 v15, v15, v140
  v_max3_u32 v14, v14, v144, v145
  v_max3_u32 v14, v14, v146, v147
  v_max_u32 v15, v15, v148
  v_max3_u32 v14, v14, v152, v153
  v_max3_u32 v14, v14, v154, v155
  v_max_u32_e64 v15, v15, v156
  v_max3_u32 v14, v14, v160, v161
  v_max3_u32 v14, v14, v162, v163
  v_max_u32 v15, v15, v164
  v_max3_u32 v14, v14, v168, v169
  v_max3_u32 v14, v14, v170, v171
  v_max_u32 v15, v15, v172
  s_cmp_eq_u32 s71, 12
  s_cselect_b32 s68, 0, -1
  v_and_b32 v15, s68, v15
  v_max_u32 v14, v14, v15
  v_cmp_eq_u32 vcc, -1, v14
  s_cbranch_vccnz L_again
  s_branch L_ok
L_done:
  s_endpgm
L_cin_done:
  s_mul_i32 s98, s3, 1536
  s_add_u32 s98, s98, 116736
  v_lshlrev_b32 v120, 5, v0
  v_add_u32 v120, s98, v120
  ds_read_b128 v[60:63], v120
  ds_read_b128 v[64:67], v120 offset:16
  v_mul_f32 v116, v184, v192
  v_mul_f32 v117, v185, v193
  v_mul_f32 v118, v186, v194
  v_mul_f32 v119, v187, v195
  v_fmac_f32 v116, v188, v191
  v_fmac_f32 v117, v200, v208
  v_fmac_f32 v118, v201, v209
  v_fmac_f32 v119, v202, v210
  v_fmac_f32 v116, v203, v211
  v_fmac_f32 v117, v204, v207
  v_fmac_f32 v118, v216, v224
  v_fmac_f32 v119, v217, v225
  v_fmac_f32 v116, v218, v226
  v_fmac_f32 v117, v219, v227
  v_fmac_f32 v118, v220, v223
  v_fmac_f32 v119, v232, v240
  v_fmac_f32 v116, v233, v241
  v_fmac_f32 v117, v234, v242
  v_fmac_f32 v118, v235, v243
  v_fmac_f32 v119, v236, v239
  v_fmac_f32 v116, v189, v196
  v_fmac_f32 v117, v189, v197
  v_fmac_f32 v118, v190, v198
  v_fmac_f32 v119, v190, v199
  v_fmac_f32 v116, v205, v212
  v_fmac_f32 v117, v205, v213
  v_fmac_f32 v118, v206, v214
  v_fmac_f32 v119, v206, v215
  v_fmac_f32 v116, v221, v228
  v_fmac_f32 v117, v221, v229
  v_fmac_f32 v118, v222, v230
  v_fmac_f32 v119, v222, v231
  v_fmac_f32 v116, v237, v244
  v_fmac_f32 v117, v237, v245
  v_fmac_f32 v118, v238, v246
  v_fmac_f32 v119, v238, v247
  v_add_f32 v116, v116, v117
  v_add_f32 v118, v118, v119
  v_add_f32 v116, v116, v118
  v_mul_f32 v116, s74, v116
  v_mul_f32 v116, s75, v116
  s_nop 1
  v_add_f32_dpp v116, v116, v116 row_shr:1 row_mask:0xf bank_mask:0xf
  v_subrev_u32 v122, s98, v7
  v_lshrrev_b32 v122, 8, v122
  v_lshrrev_b32 v121, 3, v0
  v_add_f32_dpp v116, v116, v116 row_shr:2 row_mask:0xf bank_mask:0xf
  v_cmp_gt_u32 vcc, v122, v121
  v_min_u32 v121, v121, v122
  v_lshlrev_b32 v121, 4, v121
  v_add_f32_dpp v116, v116, v116 row_shr:4 row_mask:0xf bank_mask:0xf
  v_add_u32 v121, s85, v121
  s_waitcnt lgkmcnt(1)
  v_add_f32 v60, v60, v61
  v_add_f32 v62, v62, v63
  v_add_f32_dpp v116, v116, v116 row_shr:8 row_mask:0xf bank_mask:0xf
  s_waitcnt lgkmcnt(0)
  v_add_f32 v64, v64, v65
  v_add_f32 v66, v66, v67
  v_add_f32 v60, v60, v62
  v_add_f32_dpp v116, v116, v116 row_bcast:15 row_mask:0xa bank_mask:0xf
  v_add_f32 v64, v64, v66
  v_add_f32_e64 v60, v60, v64
  s_nop 1
  v_add_f32_dpp v60, v60, v60 quad_perm:[1,0,3,2] row_mask:0xf bank_mask:0xf
  v_add_f32_dpp v116, v116, v116 row_bcast:31 row_mask:0xc bank_mask:0xf
  s_nop 0
  v_add_f32_dpp v60, v60, v60 quad_perm:[2,3,0,1] row_mask:0xf bank_mask:0xf
  s_nop 1
  v_add_f32_dpp v60, v60, v60 row_half_mirror row_mask:0xf bank_mask:0xf
  v_cndmask_b32 v60, v116, v60, vcc
  s_bitset1_b32 vcc_hi, 31
  s_mov_b64 exec, vcc
  ds_write_b32 v121, v60
  s_mov_b64 exec, -1
  s_cmp_eq_u32 s3, 0
  s_cbranch_scc1 L_cpub
  s_waitcnt lgkmcnt(0)
  s_barrier
  s_endpgm
L_cpub:
  s_load_dword s80, s[18:19], 0
  s_mov_b32 s60, s24
  s_and_b32 s61, s25, 0xffff
  s_mov_b32 s62, 268435456
  s_mov_b32 s63, 0x20000
  s_mov_b32 s56, s20
  s_and_b32 s57, s21, 0xffff
  s_mov_b32 s58, 8192
  s_mov_b32 s59, 0x20000
  s_mov_b32 s64, s22
  s_and_b32 s65, s23, 0xffff
  s_mov_b32 s66, 256
  s_mov_b32 s67, 0x20000
  v_lshlrev_b32_e64 v6, 2, v0
  v_add_u32 v2, 129728, v6
  v_add_u32 v4, 1024, v6
  s_mul_i32 s69, s26, 192
  s_add_u32 s69, s69, 216320
  v_mov_b32 v13, -1
  s_mov_b32 exec_hi, 0xffff
  buffer_store_dword v13, v6, s[60:63], s69 offen sc1
  s_mov_b64 exec, 1
  buffer_load_dword v250, v6, s[56:59], 0 offen
  buffer_load_dword v251, v6, s[64:67], 0 offen offset:240 sc1
  s_mov_b64 exec, -1
  s_mul_i32 s68, s26, 3
  s_mul_i32 s70, s68, 3277
  s_lshr_b32 s70, s70, 16
  v_add_u32 v7, s70, v0
  s_mul_i32 s70, s70, 20
  s_add_u32 s70, s70, 20
  s_sub_u32 s70, s70, s68
  s_min_u32 s70, s70, 3
  s_sub_u32 s68, 3, s70
  v_mov_b32 v5, s68
  v_writelane_b32 v5, s70, 0
  s_cmp_eq_u32 s68, 0
  s_cselect_b32 s68, 1, 3
  v_lshlrev_b32 v3, 4, v0
  s_mov_b32 exec_hi, 0xffff
  s_waitcnt vmcnt(0) lgkmcnt(0)
  s_barrier
  ds_read_b32 v64, v2
  s_waitcnt lgkmcnt(0)
  v_min_u32_e64 v64, -2, v64
  buffer_store_dword v64, v6, s[60:63], s69 offen sc1
  s_mov_b32 exec_lo, s68
  s_mov_b32 exec_hi, 0
  s_branch L_pub
L_dnn_loop1:
  s_barrier
L_ld_in:
  s_add_u32 m0, s75, 131072
  s_nop 0
  buffer_load_dwordx4 v4, s[44:47], s74 offen lds
  s_add_u32 m0, s75, 132096
  s_nop 0
  buffer_load_dwordx4 v5, s[44:47], s74 offen lds
  s_add_u32 s74, s74, 106496
  s_add_u32 m0, s75, 139264
  s_nop 0
  buffer_load_dwordx4 v4, s[44:47], s74 offen lds
  s_add_u32 m0, s75, 140288
  s_nop 0
  buffer_load_dwordx4 v5, s[44:47], s74 offen lds
  s_add_u32 s74, s74, 106496
  s_add_u32 m0, s76, 0
  s_nop 0
  buffer_load_dwordx4 v56, s[32:35], 0 offen lds
  s_add_u32 m0, s76, 2048
  v_add_u32_dpp v56, v16, v2 row_newbcast:1 row_mask:0xf bank_mask:0x3
  buffer_load_dwordx4 v57, s[32:35], 0 offen lds
  s_nop 0
  v_add_u32_dpp v56, v18, v2 row_newbcast:7 row_mask:0xf bank_mask:0xc
  s_add_u32 m0, s76, 4096
  v_add_u32_dpp v57, v20, v2 row_newbcast:1 row_mask:0xf bank_mask:0x3
  buffer_load_dwordx4 v58, s[32:35], 0 offen lds
  s_nop 0
  v_add_u32_dpp v57, v22, v2 row_newbcast:7 row_mask:0xf bank_mask:0xc
  s_add_u32 m0, s76, 6144
  v_add_u32_dpp v58, v24, v2 row_newbcast:1 row_mask:0xf bank_mask:0x3
  buffer_load_dwordx4 v59, s[32:35], 0 offen lds
  s_nop 0
  v_add_u32_dpp v58, v26, v2 row_newbcast:7 row_mask:0xf bank_mask:0xc
  s_add_u32 m0, s76, 8192
  v_add_u32_dpp v59, v28, v2 row_newbcast:1 row_mask:0xf bank_mask:0x3
  buffer_load_dwordx4 v60, s[32:35], 0 offen lds
  s_nop 0
  v_add_u32_dpp v59, v30, v2 row_newbcast:7 row_mask:0xf bank_mask:0xc
  s_add_u32 m0, s76, 10240
  v_add_u32_dpp v60, v32, v2 row_newbcast:1 row_mask:0xf bank_mask:0x3
  buffer_load_dwordx4 v61, s[32:35], 0 offen lds
  s_nop 0
  v_add_u32_dpp v60, v34, v2 row_newbcast:7 row_mask:0xf bank_mask:0xc
  s_add_u32 m0, s76, 12288
  v_add_u32_dpp v61, v36, v2 row_newbcast:1 row_mask:0xf bank_mask:0x3
  buffer_load_dwordx4 v62, s[32:35], 0 offen lds
  s_nop 0
  v_add_u32_dpp v61, v38, v2 row_newbcast:7 row_mask:0xf bank_mask:0xc
  s_add_u32 m0, s76, 14336
  v_add_u32_dpp v62, v40, v2 row_newbcast:1 row_mask:0xf bank_mask:0x3
  buffer_load_dwordx4 v63, s[32:35], 0 offen lds
  s_nop 0
  v_add_u32_dpp v62, v42, v2 row_newbcast:7 row_mask:0xf bank_mask:0xc
  s_add_u32 m0, s76, 16384
  v_add_u32_dpp v63, v44, v2 row_newbcast:1 row_mask:0xf bank_mask:0x3
  buffer_load_dwordx4 v64, s[32:35], 0 offen lds
  s_nop 0
  v_add_u32_dpp v63, v46, v2 row_newbcast:7 row_mask:0xf bank_mask:0xc
  s_add_u32 m0, s76, 18432
  v_add_u32_dpp v64, v48, v2 row_newbcast:1 row_mask:0xf bank_mask:0x3
  buffer_load_dwordx4 v65, s[32:35], 0 offen lds
  s_nop 0
  v_add_u32_dpp v64, v50, v2 row_newbcast:7 row_mask:0xf bank_mask:0xc
  v_add_u32_dpp v65, v52, v2 row_newbcast:1 row_mask:0xf bank_mask:0x3
  s_nop 1
  v_add_u32_dpp v65, v54, v2 row_newbcast:7 row_mask:0xf bank_mask:0xc
  s_mov_b64 exec, 0x3ff
  buffer_load_dword v103, v84, s[44:47], s85 offen
  s_mov_b64 exec, -1
  s_add_u32 s85, s85, 865280
  s_waitcnt vmcnt(11)
  s_barrier
  s_add_u32 m0, s75, 147456
  s_nop 0
  buffer_load_dwordx4 v4, s[44:47], s74 offen lds
  s_add_u32 m0, s75, 148480
  s_nop 0
  buffer_load_dwordx4 v5, s[44:47], s74 offen lds
  s_add_u32 s74, s74, 106496
  s_add_u32 m0, s75, 155648
  s_nop 0
  buffer_load_dwordx4 v4, s[44:47], s74 offen lds
  s_add_u32 m0, s75, 156672
  s_nop 0
  buffer_load_dwordx4 v5, s[44:47], s74 offen lds
  s_add_u32 s74, s74, 106496
  s_add_u32 m0, s76, 40960
  s_nop 0
  buffer_load_dwordx4 v56, s[32:35], 0 offen lds
  s_add_u32 m0, s76, 43008
  v_add_u32_dpp v56, v17, v2 row_newbcast:1 row_mask:0xf bank_mask:0x3
  buffer_load_dwordx4 v57, s[32:35], 0 offen lds
  s_nop 0
  v_add_u32_dpp v56, v19, v2 row_newbcast:7 row_mask:0xf bank_mask:0xc
  s_add_u32 m0, s76, 45056
  v_add_u32_dpp v57, v21, v2 row_newbcast:1 row_mask:0xf bank_mask:0x3
  buffer_load_dwordx4 v58, s[32:35], 0 offen lds
  s_nop 0
  v_add_u32_dpp v57, v23, v2 row_newbcast:7 row_mask:0xf bank_mask:0xc
  s_add_u32 m0, s76, 47104
  v_add_u32_dpp v58, v25, v2 row_newbcast:1 row_mask:0xf bank_mask:0x3
  buffer_load_dwordx4 v59, s[32:35], 0 offen lds
  s_nop 0
  v_add_u32_dpp v58, v27, v2 row_newbcast:7 row_mask:0xf bank_mask:0xc
  s_add_u32 m0, s76, 49152
  v_add_u32_dpp v59, v29, v2 row_newbcast:1 row_mask:0xf bank_mask:0x3
  buffer_load_dwordx4 v60, s[32:35], 0 offen lds
  s_nop 0
  v_add_u32_dpp v59, v31, v2 row_newbcast:7 row_mask:0xf bank_mask:0xc
  s_add_u32 m0, s76, 51200
  v_add_u32_dpp v60, v33, v2 row_newbcast:1 row_mask:0xf bank_mask:0x3
  buffer_load_dwordx4 v61, s[32:35], 0 offen lds
  s_nop 0
  v_add_u32_dpp v60, v35, v2 row_newbcast:7 row_mask:0xf bank_mask:0xc
  s_add_u32 m0, s76, 53248
  v_add_u32_dpp v61, v37, v2 row_newbcast:1 row_mask:0xf bank_mask:0x3
  buffer_load_dwordx4 v62, s[32:35], 0 offen lds
  s_nop 0
  v_add_u32_dpp v61, v39, v2 row_newbcast:7 row_mask:0xf bank_mask:0xc
  s_add_u32 m0, s76, 55296
  v_add_u32_dpp v62, v41, v2 row_newbcast:1 row_mask:0xf bank_mask:0x3
  buffer_load_dwordx4 v63, s[32:35], 0 offen lds
  s_nop 0
  v_add_u32_dpp v62, v43, v2 row_newbcast:7 row_mask:0xf bank_mask:0xc
  s_add_u32 m0, s76, 57344
  v_add_u32_dpp v63, v45, v2 row_newbcast:1 row_mask:0xf bank_mask:0x3
  buffer_load_dwordx4 v64, s[32:35], 0 offen lds
  s_nop 0
  v_add_u32_dpp v63, v47, v2 row_newbcast:7 row_mask:0xf bank_mask:0xc
  s_add_u32 m0, s76, 59392
  v_add_u32_dpp v64, v49, v2 row_newbcast:1 row_mask:0xf bank_mask:0x3
  buffer_load_dwordx4 v65, s[32:35], 0 offen lds
  s_nop 0
  v_add_u32_dpp v64, v51, v2 row_newbcast:7 row_mask:0xf bank_mask:0xc
  v_add_u32_dpp v65, v53, v2 row_newbcast:1 row_mask:0xf bank_mask:0x3
  s_nop 1
  v_add_u32_dpp v65, v55, v2 row_newbcast:7 row_mask:0xf bank_mask:0xc
  v_lshlrev_b32 v101, 7, v70
  s_mov_b32 exec_lo, 0xffffffff
  s_mov_b32 exec_hi, 0x0
  buffer_load_dword v102, v101, s[32:35], 0 offen
  s_mov_b64 exec, -1
  v_mov_b32 v70, v71
  v_mov_b32 v71, v72
  v_mov_b32 v72, v73
  v_mov_b32_e64 v73, v74
  v_mov_b32 v74, 0xffffff
  s_waitcnt vmcnt(11)
  s_barrier
  s_add_u32 m0, s75, 131072
  s_nop 0
  buffer_load_dwordx4 v4, s[44:47], s74 offen lds
  s_add_u32 m0, s75, 132096
  s_nop 0
  buffer_load_dwordx4 v5, s[44:47], s74 offen lds
  s_add_u32 s74, s74, 106496
  s_add_u32 m0, s75, 139264
  s_nop 0
  buffer_load_dwordx4 v4, s[44:47], s74 offen lds
  s_add_u32 m0, s75, 140288
  s_nop 0
  buffer_load_dwordx4 v5, s[44:47], s74 offen lds
  s_add_u32 s74, s74, 106496
  s_add_u32 m0, s76, 81920
  s_nop 0
  buffer_load_dwordx4 v56, s[32:35], 0 offen lds
  s_add_u32 m0, s76, 83968
  v_add_u32_dpp v56, v18, v2 row_newbcast:1 row_mask:0xf bank_mask:0x3
  buffer_load_dwordx4 v57, s[32:35], 0 offen lds
  s_nop 0
  v_add_u32_dpp v56, v16, v2 row_newbcast:8 row_mask:0xf bank_mask:0xc
  s_add_u32 m0, s76, 86016
  v_add_u32_dpp v57, v22, v2 row_newbcast:1 row_mask:0xf bank_mask:0x3
  buffer_load_dwordx4 v58, s[32:35], 0 offen lds
  s_nop 0
  v_add_u32_dpp v57, v20, v2 row_newbcast:8 row_mask:0xf bank_mask:0xc
  s_add_u32 m0, s76, 88064
  v_add_u32_dpp v58, v26, v2 row_newbcast:1 row_mask:0xf bank_mask:0x3
  buffer_load_dwordx4 v59, s[32:35], 0 offen lds
  s_nop 0
  v_add_u32_dpp v58, v24, v2 row_newbcast:8 row_mask:0xf bank_mask:0xc
  s_add_u32 m0, s76, 90112
  v_add_u32_dpp v59, v30, v2 row_newbcast:1 row_mask:0xf bank_mask:0x3
  buffer_load_dwordx4 v60, s[32:35], 0 offen lds
  s_nop 0
  v_add_u32_dpp v59, v28, v2 row_newbcast:8 row_mask:0xf bank_mask:0xc
  s_add_u32 m0, s76, 92160
  v_add_u32_dpp v60, v34, v2 row_newbcast:1 row_mask:0xf bank_mask:0x3
  buffer_load_dwordx4 v61, s[32:35], 0 offen lds
  s_nop 0
  v_add_u32_dpp v60, v32, v2 row_newbcast:8 row_mask:0xf bank_mask:0xc
  s_add_u32 m0, s76, 94208
  v_add_u32_dpp v61, v38, v2 row_newbcast:1 row_mask:0xf bank_mask:0x3
  buffer_load_dwordx4 v62, s[32:35], 0 offen lds
  s_nop 0
  v_add_u32_dpp v61, v36, v2 row_newbcast:8 row_mask:0xf bank_mask:0xc
  s_add_u32 m0, s76, 96256
  v_add_u32_dpp v62, v42, v2 row_newbcast:1 row_mask:0xf bank_mask:0x3
  buffer_load_dwordx4 v63, s[32:35], 0 offen lds
  s_nop 0
  v_add_u32_dpp v62, v40, v2 row_newbcast:8 row_mask:0xf bank_mask:0xc
  s_add_u32 m0, s76, 98304
  v_add_u32_dpp v63, v46, v2 row_newbcast:1 row_mask:0xf bank_mask:0x3
  buffer_load_dwordx4 v64, s[32:35], 0 offen lds
  s_nop 0
  v_add_u32_dpp v63, v44, v2 row_newbcast:8 row_mask:0xf bank_mask:0xc
  s_add_u32 m0, s76, 100352
  v_add_u32_dpp v64, v50, v2 row_newbcast:1 row_mask:0xf bank_mask:0x3
  buffer_load_dwordx4 v65, s[32:35], 0 offen lds
  s_nop 0
  v_add_u32_dpp v64, v48, v2 row_newbcast:8 row_mask:0xf bank_mask:0xc
  v_add_u32_dpp v65, v54, v2 row_newbcast:1 row_mask:0xf bank_mask:0x3
  s_nop 1
  v_add_u32_dpp v65, v52, v2 row_newbcast:8 row_mask:0xf bank_mask:0xc
  s_waitcnt vmcnt(10)
  s_barrier
  s_add_u32 m0, s75, 147456
  s_nop 0
  buffer_load_dwordx4 v4, s[44:47], s74 offen lds
  s_add_u32 m0, s75, 148480
  s_nop 0
  buffer_load_dwordx4 v5, s[44:47], s74 offen lds
  s_add_u32 s74, s74, 106496
  s_add_u32 m0, s75, 155648
  s_nop 0
  buffer_load_dwordx4 v4, s[44:47], s74 offen lds
  s_add_u32 m0, s75, 156672
  s_nop 0
  buffer_load_dwordx4 v5, s[44:47], s74 offen lds
  s_add_u32 s74, s74, 106496
  s_add_u32 m0, s76, 0
  s_nop 0
  buffer_load_dwordx4 v56, s[32:35], 0 offen lds
  s_add_u32 m0, s76, 2048
  v_add_u32_dpp v56, v19, v2 row_newbcast:1 row_mask:0xf bank_mask:0x3
  buffer_load_dwordx4 v57, s[32:35], 0 offen lds
  s_nop 0
  v_add_u32_dpp v56, v17, v2 row_newbcast:8 row_mask:0xf bank_mask:0xc
  s_add_u32 m0, s76, 4096
  v_add_u32_dpp v57, v23, v2 row_newbcast:1 row_mask:0xf bank_mask:0x3
  buffer_load_dwordx4 v58, s[32:35], 0 offen lds
  s_nop 0
  v_add_u32_dpp v57, v21, v2 row_newbcast:8 row_mask:0xf bank_mask:0xc
  s_add_u32 m0, s76, 6144
  v_add_u32_dpp v58, v27, v2 row_newbcast:1 row_mask:0xf bank_mask:0x3
  buffer_load_dwordx4 v59, s[32:35], 0 offen lds
  s_nop 0
  v_add_u32_dpp v58, v25, v2 row_newbcast:8 row_mask:0xf bank_mask:0xc
  s_add_u32 m0, s76, 8192
  v_add_u32_dpp v59, v31, v2 row_newbcast:1 row_mask:0xf bank_mask:0x3
  buffer_load_dwordx4 v60, s[32:35], 0 offen lds
  s_nop 0
  v_add_u32_dpp v59, v29, v2 row_newbcast:8 row_mask:0xf bank_mask:0xc
  s_add_u32 m0, s76, 10240
  v_add_u32_dpp v60, v35, v2 row_newbcast:1 row_mask:0xf bank_mask:0x3
  buffer_load_dwordx4 v61, s[32:35], 0 offen lds
  s_nop 0
  v_add_u32_dpp v60, v33, v2 row_newbcast:8 row_mask:0xf bank_mask:0xc
  s_add_u32 m0, s76, 12288
  v_add_u32_dpp v61, v39, v2 row_newbcast:1 row_mask:0xf bank_mask:0x3
  buffer_load_dwordx4 v62, s[32:35], 0 offen lds
  s_nop 0
  v_add_u32_dpp v61, v37, v2 row_newbcast:8 row_mask:0xf bank_mask:0xc
  s_add_u32 m0, s76, 14336
  v_add_u32_dpp v62, v43, v2 row_newbcast:1 row_mask:0xf bank_mask:0x3
  buffer_load_dwordx4 v63, s[32:35], 0 offen lds
  s_nop 0
  v_add_u32_dpp v62, v41, v2 row_newbcast:8 row_mask:0xf bank_mask:0xc
  s_add_u32 m0, s76, 16384
  v_add_u32_dpp v63, v47, v2 row_newbcast:1 row_mask:0xf bank_mask:0x3
  buffer_load_dwordx4 v64, s[32:35], 0 offen lds
  s_nop 0
  v_add_u32_dpp v63, v45, v2 row_newbcast:8 row_mask:0xf bank_mask:0xc
  s_add_u32 m0, s76, 18432
  v_add_u32_dpp v64, v51, v2 row_newbcast:1 row_mask:0xf bank_mask:0x3
  buffer_load_dwordx4 v65, s[32:35], 0 offen lds
  s_nop 0
  v_add_u32_dpp v64, v49, v2 row_newbcast:8 row_mask:0xf bank_mask:0xc
  v_add_u32_dpp v65, v55, v2 row_newbcast:1 row_mask:0xf bank_mask:0x3
  s_nop 1
  v_add_u32_dpp v65, v53, v2 row_newbcast:8 row_mask:0xf bank_mask:0xc
  s_waitcnt vmcnt(10)
  s_barrier
  s_add_u32 m0, s75, 131072
  s_nop 0
  buffer_load_dwordx4 v4, s[44:47], s74 offen lds
  s_add_u32 m0, s75, 132096
  s_nop 0
  buffer_load_dwordx4 v5, s[44:47], s74 offen lds
  s_add_u32 s74, s74, 106496
  s_add_u32 m0, s75, 139264
  s_nop 0
  buffer_load_dwordx4 v4, s[44:47], s74 offen lds
  s_add_u32 m0, s75, 140288
  s_nop 0
  buffer_load_dwordx4 v5, s[44:47], s74 offen lds
  s_add_u32 s74, s74, 106496
  s_add_u32 m0, s76, 40960
  s_nop 0
  buffer_load_dwordx4 v56, s[32:35], 0 offen lds
  s_add_u32 m0, s76, 43008
  v_add_u32_dpp v56, v16, v2 row_newbcast:2 row_mask:0xf bank_mask:0x3
  buffer_load_dwordx4 v57, s[32:35], 0 offen lds
  s_nop 0
  v_add_u32_dpp v56, v18, v2 row_newbcast:8 row_mask:0xf bank_mask:0xc
  s_add_u32 m0, s76, 45056
  v_add_u32_dpp v57, v20, v2 row_newbcast:2 row_mask:0xf bank_mask:0x3
  buffer_load_dwordx4 v58, s[32:35], 0 offen lds
  s_nop 0
  v_add_u32_dpp v57, v22, v2 row_newbcast:8 row_mask:0xf bank_mask:0xc
  s_add_u32 m0, s76, 47104
  v_add_u32_dpp v58, v24, v2 row_newbcast:2 row_mask:0xf bank_mask:0x3
  buffer_load_dwordx4 v59, s[32:35], 0 offen lds
  s_nop 0
  v_add_u32_dpp v58, v26, v2 row_newbcast:8 row_mask:0xf bank_mask:0xc
  s_add_u32 m0, s76, 49152
  v_add_u32_dpp v59, v28, v2 row_newbcast:2 row_mask:0xf bank_mask:0x3
  buffer_load_dwordx4 v60, s[32:35], 0 offen lds
  s_nop 0
  v_add_u32_dpp v59, v30, v2 row_newbcast:8 row_mask:0xf bank_mask:0xc
  s_add_u32 m0, s76, 51200
  v_add_u32_dpp v60, v32, v2 row_newbcast:2 row_mask:0xf bank_mask:0x3
  buffer_load_dwordx4 v61, s[32:35], 0 offen lds
  s_nop 0
  v_add_u32_dpp v60, v34, v2 row_newbcast:8 row_mask:0xf bank_mask:0xc
  s_add_u32 m0, s76, 53248
  v_add_u32_dpp v61, v36, v2 row_newbcast:2 row_mask:0xf bank_mask:0x3
  buffer_load_dwordx4 v62, s[32:35], 0 offen lds
  s_nop 0
  v_add_u32_dpp v61, v38, v2 row_newbcast:8 row_mask:0xf bank_mask:0xc
  s_add_u32 m0, s76, 55296
  v_add_u32_dpp v62, v40, v2 row_newbcast:2 row_mask:0xf bank_mask:0x3
  buffer_load_dwordx4 v63, s[32:35], 0 offen lds
  s_nop 0
  v_add_u32_dpp v62, v42, v2 row_newbcast:8 row_mask:0xf bank_mask:0xc
  s_add_u32 m0, s76, 57344
  v_add_u32_dpp v63, v44, v2 row_newbcast:2 row_mask:0xf bank_mask:0x3
  buffer_load_dwordx4 v64, s[32:35], 0 offen lds
  s_nop 0
  v_add_u32_dpp v63, v46, v2 row_newbcast:8 row_mask:0xf bank_mask:0xc
  s_add_u32 m0, s76, 59392
  v_add_u32_dpp v64, v48, v2 row_newbcast:2 row_mask:0xf bank_mask:0x3
  buffer_load_dwordx4 v65, s[32:35], 0 offen lds
  s_nop 0
  v_add_u32_dpp v64, v50, v2 row_newbcast:8 row_mask:0xf bank_mask:0xc
  v_add_u32_dpp v65, v52, v2 row_newbcast:2 row_mask:0xf bank_mask:0x3
  s_nop 1
  v_add_u32_dpp v65, v54, v2 row_newbcast:8 row_mask:0xf bank_mask:0xc
  s_mov_b64 exec, 0x3ff
  buffer_load_dword v103, v84, s[44:47], s85 offen
  s_mov_b64 exec, -1
  s_add_u32 s85, s85, 865280
  s_waitcnt vmcnt(11)
  s_barrier
  s_add_u32 m0, s75, 147456
  s_nop 0
  buffer_load_dwordx4 v4, s[44:47], s74 offen lds
  s_add_u32 m0, s75, 148480
  s_nop 0
  buffer_load_dwordx4 v5, s[44:47], s74 offen lds
  s_add_u32 s74, s74, 106496
  s_add_u32 m0, s75, 155648
  s_nop 0
  buffer_load_dwordx4 v4, s[44:47], s74 offen lds
  s_add_u32 m0, s75, 156672
  s_nop 0
  buffer_load_dwordx4 v5, s[44:47], s74 offen lds
  s_add_u32 s74, s74, 106496
  s_add_u32 m0, s76, 81920
  s_nop 0
  buffer_load_dwordx4 v56, s[32:35], 0 offen lds
  s_add_u32 m0, s76, 83968
  v_add_u32_dpp v56, v17, v2 row_newbcast:2 row_mask:0xf bank_mask:0x3
  buffer_load_dwordx4 v57, s[32:35], 0 offen lds
  s_nop 0
  v_add_u32_dpp v56, v19, v2 row_newbcast:8 row_mask:0xf bank_mask:0xc
  s_add_u32 m0, s76, 86016
  v_add_u32_dpp v57, v21, v2 row_newbcast:2 row_mask:0xf bank_mask:0x3
  buffer_load_dwordx4 v58, s[32:35], 0 offen lds
  s_nop 0
  v_add_u32_dpp v57, v23, v2 row_newbcast:8 row_mask:0xf bank_mask:0xc
  s_add_u32 m0, s76, 88064
  v_add_u32_dpp v58, v25, v2 row_newbcast:2 row_mask:0xf bank_mask:0x3
  buffer_load_dwordx4 v59, s[32:35], 0 offen lds
  s_nop 0
  v_add_u32_dpp v58, v27, v2 row_newbcast:8 row_mask:0xf bank_mask:0xc
  s_add_u32 m0, s76, 90112
  v_add_u32_dpp v59, v29, v2 row_newbcast:2 row_mask:0xf bank_mask:0x3
  buffer_load_dwordx4 v60, s[32:35], 0 offen lds
  s_nop 0
  v_add_u32_dpp v59, v31, v2 row_newbcast:8 row_mask:0xf bank_mask:0xc
  s_add_u32 m0, s76, 92160
  v_add_u32_dpp v60, v33, v2 row_newbcast:2 row_mask:0xf bank_mask:0x3
  buffer_load_dwordx4 v61, s[32:35], 0 offen lds
  s_nop 0
  v_add_u32_dpp v60, v35, v2 row_newbcast:8 row_mask:0xf bank_mask:0xc
  s_add_u32 m0, s76, 94208
  v_add_u32_dpp v61, v37, v2 row_newbcast:2 row_mask:0xf bank_mask:0x3
  buffer_load_dwordx4 v62, s[32:35], 0 offen lds
  s_nop 0
  v_add_u32_dpp v61, v39, v2 row_newbcast:8 row_mask:0xf bank_mask:0xc
  s_add_u32 m0, s76, 96256
  v_add_u32_dpp v62, v41, v2 row_newbcast:2 row_mask:0xf bank_mask:0x3
  buffer_load_dwordx4 v63, s[32:35], 0 offen lds
  s_nop 0
  v_add_u32_dpp v62, v43, v2 row_newbcast:8 row_mask:0xf bank_mask:0xc
  s_add_u32 m0, s76, 98304
  v_add_u32_dpp v63, v45, v2 row_newbcast:2 row_mask:0xf bank_mask:0x3
  buffer_load_dwordx4 v64, s[32:35], 0 offen lds
  s_nop 0
  v_add_u32_dpp v63, v47, v2 row_newbcast:8 row_mask:0xf bank_mask:0xc
  s_add_u32 m0, s76, 100352
  v_add_u32_dpp v64, v49, v2 row_newbcast:2 row_mask:0xf bank_mask:0x3
  buffer_load_dwordx4 v65, s[32:35], 0 offen lds
  s_nop 0
  v_add_u32_dpp v64, v51, v2 row_newbcast:8 row_mask:0xf bank_mask:0xc
  v_add_u32_dpp v65, v53, v2 row_newbcast:2 row_mask:0xf bank_mask:0x3
  s_nop 1
  v_add_u32_dpp v65, v55, v2 row_newbcast:8 row_mask:0xf bank_mask:0xc
  v_lshlrev_b32 v101, 7, v70
  s_mov_b32 exec_lo, 0xffffffff
  s_mov_b32 exec_hi, 0x0
  buffer_load_dword v102, v101, s[32:35], 0 offen
  s_mov_b64 exec, -1
  v_mov_b32 v70, v71
  v_mov_b32 v71, v72
  v_mov_b32 v72, v73
  v_mov_b32_e64 v73, v74
  v_mov_b32 v74, 0xffffff
  s_waitcnt vmcnt(11)
  s_barrier
  s_add_u32 m0, s75, 131072
  s_nop 0
  buffer_load_dwordx4 v4, s[44:47], s74 offen lds
  s_add_u32 m0, s75, 132096
  s_nop 0
  buffer_load_dwordx4 v5, s[44:47], s74 offen lds
  s_add_u32 s74, s74, 106496
  s_add_u32 m0, s75, 139264
  s_nop 0
  buffer_load_dwordx4 v4, s[44:47], s74 offen lds
  s_add_u32 m0, s75, 140288
  s_nop 0
  buffer_load_dwordx4 v5, s[44:47], s74 offen lds
  s_add_u32 s74, s74, 106496
  s_add_u32 m0, s76, 0
  s_nop 0
  buffer_load_dwordx4 v56, s[32:35], 0 offen lds
  s_add_u32 m0, s76, 2048
  v_add_u32_dpp v56, v18, v2 row_newbcast:2 row_mask:0xf bank_mask:0x3
  buffer_load_dwordx4 v57, s[32:35], 0 offen lds
  s_nop 0
  v_add_u32_dpp v56, v16, v2 row_newbcast:9 row_mask:0xf bank_mask:0xc
  s_add_u32 m0, s76, 4096
  v_add_u32_dpp v57, v22, v2 row_newbcast:2 row_mask:0xf bank_mask:0x3
  buffer_load_dwordx4 v58, s[32:35], 0 offen lds
  s_nop 0
  v_add_u32_dpp v57, v20, v2 row_newbcast:9 row_mask:0xf bank_mask:0xc
  s_add_u32 m0, s76, 6144
  v_add_u32_dpp v58, v26, v2 row_newbcast:2 row_mask:0xf bank_mask:0x3
  buffer_load_dwordx4 v59, s[32:35], 0 offen lds
  s_nop 0
  v_add_u32_dpp v58, v24, v2 row_newbcast:9 row_mask:0xf bank_mask:0xc
  s_add_u32 m0, s76, 8192
  v_add_u32_dpp v59, v30, v2 row_newbcast:2 row_mask:0xf bank_mask:0x3
  buffer_load_dwordx4 v60, s[32:35], 0 offen lds
  s_nop 0
  v_add_u32_dpp v59, v28, v2 row_newbcast:9 row_mask:0xf bank_mask:0xc
  s_add_u32 m0, s76, 10240
  v_add_u32_dpp v60, v34, v2 row_newbcast:2 row_mask:0xf bank_mask:0x3
  buffer_load_dwordx4 v61, s[32:35], 0 offen lds
  s_nop 0
  v_add_u32_dpp v60, v32, v2 row_newbcast:9 row_mask:0xf bank_mask:0xc
  s_add_u32 m0, s76, 12288
  v_add_u32_dpp v61, v38, v2 row_newbcast:2 row_mask:0xf bank_mask:0x3
  buffer_load_dwordx4 v62, s[32:35], 0 offen lds
  s_nop 0
  v_add_u32_dpp v61, v36, v2 row_newbcast:9 row_mask:0xf bank_mask:0xc
  s_add_u32 m0, s76, 14336
  v_add_u32_dpp v62, v42, v2 row_newbcast:2 row_mask:0xf bank_mask:0x3
  buffer_load_dwordx4 v63, s[32:35], 0 offen lds
  s_nop 0
  v_add_u32_dpp v62, v40, v2 row_newbcast:9 row_mask:0xf bank_mask:0xc
  s_add_u32 m0, s76, 16384
  v_add_u32_dpp v63, v46, v2 row_newbcast:2 row_mask:0xf bank_mask:0x3
  buffer_load_dwordx4 v64, s[32:35], 0 offen lds
  s_nop 0
  v_add_u32_dpp v63, v44, v2 row_newbcast:9 row_mask:0xf bank_mask:0xc
  s_add_u32 m0, s76, 18432
  v_add_u32_dpp v64, v50, v2 row_newbcast:2 row_mask:0xf bank_mask:0x3
  buffer_load_dwordx4 v65, s[32:35], 0 offen lds
  s_nop 0
  v_add_u32_dpp v64, v48, v2 row_newbcast:9 row_mask:0xf bank_mask:0xc
  v_add_u32_dpp v65, v54, v2 row_newbcast:2 row_mask:0xf bank_mask:0x3
  s_nop 1
  v_add_u32_dpp v65, v52, v2 row_newbcast:9 row_mask:0xf bank_mask:0xc
  s_waitcnt vmcnt(10)
  s_barrier
  s_add_u32 m0, s75, 147456
  s_nop 0
  buffer_load_dwordx4 v4, s[44:47], s74 offen lds
  s_add_u32 m0, s75, 148480
  s_nop 0
  buffer_load_dwordx4 v5, s[44:47], s74 offen lds
  s_add_u32 s74, s74, 106496
  s_add_u32 m0, s75, 155648
  s_nop 0
  buffer_load_dwordx4 v4, s[44:47], s74 offen lds
  s_add_u32 m0, s75, 156672
  s_nop 0
  buffer_load_dwordx4 v5, s[44:47], s74 offen lds
  s_add_u32 s74, s74, 106496
  s_add_u32 m0, s76, 40960
  s_nop 0
  buffer_load_dwordx4 v56, s[32:35], 0 offen lds
  s_add_u32 m0, s76, 43008
  v_add_u32_dpp v56, v19, v2 row_newbcast:2 row_mask:0xf bank_mask:0x3
  buffer_load_dwordx4 v57, s[32:35], 0 offen lds
  s_nop 0
  v_add_u32_dpp v56, v17, v2 row_newbcast:9 row_mask:0xf bank_mask:0xc
  s_add_u32 m0, s76, 45056
  v_add_u32_dpp v57, v23, v2 row_newbcast:2 row_mask:0xf bank_mask:0x3
  buffer_load_dwordx4 v58, s[32:35], 0 offen lds
  s_nop 0
  v_add_u32_dpp v57, v21, v2 row_newbcast:9 row_mask:0xf bank_mask:0xc
  s_add_u32 m0, s76, 47104
  v_add_u32_dpp v58, v27, v2 row_newbcast:2 row_mask:0xf bank_mask:0x3
  buffer_load_dwordx4 v59, s[32:35], 0 offen lds
  s_nop 0
  v_add_u32_dpp v58, v25, v2 row_newbcast:9 row_mask:0xf bank_mask:0xc
  s_add_u32 m0, s76, 49152
  v_add_u32_dpp v59, v31, v2 row_newbcast:2 row_mask:0xf bank_mask:0x3
  buffer_load_dwordx4 v60, s[32:35], 0 offen lds
  s_nop 0
  v_add_u32_dpp v59, v29, v2 row_newbcast:9 row_mask:0xf bank_mask:0xc
  s_add_u32 m0, s76, 51200
  v_add_u32_dpp v60, v35, v2 row_newbcast:2 row_mask:0xf bank_mask:0x3
  buffer_load_dwordx4 v61, s[32:35], 0 offen lds
  s_nop 0
  v_add_u32_dpp v60, v33, v2 row_newbcast:9 row_mask:0xf bank_mask:0xc
  s_add_u32 m0, s76, 53248
  v_add_u32_dpp v61, v39, v2 row_newbcast:2 row_mask:0xf bank_mask:0x3
  buffer_load_dwordx4 v62, s[32:35], 0 offen lds
  s_nop 0
  v_add_u32_dpp v61, v37, v2 row_newbcast:9 row_mask:0xf bank_mask:0xc
  s_add_u32 m0, s76, 55296
  v_add_u32_dpp v62, v43, v2 row_newbcast:2 row_mask:0xf bank_mask:0x3
  buffer_load_dwordx4 v63, s[32:35], 0 offen lds
  s_nop 0
  v_add_u32_dpp v62, v41, v2 row_newbcast:9 row_mask:0xf bank_mask:0xc
  s_add_u32 m0, s76, 57344
  v_add_u32_dpp v63, v47, v2 row_newbcast:2 row_mask:0xf bank_mask:0x3
  buffer_load_dwordx4 v64, s[32:35], 0 offen lds
  s_nop 0
  v_add_u32_dpp v63, v45, v2 row_newbcast:9 row_mask:0xf bank_mask:0xc
  s_add_u32 m0, s76, 59392
  v_add_u32_dpp v64, v51, v2 row_newbcast:2 row_mask:0xf bank_mask:0x3
  buffer_load_dwordx4 v65, s[32:35], 0 offen lds
  s_nop 0
  v_add_u32_dpp v64, v49, v2 row_newbcast:9 row_mask:0xf bank_mask:0xc
  v_add_u32_dpp v65, v55, v2 row_newbcast:2 row_mask:0xf bank_mask:0x3
  s_nop 1
  v_add_u32_dpp v65, v53, v2 row_newbcast:9 row_mask:0xf bank_mask:0xc
  s_waitcnt vmcnt(10)
  s_cmp_lg_u32 s72, 1
  s_cbranch_scc1 L_nolpf
  s_mov_b64 exec, 1048575
  global_load_dword v10, v[8:9], off
  s_mov_b64 exec, -1
  s_mov_b32 m0, 123136
  s_mov_b64 exec, 0xffff
  buffer_load_dwordx4 v11, s[52:55], s77 offen lds
  s_mov_b64 exec, -1
L_nolpf:
  s_barrier
  s_add_u32 m0, s75, 131072
  s_nop 0
  buffer_load_dwordx4 v4, s[44:47], s74 offen lds
  s_add_u32 m0, s75, 132096
  s_nop 0
  buffer_load_dwordx4 v5, s[44:47], s74 offen lds
  s_add_u32 s74, s74, 106496
  s_add_u32 m0, s75, 139264
  s_nop 0
  buffer_load_dwordx4 v4, s[44:47], s74 offen lds
  s_add_u32 m0, s75, 140288
  s_nop 0
  buffer_load_dwordx4 v5, s[44:47], s74 offen lds
  s_add_u32 s74, s74, 106496
  s_add_u32 m0, s76, 81920
  s_nop 0
  buffer_load_dwordx4 v56, s[32:35], 0 offen lds
  s_add_u32 m0, s76, 83968
  v_add_u32_dpp v56, v16, v2 row_newbcast:3 row_mask:0xf bank_mask:0x3
  buffer_load_dwordx4 v57, s[32:35], 0 offen lds
  s_nop 0
  v_add_u32_dpp v56, v18, v2 row_newbcast:9 row_mask:0xf bank_mask:0xc
  s_add_u32 m0, s76, 86016
  v_add_u32_dpp v57, v20, v2 row_newbcast:3 row_mask:0xf bank_mask:0x3
  buffer_load_dwordx4 v58, s[32:35], 0 offen lds
  s_nop 0
  v_add_u32_dpp v57, v22, v2 row_newbcast:9 row_mask:0xf bank_mask:0xc
  s_add_u32 m0, s76, 88064
  v_add_u32_dpp v58, v24, v2 row_newbcast:3 row_mask:0xf bank_mask:0x3
  buffer_load_dwordx4 v59, s[32:35], 0 offen lds
  s_nop 0
  v_add_u32_dpp v58, v26, v2 row_newbcast:9 row_mask:0xf bank_mask:0xc
  s_add_u32 m0, s76, 90112
  v_add_u32_dpp v59, v28, v2 row_newbcast:3 row_mask:0xf bank_mask:0x3
  buffer_load_dwordx4 v60, s[32:35], 0 offen lds
  s_nop 0
  v_add_u32_dpp v59, v30, v2 row_newbcast:9 row_mask:0xf bank_mask:0xc
  s_add_u32 m0, s76, 92160
  v_add_u32_dpp v60, v32, v2 row_newbcast:3 row_mask:0xf bank_mask:0x3
  buffer_load_dwordx4 v61, s[32:35], 0 offen lds
  s_nop 0
  v_add_u32_dpp v60, v34, v2 row_newbcast:9 row_mask:0xf bank_mask:0xc
  s_add_u32 m0, s76, 94208
  v_add_u32_dpp v61, v36, v2 row_newbcast:3 row_mask:0xf bank_mask:0x3
  buffer_load_dwordx4 v62, s[32:35], 0 offen lds
  s_nop 0
  v_add_u32_dpp v61, v38, v2 row_newbcast:9 row_mask:0xf bank_mask:0xc
  s_add_u32 m0, s76, 96256
  v_add_u32_dpp v62, v40, v2 row_newbcast:3 row_mask:0xf bank_mask:0x3
  buffer_load_dwordx4 v63, s[32:35], 0 offen lds
  s_nop 0
  v_add_u32_dpp v62, v42, v2 row_newbcast:9 row_mask:0xf bank_mask:0xc
  s_add_u32 m0, s76, 98304
  v_add_u32_dpp v63, v44, v2 row_newbcast:3 row_mask:0xf bank_mask:0x3
  buffer_load_dwordx4 v64, s[32:35], 0 offen lds
  s_nop 0
  v_add_u32_dpp v63, v46, v2 row_newbcast:9 row_mask:0xf bank_mask:0xc
  s_add_u32 m0, s76, 100352
  v_add_u32_dpp v64, v48, v2 row_newbcast:3 row_mask:0xf bank_mask:0x3
  buffer_load_dwordx4 v65, s[32:35], 0 offen lds
  s_nop 0
  v_add_u32_dpp v64, v50, v2 row_newbcast:9 row_mask:0xf bank_mask:0xc
  v_add_u32_dpp v65, v52, v2 row_newbcast:3 row_mask:0xf bank_mask:0x3
  s_nop 1
  v_add_u32_dpp v65, v54, v2 row_newbcast:9 row_mask:0xf bank_mask:0xc
  s_mov_b64 exec, 0x3ff
  buffer_load_dword v103, v84, s[44:47], s85 offen
  s_mov_b64 exec, -1
  s_add_u32 s85, s85, 865280
  s_waitcnt vmcnt(11)
  s_barrier
  s_add_u32 m0, s75, 147456
  s_nop 0
  buffer_load_dwordx4 v4, s[44:47], s74 offen lds
  s_add_u32 m0, s75, 148480
  s_nop 0
  buffer_load_dwordx4 v5, s[44:47], s74 offen lds
  s_add_u32 s74, s74, 106496
  s_add_u32 m0, s75, 155648
  s_nop 0
  buffer_load_dwordx4 v4, s[44:47], s74 offen lds
  s_add_u32 m0, s75, 156672
  s_nop 0
  buffer_load_dwordx4 v5, s[44:47], s74 offen lds
  s_add_u32 s74, s74, 106496
  s_add_u32 m0, s76, 0
  s_nop 0
  buffer_load_dwordx4 v56, s[32:35], 0 offen lds
  s_add_u32 m0, s76, 2048
  v_add_u32_dpp v56, v17, v2 row_newbcast:3 row_mask:0xf bank_mask:0x3
  buffer_load_dwordx4 v57, s[32:35], 0 offen lds
  s_nop 0
  v_add_u32_dpp v56, v19, v2 row_newbcast:9 row_mask:0xf bank_mask:0xc
  s_add_u32 m0, s76, 4096
  v_add_u32_dpp v57, v21, v2 row_newbcast:3 row_mask:0xf bank_mask:0x3
  buffer_load_dwordx4 v58, s[32:35], 0 offen lds
  s_nop 0
  v_add_u32_dpp v57, v23, v2 row_newbcast:9 row_mask:0xf bank_mask:0xc
  s_add_u32 m0, s76, 6144
  v_add_u32_dpp v58, v25, v2 row_newbcast:3 row_mask:0xf bank_mask:0x3
  buffer_load_dwordx4 v59, s[32:35], 0 offen lds
  s_nop 0
  v_add_u32_dpp v58, v27, v2 row_newbcast:9 row_mask:0xf bank_mask:0xc
  s_add_u32 m0, s76, 8192
  v_add_u32_dpp v59, v29, v2 row_newbcast:3 row_mask:0xf bank_mask:0x3
  buffer_load_dwordx4 v60, s[32:35], 0 offen lds
  s_nop 0
  v_add_u32_dpp v59, v31, v2 row_newbcast:9 row_mask:0xf bank_mask:0xc
  s_add_u32 m0, s76, 10240
  v_add_u32_dpp v60, v33, v2 row_newbcast:3 row_mask:0xf bank_mask:0x3
  buffer_load_dwordx4 v61, s[32:35], 0 offen lds
  s_nop 0
  v_add_u32_dpp v60, v35, v2 row_newbcast:9 row_mask:0xf bank_mask:0xc
  s_add_u32 m0, s76, 12288
  v_add_u32_dpp v61, v37, v2 row_newbcast:3 row_mask:0xf bank_mask:0x3
  buffer_load_dwordx4 v62, s[32:35], 0 offen lds
  s_nop 0
  v_add_u32_dpp v61, v39, v2 row_newbcast:9 row_mask:0xf bank_mask:0xc
  s_add_u32 m0, s76, 14336
  v_add_u32_dpp v62, v41, v2 row_newbcast:3 row_mask:0xf bank_mask:0x3
  buffer_load_dwordx4 v63, s[32:35], 0 offen lds
  s_nop 0
  v_add_u32_dpp v62, v43, v2 row_newbcast:9 row_mask:0xf bank_mask:0xc
  s_add_u32 m0, s76, 16384
  v_add_u32_dpp v63, v45, v2 row_newbcast:3 row_mask:0xf bank_mask:0x3
  buffer_load_dwordx4 v64, s[32:35], 0 offen lds
  s_nop 0
  v_add_u32_dpp v63, v47, v2 row_newbcast:9 row_mask:0xf bank_mask:0xc
  s_add_u32 m0, s76, 18432
  v_add_u32_dpp v64, v49, v2 row_newbcast:3 row_mask:0xf bank_mask:0x3
  buffer_load_dwordx4 v65, s[32:35], 0 offen lds
  s_nop 0
  v_add_u32_dpp v64, v51, v2 row_newbcast:9 row_mask:0xf bank_mask:0xc
  v_add_u32_dpp v65, v53, v2 row_newbcast:3 row_mask:0xf bank_mask:0x3
  s_nop 1
  v_add_u32_dpp v65, v55, v2 row_newbcast:9 row_mask:0xf bank_mask:0xc
  v_lshlrev_b32 v101, 7, v70
  s_mov_b32 exec_lo, 0xffffffff
  s_mov_b32 exec_hi, 0x0
  buffer_load_dword v102, v101, s[32:35], 0 offen
  s_mov_b64 exec, -1
  v_mov_b32 v70, v71
  v_mov_b32 v71, v72
  v_mov_b32 v72, v73
  v_mov_b32_e64 v73, v74
  v_mov_b32 v74, 0xffffff
  s_waitcnt vmcnt(11)
  s_barrier
  s_add_u32 m0, s75, 131072
  s_nop 0
  buffer_load_dwordx4 v4, s[44:47], s74 offen lds
  s_add_u32 m0, s75, 132096
  s_nop 0
  buffer_load_dwordx4 v5, s[44:47], s74 offen lds
  s_add_u32 s74, s74, 106496
  s_add_u32 m0, s75, 139264
  s_nop 0
  buffer_load_dwordx4 v4, s[44:47], s74 offen lds
  s_add_u32 m0, s75, 140288
  s_nop 0
  buffer_load_dwordx4 v5, s[44:47], s74 offen lds
  s_add_u32 s74, s74, 106496
  s_add_u32 m0, s76, 40960
  s_nop 0
  buffer_load_dwordx4 v56, s[32:35], 0 offen lds
  s_add_u32 m0, s76, 43008
  v_add_u32_dpp v56, v18, v2 row_newbcast:3 row_mask:0xf bank_mask:0x3
  buffer_load_dwordx4 v57, s[32:35], 0 offen lds
  s_nop 0
  v_add_u32_dpp v56, v16, v2 row_newbcast:10 row_mask:0xf bank_mask:0xc
  s_add_u32 m0, s76, 45056
  v_add_u32_dpp v57, v22, v2 row_newbcast:3 row_mask:0xf bank_mask:0x3
  buffer_load_dwordx4 v58, s[32:35], 0 offen lds
  s_nop 0
  v_add_u32_dpp v57, v20, v2 row_newbcast:10 row_mask:0xf bank_mask:0xc
  s_add_u32 m0, s76, 47104
  v_add_u32_dpp v58, v26, v2 row_newbcast:3 row_mask:0xf bank_mask:0x3
  buffer_load_dwordx4 v59, s[32:35], 0 offen lds
  s_nop 0
  v_add_u32_dpp v58, v24, v2 row_newbcast:10 row_mask:0xf bank_mask:0xc
  s_add_u32 m0, s76, 49152
  v_add_u32_dpp v59, v30, v2 row_newbcast:3 row_mask:0xf bank_mask:0x3
  buffer_load_dwordx4 v60, s[32:35], 0 offen lds
  s_nop 0
  v_add_u32_dpp v59, v28, v2 row_newbcast:10 row_mask:0xf bank_mask:0xc
  s_add_u32 m0, s76, 51200
  v_add_u32_dpp v60, v34, v2 row_newbcast:3 row_mask:0xf bank_mask:0x3
  buffer_load_dwordx4 v61, s[32:35], 0 offen lds
  s_nop 0
  v_add_u32_dpp v60, v32, v2 row_newbcast:10 row_mask:0xf bank_mask:0xc
  s_add_u32 m0, s76, 53248
  v_add_u32_dpp v61, v38, v2 row_newbcast:3 row_mask:0xf bank_mask:0x3
  buffer_load_dwordx4 v62, s[32:35], 0 offen lds
  s_nop 0
  v_add_u32_dpp v61, v36, v2 row_newbcast:10 row_mask:0xf bank_mask:0xc
  s_add_u32 m0, s76, 55296
  v_add_u32_dpp v62, v42, v2 row_newbcast:3 row_mask:0xf bank_mask:0x3
  buffer_load_dwordx4 v63, s[32:35], 0 offen lds
  s_nop 0
  v_add_u32_dpp v62, v40, v2 row_newbcast:10 row_mask:0xf bank_mask:0xc
  s_add_u32 m0, s76, 57344
  v_add_u32_dpp v63, v46, v2 row_newbcast:3 row_mask:0xf bank_mask:0x3
  buffer_load_dwordx4 v64, s[32:35], 0 offen lds
  s_nop 0
  v_add_u32_dpp v63, v44, v2 row_newbcast:10 row_mask:0xf bank_mask:0xc
  s_add_u32 m0, s76, 59392
  v_add_u32_dpp v64, v50, v2 row_newbcast:3 row_mask:0xf bank_mask:0x3
  buffer_load_dwordx4 v65, s[32:35], 0 offen lds
  s_nop 0
  v_add_u32_dpp v64, v48, v2 row_newbcast:10 row_mask:0xf bank_mask:0xc
  v_add_u32_dpp v65, v54, v2 row_newbcast:3 row_mask:0xf bank_mask:0x3
  s_nop 1
  v_add_u32_dpp v65, v52, v2 row_newbcast:10 row_mask:0xf bank_mask:0xc
  v_mov_b32_dpp v16, v16 row_shl:3 row_mask:0xf bank_mask:0xf
  v_mov_b32_dpp v18, v18 row_shl:3 row_mask:0xf bank_mask:0xf
  v_mov_b32_dpp v20, v20 row_shl:3 row_mask:0xf bank_mask:0xf
  v_mov_b32_dpp v22, v22 row_shl:3 row_mask:0xf bank_mask:0xf
  v_mov_b32_dpp v24, v24 row_shl:3 row_mask:0xf bank_mask:0xf
  v_mov_b32_dpp v26, v26 row_shl:3 row_mask:0xf bank_mask:0xf
  v_mov_b32_dpp v28, v28 row_shl:3 row_mask:0xf bank_mask:0xf
  v_mov_b32_dpp v30, v30 row_shl:3 row_mask:0xf bank_mask:0xf
  v_mov_b32_dpp v32, v32 row_shl:3 row_mask:0xf bank_mask:0xf
  v_mov_b32_dpp v34, v34 row_shl:3 row_mask:0xf bank_mask:0xf
  v_mov_b32_dpp v36, v36 row_shl:3 row_mask:0xf bank_mask:0xf
  v_mov_b32_dpp v38, v38 row_shl:3 row_mask:0xf bank_mask:0xf
  v_mov_b32_dpp v40, v40 row_shl:3 row_mask:0xf bank_mask:0xf
  v_mov_b32_dpp v42, v42 row_shl:3 row_mask:0xf bank_mask:0xf
  v_mov_b32_dpp v44, v44 row_shl:3 row_mask:0xf bank_mask:0xf
  v_mov_b32_dpp v46, v46 row_shl:3 row_mask:0xf bank_mask:0xf
  v_mov_b32_dpp v48, v48 row_shl:3 row_mask:0xf bank_mask:0xf
  v_mov_b32_dpp v50, v50 row_shl:3 row_mask:0xf bank_mask:0xf
  v_mov_b32_dpp v52, v52 row_shl:3 row_mask:0xf bank_mask:0xf
  v_mov_b32_dpp v54, v54 row_shl:3 row_mask:0xf bank_mask:0xf
  s_waitcnt vmcnt(10)
  s_barrier
  s_add_u32 m0, s75, 147456
  s_nop 0
  buffer_load_dwordx4 v4, s[44:47], s74 offen lds
  s_add_u32 m0, s75, 148480
  s_nop 0
  buffer_load_dwordx4 v5, s[44:47], s74 offen lds
  s_add_u32 s74, s74, 106496
  s_add_u32 m0, s75, 155648
  s_nop 0
  buffer_load_dwordx4 v4, s[44:47], s74 offen lds
  s_add_u32 m0, s75, 156672
  s_nop 0
  buffer_load_dwordx4 v5, s[44:47], s74 offen lds
  s_add_u32 s74, s74, 106496
  s_cmp_eq_u32 s72, 1
  s_cbranch_scc1 L_ld_tail0
  s_add_u32 m0, s76, 81920
  s_nop 0
  buffer_load_dwordx4 v56, s[32:35], 0 offen lds
  s_add_u32 m0, s76, 83968
  v_add_u32_dpp v56, v19, v2 row_newbcast:3 row_mask:0xf bank_mask:0x3
  buffer_load_dwordx4 v57, s[32:35], 0 offen lds
  s_nop 0
  v_add_u32_dpp v56, v17, v2 row_newbcast:10 row_mask:0xf bank_mask:0xc
  s_add_u32 m0, s76, 86016
  v_add_u32_dpp v57, v23, v2 row_newbcast:3 row_mask:0xf bank_mask:0x3
  buffer_load_dwordx4 v58, s[32:35], 0 offen lds
  s_nop 0
  v_add_u32_dpp v57, v21, v2 row_newbcast:10 row_mask:0xf bank_mask:0xc
  s_add_u32 m0, s76, 88064
  v_add_u32_dpp v58, v27, v2 row_newbcast:3 row_mask:0xf bank_mask:0x3
  buffer_load_dwordx4 v59, s[32:35], 0 offen lds
  s_nop 0
  v_add_u32_dpp v58, v25, v2 row_newbcast:10 row_mask:0xf bank_mask:0xc
  s_add_u32 m0, s76, 90112
  v_add_u32_dpp v59, v31, v2 row_newbcast:3 row_mask:0xf bank_mask:0x3
  buffer_load_dwordx4 v60, s[32:35], 0 offen lds
  s_nop 0
  v_add_u32_dpp v59, v29, v2 row_newbcast:10 row_mask:0xf bank_mask:0xc
  s_add_u32 m0, s76, 92160
  v_add_u32_dpp v60, v35, v2 row_newbcast:3 row_mask:0xf bank_mask:0x3
  buffer_load_dwordx4 v61, s[32:35], 0 offen lds
  s_nop 0
  v_add_u32_dpp v60, v33, v2 row_newbcast:10 row_mask:0xf bank_mask:0xc
  s_add_u32 m0, s76, 94208
  v_add_u32_dpp v61, v39, v2 row_newbcast:3 row_mask:0xf bank_mask:0x3
  buffer_load_dwordx4 v62, s[32:35], 0 offen lds
  s_nop 0
  v_add_u32_dpp v61, v37, v2 row_newbcast:10 row_mask:0xf bank_mask:0xc
  s_add_u32 m0, s76, 96256
  v_add_u32_dpp v62, v43, v2 row_newbcast:3 row_mask:0xf bank_mask:0x3
  buffer_load_dwordx4 v63, s[32:35], 0 offen lds
  s_nop 0
  v_add_u32_dpp v62, v41, v2 row_newbcast:10 row_mask:0xf bank_mask:0xc
  s_add_u32 m0, s76, 98304
  v_add_u32_dpp v63, v47, v2 row_newbcast:3 row_mask:0xf bank_mask:0x3
  buffer_load_dwordx4 v64, s[32:35], 0 offen lds
  s_nop 0
  v_add_u32_dpp v63, v45, v2 row_newbcast:10 row_mask:0xf bank_mask:0xc
  s_add_u32 m0, s76, 100352
  v_add_u32_dpp v64, v51, v2 row_newbcast:3 row_mask:0xf bank_mask:0x3
  buffer_load_dwordx4 v65, s[32:35], 0 offen lds
  s_nop 0
  v_add_u32_dpp v64, v49, v2 row_newbcast:10 row_mask:0xf bank_mask:0xc
  v_add_u32_dpp v65, v55, v2 row_newbcast:3 row_mask:0xf bank_mask:0x3
  s_nop 1
  v_add_u32_dpp v65, v53, v2 row_newbcast:10 row_mask:0xf bank_mask:0xc
  v_mov_b32_dpp v17, v17 row_shl:3 row_mask:0xf bank_mask:0xf
  v_mov_b32_dpp v19, v19 row_shl:3 row_mask:0xf bank_mask:0xf
  v_mov_b32_dpp v21, v21 row_shl:3 row_mask:0xf bank_mask:0xf
  v_mov_b32_dpp v23, v23 row_shl:3 row_mask:0xf bank_mask:0xf
  v_mov_b32_dpp v25, v25 row_shl:3 row_mask:0xf bank_mask:0xf
  v_mov_b32_dpp v27, v27 row_shl:3 row_mask:0xf bank_mask:0xf
  v_mov_b32_dpp v29, v29 row_shl:3 row_mask:0xf bank_mask:0xf
  v_mov_b32_dpp v31, v31 row_shl:3 row_mask:0xf bank_mask:0xf
  v_mov_b32_dpp v33, v33 row_shl:3 row_mask:0xf bank_mask:0xf
  v_mov_b32_dpp v35, v35 row_shl:3 row_mask:0xf bank_mask:0xf
  v_mov_b32_dpp v37, v37 row_shl:3 row_mask:0xf bank_mask:0xf
  v_mov_b32_dpp v39, v39 row_shl:3 row_mask:0xf bank_mask:0xf
  v_mov_b32_dpp v41, v41 row_shl:3 row_mask:0xf bank_mask:0xf
  v_mov_b32_dpp v43, v43 row_shl:3 row_mask:0xf bank_mask:0xf
  v_mov_b32_dpp v45, v45 row_shl:3 row_mask:0xf bank_mask:0xf
  v_mov_b32_dpp v47, v47 row_shl:3 row_mask:0xf bank_mask:0xf
  v_mov_b32_dpp v49, v49 row_shl:3 row_mask:0xf bank_mask:0xf
  v_mov_b32_dpp v51, v51 row_shl:3 row_mask:0xf bank_mask:0xf
  v_mov_b32_dpp v53, v53 row_shl:3 row_mask:0xf bank_mask:0xf
  v_mov_b32_dpp v55, v55 row_shl:3 row_mask:0xf bank_mask:0xf
  s_add_u32 s72, s72, 1
  s_cmp_lt_u32 s72, 2
  s_waitcnt vmcnt(10)
  s_cbranch_scc1 L_dnn_loop1
  s_branch L_ld_tail
L_cin:
  v_lshlrev_b32 v1, 4, v0
  s_and_b32 s79, s3, 3
  s_lshr_b32 s84, s3, 2
  s_lshl_b32 s95, s79, 10
  s_mul_i32 s26, s68, 11
  s_add_u32 s26, s26, s69
  s_sub_u32 s26, s26, 22
  s_cmp_eq_u32 s26, 86
  s_cbranch_scc1 L_end
  s_cmp_eq_u32 s84, 0
  s_cbranch_scc1 L_sc
  s_setprio 2
  v_add_u32 v2, L_tables-L_pc+4096, v1
  v_mov_b32_e64 v3, s93
  v_add_co_u32 v2, vcc, s92, v2
  s_nop 1
  v_addc_co_u32 v3, vcc, 0, v3, vcc
  v_add_co_u32 v32, vcc, s95, v2
  s_nop 1
  v_addc_co_u32 v33, vcc, 0, v3, vcc
  global_load_dwordx4 v[224:227], v[2:3], off offset:-4096
  v_add_co_u32 v2, vcc, 0x1800, v2
  s_nop 1
  v_addc_co_u32 v3, vcc, 0, v3, vcc
  global_load_dwordx4 v[240:243], v[2:3], off
  s_cmp_lt_u32 s79, 3
  s_mov_b32 s70, 122176
  s_cselect_b32 s70, 81920, s70
  s_add_u32 m0, s95, 81920
  s_nop 0
  global_load_lds_dwordx4 v[32:33], off offset:-4096
  s_add_u32 m0, s95, s70
  s_nop 0
  global_load_lds_dwordx4 v[32:33], off offset:0
  v_add_co_u32 v32, vcc, 0x2000, v32
  s_nop 1
  v_addc_co_u32 v33, vcc, 0, v33, vcc
  s_add_u32 m0, s95, 2048
  s_nop 0
  global_load_lds_dwordx4 v[32:33], off offset:0
  s_add_u32 m0, s95, 130368
  s_cmp_ge_u32 s79, 2
  s_cbranch_scc1 L_sc
  global_load_lds_dwordx4 v[32:33], off offset:-4096
L_sc:
  s_mul_i32 s85, s84, 20
  s_add_u32 s85, s85, s3
  s_mul_i32 s94, s26, 48
  s_add_u32 s94, s94, s85
  s_mul_i32 s94, s94, 104
  v_lshrrev_b32 v30, 3, v0
  v_lshlrev_b32_e64 v30, 4, v30
  v_and_b32 v29, 0x70, v1
  s_mul_i32 s76, s3, 4064
  s_add_u32 s76, s76, 131136
  s_cmp_eq_u32 s84, 0
  s_cbranch_scc1 L_g0
  s_sub_u32 s68, s71, 22
  s_min_u32 s68, s68, 9
  s_lshl_b32 s68, s68, 2
  s_add_u32 s68, s68, s79
  s_lshl_b32 s68, s68, 7
  v_mul_u32_u24 v31, 5120, v0
  s_waitcnt lgkmcnt(0)
  s_mov_b32 s36, s8
  s_and_b32 s37, s9, 0xffff
  s_mov_b32 s38, 105456
  s_mov_b32 s39, 0x20000
  buffer_load_dword v107, v31, s[36:39], s68 offen
  s_waitcnt lgkmcnt(0)
  s_mov_b32 s40, s10
  s_and_b32 s41, s11, 0xffff
  s_mov_b32 s42, 156
  s_mov_b32 s43, 0x20000
  s_mov_b32 m0, 129472
  s_mov_b64 exec, 0x7ff
  buffer_load_dwordx4 v1, s[40:43], 0 offen lds
  s_mov_b64 exec, -1
  s_barrier
  s_lshl_b32 s85, s85, 2
  s_add_u32 s85, s85, 129728
  s_mul_i32 s72, s84, 3
  s_sub_u32 s72, 4, s72
  s_cmp_eq_u32 s26, 85
  s_cselect_b32 s72, s72, 6
  s_lshl_b32 s52, s3, 7
  s_mul_i32 s53, s3, 5280
  s_lshl_b32 s54, s3, 2
  s_lshl_b32 s55, s3, 1
  s_lshl_b32 s82, s3, 12
  s_and_b32 s98, s3, 1
  s_lshr_b32 s99, s3, 1
  s_mul_i32 s68, s99, 3072
  s_lshl_b32 s83, s98, 3
  s_add_u32 s68, s68, s83
  v_add_u32 v59, s68, v1
  s_lshl_b32 s69, s99, 3
  s_lshr_b32 s69, 0x05030200, s69
  s_and_b32 s69, s69, 0xff
  s_lshl_b32 s69, s69, 9
  s_lshl_b32 s70, s98, 2
  s_add_u32 s91, s69, s70
  s_mov_b32 s99, 0x05040100
  s_mov_b32 s100, 0x07060302
  v_mov_b32 v2, 129664
  v_mov_b32 v109, 0
  v_mov_b32 v108, 0
  v_mov_b64 v[32:33], 0
  v_mov_b64 v[34:35], 0
  v_mov_b64 v[36:37], 0
  v_mov_b64 v[38:39], 0
  v_mov_b64 v[40:41], 0
  v_mov_b64 v[42:43], 0
  v_mov_b64 v[44:45], 0
  v_mov_b64 v[46:47], 0
  v_mov_b64 v[48:49], 0
  v_mov_b64 v[50:51], 0
  v_mov_b64 v[52:53], 0
  v_mov_b64 v[54:55], 0
  v_mov_b64 v[56:57], 0
  v_add_u32 v250, 77824, v1
  s_waitcnt vmcnt(7)
  v_add_u32 v251, 125248, v1
  v_lshrrev_b32 v3, 5, v0
  v_lshl_add_u32 v3, v3, 2, v2
  s_mov_b32 s28, s4
  s_and_b32 s29, s5, 0xffff
  s_mov_b32 s30, 425984
  s_mov_b32 s31, 0x20000
  s_mov_b32 s32, s6
  s_and_b32 s33, s7, 0xffff
  s_mov_b32 s34, 12800000
  s_mov_b32 s35, 0x20000
  v_and_b32 v13, 31, v0
  v_min_u32 v13, 25, v13
  v_lshrrev_b32 v14, 5, v0
  v_mul_u32_u24 v14, 416, v14
  v_lshl_add_u32 v13, v13, 2, v14
  buffer_load_dword v14, v13, s[28:31], s94 offen
  ds_write_b128 v2, v[32:35] offset:16
  s_lshl_b32 s68, s79, 6
  v_add_u32 v29, s68, v0
  v_mul_u32_u24 v30, 2521, v29
  v_lshrrev_b32 v30, 16, v30
  v_mul_u32_u24 v30, 12, v30
  v_lshl_add_u32 v28, v29, 1, v30
  v_add_u32 v29, 256, v29
  v_mul_u32_u24 v30, 2521, v29
  v_lshrrev_b32 v30, 16, v30
  v_mul_u32_u24 v30, 12, v30
  v_lshl_add_u32 v58, v29, 1, v30
  v_add_u32 v29, 256, v29
  v_mul_u32_u24 v30, 2521, v29
  v_lshrrev_b32 v30, 16, v30
  v_mul_u32_u24 v30, 12, v30
  v_lshl_add_u32 v111, v29, 1, v30
  v_cmp_gt_u32 vcc, 676, v29
  s_nop 0
  s_mov_b64 s[92:93], vcc
  v_lshlrev_b32 v29, 3, v0
  s_mov_b32 exec_hi, 0xffff
  ds_write_b64 v29, v[32:33] offset:1664
  s_mov_b32 exec_hi, -1
  s_waitcnt vmcnt(6)
  ds_write_b32 v243, v32
  ds_write_b32 v243, v32 offset:43328
  s_waitcnt vmcnt(1)
  ds_read_b64 v[112:113], v240 offset:0
  ds_read_b64 v[114:115], v240 offset:8
  ds_read_b64 v[116:117], v240 offset:32
  ds_read_b64 v[118:119], v240 offset:40
  ds_read_u16 v110, v241
  s_mov_b64 exec, 0x3ffffff
  s_waitcnt lgkmcnt(0)
  ds_write_b16 v242, v110
  v_lshlrev_b32 v109, 17, v110
  v_lshrrev_b32 v109, 1, v109
  s_mov_b64 exec, -1
  v_add_u32 v225, s52, v225
  v_add_u32 v226, s52, v226
  v_add_u32_e64 v227, s52, v227
  s_waitcnt lgkmcnt(0)
  s_barrier
  ds_read_b64_tr_b16 v[60:61], v225 offset:35328
  ds_read_b64_tr_b16 v[62:63], v225 offset:40736
  ds_read_b64_tr_b16 v[64:65], v226 offset:35328
  ds_read_b64_tr_b16 v[66:67], v227 offset:35328
  ds_read_b64_tr_b16 v[68:69], v225 offset:35392
  ds_read_b64_tr_b16 v[70:71], v225 offset:40800
  ds_read_b64_tr_b16 v[72:73], v226 offset:35392
  ds_read_b64_tr_b16 v[74:75], v227 offset:35392
  ds_read_b64_tr_b16 v[76:77], v225 offset:35840
  ds_read_b64_tr_b16 v[78:79], v225 offset:41248
  ds_read_b64_tr_b16 v[80:81], v226 offset:35840
  ds_read_b64_tr_b16 v[82:83], v227 offset:35840
  ds_read_b64_tr_b16 v[84:85], v225 offset:35904
  ds_read_b64_tr_b16 v[86:87], v225 offset:41312
  ds_read_b64_tr_b16 v[88:89], v226 offset:35904
  ds_read_b64_tr_b16 v[90:91], v227 offset:35904
  s_waitcnt lgkmcnt(14)
  v_mfma_f32_32x32x16_bf16 v[120:135], v[112:115], v[60:63], 0
  s_waitcnt lgkmcnt(12)
  v_mfma_f32_32x32x16_bf16 v[120:135], v[116:119], v[64:67], v[120:135]
  ds_read_b64_tr_b16 v[92:93], v225 offset:36352
  ds_read_b64_tr_b16 v[94:95], v225 offset:41760
  ds_read_b64_tr_b16 v[96:97], v226 offset:36352
  ds_read_b64_tr_b16 v[98:99], v227 offset:36352
  s_waitcnt lgkmcnt(14)
  v_mfma_f32_32x32x16_bf16 v[136:151], v[112:115], v[68:71], 0
  s_waitcnt lgkmcnt(12)
  v_mfma_f32_32x32x16_bf16 v[136:151], v[116:119], v[72:75], v[136:151]
  ds_read_b64_tr_b16 v[100:101], v225 offset:36416
  ds_read_b64_tr_b16 v[102:103], v225 offset:41824
  ds_read_b64_tr_b16 v[104:105], v226 offset:36416
  ds_read_b64_tr_b16 v[106:107], v227 offset:36416
  s_waitcnt lgkmcnt(14)
  v_mfma_f32_32x32x16_bf16 v[152:167], v[112:115], v[76:79], 0
  s_waitcnt lgkmcnt(12)
  v_mfma_f32_32x32x16_bf16 v[152:167], v[116:119], v[80:83], v[152:167]
  s_waitcnt lgkmcnt(10)
  v_mfma_f32_32x32x16_bf16 v[168:183], v[112:115], v[84:87], 0
  s_waitcnt lgkmcnt(8)
  v_mfma_f32_32x32x16_bf16 v[168:183], v[116:119], v[88:91], v[168:183]
  ds_read_b128 v[228:231], v250 offset:6144
  ds_read_b128 v[232:235], v251 offset:0
  ds_read_b128 v[4:7], v250 offset:3072
  ds_read_b128 v[8:11], v251 offset:2048
  ds_read_b128 v[20:23], v250 offset:1024
  ds_read_b128 v[24:27], v250 offset:2048
  ds_read_b128 v[216:219], v250 offset:4096
  ds_read_b128 v[220:223], v250 offset:5120
  ds_read_b128 v[236:239], v251 offset:1024
  s_waitcnt lgkmcnt(14)
  v_mfma_f32_32x32x16_bf16 v[184:199], v[112:115], v[92:95], 0
  s_waitcnt lgkmcnt(13)
  v_mfma_f32_32x32x16_bf16 v[184:199], v[116:119], v[96:99], v[184:199]
  s_waitcnt lgkmcnt(11)
  v_mfma_f32_32x32x16_bf16 v[200:215], v[112:115], v[100:103], 0
  s_waitcnt lgkmcnt(9)
  v_mfma_f32_32x32x16_bf16 v[200:215], v[116:119], v[104:107], v[200:215]
  s_waitcnt lgkmcnt(8)
  v_add_u32 v228, s54, v228
  v_add_u32 v229, s54, v229
  v_add_u32 v231, s83, v231
  v_add_u32 v230, s91, v230
  s_waitcnt lgkmcnt(7)
  v_mad_u32_u24 v232, v233, s3, v232
  v_add_u32 v234, s55, v234
  v_mad_u32_u24 v233, v233, 8, v232
  v_add_u32 v246, s82, v235
  v_add_u32 v247, 2048, v246
  v_add_u32 v31, 0, v234
  v_and_b32 v31, 3, v31
  v_lshl_add_u32 v244, v31, 4, v232
  v_add_u32 v31, 1, v234
  v_and_b32 v31, 3, v31
  v_lshl_add_u32 v245, v31, 4, v232
  v_add_u32 v245, 1664, v245
  v_add_u32 v31, 0, v234
  v_and_b32 v31, 3, v31
  v_lshl_add_u32 v248, v31, 4, v233
  v_add_u32 v31, 1, v234
  v_and_b32 v31, 3, v31
  v_lshl_add_u32 v249, v31, 4, v233
  v_add_u32 v249, 1664, v249
  s_waitcnt lgkmcnt(5)
  v_add_u32 v10, s76, v10
  v_add_u32 v4, s76, v4
  v_add_u32 v5, s76, v5
  ds_write_b32 v10, v7 offset:2880
  v_add_u32 v11, s53, v11
  s_waitcnt lgkmcnt(5)
  v_add_u32 v20, s53, v20
  v_add_u32 v21, s53, v21
  v_add_u32 v22, s53, v22
  v_add_u32 v23, s53, v23
  s_waitcnt lgkmcnt(4)
  v_add_u32 v24, s53, v24
  v_add_u32 v25, s53, v25
  v_add_u32 v26, s53, v26
  v_add_u32 v27, s53, v27
  s_mov_b32 exec_lo, 0
  v_mov_b32 v120, v136
  s_mov_b32 exec_lo, -1
  v_cvt_pk_bf16_f32 v60, 0, v120
  ds_write_b16_d16_hi v28, v60
  v_max_f32 v108, |v60|, v108
  s_mov_b32 exec_lo, 0
  v_mov_b32_e64 v152, v168
  s_mov_b32 exec_lo, -1
  v_cvt_pk_bf16_f32 v61, 0, v152
  ds_write_b16_d16_hi v58, v61
  v_max_f32 v108, |v61|, v108
  s_mov_b32 exec_lo, 0
  v_mov_b32 v184, v200
  s_mov_b32 exec_lo, -1
  v_cvt_pk_bf16_f32 v62, 0, v184
  s_mov_b64 exec, s[92:93]
  ds_write_b16_d16_hi v111, v62
  v_max_f32 v108, |v62|, v108
  s_mov_b64 exec, -1
  s_nop 0
  v_permlane32_swap_b32 v108, v109
  v_max_u32_e64 v108, v108, v109
  s_nop 1
  v_max_u32_dpp v108, v108, v108 row_shr:1 row_mask:0xf bank_mask:0xf
  s_nop 1
  v_max_u32_dpp v108, v108, v108 row_shr:2 row_mask:0xf bank_mask:0xf
  s_nop 1
  v_max_u32_dpp v108, v108, v108 row_shr:4 row_mask:0xf bank_mask:0xf
  s_nop 1
  v_max_u32_dpp v108, v108, v108 row_shr:8 row_mask:0xf bank_mask:0xf
  s_nop 1
  v_max_u32_dpp v108, v108, v108 row_bcast:15 row_mask:0xa bank_mask:0xf
  s_mov_b32 exec_lo, 0x80000000
  s_mov_b32 exec_hi, 0x80000000
  ds_max_u32 v3, v108 offset:24
  s_mov_b64 exec, -1
  s_setprio 0
  s_waitcnt vmcnt(0)
  v_lshlrev_b32 v14, 7, v14
  buffer_load_dword v13, v14, s[32:35], 0 offen
  s_waitcnt lgkmcnt(0)
  s_barrier
  s_branch L_w2
L_g0:
  s_waitcnt lgkmcnt(0)
  s_mov_b32 s36, s8
  s_and_b32 s37, s9, 0xffff
  s_mov_b32 s38, 105456
  s_mov_b32 s39, 0x20000
  s_barrier
  s_add_u32 m0, s95, 41984
  s_add_u32 s81, s95, 70304
  buffer_load_dwordx4 v1, s[36:39], s81 offen lds
  s_add_u32 m0, s95, 46080
  s_add_u32 s81, s95, 74400
  buffer_load_dwordx4 v1, s[36:39], s81 offen lds
  s_add_u32 m0, s95, 50176
  s_add_u32 s81, s95, 78496
  buffer_load_dwordx4 v1, s[36:39], s81 offen lds
  s_add_u32 m0, s95, 54272
  s_add_u32 s81, s95, 82592
  buffer_load_dwordx4 v1, s[36:39], s81 offen lds
  s_add_u32 m0, s95, 58368
  s_add_u32 s81, s95, 86688
  buffer_load_dwordx4 v1, s[36:39], s81 offen lds
  s_add_u32 m0, s95, 62464
  s_add_u32 s81, s95, 90784
  buffer_load_dwordx4 v1, s[36:39], s81 offen lds
  s_add_u32 m0, s95, 66560
  s_add_u32 s81, s95, 94880
  buffer_load_dwordx4 v1, s[36:39], s81 offen lds
  s_add_u32 m0, s95, 70656
  s_add_u32 s81, s95, 98976
  buffer_load_dwordx4 v1, s[36:39], s81 offen lds
  s_cmp_eq_u32 s79, 3
  s_cbranch_scc1 L_st3
  s_add_u32 m0, s95, 74752
  s_add_u32 s81, s95, 103072
  buffer_load_dwordx4 v1, s[36:39], s81 offen lds
L_st3:
  s_mov_b32 s28, s4
  s_and_b32 s29, s5, 0xffff
  s_mov_b32 s30, 425984
  s_mov_b32 s31, 0x20000
  buffer_load_dwordx4 v[16:19], v30, s[28:31], s94 offen
  s_add_u32 s94, s94, 416
  buffer_load_dwordx4 v[12:15], v30, s[28:31], s94 offen
  s_add_u32 s94, s94, 416
  s_mov_b32 s32, s6
  s_and_b32 s33, s7, 0xffff
  s_mov_b32 s34, 12800000
  s_mov_b32 s35, 0x20000
  s_mul_i32 s96, s79, 3072
  s_mul_i32 s97, s79, 2704
  v_lshrrev_b32 v31, 5, v0
  v_mul_u32_u24 v31, 184, v31
  v_sub_u32 v31, v1, v31
  s_add_u32 m0, s96, 85312
  s_add_u32 s81, s97, 35152
  buffer_load_dwordx4 v1, s[36:39], s81 offen lds
  s_lshl_b32 s85, s85, 2
  s_add_u32 s85, s85, 129728
  s_mul_i32 s72, s84, 3
  s_sub_u32 s72, 4, s72
  s_cmp_eq_u32 s26, 85
  s_cselect_b32 s72, s72, 6
  s_add_u32 m0, s96, 86336
  s_add_u32 s81, s97, 36176
  buffer_load_dwordx4 v31, s[36:39], s81 offen lds
  s_lshl_b32 s52, s3, 7
  s_mul_i32 s53, s3, 5280
  s_lshl_b32 s54, s3, 2
  s_lshl_b32 s55, s3, 1
  s_lshl_b32 s82, s3, 12
  s_add_u32 m0, s96, 87360
  s_add_u32 s81, s97, 37016
  buffer_load_dwordx4 v1, s[36:39], s81 offen lds
  s_and_b32 s98, s3, 1
  s_lshr_b32 s99, s3, 1
  s_mul_i32 s68, s99, 3072
  s_lshl_b32 s83, s98, 3
  s_add_u32 s68, s68, s83
  s_add_u32 m0, s96, 97600
  s_add_u32 s81, s97, 45968
  buffer_load_dwordx4 v1, s[36:39], s81 offen lds
  v_add_u32 v59, s68, v1
  s_lshl_b32 s69, s99, 3
  s_lshr_b32 s69, 0x05030200, s69
  s_and_b32 s69, s69, 0xff
  s_lshl_b32 s69, s69, 9
  s_add_u32 m0, s96, 98624
  s_add_u32 s81, s97, 46992
  buffer_load_dwordx4 v31, s[36:39], s81 offen lds
  s_lshl_b32 s70, s98, 2
  s_add_u32 s91, s69, s70
  s_mov_b32 s99, 0x05040100
  s_mov_b32 s100, 0x07060302
  v_mov_b32 v2, 129664
  s_add_u32 m0, s96, 99648
  s_add_u32 s81, s97, 47832
  buffer_load_dwordx4 v1, s[36:39], s81 offen lds
  v_mov_b32 v109, 0
  v_mov_b32 v108, 0
  v_mov_b64 v[32:33], 0
  v_mov_b64 v[34:35], 0
  v_mov_b64 v[36:37], 0
  s_add_u32 m0, s96, 109888
  s_add_u32 s81, s97, 56784
  buffer_load_dwordx4 v1, s[36:39], s81 offen lds
  v_mov_b64 v[38:39], 0
  v_mov_b64 v[40:41], 0
  v_mov_b64 v[42:43], 0
  v_mov_b64 v[44:45], 0
  v_mov_b64 v[46:47], 0
  s_add_u32 m0, s96, 110912
  s_add_u32 s81, s97, 57808
  buffer_load_dwordx4 v31, s[36:39], s81 offen lds
  v_mov_b64 v[48:49], 0
  v_mov_b64 v[50:51], 0
  v_mov_b64 v[52:53], 0
  v_mov_b64 v[54:55], 0
  v_mov_b64 v[56:57], 0
  s_add_u32 m0, s96, 111936
  s_add_u32 s81, s97, 58648
  buffer_load_dwordx4 v1, s[36:39], s81 offen lds
  v_add_u32 v250, 77824, v1
  s_waitcnt vmcnt(19)
  v_add_u32 v251, 125248, v1
  v_lshrrev_b32 v3, 5, v0
  v_lshl_add_u32 v3, v3, 2, v2
  s_cmp_lg_u32 s79, 0
  s_cbranch_scc1 L_st2
  s_add_u32 m0, s96, 122176
  s_add_u32 s81, s97, 67600
  buffer_load_dwordx4 v1, s[36:39], s81 offen lds
  s_add_u32 m0, s96, 123200
  s_add_u32 s81, s97, 68624
  buffer_load_dwordx4 v31, s[36:39], s81 offen lds
  s_add_u32 m0, s96, 124224
  s_add_u32 s81, s97, 69464
  buffer_load_dwordx4 v1, s[36:39], s81 offen lds
L_st2:
  s_add_u32 m0, s95, 6144
  s_add_u32 s81, s95, 0
  buffer_load_dwordx4 v1, s[36:39], s81 offen lds
  s_add_u32 m0, s95, 10240
  s_add_u32 s81, s95, 4096
  buffer_load_dwordx4 v1, s[36:39], s81 offen lds
  s_add_u32 m0, s95, 14336
  s_add_u32 s81, s95, 8192
  buffer_load_dwordx4 v1, s[36:39], s81 offen lds
  s_add_u32 m0, s95, 18432
  s_add_u32 s81, s95, 12288
  buffer_load_dwordx4 v1, s[36:39], s81 offen lds
  s_waitcnt vmcnt(15)
  s_barrier
  ds_read_b128 v[224:227], v250 offset:0
  ds_read_b128 v[228:231], v250 offset:6144
  ds_read_b128 v[232:235], v251 offset:0
  ds_read_b128 v[4:7], v250 offset:3072
  ds_read_b128 v[8:11], v251 offset:2048
  ds_read_b128 v[20:23], v250 offset:1024
  ds_read_b128 v[24:27], v250 offset:2048
  ds_read_b128 v[216:219], v250 offset:4096
  ds_read_b128 v[220:223], v250 offset:5120
  ds_read_b128 v[236:239], v251 offset:1024
  s_add_u32 m0, s95, 22528
  s_add_u32 s81, s95, 16384
  buffer_load_dwordx4 v1, s[36:39], s81 offen lds
  s_add_u32 m0, s95, 26624
  s_add_u32 s81, s95, 20480
  buffer_load_dwordx4 v1, s[36:39], s81 offen lds
  s_add_u32 m0, s95, 30720
  s_add_u32 s81, s95, 24576
  buffer_load_dwordx4 v1, s[36:39], s81 offen lds
  s_add_u32 m0, s95, 34816
  s_add_u32 s81, s95, 28672
  buffer_load_dwordx4 v1, s[36:39], s81 offen lds
  s_cmp_eq_u32 s79, 3
  s_cbranch_scc1 L_st1
  s_add_u32 m0, s95, 38912
  s_add_u32 s81, s95, 32768
  buffer_load_dwordx4 v1, s[36:39], s81 offen lds
L_st1:
  s_waitcnt lgkmcnt(9)
  v_add_u32 v225, s52, v225
  v_add_u32 v226, s52, v226
  v_add_u32 v227, s52, v227
  s_waitcnt lgkmcnt(8)
  v_add_u32 v228, s54, v228
  v_add_u32 v229, s54, v229
  v_add_u32 v231, s83, v231
  v_add_u32 v230, s91, v230
  s_waitcnt lgkmcnt(7)
  v_mad_u32_u24 v232, v233, s3, v232
  v_add_u32 v234, s55, v234
  v_mad_u32_u24 v233, v233, 8, v232
  v_add_u32 v246, s82, v235
  v_add_u32 v247, 2048, v246
  v_add_u32 v31, 0, v234
  v_and_b32 v31, 3, v31
  v_lshl_add_u32 v244, v31, 4, v232
  v_add_u32 v31, 1, v234
  v_and_b32 v31, 3, v31
  v_lshl_add_u32 v245, v31, 4, v232
  v_add_u32 v245, 1664, v245
  v_add_u32 v31, 0, v234
  v_and_b32_e64 v31, 3, v31
  v_lshl_add_u32 v248, v31, 4, v233
  v_add_u32 v31, 1, v234
  v_and_b32 v31, 3, v31
  v_lshl_add_u32 v249, v31, 4, v233
  v_add_u32 v249, 1664, v249
  s_waitcnt lgkmcnt(5)
  v_add_u32 v10, s76, v10
  v_add_u32 v4, s76, v4
  v_add_u32 v5, s76, v5
  ds_write_b32 v10, v7 offset:2880
  v_add_u32 v11, s53, v11
  s_waitcnt lgkmcnt(5)
  v_add_u32 v20, s53, v20
  v_add_u32 v21, s53, v21
  v_add_u32 v22, s53, v22
  v_add_u32 v23, s53, v23
  s_waitcnt lgkmcnt(4)
  v_add_u32 v24, s53, v24
  v_add_u32 v25, s53, v25
  v_add_u32 v26, s53, v26
  v_add_u32 v27, s53, v27
  s_waitcnt vmcnt(18)
  v_lshl_add_u32 v16, v16, 7, v29
  v_lshl_add_u32 v17, v17, 7, v29
  v_lshl_add_u32 v18, v18, 7, v29
  v_lshl_add_u32 v19, v19, 7, v29
  s_add_u32 m0, s76, 0
  s_mov_b32 exec_hi, 0xffffff
  buffer_load_dwordx4 v16, s[32:35], 0 offen lds
  s_add_u32 m0, s76, 1056
  s_nop 0
  buffer_load_dwordx4 v17, s[32:35], 0 offen lds
  s_add_u32 m0, s76, 2112
  s_mov_b32 exec_hi, 0xffff
  buffer_load_dwordx4 v18, s[32:35], 0 offen lds
  s_add_u32 m0, s76, 3168
  s_nop 0
  buffer_load_dwordx4 v19, s[32:35], 0 offen lds
  s_mov_b32 exec_hi, -1
  s_waitcnt vmcnt(4)
  s_barrier
L_w2:
  ds_read2st64_b32 v[60:61], v228 offset0:0 offset1:6
  ds_read2st64_b32 v[62:63], v228 offset0:12 offset1:18
  ds_read2st64_b32 v[64:65], v228 offset0:24 offset1:30
  ds_read2st64_b32 v[66:67], v228 offset0:36 offset1:42
  ds_read2st64_b32 v[68:69], v228 offset0:96 offset1:102
  ds_read2st64_b32 v[70:71], v229 offset0:108 offset1:114
  ds_read2st64_b32 v[72:73], v229 offset0:120 offset1:126
  ds_read2st64_b32 v[74:75], v229 offset0:132 offset1:138
  s_cmp_ge_u32 s3, 5
  s_cbranch_scc1 L_u0
  v_add_u32 v228, 32, v228
  v_add_u32 v229, 32, v229
  ds_read2st64_b32 v[92:93], v228 offset0:0 offset1:6
  ds_read2st64_b32 v[94:95], v228 offset0:12 offset1:18
  ds_read2st64_b32 v[96:97], v228 offset0:24 offset1:30
  ds_read2st64_b32 v[98:99], v228 offset0:36 offset1:42
  ds_read2st64_b32 v[100:101], v228 offset0:96 offset1:102
  ds_read2st64_b32 v[102:103], v229 offset0:108 offset1:114
  ds_read2st64_b32 v[104:105], v229 offset0:120 offset1:126
  ds_read2st64_b32 v[106:107], v229 offset0:132 offset1:138
  ds_read_b64_tr_b16 v[76:77], v225 offset:0
  ds_read_b64_tr_b16 v[78:79], v225 offset:5408
  ds_read_b64_tr_b16 v[80:81], v226 offset:0
  ds_read_b64_tr_b16 v[82:83], v227 offset:0
  ds_read_b64_tr_b16 v[84:85], v225 offset:64
  ds_read_b64_tr_b16 v[86:87], v225 offset:5472
  ds_read_b64_tr_b16 v[88:89], v226 offset:64
  ds_read_b64_tr_b16 v[90:91], v227 offset:64
  ds_read_b64_tr_b16 v[112:113], v224 offset:0
  ds_read_b64_tr_b16 v[114:115], v224 offset:256
  ds_read_b64_tr_b16 v[116:117], v224 offset:1024
  ds_read_b64_tr_b16 v[118:119], v224 offset:1280
  s_waitcnt lgkmcnt(14)
  v_mfma_f32_16x16x32_bf16 v[108:111], v[60:63], v[60:63], 0
  v_mfma_f32_16x16x32_bf16 v[108:111], v[64:67], v[64:67], v[108:111]
  v_mfma_f32_16x16x32_bf16 v[108:111], v[68:71], v[68:71], v[108:111]
  s_nop 0
  v_mfma_f32_16x16x32_bf16 v[108:111], v[72:75], v[72:75], v[108:111]
  v_perm_b32 v184, v61, v60, s99
  v_perm_b32 v185, v63, v62, s99
  v_perm_b32 v186, v65, v64, s99
  v_perm_b32 v187, v67, v66, s99
  v_perm_b32 v188, v69, v68, s99
  v_perm_b32 v189, v71, v70, s99
  v_perm_b32 v190, v73, v72, s99
  v_perm_b32 v191, v75, v74, s99
  v_mfma_f32_16x16x32_bf16 v[108:111], v[92:95], v[92:95], v[108:111]
  v_mfma_f32_16x16x32_bf16 v[108:111], v[96:99], v[96:99], v[108:111]
  v_mfma_f32_16x16x32_bf16 v[108:111], v[100:103], v[100:103], v[108:111]
  s_waitcnt lgkmcnt(12)
  v_mfma_f32_16x16x32_bf16 v[108:111], v[104:107], v[104:107], v[108:111]
  s_waitcnt lgkmcnt(10)
  v_mfma_f32_16x16x32_bf16 v[28:31], v[76:79], v[76:79], 0
  s_waitcnt lgkmcnt(8)
  v_mfma_f32_16x16x32_bf16 v[28:31], v[80:83], v[80:83], v[28:31]
  s_waitcnt lgkmcnt(6)
  v_mfma_f32_16x16x32_bf16 v[28:31], v[84:87], v[84:87], v[28:31]
  s_nop 0
  s_waitcnt lgkmcnt(4)
  v_mfma_f32_16x16x32_bf16 v[28:31], v[88:91], v[88:91], v[28:31]
  v_perm_b32 v192, v61, v60, s100
  v_perm_b32 v193, v63, v62, s100
  v_perm_b32 v194, v65, v64, s100
  v_perm_b32 v195, v67, v66, s100
  v_perm_b32 v196, v69, v68, s100
  v_perm_b32 v197, v71, v70, s100
  v_perm_b32 v198, v73, v72, s100
  v_perm_b32 v199, v75, v74, s100
  v_max3_f32 v28, v28, v29, 0
  v_perm_b32 v60, v93, v92, s99
  v_perm_b32 v61, v95, v94, s99
  v_max3_f32 v108, v108, v109, 0
  v_perm_b32 v62, v97, v96, s99
  v_max3_f32 v28, v28, v30, v31
  v_perm_b32 v63, v99, v98, s99
  v_max3_f32 v108, v108, v110, v111
  v_perm_b32 v64, v101, v100, s99
  v_perm_b32 v65, v103, v102, s99
  v_permlane32_swap_b32 v28, v108
  v_perm_b32 v66, v105, v104, s99
  v_max_u32 v28, v28, v108
  v_perm_b32 v67, v107, v106, s99
  s_nop 0
  v_max_u32_dpp v28, v28, v28 row_shr:1 row_mask:0xf bank_mask:0xf
  v_perm_b32 v68, v93, v92, s100
  v_perm_b32 v69, v95, v94, s100
  v_max_u32_dpp v28, v28, v28 row_shr:2 row_mask:0xf bank_mask:0xf
  v_perm_b32 v70, v97, v96, s100
  s_nop 0
  v_max_u32_dpp v28, v28, v28 row_shr:4 row_mask:0xf bank_mask:0xf
  v_perm_b32 v71, v99, v98, s100
  s_nop 0
  v_max_u32_dpp v28, v28, v28 row_shr:8 row_mask:0xf bank_mask:0xf
  v_perm_b32 v72, v101, v100, s100
  v_perm_b32 v73, v103, v102, s100
  v_max_u32_dpp v28, v28, v28 row_bcast:15 row_mask:0xa bank_mask:0xf
  v_perm_b32 v74, v105, v104, s100
  s_mov_b32 exec_lo, 0x80000000
  s_mov_b32 exec_hi, 0x80000000
  ds_max_u32 v3, v28 offset:16
  s_mov_b64 exec, -1
  v_perm_b32 v75, v107, v106, s100
  s_branch L_u1
L_u0:
  ds_read_b64_tr_b16 v[76:77], v225 offset:0
  ds_read_b64_tr_b16 v[78:79], v225 offset:5408
  ds_read_b64_tr_b16 v[80:81], v226 offset:0
  ds_read_b64_tr_b16 v[82:83], v227 offset:0
  ds_read_b64_tr_b16 v[84:85], v225 offset:64
  ds_read_b64_tr_b16 v[86:87], v225 offset:5472
  ds_read_b64_tr_b16 v[88:89], v226 offset:64
  ds_read_b64_tr_b16 v[90:91], v227 offset:64
  ds_read_b64_tr_b16 v[92:93], v225 offset:384
  ds_read_b64_tr_b16 v[94:95], v225 offset:5792
  ds_read_b64_tr_b16 v[96:97], v226 offset:384
  ds_read_b64_tr_b16 v[98:99], v227 offset:384
  ds_read_b64_tr_b16 v[100:101], v225 offset:448
  ds_read_b64_tr_b16 v[102:103], v225 offset:5856
  ds_read_b64_tr_b16 v[104:105], v226 offset:448
  ds_read_b64_tr_b16 v[106:107], v227 offset:448
  ds_read_b64_tr_b16 v[112:113], v224 offset:0
  ds_read_b64_tr_b16 v[114:115], v224 offset:256
  ds_read_b64_tr_b16 v[116:117], v224 offset:1024
  ds_read_b64_tr_b16 v[118:119], v224 offset:1280
  s_waitcnt lgkmcnt(14)
  v_mfma_f32_16x16x32_bf16 v[108:111], v[60:63], v[60:63], 0
  v_mfma_f32_16x16x32_bf16 v[108:111], v[64:67], v[64:67], v[108:111]
  v_mfma_f32_16x16x32_bf16 v[108:111], v[68:71], v[68:71], v[108:111]
  v_mfma_f32_16x16x32_bf16 v[108:111], v[72:75], v[72:75], v[108:111]
  v_mfma_f32_16x16x32_bf16 v[28:31], v[76:79], v[76:79], 0
  v_mfma_f32_16x16x32_bf16 v[28:31], v[80:83], v[80:83], v[28:31]
  v_mfma_f32_16x16x32_bf16 v[28:31], v[84:87], v[84:87], v[28:31]
  s_waitcnt lgkmcnt(12)
  v_mfma_f32_16x16x32_bf16 v[28:31], v[88:91], v[88:91], v[28:31]
  s_waitcnt lgkmcnt(10)
  v_mfma_f32_16x16x32_bf16 v[28:31], v[92:95], v[92:95], v[28:31]
  s_waitcnt lgkmcnt(8)
  v_mfma_f32_16x16x32_bf16 v[28:31], v[96:99], v[96:99], v[28:31]
  s_waitcnt lgkmcnt(6)
  v_mfma_f32_16x16x32_bf16 v[28:31], v[100:103], v[100:103], v[28:31]
  s_nop 0
  s_waitcnt lgkmcnt(4)
  v_mfma_f32_16x16x32_bf16 v[28:31], v[104:107], v[104:107], v[28:31]
  v_perm_b32 v184, v61, v60, s99
  v_perm_b32 v185, v63, v62, s99
  v_perm_b32 v186, v65, v64, s99
  v_perm_b32 v187, v67, v66, s99
  s_nop 3
  v_max3_f32 v28, v28, v29, 0
  v_perm_b32 v188, v69, v68, s99
  v_max3_f32 v108, v108, v109, 0
  v_perm_b32 v189, v71, v70, s99
  v_max3_f32 v28, v28, v30, v31
  v_perm_b32 v190, v73, v72, s99
  v_max3_f32 v108, v108, v110, v111
  v_perm_b32 v191, v75, v74, s99
  s_nop 0
  v_permlane32_swap_b32 v28, v108
  v_perm_b32 v192, v61, v60, s100
  v_max_u32_e64 v28, v28, v108
  v_perm_b32 v193, v63, v62, s100
  s_nop 0
  v_max_u32_dpp v28, v28, v28 row_shr:1 row_mask:0xf bank_mask:0xf
  v_perm_b32 v194, v65, v64, s100
  s_nop 0
  v_max_u32_dpp v28, v28, v28 row_shr:2 row_mask:0xf bank_mask:0xf
  v_perm_b32 v195, v67, v66, s100
  s_nop 0
  v_max_u32_dpp v28, v28, v28 row_shr:4 row_mask:0xf bank_mask:0xf
  v_perm_b32 v196, v69, v68, s100
  s_nop 0
  v_max_u32_dpp v28, v28, v28 row_shr:8 row_mask:0xf bank_mask:0xf
  v_perm_b32 v197, v71, v70, s100
  s_nop 0
  v_max_u32_dpp v28, v28, v28 row_bcast:15 row_mask:0xa bank_mask:0xf
  v_perm_b32 v198, v73, v72, s100
  s_mov_b32 exec_lo, 0x80000000
  s_mov_b32 exec_hi, 0x80000000
  ds_max_u32 v3, v28 offset:16
  s_mov_b64 exec, -1
  v_perm_b32 v199, v75, v74, s100
  v_add_u32 v248, 12288, v246
  v_add_u32 v249, 12288, v247
  s_cmp_lg_u32 s3, 7
  s_cbranch_scc1 L_u1
  s_mov_b32 exec_lo, 0xfffffff0
  s_mov_b32 exec_hi, 0xfffffff0
  v_mov_b32 v249, 1048576
  s_mov_b64 exec, -1
L_u1:
  s_waitcnt lgkmcnt(0)
  s_barrier
  ds_read_b128 v[108:111], v2 offset:16
  s_mul_i32 s68, s3, 384
  v_lshrrev_b32 v29, 2, v0
  v_mul_u32_u24 v29, 24, v29
  v_add_u32 v29, s68, v29
  v_and_b32 v30, 3, v0
  v_lshlrev_b32 v30, 3, v30
  ds_read_b64 v[224:225], v29 offset:2048
  ds_read_b64 v[226:227], v29 offset:2056
  ds_read_b64 v[228:229], v29 offset:2064
  s_waitcnt lgkmcnt(3)
  v_add_u32 v108, 0x3f800000, v108
  v_add_u32 v109, 0x3f800000, v109
  v_lshrrev_b32 v108, 24, v108
  v_lshrrev_b32 v109, 24, v109
  v_sub_u32 v108, 267, v108
  s_mov_b32 vcc_lo, 0x4000000
  v_min_u32 v108, 167, v108
  s_mov_b32 vcc_hi, 0x4000000
  v_readfirstlane_b32 s74, v108
  v_cndmask_b32 v250, v110, v111, vcc
  v_mul_u32_u24 v108, 0x800080, v108
  v_lshrrev_b32 v250, 23, v250
  v_and_b32 v216, v216, v108
  v_and_b32 v217, v217, v108
  v_and_b32 v218, v218, v108
  v_and_b32 v219, v219, v108
  v_and_b32 v220, v220, v108
  v_and_b32 v221, v221, v108
  v_and_b32 v222, v222, v108
  v_and_b32 v223, v223, v108
  v_mfma_f32_32x32x16_bf16 v[152:167], v[216:219], v[76:79], 0
  v_add_u32_e64 v250, v250, v109
  v_sub_u32 v250, 388, v250
  v_mfma_f32_32x32x16_bf16 v[168:183], v[216:219], v[84:87], 0
  s_movk_i32 s98, 167
  v_med3_i32 v250, v250, 1, s98
  v_mfma_f32_32x32x16_bf16 v[152:167], v[220:223], v[80:83], v[152:167]
  v_subrev_u32 v110, 127, v250
  v_lshlrev_b32 v250, 23, v250
  v_mfma_f32_32x32x16_bf16 v[168:183], v[220:223], v[88:91], v[168:183]
  v_cmp_gt_i32 vcc, 0, v110
  v_mul_u32_u24 v110, 0x800080, v110
  s_cbranch_vccnz L_sdown
  v_add_u32 v112, v112, v110
  v_add_u32 v113, v113, v110
  v_add_u32 v114, v114, v110
  v_add_u32 v115, v115, v110
  v_add_u32 v116, v116, v110
  v_add_u32 v117, v117, v110
  v_add_u32 v118, v118, v110
  v_add_u32 v119, v119, v110
L_scaled:
  v_mfma_f32_32x32x16_bf16 v[120:135], v[184:187], v[112:115], 0
  v_cvt_pk_f16_f32 v152, v152, v153
  v_cvt_pk_f16_f32 v153, v154, v155
  v_cvt_pk_f16_f32 v154, v156, v157
  v_cvt_pk_f16_f32 v155, v158, v159
  ds_write_b128 v246, v[152:155]
  v_xor_b32 v246, 16, v246
  v_mfma_f32_32x32x16_bf16 v[120:135], v[188:191], v[116:119], v[120:135]
  v_cvt_pk_f16_f32 v156, v160, v161
  v_cvt_pk_f16_f32 v157, v162, v163
  v_cvt_pk_f16_f32 v158, v164, v165
  v_cvt_pk_f16_f32 v159, v166, v167
  ds_write_b128 v246, v[156:159]
  v_mfma_f32_32x32x16_bf16 v[136:151], v[192:195], v[112:115], 0
  v_cvt_pk_f16_f32 v168, v168, v169
  v_cvt_pk_f16_f32 v169, v170, v171
  v_cvt_pk_f16_f32 v170, v172, v173
  v_cvt_pk_f16_f32 v171, v174, v175
  ds_write_b128 v247, v[168:171]
  v_xor_b32_e64 v247, 16, v247
  v_mfma_f32_32x32x16_bf16 v[136:151], v[196:199], v[116:119], v[136:151]
  v_cvt_pk_f16_f32 v172, v176, v177
  v_cvt_pk_f16_f32 v173, v178, v179
  v_cvt_pk_f16_f32 v174, v180, v181
  v_cvt_pk_f16_f32 v175, v182, v183
  ds_write_b128 v247, v[172:175]
  s_cmp_ge_u32 s3, 5
  s_cbranch_scc1 L_u2
  v_mfma_f32_32x32x16_bf16 v[184:199], v[60:63], v[112:115], 0
  v_cvt_pk_f16_f32 v120, v120, v121
  v_cvt_pk_f16_f32 v121, v122, v123
  v_cvt_pk_f16_f32 v122, v124, v125
  v_mfma_f32_32x32x16_bf16 v[184:199], v[64:67], v[116:119], v[184:199]
  v_cvt_pk_f16_f32 v123, v126, v127
  ds_write_b128 v244, v[120:123]
  v_xor_b32_e64 v244, 16, v244
  v_mfma_f32_32x32x16_bf16 v[200:215], v[68:71], v[112:115], 0
  v_cvt_pk_f16_f32 v124, v128, v129
  v_cvt_pk_f16_f32 v125, v130, v131
  v_cvt_pk_f16_f32 v126, v132, v133
  v_mfma_f32_32x32x16_bf16 v[200:215], v[72:75], v[116:119], v[200:215]
  v_cvt_pk_f16_f32 v127, v134, v135
  ds_write_b128 v244, v[124:127]
  s_branch L_u3
L_u2:
  v_mfma_f32_32x32x16_bf16 v[184:199], v[216:219], v[92:95], 0
  v_cvt_pk_f16_f32 v120, v120, v121
  v_cvt_pk_f16_f32 v121, v122, v123
  v_cvt_pk_f16_f32 v122, v124, v125
  v_mfma_f32_32x32x16_bf16 v[184:199], v[220:223], v[96:99], v[184:199]
  v_cvt_pk_f16_f32 v123, v126, v127
  ds_write_b128 v244, v[120:123]
  v_xor_b32 v244, 16, v244
  v_mfma_f32_32x32x16_bf16 v[200:215], v[216:219], v[100:103], 0
  v_cvt_pk_f16_f32 v124, v128, v129
  v_cvt_pk_f16_f32 v125, v130, v131
  v_cvt_pk_f16_f32 v126, v132, v133
  v_mfma_f32_32x32x16_bf16 v[200:215], v[220:223], v[104:107], v[200:215]
  v_cvt_pk_f16_f32 v127, v134, v135
  ds_write_b128 v244, v[124:127]
L_u3:
  buffer_load_dwordx4 v[16:19], v6, s[28:31], s94 offen
  s_add_u32 s94, s94, 416
  buffer_load_dwordx4 v[112:115], v6, s[28:31], s94 offen
  s_add_u32 s94, s94, 416
  s_cmp_lg_u32 s84, 0
  s_cbranch_scc1 L_hu1
  v_lshl_add_u32 v12, v12, 7, v8
  v_lshl_add_u32 v13, v13, 7, v8
  v_lshl_add_u32 v14, v14, 7, v8
  v_lshl_add_u32 v15, v15, 7, v8
  s_add_u32 m0, s76, 16256
  s_mov_b32 exec_hi, 0xffffff
  buffer_load_dwordx4 v12, s[32:35], 0 offen lds
  s_add_u32 m0, s76, 17312
  s_nop 0
  buffer_load_dwordx4 v13, s[32:35], 0 offen lds
  s_add_u32 m0, s76, 18368
  s_mov_b32 exec_hi, 0xffff
  buffer_load_dwordx4 v14, s[32:35], 0 offen lds
  s_add_u32 m0, s76, 19424
  s_nop 0
  buffer_load_dwordx4 v15, s[32:35], 0 offen lds
  s_mov_b32 exec_hi, -1
  s_branch L_hu2
L_hu1:
L_hu2:
  v_cvt_pk_f16_f32 v136, v136, v137
  s_waitcnt lgkmcnt(8)
  v_xor_b32 v224, v224, v30
  v_cvt_pk_f16_f32 v137, v138, v139
  v_cvt_pk_f16_f32 v138, v140, v141
  v_xor_b32 v232, 32, v224
  v_cvt_pk_f16_f32 v139, v142, v143
  ds_write_b128 v245, v[136:139]
  v_xor_b32 v245, 16, v245
  v_xor_b32_e64 v225, v225, v30
  v_cvt_pk_f16_f32 v140, v144, v145
  v_cvt_pk_f16_f32 v141, v146, v147
  v_cvt_pk_f16_f32 v142, v148, v149
  v_xor_b32 v233, 32, v225
  v_cvt_pk_f16_f32 v143, v150, v151
  ds_write_b128 v245, v[140:143]
  v_cvt_pk_f16_f32 v184, v184, v185
  s_waitcnt lgkmcnt(9)
  v_xor_b32_e64 v226, v226, v30
  v_cvt_pk_f16_f32 v185, v186, v187
  v_cvt_pk_f16_f32 v186, v188, v189
  v_xor_b32 v234, 32, v226
  v_cvt_pk_f16_f32 v187, v190, v191
  ds_write_b128 v248, v[184:187]
  v_xor_b32 v248, 16, v248
  v_xor_b32 v227, v227, v30
  v_cvt_pk_f16_f32 v188, v192, v193
  v_cvt_pk_f16_f32 v189, v194, v195
  v_cvt_pk_f16_f32 v190, v196, v197
  v_xor_b32 v235, 32, v227
  v_cvt_pk_f16_f32 v191, v198, v199
  ds_write_b128 v248, v[188:191]
  v_cvt_pk_f16_f32 v200, v200, v201
  s_waitcnt lgkmcnt(10)
  v_xor_b32 v228, v228, v30
  v_cvt_pk_f16_f32 v201, v202, v203
  v_cvt_pk_f16_f32 v202, v204, v205
  v_xor_b32_e64 v240, 32, v228
  v_cvt_pk_f16_f32 v203, v206, v207
  ds_write_b128 v249, v[200:203]
  v_xor_b32 v249, 16, v249
  v_xor_b32 v229, v229, v30
  v_cvt_pk_f16_f32 v204, v208, v209
  v_cvt_pk_f16_f32 v205, v210, v211
  v_cvt_pk_f16_f32 v206, v212, v213
  v_xor_b32_e64 v241, 32, v229
  v_cvt_pk_f16_f32 v207, v214, v215
  ds_write_b128 v249, v[204:207]
  v_readlane_b32 s0, v250, 0
  v_readlane_b32 s1, v250, 26
  s_sub_u32 s75, 0x7f000000, s0
  s_sub_u32 s1, 0x7f000000, s1
  s_sub_u32 s74, 254, s74
  s_lshl_b32 s74, s74, 23
  s_mov_b32 s92, 0x88888888
  s_mov_b32 s93, 0x88888888
  s_waitcnt lgkmcnt(0)
  s_barrier
  ds_read_b64_tr_b16 v[60:61], v224 offset:0
  ds_read_b64_tr_b16 v[62:63], v225 offset:0
  ds_read_b64_tr_b16 v[64:65], v232 offset:0
  ds_read_b64_tr_b16 v[66:67], v233 offset:0
  ds_read_b64_tr_b16 v[68:69], v224 offset:43328
  ds_read_b64_tr_b16 v[70:71], v225 offset:43328
  ds_read_b64_tr_b16 v[72:73], v232 offset:43328
  ds_read_b64_tr_b16 v[74:75], v233 offset:43328
  ds_read_b64_tr_b16 v[76:77], v226 offset:0
  ds_read_b64_tr_b16 v[78:79], v227 offset:0
  ds_read_b64_tr_b16 v[80:81], v234 offset:0
  ds_read_b64_tr_b16 v[82:83], v235 offset:0
  ds_read_b64_tr_b16 v[84:85], v226 offset:43328
  ds_read_b64_tr_b16 v[86:87], v227 offset:43328
  ds_read_b64_tr_b16 v[88:89], v234 offset:43328
  ds_read_b64_tr_b16 v[90:91], v235 offset:43328
  s_cmp_ge_u32 s3, 6
  s_cbranch_scc1 L_lin
  ds_read_b64_tr_b16 v[92:93], v228 offset:0
  ds_read_b64_tr_b16 v[94:95], v229 offset:0
  ds_read_b64_tr_b16 v[96:97], v240 offset:0
  ds_read_b64_tr_b16 v[98:99], v241 offset:0
  ds_read_b64_tr_b16 v[100:101], v228 offset:43328
  ds_read_b64_tr_b16 v[102:103], v229 offset:43328
  ds_read_b64_tr_b16 v[104:105], v240 offset:43328
  ds_read_b64_tr_b16 v[106:107], v241 offset:43328
  s_waitcnt lgkmcnt(6)
  v_pk_add_f16 v92, v92, v94
  v_pk_add_f16 v93, v93, v95
  ds_write_b64 v59, v[92:93] offset:30720
  s_waitcnt lgkmcnt(5)
  v_pk_add_f16 v96, v96, v98
  v_pk_add_f16 v97, v97, v99
  s_waitcnt lgkmcnt(3)
  v_pk_add_f16 v100, v100, v102
  v_pk_add_f16 v101, v101, v103
  ds_write_b64 v59, v[100:101] offset:32768
  s_waitcnt lgkmcnt(2)
  v_pk_add_f16 v104, v104, v106
  v_pk_add_f16 v105, v105, v107
  v_cndmask_b32 v96, v96, v104, s[92:93]
  v_cndmask_b32 v97, v97, v105, s[92:93]
  ds_write_b64 v59, v[96:97] offset:31744
  ds_write_b32 v230, v104 offset:3072
  ds_write_b32 v230, v105 offset:3088
  s_branch L_p2
L_lin:
  s_and_b32 s98, s3, 1
  s_cselect_b64 vcc, -1, 0
  s_lshl_b32 s99, s98, 5
  v_mov_b32 v31, 0
  v_xor_b32 v236, s99, v236
  v_xor_b32_e64 v237, s99, v237
  v_cndmask_b32 v238, v238, v239, vcc
  ds_read_b64_tr_b16 v[92:93], v236
  ds_read_b64_tr_b16 v[94:95], v237
  ds_read_u16_d16_hi v31, v238
  s_lshl_b32 s98, s98, 10
  v_add_u32 v29, s98, v1
  s_waitcnt lgkmcnt(2)
  v_cvt_f32_f16 v96, v92
  v_cvt_f32_f16_sdwa v97, v92 dst_sel:DWORD dst_unused:UNUSED_PAD src0_sel:WORD_1
  v_mul_f32 v96, s1, v96
  v_mul_f32 v97, s1, v97
  v_mul_f32 v96, s0, v96
  v_mul_f32 v97, s0, v97
  v_cvt_pk_bf16_f32 v92, v96, v97
  v_cvt_f32_f16 v98, v93
  v_cvt_f32_f16_sdwa v99, v93 dst_sel:DWORD dst_unused:UNUSED_PAD src0_sel:WORD_1
  v_mul_f32 v98, s1, v98
  v_mul_f32 v99, s1, v99
  v_mul_f32 v98, s0, v98
  v_mul_f32 v99, s0, v99
  v_cvt_pk_bf16_f32 v93, v98, v99
  s_waitcnt lgkmcnt(1)
  v_cvt_f32_f16 v100, v94
  v_cvt_f32_f16_sdwa v101, v94 dst_sel:DWORD dst_unused:UNUSED_PAD src0_sel:WORD_1
  v_mul_f32 v100, s1, v100
  v_mul_f32 v101, s1, v101
  v_mul_f32 v100, s0, v100
  v_mul_f32 v101, s0, v101
  v_cvt_pk_bf16_f32 v94, v100, v101
  v_cvt_f32_f16 v102, v95
  v_cvt_f32_f16_sdwa v103, v95 dst_sel:DWORD dst_unused:UNUSED_PAD src0_sel:WORD_1
  v_mul_f32 v102, s1, v102
  v_mul_f32 v103, s1, v103
  s_mov_b32 exec_lo, 0
  s_mov_b32 exec_hi, 0xffff
  s_waitcnt lgkmcnt(0)
  v_mov_b32 v102, v31
  s_mov_b64 exec, -1
  v_mul_f32 v102, s0, v102
  v_mul_f32 v103, s0, v103
  v_cvt_pk_bf16_f32 v95, v102, v103
  ds_write_b128 v29, v[92:95] offset:39936
L_p2:
  v_pk_add_f16 v76, v76, v78
  v_pk_add_f16 v77, v77, v79
  ds_write_b64 v59, v[76:77] offset:18432
  v_pk_add_f16 v80, v80, v82
  v_pk_add_f16 v81, v81, v83
  v_pk_add_f16 v84, v84, v86
  v_pk_add_f16 v85, v85, v87
  ds_write_b64 v59, v[84:85] offset:20480
  v_pk_add_f16 v88, v88, v90
  v_pk_add_f16 v89, v89, v91
  v_cndmask_b32 v80, v80, v88, s[92:93]
  v_cndmask_b32 v81, v81, v89, s[92:93]
  ds_write_b64 v59, v[80:81] offset:19456
  ds_write_b32 v230, v88 offset:1024
  ds_write_b32 v230, v89 offset:1040
  v_pk_add_f16 v60, v60, v62
  v_pk_add_f16 v61, v61, v63
  ds_write_b64 v59, v[60:61] offset:6144
  v_pk_add_f16 v64, v64, v66
  v_pk_add_f16 v65, v65, v67
  v_pk_add_f16 v68, v68, v70
  v_pk_add_f16 v69, v69, v71
  ds_write_b64 v59, v[68:69] offset:8192
  v_pk_add_f16 v72, v72, v74
  v_pk_add_f16 v73, v73, v75
  v_cndmask_b32 v64, v64, v72, s[92:93]
  v_cndmask_b32 v65, v65, v73, s[92:93]
  ds_write_b64 v59, v[64:65] offset:7168
  s_cmp_lt_u32 s3, 2
  s_cbranch_scc1 L_p2d
  v_subrev_u32 v230, 1024, v230
  ds_write_b32 v230, v72 offset:0
  ds_write_b32 v230, v73 offset:16
  s_branch L_built
L_p2d:
  ds_write_b64 v231, v[72:73] offset:5120
L_built:
  s_mov_b32 s0, s74
  s_mov_b32 s1, s75
  s_mov_b32 s96, 0x3e000000
  s_mov_b32 s97, 0x43000000
  s_mov_b32 s51, 1
  s_mul_i32 s98, s3, 1536
  s_add_u32 s98, s98, 116736
  s_cmp_lg_u32 s84, 0
  s_cbranch_scc1 L_g1c
  s_sub_u32 s94, s94, 416
  s_waitcnt vmcnt(4)
  ds_read_u16_d16_hi v32, v10 offset:0
  ds_read_u16_d16_hi v33, v10 offset:2
  ds_read_u16_d16_hi v34, v10 offset:2112
  ds_read_u16_d16_hi v35, v10 offset:2114
  ds_read_u16_d16_hi v36, v10 offset:128
  ds_read_u16_d16_hi v37, v10 offset:130
  ds_read_u16_d16_hi v38, v10 offset:2240
  ds_read_u16_d16_hi v39, v10 offset:2242
  ds_read_u16_d16_hi v40, v10 offset:256
  ds_read_u16_d16_hi v41, v10 offset:258
  ds_read_u16_d16_hi v42, v10 offset:2368
  ds_read_u16_d16_hi v43, v10 offset:2370
  ds_read_u16_d16_hi v44, v10 offset:384
  ds_read_u16_d16_hi v45, v10 offset:386
  ds_read_u16_d16_hi v46, v10 offset:2496
  ds_read_u16_d16_hi v47, v10 offset:2498
  ds_read_u16_d16_hi v48, v10 offset:512
  ds_read_u16_d16_hi v49, v10 offset:514
  ds_read_u16_d16_hi v50, v10 offset:2624
  ds_read_u16_d16_hi v51, v10 offset:2626
  ds_read_u16_d16_hi v52, v10 offset:640
  ds_read_u16_d16_hi v53, v10 offset:642
  ds_read_u16_d16_hi v54, v10 offset:2752
  ds_read_u16_d16_hi v55, v10 offset:2754
  ds_read_u16_d16_hi v56, v10 offset:768
  ds_read_u16_d16_hi v57, v10 offset:770
  s_waitcnt lgkmcnt(14)
  v_max3_f32 v58, |v32|, |v33|, 0
  v_cvt_pk_f16_f32 v184, v32, v33
  v_max3_f32 v58, |v34|, |v35|, v58
  v_cvt_pk_f16_f32 v185, v34, v35
  v_max3_f32 v58, |v36|, |v37|, v58
  v_cvt_pk_f16_f32 v186, v36, v37
  v_max3_f32 v58, |v38|, |v39|, v58
  v_cvt_pk_f16_f32 v187, v38, v39
  v_max3_f32 v58, |v40|, |v41|, v58
  v_cvt_pk_f16_f32 v188, v40, v41
  v_max3_f32 v58, |v42|, |v43|, v58
  v_cvt_pk_f16_f32 v189, v42, v43
  s_waitcnt lgkmcnt(12)
  v_max3_f32 v58, |v44|, |v45|, v58
  v_cvt_pk_f16_f32 v190, v44, v45
  s_waitcnt lgkmcnt(10)
  v_max3_f32 v58, |v46|, |v47|, v58
  v_cvt_pk_f16_f32 v191, v46, v47
  s_waitcnt lgkmcnt(8)
  v_max3_f32 v58, |v48|, |v49|, v58
  v_cvt_pk_f16_f32 v192, v48, v49
  s_waitcnt lgkmcnt(6)
  v_max3_f32 v58, |v50|, |v51|, v58
  v_cvt_pk_f16_f32 v193, v50, v51
  s_waitcnt lgkmcnt(4)
  v_max3_f32 v58, |v52|, |v53|, v58
  v_cvt_pk_f16_f32 v194, v52, v53
  s_waitcnt lgkmcnt(2)
  v_max3_f32 v58, |v54|, |v55|, v58
  v_cvt_pk_f16_f32 v195, v54, v55
  s_waitcnt lgkmcnt(0)
  v_max3_f32 v58, |v56|, |v57|, v58
  v_cvt_pk_f16_f32 v196, v56, v57
  s_waitcnt lgkmcnt(0)
  s_barrier
  s_branch L_cin_go
L_g1c:
  s_waitcnt lgkmcnt(0)
  s_barrier
  s_add_u32 s76, s76, -63168
  s_waitcnt vmcnt(1)
  v_lshl_add_u32 v16, v16, 7, v8
  v_lshl_add_u32 v17, v17, 7, v8
  v_lshl_add_u32 v18, v18, 7, v8
  v_lshl_add_u32 v19, v19, 7, v8
  s_add_u32 m0, s76, 0
  s_mov_b32 exec_hi, 0xffffff
  buffer_load_dwordx4 v16, s[32:35], 0 offen lds
  s_add_u32 m0, s76, 1056
  s_nop 0
  buffer_load_dwordx4 v17, s[32:35], 0 offen lds
  s_add_u32 m0, s76, 2112
  s_mov_b32 exec_hi, 0xffff
  buffer_load_dwordx4 v18, s[32:35], 0 offen lds
  s_add_u32 m0, s76, 3168
  s_nop 0
  buffer_load_dwordx4 v19, s[32:35], 0 offen lds
  s_mov_b32 exec_hi, -1
  s_waitcnt vmcnt(4)
  v_lshl_add_u32 v112, v112, 7, v8
  v_lshl_add_u32 v113, v113, 7, v8
  v_lshl_add_u32 v114, v114, 7, v8
  v_lshl_add_u32 v115, v115, 7, v8
  s_add_u32 m0, s76, 16256
  s_mov_b32 exec_hi, 0xffffff
  buffer_load_dwordx4 v112, s[32:35], 0 offen lds
  s_add_u32 m0, s76, 17312
  s_nop 0
  buffer_load_dwordx4 v113, s[32:35], 0 offen lds
  s_add_u32 m0, s76, 18368
  s_mov_b32 exec_hi, 0xffff
  buffer_load_dwordx4 v114, s[32:35], 0 offen lds
  s_add_u32 m0, s76, 19424
  s_nop 0
  buffer_load_dwordx4 v115, s[32:35], 0 offen lds
  s_mov_b32 exec_hi, -1
  buffer_load_dwordx4 v[16:19], v6, s[28:31], s94 offen
  s_add_u32 s94, s94, 416
  v_add_u32 v10, -63168, v10
  v_add_u32 v4, -63168, v4
  v_add_u32 v5, -63168, v5
  ds_write_b32 v10, v7 offset:2880
  ds_write_b32 v10, v7 offset:19136
L_g1d:
  s_waitcnt vmcnt(5)
  ds_read_u16_d16_hi v32, v10 offset:0
  ds_read_u16_d16_hi v33, v10 offset:2
  ds_read_u16_d16_hi v34, v10 offset:2112
  ds_read_u16_d16_hi v35, v10 offset:2114
  ds_read_u16_d16_hi v36, v10 offset:128
  ds_read_u16_d16_hi v37, v10 offset:130
  ds_read_u16_d16_hi v38, v10 offset:2240
  ds_read_u16_d16_hi v39, v10 offset:2242
  ds_read_u16_d16_hi v40, v10 offset:256
  ds_read_u16_d16_hi v41, v10 offset:258
  ds_read_u16_d16_hi v42, v10 offset:2368
  ds_read_u16_d16_hi v43, v10 offset:2370
  ds_read_u16_d16_hi v44, v10 offset:384
  ds_read_u16_d16_hi v45, v10 offset:386
  ds_read_u16_d16_hi v46, v10 offset:2496
  ds_read_u16_d16_hi v47, v10 offset:2498
  ds_read_u16_d16_hi v48, v10 offset:512
  ds_read_u16_d16_hi v49, v10 offset:514
  ds_read_u16_d16_hi v50, v10 offset:2624
  ds_read_u16_d16_hi v51, v10 offset:2626
  ds_read_u16_d16_hi v52, v10 offset:640
  ds_read_u16_d16_hi v53, v10 offset:642
  ds_read_u16_d16_hi v54, v10 offset:2752
  ds_read_u16_d16_hi v55, v10 offset:2754
  ds_read_u16_d16_hi v56, v10 offset:768
  ds_read_u16_d16_hi v57, v10 offset:770
  s_waitcnt lgkmcnt(14)
  v_max3_f32 v58, |v32|, |v33|, 0
  v_cvt_pk_f16_f32 v184, v32, v33
  v_max3_f32 v58, |v34|, |v35|, v58
  v_cvt_pk_f16_f32 v185, v34, v35
  v_max3_f32 v58, |v36|, |v37|, v58
  v_cvt_pk_f16_f32 v186, v36, v37
  v_max3_f32 v58, |v38|, |v39|, v58
  v_cvt_pk_f16_f32 v187, v38, v39
  v_max3_f32 v58, |v40|, |v41|, v58
  v_cvt_pk_f16_f32 v188, v40, v41
  v_max3_f32 v58, |v42|, |v43|, v58
  v_cvt_pk_f16_f32 v189, v42, v43
  s_waitcnt lgkmcnt(12)
  v_max3_f32 v58, |v44|, |v45|, v58
  v_cvt_pk_f16_f32 v190, v44, v45
  s_waitcnt lgkmcnt(10)
  v_max3_f32 v58, |v46|, |v47|, v58
  v_cvt_pk_f16_f32 v191, v46, v47
  s_waitcnt lgkmcnt(8)
  v_max3_f32 v58, |v48|, |v49|, v58
  v_cvt_pk_f16_f32 v192, v48, v49
  s_waitcnt lgkmcnt(6)
  v_max3_f32 v58, |v50|, |v51|, v58
  v_cvt_pk_f16_f32 v193, v50, v51
  s_waitcnt lgkmcnt(4)
  v_max3_f32 v58, |v52|, |v53|, v58
  v_cvt_pk_f16_f32 v194, v52, v53
  s_waitcnt lgkmcnt(2)
  v_max3_f32 v58, |v54|, |v55|, v58
  v_cvt_pk_f16_f32 v195, v54, v55
  s_waitcnt lgkmcnt(0)
  v_max3_f32 v58, |v56|, |v57|, v58
  v_cvt_pk_f16_f32 v196, v56, v57
L_cin_go:
  ds_write_b32 v11, v184 offset:0
  ds_write_b32 v11, v185 offset:160
  ds_write_b32 v11, v186 offset:320
  ds_write_b32 v11, v187 offset:480
  ds_write_b32 v11, v188 offset:640
  ds_write_b32 v11, v189 offset:800
  ds_write_b32 v11, v190 offset:960
  ds_write_b32 v11, v191 offset:1120
  ds_write_b32 v11, v192 offset:1280
  ds_write_b32 v11, v193 offset:1440
  ds_write_b32 v11, v194 offset:1600
  ds_write_b32 v11, v195 offset:1760
  ds_write_b32 v11, v196 offset:1920
  s_mov_b32 s81, 16256
  s_add_u32 s76, s76, 16256
  v_lshlrev_b32 v7, 2, v0
  v_add_u32 v7, s98, v7
L_cin_loop:
  v_cmp_le_f32 s[90:91], s97, v58
  v_cmp_le_f32 vcc, s96, v58
  s_mov_b32 s49, s74
  s_mov_b32 s50, s75
  s_cmp_lg_u64 s[90:91], 0
  s_cbranch_scc1 L_cslow
  s_cbranch_vccz L_cslow
L_cconv:
  s_cmp_lg_u32 s51, 0
  s_cbranch_scc1 L_first
  ds_read_b64_tr_b16 v[60:61], v20 offset:0
  v_mul_f32 v116, v184, v192
  v_mul_f32 v117, v185, v193
  ds_read_b64_tr_b16 v[74:75], v20 offset:32
  v_mul_f32 v118, v186, v194
  ds_read_b64_tr_b16 v[88:89], v20 offset:64
  v_mul_f32 v119, v187, v195
  ds_read_b64_tr_b16 v[102:103], v20 offset:96
  v_fmac_f32 v116, v188, v191
  ds_read_b64_tr_b16 v[66:67], v23 offset:0
  v_fmac_f32 v117, v200, v208
  ds_read_b64_tr_b16 v[80:81], v23 offset:32
  v_fmac_f32 v118, v201, v209
  ds_read_b64_tr_b16 v[94:95], v23 offset:64
  v_fmac_f32 v119, v202, v210
  ds_read_b64_tr_b16 v[108:109], v23 offset:96
  v_fmac_f32_e64 v116, v203, v211
  ds_read_b64_tr_b16 v[68:69], v24 offset:0
  v_fmac_f32 v117, v204, v207
  ds_read_b64_tr_b16 v[82:83], v24 offset:32
  v_fmac_f32 v118, v216, v224
  ds_read_b64_tr_b16 v[96:97], v24 offset:64
  v_fmac_f32 v119, v217, v225
  ds_read_b64_tr_b16 v[110:111], v24 offset:96
  v_fmac_f32 v116, v218, v226
  ds_read_b64_tr_b16 v[124:125], v4 offset:0
  v_fmac_f32_e64 v117, v219, v227
  ds_read_b64_tr_b16 v[126:127], v5 offset:0
  v_fmac_f32 v118, v220, v223
  v_fmac_f32 v119, v232, v240
  ds_read_b64_tr_b16 v[136:137], v4 offset:32
  v_fmac_f32 v116, v233, v241
  ds_read_b64_tr_b16 v[138:139], v5 offset:32
  v_fmac_f32 v117, v234, v242
  ds_read_b64_tr_b16 v[148:149], v4 offset:64
  v_fmac_f32 v118, v235, v243
  ds_read_b64_tr_b16 v[150:151], v5 offset:64
  v_fmac_f32 v119, v236, v239
  ds_read_b64_tr_b16 v[160:161], v4 offset:96
  v_fmac_f32 v116, v189, v196
  ds_read_b64_tr_b16 v[162:163], v5 offset:96
  v_fmac_f32 v117, v189, v197
  ds_read_b128 v[164:167], v1 offset:39936
  v_fmac_f32 v118, v190, v198
  ds_read_b128 v[168:171], v1 offset:40960
  v_fmac_f32 v119, v190, v199
  ds_read_b128 v[172:175], v1 offset:8192
  v_fmac_f32_e64 v116, v205, v212
  ds_read_b128 v[176:179], v1 offset:6144
  v_fmac_f32 v117, v205, v213
  ds_read_b64_tr_b16 v[70:71], v25 offset:0
  v_fmac_f32 v118, v206, v214
  ds_read_b64_tr_b16 v[84:85], v25 offset:32
  v_fmac_f32 v119, v206, v215
  ds_read_b64_tr_b16 v[98:99], v25 offset:64
  v_fmac_f32 v116, v221, v228
  v_fmac_f32 v117, v221, v229
  ds_read_b64_tr_b16 v[112:113], v25 offset:96
  v_fmac_f32 v118, v222, v230
  ds_read_b64_tr_b16 v[72:73], v26 offset:0
  v_fmac_f32 v119, v222, v231
  ds_read_b64_tr_b16 v[86:87], v26 offset:32
  v_fmac_f32 v116, v237, v244
  ds_read_b64_tr_b16 v[100:101], v26 offset:64
  v_fmac_f32 v117, v237, v245
  ds_read_b64_tr_b16 v[114:115], v26 offset:96
  v_fmac_f32 v118, v238, v246
  ds_read_b64_tr_b16 v[62:63], v21 offset:0
  v_fmac_f32_e64 v119, v238, v247
  ds_read_b64_tr_b16 v[76:77], v21 offset:32
  v_add_f32 v116, v116, v117
  ds_read_b64_tr_b16 v[90:91], v21 offset:64
  v_add_f32 v118, v118, v119
  ds_read_b64_tr_b16 v[104:105], v21 offset:96
  v_add_f32 v116, v116, v118
  ds_read_b64_tr_b16 v[64:65], v22 offset:0
  v_mul_f32 v116, s49, v116
  ds_read_b64_tr_b16 v[78:79], v22 offset:32
  v_mul_f32_e64 v116, s50, v116
  ds_read_b64_tr_b16 v[92:93], v22 offset:64
  ds_write_b32 v7, v116
  ds_read_b64_tr_b16 v[106:107], v22 offset:96
  v_add_u32 v7, 256, v7
  s_waitcnt lgkmcnt(14)
  v_pk_mul_f16 v120, v60, v67 op_sel:[0,0] op_sel_hi:[0,1]
  v_pk_mul_f16 v121, v60, v67 op_sel:[1,0] op_sel_hi:[1,1]
  v_pk_mul_f16 v122, v60, v68 op_sel:[0,0] op_sel_hi:[0,1]
  v_pk_mul_f16 v123, v60, v68 op_sel:[1,0] op_sel_hi:[1,1]
  v_pk_mul_f16 v132, v74, v81 op_sel:[0,0] op_sel_hi:[0,1]
  v_pk_mul_f16 v133, v74, v81 op_sel:[1,0] op_sel_hi:[1,1]
  v_pk_mul_f16 v134, v74, v82 op_sel:[0,0] op_sel_hi:[0,1]
  v_pk_mul_f16 v135, v74, v82 op_sel:[1,0] op_sel_hi:[1,1]
  v_pk_mul_f16 v144, v88, v95 op_sel:[0,0] op_sel_hi:[0,1]
  v_pk_mul_f16 v145, v88, v95 op_sel:[1,0] op_sel_hi:[1,1]
  v_pk_mul_f16 v146, v88, v96 op_sel:[0,0] op_sel_hi:[0,1]
  v_pk_mul_f16 v147, v88, v96 op_sel:[1,0] op_sel_hi:[1,1]
  v_pk_mul_f16 v156, v102, v109 op_sel:[0,0] op_sel_hi:[0,1]
  v_pk_mul_f16 v157, v102, v109 op_sel:[1,0] op_sel_hi:[1,1]
  v_pk_mul_f16 v158, v102, v110 op_sel:[0,0] op_sel_hi:[0,1]
  v_pk_mul_f16 v159, v102, v110 op_sel:[1,0] op_sel_hi:[1,1]
  s_waitcnt vmcnt(0)
  v_lshl_add_u32 v16, v16, 7, v8
  v_lshl_add_u32 v17, v17, 7, v8
  v_lshl_add_u32 v18, v18, 7, v8
  v_lshl_add_u32 v19, v19, 7, v8
  s_add_u32 m0, s76, 0
  s_mov_b32 exec_hi, 0xffffff
  buffer_load_dwordx4 v16, s[32:35], 0 offen lds
  s_add_u32 m0, s76, 1056
  s_nop 0
  buffer_load_dwordx4 v17, s[32:35], 0 offen lds
  s_add_u32 m0, s76, 2112
  s_mov_b32 exec_hi, 0xffff
  buffer_load_dwordx4 v18, s[32:35], 0 offen lds
  s_add_u32 m0, s76, 3168
  s_nop 0
  buffer_load_dwordx4 v19, s[32:35], 0 offen lds
  s_mov_b32 exec_hi, -1
  buffer_load_dwordx4 v[16:19], v6, s[28:31], s94 offen
  s_add_u32 s94, s94, 416
L_novm:
  v_add_u32 v10, s81, v10
  v_add_u32 v4, s81, v4
  v_add_u32 v5, s81, v5
  s_sub_u32 s76, s76, s81
  s_sub_u32 s81, 0, s81
  s_mov_b32 s51, 0
  s_waitcnt lgkmcnt(14)
  s_cmp_eq_u32 s84, 0
  s_cbranch_scc1 L_np1
  s_setprio 1
L_np1:
  v_mfma_f32_16x16x32_bf16 v[184:187], v[164:167], v[124:127], 0
  ds_read_b128 v[180:183], v1 offset:7168
  v_pk_mul_f16 v116, v60, v69 op_sel:[0,0] op_sel_hi:[0,1]
  v_mfma_f32_16x16x32_bf16 v[200:203], v[164:167], v[136:139], 0
  v_pk_mul_f16 v117, v60, v69 op_sel:[1,0] op_sel_hi:[1,1]
  v_mfma_f32_16x16x32_bf16 v[216:219], v[164:167], v[148:151], 0
  v_pk_mul_f16 v118, v60, v70 op_sel:[0,0] op_sel_hi:[0,1]
  v_mfma_f32_16x16x32_bf16 v[232:235], v[164:167], v[160:163], 0
  v_pk_mul_f16 v119, v60, v70 op_sel:[1,0] op_sel_hi:[1,1]
  v_mfma_f32_16x16x32_bf16 v[188:191], v[168:171], v[124:127], 0
  ds_read_b128 v[164:167], v1 offset:5120
  v_pk_mul_f16 v128, v74, v83 op_sel:[0,0] op_sel_hi:[0,1]
  v_mfma_f32_16x16x32_bf16 v[204:207], v[168:171], v[136:139], 0
  v_pk_mul_f16 v129, v74, v83 op_sel:[1,0] op_sel_hi:[1,1]
  v_mfma_f32_16x16x32_bf16 v[220:223], v[168:171], v[148:151], 0
  v_pk_mul_f16 v130, v74, v84 op_sel:[0,0] op_sel_hi:[0,1]
  v_mfma_f32_16x16x32_bf16 v[236:239], v[168:171], v[160:163], 0
  v_pk_mul_f16 v131, v74, v84 op_sel:[1,0] op_sel_hi:[1,1]
  v_mfma_f32_16x16x32_f16 v[192:195], v[172:175], v[120:123], 0
  ds_read_b128 v[168:171], v1 offset:11264
  v_pk_mul_f16 v140, v88, v97 op_sel:[0,0] op_sel_hi:[0,1]
  v_mfma_f32_16x16x32_f16 v[208:211], v[172:175], v[132:135], 0
  v_pk_mul_f16 v141, v88, v97 op_sel:[1,0] op_sel_hi:[1,1]
  v_mfma_f32_16x16x32_f16 v[224:227], v[172:175], v[144:147], 0
  s_waitcnt lgkmcnt(14)
  v_pk_mul_f16 v142, v88, v98 op_sel:[0,0] op_sel_hi:[0,1]
  v_mfma_f32_16x16x32_f16 v[240:243], v[172:175], v[156:159], 0
  s_nop 0
  v_pk_mul_f16 v143, v88, v98 op_sel:[1,0] op_sel_hi:[1,1]
  v_mfma_f32_16x16x32_f16 v[184:187], v[176:179], v[120:123], v[184:187]
  ds_read_b128 v[172:175], v1 offset:9216
  v_pk_mul_f16 v152, v102, v111 op_sel:[0,0] op_sel_hi:[0,1]
  v_mfma_f32_16x16x32_f16 v[200:203], v[176:179], v[132:135], v[200:203]
  v_pk_mul_f16 v153, v102, v111 op_sel:[1,0] op_sel_hi:[1,1]
  v_mfma_f32_16x16x32_f16 v[216:219], v[176:179], v[144:147], v[216:219]
  s_waitcnt lgkmcnt(14)
  v_pk_mul_f16 v154, v102, v112 op_sel:[0,0] op_sel_hi:[0,1]
  v_mfma_f32_16x16x32_f16 v[232:235], v[176:179], v[156:159], v[232:235]
  s_waitcnt lgkmcnt(3)
  v_pk_mul_f16 v155, v102, v112 op_sel:[1,0] op_sel_hi:[1,1]
  v_mfma_f32_16x16x32_f16 v[188:191], v[180:183], v[120:123], v[188:191]
  ds_read_b128 v[176:179], v1 offset:10240
  v_pk_mul_f16 v124, v61, v68 op_sel:[0,0] op_sel_hi:[0,1]
  v_mfma_f32_16x16x32_f16 v[204:207], v[180:183], v[132:135], v[204:207]
  v_pk_mul_f16 v125, v61, v68 op_sel:[1,0] op_sel_hi:[1,1]
  v_mfma_f32_16x16x32_f16 v[220:223], v[180:183], v[144:147], v[220:223]
  v_pk_mul_f16 v126, v61, v69 op_sel:[0,0] op_sel_hi:[0,1]
  v_mfma_f32_16x16x32_f16 v[236:239], v[180:183], v[156:159], v[236:239]
  s_waitcnt lgkmcnt(3)
  v_pk_mul_f16 v127, v61, v69 op_sel:[1,0] op_sel_hi:[1,1]
  v_mfma_f32_16x16x32_f16 v[196:199], v[164:167], v[120:123], 0
  ds_read_b128 v[180:183], v1 offset:14336
  v_pk_mul_f16 v136, v75, v82 op_sel:[0,0] op_sel_hi:[0,1]
  v_mfma_f32_16x16x32_f16 v[212:215], v[164:167], v[132:135], 0
  s_nop 0
  v_pk_mul_f16 v120, v60, v71 op_sel:[0,0] op_sel_hi:[0,1]
  v_mfma_f32_16x16x32_f16 v[228:231], v[164:167], v[144:147], 0
  v_pk_mul_f16 v121, v60, v71 op_sel:[1,0] op_sel_hi:[1,1]
  v_mfma_f32_16x16x32_f16 v[244:247], v[164:167], v[156:159], 0
  s_nop 0
  s_waitcnt lgkmcnt(3)
  v_pk_mul_f16 v122, v60, v66 op_sel:[0,1] op_sel_hi:[0,0]
  v_mfma_f32_16x16x32_f16 v[192:195], v[168:171], v[116:119], v[192:195]
  ds_read_b128 v[164:167], v1 offset:12288
  v_pk_mul_f16 v123, v60, v72 op_sel:[0,0] op_sel_hi:[1,0]
  v_mfma_f32_16x16x32_f16 v[208:211], v[168:171], v[128:131], v[208:211]
  v_pk_mul_f16 v132, v74, v85 op_sel:[0,0] op_sel_hi:[0,1]
  v_mfma_f32_16x16x32_f16 v[224:227], v[168:171], v[140:143], v[224:227]
  v_pk_mul_f16 v133, v74, v85 op_sel:[1,0] op_sel_hi:[1,1]
  v_mfma_f32_16x16x32_f16 v[240:243], v[168:171], v[152:155], v[240:243]
  s_nop 0
  s_waitcnt lgkmcnt(3)
  v_pk_mul_f16 v134, v74, v80 op_sel:[0,1] op_sel_hi:[0,0]
  v_mfma_f32_16x16x32_f16 v[184:187], v[172:175], v[116:119], v[184:187]
  ds_read_b128 v[168:171], v1 offset:13312
  v_pk_mul_f16 v135, v74, v86 op_sel:[0,0] op_sel_hi:[1,0]
  v_mfma_f32_16x16x32_f16 v[200:203], v[172:175], v[128:131], v[200:203]
  v_pk_mul_f16 v144, v88, v99 op_sel:[0,0] op_sel_hi:[0,1]
  v_mfma_f32_16x16x32_f16 v[216:219], v[172:175], v[140:143], v[216:219]
  s_setprio 2
  v_pk_mul_f16 v145, v88, v99 op_sel:[1,0] op_sel_hi:[1,1]
  v_mfma_f32_16x16x32_f16 v[232:235], v[172:175], v[152:155], v[232:235]
  s_waitcnt lgkmcnt(3)
  v_pk_mul_f16 v146, v88, v94 op_sel:[0,1] op_sel_hi:[0,0]
  v_mfma_f32_16x16x32_f16 v[188:191], v[176:179], v[116:119], v[188:191]
  ds_read_b128 v[172:175], v1 offset:0
  v_pk_mul_f16 v147, v88, v100 op_sel:[0,0] op_sel_hi:[1,0]
  v_mfma_f32_16x16x32_f16 v[204:207], v[176:179], v[128:131], v[204:207]
  v_pk_mul_f16 v156, v102, v113 op_sel:[0,0] op_sel_hi:[0,1]
  v_mfma_f32_16x16x32_f16 v[220:223], v[176:179], v[140:143], v[220:223]
  v_pk_mul_f16 v157, v102, v113 op_sel:[1,0] op_sel_hi:[1,1]
  v_mfma_f32_16x16x32_f16 v[236:239], v[176:179], v[152:155], v[236:239]
  s_waitcnt lgkmcnt(3)
  v_pk_mul_f16 v158, v102, v108 op_sel:[0,1] op_sel_hi:[0,0]
  v_mfma_f32_16x16x32_f16 v[192:195], v[180:183], v[120:123], v[192:195]
  ds_read_b128 v[176:179], v1 offset:17408
  v_pk_mul_f16 v159, v102, v114 op_sel:[0,0] op_sel_hi:[1,0]
  v_mfma_f32_16x16x32_f16 v[208:211], v[180:183], v[132:135], v[208:211]
  s_nop 0
  v_pk_mul_f16 v137, v75, v82 op_sel:[1,0] op_sel_hi:[1,1]
  v_mfma_f32_16x16x32_f16 v[224:227], v[180:183], v[144:147], v[224:227]
  v_pk_mul_f16 v138, v75, v83 op_sel:[0,0] op_sel_hi:[0,1]
  v_mfma_f32_16x16x32_f16 v[240:243], v[180:183], v[156:159], v[240:243]
  s_nop 0
  s_waitcnt lgkmcnt(3)
  v_pk_mul_f16 v139, v75, v83 op_sel:[1,0] op_sel_hi:[1,1]
  v_mfma_f32_16x16x32_f16 v[184:187], v[164:167], v[120:123], v[184:187]
  ds_read_b128 v[180:183], v1 offset:15360
  v_pk_mul_f16 v148, v89, v96 op_sel:[0,0] op_sel_hi:[0,1]
  v_mfma_f32_16x16x32_f16 v[200:203], v[164:167], v[132:135], v[200:203]
  v_pk_mul_f16 v149, v89, v96 op_sel:[1,0] op_sel_hi:[1,1]
  v_mfma_f32_16x16x32_f16 v[216:219], v[164:167], v[144:147], v[216:219]
  v_pk_mul_f16 v150, v89, v97 op_sel:[0,0] op_sel_hi:[0,1]
  v_mfma_f32_16x16x32_f16 v[232:235], v[164:167], v[156:159], v[232:235]
  s_nop 0
  s_waitcnt lgkmcnt(3)
  v_pk_mul_f16 v151, v89, v97 op_sel:[1,0] op_sel_hi:[1,1]
  v_mfma_f32_16x16x32_f16 v[188:191], v[168:171], v[120:123], v[188:191]
  ds_read_b128 v[164:167], v1 offset:16384
  v_pk_mul_f16 v160, v103, v110 op_sel:[0,0] op_sel_hi:[0,1]
  v_mfma_f32_16x16x32_f16 v[204:207], v[168:171], v[132:135], v[204:207]
  v_pk_mul_f16 v161, v103, v110 op_sel:[1,0] op_sel_hi:[1,1]
  v_mfma_f32_16x16x32_f16 v[220:223], v[168:171], v[144:147], v[220:223]
  v_pk_mul_f16 v162, v103, v111 op_sel:[0,0] op_sel_hi:[0,1]
  v_mfma_f32_16x16x32_f16 v[236:239], v[168:171], v[156:159], v[236:239]
  s_nop 0
  s_waitcnt lgkmcnt(3)
  v_pk_mul_f16 v163, v103, v111 op_sel:[1,0] op_sel_hi:[1,1]
  v_smfmac_f32_16x16x64_f16 v[196:199], v[172:175], v[116:123], v9
  ds_read_b128 v[168:171], v1 offset:20480
  v_smfmac_f32_16x16x64_f16 v[212:215], v[172:175], v[128:135], v9
  v_pk_mul_f16 v120, v61, v70 op_sel:[0,0] op_sel_hi:[0,1]
  v_smfmac_f32_16x16x64_f16 v[228:231], v[172:175], v[140:147], v9
  v_pk_mul_f16 v121, v61, v70 op_sel:[1,0] op_sel_hi:[1,1]
  v_smfmac_f32_16x16x64_f16 v[244:247], v[172:175], v[152:159], v9
  s_waitcnt lgkmcnt(3)
  v_pk_mul_f16 v122, v61, v71 op_sel:[0,0] op_sel_hi:[0,1]
  v_mfma_f32_16x16x32_f16 v[192:195], v[176:179], v[124:127], v[192:195]
  ds_read_b128 v[172:175], v1 offset:18432
  v_pk_mul_f16 v123, v61, v71 op_sel:[1,0] op_sel_hi:[1,1]
  v_mfma_f32_16x16x32_f16 v[208:211], v[176:179], v[136:139], v[208:211]
  v_pk_mul_f16 v132, v75, v84 op_sel:[0,0] op_sel_hi:[0,1]
  v_mfma_f32_16x16x32_f16 v[224:227], v[176:179], v[148:151], v[224:227]
  s_nop 0
  v_pk_mul_f16 v133, v75, v84 op_sel:[1,0] op_sel_hi:[1,1]
  v_mfma_f32_16x16x32_f16 v[240:243], v[176:179], v[160:163], v[240:243]
  s_waitcnt lgkmcnt(3)
  v_pk_mul_f16 v134, v75, v85 op_sel:[0,0] op_sel_hi:[0,1]
  v_mfma_f32_16x16x32_f16 v[184:187], v[180:183], v[124:127], v[184:187]
  ds_read_b128 v[176:179], v1 offset:19456
  v_pk_mul_f16 v135, v75, v85 op_sel:[1,0] op_sel_hi:[1,1]
  v_mfma_f32_16x16x32_f16 v[200:203], v[180:183], v[136:139], v[200:203]
  s_nop 0
  v_pk_mul_f16 v144, v89, v98 op_sel:[0,0] op_sel_hi:[0,1]
  v_mfma_f32_16x16x32_f16 v[216:219], v[180:183], v[148:151], v[216:219]
  v_pk_mul_f16 v145, v89, v98 op_sel:[1,0] op_sel_hi:[1,1]
  v_mfma_f32_16x16x32_f16 v[232:235], v[180:183], v[160:163], v[232:235]
  s_nop 0
  s_waitcnt lgkmcnt(3)
  v_pk_mul_f16 v146, v89, v99 op_sel:[0,0] op_sel_hi:[0,1]
  v_mfma_f32_16x16x32_f16 v[188:191], v[164:167], v[124:127], v[188:191]
  ds_read_b128 v[180:183], v1 offset:1024
  v_pk_mul_f16 v147, v89, v99 op_sel:[1,0] op_sel_hi:[1,1]
  v_mfma_f32_16x16x32_f16 v[204:207], v[164:167], v[136:139], v[204:207]
  s_waitcnt vmcnt(0)
  ds_read_u16_d16_hi v32, v10 offset:0
  v_pk_mul_f16 v156, v103, v112 op_sel:[0,0] op_sel_hi:[0,1]
  v_mfma_f32_16x16x32_f16 v[220:223], v[164:167], v[148:151], v[220:223]
  ds_read_u16_d16_hi v33, v10 offset:2
  v_pk_mul_f16 v157, v103, v112 op_sel:[1,0] op_sel_hi:[1,1]
  v_mfma_f32_16x16x32_f16 v[236:239], v[164:167], v[160:163], v[236:239]
  s_waitcnt lgkmcnt(5)
  v_pk_mul_f16 v158, v103, v113 op_sel:[0,0] op_sel_hi:[0,1]
  v_mfma_f32_16x16x32_f16 v[192:195], v[168:171], v[120:123], v[192:195]
  ds_read_b128 v[164:167], v1 offset:23552
  v_pk_mul_f16 v159, v103, v113 op_sel:[1,0] op_sel_hi:[1,1]
  v_mfma_f32_16x16x32_f16 v[208:211], v[168:171], v[132:135], v[208:211]
  ds_read_u16_d16_hi v34, v10 offset:2112
  v_pk_mul_f16 v116, v61, v67 op_sel:[0,1] op_sel_hi:[0,0]
  v_mfma_f32_16x16x32_f16 v[224:227], v[168:171], v[144:147], v[224:227]
  ds_read_u16_d16_hi v35, v10 offset:2114
  v_pk_mul_f16 v117, v61, v72 op_sel:[0,0] op_sel_hi:[1,0]
  v_mfma_f32_16x16x32_f16 v[240:243], v[168:171], v[156:159], v[240:243]
  s_nop 0
  s_waitcnt lgkmcnt(7)
  v_pk_mul_f16 v118, v62, v69 op_sel:[0,0] op_sel_hi:[0,1]
  v_mfma_f32_16x16x32_f16 v[184:187], v[172:175], v[120:123], v[184:187]
  ds_read_b128 v[168:171], v1 offset:21504
  v_pk_mul_f16 v119, v62, v69 op_sel:[1,0] op_sel_hi:[1,1]
  v_mfma_f32_16x16x32_f16 v[200:203], v[172:175], v[132:135], v[200:203]
  ds_read_b64_tr_b16 v[60:61], v27 offset:0
  v_pk_mul_f16 v128, v75, v81 op_sel:[0,1] op_sel_hi:[0,0]
  v_mfma_f32_16x16x32_f16 v[216:219], v[172:175], v[144:147], v[216:219]
  ds_read_u16_d16_hi v36, v10 offset:128
  v_pk_mul_f16 v129, v75, v86 op_sel:[0,0] op_sel_hi:[1,0]
  v_mfma_f32_16x16x32_f16 v[232:235], v[172:175], v[156:159], v[232:235]
  s_waitcnt lgkmcnt(9)
  v_pk_mul_f16 v130, v76, v83 op_sel:[0,0] op_sel_hi:[0,1]
  v_pk_mul_f16 v131, v76, v83 op_sel:[1,0] op_sel_hi:[1,1]
  v_mfma_f32_16x16x32_f16 v[188:191], v[176:179], v[120:123], v[188:191]
  ds_read_b128 v[172:175], v1 offset:22528
  v_pk_mul_f16 v140, v89, v95 op_sel:[0,1] op_sel_hi:[0,0]
  v_mfma_f32_16x16x32_f16 v[204:207], v[176:179], v[132:135], v[204:207]
  ds_read_b64_tr_b16 v[74:75], v27 offset:32
  v_pk_mul_f16 v141, v89, v100 op_sel:[0,0] op_sel_hi:[1,0]
  v_mfma_f32_16x16x32_f16 v[220:223], v[176:179], v[144:147], v[220:223]
  ds_read_b64_tr_b16 v[88:89], v27 offset:64
  v_pk_mul_f16 v142, v90, v97 op_sel:[0,0] op_sel_hi:[0,1]
  v_mfma_f32_16x16x32_f16 v[236:239], v[176:179], v[156:159], v[236:239]
  s_waitcnt lgkmcnt(11)
  v_pk_mul_f16 v143, v90, v97 op_sel:[1,0] op_sel_hi:[1,1]
  v_pk_mul_f16 v152, v103, v109 op_sel:[0,1] op_sel_hi:[0,0]
  v_smfmac_f32_16x16x64_f16 v[196:199], v[180:183], v[120:127], v9
  ds_read_b128 v[176:179], v1 offset:26624
  v_pk_mul_f16 v153, v103, v114 op_sel:[0,0] op_sel_hi:[1,0]
  v_smfmac_f32_16x16x64_f16 v[212:215], v[180:183], v[132:139], v9
  ds_read_b64_tr_b16 v[102:103], v27 offset:96
  v_pk_mul_f16 v154, v104, v111 op_sel:[0,0] op_sel_hi:[0,1]
  v_smfmac_f32_16x16x64_f16 v[228:231], v[180:183], v[144:151], v9
  ds_read_u16_d16_hi v37, v10 offset:130
  v_pk_mul_f16 v155, v104, v111 op_sel:[1,0] op_sel_hi:[1,1]
  v_smfmac_f32_16x16x64_f16 v[244:247], v[180:183], v[156:163], v9
  s_nop 0
  s_waitcnt lgkmcnt(11)
  v_pk_mul_f16 v120, v62, v70 op_sel:[0,0] op_sel_hi:[0,1]
  v_mfma_f32_16x16x32_f16 v[192:195], v[164:167], v[116:119], v[192:195]
  ds_read_b128 v[180:183], v1 offset:24576
  v_pk_mul_f16 v121, v62, v70 op_sel:[1,0] op_sel_hi:[1,1]
  v_mfma_f32_16x16x32_f16 v[208:211], v[164:167], v[128:131], v[208:211]
  ds_read_u16_d16_hi v38, v10 offset:2240
  v_pk_mul_f16 v122, v62, v71 op_sel:[0,0] op_sel_hi:[0,1]
  v_mfma_f32_16x16x32_f16 v[224:227], v[164:167], v[140:143], v[224:227]
  ds_read_u16_d16_hi v39, v10 offset:2242
  v_pk_mul_f16 v123, v62, v71 op_sel:[1,0] op_sel_hi:[1,1]
  v_mfma_f32_16x16x32_f16 v[240:243], v[164:167], v[152:155], v[240:243]
  s_waitcnt lgkmcnt(11)
  v_pk_mul_f16 v132, v76, v84 op_sel:[0,0] op_sel_hi:[0,1]
  v_max3_f32 v58, |v32|, |v33|, 0
  v_mfma_f32_16x16x32_f16 v[184:187], v[168:171], v[116:119], v[184:187]
  ds_read_b128 v[164:167], v1 offset:25600
  v_pk_mul_f16 v133, v76, v84 op_sel:[1,0] op_sel_hi:[1,1]
  v_mfma_f32_16x16x32_f16 v[200:203], v[168:171], v[128:131], v[200:203]
  ds_read_u16_d16_hi v40, v10 offset:256
  v_pk_mul_f16 v134, v76, v85 op_sel:[0,0] op_sel_hi:[0,1]
  v_mfma_f32_16x16x32_f16 v[216:219], v[168:171], v[140:143], v[216:219]
  ds_read_u16_d16_hi v41, v10 offset:258
  v_pk_mul_f16 v135, v76, v85 op_sel:[1,0] op_sel_hi:[1,1]
  v_mfma_f32_16x16x32_f16 v[232:235], v[168:171], v[152:155], v[232:235]
  s_waitcnt lgkmcnt(11)
  v_pk_mul_f16 v144, v90, v98 op_sel:[0,0] op_sel_hi:[0,1]
  v_max3_f32 v58, |v34|, |v35|, v58
  v_mfma_f32_16x16x32_f16 v[188:191], v[172:175], v[116:119], v[188:191]
  ds_read_b128 v[168:171], v1 offset:2048
  v_pk_mul_f16 v145, v90, v98 op_sel:[1,0] op_sel_hi:[1,1]
  v_mfma_f32_16x16x32_f16 v[204:207], v[172:175], v[128:131], v[204:207]
  ds_read_u16_d16_hi v42, v10 offset:2368
  v_pk_mul_f16 v146, v90, v99 op_sel:[0,0] op_sel_hi:[0,1]
  v_mfma_f32_16x16x32_f16 v[220:223], v[172:175], v[140:143], v[220:223]
  ds_read_u16_d16_hi v43, v10 offset:2370
  v_pk_mul_f16 v147, v90, v99 op_sel:[1,0] op_sel_hi:[1,1]
  v_mfma_f32_16x16x32_f16 v[236:239], v[172:175], v[152:155], v[236:239]
  s_nop 0
  s_waitcnt lgkmcnt(11)
  v_pk_mul_f16 v156, v104, v112 op_sel:[0,0] op_sel_hi:[0,1]
  v_mfma_f32_16x16x32_f16 v[192:195], v[176:179], v[120:123], v[192:195]
  ds_read_b128 v[172:175], v1 offset:29696
  v_pk_mul_f16 v157, v104, v112 op_sel:[1,0] op_sel_hi:[1,1]
  v_mfma_f32_16x16x32_f16 v[208:211], v[176:179], v[132:135], v[208:211]
  ds_read_u16_d16_hi v44, v10 offset:384
  v_pk_mul_f16 v158, v104, v113 op_sel:[0,0] op_sel_hi:[0,1]
  v_mfma_f32_16x16x32_f16 v[224:227], v[176:179], v[144:147], v[224:227]
  ds_read_u16_d16_hi v45, v10 offset:386
  v_pk_mul_f16 v159, v104, v113 op_sel:[1,0] op_sel_hi:[1,1]
  s_nop 1
  v_mfma_f32_16x16x32_f16 v[240:243], v[176:179], v[156:159], v[240:243]
  s_waitcnt lgkmcnt(11)
  v_pk_mul_f16 v124, v62, v68 op_sel:[0,1] op_sel_hi:[0,0]
  v_mfma_f32_16x16x32_f16 v[184:187], v[180:183], v[120:123], v[184:187]
  ds_read_b128 v[176:179], v1 offset:27648
  v_pk_mul_f16 v125, v62, v72 op_sel:[0,0] op_sel_hi:[1,0]
  v_mfma_f32_16x16x32_f16 v[200:203], v[180:183], v[132:135], v[200:203]
  ds_read_u16_d16_hi v46, v10 offset:2496
  v_pk_mul_f16 v126, v63, v70 op_sel:[0,0] op_sel_hi:[0,1]
  v_mfma_f32_16x16x32_f16 v[216:219], v[180:183], v[144:147], v[216:219]
  ds_read_u16_d16_hi v47, v10 offset:2498
  v_pk_mul_f16 v127, v63, v70 op_sel:[1,0] op_sel_hi:[1,1]
  v_mfma_f32_16x16x32_f16 v[232:235], v[180:183], v[156:159], v[232:235]
  s_waitcnt lgkmcnt(11)
  v_pk_mul_f16 v136, v76, v82 op_sel:[0,1] op_sel_hi:[0,0]
  v_pk_mul_f16 v137, v76, v86 op_sel:[0,0] op_sel_hi:[1,0]
  v_mfma_f32_16x16x32_f16 v[188:191], v[164:167], v[120:123], v[188:191]
  ds_read_b128 v[180:183], v1 offset:28672
  v_pk_mul_f16 v138, v77, v84 op_sel:[0,0] op_sel_hi:[0,1]
  v_mfma_f32_16x16x32_f16 v[204:207], v[164:167], v[132:135], v[204:207]
  ds_read_u16_d16_hi v48, v10 offset:512
  v_pk_mul_f16 v139, v77, v84 op_sel:[1,0] op_sel_hi:[1,1]
  v_mfma_f32_16x16x32_f16 v[220:223], v[164:167], v[144:147], v[220:223]
  ds_read_u16_d16_hi v49, v10 offset:514
  v_pk_mul_f16 v148, v90, v96 op_sel:[0,1] op_sel_hi:[0,0]
  v_mfma_f32_16x16x32_f16 v[236:239], v[164:167], v[156:159], v[236:239]
  s_waitcnt lgkmcnt(11)
  v_pk_mul_f16 v149, v90, v100 op_sel:[0,0] op_sel_hi:[1,0]
  v_pk_mul_f16 v150, v91, v98 op_sel:[0,0] op_sel_hi:[0,1]
  v_smfmac_f32_16x16x64_f16 v[196:199], v[168:171], v[116:123], v9
  ds_read_b128 v[164:167], v1 offset:32768
  v_pk_mul_f16 v151, v91, v98 op_sel:[1,0] op_sel_hi:[1,1]
  v_smfmac_f32_16x16x64_f16 v[212:215], v[168:171], v[128:135], v9
  ds_read_u16_d16_hi v50, v10 offset:2624
  v_pk_mul_f16 v160, v104, v110 op_sel:[0,1] op_sel_hi:[0,0]
  v_smfmac_f32_16x16x64_f16 v[228:231], v[168:171], v[140:147], v9
  ds_read_u16_d16_hi v51, v10 offset:2626
  v_pk_mul_f16 v161, v104, v114 op_sel:[0,0] op_sel_hi:[1,0]
  v_smfmac_f32_16x16x64_f16 v[244:247], v[168:171], v[152:159], v9
  s_nop 0
  s_waitcnt lgkmcnt(11)
  v_pk_mul_f16 v162, v105, v112 op_sel:[0,0] op_sel_hi:[0,1]
  v_mfma_f32_16x16x32_f16 v[192:195], v[172:175], v[124:127], v[192:195]
  ds_read_b128 v[168:171], v1 offset:30720
  v_pk_mul_f16 v163, v105, v112 op_sel:[1,0] op_sel_hi:[1,1]
  v_mfma_f32_16x16x32_f16 v[208:211], v[172:175], v[136:139], v[208:211]
  ds_read_u16_d16_hi v52, v10 offset:640
  v_pk_mul_f16 v120, v63, v71 op_sel:[0,0] op_sel_hi:[0,1]
  v_mfma_f32_16x16x32_f16 v[224:227], v[172:175], v[148:151], v[224:227]
  ds_read_u16_d16_hi v53, v10 offset:642
  v_pk_mul_f16 v121, v63, v71 op_sel:[1,0] op_sel_hi:[1,1]
  v_mfma_f32_16x16x32_f16 v[240:243], v[172:175], v[160:163], v[240:243]
  s_waitcnt lgkmcnt(11)
  v_pk_mul_f16 v122, v63, v69 op_sel:[0,1] op_sel_hi:[1,1]
  v_pk_mul_f16 v123, v63, v72 op_sel:[0,0] op_sel_hi:[1,0]
  v_mfma_f32_16x16x32_f16 v[184:187], v[176:179], v[124:127], v[184:187]
  ds_read_b128 v[172:175], v1 offset:31744
  v_pk_mul_f16 v132, v77, v85 op_sel:[0,0] op_sel_hi:[0,1]
  v_mfma_f32_16x16x32_f16 v[200:203], v[176:179], v[136:139], v[200:203]
  ds_read_u16_d16_hi v54, v10 offset:2752
  v_pk_mul_f16 v133, v77, v85 op_sel:[1,0] op_sel_hi:[1,1]
  v_mfma_f32_16x16x32_f16 v[216:219], v[176:179], v[148:151], v[216:219]
  ds_read_u16_d16_hi v55, v10 offset:2754
  v_pk_mul_f16 v134, v77, v83 op_sel:[0,1] op_sel_hi:[1,1]
  v_mfma_f32_16x16x32_f16 v[232:235], v[176:179], v[160:163], v[232:235]
  s_waitcnt lgkmcnt(11)
  v_pk_mul_f16 v135, v77, v86 op_sel:[0,0] op_sel_hi:[1,0]
  v_pk_mul_f16 v144, v91, v99 op_sel:[0,0] op_sel_hi:[0,1]
  v_mfma_f32_16x16x32_f16 v[188:191], v[180:183], v[124:127], v[188:191]
  ds_read_b128 v[176:179], v1 offset:3072
  v_pk_mul_f16 v145, v91, v99 op_sel:[1,0] op_sel_hi:[1,1]
  v_mfma_f32_16x16x32_f16 v[204:207], v[180:183], v[136:139], v[204:207]
  ds_read_u16_d16_hi v56, v10 offset:768
  v_pk_mul_f16 v146, v91, v97 op_sel:[0,1] op_sel_hi:[1,1]
  v_mfma_f32_16x16x32_f16 v[220:223], v[180:183], v[148:151], v[220:223]
  ds_read_u16_d16_hi v57, v10 offset:770
  v_pk_mul_f16 v147, v91, v100 op_sel:[0,0] op_sel_hi:[1,0]
  v_mfma_f32_16x16x32_f16 v[236:239], v[180:183], v[160:163], v[236:239]
  s_waitcnt lgkmcnt(11)
  v_pk_mul_f16 v156, v105, v113 op_sel:[0,0] op_sel_hi:[0,1]
  v_max3_f32 v58, |v36|, |v37|, v58
  v_mfma_f32_16x16x32_f16 v[192:195], v[164:167], v[120:123], v[192:195]
  ds_read_b128 v[180:183], v1 offset:35840
  v_pk_mul_f16 v157, v105, v113 op_sel:[1,0] op_sel_hi:[1,1]
  v_mfma_f32_16x16x32_f16 v[208:211], v[164:167], v[132:135], v[208:211]
  v_pk_mul_f16 v158, v105, v111 op_sel:[0,1] op_sel_hi:[1,1]
  v_max3_f32 v58, |v38|, |v39|, v58
  v_mfma_f32_16x16x32_f16 v[224:227], v[164:167], v[144:147], v[224:227]
  v_pk_mul_f16 v159, v105, v114 op_sel:[0,0] op_sel_hi:[1,0]
  v_max3_f32 v58, |v40|, |v41|, v58
  s_nop 0
  v_mfma_f32_16x16x32_f16 v[240:243], v[164:167], v[156:159], v[240:243]
  s_waitcnt lgkmcnt(9)
  v_pk_mul_f16 v116, v64, v71 op_sel:[0,0] op_sel_hi:[0,1]
  v_mfma_f32_16x16x32_f16 v[184:187], v[168:171], v[120:123], v[184:187]
  ds_read_b128 v[164:167], v1 offset:33792
  v_pk_mul_f16 v117, v64, v71 op_sel:[1,0] op_sel_hi:[1,1]
  v_mfma_f32_16x16x32_f16 v[200:203], v[168:171], v[132:135], v[200:203]
  s_nop 0
  v_pk_mul_f16 v118, v64, v70 op_sel:[0,1] op_sel_hi:[1,1]
  v_max3_f32 v58, |v42|, |v43|, v58
  v_mfma_f32_16x16x32_f16 v[216:219], v[168:171], v[144:147], v[216:219]
  s_nop 0
  v_pk_mul_f16 v119, v64, v72 op_sel:[0,0] op_sel_hi:[1,0]
  v_pk_mul_f16 v128, v78, v85 op_sel:[0,0] op_sel_hi:[0,1]
  v_mfma_f32_16x16x32_f16 v[232:235], v[168:171], v[156:159], v[232:235]
  s_waitcnt lgkmcnt(7)
  v_pk_mul_f16 v129, v78, v85 op_sel:[1,0] op_sel_hi:[1,1]
  v_pk_mul_f16 v130, v78, v84 op_sel:[0,1] op_sel_hi:[1,1]
  v_mfma_f32_16x16x32_f16 v[188:191], v[172:175], v[120:123], v[188:191]
  ds_read_b128 v[168:171], v1 offset:34816
  v_pk_mul_f16 v131, v78, v86 op_sel:[0,0] op_sel_hi:[1,0]
  v_mfma_f32_16x16x32_f16 v[204:207], v[172:175], v[132:135], v[204:207]
  v_pk_mul_f16 v140, v92, v99 op_sel:[0,0] op_sel_hi:[0,1]
  v_pk_mul_f16 v141, v92, v99 op_sel:[1,0] op_sel_hi:[1,1]
  v_mfma_f32_16x16x32_f16 v[220:223], v[172:175], v[144:147], v[220:223]
  v_pk_mul_f16 v142, v92, v98 op_sel:[0,1] op_sel_hi:[1,1]
  v_pk_mul_f16 v143, v92, v100 op_sel:[0,0] op_sel_hi:[1,0]
  v_mfma_f32_16x16x32_f16 v[236:239], v[172:175], v[156:159], v[236:239]
  s_waitcnt lgkmcnt(5)
  v_pk_mul_f16 v152, v106, v113 op_sel:[0,0] op_sel_hi:[0,1]
  v_smfmac_f32_16x16x64_f16 v[196:199], v[176:179], v[120:127], v9
  ds_read_b128 v[172:175], v1 offset:38912
  v_pk_mul_f16 v153, v106, v113 op_sel:[1,0] op_sel_hi:[1,1]
  v_smfmac_f32_16x16x64_f16 v[212:215], v[176:179], v[132:139], v9
  s_nop 0
  v_pk_mul_f16 v154, v106, v112 op_sel:[0,1] op_sel_hi:[1,1]
  v_smfmac_f32_16x16x64_f16 v[228:231], v[176:179], v[144:151], v9
  v_pk_mul_f16 v155, v106, v114 op_sel:[0,0] op_sel_hi:[1,0]
  v_smfmac_f32_16x16x64_f16 v[244:247], v[176:179], v[156:163], v9
  s_nop 0
  s_waitcnt lgkmcnt(3)
  v_pk_mul_f16 v120, v65, v71 op_sel:[0,1] op_sel_hi:[1,1]
  v_mfma_f32_16x16x32_f16 v[192:195], v[180:183], v[116:119], v[192:195]
  ds_read_b128 v[176:179], v1 offset:36864
  v_pk_mul_f16 v121, v65, v72 op_sel:[0,0] op_sel_hi:[1,0]
  v_mfma_f32_16x16x32_f16 v[208:211], v[180:183], v[128:131], v[208:211]
  v_pk_mul_f16 v122, v72, v72 op_sel:[0,0] op_sel_hi:[1,1]
  v_max3_f32 v58, |v44|, |v45|, v58
  v_mfma_f32_16x16x32_f16 v[224:227], v[180:183], v[140:143], v[224:227]
  v_pk_mul_f16 v123, v60, v61 op_sel:[0,0] op_sel_hi:[1,1]
  v_max3_f32 v58, |v46|, |v47|, v58
  v_mfma_f32_16x16x32_f16 v[240:243], v[180:183], v[152:155], v[240:243]
  s_waitcnt lgkmcnt(3)
  v_pk_mul_f16 v132, v79, v85 op_sel:[0,1] op_sel_hi:[1,1]
  v_mfma_f32_16x16x32_f16 v[184:187], v[164:167], v[116:119], v[184:187]
  ds_read_b128 v[180:183], v1 offset:37888
  v_pk_mul_f16 v133, v79, v86 op_sel:[0,0] op_sel_hi:[1,0]
  v_mfma_f32_16x16x32_f16 v[200:203], v[164:167], v[128:131], v[200:203]
  s_nop 0
  v_pk_mul_f16 v134, v86, v86 op_sel:[0,0] op_sel_hi:[1,1]
  v_max3_f32 v58, |v48|, |v49|, v58
  v_mfma_f32_16x16x32_f16 v[216:219], v[164:167], v[140:143], v[216:219]
  v_pk_mul_f16 v135, v74, v75 op_sel:[0,0] op_sel_hi:[1,1]
  v_max3_f32 v58, |v50|, |v51|, v58
  v_mfma_f32_16x16x32_f16 v[232:235], v[164:167], v[152:155], v[232:235]
  s_nop 0
  s_waitcnt lgkmcnt(3)
  v_pk_mul_f16 v144, v93, v99 op_sel:[0,1] op_sel_hi:[1,1]
  v_mfma_f32_16x16x32_f16 v[188:191], v[168:171], v[116:119], v[188:191]
  ds_read_b128 v[164:167], v1 offset:4096
  v_pk_mul_f16 v145, v93, v100 op_sel:[0,0] op_sel_hi:[1,0]
  v_mfma_f32_16x16x32_f16 v[204:207], v[168:171], v[128:131], v[204:207]
  v_pk_mul_f16 v146, v100, v100 op_sel:[0,0] op_sel_hi:[1,1]
  v_max3_f32 v58, |v52|, |v53|, v58
  v_mfma_f32_16x16x32_f16 v[220:223], v[168:171], v[140:143], v[220:223]
  v_pk_mul_f16 v147, v88, v89 op_sel:[0,0] op_sel_hi:[1,1]
  v_max3_f32 v58, |v54|, |v55|, v58
  v_mfma_f32_16x16x32_f16 v[236:239], v[168:171], v[152:155], v[236:239]
  s_waitcnt lgkmcnt(3)
  v_pk_mul_f16 v156, v107, v113 op_sel:[0,1] op_sel_hi:[1,1]
  v_mfma_f32_16x16x32_f16 v[192:195], v[172:175], v[120:123], v[192:195]
  v_pk_mul_f16 v157, v107, v114 op_sel:[0,0] op_sel_hi:[1,0]
  v_max3_f32 v58, |v56|, |v57|, v58
  v_mfma_f32_16x16x32_f16 v[208:211], v[172:175], v[132:135], v[208:211]
  s_nop 0
  v_pk_mul_f16 v158, v114, v114 op_sel:[0,0] op_sel_hi:[1,1]
  v_cvt_pk_f16_f32 v62, v32, v33
  v_mfma_f32_16x16x32_f16 v[224:227], v[172:175], v[144:147], v[224:227]
  v_pk_mul_f16 v159, v102, v103 op_sel:[0,0] op_sel_hi:[1,1]
  s_nop 1
  v_mfma_f32_16x16x32_f16 v[240:243], v[172:175], v[156:159], v[240:243]
  s_waitcnt lgkmcnt(2)
  v_cvt_pk_f16_f32 v76, v34, v35
  v_cvt_pk_f16_f32 v90, v36, v37
  v_mfma_f32_16x16x32_f16 v[184:187], v[176:179], v[120:123], v[184:187]
  ds_write_b32 v11, v62 offset:0
  v_mfma_f32_16x16x32_f16 v[200:203], v[176:179], v[132:135], v[200:203]
  ds_write_b32 v11, v76 offset:160
  v_mfma_f32_16x16x32_f16 v[216:219], v[176:179], v[144:147], v[216:219]
  ds_write_b32 v11, v90 offset:320
  v_mfma_f32_16x16x32_f16 v[232:235], v[176:179], v[156:159], v[232:235]
  s_waitcnt lgkmcnt(4)
  v_cvt_pk_f16_f32 v104, v38, v39
  v_cvt_pk_f16_f32 v63, v40, v41
  v_mfma_f32_16x16x32_f16 v[188:191], v[180:183], v[120:123], v[188:191]
  ds_write_b32 v11, v104 offset:480
  v_mfma_f32_16x16x32_f16 v[204:207], v[180:183], v[132:135], v[204:207]
  ds_write_b32 v11, v63 offset:640
  v_mfma_f32_16x16x32_f16 v[220:223], v[180:183], v[144:147], v[220:223]
  v_cvt_pk_f16_f32 v77, v42, v43
  v_cvt_pk_f16_f32 v91, v44, v45
  v_mfma_f32_16x16x32_f16 v[236:239], v[180:183], v[156:159], v[236:239]
  s_waitcnt lgkmcnt(5)
  v_cvt_pk_f16_f32 v105, v46, v47
  v_cvt_pk_f16_f32 v66, v48, v49
  v_smfmac_f32_16x16x64_f16 v[196:199], v[164:167], v[116:123], v9
  ds_write_b32 v11, v77 offset:800
  v_smfmac_f32_16x16x64_f16 v[212:215], v[164:167], v[128:135], v9
  ds_write_b32 v11, v91 offset:960
  v_smfmac_f32_16x16x64_f16 v[228:231], v[164:167], v[140:147], v9
  ds_write_b32 v11, v105 offset:1120
  v_smfmac_f32_16x16x64_f16 v[244:247], v[164:167], v[152:159], v9
  ds_write_b32 v11, v66 offset:1280
  s_setprio 0
  s_sub_u32 s72, s72, 1
  s_cmp_eq_u32 s72, 0
  s_cbranch_scc1 L_cin_done
  v_cvt_pk_f16_f32 v80, v50, v51
  v_cvt_pk_f16_f32 v94, v52, v53
  v_cvt_pk_f16_f32 v108, v54, v55
  v_cvt_pk_f16_f32 v67, v56, v57
  ds_write_b32 v11, v80 offset:1440
  ds_write_b32 v11, v94 offset:1600
  ds_write_b32 v11, v108 offset:1760
  ds_write_b32 v11, v67 offset:1920
  s_branch L_cin_loop
L_cslow:
  v_max_f32_dpp v58, v58, v58 row_shr:1 row_mask:0xf bank_mask:0xf
  s_nop 1
  v_max_f32_dpp v58, v58, v58 row_shr:2 row_mask:0xf bank_mask:0xf
  s_nop 1
  v_max_f32_dpp v58, v58, v58 row_shr:4 row_mask:0xf bank_mask:0xf
  s_nop 1
  v_max_f32_dpp v58, v58, v58 row_shr:8 row_mask:0xf bank_mask:0xf
  s_nop 1
  v_max_f32_dpp v58, v58, v58 row_bcast:15 row_mask:0xa bank_mask:0xf
  s_nop 1
  v_max_f32_dpp v58, v58, v58 row_bcast:31 row_mask:0xc bank_mask:0xf
  s_nop 0
  v_readlane_b32 s98, v58, 63
  s_mov_b32 s97, 0
  s_lshr_b32 s98, s98, 23
  s_min_u32 s98, s98, 182
  s_lshr_b32 s99, s1, 23
  s_sub_u32 s99, s99, 47
  s_lshr_b32 s99, s99, 1
  s_min_u32 s99, s99, 59
  s_sub_u32 s99, 131, s99
  s_max_u32 s98, s98, s99
  s_sub_u32 s99, 258, s98
  s_lshl_b32 s100, s99, 1
  s_sub_u32 s100, s100, 127
  s_sub_u32 s95, 254, s100
  s_lshl_b32 s95, s95, 23
  v_mov_b32 v60, s95
  v_mul_f32 v61, s0, v60
  v_mul_f32 v60, s1, v60
  v_readfirstlane_b32 s74, v61
  v_readfirstlane_b32 s75, v60
  s_lshl_b32 s99, s99, 23
  s_lshl_b32 s100, s100, 23
  v_mul_f32 v60, s99, v32
  v_mul_f32 v61, s99, v33
  v_mul_f32 v62, s100, v32
  v_mul_f32_e64 v63, s100, v33
  v_cvt_pk_f16_f32 v80, v60, v61
  v_cvt_pk_bf16_f32 v64, v62, v63
  ds_write_b32 v11, v80 offset:0
  ds_write_b32 v10, v64 offset:0
  v_mul_f32 v60, s99, v34
  v_mul_f32 v61, s99, v35
  v_mul_f32 v62, s100, v34
  v_mul_f32 v63, s100, v35
  v_cvt_pk_f16_f32 v81, v60, v61
  v_cvt_pk_bf16_f32 v65, v62, v63
  ds_write_b32 v11, v81 offset:160
  ds_write_b32 v10, v65 offset:2112
  v_mul_f32 v60, s99, v36
  v_mul_f32 v61, s99, v37
  v_mul_f32 v62, s100, v36
  v_mul_f32 v63, s100, v37
  v_cvt_pk_f16_f32 v82, v60, v61
  v_cvt_pk_bf16_f32 v66, v62, v63
  ds_write_b32 v11, v82 offset:320
  ds_write_b32 v10, v66 offset:128
  v_mul_f32 v60, s99, v38
  v_mul_f32 v61, s99, v39
  v_mul_f32 v62, s100, v38
  v_mul_f32 v63, s100, v39
  v_cvt_pk_f16_f32 v83, v60, v61
  v_cvt_pk_bf16_f32 v67, v62, v63
  ds_write_b32 v11, v83 offset:480
  ds_write_b32 v10, v67 offset:2240
  v_mul_f32 v60, s99, v40
  v_mul_f32 v61, s99, v41
  v_mul_f32 v62, s100, v40
  v_mul_f32 v63, s100, v41
  v_cvt_pk_f16_f32 v84, v60, v61
  v_cvt_pk_bf16_f32 v68, v62, v63
  ds_write_b32 v11, v84 offset:640
  ds_write_b32 v10, v68 offset:256
  v_mul_f32 v60, s99, v42
  v_mul_f32 v61, s99, v43
  v_mul_f32 v62, s100, v42
  v_mul_f32 v63, s100, v43
  v_cvt_pk_f16_f32 v85, v60, v61
  v_cvt_pk_bf16_f32 v69, v62, v63
  ds_write_b32 v11, v85 offset:800
  ds_write_b32 v10, v69 offset:2368
  v_mul_f32 v60, s99, v44
  v_mul_f32 v61, s99, v45
  v_mul_f32 v62, s100, v44
  v_mul_f32 v63, s100, v45
  v_cvt_pk_f16_f32 v86, v60, v61
  v_cvt_pk_bf16_f32 v70, v62, v63
  ds_write_b32 v11, v86 offset:960
  ds_write_b32 v10, v70 offset:384
  v_mul_f32 v60, s99, v46
  v_mul_f32 v61, s99, v47
  v_mul_f32 v62, s100, v46
  v_mul_f32 v63, s100, v47
  v_cvt_pk_f16_f32 v87, v60, v61
  v_cvt_pk_bf16_f32 v71, v62, v63
  ds_write_b32 v11, v87 offset:1120
  ds_write_b32 v10, v71 offset:2496
  v_mul_f32 v60, s99, v48
  v_mul_f32 v61, s99, v49
  v_mul_f32 v62, s100, v48
  v_mul_f32 v63, s100, v49
  v_cvt_pk_f16_f32 v88, v60, v61
  v_cvt_pk_bf16_f32 v72, v62, v63
  ds_write_b32 v11, v88 offset:1280
  ds_write_b32 v10, v72 offset:512
  v_mul_f32 v60, s99, v50
  v_mul_f32 v61, s99, v51
  v_mul_f32 v62, s100, v50
  v_mul_f32 v63, s100, v51
  v_cvt_pk_f16_f32 v89, v60, v61
  v_cvt_pk_bf16_f32 v73, v62, v63
  ds_write_b32 v11, v89 offset:1440
  ds_write_b32 v10, v73 offset:2624
  v_mul_f32 v60, s99, v52
  v_mul_f32 v61, s99, v53
  v_mul_f32 v62, s100, v52
  v_mul_f32 v63, s100, v53
  v_cvt_pk_f16_f32 v90, v60, v61
  v_cvt_pk_bf16_f32 v74, v62, v63
  ds_write_b32 v11, v90 offset:1600
  ds_write_b32 v10, v74 offset:640
  v_mul_f32 v60, s99, v54
  v_mul_f32 v61, s99, v55
  v_mul_f32 v62, s100, v54
  v_mul_f32 v63, s100, v55
  v_cvt_pk_f16_f32 v91, v60, v61
  v_cvt_pk_bf16_f32 v75, v62, v63
  ds_write_b32 v11, v91 offset:1760
  ds_write_b32 v10, v75 offset:2752
  v_mul_f32 v60, s99, v56
  v_mul_f32 v61, s99, v57
  v_mul_f32 v62, s100, v56
  v_mul_f32 v63, s100, v57
  v_cvt_pk_f16_f32 v92, v60, v61
  v_cvt_pk_bf16_f32 v76, v62, v63
  ds_write_b32 v11, v92 offset:1920
  ds_write_b32 v10, v76 offset:768
  v_mov_b32 v60, s100
  v_cvt_pk_bf16_f32 v60, v60, v60
  s_mov_b32 exec_hi, 0
  ds_write_b32 v10, v60 offset:2880
  s_mov_b32 exec_hi, -1
  s_waitcnt lgkmcnt(0)
  s_branch L_cconv
L_sdown:
  v_lshlrev_b32 v108, 16, v112
  v_and_b32 v109, 0xffff0000, v112
  v_mul_f32 v108, v108, v250
  v_mul_f32 v109, v109, v250
  v_cvt_pk_bf16_f32 v112, v108, v109
  v_lshlrev_b32 v108, 16, v113
  v_and_b32 v109, 0xffff0000, v113
  v_mul_f32 v108, v108, v250
  v_mul_f32 v109, v109, v250
  v_cvt_pk_bf16_f32 v113, v108, v109
  v_lshlrev_b32 v108, 16, v114
  v_and_b32 v109, 0xffff0000, v114
  v_mul_f32 v108, v108, v250
  v_mul_f32 v109, v109, v250
  v_cvt_pk_bf16_f32 v114, v108, v109
  v_lshlrev_b32 v108, 16, v115
  v_and_b32 v109, 0xffff0000, v115
  v_mul_f32 v108, v108, v250
  v_mul_f32 v109, v109, v250
  v_cvt_pk_bf16_f32 v115, v108, v109
  v_lshlrev_b32 v108, 16, v116
  v_and_b32 v109, 0xffff0000, v116
  v_mul_f32 v108, v108, v250
  v_mul_f32 v109, v109, v250
  v_cvt_pk_bf16_f32 v116, v108, v109
  v_lshlrev_b32 v108, 16, v117
  v_and_b32 v109, 0xffff0000, v117
  v_mul_f32 v108, v108, v250
  v_mul_f32 v109, v109, v250
  v_cvt_pk_bf16_f32 v117, v108, v109
  v_lshlrev_b32 v108, 16, v118
  v_and_b32 v109, 0xffff0000, v118
  v_mul_f32 v108, v108, v250
  v_mul_f32 v109, v109, v250
  v_cvt_pk_bf16_f32 v118, v108, v109
  v_lshlrev_b32_e64 v108, 16, v119
  v_and_b32 v109, 0xffff0000, v119
  v_mul_f32 v108, v108, v250
  v_mul_f32_e64 v109, v109, v250
  v_cvt_pk_bf16_f32 v119, v108, v109
  s_branch L_scaled
L_first:
  ds_read_b64_tr_b16 v[60:61], v20 offset:0
  ds_read_b64_tr_b16 v[74:75], v20 offset:32
  ds_read_b64_tr_b16 v[88:89], v20 offset:64
  ds_read_b64_tr_b16 v[102:103], v20 offset:96
  ds_read_b64_tr_b16 v[66:67], v23 offset:0
  ds_read_b64_tr_b16 v[80:81], v23 offset:32
  ds_read_b64_tr_b16 v[94:95], v23 offset:64
  ds_read_b64_tr_b16 v[108:109], v23 offset:96
  ds_read_b64_tr_b16 v[68:69], v24 offset:0
  ds_read_b64_tr_b16 v[82:83], v24 offset:32
  ds_read_b64_tr_b16 v[96:97], v24 offset:64
  ds_read_b64_tr_b16 v[110:111], v24 offset:96
  ds_read_b64_tr_b16 v[124:125], v4 offset:0
  ds_read_b64_tr_b16 v[126:127], v5 offset:0
  ds_read_b64_tr_b16 v[136:137], v4 offset:32
  ds_read_b64_tr_b16 v[138:139], v5 offset:32
  ds_read_b64_tr_b16 v[148:149], v4 offset:64
  ds_read_b64_tr_b16 v[150:151], v5 offset:64
  ds_read_b64_tr_b16 v[160:161], v4 offset:96
  ds_read_b64_tr_b16 v[162:163], v5 offset:96
  ds_read_b128 v[164:167], v1 offset:39936
  ds_read_b128 v[168:171], v1 offset:40960
  ds_read_b128 v[172:175], v1 offset:8192
  ds_read_b128 v[176:179], v1 offset:6144
  ds_read_b64_tr_b16 v[70:71], v25 offset:0
  ds_read_b64_tr_b16 v[84:85], v25 offset:32
  ds_read_b64_tr_b16 v[98:99], v25 offset:64
  ds_read_b64_tr_b16 v[112:113], v25 offset:96
  ds_read_b64_tr_b16 v[72:73], v26 offset:0
  s_waitcnt lgkmcnt(14)
  v_pk_mul_f16 v120, v60, v67 op_sel:[0,0] op_sel_hi:[0,1]
  v_pk_mul_f16 v121, v60, v67 op_sel:[1,0] op_sel_hi:[1,1]
  ds_read_b64_tr_b16 v[86:87], v26 offset:32
  v_pk_mul_f16 v122, v60, v68 op_sel:[0,0] op_sel_hi:[0,1]
  ds_read_b64_tr_b16 v[100:101], v26 offset:64
  v_pk_mul_f16 v123, v60, v68 op_sel:[1,0] op_sel_hi:[1,1]
  ds_read_b64_tr_b16 v[114:115], v26 offset:96
  v_pk_mul_f16 v132, v74, v81 op_sel:[0,0] op_sel_hi:[0,1]
  v_pk_mul_f16 v133, v74, v81 op_sel:[1,0] op_sel_hi:[1,1]
  ds_read_b64_tr_b16 v[62:63], v21 offset:0
  v_pk_mul_f16 v134, v74, v82 op_sel:[0,0] op_sel_hi:[0,1]
  ds_read_b64_tr_b16 v[76:77], v21 offset:32
  v_pk_mul_f16 v135, v74, v82 op_sel:[1,0] op_sel_hi:[1,1]
  ds_read_b64_tr_b16 v[90:91], v21 offset:64
  v_pk_mul_f16 v144, v88, v95 op_sel:[0,0] op_sel_hi:[0,1]
  v_pk_mul_f16 v145, v88, v95 op_sel:[1,0] op_sel_hi:[1,1]
  ds_read_b64_tr_b16 v[104:105], v21 offset:96
  v_pk_mul_f16 v146, v88, v96 op_sel:[0,0] op_sel_hi:[0,1]
  ds_read_b64_tr_b16 v[64:65], v22 offset:0
  v_pk_mul_f16 v147, v88, v96 op_sel:[1,0] op_sel_hi:[1,1]
  ds_read_b64_tr_b16 v[78:79], v22 offset:32
  v_pk_mul_f16 v156, v102, v109 op_sel:[0,0] op_sel_hi:[0,1]
  v_pk_mul_f16 v157, v102, v109 op_sel:[1,0] op_sel_hi:[1,1]
  ds_read_b64_tr_b16 v[92:93], v22 offset:64
  v_pk_mul_f16 v158, v102, v110 op_sel:[0,0] op_sel_hi:[0,1]
  ds_read_b64_tr_b16 v[106:107], v22 offset:96
  v_pk_mul_f16 v159, v102, v110 op_sel:[1,0] op_sel_hi:[1,1]
  s_branch L_novm
L_end:
  s_endpgm
.p2align 8
L_tables:
.long 0x0, 0x1800, 0x6c80, 0x81a0, 0x8, 0x1808, 0x6c88, 0x81a8
.long 0x10, 0x1810, 0x6c90, 0x81b0, 0x18, 0x1818, 0x6c98, 0x81b8
.long 0x40, 0x1d48, 0x71c8, 0x86e8, 0x48, 0x1d50, 0x71d0, 0x86f0
.long 0x50, 0x1d58, 0x71d8, 0x86f8, 0x58, 0x1d60, 0x71e0, 0x8700
.long 0x80, 0x2290, 0x7710, 0x8c30, 0x88, 0x2298, 0x7718, 0x8c38
.long 0x90, 0x22a0, 0x7720, 0x8c40, 0x98, 0x22a8, 0x7728, 0x8c48
.long 0xc0, 0x27d8, 0x7c58, 0x9178, 0xc8, 0x27e0, 0x7c60, 0x9180
.long 0xd0, 0x27e8, 0x7c68, 0x9188, 0xd8, 0x27f0, 0x7c70, 0x9190
.long 0x20, 0x1820, 0x6ca0, 0x81c0, 0x28, 0x1828, 0x6ca8, 0x81c8
.long 0x30, 0x1830, 0x6cb0, 0x81d0, 0x38, 0x1838, 0x6cb8, 0x81d8
.long 0x60, 0x1d68, 0x71e8, 0x8708, 0x68, 0x1d70, 0x71f0, 0x8710
.long 0x70, 0x1d78, 0x71f8, 0x8718, 0x78, 0x1d80, 0x7200, 0x8720
.long 0xa0, 0x22b0, 0x7730, 0x8c50, 0xa8, 0x22b8, 0x7738, 0x8c58
.long 0xb0, 0x22c0, 0x7740, 0x8c60, 0xb8, 0x22c8, 0x7748, 0x8c68
.long 0xe0, 0x27f8, 0x7c78, 0x9198, 0xe8, 0x2800, 0x7c80, 0x91a0
.long 0xf0, 0x2808, 0x7c88, 0x91a8, 0xf8, 0x2810, 0x7c90, 0x91b0
.long 0x200, 0x4240, 0x96c0, 0x9c08, 0x208, 0x4248, 0x96c8, 0x9c10
.long 0x210, 0x4250, 0x96d0, 0x9c18, 0x218, 0x4258, 0x96d8, 0x9c20
.long 0x240, 0x4788, 0x9c08, 0x9c08, 0x248, 0x4790, 0x9c10, 0x9c10
.long 0x250, 0x4798, 0x9c18, 0x9c18, 0x258, 0x47a0, 0x9c20, 0x9c20
.long 0x280, 0x4cd0, 0x9c08, 0x9c08, 0x288, 0x4cd8, 0x9c10, 0x9c10
.long 0x290, 0x4ce0, 0x9c18, 0x9c18, 0x298, 0x4ce8, 0x9c20, 0x9c20
.long 0x2c0, 0x5218, 0x9c08, 0x9c08, 0x2c8, 0x5220, 0x9c10, 0x9c10
.long 0x2d0, 0x5228, 0x9c18, 0x9c18, 0x2d8, 0x5230, 0x9c20, 0x9c20
.long 0x220, 0x4260, 0x96e0, 0x9c28, 0x228, 0x4268, 0x96e8, 0x9c30
.long 0x230, 0x4270, 0x96f0, 0x9c38, 0x238, 0x4278, 0x96f8, 0x9c40
.long 0x260, 0x47a8, 0x9c28, 0x9c28, 0x268, 0x47b0, 0x9c30, 0x9c30
.long 0x270, 0x47b8, 0x9c38, 0x9c38, 0x278, 0x47c0, 0x9c40, 0x9c40
.long 0x2a0, 0x4cf0, 0x9c28, 0x9c28, 0x2a8, 0x4cf8, 0x9c30, 0x9c30
.long 0x2b0, 0x4d00, 0x9c38, 0x9c38, 0x2b8, 0x4d08, 0x9c40, 0x9c40
.long 0x2e0, 0x5238, 0x9c28, 0x9c28, 0x2e8, 0x5240, 0x9c30, 0x9c30
.long 0x2f0, 0x5248, 0x9c38, 0x9c38, 0x2f8, 0x5250, 0x9c40, 0x9c40
.long 0xaae0, 0xa680, 0xa900, 0xaae0, 0xaae8, 0xa688, 0xa908, 0xaae8
.long 0xaaf0, 0xa690, 0xa910, 0xaaf0, 0xaaf8, 0xa698, 0xa918, 0xaaf8
.long 0xaa40, 0xa860, 0xa9a0, 0xaa40, 0xaa48, 0xa868, 0xa9a8, 0xaa48
.long 0xaa50, 0xa870, 0xa9b0, 0xaa50, 0xaa58, 0xa878, 0xa9b8, 0xaa58
.long 0xa400, 0xa7c0, 0xa540, 0xa400, 0xa408, 0xa7c8, 0xa548, 0xa408
.long 0xa410, 0xa7d0, 0xa550, 0xa410, 0xa418, 0xa7d8, 0xa558, 0xa418
.long 0xa4a0, 0xa720, 0xa5e0, 0xa4a0, 0xa4a8, 0xa728, 0xa5e8, 0xa4a8
.long 0xa4b0, 0xa730, 0xa5f0, 0xa4b0, 0xa4b8, 0xa738, 0xa5f8, 0xa4b8
.long 0xb260, 0xb4e0, 0xb6c0, 0xb260, 0xb268, 0xb4e8, 0xb6c8, 0xb268
.long 0xb270, 0xb4f0, 0xb6d0, 0xb270, 0xb278, 0xb4f8, 0xb6d8, 0xb278
.long 0xb1c0, 0xb300, 0xb760, 0xb1c0, 0xb1c8, 0xb308, 0xb768, 0xb1c8
.long 0xb1d0, 0xb310, 0xb770, 0xb1d0, 0xb1d8, 0xb318, 0xb778, 0xb1d8
.long 0xb580, 0xb440, 0xb080, 0xb580, 0xb588, 0xb448, 0xb088, 0xb588
.long 0xb590, 0xb450, 0xb090, 0xb590, 0xb598, 0xb458, 0xb098, 0xb598
.long 0xb620, 0xb3a0, 0xb120, 0xb620, 0xb628, 0xb3a8, 0xb128, 0xb628
.long 0xb630, 0xb3b0, 0xb130, 0xb630, 0xb638, 0xb3b8, 0xb138, 0xb638
.long 0xa900, 0xa400, 0xaae0, 0xb620, 0xa908, 0xa408, 0xaae8, 0xb628
.long 0xa910, 0xa410, 0xaaf0, 0xb630, 0xa918, 0xa418, 0xaaf8, 0xb638
.long 0xa9a0, 0xa4a0, 0xab80, 0xb800, 0xa9a8, 0xa4a8, 0xab88, 0xb808
.long 0xa9b0, 0xa4b0, 0xab90, 0xb810, 0xa9b8, 0xa4b8, 0xab98, 0xb818
.long 0xaa40, 0xa680, 0xa860, 0xb3a0, 0xaa48, 0xa688, 0xa868, 0xb3a8
.long 0xaa50, 0xa690, 0xa870, 0xb3b0, 0xaa58, 0xa698, 0xa878, 0xb3b8
.long 0xa720, 0xa540, 0xa7c0, 0xb1c0, 0xa728, 0xa548, 0xa7c8, 0xb1c8
.long 0xa730, 0xa550, 0xa7d0, 0xb1d0, 0xa738, 0xa558, 0xa7d8, 0xb1d8
.long 0xa5e0, 0xaae0, 0xa400, 0xb080, 0xa5e8, 0xaae8, 0xa408, 0xb088
.long 0xa5f0, 0xaaf0, 0xa410, 0xb090, 0xa5f8, 0xaaf8, 0xa418, 0xb098
.long 0xa7c0, 0xa540, 0xa720, 0xb760, 0xa7c8, 0xa548, 0xa728, 0xb768
.long 0xa7d0, 0xa550, 0xa730, 0xb770, 0xa7d8, 0xa558, 0xa738, 0xb778
.long 0xa860, 0xa680, 0xaa40, 0xb440, 0xa868, 0xa688, 0xaa48, 0xb448
.long 0xa870, 0xa690, 0xaa50, 0xb450, 0xa878, 0xa698, 0xaa58, 0xb458
.long 0xab80, 0xa4a0, 0xa9a0, 0xb4e0, 0xab88, 0xa4a8, 0xa9a8, 0xb4e8
.long 0xab90, 0xa4b0, 0xa9b0, 0xb4f0, 0xab98, 0xa4b8, 0xa9b8, 0xb4f8
.long 0xa680, 0xa900, 0xab80, 0xa4a0, 0xa688, 0xa908, 0xab88, 0xa4a8
.long 0xa690, 0xa910, 0xab90, 0xa4b0, 0xa698, 0xa918, 0xab98, 0xa4b8
.long 0xa860, 0xa9a0, 0xb1c0, 0xb440, 0xa868, 0xa9a8, 0xb1c8, 0xb448
.long 0xa870, 0xa9b0, 0xb1d0, 0xb450, 0xa878, 0xa9b8, 0xb1d8, 0xb458
.long 0xa7c0, 0xa540, 0xab80, 0xa4a0, 0xa7c8, 0xa548, 0xab88, 0xa4a8
.long 0xa7d0, 0xa550, 0xab90, 0xa4b0, 0xa7d8, 0xa558, 0xab98, 0xa4b8
.long 0xa720, 0xa5e0, 0xb1c0, 0xb440, 0xa728, 0xa5e8, 0xb1c8, 0xb448
.long 0xa730, 0xa5f0, 0xb1d0, 0xb450, 0xa738, 0xa5f8, 0xb1d8, 0xb458
.long 0xb4e0, 0xb6c0, 0xb800, 0xa860, 0xb4e8, 0xb6c8, 0xb808, 0xa868
.long 0xb4f0, 0xb6d0, 0xb810, 0xa870, 0xb4f8, 0xb6d8, 0xb818, 0xa878
.long 0xb300, 0xb760, 0xa540, 0xa900, 0xb308, 0xb768, 0xa548, 0xa908
.long 0xb310, 0xb770, 0xa550, 0xa910, 0xb318, 0xb778, 0xa558, 0xa918
.long 0xb440, 0xb080, 0xb800, 0xa860, 0xb448, 0xb088, 0xb808, 0xa868
.long 0xb450, 0xb090, 0xb810, 0xa870, 0xb458, 0xb098, 0xb818, 0xa878
.long 0xb3a0, 0xb120, 0xa540, 0xa900, 0xb3a8, 0xb128, 0xa548, 0xa908
.long 0xb3b0, 0xb130, 0xa550, 0xa910, 0xb3b8, 0xb138, 0xa558, 0xa918
.long 0xb120, 0xb580, 0xb080, 0xb300, 0xb128, 0xb588, 0xb088, 0xb308
.long 0xb130, 0xb590, 0xb090, 0xb310, 0xb138, 0xb598, 0xb098, 0xb318
.long 0xb6c0, 0xb4e0, 0xaa40, 0xb6c0, 0xb6c8, 0xb4e8, 0xaa48, 0xb6c8
.long 0xb6d0, 0xb4f0, 0xaa50, 0xb6d0, 0xb6d8, 0xb4f8, 0xaa58, 0xb6d8
.long 0xb300, 0xb440, 0xb080, 0xb300, 0xb308, 0xb448, 0xb088, 0xb308
.long 0xb310, 0xb450, 0xb090, 0xb310, 0xb318, 0xb458, 0xb098, 0xb318
.long 0xb260, 0xb760, 0xaa40, 0xb6c0, 0xb268, 0xb768, 0xaa48, 0xb6c8
.long 0xb270, 0xb770, 0xaa50, 0xb6d0, 0xb278, 0xb778, 0xaa58, 0xb6d8
.long 0xb580, 0xb120, 0xb620, 0xa680, 0xb588, 0xb128, 0xb628, 0xa688
.long 0xb590, 0xb130, 0xb630, 0xa690, 0xb598, 0xb138, 0xb638, 0xa698
.long 0xb260, 0xb1c0, 0xa7c0, 0xa680, 0xb268, 0xb1c8, 0xa7c8, 0xa688
.long 0xb270, 0xb1d0, 0xa7d0, 0xa690, 0xb278, 0xb1d8, 0xa7d8, 0xa698
.long 0xb300, 0xb3a0, 0xb620, 0xb300, 0xb308, 0xb3a8, 0xb628, 0xb308
.long 0xb310, 0xb3b0, 0xb630, 0xb310, 0xb318, 0xb3b8, 0xb638, 0xb318
.long 0xb6c0, 0xb800, 0xa7c0, 0xb300, 0xb6c8, 0xb808, 0xa7c8, 0xb308
.long 0xb6d0, 0xb810, 0xa7d0, 0xb310, 0xb6d8, 0xb818, 0xa7d8, 0xb318
.long 0x0, 0x200, 0x0, 0x3f803f80, 0x8, 0x208, 0x0, 0x3f803f80
.long 0x10, 0x210, 0x0, 0x3f803f80, 0x18, 0x218, 0x0, 0x3f803f80
.long 0x420, 0x620, 0x0, 0x3f803f80, 0x428, 0x628, 0x0, 0x3f803f80
.long 0x430, 0x630, 0x0, 0x3f803f80, 0x438, 0x638, 0x0, 0x3f803f80
.long 0x840, 0xa40, 0x10, 0x3f803f80, 0x848, 0xa48, 0x10, 0x3f803f80
.long 0x850, 0xa50, 0x10, 0x3f803f80, 0x858, 0xa58, 0x10, 0x3f803f80
.long 0xc60, 0xe60, 0x10, 0x3f803f80, 0xc68, 0xe68, 0x10, 0x3f803f80
.long 0xc70, 0xe70, 0x10, 0x3f803f80, 0xc78, 0xe78, 0x10, 0x3f803f80
.long 0x80, 0x280, 0x20, 0x3f803f80, 0x88, 0x288, 0x20, 0x3f803f80
.long 0x90, 0x290, 0x20, 0x3f803f80, 0x98, 0x298, 0x20, 0x3f803f80
.long 0x4a0, 0x6a0, 0x20, 0x3f803f80, 0x4a8, 0x6a8, 0x20, 0x3f803f80
.long 0x4b0, 0x6b0, 0x20, 0x3f803f80, 0x4b8, 0x6b8, 0x20, 0x3f803f80
.long 0x8c0, 0xac0, 0x30, 0x3f803f80, 0x8c8, 0xac8, 0x30, 0x3f803f80
.long 0x8d0, 0xad0, 0x30, 0x3f803f80, 0x8d8, 0xad8, 0x30, 0x3f803f80
.long 0xce0, 0xee0, 0x30, 0x3f803f80, 0xce8, 0xee8, 0x30, 0x3f803f80
.long 0xcf0, 0xef0, 0x30, 0x3f803f80, 0xcf8, 0xef8, 0x30, 0x3f803f80
.long 0x100, 0x300, 0x40, 0x0, 0x108, 0x308, 0x40, 0x0
.long 0x110, 0x310, 0x40, 0x0, 0x118, 0x318, 0x40, 0x0
.long 0x520, 0x720, 0x40, 0x0, 0x528, 0x728, 0x40, 0x0
.long 0x530, 0x730, 0x40, 0x0, 0x538, 0x738, 0x40, 0x0
.long 0x940, 0xb40, 0x50, 0x0, 0x948, 0xb48, 0x50, 0x0
.long 0x950, 0xb50, 0x50, 0x0, 0x958, 0xb58, 0x50, 0x0
.long 0xd60, 0xf60, 0x50, 0x0, 0xd68, 0xf68, 0x50, 0x0
.long 0xd70, 0xf70, 0x50, 0x0, 0xd78, 0xf78, 0x50, 0x0
.long 0x180, 0xf60, 0x60, 0x0, 0x188, 0xf68, 0x60, 0x0
.long 0x190, 0xf70, 0x60, 0x0, 0x198, 0xf78, 0x60, 0x0
.long 0x5a0, 0xf60, 0x60, 0x0, 0x5a8, 0xf68, 0x60, 0x0
.long 0x5b0, 0xf70, 0x60, 0x0, 0x5b8, 0xf78, 0x60, 0x0
.long 0x9c0, 0xf60, 0x70, 0x0, 0x9c8, 0xf68, 0x70, 0x0
.long 0x9d0, 0xf70, 0x70, 0x0, 0x9d8, 0xf78, 0x70, 0x0
.long 0xde0, 0xf60, 0x70, 0x0, 0xde8, 0xf68, 0x70, 0x0
.long 0xdf0, 0xf70, 0x70, 0x0, 0xdf8, 0xf78, 0x70, 0x0
.long 0xffff, 0x0, 0x0, 0x0, 0x0, 0x0, 0xffff, 0x0
.long 0x0, 0x0, 0x0, 0x0, 0x0, 0x0, 0x0, 0x0
.long 0x0, 0x0, 0x0, 0x0, 0x0, 0x0, 0x0, 0x0
.long 0x0, 0x0, 0x0, 0x0, 0x0, 0x0, 0x0, 0x0
.long 0xffff0000, 0x0, 0x0, 0x0, 0x0, 0x0, 0xffff0000, 0x0
.long 0x0, 0x0, 0x0, 0x0, 0x0, 0x0, 0x0, 0x0
.long 0x0, 0x0, 0x0, 0x0, 0x0, 0x0, 0x0, 0x0
.long 0x0, 0x0, 0x0, 0x0, 0x0, 0x0, 0x0, 0x0
.long 0x0, 0xffff, 0x0, 0x0, 0x0, 0x0, 0x0, 0xffff
.long 0x0, 0x0, 0x0, 0x0, 0x0, 0x0, 0x0, 0x0
.long 0x0, 0x0, 0x0, 0x0, 0x0, 0x0, 0x0, 0x0
.long 0x0, 0x0, 0x0, 0x0, 0x0, 0x0, 0x0, 0x0
.long 0x0, 0xffff0000, 0x0, 0x0, 0x0, 0x0, 0x0, 0xffff0000
.long 0x0, 0x0, 0x0, 0x0, 0x0, 0x0, 0x0, 0x0
.long 0x0, 0x0, 0x0, 0x0, 0x0, 0x0, 0x0, 0x0
.long 0x0, 0x0, 0x0, 0x0, 0x0, 0x0, 0x0, 0x0
.long 0x0, 0x0, 0x0, 0x0, 0x0, 0x0, 0x0, 0x0
.long 0xffff, 0x0, 0x0, 0x0, 0x0, 0x0, 0xffff, 0x0
.long 0x0, 0x0, 0x0, 0x0, 0x0, 0x0, 0x0, 0x0
.long 0x0, 0x0, 0x0, 0x0, 0x0, 0x0, 0x0, 0x0
.long 0x0, 0x0, 0x0, 0x0, 0x0, 0x0, 0x0, 0x0
.long 0xffff0000, 0x0, 0x0, 0x0, 0x0, 0x0, 0xffff0000, 0x0
.long 0x0, 0x0, 0x0, 0x0, 0x0, 0x0, 0x0, 0x0
.long 0x0, 0x0, 0x0, 0x0, 0x0, 0x0, 0x0, 0x0
.long 0x0, 0x0, 0x0, 0x0, 0x0, 0x0, 0x0, 0x0
.long 0x0, 0xffff, 0x0, 0x0, 0x0, 0x0, 0x0, 0xffff
.long 0x0, 0x0, 0x0, 0x0, 0x0, 0x0, 0x0, 0x0
.long 0x0, 0x0, 0x0, 0x0, 0x0, 0x0, 0x0, 0x0
.long 0x0, 0x0, 0x0, 0x0, 0x0, 0x0, 0x0, 0x0
.long 0x0, 0xffff0000, 0x0, 0x0, 0x0, 0x0, 0x0, 0xffff0000
.long 0x0, 0x0, 0x0, 0x0, 0x0, 0x0, 0x0, 0x0
.long 0x0, 0x0, 0x0, 0x0, 0x0, 0x0, 0x0, 0x0
.long 0x0, 0x0, 0x0, 0x0, 0x0, 0x0, 0x0, 0x0
.long 0x0, 0x0, 0x0, 0x0, 0x0, 0x0, 0x0, 0x0
.long 0x0, 0x0, 0xffff, 0x0, 0x0, 0x0, 0x0, 0x0
.long 0x0, 0x0, 0x0, 0x0, 0xffff, 0x0, 0x0, 0x0
.long 0x0, 0x0, 0x0, 0x0, 0x0, 0x0, 0x0, 0x0
.long 0x0, 0x0, 0x0, 0x0, 0x0, 0x0, 0x0, 0x0
.long 0x0, 0x0, 0xffff0000, 0x0, 0x0, 0x0, 0x0, 0x0
.long 0x0, 0x0, 0x0, 0x0, 0xffff0000, 0x0, 0x0, 0x0
.long 0x0, 0x0, 0x0, 0x0, 0x0, 0x0, 0x0, 0x0
.long 0x0, 0x0, 0x0, 0x0, 0x0, 0x0, 0x0, 0x0
.long 0x0, 0x0, 0x0, 0xffff, 0x0, 0x0, 0x0, 0x0
.long 0x0, 0x0, 0x0, 0x0, 0x0, 0xffff, 0x0, 0x0
.long 0x0, 0x0, 0x0, 0x0, 0x0, 0x0, 0x0, 0x0
.long 0x0, 0x0, 0x0, 0x0, 0x0, 0x0, 0x0, 0x0
.long 0x0, 0x0, 0x0, 0xffff0000, 0x0, 0x0, 0x0, 0x0
.long 0x0, 0x0, 0x0, 0x0, 0x0, 0xffff0000, 0x0, 0x0
.long 0x0, 0x0, 0x0, 0x0, 0x0, 0x0, 0x0, 0x0
.long 0x0, 0x0, 0x0, 0x0, 0x0, 0x0, 0x0, 0x0
.long 0x0, 0x0, 0x0, 0x0, 0xffff, 0x0, 0x0, 0x0
.long 0x0, 0x0, 0x0, 0x0, 0x0, 0x0, 0x0, 0x0
.long 0x0, 0x0, 0x0, 0x0, 0x0, 0x0, 0x0, 0x0
.long 0x0, 0x0, 0x0, 0x0, 0x0, 0x0, 0x0, 0x0
.long 0x0, 0x0, 0x0, 0x0, 0xffff0000, 0x0, 0x0, 0x0
.long 0x0, 0x0, 0x0, 0x0, 0x0, 0x0, 0x0, 0x0
.long 0x0, 0x0, 0x0, 0x0, 0x0, 0x0, 0x0, 0x0
.long 0x0, 0x0, 0x0, 0x0, 0x0, 0x0, 0x0, 0x0
.long 0x0, 0x0, 0x0, 0x0, 0x0, 0x0, 0x0, 0x0
.long 0x0, 0x0, 0x0, 0x0, 0x0, 0x0, 0x0, 0x0
.long 0x0, 0x0, 0x0, 0x0, 0x0, 0x0, 0x0, 0x0
.long 0x0, 0x0, 0x0, 0x0, 0x0, 0x0, 0x0, 0x0
.long 0x0, 0x0, 0x0, 0x0, 0x0, 0x0, 0x0, 0x0
.long 0x0, 0x0, 0x0, 0x0, 0x0, 0x0, 0x0, 0x0
.long 0x14d40, 0x14d40, 0x0, 0x0, 0x14e10, 0x14e10, 0x20, 0x20
.long 0x14ee0, 0x14ee0, 0x100000, 0x100000, 0x14fb0, 0x14fb0, 0x100020, 0x100020
.long 0x15080, 0x15080, 0x40, 0x40, 0x15150, 0x15150, 0x60, 0x60
.long 0x15220, 0x15220, 0x100040, 0x100040, 0x100000, 0x100000, 0x100060, 0x100060
.long 0x14d74, 0x14d74, 0x80, 0x80, 0x14e44, 0x14e44, 0xa0, 0xa0
.long 0x14f14, 0x14f14, 0x100080, 0x100080, 0x14fe4, 0x14fe4, 0x1000a0, 0x1000a0
.long 0x150b4, 0x150b4, 0xc0, 0xc0, 0x15184, 0x15184, 0xe0, 0xe0
.long 0x15254, 0x15254, 0x1000c0, 0x1000c0, 0x100000, 0x100000, 0x1000e0, 0x1000e0
.long 0x14da8, 0x14da8, 0x8, 0x100, 0x14e78, 0x14e78, 0x28, 0x120
.long 0x14f48, 0x14f48, 0x100008, 0x100100, 0x15018, 0x15018, 0x100028, 0x100120
.long 0x150e8, 0x150e8, 0x48, 0x140, 0x151b8, 0x151b8, 0x68, 0x160
.long 0x100000, 0x100000, 0x100048, 0x100140, 0x100000, 0x100000, 0x100068, 0x100160
.long 0x14ddc, 0x14ddc, 0x88, 0x180, 0x14eac, 0x14eac, 0xa8, 0x1a0
.long 0x14f7c, 0x14f7c, 0x100088, 0x100180, 0x1504c, 0x1504c, 0x1000a8, 0x1001a0
.long 0x1511c, 0x1511c, 0xc8, 0x1c0, 0x151ec, 0x151ec, 0xe8, 0x1e0
.long 0x100000, 0x100000, 0x1000c8, 0x1001c0, 0x100000, 0x100000, 0x1000e8, 0x1001e0
.long 0x17d40, 0x114d40, 0x100, 0x200, 0x17e10, 0x114e10, 0x120, 0x220
.long 0x17ee0, 0x114ee0, 0x100100, 0x100200, 0x17fb0, 0x114fb0, 0x100120, 0x100220
.long 0x18080, 0x115080, 0x140, 0x240, 0x18150, 0x115150, 0x160, 0x260
.long 0x18220, 0x115220, 0x100140, 0x100240, 0x103000, 0x200000, 0x100160, 0x100260
.long 0x17d74, 0x114d74, 0x180, 0x280, 0x17e44, 0x114e44, 0x1a0, 0x2a0
.long 0x17f14, 0x114f14, 0x100180, 0x100280, 0x17fe4, 0x114fe4, 0x1001a0, 0x1002a0
.long 0x180b4, 0x1150b4, 0x1c0, 0x2c0, 0x18184, 0x115184, 0x1e0, 0x2e0
.long 0x18254, 0x115254, 0x1001c0, 0x1002c0, 0x103000, 0x200000, 0x1001e0, 0x1002e0
.long 0x17da8, 0x114da8, 0x108, 0x300, 0x17e78, 0x114e78, 0x128, 0x320
.long 0x17f48, 0x114f48, 0x100108, 0x100300, 0x18018, 0x115018, 0x100128, 0x100320
.long 0x180e8, 0x1150e8, 0x148, 0x340, 0x181b8, 0x1151b8, 0x168, 0x360
.long 0x103000, 0x200000, 0x100148, 0x100340, 0x103000, 0x200000, 0x100168, 0x100360
.long 0x17ddc, 0x114ddc, 0x188, 0x380, 0x17eac, 0x114eac, 0x1a8, 0x3a0
.long 0x17f7c, 0x114f7c, 0x100188, 0x100380, 0x1804c, 0x11504c, 0x1001a8, 0x1003a0
.long 0x1811c, 0x11511c, 0x1c8, 0x3c0, 0x181ec, 0x1151ec, 0x1e8, 0x3e0
.long 0x103000, 0x200000, 0x1001c8, 0x1003c0, 0x103000, 0x200000, 0x1001e8, 0x1003e0
.long 0xa400, 0xd00, 0x0, 0x14d40, 0xa440, 0xd00, 0x0, 0x14d80
.long 0xa480, 0xd00, 0x1, 0x14dd0, 0xa4c0, 0xd00, 0x1, 0x14e10
.long 0xa500, 0xd00, 0x2, 0x14e60, 0xa540, 0xd00, 0x2, 0x14ea0
.long 0xa580, 0xd00, 0x3, 0x14ef0, 0xa5c0, 0xd00, 0x3, 0x14f30
.long 0xa600, 0xd00, 0x4, 0x14f40, 0xa640, 0xd00, 0x4, 0x14f80
.long 0xa680, 0xd00, 0x5, 0x14fd0, 0xa6c0, 0xd00, 0x5, 0x15010
.long 0xa700, 0xd00, 0x6, 0x15060, 0xa740, 0xd00, 0x6, 0x150a0
.long 0xa780, 0xd00, 0x7, 0x150f0, 0xa7c0, 0xd00, 0x7, 0x15130
.long 0xa800, 0xd00, 0x8, 0x15140, 0xa840, 0xd00, 0x8, 0x15180
.long 0xa880, 0xd00, 0x9, 0x151d0, 0xa8c0, 0xd00, 0x9, 0x15210
.long 0xa900, 0xd00, 0xa, 0x15260, 0xa940, 0xd00, 0xa, 0x152a0
.long 0xa980, 0xd00, 0xb, 0x152f0, 0xa9c0, 0xd00, 0xb, 0x15330
.long 0xaa00, 0xd00, 0xc, 0x15340, 0xaa40, 0xd00, 0xc, 0x15380
.long 0x1f680, 0x40, 0xd, 0x153d0, 0x100000, 0xd00, 0xd, 0x15410
.long 0x100000, 0xd00, 0xe, 0x15460, 0x100000, 0xd00, 0xe, 0x154a0
.long 0x100000, 0xd00, 0xf, 0x154f0, 0x100000, 0xd00, 0xf, 0x15530
.long 0xa400, 0xd00, 0x2, 0x14d60, 0xa440, 0xd00, 0x2, 0x14da0
.long 0xa480, 0xd00, 0x3, 0x14df0, 0xa4c0, 0xd00, 0x3, 0x14e30
.long 0xa500, 0xd00, 0x4, 0x14e40, 0xa540, 0xd00, 0x4, 0x14e80
.long 0xa580, 0xd00, 0x5, 0x14ed0, 0xa5c0, 0xd00, 0x5, 0x14f10
.long 0xa600, 0xd00, 0x6, 0x14f60, 0xa640, 0xd00, 0x6, 0x14fa0
.long 0xa680, 0xd00, 0x7, 0x14ff0, 0xa6c0, 0xd00, 0x7, 0x15030
.long 0xa700, 0xd00, 0x8, 0x15040, 0xa740, 0xd00, 0x8, 0x15080
.long 0xa780, 0xd00, 0x9, 0x150d0, 0xa7c0, 0xd00, 0x9, 0x15110
.long 0xa800, 0xd00, 0xa, 0x15160, 0xa840, 0xd00, 0xa, 0x151a0
.long 0xa880, 0xd00, 0xb, 0x151f0, 0xa8c0, 0xd00, 0xb, 0x15230
.long 0xa900, 0xd00, 0xc, 0x15240, 0xa940, 0xd00, 0xc, 0x15280
.long 0xa980, 0xd00, 0xd, 0x152d0, 0xa9c0, 0xd00, 0xd, 0x15310
.long 0xaa00, 0xd00, 0xe, 0x15360, 0xaa40, 0xd00, 0xe, 0x153a0
.long 0x1f680, 0x40, 0xf, 0x153f0, 0x100000, 0xd00, 0xf, 0x15430
.long 0x100000, 0xd00, 0x10, 0x15440, 0x100000, 0xd00, 0x10, 0x15480
.long 0x100000, 0xd00, 0x11, 0x154d0, 0x100000, 0xd00, 0x11, 0x15510
.long 0x1f690, 0x1f890, 0x1f9c0, 0x1f9e0, 0x1f698, 0x1f898, 0x1f9c8, 0x1f9e8
.long 0x1f680, 0x1f880, 0x1f9d0, 0x1f9f0, 0x1f688, 0x1f888, 0x1f9d8, 0x100000
.long 0x1fd20, 0x1ff20, 0x1f9c2, 0x1f9e2, 0x1fd28, 0x1ff28, 0x1f9ca, 0x1f9ea
.long 0x1fd30, 0x1ff30, 0x1f9d2, 0x1f9f2, 0x1fd38, 0x1ff38, 0x1f9da, 0x100000
.long 0x1f6f0, 0x1f8f0, 0x1f9c4, 0x1f9e4, 0x1f6f8, 0x1f8f8, 0x1f9cc, 0x1f9ec
.long 0x1f6e0, 0x1f8e0, 0x1f9d4, 0x100000, 0x1f6e8, 0x1f8e8, 0x1f9dc, 0x100000
.long 0x1fd40, 0x1ff40, 0x1f9c6, 0x1f9e6, 0x1fd48, 0x1ff48, 0x1f9ce, 0x1f9ee
.long 0x1fd50, 0x1ff50, 0x1f9d6, 0x100000, 0x1fd58, 0x1ff58, 0x1f9de, 0x100000
.long 0x1f710, 0x1f910, 0x1f9c0, 0x1f9e0, 0x1f718, 0x1f918, 0x1f9c8, 0x1f9e8
.long 0x1f700, 0x1f900, 0x1f9d0, 0x1f9f0, 0x1f708, 0x1f908, 0x1f9d8, 0x100000
.long 0x1fda0, 0x1ffa0, 0x1f9c2, 0x1f9e2, 0x1fda8, 0x1ffa8, 0x1f9ca, 0x1f9ea
.long 0x1fdb0, 0x1ffb0, 0x1f9d2, 0x1f9f2, 0x1fdb8, 0x1ffb8, 0x1f9da, 0x100000
.long 0x1f770, 0x1f970, 0x1f9c4, 0x1f9e4, 0x1f778, 0x1f978, 0x1f9cc, 0x1f9ec
.long 0x1f760, 0x1f960, 0x1f9d4, 0x100000, 0x1f768, 0x1f968, 0x1f9dc, 0x100000
.long 0x1fdc0, 0x1ffc0, 0x1f9c6, 0x1f9e6, 0x1fdc8, 0x1ffc8, 0x1f9ce, 0x1f9ee
.long 0x1fdd0, 0x1ffd0, 0x1f9d6, 0x100000, 0x1fdd8, 0x1ffd8, 0x1f9de, 0x100000
.long 0x1f790, 0x1f990, 0x1f9c0, 0x1f9e0, 0x1f798, 0x1f998, 0x1f9c8, 0x1f9e8
.long 0x1f780, 0x1f980, 0x1f9d0, 0x1f9f0, 0x1f788, 0x1f988, 0x1f9d8, 0x100000
.long 0x1fe20, 0x20020, 0x1f9c2, 0x1f9e2, 0x1fe28, 0x20028, 0x1f9ca, 0x1f9ea
.long 0x1fe30, 0x20030, 0x1f9d2, 0x1f9f2, 0x1fe38, 0x20038, 0x1f9da, 0x100000
.long 0x1f7f0, 0x14d00, 0x1f9c4, 0x1f9e4, 0x1f7f8, 0x14d08, 0x1f9cc, 0x1f9ec
.long 0x1f7e0, 0x14d10, 0x1f9d4, 0x100000, 0x1f7e8, 0x14d18, 0x1f9dc, 0x100000
.long 0x1fe40, 0x14d00, 0x1f9c6, 0x1f9e6, 0x1fe48, 0x14d08, 0x1f9ce, 0x1f9ee
.long 0x1fe50, 0x14d10, 0x1f9d6, 0x100000, 0x1fe58, 0x14d18, 0x1f9de, 0x100000
.long 0x1f810, 0x14d00, 0x1f9c0, 0x1f9e0, 0x1f818, 0x14d08, 0x1f9c8, 0x1f9e8
.long 0x1f800, 0x14d10, 0x1f9d0, 0x1f9f0, 0x1f808, 0x14d18, 0x1f9d8, 0x100000
.long 0x1fea0, 0x14d00, 0x1f9c2, 0x1f9e2, 0x1fea8, 0x14d08, 0x1f9ca, 0x1f9ea
.long 0x1feb0, 0x14d10, 0x1f9d2, 0x1f9f2, 0x1feb8, 0x14d18, 0x1f9da, 0x100000
.long 0x1f870, 0x14d00, 0x1f9c4, 0x1f9e4, 0x1f878, 0x14d08, 0x1f9cc, 0x1f9ec
.long 0x1f860, 0x14d10, 0x1f9d4, 0x100000, 0x1f868, 0x14d18, 0x1f9dc, 0x100000
.long 0x1fec0, 0x14d00, 0x1f9c6, 0x1f9e6, 0x1fec8, 0x14d08, 0x1f9ce, 0x1f9ee
.long 0x1fed0, 0x14d10, 0x1f9d6, 0x100000, 0x1fed8, 0x14d18, 0x1f9de, 0x100000
.long 0x0, 0x4444, 0x0, 0xa400, 0x10, 0xeeee, 0x4, 0xa404
.long 0x20, 0x4444, 0x8, 0xa408, 0x30, 0xeeee, 0xc, 0xa40c
.long 0x40, 0x4444, 0x10, 0xa410, 0x50, 0xeeee, 0x14, 0xa414
.long 0x60, 0x4444, 0x18, 0xa418, 0x70, 0xeeee, 0x1c, 0xa41c
.long 0x0, 0x4444, 0x20, 0xa420, 0x10, 0xeeee, 0x24, 0xa424
.long 0x20, 0x4444, 0x28, 0xa428, 0x30, 0xeeee, 0x2c, 0xa42c
.long 0x40, 0x4444, 0x30, 0xa430, 0x50, 0xeeee, 0x34, 0xa434
.long 0x60, 0x4444, 0x38, 0xa438, 0x70, 0xeeee, 0x3c, 0xa43c
.long 0x0, 0x4444, 0x40, 0xa440, 0x10, 0xeeee, 0x44, 0xa444
.long 0x20, 0x4444, 0x48, 0xa448, 0x30, 0xeeee, 0x4c, 0xa44c
.long 0x40, 0x4444, 0x50, 0xa450, 0x50, 0xeeee, 0x54, 0xa454
.long 0x60, 0x4444, 0x58, 0xa458, 0x70, 0xeeee, 0x5c, 0xa45c
.long 0x0, 0x4444, 0x60, 0xa460, 0x10, 0xeeee, 0x64, 0xa464
.long 0x20, 0x4444, 0x68, 0xa468, 0x30, 0xeeee, 0x6c, 0xa46c
.long 0x40, 0x4444, 0x70, 0xa470, 0x50, 0xeeee, 0x74, 0xa474
.long 0x60, 0x4444, 0x78, 0xa478, 0x70, 0xeeee, 0x7c, 0xa47c
.long 0x0, 0x4444, 0x420, 0xb080, 0x10, 0xeeee, 0x424, 0xb084
.long 0x20, 0x4444, 0x428, 0xb088, 0x30, 0xeeee, 0x42c, 0xb08c
.long 0x40, 0x4444, 0x430, 0xb090, 0x50, 0xeeee, 0x434, 0xb094
.long 0x60, 0x4444, 0x438, 0xb098, 0x70, 0xeeee, 0x43c, 0xb09c
.long 0x0, 0x4444, 0x440, 0xb0a0, 0x10, 0xeeee, 0x444, 0xb0a4
.long 0x20, 0x4444, 0x448, 0xb0a8, 0x30, 0xeeee, 0x44c, 0xb0ac
.long 0x40, 0x4444, 0x450, 0xb0b0, 0x50, 0xeeee, 0x454, 0xb0b4
.long 0x60, 0x4444, 0x458, 0xb0b8, 0x70, 0xeeee, 0x45c, 0xb0bc
.long 0x0, 0x4444, 0x460, 0xb0c0, 0x10, 0xeeee, 0x464, 0xb0c4
.long 0x20, 0x4444, 0x468, 0xb0c8, 0x30, 0xeeee, 0x46c, 0xb0cc
.long 0x40, 0x4444, 0x470, 0xb0d0, 0x50, 0xeeee, 0x474, 0xb0d4
.long 0x60, 0x4444, 0x478, 0xb0d8, 0x70, 0xeeee, 0x47c, 0xb0dc
.long 0x0, 0x4444, 0x480, 0xb0e0, 0x10, 0xeeee, 0x484, 0xb0e4
.long 0x20, 0x4444, 0x488, 0xb0e8, 0x30, 0xeeee, 0x48c, 0xb0ec
.long 0x40, 0x4444, 0x490, 0xb0f0, 0x50, 0xeeee, 0x494, 0xb0f4
.long 0x60, 0x4444, 0x498, 0xb0f8, 0x70, 0xeeee, 0x49c, 0xb0fc
.long 0x1fa28, 0x1f9f4, 0x34, 0x14d00, 0x1fa28, 0x1f9f6, 0x74, 0x14d04
.long 0x1fa28, 0x1f9f8, 0xb4, 0x14d08, 0x1fa28, 0x1f9fa, 0xf4, 0x14d0c
.long 0x1fa28, 0x1f9fc, 0x134, 0x14d10, 0x1fa28, 0x1f9fe, 0x174, 0x14d14
.long 0x1fa28, 0x1fa00, 0x1b4, 0x14d18, 0x1fa28, 0x1fa02, 0x1f4, 0x14d1c
.long 0x1fa28, 0x1fa04, 0x234, 0x14d20, 0x1fa28, 0x1fa06, 0x274, 0x14d24
.long 0x1fa28, 0x1fa08, 0x2b4, 0x14d28, 0x1fa28, 0x1fa0a, 0x2f4, 0x14d2c
.long 0x1fa28, 0x1fa0c, 0x334, 0x14d30, 0x1fa28, 0x1fa0e, 0x374, 0x14d34
.long 0x1fa28, 0x1fa10, 0x3b4, 0x14d38, 0x1fa28, 0x1fa12, 0x3f4, 0x14d3c
.long 0x1fa28, 0x1fa14, 0x434, 0x14d00, 0x1fa28, 0x1fa16, 0x474, 0x14d04
.long 0x1fa28, 0x1fa18, 0x4b4, 0x14d08, 0x1fa28, 0x1fa1a, 0x4f4, 0x14d0c
.long 0x1fa28, 0x1fa1c, 0x534, 0x14d10, 0x1fa28, 0x1fa1e, 0x574, 0x14d14
.long 0x1fa28, 0x1fa20, 0x5b4, 0x14d18, 0x1fa28, 0x1fa22, 0x5f4, 0x14d1c
.long 0x1fa28, 0x1fa24, 0x634, 0x14d20, 0x1fa28, 0x1fa26, 0x674, 0x14d24
.long 0x1fa28, 0x1fa28, 0x6b4, 0x14d28, 0x1fa28, 0x1fa2a, 0x6f4, 0x14d2c
.long 0x1fa28, 0x1fa2c, 0x734, 0x14d30, 0x1fa28, 0x1fa2e, 0x774, 0x14d34
.long 0x1fa28, 0x1fa30, 0x7b4, 0x14d38, 0x1fa28, 0x1fa32, 0x7f4, 0x14d3c
.long 0x1fa38, 0x1fa34, 0x834, 0x14d00, 0x1fa38, 0x1fa36, 0x874, 0x14d04
.long 0x1fa38, 0x1fa38, 0x8b4, 0x14d08, 0x1fa38, 0x1fa3a, 0x8f4, 0x14d0c
.long 0x1fa38, 0x1fa3c, 0x934, 0x14d10, 0x1fa38, 0x1fa3e, 0x974, 0x14d14
.long 0x1fa38, 0x1fa40, 0x9b4, 0x14d18, 0x1fa38, 0x1fa42, 0x9f4, 0x14d1c
.long 0x1fa38, 0x1fa44, 0xa34, 0x14d20, 0x1fa38, 0x1fa46, 0xa74, 0x14d24
.long 0x1fa38, 0x1fa48, 0xab4, 0x14d28, 0x1fa38, 0x1fa4a, 0xaf4, 0x14d2c
.long 0x1fa38, 0x1fa4c, 0xb34, 0x14d30, 0x1fa38, 0x1fa4e, 0xb74, 0x14d34
.long 0x1fa38, 0x1fa50, 0xbb4, 0x14d38, 0x1fa38, 0x1fa52, 0xbf4, 0x14d3c
.long 0x1fa38, 0x1fa54, 0xc34, 0x14d00, 0x1fa38, 0x1fa56, 0xc74, 0x14d04
.long 0x1fa38, 0x1fa58, 0xcb4, 0x14d08, 0x1fa38, 0x1fa5a, 0xcf4, 0x14d0c
.long 0x1fa38, 0x1fa5c, 0xd34, 0x14d10, 0x1fa38, 0x1fa5e, 0xd74, 0x14d14
.long 0x1fa38, 0x1fa60, 0xdb4, 0x14d18, 0x1fa38, 0x1fa62, 0xdf4, 0x14d1c
.long 0x1fa38, 0x1fa64, 0xe34, 0x14d20, 0x1fa38, 0x1fa66, 0xe74, 0x14d24
.long 0x1fa38, 0x1fa68, 0xeb4, 0x14d28, 0x1fa38, 0x1fa6a, 0xef4, 0x14d2c
.long 0x1fa38, 0x1fa6c, 0xf34, 0x14d30, 0x1fa38, 0x1fa6e, 0xf74, 0x14d34
.long 0x1fa38, 0x1fa70, 0xfb4, 0x14d38, 0x1fa38, 0x1fa72, 0xff4, 0x14d3c
.long 0x0, 0x0, 0x0, 0x0, 0x0, 0x0, 0x0, 0x0
.long 0x0, 0x0, 0x0, 0x0, 0x0, 0x0, 0x0, 0x0
.long 0x0, 0x0, 0x0, 0x0, 0x0, 0x0, 0x0, 0x0
.long 0x0, 0x0, 0x0, 0x0, 0x0, 0x0, 0x0, 0x0
.long 0x0, 0x0, 0x0, 0x0, 0x0, 0x0, 0x0, 0x0
.long 0x0, 0x0, 0x0, 0x0, 0x0, 0x0, 0x0, 0x0
.long 0x0, 0x0, 0x0, 0x0, 0x0, 0x0, 0x0, 0x0
.long 0x0, 0x0, 0x0, 0x0, 0x0, 0x0, 0x0, 0x0
.long 0x0, 0x0, 0x0, 0x0, 0x0, 0x0, 0x0, 0x0
.long 0x0, 0x0, 0x0, 0x0, 0x0, 0x0, 0x0, 0x0
.long 0x0, 0x0, 0x0, 0x0, 0x0, 0x0, 0x0, 0x0
.long 0x0, 0x0, 0x0, 0x0, 0x0, 0x0, 0x0, 0x0
.long 0x0, 0x0, 0x0, 0x0, 0x0, 0x0, 0x0, 0x0
.long 0x0, 0x0, 0x0, 0x0, 0x0, 0x0, 0x0, 0x0
.long 0x0, 0x0, 0x0, 0x0, 0x0, 0x0, 0x0, 0x0
.long 0x0, 0x0, 0x0, 0x0, 0x0, 0x0, 0x0, 0x0
.long 0x0, 0x0, 0x0, 0x0, 0x0, 0x0, 0x0, 0x0
.long 0x0, 0x0, 0x0, 0x0, 0x0, 0x0, 0x0, 0x0
.long 0x0, 0x0, 0x0, 0x0, 0x0, 0x0, 0x0, 0x0
.long 0x0, 0x0, 0x0, 0x0, 0x0, 0x0, 0x0, 0x0
.long 0x0, 0x0, 0x0, 0x0, 0x0, 0x0, 0x0, 0x0
.long 0x0, 0x0, 0x0, 0x0, 0x0, 0x0, 0x0, 0x0
.long 0x0, 0x0, 0x0, 0x0, 0x0, 0x0, 0x0, 0x0
.long 0x0, 0x0, 0x0, 0x0, 0x0, 0x0, 0x0, 0x0
.long 0x0, 0x0, 0x0, 0x0, 0x0, 0x0, 0x0, 0x0
.long 0x0, 0x0, 0x0, 0x0, 0x0, 0x0, 0x0, 0x0
.long 0x0, 0x0, 0x0, 0x0, 0x0, 0x0, 0x0, 0x0
.long 0x0, 0x0, 0x0, 0x0, 0x0, 0x0, 0x0, 0x0
.long 0x0, 0x0, 0x0, 0x0, 0x0, 0x0, 0x0, 0x0
.long 0x0, 0x0, 0x0, 0x0, 0x0, 0x0, 0x0, 0x0
.long 0x0, 0x0, 0x0, 0x0, 0x0, 0x0, 0x0, 0x0
.long 0x0, 0x0, 0x0, 0x0, 0x0, 0x0, 0x0, 0x0
.long 0x13320, 0xa9b0, 0xa800, 0x10c00, 0xf320, 0xc120, 0x133b0, 0xb690
.long 0xa890, 0x11920, 0xf3b0, 0xce00, 0x12600, 0xa920, 0xb520, 0x10c90
.long 0xe600, 0xc090, 0x12690, 0xb600, 0xb5b0, 0x119b0, 0xe690, 0xcdb0
.long 0xd5f0, 0x11440, 0x117f0, 0x130d0, 0xf8d0, 0xadf0, 0xd640, 0x12160
.long 0x11840, 0x13df0, 0xf960, 0xbad0, 0xc8d0, 0x113f0, 0x124d0, 0x13160
.long 0xebf0, 0xad60, 0xc960, 0x120d0, 0x12560, 0x13e40, 0xec40, 0xba40
.long 0xefb0, 0x10ed0, 0x117b0, 0x12a40, 0xfa90, 0xdb60, 0xc890, 0x10d60
.long 0x10a90, 0x129f0, 0x13bb0, 0xddf0, 0xf000, 0x11bf0, 0x11520, 0xe960
.long 0xc160, 0xf9b0, 0xc920, 0x11a40, 0x10800, 0xe8d0, 0xc3f0, 0x13a90
.long 0xce40, 0xfa00, 0xfff0, 0xbb20, 0xedb0, 0xdad0, 0xced0, 0x10720
.long 0x10040, 0xc800, 0x14890, 0xde40, 0xf560, 0xfbb0, 0x140d0, 0xbdb0
.long 0xb3f0, 0xec00, 0xf5f0, 0x10890, 0x14160, 0xca90, 0xb760, 0x14720
.long 0x13520, 0xddb0, 0xa520, 0xbe00, 0xf490, 0xe800, 0x13690, 0x10490
.long 0xa5b0, 0xcb20, 0xe7b0, 0x14d00, 0x12800, 0xdd20, 0xb200, 0xbe90
.long 0xf800, 0x14320, 0x129b0, 0x10400, 0xb290, 0xcbb0, 0xeb20, 0x14290
.long 0xd560, 0x10760, 0x112d0, 0xaed0, 0xfb60, 0xeed0, 0xd3f0, 0xe040
.long 0x11360, 0xbbf0, 0xee40, 0x14d00, 0xc840, 0x106d0, 0x11ff0, 0xaf60
.long 0xfed0, 0x149f0, 0xc6d0, 0xdff0, 0x12040, 0xbc40, 0xf1f0, 0x14960
.long 0xbbb0, 0x10cd0, 0xfdb0, 0x12960, 0xd3b0, 0xd9f0, 0x13090, 0x11160
.long 0x13e90, 0x12bf0, 0xbff0, 0xd290, 0xbc00, 0x119f0, 0xfb20, 0xe840
.long 0xac90, 0xd840, 0x13120, 0x11e40, 0x13c00, 0xead0, 0xbe40, 0xabb0
.long 0xcf60, 0x11400, 0x101f0, 0xef20, 0x12e90, 0xdd60, 0xccd0, 0xd320
.long 0x10560, 0x14a00, 0xb640, 0x12d20, 0xf640, 0x115b0, 0x142d0, 0xf1b0
.long 0x121b0, 0xdcd0, 0xf3f0, 0xd490, 0x14640, 0x14c90, 0xb5f0, 0x12000
.long 0x13600, 0xf7b0, 0xa490, 0xb120, 0x10d20, 0xc200, 0x135b0, 0xea90
.long 0xa400, 0x14d00, 0x10db0, 0xcf20, 0x12920, 0xf720, 0xaa00, 0x14000
.long 0x11a00, 0xc290, 0x12890, 0xea00, 0xb720, 0x14090, 0x11a90, 0xcfb0
.long 0xd4d0, 0xfa40, 0x11760, 0x123f0, 0x12cd0, 0xaff0, 0xd440, 0xed60
.long 0x116d0, 0x14d00, 0x12d60, 0xbcd0, 0xc7f0, 0xf9f0, 0x118d0, 0x14ad0
.long 0x139f0, 0xb040, 0xc760, 0xecd0, 0x125f0, 0x14b60, 0x13a40, 0xbd60
.long 0xe290, 0x10e40, 0xc9b0, 0x12760, 0xfe00, 0x13640, 0x10df0, 0xd5b0
.long 0xf090, 0x128d0, 0x13f20, 0x138d0, 0xe320, 0x11b60, 0x12640, 0xafb0
.long 0xfe90, 0x14360, 0x11ad0, 0xd600, 0xe560, 0xad20, 0x13fb0, 0x145f0
.long 0xe000, 0xcd60, 0x10920, 0x102d0, 0xa6d0, 0xebb0, 0xd040, 0x12e00
.long 0xfc00, 0x10240, 0xaa40, 0x14690, 0xe1b0, 0xf440, 0x103f0, 0x12320
.long 0xe7f0, 0xee00, 0xf760, 0x12fb0, 0x144d0, 0x125b0, 0xeb60, 0x14920
.long 0x13720, 0x111b0, 0xdb20, 0xf400, 0x11090, 0x11d20, 0x137b0, 0x11e90
.long 0xda90, 0xe720, 0x11db0, 0x14d00, 0x12a00, 0x11120, 0x10200, 0xf5b0
.long 0x11200, 0x14400, 0x12a90, 0x11e00, 0x101b0, 0xe890, 0x11f20, 0x14490
.long 0xd6d0, 0x12e40, 0x108d0, 0xfc40, 0x13240, 0x13ed0, 0xd760, 0x13b60
.long 0x10840, 0xef60, 0x13f60, 0x14d00, 0xc9f0, 0x12df0, 0xe1f0, 0xfad0
.long 0x132d0, 0x14bf0, 0xca40, 0x13ad0, 0xe160, 0xedf0, 0x13ff0, 0x14c40
.long 0x11690, 0x11040, 0xde90, 0xa640, 0x10b20, 0x136d0, 0x109b0, 0x10ff0
.long 0xa5f0, 0xd1b0, 0x10bb0, 0x143f0, 0x11720, 0x11d60, 0xdf20, 0xb360
.long 0xb000, 0x13360, 0x10a00, 0x11cd0, 0xb2d0, 0xd200, 0xb090, 0x14040
.long 0xcbf0, 0xb920, 0xe400, 0x13560, 0xa560, 0xc490, 0xcc40, 0xc600
.long 0x13840, 0x13200, 0xe640, 0xc720, 0xf2d0, 0xba90, 0xdfb0, 0xc040
.long 0xa8d0, 0x11fb0, 0xf360, 0xc7b0, 0xc360, 0x12db0, 0xe9f0, 0x12200
.long 0x13400, 0xc3b0, 0xdc00, 0x10e00, 0xbfb0, 0xcc00, 0x13490, 0xd090
.long 0xdc90, 0x11b20, 0xcc90, 0x14d00, 0x12720, 0xc320, 0x10320, 0x10fb0
.long 0xc400, 0x14120, 0x127b0, 0xd000, 0x103b0, 0x11c90, 0xd120, 0x141b0
.long 0xd1f0, 0xac40, 0x10ad0, 0x13040, 0xab60, 0xb7f0, 0xd240, 0xb960
.long 0x10b60, 0x13d60, 0xb840, 0x14d00, 0xc4d0, 0xabf0, 0xe3f0, 0x12ed0
.long 0xb0d0, 0x146d0, 0xc560, 0xb8d0, 0xe440, 0x13bf0, 0xbdf0, 0x14760
.long 0xfc90, 0x10f60, 0x11290, 0xa840, 0x13d20, 0x104d0, 0x13db0, 0x111f0
.long 0x105b0, 0xa7f0, 0x13c90, 0xf7f0, 0xfd20, 0x11c40, 0x11320, 0xb560
.long 0xae00, 0xff60, 0x13e00, 0x11ed0, 0x10600, 0xb4d0, 0xadb0, 0xf240
.long 0xcdf0, 0xed20, 0x133f0, 0xbd20, 0x12c40, 0x14bb0, 0xd160, 0x14800
.long 0x13440, 0xca00, 0x11f60, 0x14b20, 0xf4d0, 0xee90, 0xbed0, 0xb890
.long 0x12ad0, 0x12490, 0xf840, 0x149b0, 0xbf60, 0xc5b0, 0x11df0, 0x12400
.long 0x12bb0, 0x13800, 0xd920, 0xc000, 0x14600, 0x14d00, 0x13890, 0x14d00
.long 0xd9b0, 0xcd20, 0xc5f0, 0x14d00, 0x13920, 0x145b0, 0x10000, 0xc1b0
.long 0xb1b0, 0x14d00, 0x12c00, 0x14520, 0x10090, 0xce90, 0xfbf0, 0x14d00
.long 0xc640, 0xd2d0, 0x105f0, 0xae40, 0x14cd0, 0x14d00, 0xd360, 0x14d00
.long 0x10640, 0xbb60, 0xbf20, 0x14d00, 0xd7f0, 0x14840, 0xded0, 0xacd0
.long 0x10290, 0x14d00, 0xcad0, 0x147f0, 0xdf60, 0xb9f0, 0x11000, 0x14d00
.long 0x14a90, 0x11240, 0xf890, 0xa760, 0x14d00, 0xaad0, 0x123b0, 0x110d0
.long 0x139b0, 0xa9f0, 0x14d00, 0x12b20, 0x10c40, 0xae90, 0xf920, 0xb440
.long 0xe0d0, 0x14d00, 0x11960, 0xaf20, 0x13a00, 0xb6d0, 0x131f0, 0x14d00
.long 0x13b20, 0xd0d0, 0x135f0, 0xf120, 0x14d00, 0x12440, 0xac00, 0xcb60
.long 0x13960, 0x14c00, 0xf520, 0x14d00, 0xcff0, 0x12120, 0xc0d0, 0xec90
.long 0xda40, 0xe090, 0xf6d0, 0x12290, 0xc440, 0x147b0, 0x14d00, 0x14d00
.long 0xa600, 0xd800, 0xdbb0, 0x10120, 0x0, 0x0, 0xa7b0, 0xff20
.long 0xda00, 0x14d00, 0x0, 0x0, 0xb320, 0xd890, 0xde00, 0x14200
.long 0x0, 0x0, 0xb490, 0xffb0, 0x10520, 0x143b0, 0x0, 0x0
.long 0x11640, 0x109f0, 0x107f0, 0xe240, 0x0, 0x0, 0x114d0, 0xe2d0
.long 0x10960, 0x14d00, 0x0, 0x0, 0x12360, 0x10a40, 0x10bf0, 0x14a40
.long 0x0, 0x0, 0x121f0, 0xe360, 0xe4d0, 0x148d0, 0x0, 0x0
.long 0xbc90, 0x126d0, 0x12c90, 0xa960, 0x0, 0x0, 0x131b0, 0x12b60
.long 0xb7b0, 0xa4d0, 0x0, 0x0, 0xba00, 0xe5f0, 0xa440, 0xaa90
.long 0x0, 0x0, 0x12f20, 0xea40, 0xb160, 0xab20, 0x0, 0x0
.long 0x10360, 0x11600, 0xd720, 0x134d0, 0x0, 0x0, 0x100d0, 0xd520
.long 0x11800, 0x13760, 0x0, 0x0, 0x14440, 0x11890, 0x137f0, 0x12520
.long 0x0, 0x0, 0x141f0, 0xd7b0, 0xc2d0, 0x12090, 0x0, 0x0
.long 0xa720, 0xf200, 0xf600, 0x10f20, 0x0, 0x0, 0xa690, 0xe520
.long 0xf690, 0x11c00, 0x0, 0x0, 0xb400, 0xf290, 0xe920, 0x10e90
.long 0x0, 0x0, 0xb3b0, 0xe5b0, 0xe9b0, 0x11bb0, 0x0, 0x0
.long 0x115f0, 0xfcd0, 0xfdf0, 0x12ff0, 0x0, 0x0, 0x11560, 0xeff0
.long 0xfe40, 0x13cd0, 0x0, 0x0, 0x122d0, 0xfd60, 0xf0d0, 0x12f60
.long 0x0, 0x0, 0x12240, 0xf040, 0xf160, 0x13c40, 0x0, 0x0
.long 0xe3b0, 0x12840, 0x11490, 0xdc40, 0x0, 0x0, 0x127f0, 0xd690
.long 0x107b0, 0xdbf0, 0x0, 0x0, 0xe120, 0xe760, 0xc240, 0x113b0
.long 0x0, 0x0, 0xe6d0, 0xd400, 0xc1f0, 0x10690, 0x0, 0x0
.long 0xe200, 0x10160, 0xb9b0, 0xd8d0, 0x0, 0x0, 0x10440, 0x13000
.long 0xc690, 0xd960, 0x0, 0x0, 0xe490, 0x14240, 0xb1f0, 0xb800
.long 0x0, 0x0, 0x14560, 0x13290, 0xb240, 0xc520, 0x0, 0x0
.long 0x0, 0x0, 0x0, 0x0, 0x0, 0x0, 0x0, 0x0
.long 0x0, 0x0, 0x0, 0x0, 0x0, 0x0, 0x0, 0x0
.long 0x0, 0x0, 0x0, 0x0, 0x0, 0x0, 0x0, 0x0
.long 0x0, 0x0, 0x0, 0x0, 0x0, 0x0, 0x0, 0x0
.long 0x0, 0x0, 0x0, 0x0, 0x0, 0x0, 0x0, 0x0
.long 0x0, 0x0, 0x0, 0x0, 0x0, 0x0, 0x0, 0x0
.long 0x0, 0x0, 0x0, 0x0, 0x0, 0x0, 0x0, 0x0
.long 0x0, 0x0, 0x0, 0x0, 0x0, 0x0, 0x0, 0x0
.long 0x0, 0x0, 0x0, 0x0, 0x0, 0x0, 0x0, 0x0
.long 0x0, 0x0, 0x0, 0x0, 0x0, 0x0, 0x0, 0x0
.long 0x0, 0x0, 0x0, 0x0, 0x0, 0x0, 0x0, 0x0
.long 0x0, 0x0, 0x0, 0x0, 0x0, 0x0, 0x0, 0x0
.long 0x0, 0x0, 0x0, 0x0, 0x0, 0x0, 0x0, 0x0
.long 0x0, 0x0, 0x0, 0x0, 0x0, 0x0, 0x0, 0x0
.long 0x0, 0x0, 0x0, 0x0, 0x0, 0x0, 0x0, 0x0
.long 0x0, 0x0, 0x0, 0x0, 0x0, 0x0, 0x0, 0x0
.long 0x0, 0x0, 0x0, 0x0, 0x0, 0x0, 0x0, 0x0
.long 0x0, 0x0, 0x0, 0x0, 0x0, 0x0, 0x0, 0x0
.long 0x0, 0x0, 0x0, 0x0, 0x0, 0x0, 0x0, 0x0
.long 0x0, 0x0, 0x0, 0x0, 0x0, 0x0, 0x0, 0x0
.long 0x0, 0x0, 0x0, 0x0, 0x0, 0x0, 0x0, 0x0
.long 0x0, 0x0, 0x0, 0x0, 0x0, 0x0, 0x0, 0x0
.long 0x0, 0x0, 0x0, 0x0, 0x0, 0x0, 0x0, 0x0
.long 0x0, 0x0, 0x0, 0x0, 0x0, 0x0, 0x0, 0x0
.long 0x0, 0x0, 0x0, 0x0, 0x0, 0x0, 0x0, 0x0
.long 0x0, 0x0, 0x0, 0x0, 0x0, 0x0, 0x0, 0x0
.long 0x0, 0x0, 0x0, 0x0, 0x0, 0x0, 0x0, 0x0
.long 0x0, 0x0, 0x0, 0x0, 0x0, 0x0, 0x0, 0x0
.long 0x0, 0x0, 0x0, 0x0, 0x0, 0x0, 0x0, 0x0
.long 0x0, 0x0, 0x0, 0x0, 0x0, 0x0, 0x0, 0x0
.long 0x0, 0x0, 0x0, 0x0, 0x0, 0x0, 0x0, 0x0
.long 0x0, 0x0, 0x0, 0x0, 0x0, 0x0, 0x0, 0x0
.section .rodata,"a"
.p2align 6
.amdhsa_kernel standalone__deep_cross_xdeepfm__recsys_kernel
  .amdhsa_next_free_vgpr 256
  .amdhsa_next_free_sgpr 102
  .amdhsa_accum_offset 256
  .amdhsa_group_segment_fixed_size 0
  .amdhsa_kernarg_size 88
  .amdhsa_user_sgpr_count 2
  .amdhsa_user_sgpr_kernarg_segment_ptr 1
  .amdhsa_system_sgpr_workgroup_id_x 1
  .amdhsa_float_denorm_mode_32 3
.end_amdhsa_kernel
```

```asm
; @launch grid=(256,1,1) block=(512,1,1) lds=163840
.amdgcn_target "amdgcn-amd-amdhsa--gfx950"
.text
.globl standalone__deep_cross_xdeepfm__recsys_kernel
.p2align 8
.type standalone__deep_cross_xdeepfm__recsys_kernel,@function
standalone__deep_cross_xdeepfm__recsys_kernel:
  s_cmp_ge_u32 s2, 256
  s_cbranch_scc1 L_end
  s_load_dwordx16 s[4:19], s[0:1], 0
  s_load_dwordx4 s[20:23], s[0:1], 64
  s_load_dwordx2 s[24:25], s[0:1], 80
  v_lshrrev_b32 v1, 6, v0
  s_getpc_b64 s[92:93]
L_pc:
  s_and_b32 s68, s2, 0xf8
  v_add_u32 v2, s68, v1
  v_and_b32_e64 v3, 32, v0
  v_lshl_add_u32 v2, v3, 3, v2
  v_lshlrev_b32 v2, 7, v2
  v_min_u32 v2, L_end-L_pc, v2
  v_mov_b32 v3, s93
  v_add_co_u32 v2, vcc, s92, v2
  s_nop 1
  v_addc_co_u32 v3, vcc, 0, v3, vcc
  global_load_dword v251, v[2:3], off
  v_and_b32 v0, 63, v0
  v_readfirstlane_b32 s3, v1
  s_and_b32 s68, s2, 7
  s_lshr_b32 s69, s2, 3
  s_xor_b32 s69, s69, 31
  s_and_b32 s80, s2, 0xf8
  s_add_u32 s80, s80, s3
  s_lshl_b32 s80, s80, 0
  s_min_u32 s70, s68, 1
  s_add_u32 s71, s69, s70
  s_cmp_ge_u32 s71, 22
  s_cbranch_scc1 L_cin
  s_mul_i32 s68, s68, 21
  s_add_u32 s68, s68, s71
  s_mul_i32 s26, s68, 5042
  s_lshr_b32 s26, s26, 16
  s_mul_i32 s69, s26, 13
  s_sub_u32 s27, s68, s69
  s_lshl_b32 s77, s27, 8
  s_mul_i32 s71, s26, 320
  v_lshrrev_b32 v116, 4, v0
  v_lshlrev_b32 v11, 4, v0
  s_and_b32 s79, s3, 3
  s_cmp_ge_u32 s3, 4
  s_cbranch_scc1 L_ld
  s_mul_i32 s70, s3, 13
  v_min_u32 v118, 12, v0
  v_add_u32 v118, s70, v118
  v_lshrrev_b32 v117, 1, v118
  v_mul_u32_u24 v117, 96, v117
  v_lshl_add_u32 v118, v118, 2, v117
  s_mul_i32 s78, s27, 25
  s_min_u32 s78, s78, 294
  s_add_u32 s78, s78, s71
  s_mul_i32 s78, s78, 104
  s_lshl_b32 s70, s26, 2
  s_add_u32 s70, s70, s3
  s_add_u32 s70, s70, 64
  s_mul_i32 s70, s70, 3328
  s_add_u32 s70, s70, s77
  s_mov_b32 s81, 173056
  v_lshrrev_b32 v112, 1, v0
  v_mul_lo_u32 v112, s81, v112
  v_and_b32 v117, 1, v0
  v_lshl_add_u32 v112, v117, 7, v112
  v_add_u32_e64 v112, s70, v112
  s_waitcnt lgkmcnt(0)
  s_mov_b32 s28, s4
  s_and_b32 s29, s5, 0xffff
  s_mov_b32 s30, 425984
  s_mov_b32 s31, 0x20000
  buffer_load_dwordx4 v[100:103], v118, s[28:31], s78 offen
  s_mov_b32 s32, s6
  s_and_b32 s33, s7, 0xffff
  s_mov_b32 s34, 12800000
  s_mov_b32 s35, 0x20000
  s_mov_b32 s48, s14
  s_and_b32 s49, s15, 0xffff
  s_mov_b32 s50, 3328
  s_mov_b32 s51, 0x20000
  s_mov_b32 m0, 122880
  s_mov_b64 exec, 0xffff
  buffer_load_dwordx4 v11, s[48:51], s77 offen lds
  s_mov_b64 exec, -1
  s_mov_b32 s44, s12
  s_and_b32 s45, s13, 0xffff
  s_mov_b32 s46, 5537792
  s_mov_b32 s47, 0x20000
  s_mov_b64 exec, 255
  buffer_load_dword v209, v112, s[44:47], 0 offen
  s_mov_b64 exec, -1
  s_barrier
  s_branch L_cmp
L_ld:
  s_lshr_b32 s68, s79, 1
  s_mul_i32 s68, s68, 20
  s_and_b32 s69, s79, 1
  s_add_u32 s68, s68, s69
  s_lshl_b32 s76, s68, 10
  s_mul_i32 s78, s71, 104
  s_mul_i32 s68, s68, 832
  s_add_u32 s94, s78, s68
  v_mul_u32_u24 v118, 48, v116
  v_sub_u32 v12, v11, v118
  s_add_u32 s95, s94, 3328
  s_add_u32 s96, s94, 6656
  s_add_u32 s97, s94, 9984
  s_add_u32 s98, s94, 13312
  s_and_b32 s70, s79, 1
  s_lshl_b32 s70, s70, 3
  v_lshlrev_b32 v117, 1, v116
  v_or_b32 v117, s70, v117
  v_xor_b32 v117, v117, v0
  v_and_b32 v117, 15, v117
  v_mul_u32_u24 v4, 3328, v116
  v_lshl_add_u32 v4, v117, 4, v4
  v_add_u32 v5, 13312, v4
  s_mul_i32 s74, s79, 26624
  s_add_u32 s74, s74, s77
  s_lshl_b32 s75, s79, 11
  s_waitcnt lgkmcnt(0)
  s_mov_b32 s28, s4
  s_and_b32 s29, s5, 0xffff
  s_mov_b32 s30, 425984
  s_mov_b32 s31, 0x20000
  buffer_load_dwordx4 v[16:19], v12, s[28:31], s94 offen offset:0
  s_mov_b32 s32, s6
  s_and_b32 s33, s7, 0xffff
  s_mov_b32 s34, 12800000
  s_mov_b32 s35, 0x20000
  s_mov_b32 s44, s12
  s_and_b32 s45, s13, 0xffff
  s_mov_b32 s46, 5537792
  s_mov_b32 s47, 0x20000
  s_add_u32 m0, s75, 131072
  s_nop 0
  buffer_load_dwordx4 v4, s[44:47], s74 offen lds
  s_add_u32 m0, s75, 132096
  s_nop 0
  buffer_load_dwordx4 v5, s[44:47], s74 offen lds
  s_add_u32 s74, s74, 106496
  s_add_u32 m0, s75, 139264
  s_nop 0
  buffer_load_dwordx4 v4, s[44:47], s74 offen lds
  s_add_u32 m0, s75, 140288
  s_nop 0
  buffer_load_dwordx4 v5, s[44:47], s74 offen lds
  s_add_u32 s74, s74, 106496
  s_barrier
  buffer_load_dwordx4 v[20:23], v12, s[28:31], s94 offen offset:1664
  buffer_load_dwordx4 v[24:27], v12, s[28:31], s95 offen offset:0
  buffer_load_dwordx4 v[28:31], v12, s[28:31], s95 offen offset:1664
  buffer_load_dwordx4 v[32:35], v12, s[28:31], s96 offen offset:0
  buffer_load_dwordx4 v[36:39], v12, s[28:31], s96 offen offset:1664
  buffer_load_dwordx4 v[40:43], v12, s[28:31], s97 offen offset:0
  buffer_load_dwordx4 v[44:47], v12, s[28:31], s97 offen offset:1664
  buffer_load_dwordx4 v[48:51], v12, s[28:31], s98 offen offset:0
  buffer_load_dwordx4 v[52:55], v12, s[28:31], s98 offen offset:1664
  s_lshl_b32 s70, s69, 6
  v_and_b32 v118, 7, v0
  v_xor_b32 v118, v118, v116
  v_lshlrev_b32 v118, 4, v118
  v_xor_b32 v2, s70, v118
  v_xor_b32 v3, 64, v2
  s_mov_b32 s72, 0
  s_mul_i32 s70, s79, 13
  s_add_u32 s70, s70, s27
  s_min_u32 s70, s70, 39
  s_lshl_b32 s70, s70, 3
  s_add_u32 s70, s70, s71
  s_mul_i32 s84, s70, 104
  v_lshrrev_b32 v118, 2, v0
  v_min_u32 v118, 7, v118
  v_mul_u32_u24 v118, 104, v118
  v_and_b32 v117, 3, v0
  v_lshl_add_u32 v7, v117, 2, v118
  s_lshl_b32 s70, s26, 2
  s_add_u32 s70, s70, s79
  s_add_u32 s70, s70, 256
  s_mul_i32 s85, s70, 3328
  s_add_u32 s85, s85, s77
  s_mov_b32 s70, 173056
  v_lshrrev_b32 v118, 1, v0
  v_mul_lo_u32 v118, s70, v118
  v_and_b32 v117, 1, v0
  v_lshl_add_u32 v84, v117, 7, v118
  s_mov_b32 s52, s16
  s_and_b32 s53, s17, 0xffff
  s_mov_b32 s54, 3328
  s_mov_b32 s55, 0x20000
  s_mul_i32 s70, s79, 2560
  s_add_u32 s70, s70, L_tail-L_pc
  v_lshlrev_b32 v8, 7, v0
  v_add_u32 v8, s70, v8
  v_mov_b32 v9, s93
  v_add_co_u32 v8, vcc, s92, v8
  s_nop 1
  v_addc_co_u32 v9, vcc, 0, v9, vcc
  s_waitcnt vmcnt(13)
  v_lshlrev_b32 v16, 7, v16
  v_lshlrev_b32 v18, 7, v18
  v_lshlrev_b32 v17, 7, v17
  v_lshlrev_b32 v19, 7, v19
  v_add_u32_dpp v56, v16, v2 row_newbcast:0 row_mask:0xf bank_mask:0x3
  s_nop 1
  v_add_u32_dpp v56, v18, v2 row_newbcast:6 row_mask:0xf bank_mask:0xc
  s_add_u32 m0, s76, 0
  s_nop 0
  buffer_load_dwordx4 v56, s[32:35], 0 offen lds
  s_waitcnt vmcnt(10)
  s_barrier
  s_waitcnt vmcnt(9)
  v_lshlrev_b32 v20, 7, v20
  v_lshlrev_b32 v22, 7, v22
  v_lshlrev_b32 v21, 7, v21
  v_lshlrev_b32 v23, 7, v23
  v_add_u32_dpp v57, v20, v2 row_newbcast:0 row_mask:0xf bank_mask:0x3
  s_nop 1
  v_add_u32_dpp v57, v22, v2 row_newbcast:6 row_mask:0xf bank_mask:0xc
  s_add_u32 m0, s76, 2048
  s_nop 0
  buffer_load_dwordx4 v57, s[32:35], 0 offen lds
  s_waitcnt vmcnt(9)
  v_lshlrev_b32 v24, 7, v24
  v_lshlrev_b32 v26, 7, v26
  v_lshlrev_b32 v25, 7, v25
  v_lshlrev_b32 v27, 7, v27
  v_add_u32_dpp v58, v24, v2 row_newbcast:0 row_mask:0xf bank_mask:0x3
  s_nop 1
  v_add_u32_dpp v58, v26, v2 row_newbcast:6 row_mask:0xf bank_mask:0xc
  s_add_u32 m0, s76, 4096
  s_nop 0
  buffer_load_dwordx4 v58, s[32:35], 0 offen lds
  s_waitcnt vmcnt(9)
  v_lshlrev_b32 v28, 7, v28
  v_lshlrev_b32 v30, 7, v30
  v_lshlrev_b32 v29, 7, v29
  v_lshlrev_b32 v31, 7, v31
  v_add_u32_dpp v59, v28, v2 row_newbcast:0 row_mask:0xf bank_mask:0x3
  s_nop 1
  v_add_u32_dpp v59, v30, v2 row_newbcast:6 row_mask:0xf bank_mask:0xc
  s_add_u32 m0, s76, 6144
  s_nop 0
  buffer_load_dwordx4 v59, s[32:35], 0 offen lds
  s_waitcnt vmcnt(9)
  v_lshlrev_b32 v32, 7, v32
  v_lshlrev_b32 v34, 7, v34
  v_lshlrev_b32 v33, 7, v33
  v_lshlrev_b32 v35, 7, v35
  v_add_u32_dpp v60, v32, v2 row_newbcast:0 row_mask:0xf bank_mask:0x3
  s_nop 1
  v_add_u32_dpp v60, v34, v2 row_newbcast:6 row_mask:0xf bank_mask:0xc
  s_add_u32 m0, s76, 8192
  s_nop 0
  buffer_load_dwordx4 v60, s[32:35], 0 offen lds
  s_waitcnt vmcnt(9)
  v_lshlrev_b32 v36, 7, v36
  v_lshlrev_b32 v38, 7, v38
  v_lshlrev_b32 v37, 7, v37
  v_lshlrev_b32_e64 v39, 7, v39
  v_add_u32_dpp v61, v36, v2 row_newbcast:0 row_mask:0xf bank_mask:0x3
  s_nop 1
  v_add_u32_dpp v61, v38, v2 row_newbcast:6 row_mask:0xf bank_mask:0xc
  s_add_u32 m0, s76, 10240
  s_nop 0
  buffer_load_dwordx4 v61, s[32:35], 0 offen lds
  s_waitcnt vmcnt(9)
  v_lshlrev_b32 v40, 7, v40
  v_lshlrev_b32 v42, 7, v42
  v_lshlrev_b32 v41, 7, v41
  v_lshlrev_b32_e64 v43, 7, v43
  v_add_u32_dpp v62, v40, v2 row_newbcast:0 row_mask:0xf bank_mask:0x3
  s_nop 1
  v_add_u32_dpp v62, v42, v2 row_newbcast:6 row_mask:0xf bank_mask:0xc
  s_add_u32 m0, s76, 12288
  s_nop 0
  buffer_load_dwordx4 v62, s[32:35], 0 offen lds
  s_waitcnt vmcnt(9)
  v_lshlrev_b32 v44, 7, v44
  v_lshlrev_b32 v46, 7, v46
  v_lshlrev_b32 v45, 7, v45
  v_lshlrev_b32_e64 v47, 7, v47
  v_add_u32_dpp v63, v44, v2 row_newbcast:0 row_mask:0xf bank_mask:0x3
  s_nop 1
  v_add_u32_dpp v63, v46, v2 row_newbcast:6 row_mask:0xf bank_mask:0xc
  s_add_u32 m0, s76, 14336
  s_nop 0
  buffer_load_dwordx4 v63, s[32:35], 0 offen lds
  s_waitcnt vmcnt(9)
  v_lshlrev_b32 v48, 7, v48
  v_lshlrev_b32 v50, 7, v50
  v_lshlrev_b32 v49, 7, v49
  v_lshlrev_b32_e64 v51, 7, v51
  v_add_u32_dpp v64, v48, v2 row_newbcast:0 row_mask:0xf bank_mask:0x3
  s_nop 1
  v_add_u32_dpp v64, v50, v2 row_newbcast:6 row_mask:0xf bank_mask:0xc
  s_add_u32 m0, s76, 16384
  s_nop 0
  buffer_load_dwordx4 v64, s[32:35], 0 offen lds
  s_waitcnt vmcnt(9)
  v_lshlrev_b32 v52, 7, v52
  v_lshlrev_b32 v54, 7, v54
  v_lshlrev_b32 v53, 7, v53
  v_lshlrev_b32_e64 v55, 7, v55
  v_add_u32_dpp v65, v52, v2 row_newbcast:0 row_mask:0xf bank_mask:0x3
  s_nop 1
  v_add_u32_dpp v65, v54, v2 row_newbcast:6 row_mask:0xf bank_mask:0xc
  s_add_u32 m0, s76, 18432
  s_nop 0
  buffer_load_dwordx4 v65, s[32:35], 0 offen lds
  v_add_u32_dpp v56, v17, v2 row_newbcast:0 row_mask:0xf bank_mask:0x3
  s_nop 1
  v_add_u32_dpp v56, v19, v2 row_newbcast:6 row_mask:0xf bank_mask:0xc
  s_add_u32 m0, s76, 40960
  s_nop 0
  buffer_load_dwordx4 v56, s[32:35], 0 offen lds
  v_add_u32_dpp v57, v21, v2 row_newbcast:0 row_mask:0xf bank_mask:0x3
  s_nop 1
  v_add_u32_dpp v57, v23, v2 row_newbcast:6 row_mask:0xf bank_mask:0xc
  s_add_u32 m0, s76, 43008
  s_nop 0
  buffer_load_dwordx4 v57, s[32:35], 0 offen lds
  v_add_u32_dpp v58, v25, v2 row_newbcast:0 row_mask:0xf bank_mask:0x3
  s_nop 1
  v_add_u32_dpp v58, v27, v2 row_newbcast:6 row_mask:0xf bank_mask:0xc
  s_add_u32 m0, s76, 45056
  s_nop 0
  buffer_load_dwordx4 v58, s[32:35], 0 offen lds
  v_add_u32_dpp v59, v29, v2 row_newbcast:0 row_mask:0xf bank_mask:0x3
  s_nop 1
  v_add_u32_dpp v59, v31, v2 row_newbcast:6 row_mask:0xf bank_mask:0xc
  s_add_u32 m0, s76, 47104
  s_nop 0
  buffer_load_dwordx4 v59, s[32:35], 0 offen lds
  v_add_u32_dpp v60, v33, v2 row_newbcast:0 row_mask:0xf bank_mask:0x3
  s_nop 1
  v_add_u32_dpp v60, v35, v2 row_newbcast:6 row_mask:0xf bank_mask:0xc
  s_add_u32 m0, s76, 49152
  s_nop 0
  buffer_load_dwordx4 v60, s[32:35], 0 offen lds
  s_waitcnt vmcnt(11)
  s_barrier
  v_add_u32_dpp v61, v37, v2 row_newbcast:0 row_mask:0xf bank_mask:0x3
  s_nop 1
  v_add_u32_dpp v61, v39, v2 row_newbcast:6 row_mask:0xf bank_mask:0xc
  s_add_u32 m0, s76, 51200
  s_nop 0
  buffer_load_dwordx4 v61, s[32:35], 0 offen lds
  v_add_u32_dpp v62, v41, v2 row_newbcast:0 row_mask:0xf bank_mask:0x3
  s_nop 1
  v_add_u32_dpp v62, v43, v2 row_newbcast:6 row_mask:0xf bank_mask:0xc
  s_add_u32 m0, s76, 53248
  s_nop 0
  buffer_load_dwordx4 v62, s[32:35], 0 offen lds
  v_add_u32_dpp v63, v45, v2 row_newbcast:0 row_mask:0xf bank_mask:0x3
  s_nop 1
  v_add_u32_dpp v63, v47, v2 row_newbcast:6 row_mask:0xf bank_mask:0xc
  s_add_u32 m0, s76, 55296
  s_nop 0
  buffer_load_dwordx4 v63, s[32:35], 0 offen lds
  v_add_u32_dpp v64, v49, v2 row_newbcast:0 row_mask:0xf bank_mask:0x3
  s_nop 1
  v_add_u32_dpp v64, v51, v2 row_newbcast:6 row_mask:0xf bank_mask:0xc
  s_add_u32 m0, s76, 57344
  s_nop 0
  buffer_load_dwordx4 v64, s[32:35], 0 offen lds
  v_add_u32_dpp v65, v53, v2 row_newbcast:0 row_mask:0xf bank_mask:0x3
  s_nop 1
  v_add_u32_dpp v65, v55, v2 row_newbcast:6 row_mask:0xf bank_mask:0xc
  s_add_u32 m0, s76, 59392
  s_nop 0
  buffer_load_dwordx4 v65, s[32:35], 0 offen lds
  s_waitcnt vmcnt(10)
  s_barrier
  s_add_u32 m0, s75, 147456
  s_nop 0
  buffer_load_dwordx4 v4, s[44:47], s74 offen lds
  s_add_u32 m0, s75, 148480
  s_nop 0
  buffer_load_dwordx4 v5, s[44:47], s74 offen lds
  s_add_u32 s74, s74, 106496
  s_add_u32 m0, s75, 155648
  s_nop 0
  buffer_load_dwordx4 v4, s[44:47], s74 offen lds
  s_add_u32 m0, s75, 156672
  s_nop 0
  buffer_load_dwordx4 v5, s[44:47], s74 offen lds
  s_add_u32 s74, s74, 106496
  v_add_u32_dpp v56, v18, v2 row_newbcast:0 row_mask:0xf bank_mask:0x3
  v_add_u32_dpp v57, v22, v2 row_newbcast:0 row_mask:0xf bank_mask:0x3
  v_add_u32_dpp v58, v26, v2 row_newbcast:0 row_mask:0xf bank_mask:0x3
  v_add_u32_dpp v59, v30, v2 row_newbcast:0 row_mask:0xf bank_mask:0x3
  v_add_u32_dpp v60, v34, v2 row_newbcast:0 row_mask:0xf bank_mask:0x3
  v_add_u32_dpp v61, v38, v2 row_newbcast:0 row_mask:0xf bank_mask:0x3
  v_add_u32_dpp v62, v42, v2 row_newbcast:0 row_mask:0xf bank_mask:0x3
  v_add_u32_dpp v63, v46, v2 row_newbcast:0 row_mask:0xf bank_mask:0x3
  v_add_u32_dpp v64, v50, v2 row_newbcast:0 row_mask:0xf bank_mask:0x3
  v_add_u32_dpp v65, v54, v2 row_newbcast:0 row_mask:0xf bank_mask:0x3
  v_add_u32_dpp v56, v16, v2 row_newbcast:7 row_mask:0xf bank_mask:0xc
  v_add_u32_dpp v57, v20, v2 row_newbcast:7 row_mask:0xf bank_mask:0xc
  v_add_u32_dpp v58, v24, v2 row_newbcast:7 row_mask:0xf bank_mask:0xc
  v_add_u32_dpp v59, v28, v2 row_newbcast:7 row_mask:0xf bank_mask:0xc
  v_add_u32_dpp v60, v32, v2 row_newbcast:7 row_mask:0xf bank_mask:0xc
  v_add_u32_dpp v61, v36, v2 row_newbcast:7 row_mask:0xf bank_mask:0xc
  v_add_u32_dpp v62, v40, v2 row_newbcast:7 row_mask:0xf bank_mask:0xc
  v_add_u32_dpp v63, v44, v2 row_newbcast:7 row_mask:0xf bank_mask:0xc
  v_add_u32_dpp v64, v48, v2 row_newbcast:7 row_mask:0xf bank_mask:0xc
  v_add_u32_dpp v65, v52, v2 row_newbcast:7 row_mask:0xf bank_mask:0xc
  buffer_load_dword v70, v7, s[28:31], s84 offen offset:32
  buffer_load_dword v71, v7, s[28:31], s84 offen offset:48
  buffer_load_dword v72, v7, s[28:31], s84 offen offset:64
  buffer_load_dword v73, v7, s[28:31], s84 offen offset:80
  buffer_load_dword v74, v7, s[28:31], s84 offen offset:88
  s_add_u32 m0, s76, 81920
  s_nop 0
  buffer_load_dwordx4 v56, s[32:35], 0 offen lds
  s_add_u32 m0, s76, 83968
  s_nop 0
  buffer_load_dwordx4 v57, s[32:35], 0 offen lds
  s_add_u32 m0, s76, 86016
  s_nop 0
  buffer_load_dwordx4 v58, s[32:35], 0 offen lds
  s_add_u32 m0, s76, 88064
  s_nop 0
  buffer_load_dwordx4 v59, s[32:35], 0 offen lds
  s_add_u32 m0, s76, 90112
  s_nop 0
  buffer_load_dwordx4 v60, s[32:35], 0 offen lds
  s_add_u32 m0, s76, 92160
  s_nop 0
  buffer_load_dwordx4 v61, s[32:35], 0 offen lds
  s_add_u32 m0, s76, 94208
  s_nop 0
  buffer_load_dwordx4 v62, s[32:35], 0 offen lds
  s_add_u32 m0, s76, 96256
  s_nop 0
  buffer_load_dwordx4 v63, s[32:35], 0 offen lds
  s_waitcnt vmcnt(13)
  s_barrier
  s_add_u32 m0, s76, 98304
  s_nop 0
  buffer_load_dwordx4 v64, s[32:35], 0 offen lds
  s_add_u32 m0, s76, 100352
  s_nop 0
  buffer_load_dwordx4 v65, s[32:35], 0 offen lds
  v_add_u32_dpp v56, v19, v2 row_newbcast:0 row_mask:0xf bank_mask:0x3
  v_add_u32_dpp v57, v23, v2 row_newbcast:0 row_mask:0xf bank_mask:0x3
  v_add_u32_dpp v58, v27, v2 row_newbcast:0 row_mask:0xf bank_mask:0x3
  v_add_u32_dpp v59, v31, v2 row_newbcast:0 row_mask:0xf bank_mask:0x3
  v_add_u32_dpp v60, v35, v2 row_newbcast:0 row_mask:0xf bank_mask:0x3
  v_add_u32_dpp v61, v39, v2 row_newbcast:0 row_mask:0xf bank_mask:0x3
  v_add_u32_dpp v62, v43, v2 row_newbcast:0 row_mask:0xf bank_mask:0x3
  v_add_u32_dpp v63, v47, v2 row_newbcast:0 row_mask:0xf bank_mask:0x3
  v_add_u32_dpp v64, v51, v2 row_newbcast:0 row_mask:0xf bank_mask:0x3
  v_add_u32_dpp v65, v55, v2 row_newbcast:0 row_mask:0xf bank_mask:0x3
  v_add_u32_dpp v56, v17, v2 row_newbcast:7 row_mask:0xf bank_mask:0xc
  v_add_u32_dpp v57, v21, v2 row_newbcast:7 row_mask:0xf bank_mask:0xc
  v_add_u32_dpp v58, v25, v2 row_newbcast:7 row_mask:0xf bank_mask:0xc
  v_add_u32_dpp v59, v29, v2 row_newbcast:7 row_mask:0xf bank_mask:0xc
  v_add_u32_dpp v60, v33, v2 row_newbcast:7 row_mask:0xf bank_mask:0xc
  v_add_u32_dpp v61, v37, v2 row_newbcast:7 row_mask:0xf bank_mask:0xc
  v_add_u32_dpp v62, v41, v2 row_newbcast:7 row_mask:0xf bank_mask:0xc
  v_add_u32_dpp v63, v45, v2 row_newbcast:7 row_mask:0xf bank_mask:0xc
  v_add_u32_dpp v64, v49, v2 row_newbcast:7 row_mask:0xf bank_mask:0xc
  v_add_u32_dpp v65, v53, v2 row_newbcast:7 row_mask:0xf bank_mask:0xc
  s_setprio 0
  s_branch L_ld_in
L_cmp:
  s_and_b32 s68, s3, 1
  s_lshr_b32 s69, s3, 1
  v_bfe_u32 v117, v0, 2, 2
  v_lshl_add_u32 v118, v116, 3, v117
  v_lshlrev_b32 v118, 8, v118
  v_bfe_u32 v117, v0, 2, 3
  s_lshl_b32 s70, s69, 2
  v_xor_b32 v117, s70, v117
  v_lshl_add_u32 v118, v117, 5, v118
  v_and_b32 v117, 3, v0
  v_lshl_add_u32 v118, v117, 3, v118
  v_add_u32 v1, 131072, v118
  v_xor_b32 v2, 32, v1
  v_xor_b32 v3, 64, v1
  v_xor_b32 v4, 96, v1
  s_lshl_b32 s70, s69, 7
  s_add_u32 s70, s70, 122880
  v_lshlrev_b32 v118, 3, v116
  v_add_u32 v9, s70, v118
  v_and_b32 v118, 15, v0
  v_lshlrev_b32 v118, 7, v118
  v_bfe_u32 v117, v0, 1, 3
  v_xor_b32 v117, v117, v116
  v_lshl_add_u32 v118, v117, 4, v118
  s_mul_i32 s70, s68, 20480
  v_add_u32 v5, s70, v118
  v_xor_b32 v7, 64, v5
  v_add_u32 v6, 81920, v5
  v_add_u32 v8, 81920, v7
  s_mul_i32 s70, s3, 640
  s_add_u32 s70, s70, 123392
  v_and_b32 v118, 15, v0
  v_lshlrev_b32 v118, 2, v118
  v_add_u32 v118, s70, v118
  v_lshrrev_b32 v117, 5, v0
  v_lshl_add_u32 v118, v117, 6, v118
  v_bfe_u32 v117, v0, 4, 1
  v_lshl_add_u32 v10, v117, 7, v118
  s_mov_b32 s72, 0
  v_mov_b32 v12, 0xc0135761
  v_mov_b32 v13, 0xc0135761
  v_mov_b32 v14, 0xbdd2d3e8
  v_mov_b32 v15, 0xbdd2d3e8
  s_waitcnt vmcnt(2)
  v_lshlrev_b32 v100, 7, v100
  buffer_load_dword v200, v100, s[32:35], 0 offen
  v_lshlrev_b32 v102, 7, v102
  buffer_load_dword v202, v102, s[32:35], 0 offen
  s_barrier
  ds_read_b64_tr_b16 v[16:17], v1 offset:0
  ds_read_b64_tr_b16 v[18:19], v1 offset:1024
  ds_read_b64_tr_b16 v[32:33], v1 offset:8192
  ds_read_b64_tr_b16 v[34:35], v1 offset:9216
  ds_read_b64_tr_b16 v[20:21], v2 offset:0
  ds_read_b64_tr_b16 v[22:23], v2 offset:1024
  ds_read_b64_tr_b16 v[36:37], v2 offset:8192
  ds_read_b64_tr_b16 v[38:39], v2 offset:9216
  ds_read_b64_tr_b16 v[24:25], v3 offset:0
  ds_read_b64_tr_b16 v[26:27], v3 offset:1024
  ds_read_b64_tr_b16 v[40:41], v3 offset:8192
  ds_read_b64_tr_b16 v[42:43], v3 offset:9216
  ds_read_b64_tr_b16 v[28:29], v4 offset:0
  ds_read_b64_tr_b16 v[30:31], v4 offset:1024
  ds_read_b64_tr_b16 v[44:45], v4 offset:8192
  ds_read_b64_tr_b16 v[46:47], v4 offset:9216
  s_waitcnt vmcnt(3)
  ds_read_b64 v[234:235], v9 offset:0
  ds_read_b64 v[238:239], v9 offset:32
  ds_read_b64 v[242:243], v9 offset:64
  ds_read_b64 v[246:247], v9 offset:96
  s_waitcnt lgkmcnt(3)
  v_lshlrev_b32 v232, 16, v234
  v_and_b32 v233, 0xffff0000, v234
  v_lshlrev_b32 v234, 16, v235
  v_and_b32 v235, 0xffff0000, v235
  s_waitcnt lgkmcnt(2)
  v_lshlrev_b32 v236, 16, v238
  v_and_b32 v237, 0xffff0000, v238
  v_lshlrev_b32 v238, 16, v239
  v_and_b32 v239, 0xffff0000, v239
  s_waitcnt lgkmcnt(1)
  v_lshlrev_b32 v240, 16, v242
  v_and_b32 v241, 0xffff0000, v242
  v_lshlrev_b32_e64 v242, 16, v243
  v_and_b32 v243, 0xffff0000, v243
  s_waitcnt lgkmcnt(0)
  v_lshlrev_b32 v244, 16, v246
  v_and_b32 v245, 0xffff0000, v246
  v_lshlrev_b32 v246, 16, v247
  v_and_b32 v247, 0xffff0000, v247
  v_mov_b64 v[216:217], v[232:233]
  v_mov_b64 v[218:219], v[234:235]
  v_mov_b64 v[220:221], v[236:237]
  v_mov_b64 v[222:223], v[238:239]
  v_mov_b64 v[224:225], v[240:241]
  v_mov_b64 v[226:227], v[242:243]
  v_mov_b64 v[228:229], v[244:245]
  v_mov_b64 v[230:231], v[246:247]
  s_waitcnt lgkmcnt(0)
  s_setprio 1
  s_barrier
  ds_read_b128 v[48:51], v5 offset:0
  ds_read_b128 v[52:55], v7 offset:0
  ds_read_b128 v[56:59], v5 offset:2048
  ds_read_b128 v[60:63], v7 offset:2048
  ds_read_b128 v[64:67], v5 offset:4096
  ds_read_b128 v[68:71], v7 offset:4096
  ds_read_b128 v[72:75], v5 offset:6144
  ds_read_b128 v[76:79], v7 offset:6144
  s_waitcnt lgkmcnt(7)
  v_mfma_f32_16x16x32_bf16 v[88:91], v[16:19], v[48:51], v[232:235]
  s_waitcnt lgkmcnt(4)
  v_mfma_f32_16x16x32_bf16 v[88:91], v[32:35], v[52:55], v[88:91]
  v_mfma_f32_16x16x32_bf16 v[104:107], v[32:35], v[60:63], v[232:235]
  v_mfma_f32_16x16x32_bf16 v[104:107], v[16:19], v[56:59], v[104:107]
  v_mfma_f32_16x16x32_bf16 v[108:111], v[20:23], v[56:59], v[236:239]
  v_mfma_f32_16x16x32_bf16 v[108:111], v[36:39], v[60:63], v[108:111]
  v_mfma_f32_16x16x32_bf16 v[92:95], v[36:39], v[52:55], v[236:239]
  v_mfma_f32_16x16x32_bf16 v[92:95], v[20:23], v[48:51], v[92:95]
  v_mfma_f32_16x16x32_bf16 v[96:99], v[24:27], v[48:51], v[240:243]
  v_xor_b32 v1, 16384, v1
  v_mfma_f32_16x16x32_bf16 v[96:99], v[40:43], v[52:55], v[96:99]
  v_xor_b32 v2, 16384, v2
  v_mfma_f32_16x16x32_bf16 v[112:115], v[40:43], v[60:63], v[240:243]
  v_xor_b32 v3, 16384, v3
  v_mfma_f32_16x16x32_bf16 v[112:115], v[24:27], v[56:59], v[112:115]
  v_xor_b32 v4, 16384, v4
  v_mfma_f32_16x16x32_bf16 v[116:119], v[28:31], v[56:59], v[244:247]
  v_mfma_f32_16x16x32_bf16 v[116:119], v[44:47], v[60:63], v[116:119]
  v_mfma_f32_16x16x32_bf16 v[100:103], v[44:47], v[52:55], v[244:247]
  s_waitcnt lgkmcnt(2)
  v_mfma_f32_16x16x32_bf16 v[100:103], v[28:31], v[48:51], v[100:103]
  s_nop 0
  v_mfma_f32_16x16x32_bf16 v[120:123], v[16:19], v[64:67], v[232:235]
  s_barrier
  s_waitcnt lgkmcnt(0)
  v_mfma_f32_16x16x32_bf16 v[120:123], v[32:35], v[68:71], v[120:123]
  ds_read_b128 v[80:83], v5 offset:8192
  v_mfma_f32_16x16x32_bf16 v[136:139], v[32:35], v[76:79], v[232:235]
  ds_read_b128 v[84:87], v7 offset:8192
  v_mfma_f32_16x16x32_bf16 v[136:139], v[16:19], v[72:75], v[136:139]
  ds_read_b128 v[48:51], v5 offset:10240
  v_mfma_f32_16x16x32_bf16 v[140:143], v[20:23], v[72:75], v[236:239]
  ds_read_b128 v[52:55], v7 offset:10240
  v_mfma_f32_16x16x32_bf16 v[140:143], v[36:39], v[76:79], v[140:143]
  ds_read_b128 v[56:59], v5 offset:12288
  v_mfma_f32_16x16x32_bf16 v[124:127], v[36:39], v[68:71], v[236:239]
  ds_read_b128 v[60:63], v7 offset:12288
  v_mfma_f32_16x16x32_bf16 v[124:127], v[20:23], v[64:67], v[124:127]
  v_mfma_f32_16x16x32_bf16 v[128:131], v[24:27], v[64:67], v[240:243]
  v_mfma_f32_16x16x32_bf16 v[128:131], v[40:43], v[68:71], v[128:131]
  v_mfma_f32_16x16x32_bf16 v[144:147], v[40:43], v[76:79], v[240:243]
  v_mfma_f32_16x16x32_bf16 v[144:147], v[24:27], v[72:75], v[144:147]
  v_mfma_f32_16x16x32_bf16 v[148:151], v[28:31], v[72:75], v[244:247]
  ds_read_b128 v[72:75], v5 offset:16384
  v_mfma_f32_16x16x32_bf16 v[148:151], v[44:47], v[76:79], v[148:151]
  ds_read_b128 v[76:79], v7 offset:16384
  v_mfma_f32_16x16x32_bf16 v[132:135], v[44:47], v[68:71], v[244:247]
  ds_read_b128 v[68:71], v7 offset:14336
  s_waitcnt lgkmcnt(7)
  v_mfma_f32_16x16x32_bf16 v[132:135], v[28:31], v[64:67], v[132:135]
  ds_read_b128 v[64:67], v5 offset:14336
  v_mfma_f32_16x16x32_bf16 v[152:155], v[16:19], v[80:83], v[232:235]
  s_waitcnt lgkmcnt(6)
  v_mfma_f32_16x16x32_bf16 v[152:155], v[32:35], v[84:87], v[152:155]
  v_mfma_f32_16x16x32_bf16 v[168:171], v[32:35], v[52:55], v[232:235]
  v_mfma_f32_16x16x32_bf16 v[168:171], v[16:19], v[48:51], v[168:171]
  v_mfma_f32_16x16x32_bf16 v[172:175], v[20:23], v[48:51], v[236:239]
  v_mfma_f32_16x16x32_bf16 v[172:175], v[36:39], v[52:55], v[172:175]
  v_mfma_f32_16x16x32_bf16 v[156:159], v[36:39], v[84:87], v[236:239]
  v_mfma_f32_16x16x32_bf16 v[156:159], v[20:23], v[80:83], v[156:159]
  v_mfma_f32_16x16x32_bf16 v[160:163], v[24:27], v[80:83], v[240:243]
  v_mfma_f32_16x16x32_bf16 v[160:163], v[40:43], v[84:87], v[160:163]
  v_mfma_f32_16x16x32_bf16 v[176:179], v[40:43], v[52:55], v[240:243]
  v_mfma_f32_16x16x32_bf16 v[176:179], v[24:27], v[48:51], v[176:179]
  v_mfma_f32_16x16x32_bf16 v[180:183], v[28:31], v[48:51], v[244:247]
  v_mfma_f32_16x16x32_bf16 v[180:183], v[44:47], v[52:55], v[180:183]
  v_mfma_f32_16x16x32_bf16 v[164:167], v[44:47], v[84:87], v[244:247]
  ds_read_b128 v[84:87], v7 offset:18432
  s_waitcnt lgkmcnt(5)
  v_mfma_f32_16x16x32_bf16 v[164:167], v[28:31], v[80:83], v[164:167]
  ds_read_b128 v[80:83], v5 offset:18432
  v_mfma_f32_16x16x32_bf16 v[184:187], v[16:19], v[56:59], v[232:235]
  s_waitcnt lgkmcnt(2)
  v_mfma_f32_16x16x32_bf16 v[184:187], v[32:35], v[60:63], v[184:187]
  s_waitcnt vmcnt(0)
  v_mfma_f32_16x16x32_bf16 v[200:203], v[32:35], v[68:71], v[232:235]
  v_mfma_f32_16x16x32_bf16 v[200:203], v[16:19], v[64:67], v[200:203]
  v_mfma_f32_16x16x32_bf16 v[204:207], v[20:23], v[64:67], v[236:239]
  v_mfma_f32_16x16x32_bf16 v[204:207], v[36:39], v[68:71], v[204:207]
  s_waitcnt lgkmcnt(0)
  s_barrier
  v_mfma_f32_16x16x32_bf16 v[188:191], v[36:39], v[60:63], v[236:239]
  s_nop 0
  ds_read_b128 v[48:51], v5 offset:40960
  v_mfma_f32_16x16x32_bf16 v[188:191], v[20:23], v[56:59], v[188:191]
  ds_read_b128 v[52:55], v7 offset:40960
  v_mfma_f32_16x16x32_bf16 v[192:195], v[24:27], v[56:59], v[240:243]
  v_mfma_f32_16x16x32_bf16 v[192:195], v[40:43], v[60:63], v[192:195]
  v_mfma_f32_16x16x32_bf16 v[208:211], v[40:43], v[68:71], v[240:243]
  v_mfma_f32_16x16x32_bf16 v[208:211], v[24:27], v[64:67], v[208:211]
  v_mfma_f32_16x16x32_bf16 v[212:215], v[28:31], v[64:67], v[244:247]
  ds_read_b128 v[64:67], v5 offset:45056
  v_mfma_f32_16x16x32_bf16 v[212:215], v[44:47], v[68:71], v[212:215]
  ds_read_b128 v[68:71], v7 offset:45056
  v_mfma_f32_16x16x32_bf16 v[196:199], v[44:47], v[60:63], v[244:247]
  ds_read_b128 v[60:63], v7 offset:43008
  v_mfma_f32_16x16x32_bf16 v[196:199], v[28:31], v[56:59], v[196:199]
  ds_read_b128 v[56:59], v5 offset:43008
  v_mfma_f32_16x16x32_bf16 v[216:219], v[32:35], v[76:79], v[216:219]
  v_mfma_f32_16x16x32_bf16 v[216:219], v[16:19], v[72:75], v[216:219]
  v_mfma_f32_16x16x32_bf16 v[232:235], v[16:19], v[80:83], v[232:235]
  ds_read_b64_tr_b16 v[16:17], v1 offset:0
  v_mfma_f32_16x16x32_bf16 v[232:235], v[32:35], v[84:87], v[232:235]
  ds_read_b64_tr_b16 v[18:19], v1 offset:1024
  v_mfma_f32_16x16x32_bf16 v[236:239], v[36:39], v[84:87], v[236:239]
  ds_read_b64_tr_b16 v[32:33], v1 offset:8192
  v_mfma_f32_16x16x32_bf16 v[236:239], v[20:23], v[80:83], v[236:239]
  ds_read_b64_tr_b16 v[34:35], v1 offset:9216
  v_mfma_f32_16x16x32_bf16 v[220:223], v[20:23], v[72:75], v[220:223]
  ds_read_b64_tr_b16 v[20:21], v2 offset:0
  v_mfma_f32_16x16x32_bf16 v[220:223], v[36:39], v[76:79], v[220:223]
  ds_read_b64_tr_b16 v[22:23], v2 offset:1024
  v_mfma_f32_16x16x32_bf16 v[224:227], v[40:43], v[76:79], v[224:227]
  ds_read_b64_tr_b16 v[36:37], v2 offset:8192
  v_mfma_f32_16x16x32_bf16 v[224:227], v[24:27], v[72:75], v[224:227]
  ds_read_b64_tr_b16 v[38:39], v2 offset:9216
  v_mfma_f32_16x16x32_bf16 v[240:243], v[24:27], v[80:83], v[240:243]
  ds_read_b64_tr_b16 v[24:25], v3 offset:0
  v_mfma_f32_16x16x32_bf16 v[240:243], v[40:43], v[84:87], v[240:243]
  ds_read_b64_tr_b16 v[26:27], v3 offset:1024
  v_mfma_f32_16x16x32_bf16 v[244:247], v[44:47], v[84:87], v[244:247]
  ds_read_b64_tr_b16 v[40:41], v3 offset:8192
  v_mfma_f32_16x16x32_bf16 v[244:247], v[28:31], v[80:83], v[244:247]
  ds_read_b64_tr_b16 v[42:43], v3 offset:9216
  v_mfma_f32_16x16x32_bf16 v[228:231], v[28:31], v[72:75], v[228:231]
  ds_read_b64_tr_b16 v[28:29], v4 offset:0
  s_waitcnt lgkmcnt(9)
  v_mfma_f32_16x16x32_bf16 v[228:231], v[44:47], v[76:79], v[228:231]
  ds_read_b64_tr_b16 v[30:31], v4 offset:1024
L_dnn_loop0:
  v_mfma_f32_16x16x32_bf16 v[88:91], v[16:19], v[48:51], v[88:91]
  s_nop 0
  ds_read_b64_tr_b16 v[44:45], v4 offset:8192
  v_mfma_f32_16x16x32_bf16 v[88:91], v[32:35], v[52:55], v[88:91]
  ds_read_b64_tr_b16 v[46:47], v4 offset:9216
  v_mfma_f32_16x16x32_bf16 v[104:107], v[32:35], v[60:63], v[104:107]
  ds_read_b128 v[72:75], v5 offset:47104
  s_waitcnt lgkmcnt(9)
  v_mfma_f32_16x16x32_bf16 v[104:107], v[16:19], v[56:59], v[104:107]
  ds_read_b128 v[76:79], v7 offset:47104
  v_mfma_f32_16x16x32_bf16 v[108:111], v[20:23], v[56:59], v[108:111]
  s_nop 0
  ds_read_b128 v[80:83], v5 offset:49152
  v_mfma_f32_16x16x32_bf16 v[108:111], v[36:39], v[60:63], v[108:111]
  ds_read_b128 v[84:87], v7 offset:49152
  v_mfma_f32_16x16x32_bf16 v[92:95], v[36:39], v[52:55], v[92:95]
  s_waitcnt lgkmcnt(8)
  v_mfma_f32_16x16x32_bf16 v[92:95], v[20:23], v[48:51], v[92:95]
  v_mfma_f32_16x16x32_bf16 v[96:99], v[24:27], v[48:51], v[96:99]
  s_nop 0
  v_xor_b32 v1, 16384, v1
  v_mfma_f32_16x16x32_bf16 v[96:99], v[40:43], v[52:55], v[96:99]
  v_xor_b32 v2, 16384, v2
  v_mfma_f32_16x16x32_bf16 v[112:115], v[40:43], v[60:63], v[112:115]
  v_xor_b32 v3, 16384, v3
  s_waitcnt lgkmcnt(4)
  v_mfma_f32_16x16x32_bf16 v[112:115], v[24:27], v[56:59], v[112:115]
  v_xor_b32 v4, 16384, v4
  v_mfma_f32_16x16x32_bf16 v[116:119], v[28:31], v[56:59], v[116:119]
  s_nop 0
  ds_read_b128 v[56:59], v5 offset:53248
  v_mfma_f32_16x16x32_bf16 v[116:119], v[44:47], v[60:63], v[116:119]
  ds_read_b128 v[60:63], v7 offset:53248
  v_mfma_f32_16x16x32_bf16 v[100:103], v[44:47], v[52:55], v[100:103]
  ds_read_b128 v[52:55], v7 offset:51200
  v_mfma_f32_16x16x32_bf16 v[100:103], v[28:31], v[48:51], v[100:103]
  ds_read_b128 v[48:51], v5 offset:51200
  v_mfma_f32_16x16x32_bf16 v[120:123], v[16:19], v[64:67], v[120:123]
  s_waitcnt lgkmcnt(6)
  v_mfma_f32_16x16x32_bf16 v[120:123], v[32:35], v[68:71], v[120:123]
  v_mfma_f32_16x16x32_bf16 v[136:139], v[32:35], v[76:79], v[136:139]
  v_mfma_f32_16x16x32_bf16 v[136:139], v[16:19], v[72:75], v[136:139]
  v_mfma_f32_16x16x32_bf16 v[140:143], v[20:23], v[72:75], v[140:143]
  v_mfma_f32_16x16x32_bf16 v[140:143], v[36:39], v[76:79], v[140:143]
  v_mfma_f32_16x16x32_bf16 v[124:127], v[36:39], v[68:71], v[124:127]
  v_mfma_f32_16x16x32_bf16 v[124:127], v[20:23], v[64:67], v[124:127]
  s_nop 0
  v_mfma_f32_16x16x32_bf16 v[128:131], v[24:27], v[64:67], v[128:131]
  v_mfma_f32_16x16x32_bf16 v[128:131], v[40:43], v[68:71], v[128:131]
  v_mfma_f32_16x16x32_bf16 v[144:147], v[40:43], v[76:79], v[144:147]
  v_mfma_f32_16x16x32_bf16 v[144:147], v[24:27], v[72:75], v[144:147]
  v_mfma_f32_16x16x32_bf16 v[148:151], v[28:31], v[72:75], v[148:151]
  ds_read_b128 v[72:75], v5 offset:57344
  v_mfma_f32_16x16x32_bf16 v[148:151], v[44:47], v[76:79], v[148:151]
  ds_read_b128 v[76:79], v7 offset:57344
  v_mfma_f32_16x16x32_bf16 v[132:135], v[44:47], v[68:71], v[132:135]
  ds_read_b128 v[68:71], v7 offset:55296
  s_waitcnt lgkmcnt(7)
  v_mfma_f32_16x16x32_bf16 v[132:135], v[28:31], v[64:67], v[132:135]
  ds_read_b128 v[64:67], v5 offset:55296
  v_mfma_f32_16x16x32_bf16 v[152:155], v[16:19], v[80:83], v[152:155]
  s_waitcnt lgkmcnt(4)
  v_mfma_f32_16x16x32_bf16 v[152:155], v[32:35], v[84:87], v[152:155]
  v_mfma_f32_16x16x32_bf16 v[168:171], v[32:35], v[52:55], v[168:171]
  v_mfma_f32_16x16x32_bf16 v[168:171], v[16:19], v[48:51], v[168:171]
  v_mfma_f32_16x16x32_bf16 v[172:175], v[20:23], v[48:51], v[172:175]
  v_mfma_f32_16x16x32_bf16 v[172:175], v[36:39], v[52:55], v[172:175]
  v_mfma_f32_16x16x32_bf16 v[156:159], v[36:39], v[84:87], v[156:159]
  v_mfma_f32_16x16x32_bf16 v[156:159], v[20:23], v[80:83], v[156:159]
  v_mfma_f32_16x16x32_bf16 v[160:163], v[24:27], v[80:83], v[160:163]
  v_mfma_f32_16x16x32_bf16 v[160:163], v[40:43], v[84:87], v[160:163]
  v_mfma_f32_16x16x32_bf16 v[176:179], v[40:43], v[52:55], v[176:179]
  v_mfma_f32_16x16x32_bf16 v[176:179], v[24:27], v[48:51], v[176:179]
  v_mfma_f32_16x16x32_bf16 v[180:183], v[28:31], v[48:51], v[180:183]
  v_mfma_f32_16x16x32_bf16 v[180:183], v[44:47], v[52:55], v[180:183]
  v_mfma_f32_16x16x32_bf16 v[164:167], v[44:47], v[84:87], v[164:167]
  ds_read_b128 v[84:87], v7 offset:59392
  v_mfma_f32_16x16x32_bf16 v[164:167], v[28:31], v[80:83], v[164:167]
  ds_read_b128 v[80:83], v5 offset:59392
  v_mfma_f32_16x16x32_bf16 v[184:187], v[16:19], v[56:59], v[184:187]
  s_waitcnt lgkmcnt(2)
  v_mfma_f32_16x16x32_bf16 v[184:187], v[32:35], v[60:63], v[184:187]
  v_mfma_f32_16x16x32_bf16 v[200:203], v[32:35], v[68:71], v[200:203]
  v_mfma_f32_16x16x32_bf16 v[200:203], v[16:19], v[64:67], v[200:203]
  v_mfma_f32_16x16x32_bf16 v[204:207], v[20:23], v[64:67], v[204:207]
  v_mfma_f32_16x16x32_bf16 v[204:207], v[36:39], v[68:71], v[204:207]
  s_waitcnt lgkmcnt(0)
  s_barrier
  v_mfma_f32_16x16x32_bf16 v[188:191], v[36:39], v[60:63], v[188:191]
  s_nop 0
  ds_read_b128 v[48:51], v6 offset:0
  v_mfma_f32_16x16x32_bf16 v[188:191], v[20:23], v[56:59], v[188:191]
  ds_read_b128 v[52:55], v8 offset:0
  v_mfma_f32_16x16x32_bf16 v[192:195], v[24:27], v[56:59], v[192:195]
  v_mfma_f32_16x16x32_bf16 v[192:195], v[40:43], v[60:63], v[192:195]
  v_mfma_f32_16x16x32_bf16 v[208:211], v[40:43], v[68:71], v[208:211]
  v_mfma_f32_16x16x32_bf16 v[208:211], v[24:27], v[64:67], v[208:211]
  v_mfma_f32_16x16x32_bf16 v[212:215], v[28:31], v[64:67], v[212:215]
  ds_read_b128 v[64:67], v6 offset:4096
  v_mfma_f32_16x16x32_bf16 v[212:215], v[44:47], v[68:71], v[212:215]
  ds_read_b128 v[68:71], v8 offset:4096
  v_mfma_f32_16x16x32_bf16 v[196:199], v[44:47], v[60:63], v[196:199]
  ds_read_b128 v[60:63], v8 offset:2048
  v_mfma_f32_16x16x32_bf16 v[196:199], v[28:31], v[56:59], v[196:199]
  ds_read_b128 v[56:59], v6 offset:2048
  v_mfma_f32_16x16x32_bf16 v[216:219], v[32:35], v[76:79], v[216:219]
  v_mfma_f32_16x16x32_bf16 v[216:219], v[16:19], v[72:75], v[216:219]
  v_mfma_f32_16x16x32_bf16 v[232:235], v[16:19], v[80:83], v[232:235]
  ds_read_b64_tr_b16 v[16:17], v1 offset:0
  v_mfma_f32_16x16x32_bf16 v[232:235], v[32:35], v[84:87], v[232:235]
  ds_read_b64_tr_b16 v[18:19], v1 offset:1024
  v_mfma_f32_16x16x32_bf16 v[236:239], v[36:39], v[84:87], v[236:239]
  ds_read_b64_tr_b16 v[32:33], v1 offset:8192
  v_mfma_f32_16x16x32_bf16 v[236:239], v[20:23], v[80:83], v[236:239]
  ds_read_b64_tr_b16 v[34:35], v1 offset:9216
  v_mfma_f32_16x16x32_bf16 v[220:223], v[20:23], v[72:75], v[220:223]
  ds_read_b64_tr_b16 v[20:21], v2 offset:0
  v_mfma_f32_16x16x32_bf16 v[220:223], v[36:39], v[76:79], v[220:223]
  ds_read_b64_tr_b16 v[22:23], v2 offset:1024
  v_mfma_f32_16x16x32_bf16 v[224:227], v[40:43], v[76:79], v[224:227]
  ds_read_b64_tr_b16 v[36:37], v2 offset:8192
  v_mfma_f32_16x16x32_bf16 v[224:227], v[24:27], v[72:75], v[224:227]
  ds_read_b64_tr_b16 v[38:39], v2 offset:9216
  v_mfma_f32_16x16x32_bf16 v[240:243], v[24:27], v[80:83], v[240:243]
  ds_read_b64_tr_b16 v[24:25], v3 offset:0
  v_mfma_f32_16x16x32_bf16 v[240:243], v[40:43], v[84:87], v[240:243]
  ds_read_b64_tr_b16 v[26:27], v3 offset:1024
  v_mfma_f32_16x16x32_bf16 v[244:247], v[44:47], v[84:87], v[244:247]
  ds_read_b64_tr_b16 v[40:41], v3 offset:8192
  v_mfma_f32_16x16x32_bf16 v[244:247], v[28:31], v[80:83], v[244:247]
  ds_read_b64_tr_b16 v[42:43], v3 offset:9216
  v_mfma_f32_16x16x32_bf16 v[228:231], v[28:31], v[72:75], v[228:231]
  ds_read_b64_tr_b16 v[28:29], v4 offset:0
  s_waitcnt lgkmcnt(9)
  v_mfma_f32_16x16x32_bf16 v[228:231], v[44:47], v[76:79], v[228:231]
  ds_read_b64_tr_b16 v[30:31], v4 offset:1024
  v_mfma_f32_16x16x32_bf16 v[88:91], v[16:19], v[48:51], v[88:91]
  s_nop 0
  ds_read_b64_tr_b16 v[44:45], v4 offset:8192
  v_mfma_f32_16x16x32_bf16 v[88:91], v[32:35], v[52:55], v[88:91]
  ds_read_b64_tr_b16 v[46:47], v4 offset:9216
  v_mfma_f32_16x16x32_bf16 v[104:107], v[32:35], v[60:63], v[104:107]
  ds_read_b128 v[72:75], v6 offset:6144
  s_waitcnt lgkmcnt(9)
  v_mfma_f32_16x16x32_bf16 v[104:107], v[16:19], v[56:59], v[104:107]
  ds_read_b128 v[76:79], v8 offset:6144
  v_mfma_f32_16x16x32_bf16 v[108:111], v[20:23], v[56:59], v[108:111]
  s_nop 0
  ds_read_b128 v[80:83], v6 offset:8192
  v_mfma_f32_16x16x32_bf16 v[108:111], v[36:39], v[60:63], v[108:111]
  ds_read_b128 v[84:87], v8 offset:8192
  v_mfma_f32_16x16x32_bf16 v[92:95], v[36:39], v[52:55], v[92:95]
  s_waitcnt lgkmcnt(8)
  v_mfma_f32_16x16x32_bf16 v[92:95], v[20:23], v[48:51], v[92:95]
  v_mfma_f32_16x16x32_bf16 v[96:99], v[24:27], v[48:51], v[96:99]
  s_nop 0
  v_xor_b32 v1, 16384, v1
  v_mfma_f32_16x16x32_bf16 v[96:99], v[40:43], v[52:55], v[96:99]
  v_xor_b32 v2, 16384, v2
  v_mfma_f32_16x16x32_bf16 v[112:115], v[40:43], v[60:63], v[112:115]
  v_xor_b32 v3, 16384, v3
  s_waitcnt lgkmcnt(4)
  v_mfma_f32_16x16x32_bf16 v[112:115], v[24:27], v[56:59], v[112:115]
  v_xor_b32 v4, 16384, v4
  v_mfma_f32_16x16x32_bf16 v[116:119], v[28:31], v[56:59], v[116:119]
  s_nop 0
  ds_read_b128 v[56:59], v6 offset:12288
  v_mfma_f32_16x16x32_bf16 v[116:119], v[44:47], v[60:63], v[116:119]
  ds_read_b128 v[60:63], v8 offset:12288
  v_mfma_f32_16x16x32_bf16 v[100:103], v[44:47], v[52:55], v[100:103]
  ds_read_b128 v[52:55], v8 offset:10240
  v_mfma_f32_16x16x32_bf16 v[100:103], v[28:31], v[48:51], v[100:103]
  ds_read_b128 v[48:51], v6 offset:10240
  v_mfma_f32_16x16x32_bf16 v[120:123], v[16:19], v[64:67], v[120:123]
  s_waitcnt lgkmcnt(6)
  v_mfma_f32_16x16x32_bf16 v[120:123], v[32:35], v[68:71], v[120:123]
  v_mfma_f32_16x16x32_bf16 v[136:139], v[32:35], v[76:79], v[136:139]
  v_mfma_f32_16x16x32_bf16 v[136:139], v[16:19], v[72:75], v[136:139]
  v_mfma_f32_16x16x32_bf16 v[140:143], v[20:23], v[72:75], v[140:143]
  v_mfma_f32_16x16x32_bf16 v[140:143], v[36:39], v[76:79], v[140:143]
  v_mfma_f32_16x16x32_bf16 v[124:127], v[36:39], v[68:71], v[124:127]
  v_mfma_f32_16x16x32_bf16 v[124:127], v[20:23], v[64:67], v[124:127]
  s_nop 0
  v_mfma_f32_16x16x32_bf16 v[128:131], v[24:27], v[64:67], v[128:131]
  v_mfma_f32_16x16x32_bf16 v[128:131], v[40:43], v[68:71], v[128:131]
  v_mfma_f32_16x16x32_bf16 v[144:147], v[40:43], v[76:79], v[144:147]
  v_mfma_f32_16x16x32_bf16 v[144:147], v[24:27], v[72:75], v[144:147]
  v_mfma_f32_16x16x32_bf16 v[148:151], v[28:31], v[72:75], v[148:151]
  ds_read_b128 v[72:75], v6 offset:16384
  v_mfma_f32_16x16x32_bf16 v[148:151], v[44:47], v[76:79], v[148:151]
  ds_read_b128 v[76:79], v8 offset:16384
  v_mfma_f32_16x16x32_bf16 v[132:135], v[44:47], v[68:71], v[132:135]
  ds_read_b128 v[68:71], v8 offset:14336
  s_waitcnt lgkmcnt(7)
  v_mfma_f32_16x16x32_bf16 v[132:135], v[28:31], v[64:67], v[132:135]
  ds_read_b128 v[64:67], v6 offset:14336
  v_mfma_f32_16x16x32_bf16 v[152:155], v[16:19], v[80:83], v[152:155]
  s_waitcnt lgkmcnt(4)
  v_mfma_f32_16x16x32_bf16 v[152:155], v[32:35], v[84:87], v[152:155]
  v_mfma_f32_16x16x32_bf16 v[168:171], v[32:35], v[52:55], v[168:171]
  v_mfma_f32_16x16x32_bf16 v[168:171], v[16:19], v[48:51], v[168:171]
  v_mfma_f32_16x16x32_bf16 v[172:175], v[20:23], v[48:51], v[172:175]
  v_mfma_f32_16x16x32_bf16 v[172:175], v[36:39], v[52:55], v[172:175]
  v_mfma_f32_16x16x32_bf16 v[156:159], v[36:39], v[84:87], v[156:159]
  v_mfma_f32_16x16x32_bf16 v[156:159], v[20:23], v[80:83], v[156:159]
  v_mfma_f32_16x16x32_bf16 v[160:163], v[24:27], v[80:83], v[160:163]
  v_mfma_f32_16x16x32_bf16 v[160:163], v[40:43], v[84:87], v[160:163]
  v_mfma_f32_16x16x32_bf16 v[176:179], v[40:43], v[52:55], v[176:179]
  v_mfma_f32_16x16x32_bf16 v[176:179], v[24:27], v[48:51], v[176:179]
  v_mfma_f32_16x16x32_bf16 v[180:183], v[28:31], v[48:51], v[180:183]
  v_mfma_f32_16x16x32_bf16 v[180:183], v[44:47], v[52:55], v[180:183]
  v_mfma_f32_16x16x32_bf16 v[164:167], v[44:47], v[84:87], v[164:167]
  ds_read_b128 v[84:87], v8 offset:18432
  v_mfma_f32_16x16x32_bf16 v[164:167], v[28:31], v[80:83], v[164:167]
  ds_read_b128 v[80:83], v6 offset:18432
  v_mfma_f32_16x16x32_bf16 v[184:187], v[16:19], v[56:59], v[184:187]
  s_waitcnt lgkmcnt(2)
  v_mfma_f32_16x16x32_bf16 v[184:187], v[32:35], v[60:63], v[184:187]
  v_mfma_f32_16x16x32_bf16 v[200:203], v[32:35], v[68:71], v[200:203]
  v_mfma_f32_16x16x32_bf16 v[200:203], v[16:19], v[64:67], v[200:203]
  v_mfma_f32_16x16x32_bf16 v[204:207], v[20:23], v[64:67], v[204:207]
  v_mfma_f32_16x16x32_bf16 v[204:207], v[36:39], v[68:71], v[204:207]
  s_waitcnt lgkmcnt(0)
  s_barrier
  v_mfma_f32_16x16x32_bf16 v[188:191], v[36:39], v[60:63], v[188:191]
  s_nop 0
  ds_read_b128 v[48:51], v5 offset:0
  v_mfma_f32_16x16x32_bf16 v[188:191], v[20:23], v[56:59], v[188:191]
  ds_read_b128 v[52:55], v7 offset:0
  v_mfma_f32_16x16x32_bf16 v[192:195], v[24:27], v[56:59], v[192:195]
  v_mfma_f32_16x16x32_bf16 v[192:195], v[40:43], v[60:63], v[192:195]
  v_mfma_f32_16x16x32_bf16 v[208:211], v[40:43], v[68:71], v[208:211]
  v_mfma_f32_16x16x32_bf16 v[208:211], v[24:27], v[64:67], v[208:211]
  v_mfma_f32_16x16x32_bf16 v[212:215], v[28:31], v[64:67], v[212:215]
  ds_read_b128 v[64:67], v5 offset:4096
  v_mfma_f32_16x16x32_bf16 v[212:215], v[44:47], v[68:71], v[212:215]
  ds_read_b128 v[68:71], v7 offset:4096
  v_mfma_f32_16x16x32_bf16 v[196:199], v[44:47], v[60:63], v[196:199]
  ds_read_b128 v[60:63], v7 offset:2048
  v_mfma_f32_16x16x32_bf16 v[196:199], v[28:31], v[56:59], v[196:199]
  ds_read_b128 v[56:59], v5 offset:2048
  v_mfma_f32_16x16x32_bf16 v[216:219], v[32:35], v[76:79], v[216:219]
  v_mfma_f32_16x16x32_bf16 v[216:219], v[16:19], v[72:75], v[216:219]
  v_mfma_f32_16x16x32_bf16 v[232:235], v[16:19], v[80:83], v[232:235]
  ds_read_b64_tr_b16 v[16:17], v1 offset:0
  v_mfma_f32_16x16x32_bf16 v[232:235], v[32:35], v[84:87], v[232:235]
  ds_read_b64_tr_b16 v[18:19], v1 offset:1024
  v_mfma_f32_16x16x32_bf16 v[236:239], v[36:39], v[84:87], v[236:239]
  ds_read_b64_tr_b16 v[32:33], v1 offset:8192
  v_mfma_f32_16x16x32_bf16 v[236:239], v[20:23], v[80:83], v[236:239]
  ds_read_b64_tr_b16 v[34:35], v1 offset:9216
  v_mfma_f32_16x16x32_bf16 v[220:223], v[20:23], v[72:75], v[220:223]
  ds_read_b64_tr_b16 v[20:21], v2 offset:0
  v_mfma_f32_16x16x32_bf16 v[220:223], v[36:39], v[76:79], v[220:223]
  ds_read_b64_tr_b16 v[22:23], v2 offset:1024
  v_mfma_f32_16x16x32_bf16 v[224:227], v[40:43], v[76:79], v[224:227]
  ds_read_b64_tr_b16 v[36:37], v2 offset:8192
  v_mfma_f32_16x16x32_bf16 v[224:227], v[24:27], v[72:75], v[224:227]
  ds_read_b64_tr_b16 v[38:39], v2 offset:9216
  v_mfma_f32_16x16x32_bf16 v[240:243], v[24:27], v[80:83], v[240:243]
  ds_read_b64_tr_b16 v[24:25], v3 offset:0
  v_mfma_f32_16x16x32_bf16 v[240:243], v[40:43], v[84:87], v[240:243]
  ds_read_b64_tr_b16 v[26:27], v3 offset:1024
  v_mfma_f32_16x16x32_bf16 v[244:247], v[44:47], v[84:87], v[244:247]
  ds_read_b64_tr_b16 v[40:41], v3 offset:8192
  v_mfma_f32_16x16x32_bf16 v[244:247], v[28:31], v[80:83], v[244:247]
  ds_read_b64_tr_b16 v[42:43], v3 offset:9216
  v_mfma_f32_16x16x32_bf16 v[228:231], v[28:31], v[72:75], v[228:231]
  ds_read_b64_tr_b16 v[28:29], v4 offset:0
  s_waitcnt lgkmcnt(9)
  v_mfma_f32_16x16x32_bf16 v[228:231], v[44:47], v[76:79], v[228:231]
  ds_read_b64_tr_b16 v[30:31], v4 offset:1024
  v_mfma_f32_16x16x32_bf16 v[88:91], v[16:19], v[48:51], v[88:91]
  s_nop 0
  ds_read_b64_tr_b16 v[44:45], v4 offset:8192
  v_mfma_f32_16x16x32_bf16 v[88:91], v[32:35], v[52:55], v[88:91]
  ds_read_b64_tr_b16 v[46:47], v4 offset:9216
  v_mfma_f32_16x16x32_bf16 v[104:107], v[32:35], v[60:63], v[104:107]
  ds_read_b128 v[72:75], v5 offset:6144
  s_waitcnt lgkmcnt(9)
  v_mfma_f32_16x16x32_bf16 v[104:107], v[16:19], v[56:59], v[104:107]
  ds_read_b128 v[76:79], v7 offset:6144
  v_mfma_f32_16x16x32_bf16 v[108:111], v[20:23], v[56:59], v[108:111]
  s_nop 0
  ds_read_b128 v[80:83], v5 offset:8192
  v_mfma_f32_16x16x32_bf16 v[108:111], v[36:39], v[60:63], v[108:111]
  ds_read_b128 v[84:87], v7 offset:8192
  v_mfma_f32_16x16x32_bf16 v[92:95], v[36:39], v[52:55], v[92:95]
  s_waitcnt lgkmcnt(8)
  v_mfma_f32_16x16x32_bf16 v[92:95], v[20:23], v[48:51], v[92:95]
  v_mfma_f32_16x16x32_bf16 v[96:99], v[24:27], v[48:51], v[96:99]
  s_nop 0
  v_xor_b32 v1, 16384, v1
  v_mfma_f32_16x16x32_bf16 v[96:99], v[40:43], v[52:55], v[96:99]
  v_xor_b32 v2, 16384, v2
  v_mfma_f32_16x16x32_bf16 v[112:115], v[40:43], v[60:63], v[112:115]
  v_xor_b32 v3, 16384, v3
  s_waitcnt lgkmcnt(4)
  v_mfma_f32_16x16x32_bf16 v[112:115], v[24:27], v[56:59], v[112:115]
  v_xor_b32 v4, 16384, v4
  v_mfma_f32_16x16x32_bf16 v[116:119], v[28:31], v[56:59], v[116:119]
  s_nop 0
  ds_read_b128 v[56:59], v5 offset:12288
  v_mfma_f32_16x16x32_bf16 v[116:119], v[44:47], v[60:63], v[116:119]
  ds_read_b128 v[60:63], v7 offset:12288
  v_mfma_f32_16x16x32_bf16 v[100:103], v[44:47], v[52:55], v[100:103]
  ds_read_b128 v[52:55], v7 offset:10240
  v_mfma_f32_16x16x32_bf16 v[100:103], v[28:31], v[48:51], v[100:103]
  ds_read_b128 v[48:51], v5 offset:10240
  v_mfma_f32_16x16x32_bf16 v[120:123], v[16:19], v[64:67], v[120:123]
  s_waitcnt lgkmcnt(6)
  v_mfma_f32_16x16x32_bf16 v[120:123], v[32:35], v[68:71], v[120:123]
  v_mfma_f32_16x16x32_bf16 v[136:139], v[32:35], v[76:79], v[136:139]
  v_mfma_f32_16x16x32_bf16 v[136:139], v[16:19], v[72:75], v[136:139]
  v_mfma_f32_16x16x32_bf16 v[140:143], v[20:23], v[72:75], v[140:143]
  v_mfma_f32_16x16x32_bf16 v[140:143], v[36:39], v[76:79], v[140:143]
  v_mfma_f32_16x16x32_bf16 v[124:127], v[36:39], v[68:71], v[124:127]
  v_mfma_f32_16x16x32_bf16 v[124:127], v[20:23], v[64:67], v[124:127]
  s_nop 0
  v_mfma_f32_16x16x32_bf16 v[128:131], v[24:27], v[64:67], v[128:131]
  v_mfma_f32_16x16x32_bf16 v[128:131], v[40:43], v[68:71], v[128:131]
  v_mfma_f32_16x16x32_bf16 v[144:147], v[40:43], v[76:79], v[144:147]
  v_mfma_f32_16x16x32_bf16 v[144:147], v[24:27], v[72:75], v[144:147]
  v_mfma_f32_16x16x32_bf16 v[148:151], v[28:31], v[72:75], v[148:151]
  ds_read_b128 v[72:75], v5 offset:16384
  v_mfma_f32_16x16x32_bf16 v[148:151], v[44:47], v[76:79], v[148:151]
  ds_read_b128 v[76:79], v7 offset:16384
  v_mfma_f32_16x16x32_bf16 v[132:135], v[44:47], v[68:71], v[132:135]
  ds_read_b128 v[68:71], v7 offset:14336
  s_waitcnt lgkmcnt(7)
  v_mfma_f32_16x16x32_bf16 v[132:135], v[28:31], v[64:67], v[132:135]
  ds_read_b128 v[64:67], v5 offset:14336
  v_mfma_f32_16x16x32_bf16 v[152:155], v[16:19], v[80:83], v[152:155]
  s_waitcnt lgkmcnt(4)
  v_mfma_f32_16x16x32_bf16 v[152:155], v[32:35], v[84:87], v[152:155]
  v_mfma_f32_16x16x32_bf16 v[168:171], v[32:35], v[52:55], v[168:171]
  v_mfma_f32_16x16x32_bf16 v[168:171], v[16:19], v[48:51], v[168:171]
  v_mfma_f32_16x16x32_bf16 v[172:175], v[20:23], v[48:51], v[172:175]
  v_mfma_f32_16x16x32_bf16 v[172:175], v[36:39], v[52:55], v[172:175]
  v_mfma_f32_16x16x32_bf16 v[156:159], v[36:39], v[84:87], v[156:159]
  v_mfma_f32_16x16x32_bf16 v[156:159], v[20:23], v[80:83], v[156:159]
  v_mfma_f32_16x16x32_bf16 v[160:163], v[24:27], v[80:83], v[160:163]
  v_mfma_f32_16x16x32_bf16 v[160:163], v[40:43], v[84:87], v[160:163]
  v_mfma_f32_16x16x32_bf16 v[176:179], v[40:43], v[52:55], v[176:179]
  v_mfma_f32_16x16x32_bf16 v[176:179], v[24:27], v[48:51], v[176:179]
  v_mfma_f32_16x16x32_bf16 v[180:183], v[28:31], v[48:51], v[180:183]
  v_mfma_f32_16x16x32_bf16 v[180:183], v[44:47], v[52:55], v[180:183]
  v_mfma_f32_16x16x32_bf16 v[164:167], v[44:47], v[84:87], v[164:167]
  ds_read_b128 v[84:87], v7 offset:18432
  v_mfma_f32_16x16x32_bf16 v[164:167], v[28:31], v[80:83], v[164:167]
  ds_read_b128 v[80:83], v5 offset:18432
  v_mfma_f32_16x16x32_bf16 v[184:187], v[16:19], v[56:59], v[184:187]
  s_waitcnt lgkmcnt(2)
  s_add_u32 s72, s72, 1
  s_cmp_lt_u32 s72, 8
  v_mfma_f32_16x16x32_bf16 v[184:187], v[32:35], v[60:63], v[184:187]
  v_mfma_f32_16x16x32_bf16 v[200:203], v[32:35], v[68:71], v[200:203]
  v_mfma_f32_16x16x32_bf16 v[200:203], v[16:19], v[64:67], v[200:203]
  v_mfma_f32_16x16x32_bf16 v[204:207], v[20:23], v[64:67], v[204:207]
  s_nop 0
  v_mfma_f32_16x16x32_bf16 v[204:207], v[36:39], v[68:71], v[204:207]
  s_waitcnt lgkmcnt(0)
  s_barrier
  v_mfma_f32_16x16x32_bf16 v[188:191], v[36:39], v[60:63], v[188:191]
  ds_read_b128 v[48:51], v5 offset:40960
  v_mfma_f32_16x16x32_bf16 v[188:191], v[20:23], v[56:59], v[188:191]
  ds_read_b128 v[52:55], v7 offset:40960
  v_mfma_f32_16x16x32_bf16 v[192:195], v[24:27], v[56:59], v[192:195]
  v_mfma_f32_16x16x32_bf16 v[192:195], v[40:43], v[60:63], v[192:195]
  v_mfma_f32_16x16x32_bf16 v[208:211], v[40:43], v[68:71], v[208:211]
  v_mfma_f32_16x16x32_bf16 v[208:211], v[24:27], v[64:67], v[208:211]
  v_mfma_f32_16x16x32_bf16 v[212:215], v[28:31], v[64:67], v[212:215]
  ds_read_b128 v[64:67], v5 offset:45056
  v_mfma_f32_16x16x32_bf16 v[212:215], v[44:47], v[68:71], v[212:215]
  ds_read_b128 v[68:71], v7 offset:45056
  v_mfma_f32_16x16x32_bf16 v[196:199], v[44:47], v[60:63], v[196:199]
  ds_read_b128 v[60:63], v7 offset:43008
  v_mfma_f32_16x16x32_bf16 v[196:199], v[28:31], v[56:59], v[196:199]
  ds_read_b128 v[56:59], v5 offset:43008
  v_mfma_f32_16x16x32_bf16 v[216:219], v[32:35], v[76:79], v[216:219]
  v_mfma_f32_16x16x32_bf16 v[216:219], v[16:19], v[72:75], v[216:219]
  v_mfma_f32_16x16x32_bf16 v[232:235], v[16:19], v[80:83], v[232:235]
  ds_read_b64_tr_b16 v[16:17], v1 offset:0
  v_mfma_f32_16x16x32_bf16 v[232:235], v[32:35], v[84:87], v[232:235]
  ds_read_b64_tr_b16 v[18:19], v1 offset:1024
  v_mfma_f32_16x16x32_bf16 v[236:239], v[36:39], v[84:87], v[236:239]
  ds_read_b64_tr_b16 v[32:33], v1 offset:8192
  v_mfma_f32_16x16x32_bf16 v[236:239], v[20:23], v[80:83], v[236:239]
  ds_read_b64_tr_b16 v[34:35], v1 offset:9216
  v_mfma_f32_16x16x32_bf16 v[220:223], v[20:23], v[72:75], v[220:223]
  ds_read_b64_tr_b16 v[20:21], v2 offset:0
  v_mfma_f32_16x16x32_bf16 v[220:223], v[36:39], v[76:79], v[220:223]
  ds_read_b64_tr_b16 v[22:23], v2 offset:1024
  v_mfma_f32_16x16x32_bf16 v[224:227], v[40:43], v[76:79], v[224:227]
  ds_read_b64_tr_b16 v[36:37], v2 offset:8192
  v_mfma_f32_16x16x32_bf16 v[224:227], v[24:27], v[72:75], v[224:227]
  ds_read_b64_tr_b16 v[38:39], v2 offset:9216
  v_mfma_f32_16x16x32_bf16 v[240:243], v[24:27], v[80:83], v[240:243]
  ds_read_b64_tr_b16 v[24:25], v3 offset:0
  v_mfma_f32_16x16x32_bf16 v[240:243], v[40:43], v[84:87], v[240:243]
  ds_read_b64_tr_b16 v[26:27], v3 offset:1024
  v_mfma_f32_16x16x32_bf16 v[244:247], v[44:47], v[84:87], v[244:247]
  ds_read_b64_tr_b16 v[40:41], v3 offset:8192
  v_mfma_f32_16x16x32_bf16 v[244:247], v[28:31], v[80:83], v[244:247]
  ds_read_b64_tr_b16 v[42:43], v3 offset:9216
  v_mfma_f32_16x16x32_bf16 v[228:231], v[28:31], v[72:75], v[228:231]
  ds_read_b64_tr_b16 v[28:29], v4 offset:0
  s_waitcnt lgkmcnt(9)
  v_mfma_f32_16x16x32_bf16 v[228:231], v[44:47], v[76:79], v[228:231]
  ds_read_b64_tr_b16 v[30:31], v4 offset:1024
  s_cbranch_scc1 L_dnn_loop0
L_tail:
  v_mfma_f32_16x16x32_bf16 v[88:91], v[16:19], v[48:51], v[88:91]
  ds_read_b64_tr_b16 v[44:45], v4 offset:8192
  v_mfma_f32_16x16x32_bf16 v[88:91], v[32:35], v[52:55], v[88:91]
  ds_read_b64_tr_b16 v[46:47], v4 offset:9216
  v_mfma_f32_16x16x32_bf16 v[104:107], v[32:35], v[60:63], v[104:107]
  ds_read_b128 v[72:75], v5 offset:47104
  s_waitcnt lgkmcnt(9)
  v_mfma_f32_16x16x32_bf16 v[104:107], v[16:19], v[56:59], v[104:107]
  s_nop 0
  ds_read_b128 v[76:79], v7 offset:47104
  v_mfma_f32_16x16x32_bf16 v[108:111], v[20:23], v[56:59], v[108:111]
  ds_read_b128 v[80:83], v5 offset:49152
  v_mfma_f32_16x16x32_bf16 v[108:111], v[36:39], v[60:63], v[108:111]
  ds_read_b128 v[84:87], v7 offset:49152
  v_mul_f32 v11, v88, v88
  v_mfma_f32_16x16x32_bf16 v[92:95], v[36:39], v[52:55], v[92:95]
  s_waitcnt lgkmcnt(8)
  v_mul_f32 v248, v89, v89
  v_mul_f32 v249, v90, v90
  v_mfma_f32_16x16x32_bf16 v[92:95], v[20:23], v[48:51], v[92:95]
  v_mul_f32 v250, v91, v91
  v_fma_f32 v11, v11, v14, v12
  v_mfma_f32_16x16x32_bf16 v[96:99], v[24:27], v[48:51], v[96:99]
  v_fma_f32 v248, v248, v14, v12
  v_fma_f32 v249, v249, v14, v12
  v_mfma_f32_16x16x32_bf16 v[96:99], v[40:43], v[52:55], v[96:99]
  v_fma_f32 v250, v250, v14, v12
  v_mul_f32 v11, v11, v88
  v_mfma_f32_16x16x32_bf16 v[112:115], v[40:43], v[60:63], v[112:115]
  s_waitcnt lgkmcnt(4)
  v_mul_f32 v248, v248, v89
  v_mul_f32 v249, v249, v90
  v_mfma_f32_16x16x32_bf16 v[112:115], v[24:27], v[56:59], v[112:115]
  v_mul_f32 v250, v250, v91
  v_mfma_f32_16x16x32_bf16 v[116:119], v[28:31], v[56:59], v[116:119]
  ds_read_b128 v[56:59], v5 offset:53248
  v_mfma_f32_16x16x32_bf16 v[116:119], v[44:47], v[60:63], v[116:119]
  ds_read_b128 v[60:63], v7 offset:53248
  v_mfma_f32_16x16x32_bf16 v[100:103], v[44:47], v[52:55], v[100:103]
  ds_read_b128 v[52:55], v7 offset:51200
  v_mfma_f32_16x16x32_bf16 v[100:103], v[28:31], v[48:51], v[100:103]
  ds_read_b128 v[48:51], v5 offset:51200
  v_mfma_f32_16x16x32_bf16 v[120:123], v[16:19], v[64:67], v[120:123]
  s_waitcnt lgkmcnt(6)
  v_exp_f32 v11, v11
  v_mfma_f32_16x16x32_bf16 v[120:123], v[32:35], v[68:71], v[120:123]
  v_exp_f32 v248, v248
  v_mfma_f32_16x16x32_bf16 v[136:139], v[32:35], v[76:79], v[136:139]
  v_exp_f32 v249, v249
  v_mfma_f32_16x16x32_bf16 v[136:139], v[16:19], v[72:75], v[136:139]
  v_exp_f32 v250, v250
  v_mfma_f32_16x16x32_bf16 v[140:143], v[20:23], v[72:75], v[140:143]
  v_add_f32 v11, 1.0, v11
  v_add_f32 v248, 1.0, v248
  v_mfma_f32_16x16x32_bf16 v[140:143], v[36:39], v[76:79], v[140:143]
  v_add_f32 v249, 1.0, v249
  v_add_f32 v250, 1.0, v250
  v_mfma_f32_16x16x32_bf16 v[124:127], v[36:39], v[68:71], v[124:127]
  v_rcp_f32 v11, v11
  v_mfma_f32_16x16x32_bf16 v[124:127], v[20:23], v[64:67], v[124:127]
  v_rcp_f32 v248, v248
  v_mfma_f32_16x16x32_bf16 v[128:131], v[24:27], v[64:67], v[128:131]
  v_rcp_f32 v249, v249
  v_mfma_f32_16x16x32_bf16 v[128:131], v[40:43], v[68:71], v[128:131]
  v_rcp_f32 v250, v250
  v_mfma_f32_16x16x32_bf16 v[144:147], v[40:43], v[76:79], v[144:147]
  v_mul_f32 v88, v88, v11
  v_mul_f32 v89, v89, v248
  v_mfma_f32_16x16x32_bf16 v[144:147], v[24:27], v[72:75], v[144:147]
  v_mul_f32 v90, v90, v249
  v_mul_f32_e64 v91, v91, v250
  v_mfma_f32_16x16x32_bf16 v[148:151], v[28:31], v[72:75], v[148:151]
  ds_read_b128 v[72:75], v5 offset:57344
  v_mul_f32 v11, v92, v92
  v_mfma_f32_16x16x32_bf16 v[148:151], v[44:47], v[76:79], v[148:151]
  ds_read_b128 v[76:79], v7 offset:57344
  v_mul_f32 v248, v93, v93
  v_mfma_f32_16x16x32_bf16 v[132:135], v[44:47], v[68:71], v[132:135]
  ds_read_b128 v[68:71], v7 offset:55296
  s_waitcnt lgkmcnt(7)
  v_mul_f32 v249, v94, v94
  v_mfma_f32_16x16x32_bf16 v[132:135], v[28:31], v[64:67], v[132:135]
  ds_read_b128 v[64:67], v5 offset:55296
  v_mul_f32 v250, v95, v95
  v_mfma_f32_16x16x32_bf16 v[152:155], v[16:19], v[80:83], v[152:155]
  s_waitcnt lgkmcnt(4)
  v_fma_f32 v11, v11, v14, v12
  v_fma_f32 v248, v248, v14, v12
  v_mfma_f32_16x16x32_bf16 v[152:155], v[32:35], v[84:87], v[152:155]
  v_fma_f32 v249, v249, v14, v12
  v_fma_f32 v250, v250, v14, v12
  v_mfma_f32_16x16x32_bf16 v[168:171], v[32:35], v[52:55], v[168:171]
  v_mul_f32 v11, v11, v92
  v_mul_f32 v248, v248, v93
  v_mfma_f32_16x16x32_bf16 v[168:171], v[16:19], v[48:51], v[168:171]
  v_mul_f32 v249, v249, v94
  v_mul_f32 v250, v250, v95
  v_mfma_f32_16x16x32_bf16 v[172:175], v[20:23], v[48:51], v[172:175]
  v_exp_f32 v11, v11
  v_mfma_f32_16x16x32_bf16 v[172:175], v[36:39], v[52:55], v[172:175]
  v_exp_f32 v248, v248
  v_mfma_f32_16x16x32_bf16 v[156:159], v[36:39], v[84:87], v[156:159]
  v_exp_f32 v249, v249
  v_mfma_f32_16x16x32_bf16 v[156:159], v[20:23], v[80:83], v[156:159]
  v_exp_f32 v250, v250
  v_mfma_f32_16x16x32_bf16 v[160:163], v[24:27], v[80:83], v[160:163]
  v_add_f32 v11, 1.0, v11
  v_add_f32 v248, 1.0, v248
  v_mfma_f32_16x16x32_bf16 v[160:163], v[40:43], v[84:87], v[160:163]
  v_add_f32 v249, 1.0, v249
  v_add_f32 v250, 1.0, v250
  v_mfma_f32_16x16x32_bf16 v[176:179], v[40:43], v[52:55], v[176:179]
  v_rcp_f32 v11, v11
  v_mfma_f32_16x16x32_bf16 v[176:179], v[24:27], v[48:51], v[176:179]
  v_rcp_f32 v248, v248
  v_mfma_f32_16x16x32_bf16 v[180:183], v[28:31], v[48:51], v[180:183]
  v_rcp_f32 v249, v249
  v_mfma_f32_16x16x32_bf16 v[180:183], v[44:47], v[52:55], v[180:183]
  v_rcp_f32 v250, v250
  v_mfma_f32_16x16x32_bf16 v[164:167], v[44:47], v[84:87], v[164:167]
  ds_read_b128 v[84:87], v7 offset:59392
  v_mul_f32_e64 v92, v92, v11
  v_mfma_f32_16x16x32_bf16 v[164:167], v[28:31], v[80:83], v[164:167]
  ds_read_b128 v[80:83], v5 offset:59392
  v_mul_f32 v93, v93, v248
  v_mfma_f32_16x16x32_bf16 v[184:187], v[16:19], v[56:59], v[184:187]
  s_waitcnt lgkmcnt(2)
  v_mul_f32 v94, v94, v249
  v_mul_f32 v95, v95, v250
  v_mfma_f32_16x16x32_bf16 v[184:187], v[32:35], v[60:63], v[184:187]
  v_mul_f32 v11, v96, v96
  v_mul_f32 v248, v97, v97
  v_mfma_f32_16x16x32_bf16 v[200:203], v[32:35], v[68:71], v[200:203]
  v_mul_f32 v249, v98, v98
  v_mul_f32 v250, v99, v99
  v_mfma_f32_16x16x32_bf16 v[200:203], v[16:19], v[64:67], v[200:203]
  v_fma_f32 v11, v11, v14, v12
  v_fma_f32 v248, v248, v14, v12
  v_mfma_f32_16x16x32_bf16 v[204:207], v[20:23], v[64:67], v[204:207]
  v_fma_f32 v249, v249, v14, v12
  v_fma_f32 v250, v250, v14, v12
  v_mfma_f32_16x16x32_bf16 v[204:207], v[36:39], v[68:71], v[204:207]
  v_mul_f32 v11, v11, v96
  v_mul_f32 v248, v248, v97
  v_mfma_f32_16x16x32_bf16 v[188:191], v[36:39], v[60:63], v[188:191]
  v_mul_f32 v249, v249, v98
  v_mul_f32 v250, v250, v99
  v_mfma_f32_16x16x32_bf16 v[188:191], v[20:23], v[56:59], v[188:191]
  v_exp_f32 v11, v11
  v_mfma_f32_16x16x32_bf16 v[192:195], v[24:27], v[56:59], v[192:195]
  v_exp_f32 v248, v248
  v_mfma_f32_16x16x32_bf16 v[192:195], v[40:43], v[60:63], v[192:195]
  v_exp_f32_e64 v249, v249
  v_mfma_f32_16x16x32_bf16 v[208:211], v[40:43], v[68:71], v[208:211]
  v_exp_f32 v250, v250
  v_mfma_f32_16x16x32_bf16 v[208:211], v[24:27], v[64:67], v[208:211]
  v_add_f32 v11, 1.0, v11
  v_add_f32 v248, 1.0, v248
  v_mfma_f32_16x16x32_bf16 v[212:215], v[28:31], v[64:67], v[212:215]
  v_add_f32 v249, 1.0, v249
  v_add_f32 v250, 1.0, v250
  v_mfma_f32_16x16x32_bf16 v[212:215], v[44:47], v[68:71], v[212:215]
  v_rcp_f32 v11, v11
  v_mfma_f32_16x16x32_bf16 v[196:199], v[44:47], v[60:63], v[196:199]
  v_rcp_f32 v248, v248
  v_mfma_f32_16x16x32_bf16 v[196:199], v[28:31], v[56:59], v[196:199]
  v_rcp_f32 v249, v249
  v_mfma_f32_16x16x32_bf16 v[216:219], v[32:35], v[76:79], v[216:219]
  s_waitcnt lgkmcnt(0)
  v_rcp_f32 v250, v250
  v_mfma_f32_16x16x32_bf16 v[216:219], v[16:19], v[72:75], v[216:219]
  v_mul_f32 v96, v96, v11
  v_mul_f32 v97, v97, v248
  v_mfma_f32_16x16x32_bf16 v[232:235], v[16:19], v[80:83], v[232:235]
  v_mul_f32 v98, v98, v249
  v_mul_f32 v99, v99, v250
  v_mfma_f32_16x16x32_bf16 v[232:235], v[32:35], v[84:87], v[232:235]
  v_mul_f32 v11, v100, v100
  v_mul_f32 v248, v101, v101
  v_mfma_f32_16x16x32_bf16 v[236:239], v[36:39], v[84:87], v[236:239]
  v_mul_f32 v249, v102, v102
  v_mul_f32 v250, v103, v103
  v_mfma_f32_16x16x32_bf16 v[236:239], v[20:23], v[80:83], v[236:239]
  v_fma_f32 v11, v11, v14, v12
  v_fma_f32 v248, v248, v14, v12
  v_mfma_f32_16x16x32_bf16 v[220:223], v[20:23], v[72:75], v[220:223]
  v_fma_f32 v249, v249, v14, v12
  v_fma_f32 v250, v250, v14, v12
  v_mfma_f32_16x16x32_bf16 v[220:223], v[36:39], v[76:79], v[220:223]
  v_mul_f32 v11, v11, v100
  v_mul_f32 v248, v248, v101
  v_mfma_f32_16x16x32_bf16 v[224:227], v[40:43], v[76:79], v[224:227]
  v_mul_f32 v249, v249, v102
  v_mul_f32 v250, v250, v103
  v_mfma_f32_16x16x32_bf16 v[224:227], v[24:27], v[72:75], v[224:227]
  v_exp_f32_e64 v11, v11
  v_mfma_f32_16x16x32_bf16 v[240:243], v[24:27], v[80:83], v[240:243]
  v_exp_f32 v248, v248
  v_mfma_f32_16x16x32_bf16 v[240:243], v[40:43], v[84:87], v[240:243]
  v_exp_f32 v249, v249
  v_mfma_f32_16x16x32_bf16 v[244:247], v[44:47], v[84:87], v[244:247]
  v_exp_f32 v250, v250
  v_mfma_f32_16x16x32_bf16 v[244:247], v[28:31], v[80:83], v[244:247]
  v_add_f32 v11, 1.0, v11
  v_add_f32 v248, 1.0, v248
  v_mfma_f32_16x16x32_bf16 v[228:231], v[28:31], v[72:75], v[228:231]
  v_add_f32 v249, 1.0, v249
  v_add_f32 v250, 1.0, v250
  v_mfma_f32_16x16x32_bf16 v[228:231], v[44:47], v[76:79], v[228:231]
  v_rcp_f32 v11, v11
  v_rcp_f32 v248, v248
  v_rcp_f32 v249, v249
  v_rcp_f32 v250, v250
  v_mul_f32 v100, v100, v11
  v_mul_f32 v101, v101, v248
  v_mul_f32 v102, v102, v249
  v_mul_f32_e64 v103, v103, v250
  ds_read_b64 v[18:19], v9 offset:256
  ds_read_b64 v[22:23], v9 offset:288
  ds_read_b64 v[26:27], v9 offset:320
  ds_read_b64 v[30:31], v9 offset:352
  v_mov_b32 v248, 1.0
  v_mov_b32 v249, 1.0
L_epi:
  v_mov_b32 v84, 0xc1c00000
  v_mov_b32 v85, 0xc1c00000
  v_mov_b32 v86, 0x4b800000
  v_mov_b32 v87, 0x4b800000
  v_pk_mul_f32 v[52:53], v[104:105], v[104:105]
  v_pk_mul_f32 v[56:57], v[106:107], v[106:107]
  v_pk_mul_f32 v[60:61], v[108:109], v[108:109]
  v_pk_mul_f32 v[64:65], v[110:111], v[110:111]
  v_pk_mul_f32 v[68:69], v[120:121], v[120:121]
  v_pk_mul_f32 v[72:73], v[122:123], v[122:123]
  v_pk_mul_f32 v[76:77], v[124:125], v[124:125]
  v_pk_mul_f32 v[80:81], v[126:127], v[126:127]
  v_pk_fma_f32 v[52:53], v[52:53], v[14:15], v[12:13]
  v_pk_fma_f32 v[56:57], v[56:57], v[14:15], v[12:13]
  v_pk_fma_f32 v[60:61], v[60:61], v[14:15], v[12:13]
  v_pk_fma_f32 v[64:65], v[64:65], v[14:15], v[12:13]
  v_pk_fma_f32 v[68:69], v[68:69], v[14:15], v[12:13]
  v_pk_fma_f32 v[72:73], v[72:73], v[14:15], v[12:13]
  v_pk_fma_f32 v[76:77], v[76:77], v[14:15], v[12:13]
  v_pk_fma_f32 v[80:81], v[80:81], v[14:15], v[12:13]
  v_pk_fma_f32 v[52:53], v[52:53], v[104:105], v[84:85]
  v_pk_fma_f32 v[56:57], v[56:57], v[106:107], v[84:85]
  v_pk_fma_f32 v[60:61], v[60:61], v[108:109], v[84:85]
  v_pk_fma_f32 v[64:65], v[64:65], v[110:111], v[84:85]
  v_pk_fma_f32 v[68:69], v[68:69], v[120:121], v[84:85]
  v_pk_fma_f32 v[72:73], v[72:73], v[122:123], v[84:85]
  v_pk_fma_f32 v[76:77], v[76:77], v[124:125], v[84:85]
  v_pk_fma_f32 v[80:81], v[80:81], v[126:127], v[84:85]
  v_exp_f32 v52, v52 clamp
  v_exp_f32 v53, v53 clamp
  v_exp_f32 v56, v56 clamp
  v_exp_f32 v57, v57 clamp
  v_exp_f32 v60, v60 clamp
  v_exp_f32 v61, v61 clamp
  v_exp_f32 v64, v64 clamp
  v_exp_f32 v65, v65 clamp
  v_exp_f32 v68, v68 clamp
  v_exp_f32 v69, v69 clamp
  v_exp_f32 v72, v72 clamp
  v_exp_f32 v73, v73 clamp
  v_exp_f32 v76, v76 clamp
  v_exp_f32 v77, v77 clamp
  v_exp_f32 v80, v80 clamp
  v_exp_f32 v81, v81 clamp
  s_waitcnt lgkmcnt(3)
  v_lshlrev_b32 v16, 16, v18
  v_and_b32 v17, 0xffff0000, v18
  v_lshlrev_b32 v18, 16, v19
  v_and_b32 v19, 0xffff0000, v19
  s_waitcnt lgkmcnt(2)
  v_lshlrev_b32 v20, 16, v22
  v_and_b32 v21, 0xffff0000, v22
  v_lshlrev_b32 v22, 16, v23
  v_and_b32 v23, 0xffff0000, v23
  s_waitcnt lgkmcnt(1)
  v_lshlrev_b32 v24, 16, v26
  v_and_b32 v25, 0xffff0000, v26
  v_lshlrev_b32 v26, 16, v27
  v_and_b32 v27, 0xffff0000, v27
  s_waitcnt lgkmcnt(0)
  v_lshlrev_b32 v28, 16, v30
  v_and_b32 v29, 0xffff0000, v30
  v_lshlrev_b32 v30, 16, v31
  v_and_b32 v31, 0xffff0000, v31
  v_pk_mul_f32 v[54:55], v[104:105], v[16:17]
  v_pk_mul_f32 v[58:59], v[106:107], v[18:19]
  v_pk_mul_f32 v[62:63], v[108:109], v[20:21]
  v_pk_mul_f32 v[66:67], v[110:111], v[22:23]
  v_pk_mul_f32 v[70:71], v[120:121], v[16:17]
  v_pk_mul_f32 v[74:75], v[122:123], v[18:19]
  v_pk_mul_f32 v[78:79], v[124:125], v[20:21]
  v_pk_mul_f32 v[82:83], v[126:127], v[22:23]
  v_pk_fma_f32 v[52:53], v[52:53], v[86:87], v[248:249]
  v_pk_fma_f32 v[56:57], v[56:57], v[86:87], v[248:249]
  v_pk_fma_f32 v[60:61], v[60:61], v[86:87], v[248:249]
  v_pk_fma_f32 v[64:65], v[64:65], v[86:87], v[248:249]
  v_pk_fma_f32 v[68:69], v[68:69], v[86:87], v[248:249]
  v_pk_fma_f32 v[72:73], v[72:73], v[86:87], v[248:249]
  v_pk_fma_f32 v[76:77], v[76:77], v[86:87], v[248:249]
  v_pk_fma_f32 v[80:81], v[80:81], v[86:87], v[248:249]
  v_pk_mul_f32 v[54:55], v[54:55], v[56:57]
  v_pk_mul_f32 v[62:63], v[62:63], v[64:65]
  v_pk_mul_f32 v[70:71], v[70:71], v[72:73]
  v_pk_mul_f32 v[78:79], v[78:79], v[80:81]
  v_pk_fma_f32 v[54:55], v[58:59], v[52:53], v[54:55]
  v_pk_fma_f32 v[62:63], v[66:67], v[60:61], v[62:63]
  v_pk_fma_f32 v[70:71], v[74:75], v[68:69], v[70:71]
  v_pk_fma_f32 v[78:79], v[82:83], v[76:77], v[78:79]
  v_pk_mul_f32 v[52:53], v[52:53], v[56:57]
  v_pk_mul_f32 v[60:61], v[60:61], v[64:65]
  v_pk_mul_f32 v[68:69], v[68:69], v[72:73]
  v_pk_mul_f32 v[76:77], v[76:77], v[80:81]
  v_pk_mul_f32 v[54:55], v[54:55], v[60:61]
  v_pk_mul_f32 v[70:71], v[70:71], v[76:77]
  v_pk_fma_f32 v[54:55], v[62:63], v[52:53], v[54:55]
  v_pk_fma_f32 v[70:71], v[78:79], v[68:69], v[70:71]
  v_pk_mul_f32 v[52:53], v[52:53], v[60:61]
  v_pk_mul_f32 v[68:69], v[68:69], v[76:77]
  v_rcp_f32 v52, v52
  v_rcp_f32 v53, v53
  v_rcp_f32 v68, v68
  v_rcp_f32 v69, v69
  v_pk_mul_f32 v[34:35], v[52:53], v[54:55]
  v_pk_mul_f32 v[36:37], v[68:69], v[70:71]
  v_pk_mul_f32 v[52:53], v[112:113], v[112:113]
  v_pk_mul_f32 v[56:57], v[114:115], v[114:115]
  v_pk_mul_f32 v[60:61], v[116:117], v[116:117]
  v_pk_mul_f32 v[64:65], v[118:119], v[118:119]
  v_pk_mul_f32 v[68:69], v[128:129], v[128:129]
  v_pk_mul_f32 v[72:73], v[130:131], v[130:131]
  v_pk_mul_f32 v[76:77], v[132:133], v[132:133]
  v_pk_mul_f32 v[80:81], v[134:135], v[134:135]
  v_pk_fma_f32 v[52:53], v[52:53], v[14:15], v[12:13]
  v_pk_fma_f32 v[56:57], v[56:57], v[14:15], v[12:13]
  v_pk_fma_f32 v[60:61], v[60:61], v[14:15], v[12:13]
  v_pk_fma_f32 v[64:65], v[64:65], v[14:15], v[12:13]
  v_pk_fma_f32 v[68:69], v[68:69], v[14:15], v[12:13]
  v_pk_fma_f32 v[72:73], v[72:73], v[14:15], v[12:13]
  v_pk_fma_f32 v[76:77], v[76:77], v[14:15], v[12:13]
  v_pk_fma_f32 v[80:81], v[80:81], v[14:15], v[12:13]
  v_pk_fma_f32 v[52:53], v[52:53], v[112:113], v[84:85]
  v_pk_fma_f32 v[56:57], v[56:57], v[114:115], v[84:85]
  v_pk_fma_f32 v[60:61], v[60:61], v[116:117], v[84:85]
  v_pk_fma_f32 v[64:65], v[64:65], v[118:119], v[84:85]
  v_pk_fma_f32 v[68:69], v[68:69], v[128:129], v[84:85]
  v_pk_fma_f32 v[72:73], v[72:73], v[130:131], v[84:85]
  v_pk_fma_f32 v[76:77], v[76:77], v[132:133], v[84:85]
  v_pk_fma_f32 v[80:81], v[80:81], v[134:135], v[84:85]
  v_exp_f32 v52, v52 clamp
  v_exp_f32 v53, v53 clamp
  v_exp_f32 v56, v56 clamp
  v_exp_f32 v57, v57 clamp
  v_exp_f32 v60, v60 clamp
  v_exp_f32 v61, v61 clamp
  v_exp_f32 v64, v64 clamp
  v_exp_f32 v65, v65 clamp
  v_exp_f32 v68, v68 clamp
  v_exp_f32 v69, v69 clamp
  v_exp_f32 v72, v72 clamp
  v_exp_f32 v73, v73 clamp
  v_exp_f32 v76, v76 clamp
  v_exp_f32 v77, v77 clamp
  v_exp_f32 v80, v80 clamp
  v_exp_f32 v81, v81 clamp
  v_pk_mul_f32 v[54:55], v[112:113], v[24:25]
  v_pk_mul_f32 v[58:59], v[114:115], v[26:27]
  v_pk_mul_f32 v[62:63], v[116:117], v[28:29]
  v_pk_mul_f32 v[66:67], v[118:119], v[30:31]
  v_pk_mul_f32 v[70:71], v[128:129], v[24:25]
  v_pk_mul_f32 v[74:75], v[130:131], v[26:27]
  v_pk_mul_f32 v[78:79], v[132:133], v[28:29]
  v_pk_mul_f32 v[82:83], v[134:135], v[30:31]
  v_pk_fma_f32 v[52:53], v[52:53], v[86:87], v[248:249]
  v_pk_fma_f32 v[56:57], v[56:57], v[86:87], v[248:249]
  v_pk_fma_f32 v[60:61], v[60:61], v[86:87], v[248:249]
  v_pk_fma_f32 v[64:65], v[64:65], v[86:87], v[248:249]
  v_pk_fma_f32 v[68:69], v[68:69], v[86:87], v[248:249]
  v_pk_fma_f32 v[72:73], v[72:73], v[86:87], v[248:249]
  v_pk_fma_f32 v[76:77], v[76:77], v[86:87], v[248:249]
  v_pk_fma_f32 v[80:81], v[80:81], v[86:87], v[248:249]
  v_pk_mul_f32 v[54:55], v[54:55], v[56:57]
  v_pk_mul_f32 v[62:63], v[62:63], v[64:65]
  v_pk_mul_f32 v[70:71], v[70:71], v[72:73]
  v_pk_mul_f32 v[78:79], v[78:79], v[80:81]
  v_pk_fma_f32 v[54:55], v[58:59], v[52:53], v[54:55]
  v_pk_fma_f32 v[62:63], v[66:67], v[60:61], v[62:63]
  v_pk_fma_f32 v[70:71], v[74:75], v[68:69], v[70:71]
  v_pk_fma_f32 v[78:79], v[82:83], v[76:77], v[78:79]
  v_pk_mul_f32 v[52:53], v[52:53], v[56:57]
  v_pk_mul_f32 v[60:61], v[60:61], v[64:65]
  v_pk_mul_f32 v[68:69], v[68:69], v[72:73]
  v_pk_mul_f32 v[76:77], v[76:77], v[80:81]
  v_pk_mul_f32 v[54:55], v[54:55], v[60:61]
  v_pk_mul_f32 v[70:71], v[70:71], v[76:77]
  v_pk_fma_f32 v[54:55], v[62:63], v[52:53], v[54:55]
  v_pk_fma_f32 v[70:71], v[78:79], v[68:69], v[70:71]
  v_pk_mul_f32 v[52:53], v[52:53], v[60:61]
  v_pk_mul_f32 v[68:69], v[68:69], v[76:77]
  v_rcp_f32 v52, v52
  v_rcp_f32 v53, v53
  v_rcp_f32 v68, v68
  v_rcp_f32 v69, v69
  v_pk_fma_f32 v[34:35], v[52:53], v[54:55], v[34:35]
  v_pk_fma_f32 v[36:37], v[68:69], v[70:71], v[36:37]
  v_pk_mul_f32 v[52:53], v[136:137], v[136:137]
  v_pk_mul_f32 v[56:57], v[138:139], v[138:139]
  v_pk_mul_f32 v[60:61], v[140:141], v[140:141]
  v_pk_mul_f32 v[64:65], v[142:143], v[142:143]
  v_pk_mul_f32 v[68:69], v[152:153], v[152:153]
  v_pk_mul_f32 v[72:73], v[154:155], v[154:155]
  v_pk_mul_f32 v[76:77], v[156:157], v[156:157]
  v_pk_mul_f32 v[80:81], v[158:159], v[158:159]
  v_pk_fma_f32 v[52:53], v[52:53], v[14:15], v[12:13]
  v_pk_fma_f32 v[56:57], v[56:57], v[14:15], v[12:13]
  v_pk_fma_f32 v[60:61], v[60:61], v[14:15], v[12:13]
  v_pk_fma_f32 v[64:65], v[64:65], v[14:15], v[12:13]
  v_pk_fma_f32 v[68:69], v[68:69], v[14:15], v[12:13]
  v_pk_fma_f32 v[72:73], v[72:73], v[14:15], v[12:13]
  v_pk_fma_f32 v[76:77], v[76:77], v[14:15], v[12:13]
  v_pk_fma_f32 v[80:81], v[80:81], v[14:15], v[12:13]
  v_pk_fma_f32 v[52:53], v[52:53], v[136:137], v[84:85]
  v_pk_fma_f32 v[56:57], v[56:57], v[138:139], v[84:85]
  v_pk_fma_f32 v[60:61], v[60:61], v[140:141], v[84:85]
  v_pk_fma_f32 v[64:65], v[64:65], v[142:143], v[84:85]
  v_pk_fma_f32 v[68:69], v[68:69], v[152:153], v[84:85]
  v_pk_fma_f32 v[72:73], v[72:73], v[154:155], v[84:85]
  v_pk_fma_f32 v[76:77], v[76:77], v[156:157], v[84:85]
  v_pk_fma_f32 v[80:81], v[80:81], v[158:159], v[84:85]
  v_exp_f32 v52, v52 clamp
  v_exp_f32 v53, v53 clamp
  v_exp_f32 v56, v56 clamp
  v_exp_f32 v57, v57 clamp
  v_exp_f32 v60, v60 clamp
  v_exp_f32 v61, v61 clamp
  v_exp_f32 v64, v64 clamp
  v_exp_f32 v65, v65 clamp
  v_exp_f32 v68, v68 clamp
  v_exp_f32 v69, v69 clamp
  v_exp_f32 v72, v72 clamp
  v_exp_f32 v73, v73 clamp
  v_exp_f32 v76, v76 clamp
  v_exp_f32 v77, v77 clamp
  v_exp_f32 v80, v80 clamp
  v_exp_f32 v81, v81 clamp
  v_pk_mul_f32 v[54:55], v[136:137], v[16:17]
  v_pk_mul_f32 v[58:59], v[138:139], v[18:19]
  v_pk_mul_f32 v[62:63], v[140:141], v[20:21]
  v_pk_mul_f32 v[66:67], v[142:143], v[22:23]
  v_pk_mul_f32 v[70:71], v[152:153], v[16:17]
  v_pk_mul_f32 v[74:75], v[154:155], v[18:19]
  v_pk_mul_f32 v[78:79], v[156:157], v[20:21]
  v_pk_mul_f32 v[82:83], v[158:159], v[22:23]
  v_pk_fma_f32 v[52:53], v[52:53], v[86:87], v[248:249]
  v_pk_fma_f32 v[56:57], v[56:57], v[86:87], v[248:249]
  v_pk_fma_f32 v[60:61], v[60:61], v[86:87], v[248:249]
  v_pk_fma_f32 v[64:65], v[64:65], v[86:87], v[248:249]
  v_pk_fma_f32 v[68:69], v[68:69], v[86:87], v[248:249]
  v_pk_fma_f32 v[72:73], v[72:73], v[86:87], v[248:249]
  v_pk_fma_f32 v[76:77], v[76:77], v[86:87], v[248:249]
  v_pk_fma_f32 v[80:81], v[80:81], v[86:87], v[248:249]
  v_pk_mul_f32 v[54:55], v[54:55], v[56:57]
  v_pk_mul_f32 v[62:63], v[62:63], v[64:65]
  v_pk_mul_f32 v[70:71], v[70:71], v[72:73]
  v_pk_mul_f32 v[78:79], v[78:79], v[80:81]
  v_pk_fma_f32 v[54:55], v[58:59], v[52:53], v[54:55]
  v_pk_fma_f32 v[62:63], v[66:67], v[60:61], v[62:63]
  v_pk_fma_f32 v[70:71], v[74:75], v[68:69], v[70:71]
  v_pk_fma_f32 v[78:79], v[82:83], v[76:77], v[78:79]
  v_pk_mul_f32 v[52:53], v[52:53], v[56:57]
  v_pk_mul_f32 v[60:61], v[60:61], v[64:65]
  v_pk_mul_f32 v[68:69], v[68:69], v[72:73]
  v_pk_mul_f32 v[76:77], v[76:77], v[80:81]
  v_pk_mul_f32 v[54:55], v[54:55], v[60:61]
  v_pk_mul_f32 v[70:71], v[70:71], v[76:77]
  v_pk_fma_f32 v[54:55], v[62:63], v[52:53], v[54:55]
  v_pk_fma_f32 v[70:71], v[78:79], v[68:69], v[70:71]
  v_pk_mul_f32 v[52:53], v[52:53], v[60:61]
  v_pk_mul_f32 v[68:69], v[68:69], v[76:77]
  v_rcp_f32 v52, v52
  v_rcp_f32 v53, v53
  v_rcp_f32 v68, v68
  v_rcp_f32 v69, v69
  v_pk_mul_f32 v[38:39], v[52:53], v[54:55]
  v_pk_mul_f32 v[40:41], v[68:69], v[70:71]
  v_pk_mul_f32 v[52:53], v[144:145], v[144:145]
  v_pk_mul_f32 v[56:57], v[146:147], v[146:147]
  v_pk_mul_f32 v[60:61], v[148:149], v[148:149]
  v_pk_mul_f32 v[64:65], v[150:151], v[150:151]
  v_pk_mul_f32 v[68:69], v[160:161], v[160:161]
  v_pk_mul_f32 v[72:73], v[162:163], v[162:163]
  v_pk_mul_f32 v[76:77], v[164:165], v[164:165]
  v_pk_mul_f32 v[80:81], v[166:167], v[166:167]
  v_pk_fma_f32 v[52:53], v[52:53], v[14:15], v[12:13]
  v_pk_fma_f32 v[56:57], v[56:57], v[14:15], v[12:13]
  v_pk_fma_f32 v[60:61], v[60:61], v[14:15], v[12:13]
  v_pk_fma_f32 v[64:65], v[64:65], v[14:15], v[12:13]
  v_pk_fma_f32 v[68:69], v[68:69], v[14:15], v[12:13]
  v_pk_fma_f32 v[72:73], v[72:73], v[14:15], v[12:13]
  v_pk_fma_f32 v[76:77], v[76:77], v[14:15], v[12:13]
  v_pk_fma_f32 v[80:81], v[80:81], v[14:15], v[12:13]
  v_pk_fma_f32 v[52:53], v[52:53], v[144:145], v[84:85]
  v_pk_fma_f32 v[56:57], v[56:57], v[146:147], v[84:85]
  v_pk_fma_f32 v[60:61], v[60:61], v[148:149], v[84:85]
  v_pk_fma_f32 v[64:65], v[64:65], v[150:151], v[84:85]
  v_pk_fma_f32 v[68:69], v[68:69], v[160:161], v[84:85]
  v_pk_fma_f32 v[72:73], v[72:73], v[162:163], v[84:85]
  v_pk_fma_f32 v[76:77], v[76:77], v[164:165], v[84:85]
  v_pk_fma_f32 v[80:81], v[80:81], v[166:167], v[84:85]
  v_exp_f32 v52, v52 clamp
  v_exp_f32 v53, v53 clamp
  v_exp_f32 v56, v56 clamp
  v_exp_f32 v57, v57 clamp
  v_exp_f32 v60, v60 clamp
  v_exp_f32 v61, v61 clamp
  v_exp_f32 v64, v64 clamp
  v_exp_f32 v65, v65 clamp
  v_exp_f32 v68, v68 clamp
  v_exp_f32 v69, v69 clamp
  v_exp_f32 v72, v72 clamp
  v_exp_f32 v73, v73 clamp
  v_exp_f32 v76, v76 clamp
  v_exp_f32 v77, v77 clamp
  v_exp_f32 v80, v80 clamp
  v_exp_f32 v81, v81 clamp
  v_pk_mul_f32 v[54:55], v[144:145], v[24:25]
  v_pk_mul_f32 v[58:59], v[146:147], v[26:27]
  v_pk_mul_f32 v[62:63], v[148:149], v[28:29]
  v_pk_mul_f32 v[66:67], v[150:151], v[30:31]
  v_pk_mul_f32 v[70:71], v[160:161], v[24:25]
  v_pk_mul_f32 v[74:75], v[162:163], v[26:27]
  v_pk_mul_f32 v[78:79], v[164:165], v[28:29]
  v_pk_mul_f32 v[82:83], v[166:167], v[30:31]
  v_pk_fma_f32 v[52:53], v[52:53], v[86:87], v[248:249]
  v_pk_fma_f32 v[56:57], v[56:57], v[86:87], v[248:249]
  v_pk_fma_f32 v[60:61], v[60:61], v[86:87], v[248:249]
  v_pk_fma_f32 v[64:65], v[64:65], v[86:87], v[248:249]
  v_pk_fma_f32 v[68:69], v[68:69], v[86:87], v[248:249]
  v_pk_fma_f32 v[72:73], v[72:73], v[86:87], v[248:249]
  v_pk_fma_f32 v[76:77], v[76:77], v[86:87], v[248:249]
  v_pk_fma_f32 v[80:81], v[80:81], v[86:87], v[248:249]
  v_pk_mul_f32 v[54:55], v[54:55], v[56:57]
  v_pk_mul_f32 v[62:63], v[62:63], v[64:65]
  v_pk_mul_f32 v[70:71], v[70:71], v[72:73]
  v_pk_mul_f32 v[78:79], v[78:79], v[80:81]
  v_pk_fma_f32 v[54:55], v[58:59], v[52:53], v[54:55]
  v_pk_fma_f32 v[62:63], v[66:67], v[60:61], v[62:63]
  v_pk_fma_f32 v[70:71], v[74:75], v[68:69], v[70:71]
  v_pk_fma_f32 v[78:79], v[82:83], v[76:77], v[78:79]
  v_pk_mul_f32 v[52:53], v[52:53], v[56:57]
  v_pk_mul_f32 v[60:61], v[60:61], v[64:65]
  v_pk_mul_f32 v[68:69], v[68:69], v[72:73]
  v_pk_mul_f32 v[76:77], v[76:77], v[80:81]
  v_pk_mul_f32 v[54:55], v[54:55], v[60:61]
  v_pk_mul_f32 v[70:71], v[70:71], v[76:77]
  v_pk_fma_f32 v[54:55], v[62:63], v[52:53], v[54:55]
  v_pk_fma_f32 v[70:71], v[78:79], v[68:69], v[70:71]
  v_pk_mul_f32 v[52:53], v[52:53], v[60:61]
  v_pk_mul_f32 v[68:69], v[68:69], v[76:77]
  v_rcp_f32 v52, v52
  v_rcp_f32 v53, v53
  v_rcp_f32 v68, v68
  v_rcp_f32 v69, v69
  v_pk_fma_f32 v[38:39], v[52:53], v[54:55], v[38:39]
  v_pk_fma_f32 v[40:41], v[68:69], v[70:71], v[40:41]
  v_pk_mul_f32 v[52:53], v[168:169], v[168:169]
  v_pk_mul_f32 v[56:57], v[170:171], v[170:171]
  v_pk_mul_f32 v[60:61], v[172:173], v[172:173]
  v_pk_mul_f32 v[64:65], v[174:175], v[174:175]
  v_pk_mul_f32 v[68:69], v[184:185], v[184:185]
  v_pk_mul_f32 v[72:73], v[186:187], v[186:187]
  v_pk_mul_f32 v[76:77], v[188:189], v[188:189]
  v_pk_mul_f32 v[80:81], v[190:191], v[190:191]
  v_pk_fma_f32 v[52:53], v[52:53], v[14:15], v[12:13]
  v_pk_fma_f32 v[56:57], v[56:57], v[14:15], v[12:13]
  v_pk_fma_f32 v[60:61], v[60:61], v[14:15], v[12:13]
  v_pk_fma_f32 v[64:65], v[64:65], v[14:15], v[12:13]
  v_pk_fma_f32 v[68:69], v[68:69], v[14:15], v[12:13]
  v_pk_fma_f32 v[72:73], v[72:73], v[14:15], v[12:13]
  v_pk_fma_f32 v[76:77], v[76:77], v[14:15], v[12:13]
  v_pk_fma_f32 v[80:81], v[80:81], v[14:15], v[12:13]
  v_pk_fma_f32 v[52:53], v[52:53], v[168:169], v[84:85]
  v_pk_fma_f32 v[56:57], v[56:57], v[170:171], v[84:85]
  v_pk_fma_f32 v[60:61], v[60:61], v[172:173], v[84:85]
  v_pk_fma_f32 v[64:65], v[64:65], v[174:175], v[84:85]
  v_pk_fma_f32 v[68:69], v[68:69], v[184:185], v[84:85]
  v_pk_fma_f32 v[72:73], v[72:73], v[186:187], v[84:85]
  v_pk_fma_f32 v[76:77], v[76:77], v[188:189], v[84:85]
  v_pk_fma_f32 v[80:81], v[80:81], v[190:191], v[84:85]
  v_exp_f32 v52, v52 clamp
  v_exp_f32 v53, v53 clamp
  v_exp_f32 v56, v56 clamp
  v_exp_f32 v57, v57 clamp
  v_exp_f32 v60, v60 clamp
  v_exp_f32 v61, v61 clamp
  v_exp_f32 v64, v64 clamp
  v_exp_f32 v65, v65 clamp
  v_exp_f32 v68, v68 clamp
  v_exp_f32 v69, v69 clamp
  v_exp_f32 v72, v72 clamp
  v_exp_f32 v73, v73 clamp
  v_exp_f32 v76, v76 clamp
  v_exp_f32 v77, v77 clamp
  v_exp_f32 v80, v80 clamp
  v_exp_f32 v81, v81 clamp
  v_pk_mul_f32 v[54:55], v[168:169], v[16:17]
  v_pk_mul_f32 v[58:59], v[170:171], v[18:19]
  v_pk_mul_f32 v[62:63], v[172:173], v[20:21]
  v_pk_mul_f32 v[66:67], v[174:175], v[22:23]
  v_pk_mul_f32 v[70:71], v[184:185], v[16:17]
  v_pk_mul_f32 v[74:75], v[186:187], v[18:19]
  v_pk_mul_f32 v[78:79], v[188:189], v[20:21]
  v_pk_mul_f32 v[82:83], v[190:191], v[22:23]
  v_pk_fma_f32 v[52:53], v[52:53], v[86:87], v[248:249]
  v_pk_fma_f32 v[56:57], v[56:57], v[86:87], v[248:249]
  v_pk_fma_f32 v[60:61], v[60:61], v[86:87], v[248:249]
  v_pk_fma_f32 v[64:65], v[64:65], v[86:87], v[248:249]
  v_pk_fma_f32 v[68:69], v[68:69], v[86:87], v[248:249]
  v_pk_fma_f32 v[72:73], v[72:73], v[86:87], v[248:249]
  v_pk_fma_f32 v[76:77], v[76:77], v[86:87], v[248:249]
  v_pk_fma_f32 v[80:81], v[80:81], v[86:87], v[248:249]
  v_pk_mul_f32 v[54:55], v[54:55], v[56:57]
  v_pk_mul_f32 v[62:63], v[62:63], v[64:65]
  v_pk_mul_f32 v[70:71], v[70:71], v[72:73]
  v_pk_mul_f32 v[78:79], v[78:79], v[80:81]
  v_pk_fma_f32 v[54:55], v[58:59], v[52:53], v[54:55]
  v_pk_fma_f32 v[62:63], v[66:67], v[60:61], v[62:63]
  v_pk_fma_f32 v[70:71], v[74:75], v[68:69], v[70:71]
  v_pk_fma_f32 v[78:79], v[82:83], v[76:77], v[78:79]
  v_pk_mul_f32 v[52:53], v[52:53], v[56:57]
  v_pk_mul_f32 v[60:61], v[60:61], v[64:65]
  v_pk_mul_f32 v[68:69], v[68:69], v[72:73]
  v_pk_mul_f32 v[76:77], v[76:77], v[80:81]
  v_pk_mul_f32 v[54:55], v[54:55], v[60:61]
  v_pk_mul_f32 v[70:71], v[70:71], v[76:77]
  v_pk_fma_f32 v[54:55], v[62:63], v[52:53], v[54:55]
  v_pk_fma_f32 v[70:71], v[78:79], v[68:69], v[70:71]
  v_pk_mul_f32 v[52:53], v[52:53], v[60:61]
  v_pk_mul_f32 v[68:69], v[68:69], v[76:77]
  v_rcp_f32 v52, v52
  v_rcp_f32 v53, v53
  v_rcp_f32 v68, v68
  v_rcp_f32 v69, v69
  v_pk_mul_f32 v[42:43], v[52:53], v[54:55]
  v_pk_mul_f32 v[44:45], v[68:69], v[70:71]
  v_pk_mul_f32 v[52:53], v[176:177], v[176:177]
  v_pk_mul_f32 v[56:57], v[178:179], v[178:179]
  v_pk_mul_f32 v[60:61], v[180:181], v[180:181]
  v_pk_mul_f32 v[64:65], v[182:183], v[182:183]
  v_pk_mul_f32 v[68:69], v[192:193], v[192:193]
  v_pk_mul_f32 v[72:73], v[194:195], v[194:195]
  v_pk_mul_f32 v[76:77], v[196:197], v[196:197]
  v_pk_mul_f32 v[80:81], v[198:199], v[198:199]
  v_pk_fma_f32 v[52:53], v[52:53], v[14:15], v[12:13]
  v_pk_fma_f32 v[56:57], v[56:57], v[14:15], v[12:13]
  v_pk_fma_f32 v[60:61], v[60:61], v[14:15], v[12:13]
  v_pk_fma_f32 v[64:65], v[64:65], v[14:15], v[12:13]
  v_pk_fma_f32 v[68:69], v[68:69], v[14:15], v[12:13]
  v_pk_fma_f32 v[72:73], v[72:73], v[14:15], v[12:13]
  v_pk_fma_f32 v[76:77], v[76:77], v[14:15], v[12:13]
  v_pk_fma_f32 v[80:81], v[80:81], v[14:15], v[12:13]
  v_pk_fma_f32 v[52:53], v[52:53], v[176:177], v[84:85]
  v_pk_fma_f32 v[56:57], v[56:57], v[178:179], v[84:85]
  v_pk_fma_f32 v[60:61], v[60:61], v[180:181], v[84:85]
  v_pk_fma_f32 v[64:65], v[64:65], v[182:183], v[84:85]
  v_pk_fma_f32 v[68:69], v[68:69], v[192:193], v[84:85]
  v_pk_fma_f32 v[72:73], v[72:73], v[194:195], v[84:85]
  v_pk_fma_f32 v[76:77], v[76:77], v[196:197], v[84:85]
  v_pk_fma_f32 v[80:81], v[80:81], v[198:199], v[84:85]
  v_exp_f32 v52, v52 clamp
  v_exp_f32 v53, v53 clamp
  v_exp_f32 v56, v56 clamp
  v_exp_f32 v57, v57 clamp
  v_exp_f32 v60, v60 clamp
  v_exp_f32 v61, v61 clamp
  v_exp_f32 v64, v64 clamp
  v_exp_f32 v65, v65 clamp
  v_exp_f32 v68, v68 clamp
  v_exp_f32 v69, v69 clamp
  v_exp_f32 v72, v72 clamp
  v_exp_f32 v73, v73 clamp
  v_exp_f32 v76, v76 clamp
  v_exp_f32 v77, v77 clamp
  v_exp_f32 v80, v80 clamp
  v_exp_f32 v81, v81 clamp
  v_pk_mul_f32 v[54:55], v[176:177], v[24:25]
  v_pk_mul_f32 v[58:59], v[178:179], v[26:27]
  v_pk_mul_f32 v[62:63], v[180:181], v[28:29]
  v_pk_mul_f32 v[66:67], v[182:183], v[30:31]
  v_pk_mul_f32 v[70:71], v[192:193], v[24:25]
  v_pk_mul_f32 v[74:75], v[194:195], v[26:27]
  v_pk_mul_f32 v[78:79], v[196:197], v[28:29]
  v_pk_mul_f32 v[82:83], v[198:199], v[30:31]
  v_pk_fma_f32 v[52:53], v[52:53], v[86:87], v[248:249]
  v_pk_fma_f32 v[56:57], v[56:57], v[86:87], v[248:249]
  v_pk_fma_f32 v[60:61], v[60:61], v[86:87], v[248:249]
  v_pk_fma_f32 v[64:65], v[64:65], v[86:87], v[248:249]
  v_pk_fma_f32 v[68:69], v[68:69], v[86:87], v[248:249]
  v_pk_fma_f32 v[72:73], v[72:73], v[86:87], v[248:249]
  v_pk_fma_f32 v[76:77], v[76:77], v[86:87], v[248:249]
  v_pk_fma_f32 v[80:81], v[80:81], v[86:87], v[248:249]
  v_pk_mul_f32 v[54:55], v[54:55], v[56:57]
  v_pk_mul_f32 v[62:63], v[62:63], v[64:65]
  v_pk_mul_f32 v[70:71], v[70:71], v[72:73]
  v_pk_mul_f32 v[78:79], v[78:79], v[80:81]
  v_pk_fma_f32 v[54:55], v[58:59], v[52:53], v[54:55]
  v_pk_fma_f32 v[62:63], v[66:67], v[60:61], v[62:63]
  v_pk_fma_f32 v[70:71], v[74:75], v[68:69], v[70:71]
  v_pk_fma_f32 v[78:79], v[82:83], v[76:77], v[78:79]
  v_pk_mul_f32 v[52:53], v[52:53], v[56:57]
  v_pk_mul_f32 v[60:61], v[60:61], v[64:65]
  v_pk_mul_f32 v[68:69], v[68:69], v[72:73]
  v_pk_mul_f32 v[76:77], v[76:77], v[80:81]
  v_pk_mul_f32 v[54:55], v[54:55], v[60:61]
  v_pk_mul_f32 v[70:71], v[70:71], v[76:77]
  v_pk_fma_f32 v[54:55], v[62:63], v[52:53], v[54:55]
  v_pk_fma_f32 v[70:71], v[78:79], v[68:69], v[70:71]
  v_pk_mul_f32 v[52:53], v[52:53], v[60:61]
  v_pk_mul_f32 v[68:69], v[68:69], v[76:77]
  v_rcp_f32 v52, v52
  v_rcp_f32 v53, v53
  v_rcp_f32 v68, v68
  v_rcp_f32 v69, v69
  v_pk_fma_f32 v[42:43], v[52:53], v[54:55], v[42:43]
  v_pk_fma_f32 v[44:45], v[68:69], v[70:71], v[44:45]
  v_pk_mul_f32 v[52:53], v[200:201], v[200:201]
  v_pk_mul_f32 v[56:57], v[202:203], v[202:203]
  v_pk_mul_f32 v[60:61], v[204:205], v[204:205]
  v_pk_mul_f32 v[64:65], v[206:207], v[206:207]
  v_pk_mul_f32 v[68:69], v[216:217], v[216:217]
  v_pk_mul_f32 v[72:73], v[218:219], v[218:219]
  v_pk_mul_f32 v[76:77], v[220:221], v[220:221]
  v_pk_mul_f32 v[80:81], v[222:223], v[222:223]
  v_pk_fma_f32 v[52:53], v[52:53], v[14:15], v[12:13]
  v_pk_fma_f32 v[56:57], v[56:57], v[14:15], v[12:13]
  v_pk_fma_f32 v[60:61], v[60:61], v[14:15], v[12:13]
  v_pk_fma_f32 v[64:65], v[64:65], v[14:15], v[12:13]
  v_pk_fma_f32 v[68:69], v[68:69], v[14:15], v[12:13]
  v_pk_fma_f32 v[72:73], v[72:73], v[14:15], v[12:13]
  v_pk_fma_f32 v[76:77], v[76:77], v[14:15], v[12:13]
  v_pk_fma_f32 v[80:81], v[80:81], v[14:15], v[12:13]
  v_pk_fma_f32 v[52:53], v[52:53], v[200:201], v[84:85]
  v_pk_fma_f32 v[56:57], v[56:57], v[202:203], v[84:85]
  v_pk_fma_f32 v[60:61], v[60:61], v[204:205], v[84:85]
  v_pk_fma_f32 v[64:65], v[64:65], v[206:207], v[84:85]
  v_pk_fma_f32 v[68:69], v[68:69], v[216:217], v[84:85]
  v_pk_fma_f32 v[72:73], v[72:73], v[218:219], v[84:85]
  v_pk_fma_f32 v[76:77], v[76:77], v[220:221], v[84:85]
  v_pk_fma_f32 v[80:81], v[80:81], v[222:223], v[84:85]
  v_exp_f32 v52, v52 clamp
  v_exp_f32 v53, v53 clamp
  v_exp_f32 v56, v56 clamp
  v_exp_f32 v57, v57 clamp
  v_exp_f32 v60, v60 clamp
  v_exp_f32 v61, v61 clamp
  v_exp_f32 v64, v64 clamp
  v_exp_f32 v65, v65 clamp
  v_exp_f32 v68, v68 clamp
  v_exp_f32 v69, v69 clamp
  v_exp_f32 v72, v72 clamp
  v_exp_f32 v73, v73 clamp
  v_exp_f32 v76, v76 clamp
  v_exp_f32 v77, v77 clamp
  v_exp_f32 v80, v80 clamp
  v_exp_f32 v81, v81 clamp
  v_pk_mul_f32 v[54:55], v[200:201], v[16:17]
  v_pk_mul_f32 v[58:59], v[202:203], v[18:19]
  v_pk_mul_f32 v[62:63], v[204:205], v[20:21]
  v_pk_mul_f32 v[66:67], v[206:207], v[22:23]
  v_pk_mul_f32 v[70:71], v[216:217], v[16:17]
  v_pk_mul_f32 v[74:75], v[218:219], v[18:19]
  v_pk_mul_f32 v[78:79], v[220:221], v[20:21]
  v_pk_mul_f32 v[82:83], v[222:223], v[22:23]
  v_pk_fma_f32 v[52:53], v[52:53], v[86:87], v[248:249]
  v_pk_fma_f32 v[56:57], v[56:57], v[86:87], v[248:249]
  v_pk_fma_f32 v[60:61], v[60:61], v[86:87], v[248:249]
  v_pk_fma_f32 v[64:65], v[64:65], v[86:87], v[248:249]
  v_pk_fma_f32 v[68:69], v[68:69], v[86:87], v[248:249]
  v_pk_fma_f32 v[72:73], v[72:73], v[86:87], v[248:249]
  v_pk_fma_f32 v[76:77], v[76:77], v[86:87], v[248:249]
  v_pk_fma_f32 v[80:81], v[80:81], v[86:87], v[248:249]
  v_pk_mul_f32 v[54:55], v[54:55], v[56:57]
  v_pk_mul_f32 v[62:63], v[62:63], v[64:65]
  v_pk_mul_f32 v[70:71], v[70:71], v[72:73]
  v_pk_mul_f32 v[78:79], v[78:79], v[80:81]
  v_pk_fma_f32 v[54:55], v[58:59], v[52:53], v[54:55]
  v_pk_fma_f32 v[62:63], v[66:67], v[60:61], v[62:63]
  v_pk_fma_f32 v[70:71], v[74:75], v[68:69], v[70:71]
  v_pk_fma_f32 v[78:79], v[82:83], v[76:77], v[78:79]
  v_pk_mul_f32 v[52:53], v[52:53], v[56:57]
  v_pk_mul_f32 v[60:61], v[60:61], v[64:65]
  v_pk_mul_f32 v[68:69], v[68:69], v[72:73]
  v_pk_mul_f32 v[76:77], v[76:77], v[80:81]
  v_pk_mul_f32 v[54:55], v[54:55], v[60:61]
  v_pk_mul_f32 v[70:71], v[70:71], v[76:77]
  v_pk_fma_f32 v[54:55], v[62:63], v[52:53], v[54:55]
  v_pk_fma_f32 v[70:71], v[78:79], v[68:69], v[70:71]
  v_pk_mul_f32 v[52:53], v[52:53], v[60:61]
  v_pk_mul_f32 v[68:69], v[68:69], v[76:77]
  v_rcp_f32 v52, v52
  v_rcp_f32 v53, v53
  v_rcp_f32 v68, v68
  v_rcp_f32 v69, v69
  v_pk_mul_f32 v[46:47], v[52:53], v[54:55]
  v_pk_mul_f32 v[48:49], v[68:69], v[70:71]
  v_pk_mul_f32 v[52:53], v[208:209], v[208:209]
  v_pk_mul_f32 v[56:57], v[210:211], v[210:211]
  v_pk_mul_f32 v[60:61], v[212:213], v[212:213]
  v_pk_mul_f32 v[64:65], v[214:215], v[214:215]
  v_pk_mul_f32 v[68:69], v[224:225], v[224:225]
  v_pk_mul_f32 v[72:73], v[226:227], v[226:227]
  v_pk_mul_f32 v[76:77], v[228:229], v[228:229]
  v_pk_mul_f32 v[80:81], v[230:231], v[230:231]
  v_pk_fma_f32 v[52:53], v[52:53], v[14:15], v[12:13]
  v_pk_fma_f32 v[56:57], v[56:57], v[14:15], v[12:13]
  v_pk_fma_f32 v[60:61], v[60:61], v[14:15], v[12:13]
  v_pk_fma_f32 v[64:65], v[64:65], v[14:15], v[12:13]
  v_pk_fma_f32 v[68:69], v[68:69], v[14:15], v[12:13]
  v_pk_fma_f32 v[72:73], v[72:73], v[14:15], v[12:13]
  v_pk_fma_f32 v[76:77], v[76:77], v[14:15], v[12:13]
  v_pk_fma_f32 v[80:81], v[80:81], v[14:15], v[12:13]
  v_pk_fma_f32 v[52:53], v[52:53], v[208:209], v[84:85]
  v_pk_fma_f32 v[56:57], v[56:57], v[210:211], v[84:85]
  v_pk_fma_f32 v[60:61], v[60:61], v[212:213], v[84:85]
  v_pk_fma_f32 v[64:65], v[64:65], v[214:215], v[84:85]
  v_pk_fma_f32 v[68:69], v[68:69], v[224:225], v[84:85]
  v_pk_fma_f32 v[72:73], v[72:73], v[226:227], v[84:85]
  v_pk_fma_f32 v[76:77], v[76:77], v[228:229], v[84:85]
  v_pk_fma_f32 v[80:81], v[80:81], v[230:231], v[84:85]
  v_exp_f32 v52, v52 clamp
  v_exp_f32 v53, v53 clamp
  v_exp_f32 v56, v56 clamp
  v_exp_f32 v57, v57 clamp
  v_exp_f32 v60, v60 clamp
  v_exp_f32 v61, v61 clamp
  v_exp_f32 v64, v64 clamp
  v_exp_f32 v65, v65 clamp
  v_exp_f32 v68, v68 clamp
  v_exp_f32 v69, v69 clamp
  v_exp_f32 v72, v72 clamp
  v_exp_f32 v73, v73 clamp
  v_exp_f32 v76, v76 clamp
  v_exp_f32 v77, v77 clamp
  v_exp_f32 v80, v80 clamp
  v_exp_f32 v81, v81 clamp
  v_pk_mul_f32 v[54:55], v[208:209], v[24:25]
  v_pk_mul_f32 v[58:59], v[210:211], v[26:27]
  v_pk_mul_f32 v[62:63], v[212:213], v[28:29]
  v_pk_mul_f32 v[66:67], v[214:215], v[30:31]
  v_pk_mul_f32 v[70:71], v[224:225], v[24:25]
  v_pk_mul_f32 v[74:75], v[226:227], v[26:27]
  v_pk_mul_f32 v[78:79], v[228:229], v[28:29]
  v_pk_mul_f32 v[82:83], v[230:231], v[30:31]
  v_pk_fma_f32 v[52:53], v[52:53], v[86:87], v[248:249]
  v_pk_fma_f32 v[56:57], v[56:57], v[86:87], v[248:249]
  v_pk_fma_f32 v[60:61], v[60:61], v[86:87], v[248:249]
  v_pk_fma_f32 v[64:65], v[64:65], v[86:87], v[248:249]
  v_pk_fma_f32 v[68:69], v[68:69], v[86:87], v[248:249]
  v_pk_fma_f32 v[72:73], v[72:73], v[86:87], v[248:249]
  v_pk_fma_f32 v[76:77], v[76:77], v[86:87], v[248:249]
  v_pk_fma_f32 v[80:81], v[80:81], v[86:87], v[248:249]
  v_pk_mul_f32 v[54:55], v[54:55], v[56:57]
  v_pk_mul_f32 v[62:63], v[62:63], v[64:65]
  v_pk_mul_f32 v[70:71], v[70:71], v[72:73]
  v_pk_mul_f32 v[78:79], v[78:79], v[80:81]
  v_pk_fma_f32 v[54:55], v[58:59], v[52:53], v[54:55]
  v_pk_fma_f32 v[62:63], v[66:67], v[60:61], v[62:63]
  v_pk_fma_f32 v[70:71], v[74:75], v[68:69], v[70:71]
  v_pk_fma_f32 v[78:79], v[82:83], v[76:77], v[78:79]
  v_pk_mul_f32 v[52:53], v[52:53], v[56:57]
  v_pk_mul_f32 v[60:61], v[60:61], v[64:65]
  v_pk_mul_f32 v[68:69], v[68:69], v[72:73]
  v_pk_mul_f32 v[76:77], v[76:77], v[80:81]
  v_pk_mul_f32 v[54:55], v[54:55], v[60:61]
  v_pk_mul_f32 v[70:71], v[70:71], v[76:77]
  v_pk_fma_f32 v[54:55], v[62:63], v[52:53], v[54:55]
  v_pk_fma_f32 v[70:71], v[78:79], v[68:69], v[70:71]
  v_pk_mul_f32 v[52:53], v[52:53], v[60:61]
  v_pk_mul_f32 v[68:69], v[68:69], v[76:77]
  v_rcp_f32 v52, v52
  v_rcp_f32 v53, v53
  v_rcp_f32 v68, v68
  v_rcp_f32 v69, v69
  v_pk_fma_f32 v[46:47], v[52:53], v[54:55], v[46:47]
  v_pk_fma_f32 v[48:49], v[68:69], v[70:71], v[48:49]
  v_pk_mul_f32 v[52:53], v[232:233], v[232:233]
  v_pk_mul_f32 v[56:57], v[234:235], v[234:235]
  v_pk_mul_f32 v[60:61], v[236:237], v[236:237]
  v_pk_mul_f32 v[64:65], v[238:239], v[238:239]
  v_pk_mul_f32 v[68:69], v[240:241], v[240:241]
  v_pk_mul_f32 v[72:73], v[242:243], v[242:243]
  v_pk_mul_f32 v[76:77], v[244:245], v[244:245]
  v_pk_mul_f32 v[80:81], v[246:247], v[246:247]
  v_pk_fma_f32 v[52:53], v[52:53], v[14:15], v[12:13]
  v_pk_fma_f32 v[56:57], v[56:57], v[14:15], v[12:13]
  v_pk_fma_f32 v[60:61], v[60:61], v[14:15], v[12:13]
  v_pk_fma_f32 v[64:65], v[64:65], v[14:15], v[12:13]
  v_pk_fma_f32 v[68:69], v[68:69], v[14:15], v[12:13]
  v_pk_fma_f32 v[72:73], v[72:73], v[14:15], v[12:13]
  v_pk_fma_f32 v[76:77], v[76:77], v[14:15], v[12:13]
  v_pk_fma_f32 v[80:81], v[80:81], v[14:15], v[12:13]
  v_pk_fma_f32 v[52:53], v[52:53], v[232:233], v[84:85]
  v_pk_fma_f32 v[56:57], v[56:57], v[234:235], v[84:85]
  v_pk_fma_f32 v[60:61], v[60:61], v[236:237], v[84:85]
  v_pk_fma_f32 v[64:65], v[64:65], v[238:239], v[84:85]
  v_pk_fma_f32 v[68:69], v[68:69], v[240:241], v[84:85]
  v_pk_fma_f32 v[72:73], v[72:73], v[242:243], v[84:85]
  v_pk_fma_f32 v[76:77], v[76:77], v[244:245], v[84:85]
  v_pk_fma_f32 v[80:81], v[80:81], v[246:247], v[84:85]
  v_exp_f32 v52, v52 clamp
  v_exp_f32 v53, v53 clamp
  v_exp_f32 v56, v56 clamp
  v_exp_f32 v57, v57 clamp
  v_exp_f32 v60, v60 clamp
  v_exp_f32 v61, v61 clamp
  v_exp_f32 v64, v64 clamp
  v_exp_f32 v65, v65 clamp
  v_exp_f32 v68, v68 clamp
  v_exp_f32 v69, v69 clamp
  v_exp_f32 v72, v72 clamp
  v_exp_f32 v73, v73 clamp
  v_exp_f32 v76, v76 clamp
  v_exp_f32 v77, v77 clamp
  v_exp_f32 v80, v80 clamp
  v_exp_f32 v81, v81 clamp
  v_pk_mul_f32 v[54:55], v[232:233], v[16:17]
  v_pk_mul_f32 v[58:59], v[234:235], v[18:19]
  v_pk_mul_f32 v[62:63], v[236:237], v[20:21]
  v_pk_mul_f32 v[66:67], v[238:239], v[22:23]
  v_pk_mul_f32 v[70:71], v[240:241], v[24:25]
  v_pk_mul_f32 v[74:75], v[242:243], v[26:27]
  v_pk_mul_f32 v[78:79], v[244:245], v[28:29]
  v_pk_mul_f32 v[82:83], v[246:247], v[30:31]
  v_pk_fma_f32 v[52:53], v[52:53], v[86:87], v[248:249]
  v_pk_fma_f32 v[56:57], v[56:57], v[86:87], v[248:249]
  v_pk_fma_f32 v[60:61], v[60:61], v[86:87], v[248:249]
  v_pk_fma_f32 v[64:65], v[64:65], v[86:87], v[248:249]
  v_pk_fma_f32 v[68:69], v[68:69], v[86:87], v[248:249]
  v_pk_fma_f32 v[72:73], v[72:73], v[86:87], v[248:249]
  v_pk_fma_f32 v[76:77], v[76:77], v[86:87], v[248:249]
  v_pk_fma_f32 v[80:81], v[80:81], v[86:87], v[248:249]
  v_pk_mul_f32 v[54:55], v[54:55], v[56:57]
  v_pk_mul_f32 v[62:63], v[62:63], v[64:65]
  v_pk_mul_f32 v[70:71], v[70:71], v[72:73]
  v_pk_mul_f32 v[78:79], v[78:79], v[80:81]
  v_pk_fma_f32 v[54:55], v[58:59], v[52:53], v[54:55]
  v_pk_fma_f32 v[62:63], v[66:67], v[60:61], v[62:63]
  v_pk_fma_f32 v[70:71], v[74:75], v[68:69], v[70:71]
  v_pk_fma_f32 v[78:79], v[82:83], v[76:77], v[78:79]
  v_pk_mul_f32 v[52:53], v[52:53], v[56:57]
  v_pk_mul_f32 v[60:61], v[60:61], v[64:65]
  v_pk_mul_f32 v[68:69], v[68:69], v[72:73]
  v_pk_mul_f32 v[76:77], v[76:77], v[80:81]
  v_pk_mul_f32 v[54:55], v[54:55], v[60:61]
  v_pk_mul_f32 v[70:71], v[70:71], v[76:77]
  v_pk_fma_f32 v[54:55], v[62:63], v[52:53], v[54:55]
  v_pk_fma_f32 v[70:71], v[78:79], v[68:69], v[70:71]
  v_pk_mul_f32 v[52:53], v[52:53], v[60:61]
  v_pk_mul_f32 v[68:69], v[68:69], v[76:77]
  v_rcp_f32 v52, v52
  v_rcp_f32 v53, v53
  v_rcp_f32 v68, v68
  v_rcp_f32 v69, v69
  v_pk_mul_f32 v[50:51], v[52:53], v[54:55]
  v_pk_fma_f32 v[50:51], v[68:69], v[70:71], v[50:51]
  v_pk_mul_f32 v[32:33], v[88:89], v[16:17]
  v_pk_fma_f32 v[32:33], v[90:91], v[18:19], v[32:33]
  v_pk_fma_f32 v[32:33], v[92:93], v[20:21], v[32:33]
  v_pk_fma_f32 v[32:33], v[94:95], v[22:23], v[32:33]
  v_pk_fma_f32 v[32:33], v[96:97], v[24:25], v[32:33]
  v_pk_fma_f32 v[32:33], v[98:99], v[26:27], v[32:33]
  v_pk_fma_f32 v[32:33], v[100:101], v[28:29], v[32:33]
  v_pk_fma_f32 v[32:33], v[102:103], v[30:31], v[32:33]
  v_add_f32 v32, v32, v33
  v_add_f32 v34, v34, v35
  v_add_f32 v36, v36, v37
  v_add_f32 v38, v38, v39
  v_add_f32 v40, v40, v41
  v_add_f32 v42, v42, v43
  v_add_f32 v44, v44, v45
  v_add_f32 v46, v46, v47
  v_add_f32 v48, v48, v49
  v_add_f32 v50, v50, v51
  v_permlane32_swap_b32 v32, v34
  v_permlane32_swap_b32 v36, v38
  v_permlane32_swap_b32 v40, v42
  v_permlane32_swap_b32 v44, v46
  v_permlane32_swap_b32 v48, v50
  v_add_f32 v48, v48, v50
  v_add_f32 v32, v32, v34
  v_add_f32 v36, v36, v38
  v_add_f32 v40, v40, v42
  v_add_f32 v44, v44, v46
  v_mov_b32 v50, v48
  v_permlane16_swap_b32 v32, v36
  v_permlane16_swap_b32 v40, v44
  v_permlane16_swap_b32 v48, v50
  v_add_f32 v32, v32, v36
  v_add_f32 v40, v40, v44
  v_add_f32 v48, v48, v50
  ds_write_b32 v10, v32
  ds_write_b32 v10, v40 offset:256
  s_mov_b32 exec_lo, 0xffff
  s_mov_b32 exec_hi, 0xffff
  ds_write_b32 v10, v48 offset:512
  s_mov_b64 exec, -1
  s_waitcnt lgkmcnt(0)
  s_barrier
  s_endpgm
L_ld_tail0:
  s_waitcnt vmcnt(0)
L_ld_tail:
  s_barrier
  s_mov_b32 s60, s24
  s_and_b32 s61, s25, 0xffff
  s_mov_b32 s62, 268435456
  s_mov_b32 s63, 0x20000
  s_mov_b32 s56, s20
  s_and_b32 s57, s21, 0xffff
  s_mov_b32 s58, 8192
  s_mov_b32 s59, 0x20000
  s_mov_b32 s64, s22
  s_and_b32 s65, s23, 0xffff
  s_mov_b32 s66, 256
  s_mov_b32 s67, 0x20000
  s_load_dword s80, s[18:19], 0
  v_mov_b32 v100, 0
  s_mov_b64 exec, 1
  s_mov_b32 s81, 0x80000
  buffer_load_dword v101, v100, s[60:63], s81 offen
  buffer_load_dword v102, v100, s[56:59], 0 offen
  s_mov_b64 exec, -1
  s_mov_b64 exec, 1
  buffer_load_dword v250, v100, s[64:67], 0 offen offset:240 sc1
  s_mov_b64 exec, -1
  s_cmp_lg_u32 s3, 4
  s_cbranch_scc1 L_end
  v_lshlrev_b32 v3, 4, v0
  v_lshlrev_b32 v4, 2, v0
  v_add_u32 v1, 123392, v3
  v_add_u32 v2, 124416, v4
  v_add_u32 v4, 1024, v4
  v_mov_b32 v5, 32
  v_mov_b32 v7, s26
  s_mul_i32 s68, s26, 1280
  s_mul_i32 s69, s27, 16640
  s_add_u32 s69, s69, s68
  s_setprio 3
  v_mov_b32 v64, -1
  v_mov_b32 v65, -1
  v_mov_b32 v66, -1
  v_mov_b32 v67, -1
  buffer_store_dwordx4 v[64:67], v3, s[60:63], s69 offen sc1
  buffer_store_dword v64, v4, s[60:63], s69 offen sc1
  s_waitcnt vmcnt(0)
  s_barrier
  ds_read_b128 v[64:67], v1
  ds_read_b128 v[72:75], v1 offset:1280
  ds_read2st64_b32 v[68:69], v2 offset0:0 offset1:5
  s_waitcnt lgkmcnt(0)
  v_pk_add_f32 v[64:65], v[64:65], v[72:73]
  v_pk_add_f32 v[66:67], v[66:67], v[74:75]
  v_add_f32 v68, v68, v69
  v_min_u32 v64, -2, v64
  v_min_u32 v65, -2, v65
  v_min_u32 v66, -2, v66
  v_min_u32 v67, -2, v67
  v_min_u32 v68, -2, v68
  buffer_store_dwordx4 v[64:67], v3, s[60:63], s69 offen sc1
  buffer_store_dword v68, v4, s[60:63], s69 offen sc1
  s_mov_b64 exec, 1
L_pub:
  v_lshlrev_b32 v6, 4, v7
  v_mov_b32 v13, v5
  buffer_atomic_add v5, v6, s[64:67], 0 offen sc0
  v_cmp_eq_u32 vcc, 12, v7
  v_mov_b32 v8, 436
  v_mov_b32 v9, 434
  v_cndmask_b32 v8, v8, v9, vcc
  v_sub_u32 v8, v8, v13
  s_waitcnt vmcnt(0) lgkmcnt(0)
  v_cmp_eq_u32 s[82:83], v5, v8
  s_mov_b64 exec, -1
  s_lshl_b32 s80, s80, 16
  v_lshrrev_b32 v1, 1, v3
  v_lshrrev_b32 v2, 1, v4
L_fin:
  s_cmp_eq_u32 s82, 0
  s_cbranch_scc1 L_done
  s_ff1_i32_b32 s70, s82
  s_bitset0_b32 s82, s70
  v_readlane_b32 s71, v7, s70
  s_waitcnt vmcnt(0)
L_again:
  s_mul_i32 s68, s71, 1280
  buffer_load_dwordx4 v[64:67], v3, s[60:63], s68 offen sc1
  buffer_load_dword v68, v4, s[60:63], s68 offen sc1
  s_add_u32 s68, s68, 16640
  buffer_load_dwordx4 v[72:75], v3, s[60:63], s68 offen sc1
  buffer_load_dword v76, v4, s[60:63], s68 offen sc1
  s_add_u32 s68, s68, 16640
  buffer_load_dwordx4 v[80:83], v3, s[60:63], s68 offen sc1
  buffer_load_dword v84, v4, s[60:63], s68 offen sc1
  s_add_u32 s68, s68, 16640
  buffer_load_dwordx4 v[88:91], v3, s[60:63], s68 offen sc1
  buffer_load_dword v92, v4, s[60:63], s68 offen sc1
  s_add_u32 s68, s68, 16640
  buffer_load_dwordx4 v[96:99], v3, s[60:63], s68 offen sc1
  buffer_load_dword v100, v4, s[60:63], s68 offen sc1
  s_add_u32 s68, s68, 16640
  buffer_load_dwordx4 v[104:107], v3, s[60:63], s68 offen sc1
  buffer_load_dword v108, v4, s[60:63], s68 offen sc1
  s_add_u32 s68, s68, 16640
  buffer_load_dwordx4 v[112:115], v3, s[60:63], s68 offen sc1
  buffer_load_dword v116, v4, s[60:63], s68 offen sc1
  s_add_u32 s68, s68, 16640
  buffer_load_dwordx4 v[120:123], v3, s[60:63], s68 offen sc1
  buffer_load_dword v124, v4, s[60:63], s68 offen sc1
  s_add_u32 s68, s68, 16640
  buffer_load_dwordx4 v[128:131], v3, s[60:63], s68 offen sc1
  buffer_load_dword v132, v4, s[60:63], s68 offen sc1
  s_add_u32 s68, s68, 16640
  buffer_load_dwordx4 v[136:139], v3, s[60:63], s68 offen sc1
  buffer_load_dword v140, v4, s[60:63], s68 offen sc1
  s_add_u32 s68, s68, 16640
  buffer_load_dwordx4 v[144:147], v3, s[60:63], s68 offen sc1
  buffer_load_dword v148, v4, s[60:63], s68 offen sc1
  s_add_u32 s68, s68, 16640
  buffer_load_dwordx4 v[152:155], v3, s[60:63], s68 offen sc1
  buffer_load_dword v156, v4, s[60:63], s68 offen sc1
  s_add_u32 s68, s68, 16640
  buffer_load_dwordx4 v[160:163], v3, s[60:63], s68 offen sc1
  buffer_load_dword v164, v4, s[60:63], s68 offen sc1
  s_add_u32 s68, s68, 16640
  buffer_load_dwordx4 v[168:171], v3, s[60:63], s68 offen sc1
  buffer_load_dword v172, v4, s[60:63], s68 offen sc1
  s_add_u32 s68, s68, 16640
L_sum:
  s_waitcnt vmcnt(25)
  v_pk_add_f32 v[56:57], v[64:65], v[72:73]
  v_pk_add_f32 v[58:59], v[66:67], v[74:75]
  s_waitcnt vmcnt(24)
  v_add_f32 v60, v68, v76
  s_waitcnt vmcnt(23)
  v_pk_add_f32 v[56:57], v[56:57], v[80:81]
  v_pk_add_f32 v[58:59], v[58:59], v[82:83]
  s_waitcnt vmcnt(22)
  v_add_f32 v60, v60, v84
  s_waitcnt vmcnt(21)
  v_pk_add_f32 v[56:57], v[56:57], v[88:89]
  v_pk_add_f32 v[58:59], v[58:59], v[90:91]
  s_waitcnt vmcnt(20)
  v_add_f32 v60, v60, v92
  s_waitcnt vmcnt(19)
  v_pk_add_f32 v[56:57], v[56:57], v[96:97]
  v_pk_add_f32 v[58:59], v[58:59], v[98:99]
  s_waitcnt vmcnt(18)
  v_add_f32 v60, v60, v100
  s_waitcnt vmcnt(17)
  v_pk_add_f32 v[56:57], v[56:57], v[104:105]
  v_pk_add_f32 v[58:59], v[58:59], v[106:107]
  s_waitcnt vmcnt(16)
  v_add_f32 v60, v60, v108
  s_waitcnt vmcnt(15)
  v_pk_add_f32 v[56:57], v[56:57], v[112:113]
  v_pk_add_f32 v[58:59], v[58:59], v[114:115]
  s_waitcnt vmcnt(14)
  v_add_f32 v60, v60, v116
  s_waitcnt vmcnt(13)
  v_pk_add_f32 v[56:57], v[56:57], v[120:121]
  v_pk_add_f32 v[58:59], v[58:59], v[122:123]
  s_waitcnt vmcnt(12)
  v_add_f32 v60, v60, v124
  s_waitcnt vmcnt(11)
  v_pk_add_f32 v[56:57], v[56:57], v[128:129]
  v_pk_add_f32 v[58:59], v[58:59], v[130:131]
  s_waitcnt vmcnt(10)
  v_add_f32_e64 v60, v60, v132
  s_waitcnt vmcnt(9)
  v_pk_add_f32 v[56:57], v[56:57], v[136:137]
  v_pk_add_f32 v[58:59], v[58:59], v[138:139]
  s_waitcnt vmcnt(8)
  v_add_f32 v60, v60, v140
  s_waitcnt vmcnt(7)
  v_pk_add_f32 v[56:57], v[56:57], v[144:145]
  v_pk_add_f32 v[58:59], v[58:59], v[146:147]
  s_waitcnt vmcnt(6)
  v_add_f32 v60, v60, v148
  s_waitcnt vmcnt(5)
  v_pk_add_f32 v[56:57], v[56:57], v[152:153]
  v_pk_add_f32 v[58:59], v[58:59], v[154:155]
  s_waitcnt vmcnt(4)
  v_add_f32 v60, v60, v156
  s_waitcnt vmcnt(3)
  v_pk_add_f32 v[56:57], v[56:57], v[160:161]
  v_pk_add_f32 v[58:59], v[58:59], v[162:163]
  s_waitcnt vmcnt(2)
  v_add_f32 v60, v60, v164
  s_waitcnt vmcnt(1)
  v_pk_add_f32 v[56:57], v[56:57], v[168:169]
  v_pk_add_f32 v[58:59], v[58:59], v[170:171]
  s_waitcnt vmcnt(0)
  v_add_f32 v60, v60, v172
  v_cmp_u_f32 vcc, v56, v57
  v_cmp_u_f32 s[92:93], v58, v59
  s_nop 0
  s_or_b64 s[92:93], s[92:93], vcc
  v_cmp_u_f32 vcc, v60, v60
  s_nop 0
  s_or_b64 vcc, s[92:93], vcc
  s_cbranch_vccnz L_chk
L_ok:
  s_mul_i32 s71, s71, 640
  v_add_f32 v56, s80, v56
  v_add_f32 v57, s80, v57
  v_add_f32 v58, s80, v58
  v_add_f32 v59, s80, v59
  v_add_f32 v60, s80, v60
  v_cvt_pk_bf16_f32 v10, v56, v57
  v_cvt_pk_bf16_f32 v11, v58, v59
  v_cvt_pk_bf16_f32 v12, v60, v60
  buffer_store_dwordx2 v[10:11], v1, s[56:59], s71 offen
  buffer_store_short v12, v2, s[56:59], s71 offen
  s_branch L_fin
L_chk:
  v_mov_b32 v14, 0
  v_mov_b32_e64 v15, 0
  v_max3_u32 v14, v14, v64, v65
  v_max3_u32 v14, v14, v66, v67
  v_max_u32 v15, v15, v68
  v_max3_u32 v14, v14, v72, v73
  v_max3_u32 v14, v14, v74, v75
  v_max_u32 v15, v15, v76
  v_max3_u32 v14, v14, v80, v81
  v_max3_u32 v14, v14, v82, v83
  v_max_u32_e64 v15, v15, v84
  v_max3_u32 v14, v14, v88, v89
  v_max3_u32 v14, v14, v90, v91
  v_max_u32 v15, v15, v92
  v_max3_u32 v14, v14, v96, v97
  v_max3_u32 v14, v14, v98, v99
  v_max_u32 v15, v15, v100
  v_max3_u32 v14, v14, v104, v105
  v_max3_u32 v14, v14, v106, v107
  v_max_u32_e64 v15, v15, v108
  v_max3_u32 v14, v14, v112, v113
  v_max3_u32 v14, v14, v114, v115
  v_max_u32 v15, v15, v116
  v_max3_u32 v14, v14, v120, v121
  v_max3_u32 v14, v14, v122, v123
  v_max_u32 v15, v15, v124
  v_max3_u32 v14, v14, v128, v129
  v_max3_u32 v14, v14, v130, v131
  v_max_u32_e64 v15, v15, v132
  v_max3_u32 v14, v14, v136, v137
  v_max3_u32 v14, v14, v138, v139
  v_max_u32 v15, v15, v140
  v_max3_u32 v14, v14, v144, v145
  v_max3_u32 v14, v14, v146, v147
  v_max_u32 v15, v15, v148
  v_max3_u32 v14, v14, v152, v153
  v_max3_u32 v14, v14, v154, v155
  v_max_u32_e64 v15, v15, v156
  v_max3_u32 v14, v14, v160, v161
  v_max3_u32 v14, v14, v162, v163
  v_max_u32 v15, v15, v164
  v_max3_u32 v14, v14, v168, v169
  v_max3_u32 v14, v14, v170, v171
  v_max_u32 v15, v15, v172
  s_cmp_eq_u32 s71, 12
  s_cselect_b32 s68, 0, -1
  v_and_b32 v15, s68, v15
  v_max_u32 v14, v14, v15
  v_cmp_eq_u32 vcc, -1, v14
  s_cbranch_vccnz L_again
  s_branch L_ok
L_done:
  s_endpgm
L_cin_done:
  s_mul_i32 s98, s3, 1536
  s_add_u32 s98, s98, 116736
  v_lshlrev_b32 v120, 5, v0
  v_add_u32 v120, s98, v120
  ds_read_b128 v[60:63], v120
  ds_read_b128 v[64:67], v120 offset:16
  v_mul_f32 v116, v184, v192
  v_mul_f32 v117, v185, v193
  v_mul_f32 v118, v186, v194
  v_mul_f32 v119, v187, v195
  v_fmac_f32 v116, v188, v191
  v_fmac_f32 v117, v200, v208
  v_fmac_f32 v118, v201, v209
  v_fmac_f32 v119, v202, v210
  v_fmac_f32 v116, v203, v211
  v_fmac_f32 v117, v204, v207
  v_fmac_f32 v118, v216, v224
  v_fmac_f32 v119, v217, v225
  v_fmac_f32 v116, v218, v226
  v_fmac_f32 v117, v219, v227
  v_fmac_f32 v118, v220, v223
  v_fmac_f32 v119, v232, v240
  v_fmac_f32 v116, v233, v241
  v_fmac_f32 v117, v234, v242
  v_fmac_f32 v118, v235, v243
  v_fmac_f32 v119, v236, v239
  v_fmac_f32 v116, v189, v196
  v_fmac_f32 v117, v189, v197
  v_fmac_f32 v118, v190, v198
  v_fmac_f32 v119, v190, v199
  v_fmac_f32 v116, v205, v212
  v_fmac_f32 v117, v205, v213
  v_fmac_f32 v118, v206, v214
  v_fmac_f32 v119, v206, v215
  v_fmac_f32 v116, v221, v228
  v_fmac_f32 v117, v221, v229
  v_fmac_f32 v118, v222, v230
  v_fmac_f32 v119, v222, v231
  v_fmac_f32 v116, v237, v244
  v_fmac_f32 v117, v237, v245
  v_fmac_f32 v118, v238, v246
  v_fmac_f32 v119, v238, v247
  v_add_f32 v116, v116, v117
  v_add_f32 v118, v118, v119
  v_add_f32 v116, v116, v118
  v_mul_f32 v116, s74, v116
  v_mul_f32 v116, s75, v116
  s_nop 1
  v_add_f32_dpp v116, v116, v116 row_shr:1 row_mask:0xf bank_mask:0xf
  v_subrev_u32 v122, s98, v7
  v_lshrrev_b32 v122, 8, v122
  v_lshrrev_b32 v121, 3, v0
  v_add_f32_dpp v116, v116, v116 row_shr:2 row_mask:0xf bank_mask:0xf
  v_cmp_gt_u32 vcc, v122, v121
  v_min_u32 v121, v121, v122
  v_lshlrev_b32 v121, 4, v121
  v_add_f32_dpp v116, v116, v116 row_shr:4 row_mask:0xf bank_mask:0xf
  v_add_u32 v121, s85, v121
  s_waitcnt lgkmcnt(1)
  v_add_f32 v60, v60, v61
  v_add_f32 v62, v62, v63
  v_add_f32_dpp v116, v116, v116 row_shr:8 row_mask:0xf bank_mask:0xf
  s_waitcnt lgkmcnt(0)
  v_add_f32 v64, v64, v65
  v_add_f32 v66, v66, v67
  v_add_f32 v60, v60, v62
  v_add_f32_dpp v116, v116, v116 row_bcast:15 row_mask:0xa bank_mask:0xf
  v_add_f32 v64, v64, v66
  v_add_f32 v60, v60, v64
  s_nop 1
  v_add_f32_dpp v60, v60, v60 quad_perm:[1,0,3,2] row_mask:0xf bank_mask:0xf
  v_add_f32_dpp v116, v116, v116 row_bcast:31 row_mask:0xc bank_mask:0xf
  s_nop 0
  v_add_f32_dpp v60, v60, v60 quad_perm:[2,3,0,1] row_mask:0xf bank_mask:0xf
  s_nop 1
  v_add_f32_dpp v60, v60, v60 row_half_mirror row_mask:0xf bank_mask:0xf
  v_cndmask_b32 v60, v116, v60, vcc
  s_bitset1_b32 vcc_hi, 31
  s_mov_b64 exec, vcc
  ds_write_b32 v121, v60
  s_mov_b64 exec, -1
  s_cmp_eq_u32 s3, 0
  s_cbranch_scc1 L_cpub
  s_waitcnt lgkmcnt(0)
  s_barrier
  s_endpgm
L_cpub:
  s_load_dword s80, s[18:19], 0
  s_mov_b32 s60, s24
  s_and_b32 s61, s25, 0xffff
  s_mov_b32 s62, 268435456
  s_mov_b32 s63, 0x20000
  s_mov_b32 s56, s20
  s_and_b32 s57, s21, 0xffff
  s_mov_b32 s58, 8192
  s_mov_b32 s59, 0x20000
  s_mov_b32 s64, s22
  s_and_b32 s65, s23, 0xffff
  s_mov_b32 s66, 256
  s_mov_b32 s67, 0x20000
  v_lshlrev_b32 v6, 2, v0
  v_add_u32 v2, 129728, v6
  v_add_u32 v4, 1024, v6
  s_mul_i32 s69, s26, 192
  s_add_u32 s69, s69, 216320
  v_mov_b32 v13, -1
  s_mov_b32 exec_hi, 0xffff
  buffer_store_dword v13, v6, s[60:63], s69 offen sc1
  s_mov_b64 exec, 1
  buffer_load_dword v250, v6, s[56:59], 0 offen
  buffer_load_dword v251, v6, s[64:67], 0 offen offset:240 sc1
  s_mov_b64 exec, -1
  s_mul_i32 s68, s26, 3
  s_mul_i32 s70, s68, 3277
  s_lshr_b32 s70, s70, 16
  v_add_u32 v7, s70, v0
  s_mul_i32 s70, s70, 20
  s_add_u32 s70, s70, 20
  s_sub_u32 s70, s70, s68
  s_min_u32 s70, s70, 3
  s_sub_u32 s68, 3, s70
  v_mov_b32 v5, s68
  v_writelane_b32 v5, s70, 0
  s_cmp_eq_u32 s68, 0
  s_cselect_b32 s68, 1, 3
  v_lshlrev_b32 v3, 4, v0
  s_mov_b32 exec_hi, 0xffff
  s_waitcnt vmcnt(0) lgkmcnt(0)
  s_barrier
  ds_read_b32 v64, v2
  s_waitcnt lgkmcnt(0)
  v_min_u32_e64 v64, -2, v64
  buffer_store_dword v64, v6, s[60:63], s69 offen sc1
  s_mov_b32 exec_lo, s68
  s_mov_b32 exec_hi, 0
  s_branch L_pub
L_dnn_loop1:
  s_barrier
L_ld_in:
  s_add_u32 m0, s75, 131072
  s_nop 0
  buffer_load_dwordx4 v4, s[44:47], s74 offen lds
  s_add_u32 m0, s75, 132096
  s_nop 0
  buffer_load_dwordx4 v5, s[44:47], s74 offen lds
  s_add_u32 s74, s74, 106496
  s_add_u32 m0, s75, 139264
  s_nop 0
  buffer_load_dwordx4 v4, s[44:47], s74 offen lds
  s_add_u32 m0, s75, 140288
  s_nop 0
  buffer_load_dwordx4 v5, s[44:47], s74 offen lds
  s_add_u32 s74, s74, 106496
  s_add_u32 m0, s76, 0
  s_nop 0
  buffer_load_dwordx4 v56, s[32:35], 0 offen lds
  s_add_u32 m0, s76, 2048
  v_add_u32_dpp v56, v16, v2 row_newbcast:1 row_mask:0xf bank_mask:0x3
  buffer_load_dwordx4 v57, s[32:35], 0 offen lds
  s_nop 0
  v_add_u32_dpp v56, v18, v2 row_newbcast:7 row_mask:0xf bank_mask:0xc
  s_add_u32 m0, s76, 4096
  v_add_u32_dpp v57, v20, v2 row_newbcast:1 row_mask:0xf bank_mask:0x3
  buffer_load_dwordx4 v58, s[32:35], 0 offen lds
  s_nop 0
  v_add_u32_dpp v57, v22, v2 row_newbcast:7 row_mask:0xf bank_mask:0xc
  s_add_u32 m0, s76, 6144
  v_add_u32_dpp v58, v24, v2 row_newbcast:1 row_mask:0xf bank_mask:0x3
  buffer_load_dwordx4 v59, s[32:35], 0 offen lds
  s_nop 0
  v_add_u32_dpp v58, v26, v2 row_newbcast:7 row_mask:0xf bank_mask:0xc
  s_add_u32 m0, s76, 8192
  v_add_u32_dpp v59, v28, v2 row_newbcast:1 row_mask:0xf bank_mask:0x3
  buffer_load_dwordx4 v60, s[32:35], 0 offen lds
  s_nop 0
  v_add_u32_dpp v59, v30, v2 row_newbcast:7 row_mask:0xf bank_mask:0xc
  s_add_u32 m0, s76, 10240
  v_add_u32_dpp v60, v32, v2 row_newbcast:1 row_mask:0xf bank_mask:0x3
  buffer_load_dwordx4 v61, s[32:35], 0 offen lds
  s_nop 0
  v_add_u32_dpp v60, v34, v2 row_newbcast:7 row_mask:0xf bank_mask:0xc
  s_add_u32 m0, s76, 12288
  v_add_u32_dpp v61, v36, v2 row_newbcast:1 row_mask:0xf bank_mask:0x3
  buffer_load_dwordx4 v62, s[32:35], 0 offen lds
  s_nop 0
  v_add_u32_dpp v61, v38, v2 row_newbcast:7 row_mask:0xf bank_mask:0xc
  s_add_u32 m0, s76, 14336
  v_add_u32_dpp v62, v40, v2 row_newbcast:1 row_mask:0xf bank_mask:0x3
  buffer_load_dwordx4 v63, s[32:35], 0 offen lds
  s_nop 0
  v_add_u32_dpp v62, v42, v2 row_newbcast:7 row_mask:0xf bank_mask:0xc
  s_add_u32 m0, s76, 16384
  v_add_u32_dpp v63, v44, v2 row_newbcast:1 row_mask:0xf bank_mask:0x3
  buffer_load_dwordx4 v64, s[32:35], 0 offen lds
  s_nop 0
  v_add_u32_dpp v63, v46, v2 row_newbcast:7 row_mask:0xf bank_mask:0xc
  s_add_u32 m0, s76, 18432
  v_add_u32_dpp v64, v48, v2 row_newbcast:1 row_mask:0xf bank_mask:0x3
  buffer_load_dwordx4 v65, s[32:35], 0 offen lds
  s_nop 0
  v_add_u32_dpp v64, v50, v2 row_newbcast:7 row_mask:0xf bank_mask:0xc
  v_add_u32_dpp v65, v52, v2 row_newbcast:1 row_mask:0xf bank_mask:0x3
  s_nop 1
  v_add_u32_dpp v65, v54, v2 row_newbcast:7 row_mask:0xf bank_mask:0xc
  s_mov_b64 exec, 0x3ff
  buffer_load_dword v103, v84, s[44:47], s85 offen
  s_mov_b64 exec, -1
  s_add_u32 s85, s85, 865280
  s_waitcnt vmcnt(11)
  s_barrier
  s_add_u32 m0, s75, 147456
  s_nop 0
  buffer_load_dwordx4 v4, s[44:47], s74 offen lds
  s_add_u32 m0, s75, 148480
  s_nop 0
  buffer_load_dwordx4 v5, s[44:47], s74 offen lds
  s_add_u32 s74, s74, 106496
  s_add_u32 m0, s75, 155648
  s_nop 0
  buffer_load_dwordx4 v4, s[44:47], s74 offen lds
  s_add_u32 m0, s75, 156672
  s_nop 0
  buffer_load_dwordx4 v5, s[44:47], s74 offen lds
  s_add_u32 s74, s74, 106496
  s_add_u32 m0, s76, 40960
  s_nop 0
  buffer_load_dwordx4 v56, s[32:35], 0 offen lds
  s_add_u32 m0, s76, 43008
  v_add_u32_dpp v56, v17, v2 row_newbcast:1 row_mask:0xf bank_mask:0x3
  buffer_load_dwordx4 v57, s[32:35], 0 offen lds
  s_nop 0
  v_add_u32_dpp v56, v19, v2 row_newbcast:7 row_mask:0xf bank_mask:0xc
  s_add_u32 m0, s76, 45056
  v_add_u32_dpp v57, v21, v2 row_newbcast:1 row_mask:0xf bank_mask:0x3
  buffer_load_dwordx4 v58, s[32:35], 0 offen lds
  s_nop 0
  v_add_u32_dpp v57, v23, v2 row_newbcast:7 row_mask:0xf bank_mask:0xc
  s_add_u32 m0, s76, 47104
  v_add_u32_dpp v58, v25, v2 row_newbcast:1 row_mask:0xf bank_mask:0x3
  buffer_load_dwordx4 v59, s[32:35], 0 offen lds
  s_nop 0
  v_add_u32_dpp v58, v27, v2 row_newbcast:7 row_mask:0xf bank_mask:0xc
  s_add_u32 m0, s76, 49152
  v_add_u32_dpp v59, v29, v2 row_newbcast:1 row_mask:0xf bank_mask:0x3
  buffer_load_dwordx4 v60, s[32:35], 0 offen lds
  s_nop 0
  v_add_u32_dpp v59, v31, v2 row_newbcast:7 row_mask:0xf bank_mask:0xc
  s_add_u32 m0, s76, 51200
  v_add_u32_dpp v60, v33, v2 row_newbcast:1 row_mask:0xf bank_mask:0x3
  buffer_load_dwordx4 v61, s[32:35], 0 offen lds
  s_nop 0
  v_add_u32_dpp v60, v35, v2 row_newbcast:7 row_mask:0xf bank_mask:0xc
  s_add_u32 m0, s76, 53248
  v_add_u32_dpp v61, v37, v2 row_newbcast:1 row_mask:0xf bank_mask:0x3
  buffer_load_dwordx4 v62, s[32:35], 0 offen lds
  s_nop 0
  v_add_u32_dpp v61, v39, v2 row_newbcast:7 row_mask:0xf bank_mask:0xc
  s_add_u32 m0, s76, 55296
  v_add_u32_dpp v62, v41, v2 row_newbcast:1 row_mask:0xf bank_mask:0x3
  buffer_load_dwordx4 v63, s[32:35], 0 offen lds
  s_nop 0
  v_add_u32_dpp v62, v43, v2 row_newbcast:7 row_mask:0xf bank_mask:0xc
  s_add_u32 m0, s76, 57344
  v_add_u32_dpp v63, v45, v2 row_newbcast:1 row_mask:0xf bank_mask:0x3
  buffer_load_dwordx4 v64, s[32:35], 0 offen lds
  s_nop 0
  v_add_u32_dpp v63, v47, v2 row_newbcast:7 row_mask:0xf bank_mask:0xc
  s_add_u32 m0, s76, 59392
  v_add_u32_dpp v64, v49, v2 row_newbcast:1 row_mask:0xf bank_mask:0x3
  buffer_load_dwordx4 v65, s[32:35], 0 offen lds
  s_nop 0
  v_add_u32_dpp v64, v51, v2 row_newbcast:7 row_mask:0xf bank_mask:0xc
  v_add_u32_dpp v65, v53, v2 row_newbcast:1 row_mask:0xf bank_mask:0x3
  s_nop 1
  v_add_u32_dpp v65, v55, v2 row_newbcast:7 row_mask:0xf bank_mask:0xc
  s_waitcnt vmcnt(10)
  s_barrier
  s_add_u32 m0, s75, 131072
  s_nop 0
  buffer_load_dwordx4 v4, s[44:47], s74 offen lds
  s_add_u32 m0, s75, 132096
  s_nop 0
  buffer_load_dwordx4 v5, s[44:47], s74 offen lds
  s_add_u32 s74, s74, 106496
  s_add_u32 m0, s75, 139264
  s_nop 0
  buffer_load_dwordx4 v4, s[44:47], s74 offen lds
  s_add_u32 m0, s75, 140288
  s_nop 0
  buffer_load_dwordx4 v5, s[44:47], s74 offen lds
  s_add_u32 s74, s74, 106496
  s_add_u32 m0, s76, 81920
  s_nop 0
  buffer_load_dwordx4 v56, s[32:35], 0 offen lds
  s_add_u32 m0, s76, 83968
  v_add_u32_dpp v56, v18, v2 row_newbcast:1 row_mask:0xf bank_mask:0x3
  buffer_load_dwordx4 v57, s[32:35], 0 offen lds
  s_nop 0
  v_add_u32_dpp v56, v16, v2 row_newbcast:8 row_mask:0xf bank_mask:0xc
  s_add_u32 m0, s76, 86016
  v_add_u32_dpp v57, v22, v2 row_newbcast:1 row_mask:0xf bank_mask:0x3
  buffer_load_dwordx4 v58, s[32:35], 0 offen lds
  s_nop 0
  v_add_u32_dpp v57, v20, v2 row_newbcast:8 row_mask:0xf bank_mask:0xc
  s_add_u32 m0, s76, 88064
  v_add_u32_dpp v58, v26, v2 row_newbcast:1 row_mask:0xf bank_mask:0x3
  buffer_load_dwordx4 v59, s[32:35], 0 offen lds
  s_nop 0
  v_add_u32_dpp v58, v24, v2 row_newbcast:8 row_mask:0xf bank_mask:0xc
  s_add_u32 m0, s76, 90112
  v_add_u32_dpp v59, v30, v2 row_newbcast:1 row_mask:0xf bank_mask:0x3
  buffer_load_dwordx4 v60, s[32:35], 0 offen lds
  s_nop 0
  v_add_u32_dpp v59, v28, v2 row_newbcast:8 row_mask:0xf bank_mask:0xc
  s_add_u32 m0, s76, 92160
  v_add_u32_dpp v60, v34, v2 row_newbcast:1 row_mask:0xf bank_mask:0x3
  buffer_load_dwordx4 v61, s[32:35], 0 offen lds
  s_nop 0
  v_add_u32_dpp v60, v32, v2 row_newbcast:8 row_mask:0xf bank_mask:0xc
  s_add_u32 m0, s76, 94208
  v_add_u32_dpp v61, v38, v2 row_newbcast:1 row_mask:0xf bank_mask:0x3
  buffer_load_dwordx4 v62, s[32:35], 0 offen lds
  s_nop 0
  v_add_u32_dpp v61, v36, v2 row_newbcast:8 row_mask:0xf bank_mask:0xc
  s_add_u32 m0, s76, 96256
  v_add_u32_dpp v62, v42, v2 row_newbcast:1 row_mask:0xf bank_mask:0x3
  buffer_load_dwordx4 v63, s[32:35], 0 offen lds
  s_nop 0
  v_add_u32_dpp v62, v40, v2 row_newbcast:8 row_mask:0xf bank_mask:0xc
  s_add_u32 m0, s76, 98304
  v_add_u32_dpp v63, v46, v2 row_newbcast:1 row_mask:0xf bank_mask:0x3
  buffer_load_dwordx4 v64, s[32:35], 0 offen lds
  s_nop 0
  v_add_u32_dpp v63, v44, v2 row_newbcast:8 row_mask:0xf bank_mask:0xc
  s_add_u32 m0, s76, 100352
  v_add_u32_dpp v64, v50, v2 row_newbcast:1 row_mask:0xf bank_mask:0x3
  buffer_load_dwordx4 v65, s[32:35], 0 offen lds
  s_nop 0
  v_add_u32_dpp v64, v48, v2 row_newbcast:8 row_mask:0xf bank_mask:0xc
  v_add_u32_dpp v65, v54, v2 row_newbcast:1 row_mask:0xf bank_mask:0x3
  s_nop 1
  v_add_u32_dpp v65, v52, v2 row_newbcast:8 row_mask:0xf bank_mask:0xc
  v_lshlrev_b32 v101, 7, v70
  s_mov_b32 exec_lo, 0xffffffff
  s_mov_b32 exec_hi, 0x0
  buffer_load_dword v102, v101, s[32:35], 0 offen
  s_mov_b64 exec, -1
  v_mov_b32 v70, v71
  v_mov_b32 v71, v72
  v_mov_b32 v72, v73
  v_mov_b32 v73, v74
  v_mov_b32 v74, 0xffffff
  s_waitcnt vmcnt(11)
  s_barrier
  s_add_u32 m0, s75, 147456
  s_nop 0
  buffer_load_dwordx4 v4, s[44:47], s74 offen lds
  s_add_u32 m0, s75, 148480
  s_nop 0
  buffer_load_dwordx4 v5, s[44:47], s74 offen lds
  s_add_u32 s74, s74, 106496
  s_add_u32 m0, s75, 155648
  s_nop 0
  buffer_load_dwordx4 v4, s[44:47], s74 offen lds
  s_add_u32 m0, s75, 156672
  s_nop 0
  buffer_load_dwordx4 v5, s[44:47], s74 offen lds
  s_add_u32 s74, s74, 106496
  s_add_u32 m0, s76, 0
  s_nop 0
  buffer_load_dwordx4 v56, s[32:35], 0 offen lds
  s_add_u32 m0, s76, 2048
  v_add_u32_dpp v56, v19, v2 row_newbcast:1 row_mask:0xf bank_mask:0x3
  buffer_load_dwordx4 v57, s[32:35], 0 offen lds
  s_nop 0
  v_add_u32_dpp v56, v17, v2 row_newbcast:8 row_mask:0xf bank_mask:0xc
  s_add_u32 m0, s76, 4096
  v_add_u32_dpp v57, v23, v2 row_newbcast:1 row_mask:0xf bank_mask:0x3
  buffer_load_dwordx4 v58, s[32:35], 0 offen lds
  s_nop 0
  v_add_u32_dpp v57, v21, v2 row_newbcast:8 row_mask:0xf bank_mask:0xc
  s_add_u32 m0, s76, 6144
  v_add_u32_dpp v58, v27, v2 row_newbcast:1 row_mask:0xf bank_mask:0x3
  buffer_load_dwordx4 v59, s[32:35], 0 offen lds
  s_nop 0
  v_add_u32_dpp v58, v25, v2 row_newbcast:8 row_mask:0xf bank_mask:0xc
  s_add_u32 m0, s76, 8192
  v_add_u32_dpp v59, v31, v2 row_newbcast:1 row_mask:0xf bank_mask:0x3
  buffer_load_dwordx4 v60, s[32:35], 0 offen lds
  s_nop 0
  v_add_u32_dpp v59, v29, v2 row_newbcast:8 row_mask:0xf bank_mask:0xc
  s_add_u32 m0, s76, 10240
  v_add_u32_dpp v60, v35, v2 row_newbcast:1 row_mask:0xf bank_mask:0x3
  buffer_load_dwordx4 v61, s[32:35], 0 offen lds
  s_nop 0
  v_add_u32_dpp v60, v33, v2 row_newbcast:8 row_mask:0xf bank_mask:0xc
  s_add_u32 m0, s76, 12288
  v_add_u32_dpp v61, v39, v2 row_newbcast:1 row_mask:0xf bank_mask:0x3
  buffer_load_dwordx4 v62, s[32:35], 0 offen lds
  s_nop 0
  v_add_u32_dpp v61, v37, v2 row_newbcast:8 row_mask:0xf bank_mask:0xc
  s_add_u32 m0, s76, 14336
  v_add_u32_dpp v62, v43, v2 row_newbcast:1 row_mask:0xf bank_mask:0x3
  buffer_load_dwordx4 v63, s[32:35], 0 offen lds
  s_nop 0
  v_add_u32_dpp v62, v41, v2 row_newbcast:8 row_mask:0xf bank_mask:0xc
  s_add_u32 m0, s76, 16384
  v_add_u32_dpp v63, v47, v2 row_newbcast:1 row_mask:0xf bank_mask:0x3
  buffer_load_dwordx4 v64, s[32:35], 0 offen lds
  s_nop 0
  v_add_u32_dpp v63, v45, v2 row_newbcast:8 row_mask:0xf bank_mask:0xc
  s_add_u32 m0, s76, 18432
  v_add_u32_dpp v64, v51, v2 row_newbcast:1 row_mask:0xf bank_mask:0x3
  buffer_load_dwordx4 v65, s[32:35], 0 offen lds
  s_nop 0
  v_add_u32_dpp v64, v49, v2 row_newbcast:8 row_mask:0xf bank_mask:0xc
  v_add_u32_dpp v65, v55, v2 row_newbcast:1 row_mask:0xf bank_mask:0x3
  s_nop 1
  v_add_u32_dpp v65, v53, v2 row_newbcast:8 row_mask:0xf bank_mask:0xc
  s_waitcnt vmcnt(10)
  s_barrier
  s_add_u32 m0, s75, 131072
  s_nop 0
  buffer_load_dwordx4 v4, s[44:47], s74 offen lds
  s_add_u32 m0, s75, 132096
  s_nop 0
  buffer_load_dwordx4 v5, s[44:47], s74 offen lds
  s_add_u32 s74, s74, 106496
  s_add_u32 m0, s75, 139264
  s_nop 0
  buffer_load_dwordx4 v4, s[44:47], s74 offen lds
  s_add_u32 m0, s75, 140288
  s_nop 0
  buffer_load_dwordx4 v5, s[44:47], s74 offen lds
  s_add_u32 s74, s74, 106496
  s_add_u32 m0, s76, 40960
  s_nop 0
  buffer_load_dwordx4 v56, s[32:35], 0 offen lds
  s_add_u32 m0, s76, 43008
  v_add_u32_dpp v56, v16, v2 row_newbcast:2 row_mask:0xf bank_mask:0x3
  buffer_load_dwordx4 v57, s[32:35], 0 offen lds
  s_nop 0
  v_add_u32_dpp v56, v18, v2 row_newbcast:8 row_mask:0xf bank_mask:0xc
  s_add_u32 m0, s76, 45056
  v_add_u32_dpp v57, v20, v2 row_newbcast:2 row_mask:0xf bank_mask:0x3
  buffer_load_dwordx4 v58, s[32:35], 0 offen lds
  s_nop 0
  v_add_u32_dpp v57, v22, v2 row_newbcast:8 row_mask:0xf bank_mask:0xc
  s_add_u32 m0, s76, 47104
  v_add_u32_dpp v58, v24, v2 row_newbcast:2 row_mask:0xf bank_mask:0x3
  buffer_load_dwordx4 v59, s[32:35], 0 offen lds
  s_nop 0
  v_add_u32_dpp v58, v26, v2 row_newbcast:8 row_mask:0xf bank_mask:0xc
  s_add_u32 m0, s76, 49152
  v_add_u32_dpp v59, v28, v2 row_newbcast:2 row_mask:0xf bank_mask:0x3
  buffer_load_dwordx4 v60, s[32:35], 0 offen lds
  s_nop 0
  v_add_u32_dpp v59, v30, v2 row_newbcast:8 row_mask:0xf bank_mask:0xc
  s_add_u32 m0, s76, 51200
  v_add_u32_dpp v60, v32, v2 row_newbcast:2 row_mask:0xf bank_mask:0x3
  buffer_load_dwordx4 v61, s[32:35], 0 offen lds
  s_nop 0
  v_add_u32_dpp v60, v34, v2 row_newbcast:8 row_mask:0xf bank_mask:0xc
  s_add_u32 m0, s76, 53248
  v_add_u32_dpp v61, v36, v2 row_newbcast:2 row_mask:0xf bank_mask:0x3
  buffer_load_dwordx4 v62, s[32:35], 0 offen lds
  s_nop 0
  v_add_u32_dpp v61, v38, v2 row_newbcast:8 row_mask:0xf bank_mask:0xc
  s_add_u32 m0, s76, 55296
  v_add_u32_dpp v62, v40, v2 row_newbcast:2 row_mask:0xf bank_mask:0x3
  buffer_load_dwordx4 v63, s[32:35], 0 offen lds
  s_nop 0
  v_add_u32_dpp v62, v42, v2 row_newbcast:8 row_mask:0xf bank_mask:0xc
  s_add_u32 m0, s76, 57344
  v_add_u32_dpp v63, v44, v2 row_newbcast:2 row_mask:0xf bank_mask:0x3
  buffer_load_dwordx4 v64, s[32:35], 0 offen lds
  s_nop 0
  v_add_u32_dpp v63, v46, v2 row_newbcast:8 row_mask:0xf bank_mask:0xc
  s_add_u32 m0, s76, 59392
  v_add_u32_dpp v64, v48, v2 row_newbcast:2 row_mask:0xf bank_mask:0x3
  buffer_load_dwordx4 v65, s[32:35], 0 offen lds
  s_nop 0
  v_add_u32_dpp v64, v50, v2 row_newbcast:8 row_mask:0xf bank_mask:0xc
  v_add_u32_dpp v65, v52, v2 row_newbcast:2 row_mask:0xf bank_mask:0x3
  s_nop 1
  v_add_u32_dpp v65, v54, v2 row_newbcast:8 row_mask:0xf bank_mask:0xc
  s_mov_b64 exec, 0x3ff
  buffer_load_dword v103, v84, s[44:47], s85 offen
  s_mov_b64 exec, -1
  s_add_u32 s85, s85, 865280
  s_waitcnt vmcnt(11)
  s_barrier
  s_add_u32 m0, s75, 147456
  s_nop 0
  buffer_load_dwordx4 v4, s[44:47], s74 offen lds
  s_add_u32 m0, s75, 148480
  s_nop 0
  buffer_load_dwordx4 v5, s[44:47], s74 offen lds
  s_add_u32 s74, s74, 106496
  s_add_u32 m0, s75, 155648
  s_nop 0
  buffer_load_dwordx4 v4, s[44:47], s74 offen lds
  s_add_u32 m0, s75, 156672
  s_nop 0
  buffer_load_dwordx4 v5, s[44:47], s74 offen lds
  s_add_u32 s74, s74, 106496
  s_add_u32 m0, s76, 81920
  s_nop 0
  buffer_load_dwordx4 v56, s[32:35], 0 offen lds
  s_add_u32 m0, s76, 83968
  v_add_u32_dpp v56, v17, v2 row_newbcast:2 row_mask:0xf bank_mask:0x3
  buffer_load_dwordx4 v57, s[32:35], 0 offen lds
  s_nop 0
  v_add_u32_dpp v56, v19, v2 row_newbcast:8 row_mask:0xf bank_mask:0xc
  s_add_u32 m0, s76, 86016
  v_add_u32_dpp v57, v21, v2 row_newbcast:2 row_mask:0xf bank_mask:0x3
  buffer_load_dwordx4 v58, s[32:35], 0 offen lds
  s_nop 0
  v_add_u32_dpp v57, v23, v2 row_newbcast:8 row_mask:0xf bank_mask:0xc
  s_add_u32 m0, s76, 88064
  v_add_u32_dpp v58, v25, v2 row_newbcast:2 row_mask:0xf bank_mask:0x3
  buffer_load_dwordx4 v59, s[32:35], 0 offen lds
  s_nop 0
  v_add_u32_dpp v58, v27, v2 row_newbcast:8 row_mask:0xf bank_mask:0xc
  s_add_u32 m0, s76, 90112
  v_add_u32_dpp v59, v29, v2 row_newbcast:2 row_mask:0xf bank_mask:0x3
  buffer_load_dwordx4 v60, s[32:35], 0 offen lds
  s_nop 0
  v_add_u32_dpp v59, v31, v2 row_newbcast:8 row_mask:0xf bank_mask:0xc
  s_add_u32 m0, s76, 92160
  v_add_u32_dpp v60, v33, v2 row_newbcast:2 row_mask:0xf bank_mask:0x3
  buffer_load_dwordx4 v61, s[32:35], 0 offen lds
  s_nop 0
  v_add_u32_dpp v60, v35, v2 row_newbcast:8 row_mask:0xf bank_mask:0xc
  s_add_u32 m0, s76, 94208
  v_add_u32_dpp v61, v37, v2 row_newbcast:2 row_mask:0xf bank_mask:0x3
  buffer_load_dwordx4 v62, s[32:35], 0 offen lds
  s_nop 0
  v_add_u32_dpp v61, v39, v2 row_newbcast:8 row_mask:0xf bank_mask:0xc
  s_add_u32 m0, s76, 96256
  v_add_u32_dpp v62, v41, v2 row_newbcast:2 row_mask:0xf bank_mask:0x3
  buffer_load_dwordx4 v63, s[32:35], 0 offen lds
  s_nop 0
  v_add_u32_dpp v62, v43, v2 row_newbcast:8 row_mask:0xf bank_mask:0xc
  s_add_u32 m0, s76, 98304
  v_add_u32_dpp v63, v45, v2 row_newbcast:2 row_mask:0xf bank_mask:0x3
  buffer_load_dwordx4 v64, s[32:35], 0 offen lds
  s_nop 0
  v_add_u32_dpp v63, v47, v2 row_newbcast:8 row_mask:0xf bank_mask:0xc
  s_add_u32 m0, s76, 100352
  v_add_u32_dpp v64, v49, v2 row_newbcast:2 row_mask:0xf bank_mask:0x3
  buffer_load_dwordx4 v65, s[32:35], 0 offen lds
  s_nop 0
  v_add_u32_dpp v64, v51, v2 row_newbcast:8 row_mask:0xf bank_mask:0xc
  v_add_u32_dpp v65, v53, v2 row_newbcast:2 row_mask:0xf bank_mask:0x3
  s_nop 1
  v_add_u32_dpp v65, v55, v2 row_newbcast:8 row_mask:0xf bank_mask:0xc
  s_waitcnt vmcnt(10)
  s_barrier
  s_add_u32 m0, s75, 131072
  s_nop 0
  buffer_load_dwordx4 v4, s[44:47], s74 offen lds
  s_add_u32 m0, s75, 132096
  s_nop 0
  buffer_load_dwordx4 v5, s[44:47], s74 offen lds
  s_add_u32 s74, s74, 106496
  s_add_u32 m0, s75, 139264
  s_nop 0
  buffer_load_dwordx4 v4, s[44:47], s74 offen lds
  s_add_u32 m0, s75, 140288
  s_nop 0
  buffer_load_dwordx4 v5, s[44:47], s74 offen lds
  s_add_u32 s74, s74, 106496
  s_add_u32 m0, s76, 0
  s_nop 0
  buffer_load_dwordx4 v56, s[32:35], 0 offen lds
  s_add_u32 m0, s76, 2048
  v_add_u32_dpp v56, v18, v2 row_newbcast:2 row_mask:0xf bank_mask:0x3
  buffer_load_dwordx4 v57, s[32:35], 0 offen lds
  s_nop 0
  v_add_u32_dpp v56, v16, v2 row_newbcast:9 row_mask:0xf bank_mask:0xc
  s_add_u32 m0, s76, 4096
  v_add_u32_dpp v57, v22, v2 row_newbcast:2 row_mask:0xf bank_mask:0x3
  buffer_load_dwordx4 v58, s[32:35], 0 offen lds
  s_nop 0
  v_add_u32_dpp v57, v20, v2 row_newbcast:9 row_mask:0xf bank_mask:0xc
  s_add_u32 m0, s76, 6144
  v_add_u32_dpp v58, v26, v2 row_newbcast:2 row_mask:0xf bank_mask:0x3
  buffer_load_dwordx4 v59, s[32:35], 0 offen lds
  s_nop 0
  v_add_u32_dpp v58, v24, v2 row_newbcast:9 row_mask:0xf bank_mask:0xc
  s_add_u32 m0, s76, 8192
  v_add_u32_dpp v59, v30, v2 row_newbcast:2 row_mask:0xf bank_mask:0x3
  buffer_load_dwordx4 v60, s[32:35], 0 offen lds
  s_nop 0
  v_add_u32_dpp v59, v28, v2 row_newbcast:9 row_mask:0xf bank_mask:0xc
  s_add_u32 m0, s76, 10240
  v_add_u32_dpp v60, v34, v2 row_newbcast:2 row_mask:0xf bank_mask:0x3
  buffer_load_dwordx4 v61, s[32:35], 0 offen lds
  s_nop 0
  v_add_u32_dpp v60, v32, v2 row_newbcast:9 row_mask:0xf bank_mask:0xc
  s_add_u32 m0, s76, 12288
  v_add_u32_dpp v61, v38, v2 row_newbcast:2 row_mask:0xf bank_mask:0x3
  buffer_load_dwordx4 v62, s[32:35], 0 offen lds
  s_nop 0
  v_add_u32_dpp v61, v36, v2 row_newbcast:9 row_mask:0xf bank_mask:0xc
  s_add_u32 m0, s76, 14336
  v_add_u32_dpp v62, v42, v2 row_newbcast:2 row_mask:0xf bank_mask:0x3
  buffer_load_dwordx4 v63, s[32:35], 0 offen lds
  s_nop 0
  v_add_u32_dpp v62, v40, v2 row_newbcast:9 row_mask:0xf bank_mask:0xc
  s_add_u32 m0, s76, 16384
  v_add_u32_dpp v63, v46, v2 row_newbcast:2 row_mask:0xf bank_mask:0x3
  buffer_load_dwordx4 v64, s[32:35], 0 offen lds
  s_nop 0
  v_add_u32_dpp v63, v44, v2 row_newbcast:9 row_mask:0xf bank_mask:0xc
  s_add_u32 m0, s76, 18432
  v_add_u32_dpp v64, v50, v2 row_newbcast:2 row_mask:0xf bank_mask:0x3
  buffer_load_dwordx4 v65, s[32:35], 0 offen lds
  s_nop 0
  v_add_u32_dpp v64, v48, v2 row_newbcast:9 row_mask:0xf bank_mask:0xc
  v_add_u32_dpp v65, v54, v2 row_newbcast:2 row_mask:0xf bank_mask:0x3
  s_nop 1
  v_add_u32_dpp v65, v52, v2 row_newbcast:9 row_mask:0xf bank_mask:0xc
  v_lshlrev_b32 v101, 7, v70
  s_mov_b32 exec_lo, 0xffffffff
  s_mov_b32 exec_hi, 0x0
  buffer_load_dword v102, v101, s[32:35], 0 offen
  s_mov_b64 exec, -1
  v_mov_b32 v70, v71
  v_mov_b32 v71, v72
  v_mov_b32 v72, v73
  v_mov_b32 v73, v74
  v_mov_b32 v74, 0xffffff
  s_waitcnt vmcnt(11)
  s_barrier
  s_add_u32 m0, s75, 147456
  s_nop 0
  buffer_load_dwordx4 v4, s[44:47], s74 offen lds
  s_add_u32 m0, s75, 148480
  s_nop 0
  buffer_load_dwordx4 v5, s[44:47], s74 offen lds
  s_add_u32 s74, s74, 106496
  s_add_u32 m0, s75, 155648
  s_nop 0
  buffer_load_dwordx4 v4, s[44:47], s74 offen lds
  s_add_u32 m0, s75, 156672
  s_nop 0
  buffer_load_dwordx4 v5, s[44:47], s74 offen lds
  s_add_u32 s74, s74, 106496
  s_add_u32 m0, s76, 40960
  s_nop 0
  buffer_load_dwordx4 v56, s[32:35], 0 offen lds
  s_add_u32 m0, s76, 43008
  v_add_u32_dpp v56, v19, v2 row_newbcast:2 row_mask:0xf bank_mask:0x3
  buffer_load_dwordx4 v57, s[32:35], 0 offen lds
  s_nop 0
  v_add_u32_dpp v56, v17, v2 row_newbcast:9 row_mask:0xf bank_mask:0xc
  s_add_u32 m0, s76, 45056
  v_add_u32_dpp v57, v23, v2 row_newbcast:2 row_mask:0xf bank_mask:0x3
  buffer_load_dwordx4 v58, s[32:35], 0 offen lds
  s_nop 0
  v_add_u32_dpp v57, v21, v2 row_newbcast:9 row_mask:0xf bank_mask:0xc
  s_add_u32 m0, s76, 47104
  v_add_u32_dpp v58, v27, v2 row_newbcast:2 row_mask:0xf bank_mask:0x3
  buffer_load_dwordx4 v59, s[32:35], 0 offen lds
  s_nop 0
  v_add_u32_dpp v58, v25, v2 row_newbcast:9 row_mask:0xf bank_mask:0xc
  s_add_u32 m0, s76, 49152
  v_add_u32_dpp v59, v31, v2 row_newbcast:2 row_mask:0xf bank_mask:0x3
  buffer_load_dwordx4 v60, s[32:35], 0 offen lds
  s_nop 0
  v_add_u32_dpp v59, v29, v2 row_newbcast:9 row_mask:0xf bank_mask:0xc
  s_add_u32 m0, s76, 51200
  v_add_u32_dpp v60, v35, v2 row_newbcast:2 row_mask:0xf bank_mask:0x3
  buffer_load_dwordx4 v61, s[32:35], 0 offen lds
  s_nop 0
  v_add_u32_dpp v60, v33, v2 row_newbcast:9 row_mask:0xf bank_mask:0xc
  s_add_u32 m0, s76, 53248
  v_add_u32_dpp v61, v39, v2 row_newbcast:2 row_mask:0xf bank_mask:0x3
  buffer_load_dwordx4 v62, s[32:35], 0 offen lds
  s_nop 0
  v_add_u32_dpp v61, v37, v2 row_newbcast:9 row_mask:0xf bank_mask:0xc
  s_add_u32 m0, s76, 55296
  v_add_u32_dpp v62, v43, v2 row_newbcast:2 row_mask:0xf bank_mask:0x3
  buffer_load_dwordx4 v63, s[32:35], 0 offen lds
  s_nop 0
  v_add_u32_dpp v62, v41, v2 row_newbcast:9 row_mask:0xf bank_mask:0xc
  s_add_u32 m0, s76, 57344
  v_add_u32_dpp v63, v47, v2 row_newbcast:2 row_mask:0xf bank_mask:0x3
  buffer_load_dwordx4 v64, s[32:35], 0 offen lds
  s_nop 0
  v_add_u32_dpp v63, v45, v2 row_newbcast:9 row_mask:0xf bank_mask:0xc
  s_add_u32 m0, s76, 59392
  v_add_u32_dpp v64, v51, v2 row_newbcast:2 row_mask:0xf bank_mask:0x3
  buffer_load_dwordx4 v65, s[32:35], 0 offen lds
  s_nop 0
  v_add_u32_dpp v64, v49, v2 row_newbcast:9 row_mask:0xf bank_mask:0xc
  v_add_u32_dpp v65, v55, v2 row_newbcast:2 row_mask:0xf bank_mask:0x3
  s_nop 1
  v_add_u32_dpp v65, v53, v2 row_newbcast:9 row_mask:0xf bank_mask:0xc
  s_waitcnt vmcnt(10)
  s_cmp_lg_u32 s72, 1
  s_cbranch_scc1 L_nolpf
  s_mov_b64 exec, 1048575
  global_load_dword v10, v[8:9], off
  s_mov_b64 exec, -1
  s_mov_b32 m0, 123136
  s_mov_b64 exec, 0xffff
  buffer_load_dwordx4 v11, s[52:55], s77 offen lds
  s_mov_b64 exec, -1
L_nolpf:
  s_barrier
  s_add_u32 m0, s75, 131072
  s_nop 0
  buffer_load_dwordx4 v4, s[44:47], s74 offen lds
  s_add_u32 m0, s75, 132096
  s_nop 0
  buffer_load_dwordx4 v5, s[44:47], s74 offen lds
  s_add_u32 s74, s74, 106496
  s_add_u32 m0, s75, 139264
  s_nop 0
  buffer_load_dwordx4 v4, s[44:47], s74 offen lds
  s_add_u32 m0, s75, 140288
  s_nop 0
  buffer_load_dwordx4 v5, s[44:47], s74 offen lds
  s_add_u32 s74, s74, 106496
  s_add_u32 m0, s76, 81920
  s_nop 0
  buffer_load_dwordx4 v56, s[32:35], 0 offen lds
  s_add_u32 m0, s76, 83968
  v_add_u32_dpp v56, v16, v2 row_newbcast:3 row_mask:0xf bank_mask:0x3
  buffer_load_dwordx4 v57, s[32:35], 0 offen lds
  s_nop 0
  v_add_u32_dpp v56, v18, v2 row_newbcast:9 row_mask:0xf bank_mask:0xc
  s_add_u32 m0, s76, 86016
  v_add_u32_dpp v57, v20, v2 row_newbcast:3 row_mask:0xf bank_mask:0x3
  buffer_load_dwordx4 v58, s[32:35], 0 offen lds
  s_nop 0
  v_add_u32_dpp v57, v22, v2 row_newbcast:9 row_mask:0xf bank_mask:0xc
  s_add_u32 m0, s76, 88064
  v_add_u32_dpp v58, v24, v2 row_newbcast:3 row_mask:0xf bank_mask:0x3
  buffer_load_dwordx4 v59, s[32:35], 0 offen lds
  s_nop 0
  v_add_u32_dpp v58, v26, v2 row_newbcast:9 row_mask:0xf bank_mask:0xc
  s_add_u32 m0, s76, 90112
  v_add_u32_dpp v59, v28, v2 row_newbcast:3 row_mask:0xf bank_mask:0x3
  buffer_load_dwordx4 v60, s[32:35], 0 offen lds
  s_nop 0
  v_add_u32_dpp v59, v30, v2 row_newbcast:9 row_mask:0xf bank_mask:0xc
  s_add_u32 m0, s76, 92160
  v_add_u32_dpp v60, v32, v2 row_newbcast:3 row_mask:0xf bank_mask:0x3
  buffer_load_dwordx4 v61, s[32:35], 0 offen lds
  s_nop 0
  v_add_u32_dpp v60, v34, v2 row_newbcast:9 row_mask:0xf bank_mask:0xc
  s_add_u32 m0, s76, 94208
  v_add_u32_dpp v61, v36, v2 row_newbcast:3 row_mask:0xf bank_mask:0x3
  buffer_load_dwordx4 v62, s[32:35], 0 offen lds
  s_nop 0
  v_add_u32_dpp v61, v38, v2 row_newbcast:9 row_mask:0xf bank_mask:0xc
  s_add_u32 m0, s76, 96256
  v_add_u32_dpp v62, v40, v2 row_newbcast:3 row_mask:0xf bank_mask:0x3
  buffer_load_dwordx4 v63, s[32:35], 0 offen lds
  s_nop 0
  v_add_u32_dpp v62, v42, v2 row_newbcast:9 row_mask:0xf bank_mask:0xc
  s_add_u32 m0, s76, 98304
  v_add_u32_dpp v63, v44, v2 row_newbcast:3 row_mask:0xf bank_mask:0x3
  buffer_load_dwordx4 v64, s[32:35], 0 offen lds
  s_nop 0
  v_add_u32_dpp v63, v46, v2 row_newbcast:9 row_mask:0xf bank_mask:0xc
  s_add_u32 m0, s76, 100352
  v_add_u32_dpp v64, v48, v2 row_newbcast:3 row_mask:0xf bank_mask:0x3
  buffer_load_dwordx4 v65, s[32:35], 0 offen lds
  s_nop 0
  v_add_u32_dpp v64, v50, v2 row_newbcast:9 row_mask:0xf bank_mask:0xc
  v_add_u32_dpp v65, v52, v2 row_newbcast:3 row_mask:0xf bank_mask:0x3
  s_nop 1
  v_add_u32_dpp v65, v54, v2 row_newbcast:9 row_mask:0xf bank_mask:0xc
  s_mov_b64 exec, 0x3ff
  buffer_load_dword v103, v84, s[44:47], s85 offen
  s_mov_b64 exec, -1
  s_add_u32 s85, s85, 865280
  s_waitcnt vmcnt(11)
  s_barrier
  s_add_u32 m0, s75, 147456
  s_nop 0
  buffer_load_dwordx4 v4, s[44:47], s74 offen lds
  s_add_u32 m0, s75, 148480
  s_nop 0
  buffer_load_dwordx4 v5, s[44:47], s74 offen lds
  s_add_u32 s74, s74, 106496
  s_add_u32 m0, s75, 155648
  s_nop 0
  buffer_load_dwordx4 v4, s[44:47], s74 offen lds
  s_add_u32 m0, s75, 156672
  s_nop 0
  buffer_load_dwordx4 v5, s[44:47], s74 offen lds
  s_add_u32 s74, s74, 106496
  s_add_u32 m0, s76, 0
  s_nop 0
  buffer_load_dwordx4 v56, s[32:35], 0 offen lds
  s_add_u32 m0, s76, 2048
  v_add_u32_dpp v56, v17, v2 row_newbcast:3 row_mask:0xf bank_mask:0x3
  buffer_load_dwordx4 v57, s[32:35], 0 offen lds
  s_nop 0
  v_add_u32_dpp v56, v19, v2 row_newbcast:9 row_mask:0xf bank_mask:0xc
  s_add_u32 m0, s76, 4096
  v_add_u32_dpp v57, v21, v2 row_newbcast:3 row_mask:0xf bank_mask:0x3
  buffer_load_dwordx4 v58, s[32:35], 0 offen lds
  s_nop 0
  v_add_u32_dpp v57, v23, v2 row_newbcast:9 row_mask:0xf bank_mask:0xc
  s_add_u32 m0, s76, 6144
  v_add_u32_dpp v58, v25, v2 row_newbcast:3 row_mask:0xf bank_mask:0x3
  buffer_load_dwordx4 v59, s[32:35], 0 offen lds
  s_nop 0
  v_add_u32_dpp v58, v27, v2 row_newbcast:9 row_mask:0xf bank_mask:0xc
  s_add_u32 m0, s76, 8192
  v_add_u32_dpp v59, v29, v2 row_newbcast:3 row_mask:0xf bank_mask:0x3
  buffer_load_dwordx4 v60, s[32:35], 0 offen lds
  s_nop 0
  v_add_u32_dpp v59, v31, v2 row_newbcast:9 row_mask:0xf bank_mask:0xc
  s_add_u32 m0, s76, 10240
  v_add_u32_dpp v60, v33, v2 row_newbcast:3 row_mask:0xf bank_mask:0x3
  buffer_load_dwordx4 v61, s[32:35], 0 offen lds
  s_nop 0
  v_add_u32_dpp v60, v35, v2 row_newbcast:9 row_mask:0xf bank_mask:0xc
  s_add_u32 m0, s76, 12288
  v_add_u32_dpp v61, v37, v2 row_newbcast:3 row_mask:0xf bank_mask:0x3
  buffer_load_dwordx4 v62, s[32:35], 0 offen lds
  s_nop 0
  v_add_u32_dpp v61, v39, v2 row_newbcast:9 row_mask:0xf bank_mask:0xc
  s_add_u32 m0, s76, 14336
  v_add_u32_dpp v62, v41, v2 row_newbcast:3 row_mask:0xf bank_mask:0x3
  buffer_load_dwordx4 v63, s[32:35], 0 offen lds
  s_nop 0
  v_add_u32_dpp v62, v43, v2 row_newbcast:9 row_mask:0xf bank_mask:0xc
  s_add_u32 m0, s76, 16384
  v_add_u32_dpp v63, v45, v2 row_newbcast:3 row_mask:0xf bank_mask:0x3
  buffer_load_dwordx4 v64, s[32:35], 0 offen lds
  s_nop 0
  v_add_u32_dpp v63, v47, v2 row_newbcast:9 row_mask:0xf bank_mask:0xc
  s_add_u32 m0, s76, 18432
  v_add_u32_dpp v64, v49, v2 row_newbcast:3 row_mask:0xf bank_mask:0x3
  buffer_load_dwordx4 v65, s[32:35], 0 offen lds
  s_nop 0
  v_add_u32_dpp v64, v51, v2 row_newbcast:9 row_mask:0xf bank_mask:0xc
  v_add_u32_dpp v65, v53, v2 row_newbcast:3 row_mask:0xf bank_mask:0x3
  s_nop 1
  v_add_u32_dpp v65, v55, v2 row_newbcast:9 row_mask:0xf bank_mask:0xc
  s_waitcnt vmcnt(10)
  s_barrier
  s_add_u32 m0, s75, 131072
  s_nop 0
  buffer_load_dwordx4 v4, s[44:47], s74 offen lds
  s_add_u32 m0, s75, 132096
  s_nop 0
  buffer_load_dwordx4 v5, s[44:47], s74 offen lds
  s_add_u32 s74, s74, 106496
  s_add_u32 m0, s75, 139264
  s_nop 0
  buffer_load_dwordx4 v4, s[44:47], s74 offen lds
  s_add_u32 m0, s75, 140288
  s_nop 0
  buffer_load_dwordx4 v5, s[44:47], s74 offen lds
  s_add_u32 s74, s74, 106496
  s_add_u32 m0, s76, 40960
  s_nop 0
  buffer_load_dwordx4 v56, s[32:35], 0 offen lds
  s_add_u32 m0, s76, 43008
  v_add_u32_dpp v56, v18, v2 row_newbcast:3 row_mask:0xf bank_mask:0x3
  buffer_load_dwordx4 v57, s[32:35], 0 offen lds
  s_nop 0
  v_add_u32_dpp v56, v16, v2 row_newbcast:10 row_mask:0xf bank_mask:0xc
  s_add_u32 m0, s76, 45056
  v_add_u32_dpp v57, v22, v2 row_newbcast:3 row_mask:0xf bank_mask:0x3
  buffer_load_dwordx4 v58, s[32:35], 0 offen lds
  s_nop 0
  v_add_u32_dpp v57, v20, v2 row_newbcast:10 row_mask:0xf bank_mask:0xc
  s_add_u32 m0, s76, 47104
  v_add_u32_dpp v58, v26, v2 row_newbcast:3 row_mask:0xf bank_mask:0x3
  buffer_load_dwordx4 v59, s[32:35], 0 offen lds
  s_nop 0
  v_add_u32_dpp v58, v24, v2 row_newbcast:10 row_mask:0xf bank_mask:0xc
  s_add_u32 m0, s76, 49152
  v_add_u32_dpp v59, v30, v2 row_newbcast:3 row_mask:0xf bank_mask:0x3
  buffer_load_dwordx4 v60, s[32:35], 0 offen lds
  s_nop 0
  v_add_u32_dpp v59, v28, v2 row_newbcast:10 row_mask:0xf bank_mask:0xc
  s_add_u32 m0, s76, 51200
  v_add_u32_dpp v60, v34, v2 row_newbcast:3 row_mask:0xf bank_mask:0x3
  buffer_load_dwordx4 v61, s[32:35], 0 offen lds
  s_nop 0
  v_add_u32_dpp v60, v32, v2 row_newbcast:10 row_mask:0xf bank_mask:0xc
  s_add_u32 m0, s76, 53248
  v_add_u32_dpp v61, v38, v2 row_newbcast:3 row_mask:0xf bank_mask:0x3
  buffer_load_dwordx4 v62, s[32:35], 0 offen lds
  s_nop 0
  v_add_u32_dpp v61, v36, v2 row_newbcast:10 row_mask:0xf bank_mask:0xc
  s_add_u32 m0, s76, 55296
  v_add_u32_dpp v62, v42, v2 row_newbcast:3 row_mask:0xf bank_mask:0x3
  buffer_load_dwordx4 v63, s[32:35], 0 offen lds
  s_nop 0
  v_add_u32_dpp v62, v40, v2 row_newbcast:10 row_mask:0xf bank_mask:0xc
  s_add_u32 m0, s76, 57344
  v_add_u32_dpp v63, v46, v2 row_newbcast:3 row_mask:0xf bank_mask:0x3
  buffer_load_dwordx4 v64, s[32:35], 0 offen lds
  s_nop 0
  v_add_u32_dpp v63, v44, v2 row_newbcast:10 row_mask:0xf bank_mask:0xc
  s_add_u32 m0, s76, 59392
  v_add_u32_dpp v64, v50, v2 row_newbcast:3 row_mask:0xf bank_mask:0x3
  buffer_load_dwordx4 v65, s[32:35], 0 offen lds
  s_nop 0
  v_add_u32_dpp v64, v48, v2 row_newbcast:10 row_mask:0xf bank_mask:0xc
  v_add_u32_dpp v65, v54, v2 row_newbcast:3 row_mask:0xf bank_mask:0x3
  s_nop 1
  v_add_u32_dpp v65, v52, v2 row_newbcast:10 row_mask:0xf bank_mask:0xc
  v_mov_b32_dpp v16, v16 row_shl:3 row_mask:0xf bank_mask:0xf
  v_mov_b32_dpp v18, v18 row_shl:3 row_mask:0xf bank_mask:0xf
  v_mov_b32_dpp v20, v20 row_shl:3 row_mask:0xf bank_mask:0xf
  v_mov_b32_dpp v22, v22 row_shl:3 row_mask:0xf bank_mask:0xf
  v_mov_b32_dpp v24, v24 row_shl:3 row_mask:0xf bank_mask:0xf
  v_mov_b32_dpp v26, v26 row_shl:3 row_mask:0xf bank_mask:0xf
  v_mov_b32_dpp v28, v28 row_shl:3 row_mask:0xf bank_mask:0xf
  v_mov_b32_dpp v30, v30 row_shl:3 row_mask:0xf bank_mask:0xf
  v_mov_b32_dpp v32, v32 row_shl:3 row_mask:0xf bank_mask:0xf
  v_mov_b32_dpp v34, v34 row_shl:3 row_mask:0xf bank_mask:0xf
  v_mov_b32_dpp v36, v36 row_shl:3 row_mask:0xf bank_mask:0xf
  v_mov_b32_dpp v38, v38 row_shl:3 row_mask:0xf bank_mask:0xf
  v_mov_b32_dpp v40, v40 row_shl:3 row_mask:0xf bank_mask:0xf
  v_mov_b32_dpp v42, v42 row_shl:3 row_mask:0xf bank_mask:0xf
  v_mov_b32_dpp v44, v44 row_shl:3 row_mask:0xf bank_mask:0xf
  v_mov_b32_dpp v46, v46 row_shl:3 row_mask:0xf bank_mask:0xf
  v_mov_b32_dpp v48, v48 row_shl:3 row_mask:0xf bank_mask:0xf
  v_mov_b32_dpp v50, v50 row_shl:3 row_mask:0xf bank_mask:0xf
  v_mov_b32_dpp v52, v52 row_shl:3 row_mask:0xf bank_mask:0xf
  v_mov_b32_dpp v54, v54 row_shl:3 row_mask:0xf bank_mask:0xf
  v_lshlrev_b32 v101, 7, v70
  s_mov_b32 exec_lo, 0xffffffff
  s_mov_b32 exec_hi, 0x0
  buffer_load_dword v102, v101, s[32:35], 0 offen
  s_mov_b64 exec, -1
  v_mov_b32 v70, v71
  v_mov_b32 v71, v72
  v_mov_b32 v72, v73
  v_mov_b32 v73, v74
  v_mov_b32 v74, 0xffffff
  s_waitcnt vmcnt(11)
  s_barrier
  s_add_u32 m0, s75, 147456
  s_nop 0
  buffer_load_dwordx4 v4, s[44:47], s74 offen lds
  s_add_u32 m0, s75, 148480
  s_nop 0
  buffer_load_dwordx4 v5, s[44:47], s74 offen lds
  s_add_u32 s74, s74, 106496
  s_add_u32 m0, s75, 155648
  s_nop 0
  buffer_load_dwordx4 v4, s[44:47], s74 offen lds
  s_add_u32 m0, s75, 156672
  s_nop 0
  buffer_load_dwordx4 v5, s[44:47], s74 offen lds
  s_add_u32 s74, s74, 106496
  s_cmp_eq_u32 s72, 1
  s_cbranch_scc1 L_ld_tail0
  s_add_u32 m0, s76, 81920
  s_nop 0
  buffer_load_dwordx4 v56, s[32:35], 0 offen lds
  s_add_u32 m0, s76, 83968
  v_add_u32_dpp v56, v19, v2 row_newbcast:3 row_mask:0xf bank_mask:0x3
  buffer_load_dwordx4 v57, s[32:35], 0 offen lds
  s_nop 0
  v_add_u32_dpp v56, v17, v2 row_newbcast:10 row_mask:0xf bank_mask:0xc
  s_add_u32 m0, s76, 86016
  v_add_u32_dpp v57, v23, v2 row_newbcast:3 row_mask:0xf bank_mask:0x3
  buffer_load_dwordx4 v58, s[32:35], 0 offen lds
  s_nop 0
  v_add_u32_dpp v57, v21, v2 row_newbcast:10 row_mask:0xf bank_mask:0xc
  s_add_u32 m0, s76, 88064
  v_add_u32_dpp v58, v27, v2 row_newbcast:3 row_mask:0xf bank_mask:0x3
  buffer_load_dwordx4 v59, s[32:35], 0 offen lds
  s_nop 0
  v_add_u32_dpp v58, v25, v2 row_newbcast:10 row_mask:0xf bank_mask:0xc
  s_add_u32 m0, s76, 90112
  v_add_u32_dpp v59, v31, v2 row_newbcast:3 row_mask:0xf bank_mask:0x3
  buffer_load_dwordx4 v60, s[32:35], 0 offen lds
  s_nop 0
  v_add_u32_dpp v59, v29, v2 row_newbcast:10 row_mask:0xf bank_mask:0xc
  s_add_u32 m0, s76, 92160
  v_add_u32_dpp v60, v35, v2 row_newbcast:3 row_mask:0xf bank_mask:0x3
  buffer_load_dwordx4 v61, s[32:35], 0 offen lds
  s_nop 0
  v_add_u32_dpp v60, v33, v2 row_newbcast:10 row_mask:0xf bank_mask:0xc
  s_add_u32 m0, s76, 94208
  v_add_u32_dpp v61, v39, v2 row_newbcast:3 row_mask:0xf bank_mask:0x3
  buffer_load_dwordx4 v62, s[32:35], 0 offen lds
  s_nop 0
  v_add_u32_dpp v61, v37, v2 row_newbcast:10 row_mask:0xf bank_mask:0xc
  s_add_u32 m0, s76, 96256
  v_add_u32_dpp v62, v43, v2 row_newbcast:3 row_mask:0xf bank_mask:0x3
  buffer_load_dwordx4 v63, s[32:35], 0 offen lds
  s_nop 0
  v_add_u32_dpp v62, v41, v2 row_newbcast:10 row_mask:0xf bank_mask:0xc
  s_add_u32 m0, s76, 98304
  v_add_u32_dpp v63, v47, v2 row_newbcast:3 row_mask:0xf bank_mask:0x3
  buffer_load_dwordx4 v64, s[32:35], 0 offen lds
  s_nop 0
  v_add_u32_dpp v63, v45, v2 row_newbcast:10 row_mask:0xf bank_mask:0xc
  s_add_u32 m0, s76, 100352
  v_add_u32_dpp v64, v51, v2 row_newbcast:3 row_mask:0xf bank_mask:0x3
  buffer_load_dwordx4 v65, s[32:35], 0 offen lds
  s_nop 0
  v_add_u32_dpp v64, v49, v2 row_newbcast:10 row_mask:0xf bank_mask:0xc
  v_add_u32_dpp v65, v55, v2 row_newbcast:3 row_mask:0xf bank_mask:0x3
  s_nop 1
  v_add_u32_dpp v65, v53, v2 row_newbcast:10 row_mask:0xf bank_mask:0xc
  v_mov_b32_dpp v17, v17 row_shl:3 row_mask:0xf bank_mask:0xf
  v_mov_b32_dpp v19, v19 row_shl:3 row_mask:0xf bank_mask:0xf
  v_mov_b32_dpp v21, v21 row_shl:3 row_mask:0xf bank_mask:0xf
  v_mov_b32_dpp v23, v23 row_shl:3 row_mask:0xf bank_mask:0xf
  v_mov_b32_dpp v25, v25 row_shl:3 row_mask:0xf bank_mask:0xf
  v_mov_b32_dpp v27, v27 row_shl:3 row_mask:0xf bank_mask:0xf
  v_mov_b32_dpp v29, v29 row_shl:3 row_mask:0xf bank_mask:0xf
  v_mov_b32_dpp v31, v31 row_shl:3 row_mask:0xf bank_mask:0xf
  v_mov_b32_dpp v33, v33 row_shl:3 row_mask:0xf bank_mask:0xf
  v_mov_b32_dpp v35, v35 row_shl:3 row_mask:0xf bank_mask:0xf
  v_mov_b32_dpp v37, v37 row_shl:3 row_mask:0xf bank_mask:0xf
  v_mov_b32_dpp v39, v39 row_shl:3 row_mask:0xf bank_mask:0xf
  v_mov_b32_dpp v41, v41 row_shl:3 row_mask:0xf bank_mask:0xf
  v_mov_b32_dpp v43, v43 row_shl:3 row_mask:0xf bank_mask:0xf
  v_mov_b32_dpp v45, v45 row_shl:3 row_mask:0xf bank_mask:0xf
  v_mov_b32_dpp v47, v47 row_shl:3 row_mask:0xf bank_mask:0xf
  v_mov_b32_dpp v49, v49 row_shl:3 row_mask:0xf bank_mask:0xf
  v_mov_b32_dpp v51, v51 row_shl:3 row_mask:0xf bank_mask:0xf
  v_mov_b32_dpp v53, v53 row_shl:3 row_mask:0xf bank_mask:0xf
  v_mov_b32_dpp v55, v55 row_shl:3 row_mask:0xf bank_mask:0xf
  s_add_u32 s72, s72, 1
  s_cmp_lt_u32 s72, 2
  s_waitcnt vmcnt(10)
  s_cbranch_scc1 L_dnn_loop1
  s_branch L_ld_tail
L_cin:
  v_lshlrev_b32 v1, 4, v0
  s_and_b32 s79, s3, 3
  s_lshr_b32 s84, s3, 2
  s_lshl_b32 s95, s79, 10
  s_mul_i32 s26, s68, 11
  s_add_u32 s26, s26, s69
  s_sub_u32 s26, s26, 22
  s_cmp_eq_u32 s26, 86
  s_cbranch_scc1 L_end
  s_cmp_eq_u32 s84, 0
  s_cbranch_scc1 L_sc
  s_setprio 2
  v_add_u32 v2, L_tables-L_pc+4096, v1
  v_mov_b32 v3, s93
  v_add_co_u32 v2, vcc, s92, v2
  s_nop 1
  v_addc_co_u32 v3, vcc, 0, v3, vcc
  v_add_co_u32 v32, vcc, s95, v2
  s_nop 1
  v_addc_co_u32 v33, vcc, 0, v3, vcc
  global_load_dwordx4 v[224:227], v[2:3], off offset:-4096
  v_add_co_u32 v2, vcc, 0x1800, v2
  s_nop 1
  v_addc_co_u32 v3, vcc, 0, v3, vcc
  global_load_dwordx4 v[240:243], v[2:3], off
  s_cmp_lt_u32 s79, 3
  s_mov_b32 s70, 122176
  s_cselect_b32 s70, 81920, s70
  s_add_u32 m0, s95, 81920
  s_nop 0
  global_load_lds_dwordx4 v[32:33], off offset:-4096
  s_add_u32 m0, s95, s70
  s_nop 0
  global_load_lds_dwordx4 v[32:33], off offset:0
  v_add_co_u32 v32, vcc, 0x2000, v32
  s_nop 1
  v_addc_co_u32 v33, vcc, 0, v33, vcc
  s_add_u32 m0, s95, 2048
  s_nop 0
  global_load_lds_dwordx4 v[32:33], off offset:0
  s_add_u32 m0, s95, 130368
  s_cmp_ge_u32 s79, 2
  s_cbranch_scc1 L_sc
  global_load_lds_dwordx4 v[32:33], off offset:-4096
L_sc:
  s_mul_i32 s85, s84, 20
  s_add_u32 s85, s85, s3
  s_mul_i32 s94, s26, 48
  s_add_u32 s94, s94, s85
  s_mul_i32 s94, s94, 104
  v_lshrrev_b32 v30, 3, v0
  v_lshlrev_b32 v30, 4, v30
  v_and_b32 v29, 0x70, v1
  s_mul_i32 s76, s3, 4064
  s_add_u32 s76, s76, 131136
  s_cmp_eq_u32 s84, 0
  s_cbranch_scc1 L_g0
  s_sub_u32 s68, s71, 22
  s_min_u32 s68, s68, 9
  s_lshl_b32 s68, s68, 2
  s_add_u32 s68, s68, s79
  s_lshl_b32 s68, s68, 7
  v_mul_u32_u24 v31, 5120, v0
  s_waitcnt lgkmcnt(0)
  s_mov_b32 s36, s8
  s_and_b32 s37, s9, 0xffff
  s_mov_b32 s38, 105456
  s_mov_b32 s39, 0x20000
  buffer_load_dword v107, v31, s[36:39], s68 offen
  s_waitcnt lgkmcnt(0)
  s_mov_b32 s40, s10
  s_and_b32 s41, s11, 0xffff
  s_mov_b32 s42, 156
  s_mov_b32 s43, 0x20000
  s_mov_b32 m0, 129472
  s_mov_b64 exec, 0x7ff
  buffer_load_dwordx4 v1, s[40:43], 0 offen lds
  s_mov_b64 exec, -1
  s_barrier
  s_lshl_b32 s85, s85, 2
  s_add_u32 s85, s85, 129728
  s_mul_i32 s72, s84, 3
  s_sub_u32 s72, 4, s72
  s_cmp_eq_u32 s26, 85
  s_cselect_b32 s72, s72, 6
  s_lshl_b32 s52, s3, 7
  s_mul_i32 s53, s3, 5280
  s_lshl_b32 s54, s3, 2
  s_lshl_b32 s55, s3, 1
  s_lshl_b32 s82, s3, 12
  s_and_b32 s98, s3, 1
  s_lshr_b32 s99, s3, 1
  s_mul_i32 s68, s99, 3072
  s_lshl_b32 s83, s98, 3
  s_add_u32 s68, s68, s83
  v_add_u32_e64 v59, s68, v1
  s_lshl_b32 s69, s99, 3
  s_lshr_b32 s69, 0x05030200, s69
  s_and_b32 s69, s69, 0xff
  s_lshl_b32 s69, s69, 9
  s_lshl_b32 s70, s98, 2
  s_add_u32 s91, s69, s70
  s_mov_b32 s99, 0x05040100
  s_mov_b32 s100, 0x07060302
  v_mov_b32 v2, 129664
  v_mov_b32 v109, 0
  v_mov_b32 v108, 0
  v_mov_b64 v[32:33], 0
  v_mov_b64 v[34:35], 0
  v_mov_b64 v[36:37], 0
  v_mov_b64 v[38:39], 0
  v_mov_b64 v[40:41], 0
  v_mov_b64 v[42:43], 0
  v_mov_b64 v[44:45], 0
  v_mov_b64 v[46:47], 0
  v_mov_b64 v[48:49], 0
  v_mov_b64 v[50:51], 0
  v_mov_b64 v[52:53], 0
  v_mov_b64 v[54:55], 0
  v_mov_b64 v[56:57], 0
  v_add_u32 v250, 77824, v1
  s_waitcnt vmcnt(7)
  v_add_u32 v251, 125248, v1
  v_lshrrev_b32 v3, 5, v0
  v_lshl_add_u32 v3, v3, 2, v2
  s_mov_b32 s28, s4
  s_and_b32 s29, s5, 0xffff
  s_mov_b32 s30, 425984
  s_mov_b32 s31, 0x20000
  s_mov_b32 s32, s6
  s_and_b32 s33, s7, 0xffff
  s_mov_b32 s34, 12800000
  s_mov_b32 s35, 0x20000
  v_and_b32 v13, 31, v0
  v_min_u32 v13, 25, v13
  v_lshrrev_b32 v14, 5, v0
  v_mul_u32_u24 v14, 416, v14
  v_lshl_add_u32 v13, v13, 2, v14
  buffer_load_dword v14, v13, s[28:31], s94 offen
  v_min_u32 v12, 47, v0
  v_mul_u32_u24 v15, 16384, v12
  v_lshrrev_b32 v15, 16, v15
  v_mul_u32_u24 v15, 88, v15
  v_lshl_add_u32 v12, v12, 2, v15
  s_lshl_b32 s68, s26, 2
  s_add_u32 s68, s68, s79
  s_mul_i32 s68, s68, 1248
  buffer_load_dword v15, v12, s[28:31], s68 offen offset:16
  ds_write_b128 v2, v[32:35] offset:16
  s_lshl_b32 s68, s79, 6
  v_add_u32 v29, s68, v0
  v_mul_u32_u24 v30, 2521, v29
  v_lshrrev_b32 v30, 16, v30
  v_mul_u32_u24 v30, 12, v30
  v_lshl_add_u32 v28, v29, 1, v30
  v_add_u32 v29, 256, v29
  v_mul_u32_u24 v30, 2521, v29
  v_lshrrev_b32 v30, 16, v30
  v_mul_u32_u24 v30, 12, v30
  v_lshl_add_u32 v58, v29, 1, v30
  v_add_u32 v29, 256, v29
  v_mul_u32_u24 v30, 2521, v29
  v_lshrrev_b32 v30, 16, v30
  v_mul_u32_u24 v30, 12, v30
  v_lshl_add_u32 v111, v29, 1, v30
  v_cmp_gt_u32 vcc, 676, v29
  s_nop 0
  s_mov_b64 s[92:93], vcc
  v_lshlrev_b32_e64 v29, 3, v0
  s_mov_b32 exec_hi, 0xffff
  ds_write_b64 v29, v[32:33] offset:1664
  s_mov_b32 exec_hi, -1
  s_waitcnt vmcnt(7)
  ds_write_b32 v243, v32
  ds_write_b32 v243, v32 offset:43328
  s_waitcnt vmcnt(2)
  ds_read_b64 v[112:113], v240 offset:0
  ds_read_b64 v[114:115], v240 offset:8
  ds_read_b64 v[116:117], v240 offset:32
  ds_read_b64 v[118:119], v240 offset:40
  ds_read_u16 v110, v241
  s_mov_b64 exec, 0x3ffffff
  s_waitcnt lgkmcnt(0)
  ds_write_b16 v242, v110
  v_lshlrev_b32 v109, 17, v110
  v_lshrrev_b32 v109, 1, v109
  s_mov_b64 exec, -1
  v_add_u32 v225, s52, v225
  v_add_u32 v226, s52, v226
  v_add_u32 v227, s52, v227
  s_waitcnt lgkmcnt(0)
  s_barrier
  ds_read_b64_tr_b16 v[60:61], v225 offset:35328
  ds_read_b64_tr_b16 v[62:63], v225 offset:40736
  ds_read_b64_tr_b16 v[64:65], v226 offset:35328
  ds_read_b64_tr_b16 v[66:67], v227 offset:35328
  ds_read_b64_tr_b16 v[68:69], v225 offset:35392
  ds_read_b64_tr_b16 v[70:71], v225 offset:40800
  ds_read_b64_tr_b16 v[72:73], v226 offset:35392
  ds_read_b64_tr_b16 v[74:75], v227 offset:35392
  ds_read_b64_tr_b16 v[76:77], v225 offset:35840
  ds_read_b64_tr_b16 v[78:79], v225 offset:41248
  ds_read_b64_tr_b16 v[80:81], v226 offset:35840
  ds_read_b64_tr_b16 v[82:83], v227 offset:35840
  ds_read_b64_tr_b16 v[84:85], v225 offset:35904
  ds_read_b64_tr_b16 v[86:87], v225 offset:41312
  ds_read_b64_tr_b16 v[88:89], v226 offset:35904
  ds_read_b64_tr_b16 v[90:91], v227 offset:35904
  s_waitcnt lgkmcnt(14)
  v_mfma_f32_32x32x16_bf16 v[120:135], v[112:115], v[60:63], 0
  s_waitcnt lgkmcnt(12)
  v_mfma_f32_32x32x16_bf16 v[120:135], v[116:119], v[64:67], v[120:135]
  ds_read_b64_tr_b16 v[92:93], v225 offset:36352
  ds_read_b64_tr_b16 v[94:95], v225 offset:41760
  ds_read_b64_tr_b16 v[96:97], v226 offset:36352
  ds_read_b64_tr_b16 v[98:99], v227 offset:36352
  s_waitcnt lgkmcnt(14)
  v_mfma_f32_32x32x16_bf16 v[136:151], v[112:115], v[68:71], 0
  s_waitcnt lgkmcnt(12)
  v_mfma_f32_32x32x16_bf16 v[136:151], v[116:119], v[72:75], v[136:151]
  ds_read_b64_tr_b16 v[100:101], v225 offset:36416
  ds_read_b64_tr_b16 v[102:103], v225 offset:41824
  ds_read_b64_tr_b16 v[104:105], v226 offset:36416
  ds_read_b64_tr_b16 v[106:107], v227 offset:36416
  s_waitcnt lgkmcnt(14)
  v_mfma_f32_32x32x16_bf16 v[152:167], v[112:115], v[76:79], 0
  s_waitcnt lgkmcnt(12)
  v_mfma_f32_32x32x16_bf16 v[152:167], v[116:119], v[80:83], v[152:167]
  s_waitcnt lgkmcnt(10)
  v_mfma_f32_32x32x16_bf16 v[168:183], v[112:115], v[84:87], 0
  s_waitcnt lgkmcnt(8)
  v_mfma_f32_32x32x16_bf16 v[168:183], v[116:119], v[88:91], v[168:183]
  ds_read_b128 v[228:231], v250 offset:6144
  ds_read_b128 v[232:235], v251 offset:0
  ds_read_b128 v[4:7], v250 offset:3072
  ds_read_b128 v[8:11], v251 offset:2048
  ds_read_b128 v[20:23], v250 offset:1024
  ds_read_b128 v[24:27], v250 offset:2048
  ds_read_b128 v[216:219], v250 offset:4096
  ds_read_b128 v[220:223], v250 offset:5120
  ds_read_b128 v[236:239], v251 offset:1024
  s_waitcnt lgkmcnt(14)
  v_mfma_f32_32x32x16_bf16 v[184:199], v[112:115], v[92:95], 0
  s_waitcnt lgkmcnt(13)
  v_mfma_f32_32x32x16_bf16 v[184:199], v[116:119], v[96:99], v[184:199]
  s_waitcnt lgkmcnt(11)
  v_mfma_f32_32x32x16_bf16 v[200:215], v[112:115], v[100:103], 0
  s_waitcnt lgkmcnt(9)
  v_mfma_f32_32x32x16_bf16 v[200:215], v[116:119], v[104:107], v[200:215]
  s_waitcnt lgkmcnt(8)
  v_add_u32 v228, s54, v228
  v_add_u32 v229, s54, v229
  v_add_u32 v231, s83, v231
  v_add_u32 v230, s91, v230
  s_waitcnt lgkmcnt(7)
  v_mad_u32_u24 v232, v233, s3, v232
  v_add_u32 v234, s55, v234
  v_mad_u32_u24 v233, v233, 8, v232
  v_add_u32 v246, s82, v235
  v_add_u32 v247, 2048, v246
  v_add_u32 v31, 0, v234
  v_and_b32 v31, 3, v31
  v_lshl_add_u32 v244, v31, 4, v232
  v_add_u32 v31, 1, v234
  v_and_b32 v31, 3, v31
  v_lshl_add_u32 v245, v31, 4, v232
  v_add_u32 v245, 1664, v245
  v_add_u32 v31, 0, v234
  v_and_b32 v31, 3, v31
  v_lshl_add_u32 v248, v31, 4, v233
  v_add_u32 v31, 1, v234
  v_and_b32 v31, 3, v31
  v_lshl_add_u32 v249, v31, 4, v233
  v_add_u32 v249, 1664, v249
  s_waitcnt lgkmcnt(5)
  v_add_u32 v10, s76, v10
  v_add_u32 v4, s76, v4
  v_add_u32 v5, s76, v5
  ds_write_b32 v10, v7 offset:2880
  v_add_u32 v11, s53, v11
  s_waitcnt lgkmcnt(5)
  v_add_u32 v20, s53, v20
  v_add_u32 v21, s53, v21
  v_add_u32 v22, s53, v22
  v_add_u32 v23, s53, v23
  s_waitcnt lgkmcnt(4)
  v_add_u32 v24, s53, v24
  v_add_u32 v25, s53, v25
  v_add_u32 v26, s53, v26
  v_add_u32 v27, s53, v27
  s_mov_b32 exec_lo, 0
  v_mov_b32 v120, v136
  s_mov_b32 exec_lo, -1
  v_cvt_pk_bf16_f32 v60, 0, v120
  ds_write_b16_d16_hi v28, v60
  v_max_f32 v108, |v60|, v108
  s_mov_b32 exec_lo, 0
  v_mov_b32 v152, v168
  s_mov_b32 exec_lo, -1
  v_cvt_pk_bf16_f32 v61, 0, v152
  ds_write_b16_d16_hi v58, v61
  v_max_f32 v108, |v61|, v108
  s_mov_b32 exec_lo, 0
  v_mov_b32 v184, v200
  s_mov_b32 exec_lo, -1
  v_cvt_pk_bf16_f32 v62, 0, v184
  s_mov_b64 exec, s[92:93]
  ds_write_b16_d16_hi v111, v62
  v_max_f32 v108, |v62|, v108
  s_mov_b64 exec, -1
  s_nop 0
  v_permlane32_swap_b32 v108, v109
  v_max_u32_e64 v108, v108, v109
  s_nop 1
  v_max_u32_dpp v108, v108, v108 row_shr:1 row_mask:0xf bank_mask:0xf
  s_nop 1
  v_max_u32_dpp v108, v108, v108 row_shr:2 row_mask:0xf bank_mask:0xf
  s_nop 1
  v_max_u32_dpp v108, v108, v108 row_shr:4 row_mask:0xf bank_mask:0xf
  s_nop 1
  v_max_u32_dpp v108, v108, v108 row_shr:8 row_mask:0xf bank_mask:0xf
  s_nop 1
  v_max_u32_dpp v108, v108, v108 row_bcast:15 row_mask:0xa bank_mask:0xf
  s_mov_b32 exec_lo, 0x80000000
  s_mov_b32 exec_hi, 0x80000000
  ds_max_u32 v3, v108 offset:24
  s_mov_b64 exec, -1
  s_setprio 0
  s_waitcnt vmcnt(0)
  v_lshlrev_b32 v15, 7, v15
  buffer_load_dword v12, v15, s[32:35], 0 offen
  v_lshlrev_b32_e64 v14, 7, v14
  buffer_load_dword v13, v14, s[32:35], 0 offen
  s_waitcnt lgkmcnt(0)
  s_barrier
  s_branch L_w2
L_g0:
  s_waitcnt lgkmcnt(0)
  s_mov_b32 s36, s8
  s_and_b32 s37, s9, 0xffff
  s_mov_b32 s38, 105456
  s_mov_b32 s39, 0x20000
  s_barrier
  s_add_u32 m0, s95, 41984
  s_add_u32 s81, s95, 70304
  buffer_load_dwordx4 v1, s[36:39], s81 offen lds
  s_add_u32 m0, s95, 46080
  s_add_u32 s81, s95, 74400
  buffer_load_dwordx4 v1, s[36:39], s81 offen lds
  s_add_u32 m0, s95, 50176
  s_add_u32 s81, s95, 78496
  buffer_load_dwordx4 v1, s[36:39], s81 offen lds
  s_add_u32 m0, s95, 54272
  s_add_u32 s81, s95, 82592
  buffer_load_dwordx4 v1, s[36:39], s81 offen lds
  s_add_u32 m0, s95, 58368
  s_add_u32 s81, s95, 86688
  buffer_load_dwordx4 v1, s[36:39], s81 offen lds
  s_add_u32 m0, s95, 62464
  s_add_u32 s81, s95, 90784
  buffer_load_dwordx4 v1, s[36:39], s81 offen lds
  s_add_u32 m0, s95, 66560
  s_add_u32 s81, s95, 94880
  buffer_load_dwordx4 v1, s[36:39], s81 offen lds
  s_add_u32 m0, s95, 70656
  s_add_u32 s81, s95, 98976
  buffer_load_dwordx4 v1, s[36:39], s81 offen lds
  s_cmp_eq_u32 s79, 3
  s_cbranch_scc1 L_st3
  s_add_u32 m0, s95, 74752
  s_add_u32 s81, s95, 103072
  buffer_load_dwordx4 v1, s[36:39], s81 offen lds
L_st3:
  s_mov_b32 s28, s4
  s_and_b32 s29, s5, 0xffff
  s_mov_b32 s30, 425984
  s_mov_b32 s31, 0x20000
  buffer_load_dwordx4 v[16:19], v30, s[28:31], s94 offen
  s_add_u32 s94, s94, 416
  buffer_load_dwordx4 v[12:15], v30, s[28:31], s94 offen
  s_add_u32 s94, s94, 416
  s_mov_b32 s32, s6
  s_and_b32 s33, s7, 0xffff
  s_mov_b32 s34, 12800000
  s_mov_b32 s35, 0x20000
  s_mul_i32 s96, s79, 3072
  s_mul_i32 s97, s79, 2704
  v_lshrrev_b32 v31, 5, v0
  v_mul_u32_u24 v31, 184, v31
  v_sub_u32_e64 v31, v1, v31
  s_add_u32 m0, s96, 85312
  s_add_u32 s81, s97, 35152
  buffer_load_dwordx4 v1, s[36:39], s81 offen lds
  s_lshl_b32 s85, s85, 2
  s_add_u32 s85, s85, 129728
  s_mul_i32 s72, s84, 3
  s_sub_u32 s72, 4, s72
  s_cmp_eq_u32 s26, 85
  s_cselect_b32 s72, s72, 6
  s_add_u32 m0, s96, 86336
  s_add_u32 s81, s97, 36176
  buffer_load_dwordx4 v31, s[36:39], s81 offen lds
  s_lshl_b32 s52, s3, 7
  s_mul_i32 s53, s3, 5280
  s_lshl_b32 s54, s3, 2
  s_lshl_b32 s55, s3, 1
  s_lshl_b32 s82, s3, 12
  s_add_u32 m0, s96, 87360
  s_add_u32 s81, s97, 37016
  buffer_load_dwordx4 v1, s[36:39], s81 offen lds
  s_and_b32 s98, s3, 1
  s_lshr_b32 s99, s3, 1
  s_mul_i32 s68, s99, 3072
  s_lshl_b32 s83, s98, 3
  s_add_u32 s68, s68, s83
  s_add_u32 m0, s96, 97600
  s_add_u32 s81, s97, 45968
  buffer_load_dwordx4 v1, s[36:39], s81 offen lds
  v_add_u32 v59, s68, v1
  s_lshl_b32 s69, s99, 3
  s_lshr_b32 s69, 0x05030200, s69
  s_and_b32 s69, s69, 0xff
  s_lshl_b32 s69, s69, 9
  s_add_u32 m0, s96, 98624
  s_add_u32 s81, s97, 46992
  buffer_load_dwordx4 v31, s[36:39], s81 offen lds
  s_lshl_b32 s70, s98, 2
  s_add_u32 s91, s69, s70
  s_mov_b32 s99, 0x05040100
  s_mov_b32 s100, 0x07060302
  v_mov_b32 v2, 129664
  s_add_u32 m0, s96, 99648
  s_add_u32 s81, s97, 47832
  buffer_load_dwordx4 v1, s[36:39], s81 offen lds
  v_mov_b32 v109, 0
  v_mov_b32 v108, 0
  v_mov_b64 v[32:33], 0
  v_mov_b64 v[34:35], 0
  v_mov_b64 v[36:37], 0
  s_add_u32 m0, s96, 109888
  s_add_u32 s81, s97, 56784
  buffer_load_dwordx4 v1, s[36:39], s81 offen lds
  v_mov_b64 v[38:39], 0
  v_mov_b64 v[40:41], 0
  v_mov_b64 v[42:43], 0
  v_mov_b64 v[44:45], 0
  v_mov_b64 v[46:47], 0
  s_add_u32 m0, s96, 110912
  s_add_u32 s81, s97, 57808
  buffer_load_dwordx4 v31, s[36:39], s81 offen lds
  v_mov_b64 v[48:49], 0
  v_mov_b64 v[50:51], 0
  v_mov_b64 v[52:53], 0
  v_mov_b64 v[54:55], 0
  v_mov_b64 v[56:57], 0
  s_add_u32 m0, s96, 111936
  s_add_u32 s81, s97, 58648
  buffer_load_dwordx4 v1, s[36:39], s81 offen lds
  v_add_u32 v250, 77824, v1
  s_waitcnt vmcnt(19)
  v_add_u32 v251, 125248, v1
  v_lshrrev_b32 v3, 5, v0
  v_lshl_add_u32 v3, v3, 2, v2
  s_cmp_lg_u32 s79, 0
  s_cbranch_scc1 L_st2
  s_add_u32 m0, s96, 122176
  s_add_u32 s81, s97, 67600
  buffer_load_dwordx4 v1, s[36:39], s81 offen lds
  s_add_u32 m0, s96, 123200
  s_add_u32 s81, s97, 68624
  buffer_load_dwordx4 v31, s[36:39], s81 offen lds
  s_add_u32 m0, s96, 124224
  s_add_u32 s81, s97, 69464
  buffer_load_dwordx4 v1, s[36:39], s81 offen lds
L_st2:
  s_add_u32 m0, s95, 6144
  s_add_u32 s81, s95, 0
  buffer_load_dwordx4 v1, s[36:39], s81 offen lds
  s_add_u32 m0, s95, 10240
  s_add_u32 s81, s95, 4096
  buffer_load_dwordx4 v1, s[36:39], s81 offen lds
  s_add_u32 m0, s95, 14336
  s_add_u32 s81, s95, 8192
  buffer_load_dwordx4 v1, s[36:39], s81 offen lds
  s_add_u32 m0, s95, 18432
  s_add_u32 s81, s95, 12288
  buffer_load_dwordx4 v1, s[36:39], s81 offen lds
  s_waitcnt vmcnt(15)
  s_barrier
  ds_read_b128 v[224:227], v250 offset:0
  ds_read_b128 v[228:231], v250 offset:6144
  ds_read_b128 v[232:235], v251 offset:0
  ds_read_b128 v[4:7], v250 offset:3072
  ds_read_b128 v[8:11], v251 offset:2048
  ds_read_b128 v[20:23], v250 offset:1024
  ds_read_b128 v[24:27], v250 offset:2048
  ds_read_b128 v[216:219], v250 offset:4096
  ds_read_b128 v[220:223], v250 offset:5120
  ds_read_b128 v[236:239], v251 offset:1024
  s_add_u32 m0, s95, 22528
  s_add_u32 s81, s95, 16384
  buffer_load_dwordx4 v1, s[36:39], s81 offen lds
  s_add_u32 m0, s95, 26624
  s_add_u32 s81, s95, 20480
  buffer_load_dwordx4 v1, s[36:39], s81 offen lds
  s_add_u32 m0, s95, 30720
  s_add_u32 s81, s95, 24576
  buffer_load_dwordx4 v1, s[36:39], s81 offen lds
  s_add_u32 m0, s95, 34816
  s_add_u32 s81, s95, 28672
  buffer_load_dwordx4 v1, s[36:39], s81 offen lds
  s_cmp_eq_u32 s79, 3
  s_cbranch_scc1 L_st1
  s_add_u32 m0, s95, 38912
  s_add_u32 s81, s95, 32768
  buffer_load_dwordx4 v1, s[36:39], s81 offen lds
L_st1:
  s_waitcnt lgkmcnt(9)
  v_add_u32 v225, s52, v225
  v_add_u32 v226, s52, v226
  v_add_u32 v227, s52, v227
  s_waitcnt lgkmcnt(8)
  v_add_u32 v228, s54, v228
  v_add_u32 v229, s54, v229
  v_add_u32 v231, s83, v231
  v_add_u32 v230, s91, v230
  s_waitcnt lgkmcnt(7)
  v_mad_u32_u24 v232, v233, s3, v232
  v_add_u32 v234, s55, v234
  v_mad_u32_u24 v233, v233, 8, v232
  v_add_u32_e64 v246, s82, v235
  v_add_u32 v247, 2048, v246
  v_add_u32 v31, 0, v234
  v_and_b32 v31, 3, v31
  v_lshl_add_u32 v244, v31, 4, v232
  v_add_u32 v31, 1, v234
  v_and_b32 v31, 3, v31
  v_lshl_add_u32 v245, v31, 4, v232
  v_add_u32 v245, 1664, v245
  v_add_u32 v31, 0, v234
  v_and_b32 v31, 3, v31
  v_lshl_add_u32 v248, v31, 4, v233
  v_add_u32 v31, 1, v234
  v_and_b32 v31, 3, v31
  v_lshl_add_u32 v249, v31, 4, v233
  v_add_u32 v249, 1664, v249
  s_waitcnt lgkmcnt(5)
  v_add_u32 v10, s76, v10
  v_add_u32 v4, s76, v4
  v_add_u32 v5, s76, v5
  ds_write_b32 v10, v7 offset:2880
  v_add_u32 v11, s53, v11
  s_waitcnt lgkmcnt(5)
  v_add_u32 v20, s53, v20
  v_add_u32 v21, s53, v21
  v_add_u32 v22, s53, v22
  v_add_u32 v23, s53, v23
  s_waitcnt lgkmcnt(4)
  v_add_u32 v24, s53, v24
  v_add_u32 v25, s53, v25
  v_add_u32 v26, s53, v26
  v_add_u32 v27, s53, v27
  s_waitcnt vmcnt(18)
  v_lshl_add_u32 v16, v16, 7, v29
  v_lshl_add_u32 v17, v17, 7, v29
  v_lshl_add_u32 v18, v18, 7, v29
  v_lshl_add_u32 v19, v19, 7, v29
  s_add_u32 m0, s76, 0
  s_mov_b32 exec_hi, 0xffffff
  buffer_load_dwordx4 v16, s[32:35], 0 offen lds
  s_add_u32 m0, s76, 1056
  s_nop 0
  buffer_load_dwordx4 v17, s[32:35], 0 offen lds
  s_add_u32 m0, s76, 2112
  s_mov_b32 exec_hi, 0xffff
  buffer_load_dwordx4 v18, s[32:35], 0 offen lds
  s_add_u32 m0, s76, 3168
  s_nop 0
  buffer_load_dwordx4 v19, s[32:35], 0 offen lds
  s_mov_b32 exec_hi, -1
  s_waitcnt vmcnt(4)
  s_barrier
L_w2:
  ds_read2st64_b32 v[60:61], v228 offset0:0 offset1:6
  ds_read2st64_b32 v[62:63], v228 offset0:12 offset1:18
  ds_read2st64_b32 v[64:65], v228 offset0:24 offset1:30
  ds_read2st64_b32 v[66:67], v228 offset0:36 offset1:42
  ds_read2st64_b32 v[68:69], v228 offset0:96 offset1:102
  ds_read2st64_b32 v[70:71], v229 offset0:108 offset1:114
  ds_read2st64_b32 v[72:73], v229 offset0:120 offset1:126
  ds_read2st64_b32 v[74:75], v229 offset0:132 offset1:138
  s_cmp_ge_u32 s3, 5
  s_cbranch_scc1 L_u0
  v_add_u32 v228, 32, v228
  v_add_u32 v229, 32, v229
  ds_read2st64_b32 v[92:93], v228 offset0:0 offset1:6
  ds_read2st64_b32 v[94:95], v228 offset0:12 offset1:18
  ds_read2st64_b32 v[96:97], v228 offset0:24 offset1:30
  ds_read2st64_b32 v[98:99], v228 offset0:36 offset1:42
  ds_read2st64_b32 v[100:101], v228 offset0:96 offset1:102
  ds_read2st64_b32 v[102:103], v229 offset0:108 offset1:114
  ds_read2st64_b32 v[104:105], v229 offset0:120 offset1:126
  ds_read2st64_b32 v[106:107], v229 offset0:132 offset1:138
  ds_read_b64_tr_b16 v[76:77], v225 offset:0
  ds_read_b64_tr_b16 v[78:79], v225 offset:5408
  ds_read_b64_tr_b16 v[80:81], v226 offset:0
  ds_read_b64_tr_b16 v[82:83], v227 offset:0
  ds_read_b64_tr_b16 v[84:85], v225 offset:64
  ds_read_b64_tr_b16 v[86:87], v225 offset:5472
  ds_read_b64_tr_b16 v[88:89], v226 offset:64
  ds_read_b64_tr_b16 v[90:91], v227 offset:64
  ds_read_b64_tr_b16 v[112:113], v224 offset:0
  ds_read_b64_tr_b16 v[114:115], v224 offset:256
  ds_read_b64_tr_b16 v[116:117], v224 offset:1024
  ds_read_b64_tr_b16 v[118:119], v224 offset:1280
  s_waitcnt lgkmcnt(14)
  v_mfma_f32_16x16x32_bf16 v[108:111], v[60:63], v[60:63], 0
  v_mfma_f32_16x16x32_bf16 v[108:111], v[64:67], v[64:67], v[108:111]
  v_mfma_f32_16x16x32_bf16 v[108:111], v[68:71], v[68:71], v[108:111]
  s_nop 0
  v_mfma_f32_16x16x32_bf16 v[108:111], v[72:75], v[72:75], v[108:111]
  v_perm_b32 v184, v61, v60, s99
  v_perm_b32 v185, v63, v62, s99
  v_perm_b32 v186, v65, v64, s99
  v_perm_b32 v187, v67, v66, s99
  v_perm_b32 v188, v69, v68, s99
  v_perm_b32 v189, v71, v70, s99
  v_perm_b32 v190, v73, v72, s99
  v_perm_b32 v191, v75, v74, s99
  v_mfma_f32_16x16x32_bf16 v[108:111], v[92:95], v[92:95], v[108:111]
  v_mfma_f32_16x16x32_bf16 v[108:111], v[96:99], v[96:99], v[108:111]
  v_mfma_f32_16x16x32_bf16 v[108:111], v[100:103], v[100:103], v[108:111]
  s_waitcnt lgkmcnt(12)
  v_mfma_f32_16x16x32_bf16 v[108:111], v[104:107], v[104:107], v[108:111]
  s_waitcnt lgkmcnt(10)
  v_mfma_f32_16x16x32_bf16 v[28:31], v[76:79], v[76:79], 0
  s_waitcnt lgkmcnt(8)
  v_mfma_f32_16x16x32_bf16 v[28:31], v[80:83], v[80:83], v[28:31]
  s_waitcnt lgkmcnt(6)
  v_mfma_f32_16x16x32_bf16 v[28:31], v[84:87], v[84:87], v[28:31]
  s_waitcnt lgkmcnt(4)
  v_mfma_f32_16x16x32_bf16 v[28:31], v[88:91], v[88:91], v[28:31]
  v_perm_b32 v192, v61, v60, s100
  v_perm_b32 v193, v63, v62, s100
  v_perm_b32 v194, v65, v64, s100
  v_perm_b32 v195, v67, v66, s100
  v_perm_b32 v196, v69, v68, s100
  v_perm_b32 v197, v71, v70, s100
  v_perm_b32 v198, v73, v72, s100
  v_perm_b32 v199, v75, v74, s100
  v_max3_f32 v28, v28, v29, 0
  v_perm_b32 v60, v93, v92, s99
  v_perm_b32 v61, v95, v94, s99
  v_max3_f32 v108, v108, v109, 0
  v_perm_b32 v62, v97, v96, s99
  v_max3_f32 v28, v28, v30, v31
  v_perm_b32 v63, v99, v98, s99
  v_max3_f32 v108, v108, v110, v111
  v_perm_b32 v64, v101, v100, s99
  v_perm_b32 v65, v103, v102, s99
  v_permlane32_swap_b32 v28, v108
  v_perm_b32 v66, v105, v104, s99
  v_max_u32 v28, v28, v108
  v_perm_b32 v67, v107, v106, s99
  s_nop 0
  v_max_u32_dpp v28, v28, v28 row_shr:1 row_mask:0xf bank_mask:0xf
  v_perm_b32 v68, v93, v92, s100
  v_perm_b32 v69, v95, v94, s100
  v_max_u32_dpp v28, v28, v28 row_shr:2 row_mask:0xf bank_mask:0xf
  v_perm_b32 v70, v97, v96, s100
  s_nop 0
  v_max_u32_dpp v28, v28, v28 row_shr:4 row_mask:0xf bank_mask:0xf
  v_perm_b32 v71, v99, v98, s100
  s_nop 0
  v_max_u32_dpp v28, v28, v28 row_shr:8 row_mask:0xf bank_mask:0xf
  v_perm_b32 v72, v101, v100, s100
  v_perm_b32 v73, v103, v102, s100
  v_max_u32_dpp v28, v28, v28 row_bcast:15 row_mask:0xa bank_mask:0xf
  v_perm_b32 v74, v105, v104, s100
  s_mov_b32 exec_lo, 0x80000000
  s_mov_b32 exec_hi, 0x80000000
  ds_max_u32 v3, v28 offset:16
  s_mov_b64 exec, -1
  v_perm_b32 v75, v107, v106, s100
  s_branch L_u1
L_u0:
  ds_read_b64_tr_b16 v[76:77], v225 offset:0
  ds_read_b64_tr_b16 v[78:79], v225 offset:5408
  ds_read_b64_tr_b16 v[80:81], v226 offset:0
  ds_read_b64_tr_b16 v[82:83], v227 offset:0
  ds_read_b64_tr_b16 v[84:85], v225 offset:64
  ds_read_b64_tr_b16 v[86:87], v225 offset:5472
  ds_read_b64_tr_b16 v[88:89], v226 offset:64
  ds_read_b64_tr_b16 v[90:91], v227 offset:64
  ds_read_b64_tr_b16 v[92:93], v225 offset:384
  ds_read_b64_tr_b16 v[94:95], v225 offset:5792
  ds_read_b64_tr_b16 v[96:97], v226 offset:384
  ds_read_b64_tr_b16 v[98:99], v227 offset:384
  ds_read_b64_tr_b16 v[100:101], v225 offset:448
  ds_read_b64_tr_b16 v[102:103], v225 offset:5856
  ds_read_b64_tr_b16 v[104:105], v226 offset:448
  ds_read_b64_tr_b16 v[106:107], v227 offset:448
  ds_read_b64_tr_b16 v[112:113], v224 offset:0
  ds_read_b64_tr_b16 v[114:115], v224 offset:256
  ds_read_b64_tr_b16 v[116:117], v224 offset:1024
  ds_read_b64_tr_b16 v[118:119], v224 offset:1280
  s_waitcnt lgkmcnt(14)
  v_mfma_f32_16x16x32_bf16 v[108:111], v[60:63], v[60:63], 0
  v_mfma_f32_16x16x32_bf16 v[108:111], v[64:67], v[64:67], v[108:111]
  s_nop 0
  v_mfma_f32_16x16x32_bf16 v[108:111], v[68:71], v[68:71], v[108:111]
  v_mfma_f32_16x16x32_bf16 v[108:111], v[72:75], v[72:75], v[108:111]
  v_mfma_f32_16x16x32_bf16 v[28:31], v[76:79], v[76:79], 0
  v_mfma_f32_16x16x32_bf16 v[28:31], v[80:83], v[80:83], v[28:31]
  v_mfma_f32_16x16x32_bf16 v[28:31], v[84:87], v[84:87], v[28:31]
  s_waitcnt lgkmcnt(12)
  v_mfma_f32_16x16x32_bf16 v[28:31], v[88:91], v[88:91], v[28:31]
  s_waitcnt lgkmcnt(10)
  v_mfma_f32_16x16x32_bf16 v[28:31], v[92:95], v[92:95], v[28:31]
  s_waitcnt lgkmcnt(8)
  v_mfma_f32_16x16x32_bf16 v[28:31], v[96:99], v[96:99], v[28:31]
  s_waitcnt lgkmcnt(6)
  v_mfma_f32_16x16x32_bf16 v[28:31], v[100:103], v[100:103], v[28:31]
  s_nop 0
  s_waitcnt lgkmcnt(4)
  v_mfma_f32_16x16x32_bf16 v[28:31], v[104:107], v[104:107], v[28:31]
  v_perm_b32 v184, v61, v60, s99
  v_perm_b32 v185, v63, v62, s99
  v_perm_b32 v186, v65, v64, s99
  v_perm_b32 v187, v67, v66, s99
  s_nop 3
  v_max3_f32 v28, v28, v29, 0
  v_perm_b32 v188, v69, v68, s99
  v_max3_f32 v108, v108, v109, 0
  v_perm_b32 v189, v71, v70, s99
  v_max3_f32 v28, v28, v30, v31
  v_perm_b32 v190, v73, v72, s99
  v_max3_f32 v108, v108, v110, v111
  v_perm_b32 v191, v75, v74, s99
  s_nop 0
  v_permlane32_swap_b32 v28, v108
  v_perm_b32 v192, v61, v60, s100
  v_max_u32 v28, v28, v108
  v_perm_b32 v193, v63, v62, s100
  s_nop 0
  v_max_u32_dpp v28, v28, v28 row_shr:1 row_mask:0xf bank_mask:0xf
  v_perm_b32 v194, v65, v64, s100
  s_nop 0
  v_max_u32_dpp v28, v28, v28 row_shr:2 row_mask:0xf bank_mask:0xf
  v_perm_b32 v195, v67, v66, s100
  s_nop 0
  v_max_u32_dpp v28, v28, v28 row_shr:4 row_mask:0xf bank_mask:0xf
  v_perm_b32 v196, v69, v68, s100
  s_nop 0
  v_max_u32_dpp v28, v28, v28 row_shr:8 row_mask:0xf bank_mask:0xf
  v_perm_b32 v197, v71, v70, s100
  s_nop 0
  v_max_u32_dpp v28, v28, v28 row_bcast:15 row_mask:0xa bank_mask:0xf
  v_perm_b32 v198, v73, v72, s100
  s_mov_b32 exec_lo, 0x80000000
  s_mov_b32 exec_hi, 0x80000000
  ds_max_u32 v3, v28 offset:16
  s_mov_b64 exec, -1
  v_perm_b32 v199, v75, v74, s100
  v_add_u32 v248, 12288, v246
  v_add_u32 v249, 12288, v247
  s_cmp_lg_u32 s3, 7
  s_cbranch_scc1 L_u1
  s_mov_b32 exec_lo, 0xfffffff0
  s_mov_b32 exec_hi, 0xfffffff0
  v_mov_b32 v249, 1048576
  s_mov_b64 exec, -1
L_u1:
  s_waitcnt lgkmcnt(0)
  s_barrier
  ds_read_b128 v[108:111], v2 offset:16
  s_mul_i32 s68, s3, 384
  v_lshrrev_b32 v29, 2, v0
  v_mul_u32_u24 v29, 24, v29
  v_add_u32 v29, s68, v29
  v_and_b32 v30, 3, v0
  v_lshlrev_b32 v30, 3, v30
  ds_read_b64 v[224:225], v29 offset:2048
  ds_read_b64 v[226:227], v29 offset:2056
  ds_read_b64 v[228:229], v29 offset:2064
  s_waitcnt lgkmcnt(3)
  v_add_u32 v108, 0x3f800000, v108
  v_add_u32 v109, 0x3f800000, v109
  v_lshrrev_b32 v108, 24, v108
  v_lshrrev_b32_e64 v109, 24, v109
  v_sub_u32 v108, 267, v108
  s_mov_b32 vcc_lo, 0x4000000
  v_min_u32 v108, 167, v108
  s_mov_b32 vcc_hi, 0x4000000
  v_readfirstlane_b32 s74, v108
  v_cndmask_b32 v250, v110, v111, vcc
  v_mul_u32_u24 v108, 0x800080, v108
  v_lshrrev_b32 v250, 23, v250
  v_and_b32 v216, v216, v108
  v_and_b32 v217, v217, v108
  v_and_b32 v218, v218, v108
  v_and_b32 v219, v219, v108
  v_and_b32 v220, v220, v108
  v_and_b32 v221, v221, v108
  v_and_b32 v222, v222, v108
  v_and_b32 v223, v223, v108
  v_mfma_f32_32x32x16_bf16 v[152:167], v[216:219], v[76:79], 0
  v_add_u32_e64 v250, v250, v109
  v_sub_u32 v250, 388, v250
  v_mfma_f32_32x32x16_bf16 v[168:183], v[216:219], v[84:87], 0
  s_movk_i32 s98, 167
  v_med3_i32 v250, v250, 1, s98
  v_mfma_f32_32x32x16_bf16 v[152:167], v[220:223], v[80:83], v[152:167]
  v_subrev_u32 v110, 127, v250
  v_lshlrev_b32 v250, 23, v250
  v_mfma_f32_32x32x16_bf16 v[168:183], v[220:223], v[88:91], v[168:183]
  v_cmp_gt_i32 vcc, 0, v110
  v_mul_u32_u24 v110, 0x800080, v110
  s_cbranch_vccnz L_sdown
  v_add_u32 v112, v112, v110
  v_add_u32 v113, v113, v110
  v_add_u32 v114, v114, v110
  v_add_u32 v115, v115, v110
  v_add_u32 v116, v116, v110
  v_add_u32 v117, v117, v110
  v_add_u32 v118, v118, v110
  v_add_u32 v119, v119, v110
L_scaled:
  v_mfma_f32_32x32x16_bf16 v[120:135], v[184:187], v[112:115], 0
  v_cvt_pk_f16_f32 v152, v152, v153
  v_cvt_pk_f16_f32 v153, v154, v155
  v_cvt_pk_f16_f32 v154, v156, v157
  v_cvt_pk_f16_f32 v155, v158, v159
  ds_write_b128 v246, v[152:155]
  v_xor_b32 v246, 16, v246
  v_mfma_f32_32x32x16_bf16 v[120:135], v[188:191], v[116:119], v[120:135]
  v_cvt_pk_f16_f32 v156, v160, v161
  v_cvt_pk_f16_f32 v157, v162, v163
  v_cvt_pk_f16_f32 v158, v164, v165
  v_cvt_pk_f16_f32 v159, v166, v167
  ds_write_b128 v246, v[156:159]
  v_mfma_f32_32x32x16_bf16 v[136:151], v[192:195], v[112:115], 0
  v_cvt_pk_f16_f32 v168, v168, v169
  v_cvt_pk_f16_f32 v169, v170, v171
  v_cvt_pk_f16_f32 v170, v172, v173
  v_cvt_pk_f16_f32 v171, v174, v175
  ds_write_b128 v247, v[168:171]
  v_xor_b32_e64 v247, 16, v247
  v_mfma_f32_32x32x16_bf16 v[136:151], v[196:199], v[116:119], v[136:151]
  v_cvt_pk_f16_f32 v172, v176, v177
  v_cvt_pk_f16_f32 v173, v178, v179
  v_cvt_pk_f16_f32 v174, v180, v181
  v_cvt_pk_f16_f32 v175, v182, v183
  ds_write_b128 v247, v[172:175]
  s_cmp_ge_u32 s3, 5
  s_cbranch_scc1 L_u2
  v_mfma_f32_32x32x16_bf16 v[184:199], v[60:63], v[112:115], 0
  v_cvt_pk_f16_f32 v120, v120, v121
  v_cvt_pk_f16_f32 v121, v122, v123
  v_cvt_pk_f16_f32 v122, v124, v125
  v_mfma_f32_32x32x16_bf16 v[184:199], v[64:67], v[116:119], v[184:199]
  v_cvt_pk_f16_f32 v123, v126, v127
  ds_write_b128 v244, v[120:123]
  v_xor_b32_e64 v244, 16, v244
  v_mfma_f32_32x32x16_bf16 v[200:215], v[68:71], v[112:115], 0
  v_cvt_pk_f16_f32 v124, v128, v129
  v_cvt_pk_f16_f32 v125, v130, v131
  v_cvt_pk_f16_f32 v126, v132, v133
  v_mfma_f32_32x32x16_bf16 v[200:215], v[72:75], v[116:119], v[200:215]
  v_cvt_pk_f16_f32 v127, v134, v135
  ds_write_b128 v244, v[124:127]
  s_branch L_u3
L_u2:
  v_mfma_f32_32x32x16_bf16 v[184:199], v[216:219], v[92:95], 0
  v_cvt_pk_f16_f32 v120, v120, v121
  v_cvt_pk_f16_f32 v121, v122, v123
  v_cvt_pk_f16_f32 v122, v124, v125
  v_mfma_f32_32x32x16_bf16 v[184:199], v[220:223], v[96:99], v[184:199]
  v_cvt_pk_f16_f32 v123, v126, v127
  ds_write_b128 v244, v[120:123]
  v_xor_b32 v244, 16, v244
  v_mfma_f32_32x32x16_bf16 v[200:215], v[216:219], v[100:103], 0
  v_cvt_pk_f16_f32 v124, v128, v129
  v_cvt_pk_f16_f32 v125, v130, v131
  v_cvt_pk_f16_f32 v126, v132, v133
  v_mfma_f32_32x32x16_bf16 v[200:215], v[220:223], v[104:107], v[200:215]
  v_cvt_pk_f16_f32 v127, v134, v135
  ds_write_b128 v244, v[124:127]
L_u3:
  buffer_load_dwordx4 v[16:19], v6, s[28:31], s94 offen
  s_add_u32 s94, s94, 416
  buffer_load_dwordx4 v[112:115], v6, s[28:31], s94 offen
  s_add_u32 s94, s94, 416
  s_cmp_lg_u32 s84, 0
  s_cbranch_scc1 L_hu1
  v_lshl_add_u32 v12, v12, 7, v8
  v_lshl_add_u32 v13, v13, 7, v8
  v_lshl_add_u32 v14, v14, 7, v8
  v_lshl_add_u32 v15, v15, 7, v8
  s_add_u32 m0, s76, 16256
  s_mov_b32 exec_hi, 0xffffff
  buffer_load_dwordx4 v12, s[32:35], 0 offen lds
  s_add_u32 m0, s76, 17312
  s_nop 0
  buffer_load_dwordx4 v13, s[32:35], 0 offen lds
  s_add_u32 m0, s76, 18368
  s_mov_b32 exec_hi, 0xffff
  buffer_load_dwordx4 v14, s[32:35], 0 offen lds
  s_add_u32 m0, s76, 19424
  s_nop 0
  buffer_load_dwordx4 v15, s[32:35], 0 offen lds
  s_mov_b32 exec_hi, -1
  s_branch L_hu2
L_hu1:
L_hu2:
  v_cvt_pk_f16_f32 v136, v136, v137
  s_waitcnt lgkmcnt(8)
  v_xor_b32 v224, v224, v30
  v_cvt_pk_f16_f32 v137, v138, v139
  v_cvt_pk_f16_f32 v138, v140, v141
  v_xor_b32 v232, 32, v224
  v_cvt_pk_f16_f32 v139, v142, v143
  ds_write_b128 v245, v[136:139]
  v_xor_b32 v245, 16, v245
  v_xor_b32_e64 v225, v225, v30
  v_cvt_pk_f16_f32 v140, v144, v145
  v_cvt_pk_f16_f32 v141, v146, v147
  v_cvt_pk_f16_f32 v142, v148, v149
  v_xor_b32 v233, 32, v225
  v_cvt_pk_f16_f32 v143, v150, v151
  ds_write_b128 v245, v[140:143]
  v_cvt_pk_f16_f32 v184, v184, v185
  s_waitcnt lgkmcnt(9)
  v_xor_b32 v226, v226, v30
  v_cvt_pk_f16_f32 v185, v186, v187
  v_cvt_pk_f16_f32 v186, v188, v189
  v_xor_b32 v234, 32, v226
  v_cvt_pk_f16_f32 v187, v190, v191
  ds_write_b128 v248, v[184:187]
  v_xor_b32 v248, 16, v248
  v_xor_b32 v227, v227, v30
  v_cvt_pk_f16_f32 v188, v192, v193
  v_cvt_pk_f16_f32 v189, v194, v195
  v_cvt_pk_f16_f32 v190, v196, v197
  v_xor_b32_e64 v235, 32, v227
  v_cvt_pk_f16_f32 v191, v198, v199
  ds_write_b128 v248, v[188:191]
  v_cvt_pk_f16_f32 v200, v200, v201
  s_waitcnt lgkmcnt(10)
  v_xor_b32 v228, v228, v30
  v_cvt_pk_f16_f32 v201, v202, v203
  v_cvt_pk_f16_f32 v202, v204, v205
  v_xor_b32 v240, 32, v228
  v_cvt_pk_f16_f32 v203, v206, v207
  ds_write_b128 v249, v[200:203]
  v_xor_b32 v249, 16, v249
  v_xor_b32 v229, v229, v30
  v_cvt_pk_f16_f32 v204, v208, v209
  v_cvt_pk_f16_f32 v205, v210, v211
  v_cvt_pk_f16_f32 v206, v212, v213
  v_xor_b32 v241, 32, v229
  v_cvt_pk_f16_f32 v207, v214, v215
  ds_write_b128 v249, v[204:207]
  v_readlane_b32 s0, v250, 0
  v_readlane_b32 s1, v250, 26
  s_sub_u32 s75, 0x7f000000, s0
  s_sub_u32 s1, 0x7f000000, s1
  s_sub_u32 s74, 254, s74
  s_lshl_b32 s74, s74, 23
  s_mov_b32 s92, 0x88888888
  s_mov_b32 s93, 0x88888888
  s_waitcnt lgkmcnt(0)
  s_barrier
  ds_read_b64_tr_b16 v[60:61], v224 offset:0
  ds_read_b64_tr_b16 v[62:63], v225 offset:0
  ds_read_b64_tr_b16 v[64:65], v232 offset:0
  ds_read_b64_tr_b16 v[66:67], v233 offset:0
  ds_read_b64_tr_b16 v[68:69], v224 offset:43328
  ds_read_b64_tr_b16 v[70:71], v225 offset:43328
  ds_read_b64_tr_b16 v[72:73], v232 offset:43328
  ds_read_b64_tr_b16 v[74:75], v233 offset:43328
  ds_read_b64_tr_b16 v[76:77], v226 offset:0
  ds_read_b64_tr_b16 v[78:79], v227 offset:0
  ds_read_b64_tr_b16 v[80:81], v234 offset:0
  ds_read_b64_tr_b16 v[82:83], v235 offset:0
  ds_read_b64_tr_b16 v[84:85], v226 offset:43328
  ds_read_b64_tr_b16 v[86:87], v227 offset:43328
  ds_read_b64_tr_b16 v[88:89], v234 offset:43328
  ds_read_b64_tr_b16 v[90:91], v235 offset:43328
  s_cmp_ge_u32 s3, 6
  s_cbranch_scc1 L_lin
  ds_read_b64_tr_b16 v[92:93], v228 offset:0
  ds_read_b64_tr_b16 v[94:95], v229 offset:0
  ds_read_b64_tr_b16 v[96:97], v240 offset:0
  ds_read_b64_tr_b16 v[98:99], v241 offset:0
  ds_read_b64_tr_b16 v[100:101], v228 offset:43328
  ds_read_b64_tr_b16 v[102:103], v229 offset:43328
  ds_read_b64_tr_b16 v[104:105], v240 offset:43328
  ds_read_b64_tr_b16 v[106:107], v241 offset:43328
  s_waitcnt lgkmcnt(6)
  v_pk_add_f16 v92, v92, v94
  v_pk_add_f16 v93, v93, v95
  ds_write_b64 v59, v[92:93] offset:30720
  s_waitcnt lgkmcnt(5)
  v_pk_add_f16 v96, v96, v98
  v_pk_add_f16 v97, v97, v99
  s_waitcnt lgkmcnt(3)
  v_pk_add_f16 v100, v100, v102
  v_pk_add_f16 v101, v101, v103
  ds_write_b64 v59, v[100:101] offset:32768
  s_waitcnt lgkmcnt(2)
  v_pk_add_f16 v104, v104, v106
  v_pk_add_f16 v105, v105, v107
  v_cndmask_b32 v96, v96, v104, s[92:93]
  v_cndmask_b32 v97, v97, v105, s[92:93]
  ds_write_b64 v59, v[96:97] offset:31744
  ds_write_b32 v230, v104 offset:3072
  ds_write_b32 v230, v105 offset:3088
  s_branch L_p2
L_lin:
  s_and_b32 s98, s3, 1
  s_cselect_b64 vcc, -1, 0
  s_lshl_b32 s99, s98, 5
  v_mov_b32 v31, 0
  v_xor_b32 v236, s99, v236
  v_xor_b32 v237, s99, v237
  v_cndmask_b32 v238, v238, v239, vcc
  ds_read_b64_tr_b16 v[92:93], v236
  ds_read_b64_tr_b16 v[94:95], v237
  ds_read_u16_d16_hi v31, v238
  s_lshl_b32 s98, s98, 10
  v_add_u32 v29, s98, v1
  s_waitcnt lgkmcnt(2)
  v_cvt_f32_f16 v96, v92
  v_cvt_f32_f16_sdwa v97, v92 dst_sel:DWORD dst_unused:UNUSED_PAD src0_sel:WORD_1
  v_mul_f32 v96, s1, v96
  v_mul_f32 v97, s1, v97
  v_mul_f32 v96, s0, v96
  v_mul_f32 v97, s0, v97
  v_cvt_pk_bf16_f32 v92, v96, v97
  v_cvt_f32_f16 v98, v93
  v_cvt_f32_f16_sdwa v99, v93 dst_sel:DWORD dst_unused:UNUSED_PAD src0_sel:WORD_1
  v_mul_f32 v98, s1, v98
  v_mul_f32 v99, s1, v99
  v_mul_f32 v98, s0, v98
  v_mul_f32 v99, s0, v99
  v_cvt_pk_bf16_f32 v93, v98, v99
  s_waitcnt lgkmcnt(1)
  v_cvt_f32_f16 v100, v94
  v_cvt_f32_f16_sdwa v101, v94 dst_sel:DWORD dst_unused:UNUSED_PAD src0_sel:WORD_1
  v_mul_f32 v100, s1, v100
  v_mul_f32 v101, s1, v101
  v_mul_f32 v100, s0, v100
  v_mul_f32 v101, s0, v101
  v_cvt_pk_bf16_f32 v94, v100, v101
  v_cvt_f32_f16_e64 v102, v95
  v_cvt_f32_f16_sdwa v103, v95 dst_sel:DWORD dst_unused:UNUSED_PAD src0_sel:WORD_1
  v_mul_f32 v102, s1, v102
  v_mul_f32 v103, s1, v103
  s_mov_b32 exec_lo, 0
  s_mov_b32 exec_hi, 0xffff
  s_waitcnt lgkmcnt(0)
  v_mov_b32 v102, v31
  s_mov_b64 exec, -1
  v_mul_f32 v102, s0, v102
  v_mul_f32 v103, s0, v103
  v_cvt_pk_bf16_f32 v95, v102, v103
  ds_write_b128 v29, v[92:95] offset:39936
L_p2:
  v_pk_add_f16 v76, v76, v78
  v_pk_add_f16 v77, v77, v79
  ds_write_b64 v59, v[76:77] offset:18432
  v_pk_add_f16 v80, v80, v82
  v_pk_add_f16 v81, v81, v83
  v_pk_add_f16 v84, v84, v86
  v_pk_add_f16 v85, v85, v87
  ds_write_b64 v59, v[84:85] offset:20480
  v_pk_add_f16 v88, v88, v90
  v_pk_add_f16 v89, v89, v91
  v_cndmask_b32 v80, v80, v88, s[92:93]
  v_cndmask_b32 v81, v81, v89, s[92:93]
  ds_write_b64 v59, v[80:81] offset:19456
  ds_write_b32 v230, v88 offset:1024
  ds_write_b32 v230, v89 offset:1040
  v_pk_add_f16 v60, v60, v62
  v_pk_add_f16 v61, v61, v63
  ds_write_b64 v59, v[60:61] offset:6144
  v_pk_add_f16 v64, v64, v66
  v_pk_add_f16 v65, v65, v67
  v_pk_add_f16 v68, v68, v70
  v_pk_add_f16 v69, v69, v71
  ds_write_b64 v59, v[68:69] offset:8192
  v_pk_add_f16 v72, v72, v74
  v_pk_add_f16 v73, v73, v75
  v_cndmask_b32 v64, v64, v72, s[92:93]
  v_cndmask_b32 v65, v65, v73, s[92:93]
  ds_write_b64 v59, v[64:65] offset:7168
  s_cmp_lt_u32 s3, 2
  s_cbranch_scc1 L_p2d
  v_subrev_u32 v230, 1024, v230
  ds_write_b32 v230, v72 offset:0
  ds_write_b32 v230, v73 offset:16
  s_branch L_built
L_p2d:
  ds_write_b64 v231, v[72:73] offset:5120
L_built:
  s_mov_b32 s0, s74
  s_mov_b32 s1, s75
  s_mov_b32 s96, 0x3e000000
  s_mov_b32 s97, 0x43000000
  s_mov_b32 s51, 1
  s_mul_i32 s98, s3, 1536
  s_add_u32 s98, s98, 116736
  s_cmp_lg_u32 s84, 0
  s_cbranch_scc1 L_g1c
  s_sub_u32 s94, s94, 416
  s_waitcnt vmcnt(4)
  ds_read_u16_d16_hi v32, v10 offset:0
  ds_read_u16_d16_hi v33, v10 offset:2
  ds_read_u16_d16_hi v34, v10 offset:2112
  ds_read_u16_d16_hi v35, v10 offset:2114
  ds_read_u16_d16_hi v36, v10 offset:128
  ds_read_u16_d16_hi v37, v10 offset:130
  ds_read_u16_d16_hi v38, v10 offset:2240
  ds_read_u16_d16_hi v39, v10 offset:2242
  ds_read_u16_d16_hi v40, v10 offset:256
  ds_read_u16_d16_hi v41, v10 offset:258
  ds_read_u16_d16_hi v42, v10 offset:2368
  ds_read_u16_d16_hi v43, v10 offset:2370
  ds_read_u16_d16_hi v44, v10 offset:384
  ds_read_u16_d16_hi v45, v10 offset:386
  ds_read_u16_d16_hi v46, v10 offset:2496
  ds_read_u16_d16_hi v47, v10 offset:2498
  ds_read_u16_d16_hi v48, v10 offset:512
  ds_read_u16_d16_hi v49, v10 offset:514
  ds_read_u16_d16_hi v50, v10 offset:2624
  ds_read_u16_d16_hi v51, v10 offset:2626
  ds_read_u16_d16_hi v52, v10 offset:640
  ds_read_u16_d16_hi v53, v10 offset:642
  ds_read_u16_d16_hi v54, v10 offset:2752
  ds_read_u16_d16_hi v55, v10 offset:2754
  ds_read_u16_d16_hi v56, v10 offset:768
  ds_read_u16_d16_hi v57, v10 offset:770
  s_waitcnt lgkmcnt(14)
  v_max3_f32 v58, |v32|, |v33|, 0
  v_cvt_pk_f16_f32 v184, v32, v33
  v_max3_f32 v58, |v34|, |v35|, v58
  v_cvt_pk_f16_f32 v185, v34, v35
  v_max3_f32 v58, |v36|, |v37|, v58
  v_cvt_pk_f16_f32 v186, v36, v37
  v_max3_f32 v58, |v38|, |v39|, v58
  v_cvt_pk_f16_f32 v187, v38, v39
  v_max3_f32 v58, |v40|, |v41|, v58
  v_cvt_pk_f16_f32 v188, v40, v41
  v_max3_f32 v58, |v42|, |v43|, v58
  v_cvt_pk_f16_f32 v189, v42, v43
  s_waitcnt lgkmcnt(12)
  v_max3_f32 v58, |v44|, |v45|, v58
  v_cvt_pk_f16_f32 v190, v44, v45
  s_waitcnt lgkmcnt(10)
  v_max3_f32 v58, |v46|, |v47|, v58
  v_cvt_pk_f16_f32 v191, v46, v47
  s_waitcnt lgkmcnt(8)
  v_max3_f32 v58, |v48|, |v49|, v58
  v_cvt_pk_f16_f32 v192, v48, v49
  s_waitcnt lgkmcnt(6)
  v_max3_f32 v58, |v50|, |v51|, v58
  v_cvt_pk_f16_f32 v193, v50, v51
  s_waitcnt lgkmcnt(4)
  v_max3_f32 v58, |v52|, |v53|, v58
  v_cvt_pk_f16_f32 v194, v52, v53
  s_waitcnt lgkmcnt(2)
  v_max3_f32 v58, |v54|, |v55|, v58
  v_cvt_pk_f16_f32 v195, v54, v55
  s_waitcnt lgkmcnt(0)
  v_max3_f32 v58, |v56|, |v57|, v58
  v_cvt_pk_f16_f32 v196, v56, v57
  s_waitcnt lgkmcnt(0)
  s_barrier
  s_branch L_cin_go
L_g1c:
  s_waitcnt lgkmcnt(0)
  s_barrier
  s_add_u32 s76, s76, -63168
  s_waitcnt vmcnt(1)
  v_lshl_add_u32 v16, v16, 7, v8
  v_lshl_add_u32 v17, v17, 7, v8
  v_lshl_add_u32 v18, v18, 7, v8
  v_lshl_add_u32 v19, v19, 7, v8
  s_add_u32 m0, s76, 0
  s_mov_b32 exec_hi, 0xffffff
  buffer_load_dwordx4 v16, s[32:35], 0 offen lds
  s_add_u32 m0, s76, 1056
  s_nop 0
  buffer_load_dwordx4 v17, s[32:35], 0 offen lds
  s_add_u32 m0, s76, 2112
  s_mov_b32 exec_hi, 0xffff
  buffer_load_dwordx4 v18, s[32:35], 0 offen lds
  s_add_u32 m0, s76, 3168
  s_nop 0
  buffer_load_dwordx4 v19, s[32:35], 0 offen lds
  s_mov_b32 exec_hi, -1
  s_waitcnt vmcnt(4)
  v_lshl_add_u32 v112, v112, 7, v8
  v_lshl_add_u32 v113, v113, 7, v8
  v_lshl_add_u32 v114, v114, 7, v8
  v_lshl_add_u32 v115, v115, 7, v8
  s_add_u32 m0, s76, 16256
  s_mov_b32 exec_hi, 0xffffff
  buffer_load_dwordx4 v112, s[32:35], 0 offen lds
  s_add_u32 m0, s76, 17312
  s_nop 0
  buffer_load_dwordx4 v113, s[32:35], 0 offen lds
  s_add_u32 m0, s76, 18368
  s_mov_b32 exec_hi, 0xffff
  buffer_load_dwordx4 v114, s[32:35], 0 offen lds
  s_add_u32 m0, s76, 19424
  s_nop 0
  buffer_load_dwordx4 v115, s[32:35], 0 offen lds
  s_mov_b32 exec_hi, -1
  buffer_load_dwordx4 v[16:19], v6, s[28:31], s94 offen
  s_add_u32 s94, s94, 416
  v_add_u32 v10, -63168, v10
  v_add_u32 v4, -63168, v4
  v_add_u32 v5, -63168, v5
  ds_write_b32 v10, v7 offset:2880
  ds_write_b32 v10, v7 offset:19136
L_g1d:
  s_waitcnt vmcnt(5)
  ds_read_u16_d16_hi v32, v10 offset:0
  ds_read_u16_d16_hi v33, v10 offset:2
  ds_read_u16_d16_hi v34, v10 offset:2112
  ds_read_u16_d16_hi v35, v10 offset:2114
  ds_read_u16_d16_hi v36, v10 offset:128
  ds_read_u16_d16_hi v37, v10 offset:130
  ds_read_u16_d16_hi v38, v10 offset:2240
  ds_read_u16_d16_hi v39, v10 offset:2242
  ds_read_u16_d16_hi v40, v10 offset:256
  ds_read_u16_d16_hi v41, v10 offset:258
  ds_read_u16_d16_hi v42, v10 offset:2368
  ds_read_u16_d16_hi v43, v10 offset:2370
  ds_read_u16_d16_hi v44, v10 offset:384
  ds_read_u16_d16_hi v45, v10 offset:386
  ds_read_u16_d16_hi v46, v10 offset:2496
  ds_read_u16_d16_hi v47, v10 offset:2498
  ds_read_u16_d16_hi v48, v10 offset:512
  ds_read_u16_d16_hi v49, v10 offset:514
  ds_read_u16_d16_hi v50, v10 offset:2624
  ds_read_u16_d16_hi v51, v10 offset:2626
  ds_read_u16_d16_hi v52, v10 offset:640
  ds_read_u16_d16_hi v53, v10 offset:642
  ds_read_u16_d16_hi v54, v10 offset:2752
  ds_read_u16_d16_hi v55, v10 offset:2754
  ds_read_u16_d16_hi v56, v10 offset:768
  ds_read_u16_d16_hi v57, v10 offset:770
  s_waitcnt lgkmcnt(14)
  v_max3_f32 v58, |v32|, |v33|, 0
  v_cvt_pk_f16_f32 v184, v32, v33
  v_max3_f32 v58, |v34|, |v35|, v58
  v_cvt_pk_f16_f32 v185, v34, v35
  v_max3_f32 v58, |v36|, |v37|, v58
  v_cvt_pk_f16_f32 v186, v36, v37
  v_max3_f32 v58, |v38|, |v39|, v58
  v_cvt_pk_f16_f32 v187, v38, v39
  v_max3_f32 v58, |v40|, |v41|, v58
  v_cvt_pk_f16_f32 v188, v40, v41
  v_max3_f32 v58, |v42|, |v43|, v58
  v_cvt_pk_f16_f32 v189, v42, v43
  s_waitcnt lgkmcnt(12)
  v_max3_f32 v58, |v44|, |v45|, v58
  v_cvt_pk_f16_f32 v190, v44, v45
  s_waitcnt lgkmcnt(10)
  v_max3_f32 v58, |v46|, |v47|, v58
  v_cvt_pk_f16_f32 v191, v46, v47
  s_waitcnt lgkmcnt(8)
  v_max3_f32 v58, |v48|, |v49|, v58
  v_cvt_pk_f16_f32 v192, v48, v49
  s_waitcnt lgkmcnt(6)
  v_max3_f32 v58, |v50|, |v51|, v58
  v_cvt_pk_f16_f32 v193, v50, v51
  s_waitcnt lgkmcnt(4)
  v_max3_f32 v58, |v52|, |v53|, v58
  v_cvt_pk_f16_f32 v194, v52, v53
  s_waitcnt lgkmcnt(2)
  v_max3_f32 v58, |v54|, |v55|, v58
  v_cvt_pk_f16_f32 v195, v54, v55
  s_waitcnt lgkmcnt(0)
  v_max3_f32 v58, |v56|, |v57|, v58
  v_cvt_pk_f16_f32 v196, v56, v57
L_cin_go:
  ds_write_b32 v11, v184 offset:0
  ds_write_b32 v11, v185 offset:160
  ds_write_b32 v11, v186 offset:320
  ds_write_b32 v11, v187 offset:480
  ds_write_b32 v11, v188 offset:640
  ds_write_b32 v11, v189 offset:800
  ds_write_b32 v11, v190 offset:960
  ds_write_b32 v11, v191 offset:1120
  ds_write_b32 v11, v192 offset:1280
  ds_write_b32 v11, v193 offset:1440
  ds_write_b32 v11, v194 offset:1600
  ds_write_b32 v11, v195 offset:1760
  ds_write_b32 v11, v196 offset:1920
  s_mov_b32 s81, 16256
  s_add_u32 s76, s76, 16256
  v_lshlrev_b32 v7, 2, v0
  v_add_u32 v7, s98, v7
L_cin_loop:
  v_cmp_le_f32 s[90:91], s97, v58
  v_cmp_le_f32 vcc, s96, v58
  s_mov_b32 s49, s74
  s_mov_b32 s50, s75
  s_cmp_lg_u64 s[90:91], 0
  s_cbranch_scc1 L_cslow
  s_cbranch_vccz L_cslow
L_cconv:
  s_cmp_lg_u32 s51, 0
  s_cbranch_scc1 L_first
  ds_read_b64_tr_b16 v[60:61], v20 offset:0
  v_mul_f32 v116, v184, v192
  v_mul_f32 v117, v185, v193
  ds_read_b64_tr_b16 v[74:75], v20 offset:32
  v_mul_f32 v118, v186, v194
  ds_read_b64_tr_b16 v[88:89], v20 offset:64
  v_mul_f32 v119, v187, v195
  ds_read_b64_tr_b16 v[102:103], v20 offset:96
  v_fmac_f32_e64 v116, v188, v191
  ds_read_b64_tr_b16 v[66:67], v23 offset:0
  v_fmac_f32 v117, v200, v208
  ds_read_b64_tr_b16 v[80:81], v23 offset:32
  v_fmac_f32 v118, v201, v209
  ds_read_b64_tr_b16 v[94:95], v23 offset:64
  v_fmac_f32 v119, v202, v210
  ds_read_b64_tr_b16 v[108:109], v23 offset:96
  v_fmac_f32 v116, v203, v211
  ds_read_b64_tr_b16 v[68:69], v24 offset:0
  v_fmac_f32_e64 v117, v204, v207
  ds_read_b64_tr_b16 v[82:83], v24 offset:32
  v_fmac_f32 v118, v216, v224
  ds_read_b64_tr_b16 v[96:97], v24 offset:64
  v_fmac_f32 v119, v217, v225
  ds_read_b64_tr_b16 v[110:111], v24 offset:96
  v_fmac_f32 v116, v218, v226
  ds_read_b64_tr_b16 v[124:125], v4 offset:0
  v_fmac_f32 v117, v219, v227
  ds_read_b64_tr_b16 v[126:127], v5 offset:0
  v_fmac_f32 v118, v220, v223
  v_fmac_f32 v119, v232, v240
  ds_read_b64_tr_b16 v[136:137], v4 offset:32
  v_fmac_f32 v116, v233, v241
  ds_read_b64_tr_b16 v[138:139], v5 offset:32
  v_fmac_f32 v117, v234, v242
  ds_read_b64_tr_b16 v[148:149], v4 offset:64
  v_fmac_f32 v118, v235, v243
  ds_read_b64_tr_b16 v[150:151], v5 offset:64
  v_fmac_f32 v119, v236, v239
  ds_read_b64_tr_b16 v[160:161], v4 offset:96
  v_fmac_f32_e64 v116, v189, v196
  ds_read_b64_tr_b16 v[162:163], v5 offset:96
  v_fmac_f32 v117, v189, v197
  ds_read_b128 v[164:167], v1 offset:39936
  v_fmac_f32 v118, v190, v198
  ds_read_b128 v[168:171], v1 offset:40960
  v_fmac_f32 v119, v190, v199
  ds_read_b128 v[172:175], v1 offset:8192
  v_fmac_f32 v116, v205, v212
  ds_read_b128 v[176:179], v1 offset:6144
  v_fmac_f32_e64 v117, v205, v213
  ds_read_b64_tr_b16 v[70:71], v25 offset:0
  v_fmac_f32 v118, v206, v214
  ds_read_b64_tr_b16 v[84:85], v25 offset:32
  v_fmac_f32 v119, v206, v215
  ds_read_b64_tr_b16 v[98:99], v25 offset:64
  v_fmac_f32 v116, v221, v228
  v_fmac_f32 v117, v221, v229
  ds_read_b64_tr_b16 v[112:113], v25 offset:96
  v_fmac_f32 v118, v222, v230
  ds_read_b64_tr_b16 v[72:73], v26 offset:0
  v_fmac_f32 v119, v222, v231
  ds_read_b64_tr_b16 v[86:87], v26 offset:32
  v_fmac_f32 v116, v237, v244
  ds_read_b64_tr_b16 v[100:101], v26 offset:64
  v_fmac_f32 v117, v237, v245
  ds_read_b64_tr_b16 v[114:115], v26 offset:96
  v_fmac_f32 v118, v238, v246
  ds_read_b64_tr_b16 v[62:63], v21 offset:0
  v_fmac_f32 v119, v238, v247
  ds_read_b64_tr_b16 v[76:77], v21 offset:32
  v_add_f32_e64 v116, v116, v117
  ds_read_b64_tr_b16 v[90:91], v21 offset:64
  v_add_f32 v118, v118, v119
  ds_read_b64_tr_b16 v[104:105], v21 offset:96
  v_add_f32 v116, v116, v118
  ds_read_b64_tr_b16 v[64:65], v22 offset:0
  v_mul_f32 v116, s49, v116
  ds_read_b64_tr_b16 v[78:79], v22 offset:32
  v_mul_f32 v116, s50, v116
  ds_read_b64_tr_b16 v[92:93], v22 offset:64
  ds_write_b32 v7, v116
  ds_read_b64_tr_b16 v[106:107], v22 offset:96
  v_add_u32 v7, 256, v7
  s_waitcnt lgkmcnt(14)
  v_pk_mul_f16 v120, v60, v67 op_sel:[0,0] op_sel_hi:[0,1]
  v_pk_mul_f16 v121, v60, v67 op_sel:[1,0] op_sel_hi:[1,1]
  v_pk_mul_f16 v122, v60, v68 op_sel:[0,0] op_sel_hi:[0,1]
  v_pk_mul_f16 v123, v60, v68 op_sel:[1,0] op_sel_hi:[1,1]
  v_pk_mul_f16 v132, v74, v81 op_sel:[0,0] op_sel_hi:[0,1]
  v_pk_mul_f16 v133, v74, v81 op_sel:[1,0] op_sel_hi:[1,1]
  v_pk_mul_f16 v134, v74, v82 op_sel:[0,0] op_sel_hi:[0,1]
  v_pk_mul_f16 v135, v74, v82 op_sel:[1,0] op_sel_hi:[1,1]
  v_pk_mul_f16 v144, v88, v95 op_sel:[0,0] op_sel_hi:[0,1]
  v_pk_mul_f16 v145, v88, v95 op_sel:[1,0] op_sel_hi:[1,1]
  v_pk_mul_f16 v146, v88, v96 op_sel:[0,0] op_sel_hi:[0,1]
  v_pk_mul_f16 v147, v88, v96 op_sel:[1,0] op_sel_hi:[1,1]
  v_pk_mul_f16 v156, v102, v109 op_sel:[0,0] op_sel_hi:[0,1]
  v_pk_mul_f16 v157, v102, v109 op_sel:[1,0] op_sel_hi:[1,1]
  v_pk_mul_f16 v158, v102, v110 op_sel:[0,0] op_sel_hi:[0,1]
  v_pk_mul_f16 v159, v102, v110 op_sel:[1,0] op_sel_hi:[1,1]
  s_waitcnt vmcnt(0)
  v_lshl_add_u32 v16, v16, 7, v8
  v_lshl_add_u32 v17, v17, 7, v8
  v_lshl_add_u32 v18, v18, 7, v8
  v_lshl_add_u32 v19, v19, 7, v8
  s_add_u32 m0, s76, 0
  s_mov_b32 exec_hi, 0xffffff
  buffer_load_dwordx4 v16, s[32:35], 0 offen lds
  s_add_u32 m0, s76, 1056
  s_nop 0
  buffer_load_dwordx4 v17, s[32:35], 0 offen lds
  s_add_u32 m0, s76, 2112
  s_mov_b32 exec_hi, 0xffff
  buffer_load_dwordx4 v18, s[32:35], 0 offen lds
  s_add_u32 m0, s76, 3168
  s_nop 0
  buffer_load_dwordx4 v19, s[32:35], 0 offen lds
  s_mov_b32 exec_hi, -1
  buffer_load_dwordx4 v[16:19], v6, s[28:31], s94 offen
  s_add_u32 s94, s94, 416
L_novm:
  v_add_u32 v10, s81, v10
  v_add_u32 v4, s81, v4
  v_add_u32 v5, s81, v5
  s_sub_u32 s76, s76, s81
  s_sub_u32 s81, 0, s81
  s_mov_b32 s51, 0
  s_waitcnt lgkmcnt(14)
  s_cmp_eq_u32 s84, 0
  s_cbranch_scc1 L_np1
  s_setprio 1
L_np1:
  v_mfma_f32_16x16x32_bf16 v[184:187], v[164:167], v[124:127], 0
  ds_read_b128 v[180:183], v1 offset:7168
  v_pk_mul_f16 v116, v60, v69 op_sel:[0,0] op_sel_hi:[0,1]
  v_mfma_f32_16x16x32_bf16 v[200:203], v[164:167], v[136:139], 0
  v_pk_mul_f16 v117, v60, v69 op_sel:[1,0] op_sel_hi:[1,1]
  v_mfma_f32_16x16x32_bf16 v[216:219], v[164:167], v[148:151], 0
  v_pk_mul_f16 v118, v60, v70 op_sel:[0,0] op_sel_hi:[0,1]
  v_mfma_f32_16x16x32_bf16 v[232:235], v[164:167], v[160:163], 0
  v_pk_mul_f16 v119, v60, v70 op_sel:[1,0] op_sel_hi:[1,1]
  v_mfma_f32_16x16x32_bf16 v[188:191], v[168:171], v[124:127], 0
  ds_read_b128 v[164:167], v1 offset:5120
  v_pk_mul_f16 v128, v74, v83 op_sel:[0,0] op_sel_hi:[0,1]
  v_mfma_f32_16x16x32_bf16 v[204:207], v[168:171], v[136:139], 0
  v_pk_mul_f16 v129, v74, v83 op_sel:[1,0] op_sel_hi:[1,1]
  v_mfma_f32_16x16x32_bf16 v[220:223], v[168:171], v[148:151], 0
  v_pk_mul_f16 v130, v74, v84 op_sel:[0,0] op_sel_hi:[0,1]
  v_mfma_f32_16x16x32_bf16 v[236:239], v[168:171], v[160:163], 0
  v_pk_mul_f16 v131, v74, v84 op_sel:[1,0] op_sel_hi:[1,1]
  v_mfma_f32_16x16x32_f16 v[192:195], v[172:175], v[120:123], 0
  ds_read_b128 v[168:171], v1 offset:11264
  v_pk_mul_f16 v140, v88, v97 op_sel:[0,0] op_sel_hi:[0,1]
  v_mfma_f32_16x16x32_f16 v[208:211], v[172:175], v[132:135], 0
  v_pk_mul_f16 v141, v88, v97 op_sel:[1,0] op_sel_hi:[1,1]
  v_mfma_f32_16x16x32_f16 v[224:227], v[172:175], v[144:147], 0
  s_waitcnt lgkmcnt(14)
  v_pk_mul_f16 v142, v88, v98 op_sel:[0,0] op_sel_hi:[0,1]
  v_mfma_f32_16x16x32_f16 v[240:243], v[172:175], v[156:159], 0
  s_nop 0
  v_pk_mul_f16 v143, v88, v98 op_sel:[1,0] op_sel_hi:[1,1]
  v_mfma_f32_16x16x32_f16 v[184:187], v[176:179], v[120:123], v[184:187]
  ds_read_b128 v[172:175], v1 offset:9216
  v_pk_mul_f16 v152, v102, v111 op_sel:[0,0] op_sel_hi:[0,1]
  v_mfma_f32_16x16x32_f16 v[200:203], v[176:179], v[132:135], v[200:203]
  v_pk_mul_f16 v153, v102, v111 op_sel:[1,0] op_sel_hi:[1,1]
  v_mfma_f32_16x16x32_f16 v[216:219], v[176:179], v[144:147], v[216:219]
  s_waitcnt lgkmcnt(14)
  v_pk_mul_f16 v154, v102, v112 op_sel:[0,0] op_sel_hi:[0,1]
  v_mfma_f32_16x16x32_f16 v[232:235], v[176:179], v[156:159], v[232:235]
  s_waitcnt lgkmcnt(3)
  v_pk_mul_f16 v155, v102, v112 op_sel:[1,0] op_sel_hi:[1,1]
  v_mfma_f32_16x16x32_f16 v[188:191], v[180:183], v[120:123], v[188:191]
  ds_read_b128 v[176:179], v1 offset:10240
  v_pk_mul_f16 v124, v61, v68 op_sel:[0,0] op_sel_hi:[0,1]
  v_mfma_f32_16x16x32_f16 v[204:207], v[180:183], v[132:135], v[204:207]
  v_pk_mul_f16 v125, v61, v68 op_sel:[1,0] op_sel_hi:[1,1]
  v_mfma_f32_16x16x32_f16 v[220:223], v[180:183], v[144:147], v[220:223]
  v_pk_mul_f16 v126, v61, v69 op_sel:[0,0] op_sel_hi:[0,1]
  v_mfma_f32_16x16x32_f16 v[236:239], v[180:183], v[156:159], v[236:239]
  s_nop 0
  s_waitcnt lgkmcnt(3)
  v_pk_mul_f16 v127, v61, v69 op_sel:[1,0] op_sel_hi:[1,1]
  v_mfma_f32_16x16x32_f16 v[196:199], v[164:167], v[120:123], 0
  ds_read_b128 v[180:183], v1 offset:14336
  v_pk_mul_f16 v136, v75, v82 op_sel:[0,0] op_sel_hi:[0,1]
  v_mfma_f32_16x16x32_f16 v[212:215], v[164:167], v[132:135], 0
  v_pk_mul_f16 v120, v60, v71 op_sel:[0,0] op_sel_hi:[0,1]
  v_mfma_f32_16x16x32_f16 v[228:231], v[164:167], v[144:147], 0
  v_pk_mul_f16 v121, v60, v71 op_sel:[1,0] op_sel_hi:[1,1]
  v_mfma_f32_16x16x32_f16 v[244:247], v[164:167], v[156:159], 0
  s_waitcnt lgkmcnt(3)
  v_pk_mul_f16 v122, v60, v66 op_sel:[0,1] op_sel_hi:[0,0]
  v_mfma_f32_16x16x32_f16 v[192:195], v[168:171], v[116:119], v[192:195]
  ds_read_b128 v[164:167], v1 offset:12288
  v_pk_mul_f16 v123, v60, v72 op_sel:[0,0] op_sel_hi:[1,0]
  v_mfma_f32_16x16x32_f16 v[208:211], v[168:171], v[128:131], v[208:211]
  s_nop 0
  v_pk_mul_f16 v132, v74, v85 op_sel:[0,0] op_sel_hi:[0,1]
  v_mfma_f32_16x16x32_f16 v[224:227], v[168:171], v[140:143], v[224:227]
  v_pk_mul_f16 v133, v74, v85 op_sel:[1,0] op_sel_hi:[1,1]
  v_mfma_f32_16x16x32_f16 v[240:243], v[168:171], v[152:155], v[240:243]
  s_nop 0
  s_waitcnt lgkmcnt(3)
  v_pk_mul_f16 v134, v74, v80 op_sel:[0,1] op_sel_hi:[0,0]
  v_mfma_f32_16x16x32_f16 v[184:187], v[172:175], v[116:119], v[184:187]
  ds_read_b128 v[168:171], v1 offset:13312
  v_pk_mul_f16 v135, v74, v86 op_sel:[0,0] op_sel_hi:[1,0]
  v_mfma_f32_16x16x32_f16 v[200:203], v[172:175], v[128:131], v[200:203]
  v_pk_mul_f16 v144, v88, v99 op_sel:[0,0] op_sel_hi:[0,1]
  v_mfma_f32_16x16x32_f16 v[216:219], v[172:175], v[140:143], v[216:219]
  s_setprio 2
  v_pk_mul_f16 v145, v88, v99 op_sel:[1,0] op_sel_hi:[1,1]
  v_mfma_f32_16x16x32_f16 v[232:235], v[172:175], v[152:155], v[232:235]
  s_waitcnt lgkmcnt(3)
  v_pk_mul_f16 v146, v88, v94 op_sel:[0,1] op_sel_hi:[0,0]
  v_mfma_f32_16x16x32_f16 v[188:191], v[176:179], v[116:119], v[188:191]
  ds_read_b128 v[172:175], v1 offset:0
  v_pk_mul_f16 v147, v88, v100 op_sel:[0,0] op_sel_hi:[1,0]
  v_mfma_f32_16x16x32_f16 v[204:207], v[176:179], v[128:131], v[204:207]
  v_pk_mul_f16 v156, v102, v113 op_sel:[0,0] op_sel_hi:[0,1]
  v_mfma_f32_16x16x32_f16 v[220:223], v[176:179], v[140:143], v[220:223]
  v_pk_mul_f16 v157, v102, v113 op_sel:[1,0] op_sel_hi:[1,1]
  v_mfma_f32_16x16x32_f16 v[236:239], v[176:179], v[152:155], v[236:239]
  s_nop 0
  s_waitcnt lgkmcnt(3)
  v_pk_mul_f16 v158, v102, v108 op_sel:[0,1] op_sel_hi:[0,0]
  v_mfma_f32_16x16x32_f16 v[192:195], v[180:183], v[120:123], v[192:195]
  ds_read_b128 v[176:179], v1 offset:17408
  v_pk_mul_f16 v159, v102, v114 op_sel:[0,0] op_sel_hi:[1,0]
  v_mfma_f32_16x16x32_f16 v[208:211], v[180:183], v[132:135], v[208:211]
  v_pk_mul_f16 v137, v75, v82 op_sel:[1,0] op_sel_hi:[1,1]
  v_mfma_f32_16x16x32_f16 v[224:227], v[180:183], v[144:147], v[224:227]
  v_pk_mul_f16 v138, v75, v83 op_sel:[0,0] op_sel_hi:[0,1]
  v_mfma_f32_16x16x32_f16 v[240:243], v[180:183], v[156:159], v[240:243]
  s_waitcnt lgkmcnt(3)
  v_pk_mul_f16 v139, v75, v83 op_sel:[1,0] op_sel_hi:[1,1]
  v_mfma_f32_16x16x32_f16 v[184:187], v[164:167], v[120:123], v[184:187]
  ds_read_b128 v[180:183], v1 offset:15360
  v_pk_mul_f16 v148, v89, v96 op_sel:[0,0] op_sel_hi:[0,1]
  v_mfma_f32_16x16x32_f16 v[200:203], v[164:167], v[132:135], v[200:203]
  s_nop 0
  v_pk_mul_f16 v149, v89, v96 op_sel:[1,0] op_sel_hi:[1,1]
  v_mfma_f32_16x16x32_f16 v[216:219], v[164:167], v[144:147], v[216:219]
  v_pk_mul_f16 v150, v89, v97 op_sel:[0,0] op_sel_hi:[0,1]
  v_mfma_f32_16x16x32_f16 v[232:235], v[164:167], v[156:159], v[232:235]
  s_nop 0
  s_waitcnt lgkmcnt(3)
  v_pk_mul_f16 v151, v89, v97 op_sel:[1,0] op_sel_hi:[1,1]
  v_mfma_f32_16x16x32_f16 v[188:191], v[168:171], v[120:123], v[188:191]
  ds_read_b128 v[164:167], v1 offset:16384
  v_pk_mul_f16 v160, v103, v110 op_sel:[0,0] op_sel_hi:[0,1]
  v_mfma_f32_16x16x32_f16 v[204:207], v[168:171], v[132:135], v[204:207]
  v_pk_mul_f16 v161, v103, v110 op_sel:[1,0] op_sel_hi:[1,1]
  v_mfma_f32_16x16x32_f16 v[220:223], v[168:171], v[144:147], v[220:223]
  v_pk_mul_f16 v162, v103, v111 op_sel:[0,0] op_sel_hi:[0,1]
  v_mfma_f32_16x16x32_f16 v[236:239], v[168:171], v[156:159], v[236:239]
  s_waitcnt lgkmcnt(3)
  v_pk_mul_f16 v163, v103, v111 op_sel:[1,0] op_sel_hi:[1,1]
  v_smfmac_f32_16x16x64_f16 v[196:199], v[172:175], v[116:123], v9
  s_nop 0
  ds_read_b128 v[168:171], v1 offset:20480
  v_smfmac_f32_16x16x64_f16 v[212:215], v[172:175], v[128:135], v9
  v_pk_mul_f16 v120, v61, v70 op_sel:[0,0] op_sel_hi:[0,1]
  v_smfmac_f32_16x16x64_f16 v[228:231], v[172:175], v[140:147], v9
  v_pk_mul_f16 v121, v61, v70 op_sel:[1,0] op_sel_hi:[1,1]
  v_smfmac_f32_16x16x64_f16 v[244:247], v[172:175], v[152:159], v9
  s_nop 0
  s_waitcnt lgkmcnt(3)
  v_pk_mul_f16 v122, v61, v71 op_sel:[0,0] op_sel_hi:[0,1]
  v_mfma_f32_16x16x32_f16 v[192:195], v[176:179], v[124:127], v[192:195]
  ds_read_b128 v[172:175], v1 offset:18432
  v_pk_mul_f16 v123, v61, v71 op_sel:[1,0] op_sel_hi:[1,1]
  v_mfma_f32_16x16x32_f16 v[208:211], v[176:179], v[136:139], v[208:211]
  v_pk_mul_f16 v132, v75, v84 op_sel:[0,0] op_sel_hi:[0,1]
  v_mfma_f32_16x16x32_f16 v[224:227], v[176:179], v[148:151], v[224:227]
  v_pk_mul_f16 v133, v75, v84 op_sel:[1,0] op_sel_hi:[1,1]
  v_mfma_f32_16x16x32_f16 v[240:243], v[176:179], v[160:163], v[240:243]
  s_waitcnt lgkmcnt(3)
  v_pk_mul_f16 v134, v75, v85 op_sel:[0,0] op_sel_hi:[0,1]
  v_mfma_f32_16x16x32_f16 v[184:187], v[180:183], v[124:127], v[184:187]
  ds_read_b128 v[176:179], v1 offset:19456
  v_pk_mul_f16 v135, v75, v85 op_sel:[1,0] op_sel_hi:[1,1]
  v_mfma_f32_16x16x32_f16 v[200:203], v[180:183], v[136:139], v[200:203]
  v_pk_mul_f16 v144, v89, v98 op_sel:[0,0] op_sel_hi:[0,1]
  v_mfma_f32_16x16x32_f16 v[216:219], v[180:183], v[148:151], v[216:219]
  s_nop 0
  v_pk_mul_f16 v145, v89, v98 op_sel:[1,0] op_sel_hi:[1,1]
  v_mfma_f32_16x16x32_f16 v[232:235], v[180:183], v[160:163], v[232:235]
  s_waitcnt lgkmcnt(3)
  v_pk_mul_f16 v146, v89, v99 op_sel:[0,0] op_sel_hi:[0,1]
  v_mfma_f32_16x16x32_f16 v[188:191], v[164:167], v[124:127], v[188:191]
  ds_read_b128 v[180:183], v1 offset:1024
  v_pk_mul_f16 v147, v89, v99 op_sel:[1,0] op_sel_hi:[1,1]
  v_mfma_f32_16x16x32_f16 v[204:207], v[164:167], v[136:139], v[204:207]
  s_waitcnt vmcnt(0)
  ds_read_u16_d16_hi v32, v10 offset:0
  v_pk_mul_f16 v156, v103, v112 op_sel:[0,0] op_sel_hi:[0,1]
  v_mfma_f32_16x16x32_f16 v[220:223], v[164:167], v[148:151], v[220:223]
  ds_read_u16_d16_hi v33, v10 offset:2
  v_pk_mul_f16 v157, v103, v112 op_sel:[1,0] op_sel_hi:[1,1]
  v_mfma_f32_16x16x32_f16 v[236:239], v[164:167], v[160:163], v[236:239]
  s_nop 0
  s_waitcnt lgkmcnt(5)
  v_pk_mul_f16 v158, v103, v113 op_sel:[0,0] op_sel_hi:[0,1]
  v_mfma_f32_16x16x32_f16 v[192:195], v[168:171], v[120:123], v[192:195]
  ds_read_b128 v[164:167], v1 offset:23552
  v_pk_mul_f16 v159, v103, v113 op_sel:[1,0] op_sel_hi:[1,1]
  v_mfma_f32_16x16x32_f16 v[208:211], v[168:171], v[132:135], v[208:211]
  ds_read_u16_d16_hi v34, v10 offset:2112
  v_pk_mul_f16 v116, v61, v67 op_sel:[0,1] op_sel_hi:[0,0]
  v_mfma_f32_16x16x32_f16 v[224:227], v[168:171], v[144:147], v[224:227]
  ds_read_u16_d16_hi v35, v10 offset:2114
  v_pk_mul_f16 v117, v61, v72 op_sel:[0,0] op_sel_hi:[1,0]
  v_mfma_f32_16x16x32_f16 v[240:243], v[168:171], v[156:159], v[240:243]
  s_nop 0
  s_waitcnt lgkmcnt(7)
  v_pk_mul_f16 v118, v62, v69 op_sel:[0,0] op_sel_hi:[0,1]
  v_mfma_f32_16x16x32_f16 v[184:187], v[172:175], v[120:123], v[184:187]
  ds_read_b128 v[168:171], v1 offset:21504
  v_pk_mul_f16 v119, v62, v69 op_sel:[1,0] op_sel_hi:[1,1]
  v_mfma_f32_16x16x32_f16 v[200:203], v[172:175], v[132:135], v[200:203]
  ds_read_b64_tr_b16 v[60:61], v27 offset:0
  v_pk_mul_f16 v128, v75, v81 op_sel:[0,1] op_sel_hi:[0,0]
  v_mfma_f32_16x16x32_f16 v[216:219], v[172:175], v[144:147], v[216:219]
  ds_read_u16_d16_hi v36, v10 offset:128
  v_pk_mul_f16 v129, v75, v86 op_sel:[0,0] op_sel_hi:[1,0]
  v_mfma_f32_16x16x32_f16 v[232:235], v[172:175], v[156:159], v[232:235]
  s_waitcnt lgkmcnt(9)
  v_pk_mul_f16 v130, v76, v83 op_sel:[0,0] op_sel_hi:[0,1]
  v_pk_mul_f16 v131, v76, v83 op_sel:[1,0] op_sel_hi:[1,1]
  v_mfma_f32_16x16x32_f16 v[188:191], v[176:179], v[120:123], v[188:191]
  ds_read_b128 v[172:175], v1 offset:22528
  v_pk_mul_f16 v140, v89, v95 op_sel:[0,1] op_sel_hi:[0,0]
  v_mfma_f32_16x16x32_f16 v[204:207], v[176:179], v[132:135], v[204:207]
  ds_read_b64_tr_b16 v[74:75], v27 offset:32
  v_pk_mul_f16 v141, v89, v100 op_sel:[0,0] op_sel_hi:[1,0]
  v_mfma_f32_16x16x32_f16 v[220:223], v[176:179], v[144:147], v[220:223]
  ds_read_b64_tr_b16 v[88:89], v27 offset:64
  v_pk_mul_f16 v142, v90, v97 op_sel:[0,0] op_sel_hi:[0,1]
  v_mfma_f32_16x16x32_f16 v[236:239], v[176:179], v[156:159], v[236:239]
  s_waitcnt lgkmcnt(11)
  v_pk_mul_f16 v143, v90, v97 op_sel:[1,0] op_sel_hi:[1,1]
  v_pk_mul_f16 v152, v103, v109 op_sel:[0,1] op_sel_hi:[0,0]
  v_smfmac_f32_16x16x64_f16 v[196:199], v[180:183], v[120:127], v9
  ds_read_b128 v[176:179], v1 offset:26624
  v_pk_mul_f16 v153, v103, v114 op_sel:[0,0] op_sel_hi:[1,0]
  v_smfmac_f32_16x16x64_f16 v[212:215], v[180:183], v[132:139], v9
  ds_read_b64_tr_b16 v[102:103], v27 offset:96
  v_pk_mul_f16 v154, v104, v111 op_sel:[0,0] op_sel_hi:[0,1]
  v_smfmac_f32_16x16x64_f16 v[228:231], v[180:183], v[144:151], v9
  ds_read_u16_d16_hi v37, v10 offset:130
  v_pk_mul_f16 v155, v104, v111 op_sel:[1,0] op_sel_hi:[1,1]
  v_smfmac_f32_16x16x64_f16 v[244:247], v[180:183], v[156:163], v9
  s_nop 0
  s_waitcnt lgkmcnt(11)
  v_pk_mul_f16 v120, v62, v70 op_sel:[0,0] op_sel_hi:[0,1]
  v_mfma_f32_16x16x32_f16 v[192:195], v[164:167], v[116:119], v[192:195]
  ds_read_b128 v[180:183], v1 offset:24576
  v_pk_mul_f16 v121, v62, v70 op_sel:[1,0] op_sel_hi:[1,1]
  v_mfma_f32_16x16x32_f16 v[208:211], v[164:167], v[128:131], v[208:211]
  ds_read_u16_d16_hi v38, v10 offset:2240
  v_pk_mul_f16 v122, v62, v71 op_sel:[0,0] op_sel_hi:[0,1]
  v_mfma_f32_16x16x32_f16 v[224:227], v[164:167], v[140:143], v[224:227]
  ds_read_u16_d16_hi v39, v10 offset:2242
  v_pk_mul_f16 v123, v62, v71 op_sel:[1,0] op_sel_hi:[1,1]
  v_mfma_f32_16x16x32_f16 v[240:243], v[164:167], v[152:155], v[240:243]
  s_waitcnt lgkmcnt(11)
  v_pk_mul_f16 v132, v76, v84 op_sel:[0,0] op_sel_hi:[0,1]
  v_max3_f32 v58, |v32|, |v33|, 0
  v_mfma_f32_16x16x32_f16 v[184:187], v[168:171], v[116:119], v[184:187]
  ds_read_b128 v[164:167], v1 offset:25600
  v_pk_mul_f16 v133, v76, v84 op_sel:[1,0] op_sel_hi:[1,1]
  v_mfma_f32_16x16x32_f16 v[200:203], v[168:171], v[128:131], v[200:203]
  ds_read_u16_d16_hi v40, v10 offset:256
  v_pk_mul_f16 v134, v76, v85 op_sel:[0,0] op_sel_hi:[0,1]
  v_mfma_f32_16x16x32_f16 v[216:219], v[168:171], v[140:143], v[216:219]
  ds_read_u16_d16_hi v41, v10 offset:258
  v_pk_mul_f16 v135, v76, v85 op_sel:[1,0] op_sel_hi:[1,1]
  v_mfma_f32_16x16x32_f16 v[232:235], v[168:171], v[152:155], v[232:235]
  s_waitcnt lgkmcnt(11)
  v_pk_mul_f16 v144, v90, v98 op_sel:[0,0] op_sel_hi:[0,1]
  v_max3_f32 v58, |v34|, |v35|, v58
  v_mfma_f32_16x16x32_f16 v[188:191], v[172:175], v[116:119], v[188:191]
  ds_read_b128 v[168:171], v1 offset:2048
  v_pk_mul_f16 v145, v90, v98 op_sel:[1,0] op_sel_hi:[1,1]
  v_mfma_f32_16x16x32_f16 v[204:207], v[172:175], v[128:131], v[204:207]
  ds_read_u16_d16_hi v42, v10 offset:2368
  v_pk_mul_f16 v146, v90, v99 op_sel:[0,0] op_sel_hi:[0,1]
  v_mfma_f32_16x16x32_f16 v[220:223], v[172:175], v[140:143], v[220:223]
  ds_read_u16_d16_hi v43, v10 offset:2370
  v_pk_mul_f16 v147, v90, v99 op_sel:[1,0] op_sel_hi:[1,1]
  v_mfma_f32_16x16x32_f16 v[236:239], v[172:175], v[152:155], v[236:239]
  s_nop 0
  s_waitcnt lgkmcnt(11)
  v_pk_mul_f16 v156, v104, v112 op_sel:[0,0] op_sel_hi:[0,1]
  v_mfma_f32_16x16x32_f16 v[192:195], v[176:179], v[120:123], v[192:195]
  ds_read_b128 v[172:175], v1 offset:29696
  v_pk_mul_f16 v157, v104, v112 op_sel:[1,0] op_sel_hi:[1,1]
  v_mfma_f32_16x16x32_f16 v[208:211], v[176:179], v[132:135], v[208:211]
  ds_read_u16_d16_hi v44, v10 offset:384
  v_pk_mul_f16 v158, v104, v113 op_sel:[0,0] op_sel_hi:[0,1]
  v_mfma_f32_16x16x32_f16 v[224:227], v[176:179], v[144:147], v[224:227]
  ds_read_u16_d16_hi v45, v10 offset:386
  v_pk_mul_f16 v159, v104, v113 op_sel:[1,0] op_sel_hi:[1,1]
  s_nop 1
  v_mfma_f32_16x16x32_f16 v[240:243], v[176:179], v[156:159], v[240:243]
  s_waitcnt lgkmcnt(11)
  v_pk_mul_f16 v124, v62, v68 op_sel:[0,1] op_sel_hi:[0,0]
  v_mfma_f32_16x16x32_f16 v[184:187], v[180:183], v[120:123], v[184:187]
  ds_read_b128 v[176:179], v1 offset:27648
  v_pk_mul_f16 v125, v62, v72 op_sel:[0,0] op_sel_hi:[1,0]
  v_mfma_f32_16x16x32_f16 v[200:203], v[180:183], v[132:135], v[200:203]
  ds_read_u16_d16_hi v46, v10 offset:2496
  v_pk_mul_f16 v126, v63, v70 op_sel:[0,0] op_sel_hi:[0,1]
  v_mfma_f32_16x16x32_f16 v[216:219], v[180:183], v[144:147], v[216:219]
  ds_read_u16_d16_hi v47, v10 offset:2498
  v_pk_mul_f16 v127, v63, v70 op_sel:[1,0] op_sel_hi:[1,1]
  v_mfma_f32_16x16x32_f16 v[232:235], v[180:183], v[156:159], v[232:235]
  s_waitcnt lgkmcnt(11)
  v_pk_mul_f16 v136, v76, v82 op_sel:[0,1] op_sel_hi:[0,0]
  v_pk_mul_f16 v137, v76, v86 op_sel:[0,0] op_sel_hi:[1,0]
  v_mfma_f32_16x16x32_f16 v[188:191], v[164:167], v[120:123], v[188:191]
  ds_read_b128 v[180:183], v1 offset:28672
  v_pk_mul_f16 v138, v77, v84 op_sel:[0,0] op_sel_hi:[0,1]
  v_mfma_f32_16x16x32_f16 v[204:207], v[164:167], v[132:135], v[204:207]
  ds_read_u16_d16_hi v48, v10 offset:512
  v_pk_mul_f16 v139, v77, v84 op_sel:[1,0] op_sel_hi:[1,1]
  v_mfma_f32_16x16x32_f16 v[220:223], v[164:167], v[144:147], v[220:223]
  ds_read_u16_d16_hi v49, v10 offset:514
  v_pk_mul_f16 v148, v90, v96 op_sel:[0,1] op_sel_hi:[0,0]
  v_mfma_f32_16x16x32_f16 v[236:239], v[164:167], v[156:159], v[236:239]
  s_waitcnt lgkmcnt(11)
  v_pk_mul_f16 v149, v90, v100 op_sel:[0,0] op_sel_hi:[1,0]
  v_pk_mul_f16 v150, v91, v98 op_sel:[0,0] op_sel_hi:[0,1]
  v_smfmac_f32_16x16x64_f16 v[196:199], v[168:171], v[116:123], v9
  ds_read_b128 v[164:167], v1 offset:32768
  v_pk_mul_f16 v151, v91, v98 op_sel:[1,0] op_sel_hi:[1,1]
  v_smfmac_f32_16x16x64_f16 v[212:215], v[168:171], v[128:135], v9
  ds_read_u16_d16_hi v50, v10 offset:2624
  v_pk_mul_f16 v160, v104, v110 op_sel:[0,1] op_sel_hi:[0,0]
  v_smfmac_f32_16x16x64_f16 v[228:231], v[168:171], v[140:147], v9
  ds_read_u16_d16_hi v51, v10 offset:2626
  v_pk_mul_f16 v161, v104, v114 op_sel:[0,0] op_sel_hi:[1,0]
  v_smfmac_f32_16x16x64_f16 v[244:247], v[168:171], v[152:159], v9
  s_nop 0
  s_waitcnt lgkmcnt(11)
  v_pk_mul_f16 v162, v105, v112 op_sel:[0,0] op_sel_hi:[0,1]
  v_mfma_f32_16x16x32_f16 v[192:195], v[172:175], v[124:127], v[192:195]
  ds_read_b128 v[168:171], v1 offset:30720
  v_pk_mul_f16 v163, v105, v112 op_sel:[1,0] op_sel_hi:[1,1]
  v_mfma_f32_16x16x32_f16 v[208:211], v[172:175], v[136:139], v[208:211]
  ds_read_u16_d16_hi v52, v10 offset:640
  v_pk_mul_f16 v120, v63, v71 op_sel:[0,0] op_sel_hi:[0,1]
  v_mfma_f32_16x16x32_f16 v[224:227], v[172:175], v[148:151], v[224:227]
  ds_read_u16_d16_hi v53, v10 offset:642
  v_pk_mul_f16 v121, v63, v71 op_sel:[1,0] op_sel_hi:[1,1]
  v_mfma_f32_16x16x32_f16 v[240:243], v[172:175], v[160:163], v[240:243]
  s_waitcnt lgkmcnt(11)
  v_pk_mul_f16 v122, v63, v69 op_sel:[0,1] op_sel_hi:[1,1]
  v_pk_mul_f16 v123, v63, v72 op_sel:[0,0] op_sel_hi:[1,0]
  v_mfma_f32_16x16x32_f16 v[184:187], v[176:179], v[124:127], v[184:187]
  ds_read_b128 v[172:175], v1 offset:31744
  v_pk_mul_f16 v132, v77, v85 op_sel:[0,0] op_sel_hi:[0,1]
  v_mfma_f32_16x16x32_f16 v[200:203], v[176:179], v[136:139], v[200:203]
  ds_read_u16_d16_hi v54, v10 offset:2752
  v_pk_mul_f16 v133, v77, v85 op_sel:[1,0] op_sel_hi:[1,1]
  v_mfma_f32_16x16x32_f16 v[216:219], v[176:179], v[148:151], v[216:219]
  ds_read_u16_d16_hi v55, v10 offset:2754
  v_pk_mul_f16 v134, v77, v83 op_sel:[0,1] op_sel_hi:[1,1]
  v_mfma_f32_16x16x32_f16 v[232:235], v[176:179], v[160:163], v[232:235]
  s_waitcnt lgkmcnt(11)
  v_pk_mul_f16 v135, v77, v86 op_sel:[0,0] op_sel_hi:[1,0]
  v_pk_mul_f16 v144, v91, v99 op_sel:[0,0] op_sel_hi:[0,1]
  v_mfma_f32_16x16x32_f16 v[188:191], v[180:183], v[124:127], v[188:191]
  ds_read_b128 v[176:179], v1 offset:3072
  v_pk_mul_f16 v145, v91, v99 op_sel:[1,0] op_sel_hi:[1,1]
  v_mfma_f32_16x16x32_f16 v[204:207], v[180:183], v[136:139], v[204:207]
  ds_read_u16_d16_hi v56, v10 offset:768
  v_pk_mul_f16 v146, v91, v97 op_sel:[0,1] op_sel_hi:[1,1]
  v_mfma_f32_16x16x32_f16 v[220:223], v[180:183], v[148:151], v[220:223]
  ds_read_u16_d16_hi v57, v10 offset:770
  v_pk_mul_f16 v147, v91, v100 op_sel:[0,0] op_sel_hi:[1,0]
  v_mfma_f32_16x16x32_f16 v[236:239], v[180:183], v[160:163], v[236:239]
  s_waitcnt lgkmcnt(11)
  v_pk_mul_f16 v156, v105, v113 op_sel:[0,0] op_sel_hi:[0,1]
  v_max3_f32 v58, |v36|, |v37|, v58
  v_mfma_f32_16x16x32_f16 v[192:195], v[164:167], v[120:123], v[192:195]
  ds_read_b128 v[180:183], v1 offset:35840
  v_pk_mul_f16 v157, v105, v113 op_sel:[1,0] op_sel_hi:[1,1]
  v_mfma_f32_16x16x32_f16 v[208:211], v[164:167], v[132:135], v[208:211]
  v_pk_mul_f16 v158, v105, v111 op_sel:[0,1] op_sel_hi:[1,1]
  v_max3_f32 v58, |v38|, |v39|, v58
  v_mfma_f32_16x16x32_f16 v[224:227], v[164:167], v[144:147], v[224:227]
  v_pk_mul_f16 v159, v105, v114 op_sel:[0,0] op_sel_hi:[1,0]
  v_max3_f32 v58, |v40|, |v41|, v58
  s_nop 0
  v_mfma_f32_16x16x32_f16 v[240:243], v[164:167], v[156:159], v[240:243]
  s_nop 0
  s_waitcnt lgkmcnt(9)
  v_pk_mul_f16 v116, v64, v71 op_sel:[0,0] op_sel_hi:[0,1]
  v_mfma_f32_16x16x32_f16 v[184:187], v[168:171], v[120:123], v[184:187]
  ds_read_b128 v[164:167], v1 offset:33792
  v_pk_mul_f16 v117, v64, v71 op_sel:[1,0] op_sel_hi:[1,1]
  v_mfma_f32_16x16x32_f16 v[200:203], v[168:171], v[132:135], v[200:203]
  v_pk_mul_f16 v118, v64, v70 op_sel:[0,1] op_sel_hi:[1,1]
  v_max3_f32 v58, |v42|, |v43|, v58
  v_mfma_f32_16x16x32_f16 v[216:219], v[168:171], v[144:147], v[216:219]
  v_pk_mul_f16 v119, v64, v72 op_sel:[0,0] op_sel_hi:[1,0]
  v_pk_mul_f16 v128, v78, v85 op_sel:[0,0] op_sel_hi:[0,1]
  v_mfma_f32_16x16x32_f16 v[232:235], v[168:171], v[156:159], v[232:235]
  s_waitcnt lgkmcnt(7)
  v_pk_mul_f16 v129, v78, v85 op_sel:[1,0] op_sel_hi:[1,1]
  v_pk_mul_f16 v130, v78, v84 op_sel:[0,1] op_sel_hi:[1,1]
  v_mfma_f32_16x16x32_f16 v[188:191], v[172:175], v[120:123], v[188:191]
  ds_read_b128 v[168:171], v1 offset:34816
  v_pk_mul_f16 v131, v78, v86 op_sel:[0,0] op_sel_hi:[1,0]
  v_mfma_f32_16x16x32_f16 v[204:207], v[172:175], v[132:135], v[204:207]
  v_pk_mul_f16 v140, v92, v99 op_sel:[0,0] op_sel_hi:[0,1]
  v_pk_mul_f16 v141, v92, v99 op_sel:[1,0] op_sel_hi:[1,1]
  v_mfma_f32_16x16x32_f16 v[220:223], v[172:175], v[144:147], v[220:223]
  v_pk_mul_f16 v142, v92, v98 op_sel:[0,1] op_sel_hi:[1,1]
  v_pk_mul_f16 v143, v92, v100 op_sel:[0,0] op_sel_hi:[1,0]
  v_mfma_f32_16x16x32_f16 v[236:239], v[172:175], v[156:159], v[236:239]
  s_waitcnt lgkmcnt(5)
  v_pk_mul_f16 v152, v106, v113 op_sel:[0,0] op_sel_hi:[0,1]
  v_smfmac_f32_16x16x64_f16 v[196:199], v[176:179], v[120:127], v9
  ds_read_b128 v[172:175], v1 offset:38912
  v_pk_mul_f16 v153, v106, v113 op_sel:[1,0] op_sel_hi:[1,1]
  v_smfmac_f32_16x16x64_f16 v[212:215], v[176:179], v[132:139], v9
  v_pk_mul_f16 v154, v106, v112 op_sel:[0,1] op_sel_hi:[1,1]
  v_smfmac_f32_16x16x64_f16 v[228:231], v[176:179], v[144:151], v9
  v_pk_mul_f16 v155, v106, v114 op_sel:[0,0] op_sel_hi:[1,0]
  v_smfmac_f32_16x16x64_f16 v[244:247], v[176:179], v[156:163], v9
  s_waitcnt lgkmcnt(3)
  v_pk_mul_f16 v120, v65, v71 op_sel:[0,1] op_sel_hi:[1,1]
  v_mfma_f32_16x16x32_f16 v[192:195], v[180:183], v[116:119], v[192:195]
  ds_read_b128 v[176:179], v1 offset:36864
  v_pk_mul_f16 v121, v65, v72 op_sel:[0,0] op_sel_hi:[1,0]
  v_mfma_f32_16x16x32_f16 v[208:211], v[180:183], v[128:131], v[208:211]
  s_nop 0
  v_pk_mul_f16 v122, v72, v72 op_sel:[0,0] op_sel_hi:[1,1]
  v_max3_f32 v58, |v44|, |v45|, v58
  v_mfma_f32_16x16x32_f16 v[224:227], v[180:183], v[140:143], v[224:227]
  v_pk_mul_f16 v123, v60, v61 op_sel:[0,0] op_sel_hi:[1,1]
  v_max3_f32 v58, |v46|, |v47|, v58
  v_mfma_f32_16x16x32_f16 v[240:243], v[180:183], v[152:155], v[240:243]
  s_nop 0
  s_waitcnt lgkmcnt(3)
  v_pk_mul_f16 v132, v79, v85 op_sel:[0,1] op_sel_hi:[1,1]
  v_mfma_f32_16x16x32_f16 v[184:187], v[164:167], v[116:119], v[184:187]
  ds_read_b128 v[180:183], v1 offset:37888
  v_pk_mul_f16 v133, v79, v86 op_sel:[0,0] op_sel_hi:[1,0]
  v_mfma_f32_16x16x32_f16 v[200:203], v[164:167], v[128:131], v[200:203]
  v_pk_mul_f16 v134, v86, v86 op_sel:[0,0] op_sel_hi:[1,1]
  v_max3_f32 v58, |v48|, |v49|, v58
  v_mfma_f32_16x16x32_f16 v[216:219], v[164:167], v[140:143], v[216:219]
  v_pk_mul_f16 v135, v74, v75 op_sel:[0,0] op_sel_hi:[1,1]
  v_max3_f32 v58, |v50|, |v51|, v58
  v_mfma_f32_16x16x32_f16 v[232:235], v[164:167], v[152:155], v[232:235]
  s_waitcnt lgkmcnt(3)
  v_pk_mul_f16 v144, v93, v99 op_sel:[0,1] op_sel_hi:[1,1]
  v_mfma_f32_16x16x32_f16 v[188:191], v[168:171], v[116:119], v[188:191]
  ds_read_b128 v[164:167], v1 offset:4096
  v_pk_mul_f16 v145, v93, v100 op_sel:[0,0] op_sel_hi:[1,0]
  v_mfma_f32_16x16x32_f16 v[204:207], v[168:171], v[128:131], v[204:207]
  s_nop 0
  v_pk_mul_f16 v146, v100, v100 op_sel:[0,0] op_sel_hi:[1,1]
  v_max3_f32 v58, |v52|, |v53|, v58
  v_mfma_f32_16x16x32_f16 v[220:223], v[168:171], v[140:143], v[220:223]
  v_pk_mul_f16 v147, v88, v89 op_sel:[0,0] op_sel_hi:[1,1]
  v_max3_f32 v58, |v54|, |v55|, v58
  v_mfma_f32_16x16x32_f16 v[236:239], v[168:171], v[152:155], v[236:239]
  s_waitcnt lgkmcnt(3)
  v_pk_mul_f16 v156, v107, v113 op_sel:[0,1] op_sel_hi:[1,1]
  v_mfma_f32_16x16x32_f16 v[192:195], v[172:175], v[120:123], v[192:195]
  s_nop 0
  v_pk_mul_f16 v157, v107, v114 op_sel:[0,0] op_sel_hi:[1,0]
  v_max3_f32 v58, |v56|, |v57|, v58
  v_mfma_f32_16x16x32_f16 v[208:211], v[172:175], v[132:135], v[208:211]
  v_pk_mul_f16 v158, v114, v114 op_sel:[0,0] op_sel_hi:[1,1]
  v_cvt_pk_f16_f32 v62, v32, v33
  v_mfma_f32_16x16x32_f16 v[224:227], v[172:175], v[144:147], v[224:227]
  s_nop 0
  v_pk_mul_f16 v159, v102, v103 op_sel:[0,0] op_sel_hi:[1,1]
  s_nop 1
  v_mfma_f32_16x16x32_f16 v[240:243], v[172:175], v[156:159], v[240:243]
  s_waitcnt lgkmcnt(2)
  v_cvt_pk_f16_f32 v76, v34, v35
  v_cvt_pk_f16_f32 v90, v36, v37
  v_mfma_f32_16x16x32_f16 v[184:187], v[176:179], v[120:123], v[184:187]
  ds_write_b32 v11, v62 offset:0
  v_mfma_f32_16x16x32_f16 v[200:203], v[176:179], v[132:135], v[200:203]
  ds_write_b32 v11, v76 offset:160
  v_mfma_f32_16x16x32_f16 v[216:219], v[176:179], v[144:147], v[216:219]
  ds_write_b32 v11, v90 offset:320
  v_mfma_f32_16x16x32_f16 v[232:235], v[176:179], v[156:159], v[232:235]
  s_waitcnt lgkmcnt(4)
  v_cvt_pk_f16_f32 v104, v38, v39
  v_cvt_pk_f16_f32 v63, v40, v41
  v_mfma_f32_16x16x32_f16 v[188:191], v[180:183], v[120:123], v[188:191]
  ds_write_b32 v11, v104 offset:480
  v_mfma_f32_16x16x32_f16 v[204:207], v[180:183], v[132:135], v[204:207]
  ds_write_b32 v11, v63 offset:640
  v_mfma_f32_16x16x32_f16 v[220:223], v[180:183], v[144:147], v[220:223]
  s_nop 0
  v_cvt_pk_f16_f32 v77, v42, v43
  v_cvt_pk_f16_f32 v91, v44, v45
  v_mfma_f32_16x16x32_f16 v[236:239], v[180:183], v[156:159], v[236:239]
  s_waitcnt lgkmcnt(5)
  v_cvt_pk_f16_f32 v105, v46, v47
  v_cvt_pk_f16_f32 v66, v48, v49
  v_smfmac_f32_16x16x64_f16 v[196:199], v[164:167], v[116:123], v9
  ds_write_b32 v11, v77 offset:800
  v_smfmac_f32_16x16x64_f16 v[212:215], v[164:167], v[128:135], v9
  ds_write_b32 v11, v91 offset:960
  v_smfmac_f32_16x16x64_f16 v[228:231], v[164:167], v[140:147], v9
  ds_write_b32 v11, v105 offset:1120
  v_smfmac_f32_16x16x64_f16 v[244:247], v[164:167], v[152:159], v9
  ds_write_b32 v11, v66 offset:1280
  s_setprio 0
  s_sub_u32 s72, s72, 1
  s_cmp_eq_u32 s72, 0
  s_cbranch_scc1 L_cin_done
  v_cvt_pk_f16_f32 v80, v50, v51
  v_cvt_pk_f16_f32 v94, v52, v53
  v_cvt_pk_f16_f32 v108, v54, v55
  v_cvt_pk_f16_f32 v67, v56, v57
  ds_write_b32 v11, v80 offset:1440
  ds_write_b32 v11, v94 offset:1600
  ds_write_b32 v11, v108 offset:1760
  ds_write_b32 v11, v67 offset:1920
  s_branch L_cin_loop
L_cslow:
  v_max_f32_dpp v58, v58, v58 row_shr:1 row_mask:0xf bank_mask:0xf
  s_nop 1
  v_max_f32_dpp v58, v58, v58 row_shr:2 row_mask:0xf bank_mask:0xf
  s_nop 1
  v_max_f32_dpp v58, v58, v58 row_shr:4 row_mask:0xf bank_mask:0xf
  s_nop 1
  v_max_f32_dpp v58, v58, v58 row_shr:8 row_mask:0xf bank_mask:0xf
  s_nop 1
  v_max_f32_dpp v58, v58, v58 row_bcast:15 row_mask:0xa bank_mask:0xf
  s_nop 1
  v_max_f32_dpp v58, v58, v58 row_bcast:31 row_mask:0xc bank_mask:0xf
  s_nop 0
  v_readlane_b32 s98, v58, 63
  s_mov_b32 s97, 0
  s_lshr_b32 s98, s98, 23
  s_min_u32 s98, s98, 182
  s_lshr_b32 s99, s1, 23
  s_sub_u32 s99, s99, 47
  s_lshr_b32 s99, s99, 1
  s_min_u32 s99, s99, 59
  s_sub_u32 s99, 131, s99
  s_max_u32 s98, s98, s99
  s_sub_u32 s99, 258, s98
  s_lshl_b32 s100, s99, 1
  s_sub_u32 s100, s100, 127
  s_sub_u32 s95, 254, s100
  s_lshl_b32 s95, s95, 23
  v_mov_b32 v60, s95
  v_mul_f32 v61, s0, v60
  v_mul_f32 v60, s1, v60
  v_readfirstlane_b32 s74, v61
  v_readfirstlane_b32 s75, v60
  s_lshl_b32 s99, s99, 23
  s_lshl_b32 s100, s100, 23
  v_mul_f32 v60, s99, v32
  v_mul_f32 v61, s99, v33
  v_mul_f32 v62, s100, v32
  v_mul_f32 v63, s100, v33
  v_cvt_pk_f16_f32 v80, v60, v61
  v_cvt_pk_bf16_f32 v64, v62, v63
  ds_write_b32 v11, v80 offset:0
  ds_write_b32 v10, v64 offset:0
  v_mul_f32 v60, s99, v34
  v_mul_f32 v61, s99, v35
  v_mul_f32 v62, s100, v34
  v_mul_f32 v63, s100, v35
  v_cvt_pk_f16_f32 v81, v60, v61
  v_cvt_pk_bf16_f32 v65, v62, v63
  ds_write_b32 v11, v81 offset:160
  ds_write_b32 v10, v65 offset:2112
  v_mul_f32 v60, s99, v36
  v_mul_f32 v61, s99, v37
  v_mul_f32 v62, s100, v36
  v_mul_f32_e64 v63, s100, v37
  v_cvt_pk_f16_f32 v82, v60, v61
  v_cvt_pk_bf16_f32 v66, v62, v63
  ds_write_b32 v11, v82 offset:320
  ds_write_b32 v10, v66 offset:128
  v_mul_f32 v60, s99, v38
  v_mul_f32 v61, s99, v39
  v_mul_f32 v62, s100, v38
  v_mul_f32 v63, s100, v39
  v_cvt_pk_f16_f32 v83, v60, v61
  v_cvt_pk_bf16_f32 v67, v62, v63
  ds_write_b32 v11, v83 offset:480
  ds_write_b32 v10, v67 offset:2240
  v_mul_f32 v60, s99, v40
  v_mul_f32 v61, s99, v41
  v_mul_f32 v62, s100, v40
  v_mul_f32 v63, s100, v41
  v_cvt_pk_f16_f32 v84, v60, v61
  v_cvt_pk_bf16_f32 v68, v62, v63
  ds_write_b32 v11, v84 offset:640
  ds_write_b32 v10, v68 offset:256
  v_mul_f32 v60, s99, v42
  v_mul_f32 v61, s99, v43
  v_mul_f32 v62, s100, v42
  v_mul_f32 v63, s100, v43
  v_cvt_pk_f16_f32 v85, v60, v61
  v_cvt_pk_bf16_f32 v69, v62, v63
  ds_write_b32 v11, v85 offset:800
  ds_write_b32 v10, v69 offset:2368
  v_mul_f32 v60, s99, v44
  v_mul_f32 v61, s99, v45
  v_mul_f32 v62, s100, v44
  v_mul_f32 v63, s100, v45
  v_cvt_pk_f16_f32 v86, v60, v61
  v_cvt_pk_bf16_f32 v70, v62, v63
  ds_write_b32 v11, v86 offset:960
  ds_write_b32 v10, v70 offset:384
  v_mul_f32 v60, s99, v46
  v_mul_f32 v61, s99, v47
  v_mul_f32 v62, s100, v46
  v_mul_f32 v63, s100, v47
  v_cvt_pk_f16_f32 v87, v60, v61
  v_cvt_pk_bf16_f32 v71, v62, v63
  ds_write_b32 v11, v87 offset:1120
  ds_write_b32 v10, v71 offset:2496
  v_mul_f32 v60, s99, v48
  v_mul_f32 v61, s99, v49
  v_mul_f32 v62, s100, v48
  v_mul_f32 v63, s100, v49
  v_cvt_pk_f16_f32 v88, v60, v61
  v_cvt_pk_bf16_f32 v72, v62, v63
  ds_write_b32 v11, v88 offset:1280
  ds_write_b32 v10, v72 offset:512
  v_mul_f32 v60, s99, v50
  v_mul_f32 v61, s99, v51
  v_mul_f32 v62, s100, v50
  v_mul_f32 v63, s100, v51
  v_cvt_pk_f16_f32 v89, v60, v61
  v_cvt_pk_bf16_f32 v73, v62, v63
  ds_write_b32 v11, v89 offset:1440
  ds_write_b32 v10, v73 offset:2624
  v_mul_f32 v60, s99, v52
  v_mul_f32 v61, s99, v53
  v_mul_f32 v62, s100, v52
  v_mul_f32 v63, s100, v53
  v_cvt_pk_f16_f32 v90, v60, v61
  v_cvt_pk_bf16_f32 v74, v62, v63
  ds_write_b32 v11, v90 offset:1600
  ds_write_b32 v10, v74 offset:640
  v_mul_f32 v60, s99, v54
  v_mul_f32 v61, s99, v55
  v_mul_f32 v62, s100, v54
  v_mul_f32 v63, s100, v55
  v_cvt_pk_f16_f32 v91, v60, v61
  v_cvt_pk_bf16_f32 v75, v62, v63
  ds_write_b32 v11, v91 offset:1760
  ds_write_b32 v10, v75 offset:2752
  v_mul_f32 v60, s99, v56
  v_mul_f32 v61, s99, v57
  v_mul_f32 v62, s100, v56
  v_mul_f32 v63, s100, v57
  v_cvt_pk_f16_f32 v92, v60, v61
  v_cvt_pk_bf16_f32 v76, v62, v63
  ds_write_b32 v11, v92 offset:1920
  ds_write_b32 v10, v76 offset:768
  v_mov_b32 v60, s100
  v_cvt_pk_bf16_f32 v60, v60, v60
  s_mov_b32 exec_hi, 0
  ds_write_b32 v10, v60 offset:2880
  s_mov_b32 exec_hi, -1
  s_waitcnt lgkmcnt(0)
  s_branch L_cconv
L_sdown:
  v_lshlrev_b32 v108, 16, v112
  v_and_b32 v109, 0xffff0000, v112
  v_mul_f32 v108, v108, v250
  v_mul_f32 v109, v109, v250
  v_cvt_pk_bf16_f32 v112, v108, v109
  v_lshlrev_b32 v108, 16, v113
  v_and_b32 v109, 0xffff0000, v113
  v_mul_f32 v108, v108, v250
  v_mul_f32 v109, v109, v250
  v_cvt_pk_bf16_f32 v113, v108, v109
  v_lshlrev_b32 v108, 16, v114
  v_and_b32 v109, 0xffff0000, v114
  v_mul_f32 v108, v108, v250
  v_mul_f32 v109, v109, v250
  v_cvt_pk_bf16_f32 v114, v108, v109
  v_lshlrev_b32_e64 v108, 16, v115
  v_and_b32 v109, 0xffff0000, v115
  v_mul_f32 v108, v108, v250
  v_mul_f32 v109, v109, v250
  v_cvt_pk_bf16_f32 v115, v108, v109
  v_lshlrev_b32 v108, 16, v116
  v_and_b32 v109, 0xffff0000, v116
  v_mul_f32 v108, v108, v250
  v_mul_f32 v109, v109, v250
  v_cvt_pk_bf16_f32 v116, v108, v109
  v_lshlrev_b32 v108, 16, v117
  v_and_b32 v109, 0xffff0000, v117
  v_mul_f32 v108, v108, v250
  v_mul_f32 v109, v109, v250
  v_cvt_pk_bf16_f32 v117, v108, v109
  v_lshlrev_b32 v108, 16, v118
  v_and_b32 v109, 0xffff0000, v118
  v_mul_f32 v108, v108, v250
  v_mul_f32 v109, v109, v250
  v_cvt_pk_bf16_f32 v118, v108, v109
  v_lshlrev_b32 v108, 16, v119
  v_and_b32 v109, 0xffff0000, v119
  v_mul_f32 v108, v108, v250
  v_mul_f32 v109, v109, v250
  v_cvt_pk_bf16_f32 v119, v108, v109
  s_branch L_scaled
L_first:
  ds_read_b64_tr_b16 v[60:61], v20 offset:0
  ds_read_b64_tr_b16 v[74:75], v20 offset:32
  ds_read_b64_tr_b16 v[88:89], v20 offset:64
  ds_read_b64_tr_b16 v[102:103], v20 offset:96
  ds_read_b64_tr_b16 v[66:67], v23 offset:0
  ds_read_b64_tr_b16 v[80:81], v23 offset:32
  ds_read_b64_tr_b16 v[94:95], v23 offset:64
  ds_read_b64_tr_b16 v[108:109], v23 offset:96
  ds_read_b64_tr_b16 v[68:69], v24 offset:0
  ds_read_b64_tr_b16 v[82:83], v24 offset:32
  ds_read_b64_tr_b16 v[96:97], v24 offset:64
  ds_read_b64_tr_b16 v[110:111], v24 offset:96
  ds_read_b64_tr_b16 v[124:125], v4 offset:0
  ds_read_b64_tr_b16 v[126:127], v5 offset:0
  ds_read_b64_tr_b16 v[136:137], v4 offset:32
  ds_read_b64_tr_b16 v[138:139], v5 offset:32
  ds_read_b64_tr_b16 v[148:149], v4 offset:64
  ds_read_b64_tr_b16 v[150:151], v5 offset:64
  ds_read_b64_tr_b16 v[160:161], v4 offset:96
  ds_read_b64_tr_b16 v[162:163], v5 offset:96
  ds_read_b128 v[164:167], v1 offset:39936
  ds_read_b128 v[168:171], v1 offset:40960
  ds_read_b128 v[172:175], v1 offset:8192
  ds_read_b128 v[176:179], v1 offset:6144
  ds_read_b64_tr_b16 v[70:71], v25 offset:0
  ds_read_b64_tr_b16 v[84:85], v25 offset:32
  ds_read_b64_tr_b16 v[98:99], v25 offset:64
  ds_read_b64_tr_b16 v[112:113], v25 offset:96
  ds_read_b64_tr_b16 v[72:73], v26 offset:0
  s_waitcnt lgkmcnt(14)
  v_pk_mul_f16 v120, v60, v67 op_sel:[0,0] op_sel_hi:[0,1]
  v_pk_mul_f16 v121, v60, v67 op_sel:[1,0] op_sel_hi:[1,1]
  ds_read_b64_tr_b16 v[86:87], v26 offset:32
  v_pk_mul_f16 v122, v60, v68 op_sel:[0,0] op_sel_hi:[0,1]
  ds_read_b64_tr_b16 v[100:101], v26 offset:64
  v_pk_mul_f16 v123, v60, v68 op_sel:[1,0] op_sel_hi:[1,1]
  ds_read_b64_tr_b16 v[114:115], v26 offset:96
  v_pk_mul_f16 v132, v74, v81 op_sel:[0,0] op_sel_hi:[0,1]
  v_pk_mul_f16 v133, v74, v81 op_sel:[1,0] op_sel_hi:[1,1]
  ds_read_b64_tr_b16 v[62:63], v21 offset:0
  v_pk_mul_f16 v134, v74, v82 op_sel:[0,0] op_sel_hi:[0,1]
  ds_read_b64_tr_b16 v[76:77], v21 offset:32
  v_pk_mul_f16 v135, v74, v82 op_sel:[1,0] op_sel_hi:[1,1]
  ds_read_b64_tr_b16 v[90:91], v21 offset:64
  v_pk_mul_f16 v144, v88, v95 op_sel:[0,0] op_sel_hi:[0,1]
  v_pk_mul_f16 v145, v88, v95 op_sel:[1,0] op_sel_hi:[1,1]
  ds_read_b64_tr_b16 v[104:105], v21 offset:96
  v_pk_mul_f16 v146, v88, v96 op_sel:[0,0] op_sel_hi:[0,1]
  ds_read_b64_tr_b16 v[64:65], v22 offset:0
  v_pk_mul_f16 v147, v88, v96 op_sel:[1,0] op_sel_hi:[1,1]
  ds_read_b64_tr_b16 v[78:79], v22 offset:32
  v_pk_mul_f16 v156, v102, v109 op_sel:[0,0] op_sel_hi:[0,1]
  v_pk_mul_f16 v157, v102, v109 op_sel:[1,0] op_sel_hi:[1,1]
  ds_read_b64_tr_b16 v[92:93], v22 offset:64
  v_pk_mul_f16 v158, v102, v110 op_sel:[0,0] op_sel_hi:[0,1]
  ds_read_b64_tr_b16 v[106:107], v22 offset:96
  v_pk_mul_f16 v159, v102, v110 op_sel:[1,0] op_sel_hi:[1,1]
  s_branch L_novm
L_end:
  s_endpgm
.p2align 8
L_tables:
.long 0x0, 0x1800, 0x6c80, 0x81a0, 0x8, 0x1808, 0x6c88, 0x81a8
.long 0x10, 0x1810, 0x6c90, 0x81b0, 0x18, 0x1818, 0x6c98, 0x81b8
.long 0x40, 0x1d48, 0x71c8, 0x86e8, 0x48, 0x1d50, 0x71d0, 0x86f0
.long 0x50, 0x1d58, 0x71d8, 0x86f8, 0x58, 0x1d60, 0x71e0, 0x8700
.long 0x80, 0x2290, 0x7710, 0x8c30, 0x88, 0x2298, 0x7718, 0x8c38
.long 0x90, 0x22a0, 0x7720, 0x8c40, 0x98, 0x22a8, 0x7728, 0x8c48
.long 0xc0, 0x27d8, 0x7c58, 0x9178, 0xc8, 0x27e0, 0x7c60, 0x9180
.long 0xd0, 0x27e8, 0x7c68, 0x9188, 0xd8, 0x27f0, 0x7c70, 0x9190
.long 0x20, 0x1820, 0x6ca0, 0x81c0, 0x28, 0x1828, 0x6ca8, 0x81c8
.long 0x30, 0x1830, 0x6cb0, 0x81d0, 0x38, 0x1838, 0x6cb8, 0x81d8
.long 0x60, 0x1d68, 0x71e8, 0x8708, 0x68, 0x1d70, 0x71f0, 0x8710
.long 0x70, 0x1d78, 0x71f8, 0x8718, 0x78, 0x1d80, 0x7200, 0x8720
.long 0xa0, 0x22b0, 0x7730, 0x8c50, 0xa8, 0x22b8, 0x7738, 0x8c58
.long 0xb0, 0x22c0, 0x7740, 0x8c60, 0xb8, 0x22c8, 0x7748, 0x8c68
.long 0xe0, 0x27f8, 0x7c78, 0x9198, 0xe8, 0x2800, 0x7c80, 0x91a0
.long 0xf0, 0x2808, 0x7c88, 0x91a8, 0xf8, 0x2810, 0x7c90, 0x91b0
.long 0x200, 0x4240, 0x96c0, 0x9c08, 0x208, 0x4248, 0x96c8, 0x9c10
.long 0x210, 0x4250, 0x96d0, 0x9c18, 0x218, 0x4258, 0x96d8, 0x9c20
.long 0x240, 0x4788, 0x9c08, 0x9c08, 0x248, 0x4790, 0x9c10, 0x9c10
.long 0x250, 0x4798, 0x9c18, 0x9c18, 0x258, 0x47a0, 0x9c20, 0x9c20
.long 0x280, 0x4cd0, 0x9c08, 0x9c08, 0x288, 0x4cd8, 0x9c10, 0x9c10
.long 0x290, 0x4ce0, 0x9c18, 0x9c18, 0x298, 0x4ce8, 0x9c20, 0x9c20
.long 0x2c0, 0x5218, 0x9c08, 0x9c08, 0x2c8, 0x5220, 0x9c10, 0x9c10
.long 0x2d0, 0x5228, 0x9c18, 0x9c18, 0x2d8, 0x5230, 0x9c20, 0x9c20
.long 0x220, 0x4260, 0x96e0, 0x9c28, 0x228, 0x4268, 0x96e8, 0x9c30
.long 0x230, 0x4270, 0x96f0, 0x9c38, 0x238, 0x4278, 0x96f8, 0x9c40
.long 0x260, 0x47a8, 0x9c28, 0x9c28, 0x268, 0x47b0, 0x9c30, 0x9c30
.long 0x270, 0x47b8, 0x9c38, 0x9c38, 0x278, 0x47c0, 0x9c40, 0x9c40
.long 0x2a0, 0x4cf0, 0x9c28, 0x9c28, 0x2a8, 0x4cf8, 0x9c30, 0x9c30
.long 0x2b0, 0x4d00, 0x9c38, 0x9c38, 0x2b8, 0x4d08, 0x9c40, 0x9c40
.long 0x2e0, 0x5238, 0x9c28, 0x9c28, 0x2e8, 0x5240, 0x9c30, 0x9c30
.long 0x2f0, 0x5248, 0x9c38, 0x9c38, 0x2f8, 0x5250, 0x9c40, 0x9c40
.long 0xaae0, 0xa680, 0xa900, 0xaae0, 0xaae8, 0xa688, 0xa908, 0xaae8
.long 0xaaf0, 0xa690, 0xa910, 0xaaf0, 0xaaf8, 0xa698, 0xa918, 0xaaf8
.long 0xaa40, 0xa860, 0xa9a0, 0xaa40, 0xaa48, 0xa868, 0xa9a8, 0xaa48
.long 0xaa50, 0xa870, 0xa9b0, 0xaa50, 0xaa58, 0xa878, 0xa9b8, 0xaa58
.long 0xa400, 0xa7c0, 0xa540, 0xa400, 0xa408, 0xa7c8, 0xa548, 0xa408
.long 0xa410, 0xa7d0, 0xa550, 0xa410, 0xa418, 0xa7d8, 0xa558, 0xa418
.long 0xa4a0, 0xa720, 0xa5e0, 0xa4a0, 0xa4a8, 0xa728, 0xa5e8, 0xa4a8
.long 0xa4b0, 0xa730, 0xa5f0, 0xa4b0, 0xa4b8, 0xa738, 0xa5f8, 0xa4b8
.long 0xb260, 0xb4e0, 0xb6c0, 0xb260, 0xb268, 0xb4e8, 0xb6c8, 0xb268
.long 0xb270, 0xb4f0, 0xb6d0, 0xb270, 0xb278, 0xb4f8, 0xb6d8, 0xb278
.long 0xb1c0, 0xb300, 0xb760, 0xb1c0, 0xb1c8, 0xb308, 0xb768, 0xb1c8
.long 0xb1d0, 0xb310, 0xb770, 0xb1d0, 0xb1d8, 0xb318, 0xb778, 0xb1d8
.long 0xb580, 0xb440, 0xb080, 0xb580, 0xb588, 0xb448, 0xb088, 0xb588
.long 0xb590, 0xb450, 0xb090, 0xb590, 0xb598, 0xb458, 0xb098, 0xb598
.long 0xb620, 0xb3a0, 0xb120, 0xb620, 0xb628, 0xb3a8, 0xb128, 0xb628
.long 0xb630, 0xb3b0, 0xb130, 0xb630, 0xb638, 0xb3b8, 0xb138, 0xb638
.long 0xa900, 0xa400, 0xaae0, 0xb620, 0xa908, 0xa408, 0xaae8, 0xb628
.long 0xa910, 0xa410, 0xaaf0, 0xb630, 0xa918, 0xa418, 0xaaf8, 0xb638
.long 0xa9a0, 0xa4a0, 0xab80, 0xb800, 0xa9a8, 0xa4a8, 0xab88, 0xb808
.long 0xa9b0, 0xa4b0, 0xab90, 0xb810, 0xa9b8, 0xa4b8, 0xab98, 0xb818
.long 0xaa40, 0xa680, 0xa860, 0xb3a0, 0xaa48, 0xa688, 0xa868, 0xb3a8
.long 0xaa50, 0xa690, 0xa870, 0xb3b0, 0xaa58, 0xa698, 0xa878, 0xb3b8
.long 0xa720, 0xa540, 0xa7c0, 0xb1c0, 0xa728, 0xa548, 0xa7c8, 0xb1c8
.long 0xa730, 0xa550, 0xa7d0, 0xb1d0, 0xa738, 0xa558, 0xa7d8, 0xb1d8
.long 0xa5e0, 0xaae0, 0xa400, 0xb080, 0xa5e8, 0xaae8, 0xa408, 0xb088
.long 0xa5f0, 0xaaf0, 0xa410, 0xb090, 0xa5f8, 0xaaf8, 0xa418, 0xb098
.long 0xa7c0, 0xa540, 0xa720, 0xb760, 0xa7c8, 0xa548, 0xa728, 0xb768
.long 0xa7d0, 0xa550, 0xa730, 0xb770, 0xa7d8, 0xa558, 0xa738, 0xb778
.long 0xa860, 0xa680, 0xaa40, 0xb440, 0xa868, 0xa688, 0xaa48, 0xb448
.long 0xa870, 0xa690, 0xaa50, 0xb450, 0xa878, 0xa698, 0xaa58, 0xb458
.long 0xab80, 0xa4a0, 0xa9a0, 0xb4e0, 0xab88, 0xa4a8, 0xa9a8, 0xb4e8
.long 0xab90, 0xa4b0, 0xa9b0, 0xb4f0, 0xab98, 0xa4b8, 0xa9b8, 0xb4f8
.long 0xa680, 0xa900, 0xab80, 0xa4a0, 0xa688, 0xa908, 0xab88, 0xa4a8
.long 0xa690, 0xa910, 0xab90, 0xa4b0, 0xa698, 0xa918, 0xab98, 0xa4b8
.long 0xa860, 0xa9a0, 0xb1c0, 0xb440, 0xa868, 0xa9a8, 0xb1c8, 0xb448
.long 0xa870, 0xa9b0, 0xb1d0, 0xb450, 0xa878, 0xa9b8, 0xb1d8, 0xb458
.long 0xa7c0, 0xa540, 0xab80, 0xa4a0, 0xa7c8, 0xa548, 0xab88, 0xa4a8
.long 0xa7d0, 0xa550, 0xab90, 0xa4b0, 0xa7d8, 0xa558, 0xab98, 0xa4b8
.long 0xa720, 0xa5e0, 0xb1c0, 0xb440, 0xa728, 0xa5e8, 0xb1c8, 0xb448
.long 0xa730, 0xa5f0, 0xb1d0, 0xb450, 0xa738, 0xa5f8, 0xb1d8, 0xb458
.long 0xb4e0, 0xb6c0, 0xb800, 0xa860, 0xb4e8, 0xb6c8, 0xb808, 0xa868
.long 0xb4f0, 0xb6d0, 0xb810, 0xa870, 0xb4f8, 0xb6d8, 0xb818, 0xa878
.long 0xb300, 0xb760, 0xa540, 0xa900, 0xb308, 0xb768, 0xa548, 0xa908
.long 0xb310, 0xb770, 0xa550, 0xa910, 0xb318, 0xb778, 0xa558, 0xa918
.long 0xb440, 0xb080, 0xb800, 0xa860, 0xb448, 0xb088, 0xb808, 0xa868
.long 0xb450, 0xb090, 0xb810, 0xa870, 0xb458, 0xb098, 0xb818, 0xa878
.long 0xb3a0, 0xb120, 0xa540, 0xa900, 0xb3a8, 0xb128, 0xa548, 0xa908
.long 0xb3b0, 0xb130, 0xa550, 0xa910, 0xb3b8, 0xb138, 0xa558, 0xa918
.long 0xb120, 0xb580, 0xb080, 0xb300, 0xb128, 0xb588, 0xb088, 0xb308
.long 0xb130, 0xb590, 0xb090, 0xb310, 0xb138, 0xb598, 0xb098, 0xb318
.long 0xb6c0, 0xb4e0, 0xaa40, 0xb6c0, 0xb6c8, 0xb4e8, 0xaa48, 0xb6c8
.long 0xb6d0, 0xb4f0, 0xaa50, 0xb6d0, 0xb6d8, 0xb4f8, 0xaa58, 0xb6d8
.long 0xb300, 0xb440, 0xb080, 0xb300, 0xb308, 0xb448, 0xb088, 0xb308
.long 0xb310, 0xb450, 0xb090, 0xb310, 0xb318, 0xb458, 0xb098, 0xb318
.long 0xb260, 0xb760, 0xaa40, 0xb6c0, 0xb268, 0xb768, 0xaa48, 0xb6c8
.long 0xb270, 0xb770, 0xaa50, 0xb6d0, 0xb278, 0xb778, 0xaa58, 0xb6d8
.long 0xb580, 0xb120, 0xb620, 0xa680, 0xb588, 0xb128, 0xb628, 0xa688
.long 0xb590, 0xb130, 0xb630, 0xa690, 0xb598, 0xb138, 0xb638, 0xa698
.long 0xb260, 0xb1c0, 0xa7c0, 0xa680, 0xb268, 0xb1c8, 0xa7c8, 0xa688
.long 0xb270, 0xb1d0, 0xa7d0, 0xa690, 0xb278, 0xb1d8, 0xa7d8, 0xa698
.long 0xb300, 0xb3a0, 0xb620, 0xb300, 0xb308, 0xb3a8, 0xb628, 0xb308
.long 0xb310, 0xb3b0, 0xb630, 0xb310, 0xb318, 0xb3b8, 0xb638, 0xb318
.long 0xb6c0, 0xb800, 0xa7c0, 0xb300, 0xb6c8, 0xb808, 0xa7c8, 0xb308
.long 0xb6d0, 0xb810, 0xa7d0, 0xb310, 0xb6d8, 0xb818, 0xa7d8, 0xb318
.long 0x0, 0x200, 0x0, 0x3f803f80, 0x8, 0x208, 0x0, 0x3f803f80
.long 0x10, 0x210, 0x0, 0x3f803f80, 0x18, 0x218, 0x0, 0x3f803f80
.long 0x420, 0x620, 0x0, 0x3f803f80, 0x428, 0x628, 0x0, 0x3f803f80
.long 0x430, 0x630, 0x0, 0x3f803f80, 0x438, 0x638, 0x0, 0x3f803f80
.long 0x840, 0xa40, 0x10, 0x3f803f80, 0x848, 0xa48, 0x10, 0x3f803f80
.long 0x850, 0xa50, 0x10, 0x3f803f80, 0x858, 0xa58, 0x10, 0x3f803f80
.long 0xc60, 0xe60, 0x10, 0x3f803f80, 0xc68, 0xe68, 0x10, 0x3f803f80
.long 0xc70, 0xe70, 0x10, 0x3f803f80, 0xc78, 0xe78, 0x10, 0x3f803f80
.long 0x80, 0x280, 0x20, 0x3f803f80, 0x88, 0x288, 0x20, 0x3f803f80
.long 0x90, 0x290, 0x20, 0x3f803f80, 0x98, 0x298, 0x20, 0x3f803f80
.long 0x4a0, 0x6a0, 0x20, 0x3f803f80, 0x4a8, 0x6a8, 0x20, 0x3f803f80
.long 0x4b0, 0x6b0, 0x20, 0x3f803f80, 0x4b8, 0x6b8, 0x20, 0x3f803f80
.long 0x8c0, 0xac0, 0x30, 0x3f803f80, 0x8c8, 0xac8, 0x30, 0x3f803f80
.long 0x8d0, 0xad0, 0x30, 0x3f803f80, 0x8d8, 0xad8, 0x30, 0x3f803f80
.long 0xce0, 0xee0, 0x30, 0x3f803f80, 0xce8, 0xee8, 0x30, 0x3f803f80
.long 0xcf0, 0xef0, 0x30, 0x3f803f80, 0xcf8, 0xef8, 0x30, 0x3f803f80
.long 0x100, 0x300, 0x40, 0x0, 0x108, 0x308, 0x40, 0x0
.long 0x110, 0x310, 0x40, 0x0, 0x118, 0x318, 0x40, 0x0
.long 0x520, 0x720, 0x40, 0x0, 0x528, 0x728, 0x40, 0x0
.long 0x530, 0x730, 0x40, 0x0, 0x538, 0x738, 0x40, 0x0
.long 0x940, 0xb40, 0x50, 0x0, 0x948, 0xb48, 0x50, 0x0
.long 0x950, 0xb50, 0x50, 0x0, 0x958, 0xb58, 0x50, 0x0
.long 0xd60, 0xf60, 0x50, 0x0, 0xd68, 0xf68, 0x50, 0x0
.long 0xd70, 0xf70, 0x50, 0x0, 0xd78, 0xf78, 0x50, 0x0
.long 0x180, 0xf60, 0x60, 0x0, 0x188, 0xf68, 0x60, 0x0
.long 0x190, 0xf70, 0x60, 0x0, 0x198, 0xf78, 0x60, 0x0
.long 0x5a0, 0xf60, 0x60, 0x0, 0x5a8, 0xf68, 0x60, 0x0
.long 0x5b0, 0xf70, 0x60, 0x0, 0x5b8, 0xf78, 0x60, 0x0
.long 0x9c0, 0xf60, 0x70, 0x0, 0x9c8, 0xf68, 0x70, 0x0
.long 0x9d0, 0xf70, 0x70, 0x0, 0x9d8, 0xf78, 0x70, 0x0
.long 0xde0, 0xf60, 0x70, 0x0, 0xde8, 0xf68, 0x70, 0x0
.long 0xdf0, 0xf70, 0x70, 0x0, 0xdf8, 0xf78, 0x70, 0x0
.long 0xffff, 0x0, 0x0, 0x0, 0x0, 0x0, 0xffff, 0x0
.long 0x0, 0x0, 0x0, 0x0, 0x0, 0x0, 0x0, 0x0
.long 0x0, 0x0, 0x0, 0x0, 0x0, 0x0, 0x0, 0x0
.long 0x0, 0x0, 0x0, 0x0, 0x0, 0x0, 0x0, 0x0
.long 0xffff0000, 0x0, 0x0, 0x0, 0x0, 0x0, 0xffff0000, 0x0
.long 0x0, 0x0, 0x0, 0x0, 0x0, 0x0, 0x0, 0x0
.long 0x0, 0x0, 0x0, 0x0, 0x0, 0x0, 0x0, 0x0
.long 0x0, 0x0, 0x0, 0x0, 0x0, 0x0, 0x0, 0x0
.long 0x0, 0xffff, 0x0, 0x0, 0x0, 0x0, 0x0, 0xffff
.long 0x0, 0x0, 0x0, 0x0, 0x0, 0x0, 0x0, 0x0
.long 0x0, 0x0, 0x0, 0x0, 0x0, 0x0, 0x0, 0x0
.long 0x0, 0x0, 0x0, 0x0, 0x0, 0x0, 0x0, 0x0
.long 0x0, 0xffff0000, 0x0, 0x0, 0x0, 0x0, 0x0, 0xffff0000
.long 0x0, 0x0, 0x0, 0x0, 0x0, 0x0, 0x0, 0x0
.long 0x0, 0x0, 0x0, 0x0, 0x0, 0x0, 0x0, 0x0
.long 0x0, 0x0, 0x0, 0x0, 0x0, 0x0, 0x0, 0x0
.long 0x0, 0x0, 0x0, 0x0, 0x0, 0x0, 0x0, 0x0
.long 0xffff, 0x0, 0x0, 0x0, 0x0, 0x0, 0xffff, 0x0
.long 0x0, 0x0, 0x0, 0x0, 0x0, 0x0, 0x0, 0x0
.long 0x0, 0x0, 0x0, 0x0, 0x0, 0x0, 0x0, 0x0
.long 0x0, 0x0, 0x0, 0x0, 0x0, 0x0, 0x0, 0x0
.long 0xffff0000, 0x0, 0x0, 0x0, 0x0, 0x0, 0xffff0000, 0x0
.long 0x0, 0x0, 0x0, 0x0, 0x0, 0x0, 0x0, 0x0
.long 0x0, 0x0, 0x0, 0x0, 0x0, 0x0, 0x0, 0x0
.long 0x0, 0x0, 0x0, 0x0, 0x0, 0x0, 0x0, 0x0
.long 0x0, 0xffff, 0x0, 0x0, 0x0, 0x0, 0x0, 0xffff
.long 0x0, 0x0, 0x0, 0x0, 0x0, 0x0, 0x0, 0x0
.long 0x0, 0x0, 0x0, 0x0, 0x0, 0x0, 0x0, 0x0
.long 0x0, 0x0, 0x0, 0x0, 0x0, 0x0, 0x0, 0x0
.long 0x0, 0xffff0000, 0x0, 0x0, 0x0, 0x0, 0x0, 0xffff0000
.long 0x0, 0x0, 0x0, 0x0, 0x0, 0x0, 0x0, 0x0
.long 0x0, 0x0, 0x0, 0x0, 0x0, 0x0, 0x0, 0x0
.long 0x0, 0x0, 0x0, 0x0, 0x0, 0x0, 0x0, 0x0
.long 0x0, 0x0, 0x0, 0x0, 0x0, 0x0, 0x0, 0x0
.long 0x0, 0x0, 0xffff, 0x0, 0x0, 0x0, 0x0, 0x0
.long 0x0, 0x0, 0x0, 0x0, 0xffff, 0x0, 0x0, 0x0
.long 0x0, 0x0, 0x0, 0x0, 0x0, 0x0, 0x0, 0x0
.long 0x0, 0x0, 0x0, 0x0, 0x0, 0x0, 0x0, 0x0
.long 0x0, 0x0, 0xffff0000, 0x0, 0x0, 0x0, 0x0, 0x0
.long 0x0, 0x0, 0x0, 0x0, 0xffff0000, 0x0, 0x0, 0x0
.long 0x0, 0x0, 0x0, 0x0, 0x0, 0x0, 0x0, 0x0
.long 0x0, 0x0, 0x0, 0x0, 0x0, 0x0, 0x0, 0x0
.long 0x0, 0x0, 0x0, 0xffff, 0x0, 0x0, 0x0, 0x0
.long 0x0, 0x0, 0x0, 0x0, 0x0, 0xffff, 0x0, 0x0
.long 0x0, 0x0, 0x0, 0x0, 0x0, 0x0, 0x0, 0x0
.long 0x0, 0x0, 0x0, 0x0, 0x0, 0x0, 0x0, 0x0
.long 0x0, 0x0, 0x0, 0xffff0000, 0x0, 0x0, 0x0, 0x0
.long 0x0, 0x0, 0x0, 0x0, 0x0, 0xffff0000, 0x0, 0x0
.long 0x0, 0x0, 0x0, 0x0, 0x0, 0x0, 0x0, 0x0
.long 0x0, 0x0, 0x0, 0x0, 0x0, 0x0, 0x0, 0x0
.long 0x0, 0x0, 0x0, 0x0, 0xffff, 0x0, 0x0, 0x0
.long 0x0, 0x0, 0x0, 0x0, 0x0, 0x0, 0x0, 0x0
.long 0x0, 0x0, 0x0, 0x0, 0x0, 0x0, 0x0, 0x0
.long 0x0, 0x0, 0x0, 0x0, 0x0, 0x0, 0x0, 0x0
.long 0x0, 0x0, 0x0, 0x0, 0xffff0000, 0x0, 0x0, 0x0
.long 0x0, 0x0, 0x0, 0x0, 0x0, 0x0, 0x0, 0x0
.long 0x0, 0x0, 0x0, 0x0, 0x0, 0x0, 0x0, 0x0
.long 0x0, 0x0, 0x0, 0x0, 0x0, 0x0, 0x0, 0x0
.long 0x0, 0x0, 0x0, 0x0, 0x0, 0x0, 0x0, 0x0
.long 0x0, 0x0, 0x0, 0x0, 0x0, 0x0, 0x0, 0x0
.long 0x0, 0x0, 0x0, 0x0, 0x0, 0x0, 0x0, 0x0
.long 0x0, 0x0, 0x0, 0x0, 0x0, 0x0, 0x0, 0x0
.long 0x0, 0x0, 0x0, 0x0, 0x0, 0x0, 0x0, 0x0
.long 0x0, 0x0, 0x0, 0x0, 0x0, 0x0, 0x0, 0x0
.long 0x14d40, 0x14d40, 0x0, 0x0, 0x14e10, 0x14e10, 0x20, 0x20
.long 0x14ee0, 0x14ee0, 0x100000, 0x100000, 0x14fb0, 0x14fb0, 0x100020, 0x100020
.long 0x15080, 0x15080, 0x40, 0x40, 0x15150, 0x15150, 0x60, 0x60
.long 0x15220, 0x15220, 0x100040, 0x100040, 0x100000, 0x100000, 0x100060, 0x100060
.long 0x14d74, 0x14d74, 0x80, 0x80, 0x14e44, 0x14e44, 0xa0, 0xa0
.long 0x14f14, 0x14f14, 0x100080, 0x100080, 0x14fe4, 0x14fe4, 0x1000a0, 0x1000a0
.long 0x150b4, 0x150b4, 0xc0, 0xc0, 0x15184, 0x15184, 0xe0, 0xe0
.long 0x15254, 0x15254, 0x1000c0, 0x1000c0, 0x100000, 0x100000, 0x1000e0, 0x1000e0
.long 0x14da8, 0x14da8, 0x8, 0x100, 0x14e78, 0x14e78, 0x28, 0x120
.long 0x14f48, 0x14f48, 0x100008, 0x100100, 0x15018, 0x15018, 0x100028, 0x100120
.long 0x150e8, 0x150e8, 0x48, 0x140, 0x151b8, 0x151b8, 0x68, 0x160
.long 0x100000, 0x100000, 0x100048, 0x100140, 0x100000, 0x100000, 0x100068, 0x100160
.long 0x14ddc, 0x14ddc, 0x88, 0x180, 0x14eac, 0x14eac, 0xa8, 0x1a0
.long 0x14f7c, 0x14f7c, 0x100088, 0x100180, 0x1504c, 0x1504c, 0x1000a8, 0x1001a0
.long 0x1511c, 0x1511c, 0xc8, 0x1c0, 0x151ec, 0x151ec, 0xe8, 0x1e0
.long 0x100000, 0x100000, 0x1000c8, 0x1001c0, 0x100000, 0x100000, 0x1000e8, 0x1001e0
.long 0x17d40, 0x114d40, 0x100, 0x200, 0x17e10, 0x114e10, 0x120, 0x220
.long 0x17ee0, 0x114ee0, 0x100100, 0x100200, 0x17fb0, 0x114fb0, 0x100120, 0x100220
.long 0x18080, 0x115080, 0x140, 0x240, 0x18150, 0x115150, 0x160, 0x260
.long 0x18220, 0x115220, 0x100140, 0x100240, 0x103000, 0x200000, 0x100160, 0x100260
.long 0x17d74, 0x114d74, 0x180, 0x280, 0x17e44, 0x114e44, 0x1a0, 0x2a0
.long 0x17f14, 0x114f14, 0x100180, 0x100280, 0x17fe4, 0x114fe4, 0x1001a0, 0x1002a0
.long 0x180b4, 0x1150b4, 0x1c0, 0x2c0, 0x18184, 0x115184, 0x1e0, 0x2e0
.long 0x18254, 0x115254, 0x1001c0, 0x1002c0, 0x103000, 0x200000, 0x1001e0, 0x1002e0
.long 0x17da8, 0x114da8, 0x108, 0x300, 0x17e78, 0x114e78, 0x128, 0x320
.long 0x17f48, 0x114f48, 0x100108, 0x100300, 0x18018, 0x115018, 0x100128, 0x100320
.long 0x180e8, 0x1150e8, 0x148, 0x340, 0x181b8, 0x1151b8, 0x168, 0x360
.long 0x103000, 0x200000, 0x100148, 0x100340, 0x103000, 0x200000, 0x100168, 0x100360
.long 0x17ddc, 0x114ddc, 0x188, 0x380, 0x17eac, 0x114eac, 0x1a8, 0x3a0
.long 0x17f7c, 0x114f7c, 0x100188, 0x100380, 0x1804c, 0x11504c, 0x1001a8, 0x1003a0
.long 0x1811c, 0x11511c, 0x1c8, 0x3c0, 0x181ec, 0x1151ec, 0x1e8, 0x3e0
.long 0x103000, 0x200000, 0x1001c8, 0x1003c0, 0x103000, 0x200000, 0x1001e8, 0x1003e0
.long 0xa400, 0xd00, 0x0, 0x14d40, 0xa440, 0xd00, 0x0, 0x14d80
.long 0xa480, 0xd00, 0x1, 0x14dd0, 0xa4c0, 0xd00, 0x1, 0x14e10
.long 0xa500, 0xd00, 0x2, 0x14e60, 0xa540, 0xd00, 0x2, 0x14ea0
.long 0xa580, 0xd00, 0x3, 0x14ef0, 0xa5c0, 0xd00, 0x3, 0x14f30
.long 0xa600, 0xd00, 0x4, 0x14f40, 0xa640, 0xd00, 0x4, 0x14f80
.long 0xa680, 0xd00, 0x5, 0x14fd0, 0xa6c0, 0xd00, 0x5, 0x15010
.long 0xa700, 0xd00, 0x6, 0x15060, 0xa740, 0xd00, 0x6, 0x150a0
.long 0xa780, 0xd00, 0x7, 0x150f0, 0xa7c0, 0xd00, 0x7, 0x15130
.long 0xa800, 0xd00, 0x8, 0x15140, 0xa840, 0xd00, 0x8, 0x15180
.long 0xa880, 0xd00, 0x9, 0x151d0, 0xa8c0, 0xd00, 0x9, 0x15210
.long 0xa900, 0xd00, 0xa, 0x15260, 0xa940, 0xd00, 0xa, 0x152a0
.long 0xa980, 0xd00, 0xb, 0x152f0, 0xa9c0, 0xd00, 0xb, 0x15330
.long 0xaa00, 0xd00, 0xc, 0x15340, 0xaa40, 0xd00, 0xc, 0x15380
.long 0x1f680, 0x40, 0xd, 0x153d0, 0x100000, 0xd00, 0xd, 0x15410
.long 0x100000, 0xd00, 0xe, 0x15460, 0x100000, 0xd00, 0xe, 0x154a0
.long 0x100000, 0xd00, 0xf, 0x154f0, 0x100000, 0xd00, 0xf, 0x15530
.long 0xa400, 0xd00, 0x2, 0x14d60, 0xa440, 0xd00, 0x2, 0x14da0
.long 0xa480, 0xd00, 0x3, 0x14df0, 0xa4c0, 0xd00, 0x3, 0x14e30
.long 0xa500, 0xd00, 0x4, 0x14e40, 0xa540, 0xd00, 0x4, 0x14e80
.long 0xa580, 0xd00, 0x5, 0x14ed0, 0xa5c0, 0xd00, 0x5, 0x14f10
.long 0xa600, 0xd00, 0x6, 0x14f60, 0xa640, 0xd00, 0x6, 0x14fa0
.long 0xa680, 0xd00, 0x7, 0x14ff0, 0xa6c0, 0xd00, 0x7, 0x15030
.long 0xa700, 0xd00, 0x8, 0x15040, 0xa740, 0xd00, 0x8, 0x15080
.long 0xa780, 0xd00, 0x9, 0x150d0, 0xa7c0, 0xd00, 0x9, 0x15110
.long 0xa800, 0xd00, 0xa, 0x15160, 0xa840, 0xd00, 0xa, 0x151a0
.long 0xa880, 0xd00, 0xb, 0x151f0, 0xa8c0, 0xd00, 0xb, 0x15230
.long 0xa900, 0xd00, 0xc, 0x15240, 0xa940, 0xd00, 0xc, 0x15280
.long 0xa980, 0xd00, 0xd, 0x152d0, 0xa9c0, 0xd00, 0xd, 0x15310
.long 0xaa00, 0xd00, 0xe, 0x15360, 0xaa40, 0xd00, 0xe, 0x153a0
.long 0x1f680, 0x40, 0xf, 0x153f0, 0x100000, 0xd00, 0xf, 0x15430
.long 0x100000, 0xd00, 0x10, 0x15440, 0x100000, 0xd00, 0x10, 0x15480
.long 0x100000, 0xd00, 0x11, 0x154d0, 0x100000, 0xd00, 0x11, 0x15510
.long 0x1f690, 0x1f890, 0x1f9c0, 0x1f9e0, 0x1f698, 0x1f898, 0x1f9c8, 0x1f9e8
.long 0x1f680, 0x1f880, 0x1f9d0, 0x1f9f0, 0x1f688, 0x1f888, 0x1f9d8, 0x100000
.long 0x1fd20, 0x1ff20, 0x1f9c2, 0x1f9e2, 0x1fd28, 0x1ff28, 0x1f9ca, 0x1f9ea
.long 0x1fd30, 0x1ff30, 0x1f9d2, 0x1f9f2, 0x1fd38, 0x1ff38, 0x1f9da, 0x100000
.long 0x1f6f0, 0x1f8f0, 0x1f9c4, 0x1f9e4, 0x1f6f8, 0x1f8f8, 0x1f9cc, 0x1f9ec
.long 0x1f6e0, 0x1f8e0, 0x1f9d4, 0x100000, 0x1f6e8, 0x1f8e8, 0x1f9dc, 0x100000
.long 0x1fd40, 0x1ff40, 0x1f9c6, 0x1f9e6, 0x1fd48, 0x1ff48, 0x1f9ce, 0x1f9ee
.long 0x1fd50, 0x1ff50, 0x1f9d6, 0x100000, 0x1fd58, 0x1ff58, 0x1f9de, 0x100000
.long 0x1f710, 0x1f910, 0x1f9c0, 0x1f9e0, 0x1f718, 0x1f918, 0x1f9c8, 0x1f9e8
.long 0x1f700, 0x1f900, 0x1f9d0, 0x1f9f0, 0x1f708, 0x1f908, 0x1f9d8, 0x100000
.long 0x1fda0, 0x1ffa0, 0x1f9c2, 0x1f9e2, 0x1fda8, 0x1ffa8, 0x1f9ca, 0x1f9ea
.long 0x1fdb0, 0x1ffb0, 0x1f9d2, 0x1f9f2, 0x1fdb8, 0x1ffb8, 0x1f9da, 0x100000
.long 0x1f770, 0x1f970, 0x1f9c4, 0x1f9e4, 0x1f778, 0x1f978, 0x1f9cc, 0x1f9ec
.long 0x1f760, 0x1f960, 0x1f9d4, 0x100000, 0x1f768, 0x1f968, 0x1f9dc, 0x100000
.long 0x1fdc0, 0x1ffc0, 0x1f9c6, 0x1f9e6, 0x1fdc8, 0x1ffc8, 0x1f9ce, 0x1f9ee
.long 0x1fdd0, 0x1ffd0, 0x1f9d6, 0x100000, 0x1fdd8, 0x1ffd8, 0x1f9de, 0x100000
.long 0x1f790, 0x1f990, 0x1f9c0, 0x1f9e0, 0x1f798, 0x1f998, 0x1f9c8, 0x1f9e8
.long 0x1f780, 0x1f980, 0x1f9d0, 0x1f9f0, 0x1f788, 0x1f988, 0x1f9d8, 0x100000
.long 0x1fe20, 0x20020, 0x1f9c2, 0x1f9e2, 0x1fe28, 0x20028, 0x1f9ca, 0x1f9ea
.long 0x1fe30, 0x20030, 0x1f9d2, 0x1f9f2, 0x1fe38, 0x20038, 0x1f9da, 0x100000
.long 0x1f7f0, 0x14d00, 0x1f9c4, 0x1f9e4, 0x1f7f8, 0x14d08, 0x1f9cc, 0x1f9ec
.long 0x1f7e0, 0x14d10, 0x1f9d4, 0x100000, 0x1f7e8, 0x14d18, 0x1f9dc, 0x100000
.long 0x1fe40, 0x14d00, 0x1f9c6, 0x1f9e6, 0x1fe48, 0x14d08, 0x1f9ce, 0x1f9ee
.long 0x1fe50, 0x14d10, 0x1f9d6, 0x100000, 0x1fe58, 0x14d18, 0x1f9de, 0x100000
.long 0x1f810, 0x14d00, 0x1f9c0, 0x1f9e0, 0x1f818, 0x14d08, 0x1f9c8, 0x1f9e8
.long 0x1f800, 0x14d10, 0x1f9d0, 0x1f9f0, 0x1f808, 0x14d18, 0x1f9d8, 0x100000
.long 0x1fea0, 0x14d00, 0x1f9c2, 0x1f9e2, 0x1fea8, 0x14d08, 0x1f9ca, 0x1f9ea
.long 0x1feb0, 0x14d10, 0x1f9d2, 0x1f9f2, 0x1feb8, 0x14d18, 0x1f9da, 0x100000
.long 0x1f870, 0x14d00, 0x1f9c4, 0x1f9e4, 0x1f878, 0x14d08, 0x1f9cc, 0x1f9ec
.long 0x1f860, 0x14d10, 0x1f9d4, 0x100000, 0x1f868, 0x14d18, 0x1f9dc, 0x100000
.long 0x1fec0, 0x14d00, 0x1f9c6, 0x1f9e6, 0x1fec8, 0x14d08, 0x1f9ce, 0x1f9ee
.long 0x1fed0, 0x14d10, 0x1f9d6, 0x100000, 0x1fed8, 0x14d18, 0x1f9de, 0x100000
.long 0x0, 0x4444, 0x0, 0xa400, 0x10, 0xeeee, 0x4, 0xa404
.long 0x20, 0x4444, 0x8, 0xa408, 0x30, 0xeeee, 0xc, 0xa40c
.long 0x40, 0x4444, 0x10, 0xa410, 0x50, 0xeeee, 0x14, 0xa414
.long 0x60, 0x4444, 0x18, 0xa418, 0x70, 0xeeee, 0x1c, 0xa41c
.long 0x0, 0x4444, 0x20, 0xa420, 0x10, 0xeeee, 0x24, 0xa424
.long 0x20, 0x4444, 0x28, 0xa428, 0x30, 0xeeee, 0x2c, 0xa42c
.long 0x40, 0x4444, 0x30, 0xa430, 0x50, 0xeeee, 0x34, 0xa434
.long 0x60, 0x4444, 0x38, 0xa438, 0x70, 0xeeee, 0x3c, 0xa43c
.long 0x0, 0x4444, 0x40, 0xa440, 0x10, 0xeeee, 0x44, 0xa444
.long 0x20, 0x4444, 0x48, 0xa448, 0x30, 0xeeee, 0x4c, 0xa44c
.long 0x40, 0x4444, 0x50, 0xa450, 0x50, 0xeeee, 0x54, 0xa454
.long 0x60, 0x4444, 0x58, 0xa458, 0x70, 0xeeee, 0x5c, 0xa45c
.long 0x0, 0x4444, 0x60, 0xa460, 0x10, 0xeeee, 0x64, 0xa464
.long 0x20, 0x4444, 0x68, 0xa468, 0x30, 0xeeee, 0x6c, 0xa46c
.long 0x40, 0x4444, 0x70, 0xa470, 0x50, 0xeeee, 0x74, 0xa474
.long 0x60, 0x4444, 0x78, 0xa478, 0x70, 0xeeee, 0x7c, 0xa47c
.long 0x0, 0x4444, 0x420, 0xb080, 0x10, 0xeeee, 0x424, 0xb084
.long 0x20, 0x4444, 0x428, 0xb088, 0x30, 0xeeee, 0x42c, 0xb08c
.long 0x40, 0x4444, 0x430, 0xb090, 0x50, 0xeeee, 0x434, 0xb094
.long 0x60, 0x4444, 0x438, 0xb098, 0x70, 0xeeee, 0x43c, 0xb09c
.long 0x0, 0x4444, 0x440, 0xb0a0, 0x10, 0xeeee, 0x444, 0xb0a4
.long 0x20, 0x4444, 0x448, 0xb0a8, 0x30, 0xeeee, 0x44c, 0xb0ac
.long 0x40, 0x4444, 0x450, 0xb0b0, 0x50, 0xeeee, 0x454, 0xb0b4
.long 0x60, 0x4444, 0x458, 0xb0b8, 0x70, 0xeeee, 0x45c, 0xb0bc
.long 0x0, 0x4444, 0x460, 0xb0c0, 0x10, 0xeeee, 0x464, 0xb0c4
.long 0x20, 0x4444, 0x468, 0xb0c8, 0x30, 0xeeee, 0x46c, 0xb0cc
.long 0x40, 0x4444, 0x470, 0xb0d0, 0x50, 0xeeee, 0x474, 0xb0d4
.long 0x60, 0x4444, 0x478, 0xb0d8, 0x70, 0xeeee, 0x47c, 0xb0dc
.long 0x0, 0x4444, 0x480, 0xb0e0, 0x10, 0xeeee, 0x484, 0xb0e4
.long 0x20, 0x4444, 0x488, 0xb0e8, 0x30, 0xeeee, 0x48c, 0xb0ec
.long 0x40, 0x4444, 0x490, 0xb0f0, 0x50, 0xeeee, 0x494, 0xb0f4
.long 0x60, 0x4444, 0x498, 0xb0f8, 0x70, 0xeeee, 0x49c, 0xb0fc
.long 0x1fa28, 0x1f9f4, 0x34, 0x14d00, 0x1fa28, 0x1f9f6, 0x74, 0x14d04
.long 0x1fa28, 0x1f9f8, 0xb4, 0x14d08, 0x1fa28, 0x1f9fa, 0xf4, 0x14d0c
.long 0x1fa28, 0x1f9fc, 0x134, 0x14d10, 0x1fa28, 0x1f9fe, 0x174, 0x14d14
.long 0x1fa28, 0x1fa00, 0x1b4, 0x14d18, 0x1fa28, 0x1fa02, 0x1f4, 0x14d1c
.long 0x1fa28, 0x1fa04, 0x234, 0x14d20, 0x1fa28, 0x1fa06, 0x274, 0x14d24
.long 0x1fa28, 0x1fa08, 0x2b4, 0x14d28, 0x1fa28, 0x1fa0a, 0x2f4, 0x14d2c
.long 0x1fa28, 0x1fa0c, 0x334, 0x14d30, 0x1fa28, 0x1fa0e, 0x374, 0x14d34
.long 0x1fa28, 0x1fa10, 0x3b4, 0x14d38, 0x1fa28, 0x1fa12, 0x3f4, 0x14d3c
.long 0x1fa28, 0x1fa14, 0x434, 0x14d00, 0x1fa28, 0x1fa16, 0x474, 0x14d04
.long 0x1fa28, 0x1fa18, 0x4b4, 0x14d08, 0x1fa28, 0x1fa1a, 0x4f4, 0x14d0c
.long 0x1fa28, 0x1fa1c, 0x534, 0x14d10, 0x1fa28, 0x1fa1e, 0x574, 0x14d14
.long 0x1fa28, 0x1fa20, 0x5b4, 0x14d18, 0x1fa28, 0x1fa22, 0x5f4, 0x14d1c
.long 0x1fa28, 0x1fa24, 0x634, 0x14d20, 0x1fa28, 0x1fa26, 0x674, 0x14d24
.long 0x1fa28, 0x1fa28, 0x6b4, 0x14d28, 0x1fa28, 0x1fa2a, 0x6f4, 0x14d2c
.long 0x1fa28, 0x1fa2c, 0x734, 0x14d30, 0x1fa28, 0x1fa2e, 0x774, 0x14d34
.long 0x1fa28, 0x1fa30, 0x7b4, 0x14d38, 0x1fa28, 0x1fa32, 0x7f4, 0x14d3c
.long 0x1fa38, 0x1fa34, 0x834, 0x14d00, 0x1fa38, 0x1fa36, 0x874, 0x14d04
.long 0x1fa38, 0x1fa38, 0x8b4, 0x14d08, 0x1fa38, 0x1fa3a, 0x8f4, 0x14d0c
.long 0x1fa38, 0x1fa3c, 0x934, 0x14d10, 0x1fa38, 0x1fa3e, 0x974, 0x14d14
.long 0x1fa38, 0x1fa40, 0x9b4, 0x14d18, 0x1fa38, 0x1fa42, 0x9f4, 0x14d1c
.long 0x1fa38, 0x1fa44, 0xa34, 0x14d20, 0x1fa38, 0x1fa46, 0xa74, 0x14d24
.long 0x1fa38, 0x1fa48, 0xab4, 0x14d28, 0x1fa38, 0x1fa4a, 0xaf4, 0x14d2c
.long 0x1fa38, 0x1fa4c, 0xb34, 0x14d30, 0x1fa38, 0x1fa4e, 0xb74, 0x14d34
.long 0x1fa38, 0x1fa50, 0xbb4, 0x14d38, 0x1fa38, 0x1fa52, 0xbf4, 0x14d3c
.long 0x1fa38, 0x1fa54, 0xc34, 0x14d00, 0x1fa38, 0x1fa56, 0xc74, 0x14d04
.long 0x1fa38, 0x1fa58, 0xcb4, 0x14d08, 0x1fa38, 0x1fa5a, 0xcf4, 0x14d0c
.long 0x1fa38, 0x1fa5c, 0xd34, 0x14d10, 0x1fa38, 0x1fa5e, 0xd74, 0x14d14
.long 0x1fa38, 0x1fa60, 0xdb4, 0x14d18, 0x1fa38, 0x1fa62, 0xdf4, 0x14d1c
.long 0x1fa38, 0x1fa64, 0xe34, 0x14d20, 0x1fa38, 0x1fa66, 0xe74, 0x14d24
.long 0x1fa38, 0x1fa68, 0xeb4, 0x14d28, 0x1fa38, 0x1fa6a, 0xef4, 0x14d2c
.long 0x1fa38, 0x1fa6c, 0xf34, 0x14d30, 0x1fa38, 0x1fa6e, 0xf74, 0x14d34
.long 0x1fa38, 0x1fa70, 0xfb4, 0x14d38, 0x1fa38, 0x1fa72, 0xff4, 0x14d3c
.long 0x0, 0x0, 0x0, 0x0, 0x0, 0x0, 0x0, 0x0
.long 0x0, 0x0, 0x0, 0x0, 0x0, 0x0, 0x0, 0x0
.long 0x0, 0x0, 0x0, 0x0, 0x0, 0x0, 0x0, 0x0
.long 0x0, 0x0, 0x0, 0x0, 0x0, 0x0, 0x0, 0x0
.long 0x0, 0x0, 0x0, 0x0, 0x0, 0x0, 0x0, 0x0
.long 0x0, 0x0, 0x0, 0x0, 0x0, 0x0, 0x0, 0x0
.long 0x0, 0x0, 0x0, 0x0, 0x0, 0x0, 0x0, 0x0
.long 0x0, 0x0, 0x0, 0x0, 0x0, 0x0, 0x0, 0x0
.long 0x0, 0x0, 0x0, 0x0, 0x0, 0x0, 0x0, 0x0
.long 0x0, 0x0, 0x0, 0x0, 0x0, 0x0, 0x0, 0x0
.long 0x0, 0x0, 0x0, 0x0, 0x0, 0x0, 0x0, 0x0
.long 0x0, 0x0, 0x0, 0x0, 0x0, 0x0, 0x0, 0x0
.long 0x0, 0x0, 0x0, 0x0, 0x0, 0x0, 0x0, 0x0
.long 0x0, 0x0, 0x0, 0x0, 0x0, 0x0, 0x0, 0x0
.long 0x0, 0x0, 0x0, 0x0, 0x0, 0x0, 0x0, 0x0
.long 0x0, 0x0, 0x0, 0x0, 0x0, 0x0, 0x0, 0x0
.long 0x0, 0x0, 0x0, 0x0, 0x0, 0x0, 0x0, 0x0
.long 0x0, 0x0, 0x0, 0x0, 0x0, 0x0, 0x0, 0x0
.long 0x0, 0x0, 0x0, 0x0, 0x0, 0x0, 0x0, 0x0
.long 0x0, 0x0, 0x0, 0x0, 0x0, 0x0, 0x0, 0x0
.long 0x0, 0x0, 0x0, 0x0, 0x0, 0x0, 0x0, 0x0
.long 0x0, 0x0, 0x0, 0x0, 0x0, 0x0, 0x0, 0x0
.long 0x0, 0x0, 0x0, 0x0, 0x0, 0x0, 0x0, 0x0
.long 0x0, 0x0, 0x0, 0x0, 0x0, 0x0, 0x0, 0x0
.long 0x0, 0x0, 0x0, 0x0, 0x0, 0x0, 0x0, 0x0
.long 0x0, 0x0, 0x0, 0x0, 0x0, 0x0, 0x0, 0x0
.long 0x0, 0x0, 0x0, 0x0, 0x0, 0x0, 0x0, 0x0
.long 0x0, 0x0, 0x0, 0x0, 0x0, 0x0, 0x0, 0x0
.long 0x0, 0x0, 0x0, 0x0, 0x0, 0x0, 0x0, 0x0
.long 0x0, 0x0, 0x0, 0x0, 0x0, 0x0, 0x0, 0x0
.long 0x0, 0x0, 0x0, 0x0, 0x0, 0x0, 0x0, 0x0
.long 0x0, 0x0, 0x0, 0x0, 0x0, 0x0, 0x0, 0x0
.long 0x13320, 0xa9b0, 0xa800, 0x10c00, 0xf320, 0xc120, 0x133b0, 0xb690
.long 0xa890, 0x11920, 0xf3b0, 0xce00, 0x12600, 0xa920, 0xb520, 0x10c90
.long 0xe600, 0xc090, 0x12690, 0xb600, 0xb5b0, 0x119b0, 0xe690, 0xcdb0
.long 0xd5f0, 0x11440, 0x117f0, 0x130d0, 0xf8d0, 0xadf0, 0xd640, 0x12160
.long 0x11840, 0x13df0, 0xf960, 0xbad0, 0xc8d0, 0x113f0, 0x124d0, 0x13160
.long 0xebf0, 0xad60, 0xc960, 0x120d0, 0x12560, 0x13e40, 0xec40, 0xba40
.long 0xefb0, 0x10ed0, 0x117b0, 0x12a40, 0xfa90, 0xdb60, 0xc890, 0x10d60
.long 0x10a90, 0x129f0, 0x13bb0, 0xddf0, 0xf000, 0x11bf0, 0x11520, 0xe960
.long 0xc160, 0xf9b0, 0xc920, 0x11a40, 0x10800, 0xe8d0, 0xc3f0, 0x13a90
.long 0xce40, 0xfa00, 0xfff0, 0xbb20, 0xedb0, 0xdad0, 0xced0, 0x10720
.long 0x10040, 0xc800, 0x14890, 0xde40, 0xf560, 0xfbb0, 0x140d0, 0xbdb0
.long 0xb3f0, 0xec00, 0xf5f0, 0x10890, 0x14160, 0xca90, 0xb760, 0x14720
.long 0x13520, 0xddb0, 0xa520, 0xbe00, 0xf490, 0xe800, 0x13690, 0x10490
.long 0xa5b0, 0xcb20, 0xe7b0, 0x14d00, 0x12800, 0xdd20, 0xb200, 0xbe90
.long 0xf800, 0x14320, 0x129b0, 0x10400, 0xb290, 0xcbb0, 0xeb20, 0x14290
.long 0xd560, 0x10760, 0x112d0, 0xaed0, 0xfb60, 0xeed0, 0xd3f0, 0xe040
.long 0x11360, 0xbbf0, 0xee40, 0x14d00, 0xc840, 0x106d0, 0x11ff0, 0xaf60
.long 0xfed0, 0x149f0, 0xc6d0, 0xdff0, 0x12040, 0xbc40, 0xf1f0, 0x14960
.long 0xbbb0, 0x10cd0, 0xfdb0, 0x12960, 0xd3b0, 0xd9f0, 0x13090, 0x11160
.long 0x13e90, 0x12bf0, 0xbff0, 0xd290, 0xbc00, 0x119f0, 0xfb20, 0xe840
.long 0xac90, 0xd840, 0x13120, 0x11e40, 0x13c00, 0xead0, 0xbe40, 0xabb0
.long 0xcf60, 0x11400, 0x101f0, 0xef20, 0x12e90, 0xdd60, 0xccd0, 0xd320
.long 0x10560, 0x14a00, 0xb640, 0x12d20, 0xf640, 0x115b0, 0x142d0, 0xf1b0
.long 0x121b0, 0xdcd0, 0xf3f0, 0xd490, 0x14640, 0x14c90, 0xb5f0, 0x12000
.long 0x13600, 0xf7b0, 0xa490, 0xb120, 0x10d20, 0xc200, 0x135b0, 0xea90
.long 0xa400, 0x14d00, 0x10db0, 0xcf20, 0x12920, 0xf720, 0xaa00, 0x14000
.long 0x11a00, 0xc290, 0x12890, 0xea00, 0xb720, 0x14090, 0x11a90, 0xcfb0
.long 0xd4d0, 0xfa40, 0x11760, 0x123f0, 0x12cd0, 0xaff0, 0xd440, 0xed60
.long 0x116d0, 0x14d00, 0x12d60, 0xbcd0, 0xc7f0, 0xf9f0, 0x118d0, 0x14ad0
.long 0x139f0, 0xb040, 0xc760, 0xecd0, 0x125f0, 0x14b60, 0x13a40, 0xbd60
.long 0xe290, 0x10e40, 0xc9b0, 0x12760, 0xfe00, 0x13640, 0x10df0, 0xd5b0
.long 0xf090, 0x128d0, 0x13f20, 0x138d0, 0xe320, 0x11b60, 0x12640, 0xafb0
.long 0xfe90, 0x14360, 0x11ad0, 0xd600, 0xe560, 0xad20, 0x13fb0, 0x145f0
.long 0xe000, 0xcd60, 0x10920, 0x102d0, 0xa6d0, 0xebb0, 0xd040, 0x12e00
.long 0xfc00, 0x10240, 0xaa40, 0x14690, 0xe1b0, 0xf440, 0x103f0, 0x12320
.long 0xe7f0, 0xee00, 0xf760, 0x12fb0, 0x144d0, 0x125b0, 0xeb60, 0x14920
.long 0x13720, 0x111b0, 0xdb20, 0xf400, 0x11090, 0x11d20, 0x137b0, 0x11e90
.long 0xda90, 0xe720, 0x11db0, 0x14d00, 0x12a00, 0x11120, 0x10200, 0xf5b0
.long 0x11200, 0x14400, 0x12a90, 0x11e00, 0x101b0, 0xe890, 0x11f20, 0x14490
.long 0xd6d0, 0x12e40, 0x108d0, 0xfc40, 0x13240, 0x13ed0, 0xd760, 0x13b60
.long 0x10840, 0xef60, 0x13f60, 0x14d00, 0xc9f0, 0x12df0, 0xe1f0, 0xfad0
.long 0x132d0, 0x14bf0, 0xca40, 0x13ad0, 0xe160, 0xedf0, 0x13ff0, 0x14c40
.long 0x11690, 0x11040, 0xde90, 0xa640, 0x10b20, 0x136d0, 0x109b0, 0x10ff0
.long 0xa5f0, 0xd1b0, 0x10bb0, 0x143f0, 0x11720, 0x11d60, 0xdf20, 0xb360
.long 0xb000, 0x13360, 0x10a00, 0x11cd0, 0xb2d0, 0xd200, 0xb090, 0x14040
.long 0xcbf0, 0xb920, 0xe400, 0x13560, 0xa560, 0xc490, 0xcc40, 0xc600
.long 0x13840, 0x13200, 0xe640, 0xc720, 0xf2d0, 0xba90, 0xdfb0, 0xc040
.long 0xa8d0, 0x11fb0, 0xf360, 0xc7b0, 0xc360, 0x12db0, 0xe9f0, 0x12200
.long 0x13400, 0xc3b0, 0xdc00, 0x10e00, 0xbfb0, 0xcc00, 0x13490, 0xd090
.long 0xdc90, 0x11b20, 0xcc90, 0x14d00, 0x12720, 0xc320, 0x10320, 0x10fb0
.long 0xc400, 0x14120, 0x127b0, 0xd000, 0x103b0, 0x11c90, 0xd120, 0x141b0
.long 0xd1f0, 0xac40, 0x10ad0, 0x13040, 0xab60, 0xb7f0, 0xd240, 0xb960
.long 0x10b60, 0x13d60, 0xb840, 0x14d00, 0xc4d0, 0xabf0, 0xe3f0, 0x12ed0
.long 0xb0d0, 0x146d0, 0xc560, 0xb8d0, 0xe440, 0x13bf0, 0xbdf0, 0x14760
.long 0xfc90, 0x10f60, 0x11290, 0xa840, 0x13d20, 0x104d0, 0x13db0, 0x111f0
.long 0x105b0, 0xa7f0, 0x13c90, 0xf7f0, 0xfd20, 0x11c40, 0x11320, 0xb560
.long 0xae00, 0xff60, 0x13e00, 0x11ed0, 0x10600, 0xb4d0, 0xadb0, 0xf240
.long 0xcdf0, 0xed20, 0x133f0, 0xbd20, 0x12c40, 0x14bb0, 0xd160, 0x14800
.long 0x13440, 0xca00, 0x11f60, 0x14b20, 0xf4d0, 0xee90, 0xbed0, 0xb890
.long 0x12ad0, 0x12490, 0xf840, 0x149b0, 0xbf60, 0xc5b0, 0x11df0, 0x12400
.long 0x12bb0, 0x13800, 0xd920, 0xc000, 0x14600, 0x14d00, 0x13890, 0x14d00
.long 0xd9b0, 0xcd20, 0xc5f0, 0x14d00, 0x13920, 0x145b0, 0x10000, 0xc1b0
.long 0xb1b0, 0x14d00, 0x12c00, 0x14520, 0x10090, 0xce90, 0xfbf0, 0x14d00
.long 0xc640, 0xd2d0, 0x105f0, 0xae40, 0x14cd0, 0x14d00, 0xd360, 0x14d00
.long 0x10640, 0xbb60, 0xbf20, 0x14d00, 0xd7f0, 0x14840, 0xded0, 0xacd0
.long 0x10290, 0x14d00, 0xcad0, 0x147f0, 0xdf60, 0xb9f0, 0x11000, 0x14d00
.long 0x14a90, 0x11240, 0xf890, 0xa760, 0x14d00, 0xaad0, 0x123b0, 0x110d0
.long 0x139b0, 0xa9f0, 0x14d00, 0x12b20, 0x10c40, 0xae90, 0xf920, 0xb440
.long 0xe0d0, 0x14d00, 0x11960, 0xaf20, 0x13a00, 0xb6d0, 0x131f0, 0x14d00
.long 0x13b20, 0xd0d0, 0x135f0, 0xf120, 0x14d00, 0x12440, 0xac00, 0xcb60
.long 0x13960, 0x14c00, 0xf520, 0x14d00, 0xcff0, 0x12120, 0xc0d0, 0xec90
.long 0xda40, 0xe090, 0xf6d0, 0x12290, 0xc440, 0x147b0, 0x14d00, 0x14d00
.long 0xa600, 0xd800, 0xdbb0, 0x10120, 0x0, 0x0, 0xa7b0, 0xff20
.long 0xda00, 0x14d00, 0x0, 0x0, 0xb320, 0xd890, 0xde00, 0x14200
.long 0x0, 0x0, 0xb490, 0xffb0, 0x10520, 0x143b0, 0x0, 0x0
.long 0x11640, 0x109f0, 0x107f0, 0xe240, 0x0, 0x0, 0x114d0, 0xe2d0
.long 0x10960, 0x14d00, 0x0, 0x0, 0x12360, 0x10a40, 0x10bf0, 0x14a40
.long 0x0, 0x0, 0x121f0, 0xe360, 0xe4d0, 0x148d0, 0x0, 0x0
.long 0xbc90, 0x126d0, 0x12c90, 0xa960, 0x0, 0x0, 0x131b0, 0x12b60
.long 0xb7b0, 0xa4d0, 0x0, 0x0, 0xba00, 0xe5f0, 0xa440, 0xaa90
.long 0x0, 0x0, 0x12f20, 0xea40, 0xb160, 0xab20, 0x0, 0x0
.long 0x10360, 0x11600, 0xd720, 0x134d0, 0x0, 0x0, 0x100d0, 0xd520
.long 0x11800, 0x13760, 0x0, 0x0, 0x14440, 0x11890, 0x137f0, 0x12520
.long 0x0, 0x0, 0x141f0, 0xd7b0, 0xc2d0, 0x12090, 0x0, 0x0
.long 0xa720, 0xf200, 0xf600, 0x10f20, 0x0, 0x0, 0xa690, 0xe520
.long 0xf690, 0x11c00, 0x0, 0x0, 0xb400, 0xf290, 0xe920, 0x10e90
.long 0x0, 0x0, 0xb3b0, 0xe5b0, 0xe9b0, 0x11bb0, 0x0, 0x0
.long 0x115f0, 0xfcd0, 0xfdf0, 0x12ff0, 0x0, 0x0, 0x11560, 0xeff0
.long 0xfe40, 0x13cd0, 0x0, 0x0, 0x122d0, 0xfd60, 0xf0d0, 0x12f60
.long 0x0, 0x0, 0x12240, 0xf040, 0xf160, 0x13c40, 0x0, 0x0
.long 0xe3b0, 0x12840, 0x11490, 0xdc40, 0x0, 0x0, 0x127f0, 0xd690
.long 0x107b0, 0xdbf0, 0x0, 0x0, 0xe120, 0xe760, 0xc240, 0x113b0
.long 0x0, 0x0, 0xe6d0, 0xd400, 0xc1f0, 0x10690, 0x0, 0x0
.long 0xe200, 0x10160, 0xb9b0, 0xd8d0, 0x0, 0x0, 0x10440, 0x13000
.long 0xc690, 0xd960, 0x0, 0x0, 0xe490, 0x14240, 0xb1f0, 0xb800
.long 0x0, 0x0, 0x14560, 0x13290, 0xb240, 0xc520, 0x0, 0x0
.long 0x0, 0x0, 0x0, 0x0, 0x0, 0x0, 0x0, 0x0
.long 0x0, 0x0, 0x0, 0x0, 0x0, 0x0, 0x0, 0x0
.long 0x0, 0x0, 0x0, 0x0, 0x0, 0x0, 0x0, 0x0
.long 0x0, 0x0, 0x0, 0x0, 0x0, 0x0, 0x0, 0x0
.long 0x0, 0x0, 0x0, 0x0, 0x0, 0x0, 0x0, 0x0
.long 0x0, 0x0, 0x0, 0x0, 0x0, 0x0, 0x0, 0x0
.long 0x0, 0x0, 0x0, 0x0, 0x0, 0x0, 0x0, 0x0
.long 0x0, 0x0, 0x0, 0x0, 0x0, 0x0, 0x0, 0x0
.long 0x0, 0x0, 0x0, 0x0, 0x0, 0x0, 0x0, 0x0
.long 0x0, 0x0, 0x0, 0x0, 0x0, 0x0, 0x0, 0x0
.long 0x0, 0x0, 0x0, 0x0, 0x0, 0x0, 0x0, 0x0
.long 0x0, 0x0, 0x0, 0x0, 0x0, 0x0, 0x0, 0x0
.long 0x0, 0x0, 0x0, 0x0, 0x0, 0x0, 0x0, 0x0
.long 0x0, 0x0, 0x0, 0x0, 0x0, 0x0, 0x0, 0x0
.long 0x0, 0x0, 0x0, 0x0, 0x0, 0x0, 0x0, 0x0
.long 0x0, 0x0, 0x0, 0x0, 0x0, 0x0, 0x0, 0x0
.long 0x0, 0x0, 0x0, 0x0, 0x0, 0x0, 0x0, 0x0
.long 0x0, 0x0, 0x0, 0x0, 0x0, 0x0, 0x0, 0x0
.long 0x0, 0x0, 0x0, 0x0, 0x0, 0x0, 0x0, 0x0
.long 0x0, 0x0, 0x0, 0x0, 0x0, 0x0, 0x0, 0x0
.long 0x0, 0x0, 0x0, 0x0, 0x0, 0x0, 0x0, 0x0
.long 0x0, 0x0, 0x0, 0x0, 0x0, 0x0, 0x0, 0x0
.long 0x0, 0x0, 0x0, 0x0, 0x0, 0x0, 0x0, 0x0
.long 0x0, 0x0, 0x0, 0x0, 0x0, 0x0, 0x0, 0x0
.long 0x0, 0x0, 0x0, 0x0, 0x0, 0x0, 0x0, 0x0
.long 0x0, 0x0, 0x0, 0x0, 0x0, 0x0, 0x0, 0x0
.long 0x0, 0x0, 0x0, 0x0, 0x0, 0x0, 0x0, 0x0
.long 0x0, 0x0, 0x0, 0x0, 0x0, 0x0, 0x0, 0x0
.long 0x0, 0x0, 0x0, 0x0, 0x0, 0x0, 0x0, 0x0
.long 0x0, 0x0, 0x0, 0x0, 0x0, 0x0, 0x0, 0x0
.long 0x0, 0x0, 0x0, 0x0, 0x0, 0x0, 0x0, 0x0
.long 0x0, 0x0, 0x0, 0x0, 0x0, 0x0, 0x0, 0x0
.section .rodata,"a"
.p2align 6
.amdhsa_kernel standalone__deep_cross_xdeepfm__recsys_kernel
  .amdhsa_next_free_vgpr 256
  .amdhsa_next_free_sgpr 102
  .amdhsa_accum_offset 256
  .amdhsa_group_segment_fixed_size 0
  .amdhsa_kernarg_size 88
  .amdhsa_user_sgpr_count 2
  .amdhsa_user_sgpr_kernarg_segment_ptr 1
  .amdhsa_system_sgpr_workgroup_id_x 1
  .amdhsa_float_denorm_mode_32 3
.end_amdhsa_kernel
```

```asm
; @launch grid=(256,1,1) block=(512,1,1) lds=163840
.amdgcn_target "amdgcn-amd-amdhsa--gfx950"
.text
.globl standalone__deep_cross_xdeepfm__recsys_kernel
.p2align 8
.type standalone__deep_cross_xdeepfm__recsys_kernel,@function
standalone__deep_cross_xdeepfm__recsys_kernel:
  s_cmp_ge_u32 s2, 256
  s_cbranch_scc1 L_end
  s_load_dwordx16 s[4:19], s[0:1], 0
  s_load_dwordx4 s[20:23], s[0:1], 64
  s_load_dwordx2 s[24:25], s[0:1], 80
  v_lshrrev_b32 v1, 6, v0
  s_getpc_b64 s[92:93]
L_pc:
  s_and_b32 s68, s2, 0xf8
  v_add_u32 v2, s68, v1
  v_and_b32_e64 v3, 32, v0
  v_lshl_add_u32 v2, v3, 3, v2
  v_lshlrev_b32 v2, 7, v2
  v_min_u32 v2, L_end-L_pc, v2
  v_mov_b32 v3, s93
  v_add_co_u32 v2, vcc, s92, v2
  s_nop 1
  v_addc_co_u32 v3, vcc, 0, v3, vcc
  global_load_dword v251, v[2:3], off
  v_and_b32 v0, 63, v0
  v_readfirstlane_b32 s3, v1
  s_and_b32 s68, s2, 7
  s_lshr_b32 s69, s2, 3
  s_xor_b32 s69, s69, 31
  s_and_b32 s80, s2, 0xf8
  s_add_u32 s80, s80, s3
  s_lshl_b32 s80, s80, 0
  s_min_u32 s70, s68, 1
  s_add_u32 s71, s69, s70
  s_cmp_ge_u32 s71, 22
  s_cbranch_scc1 L_cin
  s_mul_i32 s68, s68, 21
  s_add_u32 s68, s68, s71
  s_mul_i32 s26, s68, 5042
  s_lshr_b32 s26, s26, 16
  s_mul_i32 s69, s26, 13
  s_sub_u32 s27, s68, s69
  s_lshl_b32 s77, s27, 8
  s_mul_i32 s71, s26, 320
  v_lshrrev_b32 v116, 4, v0
  v_lshlrev_b32 v11, 4, v0
  s_and_b32 s79, s3, 3
  s_cmp_ge_u32 s3, 4
  s_cbranch_scc1 L_ld
  s_mul_i32 s70, s3, 13
  v_min_u32 v118, 12, v0
  v_add_u32 v118, s70, v118
  v_lshrrev_b32 v117, 1, v118
  v_mul_u32_u24 v117, 96, v117
  v_lshl_add_u32 v118, v118, 2, v117
  s_mul_i32 s78, s27, 25
  s_min_u32 s78, s78, 294
  s_add_u32 s78, s78, s71
  s_mul_i32 s78, s78, 104
  s_lshl_b32 s70, s26, 2
  s_add_u32 s70, s70, s3
  s_add_u32 s70, s70, 64
  s_mul_i32 s70, s70, 3328
  s_add_u32 s70, s70, s77
  s_mov_b32 s81, 173056
  v_lshrrev_b32 v112, 1, v0
  v_mul_lo_u32 v112, s81, v112
  v_and_b32 v117, 1, v0
  v_lshl_add_u32 v112, v117, 7, v112
  v_add_u32_e64 v112, s70, v112
  s_waitcnt lgkmcnt(0)
  s_mov_b32 s28, s4
  s_and_b32 s29, s5, 0xffff
  s_mov_b32 s30, 425984
  s_mov_b32 s31, 0x20000
  buffer_load_dwordx4 v[100:103], v118, s[28:31], s78 offen
  s_mov_b32 s32, s6
  s_and_b32 s33, s7, 0xffff
  s_mov_b32 s34, 12800000
  s_mov_b32 s35, 0x20000
  s_mov_b32 s48, s14
  s_and_b32 s49, s15, 0xffff
  s_mov_b32 s50, 3328
  s_mov_b32 s51, 0x20000
  s_mov_b32 m0, 122880
  s_mov_b64 exec, 0xffff
  buffer_load_dwordx4 v11, s[48:51], s77 offen lds
  s_mov_b64 exec, -1
  s_mov_b32 s44, s12
  s_and_b32 s45, s13, 0xffff
  s_mov_b32 s46, 5537792
  s_mov_b32 s47, 0x20000
  s_mov_b64 exec, 255
  buffer_load_dword v209, v112, s[44:47], 0 offen
  s_mov_b64 exec, -1
  s_barrier
  s_branch L_cmp
L_ld:
  s_lshr_b32 s68, s79, 1
  s_mul_i32 s68, s68, 20
  s_and_b32 s69, s79, 1
  s_add_u32 s68, s68, s69
  s_lshl_b32 s76, s68, 10
  s_mul_i32 s78, s71, 104
  s_mul_i32 s68, s68, 832
  s_add_u32 s94, s78, s68
  v_mul_u32_u24 v118, 48, v116
  v_sub_u32 v12, v11, v118
  s_add_u32 s95, s94, 3328
  s_add_u32 s96, s94, 6656
  s_add_u32 s97, s94, 9984
  s_add_u32 s98, s94, 13312
  s_and_b32 s70, s79, 1
  s_lshl_b32 s70, s70, 3
  v_lshlrev_b32 v117, 1, v116
  v_or_b32 v117, s70, v117
  v_xor_b32 v117, v117, v0
  v_and_b32 v117, 15, v117
  v_mul_u32_u24 v4, 3328, v116
  v_lshl_add_u32 v4, v117, 4, v4
  v_add_u32 v5, 13312, v4
  s_mul_i32 s74, s79, 26624
  s_add_u32 s74, s74, s77
  s_lshl_b32 s75, s79, 11
  s_waitcnt lgkmcnt(0)
  s_mov_b32 s28, s4
  s_and_b32 s29, s5, 0xffff
  s_mov_b32 s30, 425984
  s_mov_b32 s31, 0x20000
  buffer_load_dwordx4 v[16:19], v12, s[28:31], s94 offen offset:0
  s_mov_b32 s32, s6
  s_and_b32 s33, s7, 0xffff
  s_mov_b32 s34, 12800000
  s_mov_b32 s35, 0x20000
  s_mov_b32 s44, s12
  s_and_b32 s45, s13, 0xffff
  s_mov_b32 s46, 5537792
  s_mov_b32 s47, 0x20000
  s_add_u32 m0, s75, 131072
  s_nop 0
  buffer_load_dwordx4 v4, s[44:47], s74 offen lds
  s_add_u32 m0, s75, 132096
  s_nop 0
  buffer_load_dwordx4 v5, s[44:47], s74 offen lds
  s_add_u32 s74, s74, 106496
  s_add_u32 m0, s75, 139264
  s_nop 0
  buffer_load_dwordx4 v4, s[44:47], s74 offen lds
  s_add_u32 m0, s75, 140288
  s_nop 0
  buffer_load_dwordx4 v5, s[44:47], s74 offen lds
  s_add_u32 s74, s74, 106496
  s_barrier
  buffer_load_dwordx4 v[20:23], v12, s[28:31], s94 offen offset:1664
  buffer_load_dwordx4 v[24:27], v12, s[28:31], s95 offen offset:0
  buffer_load_dwordx4 v[28:31], v12, s[28:31], s95 offen offset:1664
  buffer_load_dwordx4 v[32:35], v12, s[28:31], s96 offen offset:0
  buffer_load_dwordx4 v[36:39], v12, s[28:31], s96 offen offset:1664
  buffer_load_dwordx4 v[40:43], v12, s[28:31], s97 offen offset:0
  buffer_load_dwordx4 v[44:47], v12, s[28:31], s97 offen offset:1664
  buffer_load_dwordx4 v[48:51], v12, s[28:31], s98 offen offset:0
  buffer_load_dwordx4 v[52:55], v12, s[28:31], s98 offen offset:1664
  s_lshl_b32 s70, s69, 6
  v_and_b32 v118, 7, v0
  v_xor_b32 v118, v118, v116
  v_lshlrev_b32 v118, 4, v118
  v_xor_b32 v2, s70, v118
  v_xor_b32 v3, 64, v2
  s_mov_b32 s72, 0
  s_mul_i32 s70, s79, 13
  s_add_u32 s70, s70, s27
  s_min_u32 s70, s70, 39
  s_lshl_b32 s70, s70, 3
  s_add_u32 s70, s70, s71
  s_mul_i32 s84, s70, 104
  v_lshrrev_b32 v118, 2, v0
  v_min_u32 v118, 7, v118
  v_mul_u32_u24 v118, 104, v118
  v_and_b32 v117, 3, v0
  v_lshl_add_u32 v7, v117, 2, v118
  s_lshl_b32 s70, s26, 2
  s_add_u32 s70, s70, s79
  s_add_u32 s70, s70, 256
  s_mul_i32 s85, s70, 3328
  s_add_u32 s85, s85, s77
  s_mov_b32 s70, 173056
  v_lshrrev_b32 v118, 1, v0
  v_mul_lo_u32 v118, s70, v118
  v_and_b32 v117, 1, v0
  v_lshl_add_u32 v84, v117, 7, v118
  s_mov_b32 s52, s16
  s_and_b32 s53, s17, 0xffff
  s_mov_b32 s54, 3328
  s_mov_b32 s55, 0x20000
  s_mul_i32 s70, s79, 2560
  s_add_u32 s70, s70, L_tail-L_pc
  v_lshlrev_b32 v8, 7, v0
  v_add_u32 v8, s70, v8
  v_mov_b32 v9, s93
  v_add_co_u32 v8, vcc, s92, v8
  s_nop 1
  v_addc_co_u32 v9, vcc, 0, v9, vcc
  s_waitcnt vmcnt(13)
  v_lshlrev_b32 v16, 7, v16
  v_lshlrev_b32 v18, 7, v18
  v_lshlrev_b32 v17, 7, v17
  v_lshlrev_b32 v19, 7, v19
  v_add_u32_dpp v56, v16, v2 row_newbcast:0 row_mask:0xf bank_mask:0x3
  s_nop 1
  v_add_u32_dpp v56, v18, v2 row_newbcast:6 row_mask:0xf bank_mask:0xc
  s_add_u32 m0, s76, 0
  s_nop 0
  buffer_load_dwordx4 v56, s[32:35], 0 offen lds
  s_waitcnt vmcnt(10)
  s_barrier
  s_waitcnt vmcnt(9)
  v_lshlrev_b32 v20, 7, v20
  v_lshlrev_b32 v22, 7, v22
  v_lshlrev_b32 v21, 7, v21
  v_lshlrev_b32 v23, 7, v23
  v_add_u32_dpp v57, v20, v2 row_newbcast:0 row_mask:0xf bank_mask:0x3
  s_nop 1
  v_add_u32_dpp v57, v22, v2 row_newbcast:6 row_mask:0xf bank_mask:0xc
  s_add_u32 m0, s76, 2048
  s_nop 0
  buffer_load_dwordx4 v57, s[32:35], 0 offen lds
  s_waitcnt vmcnt(9)
  v_lshlrev_b32 v24, 7, v24
  v_lshlrev_b32 v26, 7, v26
  v_lshlrev_b32 v25, 7, v25
  v_lshlrev_b32 v27, 7, v27
  v_add_u32_dpp v58, v24, v2 row_newbcast:0 row_mask:0xf bank_mask:0x3
  s_nop 1
  v_add_u32_dpp v58, v26, v2 row_newbcast:6 row_mask:0xf bank_mask:0xc
  s_add_u32 m0, s76, 4096
  s_nop 0
  buffer_load_dwordx4 v58, s[32:35], 0 offen lds
  s_waitcnt vmcnt(9)
  v_lshlrev_b32 v28, 7, v28
  v_lshlrev_b32 v30, 7, v30
  v_lshlrev_b32 v29, 7, v29
  v_lshlrev_b32 v31, 7, v31
  v_add_u32_dpp v59, v28, v2 row_newbcast:0 row_mask:0xf bank_mask:0x3
  s_nop 1
  v_add_u32_dpp v59, v30, v2 row_newbcast:6 row_mask:0xf bank_mask:0xc
  s_add_u32 m0, s76, 6144
  s_nop 0
  buffer_load_dwordx4 v59, s[32:35], 0 offen lds
  s_waitcnt vmcnt(9)
  v_lshlrev_b32 v32, 7, v32
  v_lshlrev_b32 v34, 7, v34
  v_lshlrev_b32 v33, 7, v33
  v_lshlrev_b32 v35, 7, v35
  v_add_u32_dpp v60, v32, v2 row_newbcast:0 row_mask:0xf bank_mask:0x3
  s_nop 1
  v_add_u32_dpp v60, v34, v2 row_newbcast:6 row_mask:0xf bank_mask:0xc
  s_add_u32 m0, s76, 8192
  s_nop 0
  buffer_load_dwordx4 v60, s[32:35], 0 offen lds
  s_waitcnt vmcnt(9)
  v_lshlrev_b32 v36, 7, v36
  v_lshlrev_b32 v38, 7, v38
  v_lshlrev_b32 v37, 7, v37
  v_lshlrev_b32_e64 v39, 7, v39
  v_add_u32_dpp v61, v36, v2 row_newbcast:0 row_mask:0xf bank_mask:0x3
  s_nop 1
  v_add_u32_dpp v61, v38, v2 row_newbcast:6 row_mask:0xf bank_mask:0xc
  s_add_u32 m0, s76, 10240
  s_nop 0
  buffer_load_dwordx4 v61, s[32:35], 0 offen lds
  s_waitcnt vmcnt(9)
  v_lshlrev_b32 v40, 7, v40
  v_lshlrev_b32 v42, 7, v42
  v_lshlrev_b32 v41, 7, v41
  v_lshlrev_b32_e64 v43, 7, v43
  v_add_u32_dpp v62, v40, v2 row_newbcast:0 row_mask:0xf bank_mask:0x3
  s_nop 1
  v_add_u32_dpp v62, v42, v2 row_newbcast:6 row_mask:0xf bank_mask:0xc
  s_add_u32 m0, s76, 12288
  s_nop 0
  buffer_load_dwordx4 v62, s[32:35], 0 offen lds
  s_waitcnt vmcnt(9)
  v_lshlrev_b32 v44, 7, v44
  v_lshlrev_b32 v46, 7, v46
  v_lshlrev_b32 v45, 7, v45
  v_lshlrev_b32_e64 v47, 7, v47
  v_add_u32_dpp v63, v44, v2 row_newbcast:0 row_mask:0xf bank_mask:0x3
  s_nop 1
  v_add_u32_dpp v63, v46, v2 row_newbcast:6 row_mask:0xf bank_mask:0xc
  s_add_u32 m0, s76, 14336
  s_nop 0
  buffer_load_dwordx4 v63, s[32:35], 0 offen lds
  s_waitcnt vmcnt(9)
  v_lshlrev_b32 v48, 7, v48
  v_lshlrev_b32 v50, 7, v50
  v_lshlrev_b32 v49, 7, v49
  v_lshlrev_b32_e64 v51, 7, v51
  v_add_u32_dpp v64, v48, v2 row_newbcast:0 row_mask:0xf bank_mask:0x3
  s_nop 1
  v_add_u32_dpp v64, v50, v2 row_newbcast:6 row_mask:0xf bank_mask:0xc
  s_add_u32 m0, s76, 16384
  s_nop 0
  buffer_load_dwordx4 v64, s[32:35], 0 offen lds
  s_waitcnt vmcnt(9)
  v_lshlrev_b32 v52, 7, v52
  v_lshlrev_b32 v54, 7, v54
  v_lshlrev_b32 v53, 7, v53
  v_lshlrev_b32_e64 v55, 7, v55
  v_add_u32_dpp v65, v52, v2 row_newbcast:0 row_mask:0xf bank_mask:0x3
  s_nop 1
  v_add_u32_dpp v65, v54, v2 row_newbcast:6 row_mask:0xf bank_mask:0xc
  s_add_u32 m0, s76, 18432
  s_nop 0
  buffer_load_dwordx4 v65, s[32:35], 0 offen lds
  v_add_u32_dpp v56, v17, v2 row_newbcast:0 row_mask:0xf bank_mask:0x3
  s_nop 1
  v_add_u32_dpp v56, v19, v2 row_newbcast:6 row_mask:0xf bank_mask:0xc
  s_add_u32 m0, s76, 40960
  s_nop 0
  buffer_load_dwordx4 v56, s[32:35], 0 offen lds
  v_add_u32_dpp v57, v21, v2 row_newbcast:0 row_mask:0xf bank_mask:0x3
  s_nop 1
  v_add_u32_dpp v57, v23, v2 row_newbcast:6 row_mask:0xf bank_mask:0xc
  s_add_u32 m0, s76, 43008
  s_nop 0
  buffer_load_dwordx4 v57, s[32:35], 0 offen lds
  v_add_u32_dpp v58, v25, v2 row_newbcast:0 row_mask:0xf bank_mask:0x3
  s_nop 1
  v_add_u32_dpp v58, v27, v2 row_newbcast:6 row_mask:0xf bank_mask:0xc
  s_add_u32 m0, s76, 45056
  s_nop 0
  buffer_load_dwordx4 v58, s[32:35], 0 offen lds
  v_add_u32_dpp v59, v29, v2 row_newbcast:0 row_mask:0xf bank_mask:0x3
  s_nop 1
  v_add_u32_dpp v59, v31, v2 row_newbcast:6 row_mask:0xf bank_mask:0xc
  s_add_u32 m0, s76, 47104
  s_nop 0
  buffer_load_dwordx4 v59, s[32:35], 0 offen lds
  v_add_u32_dpp v60, v33, v2 row_newbcast:0 row_mask:0xf bank_mask:0x3
  s_nop 1
  v_add_u32_dpp v60, v35, v2 row_newbcast:6 row_mask:0xf bank_mask:0xc
  s_add_u32 m0, s76, 49152
  s_nop 0
  buffer_load_dwordx4 v60, s[32:35], 0 offen lds
  s_waitcnt vmcnt(11)
  s_barrier
  v_add_u32_dpp v61, v37, v2 row_newbcast:0 row_mask:0xf bank_mask:0x3
  s_nop 1
  v_add_u32_dpp v61, v39, v2 row_newbcast:6 row_mask:0xf bank_mask:0xc
  s_add_u32 m0, s76, 51200
  s_nop 0
  buffer_load_dwordx4 v61, s[32:35], 0 offen lds
  v_add_u32_dpp v62, v41, v2 row_newbcast:0 row_mask:0xf bank_mask:0x3
  s_nop 1
  v_add_u32_dpp v62, v43, v2 row_newbcast:6 row_mask:0xf bank_mask:0xc
  s_add_u32 m0, s76, 53248
  s_nop 0
  buffer_load_dwordx4 v62, s[32:35], 0 offen lds
  v_add_u32_dpp v63, v45, v2 row_newbcast:0 row_mask:0xf bank_mask:0x3
  s_nop 1
  v_add_u32_dpp v63, v47, v2 row_newbcast:6 row_mask:0xf bank_mask:0xc
  s_add_u32 m0, s76, 55296
  s_nop 0
  buffer_load_dwordx4 v63, s[32:35], 0 offen lds
  v_add_u32_dpp v64, v49, v2 row_newbcast:0 row_mask:0xf bank_mask:0x3
  s_nop 1
  v_add_u32_dpp v64, v51, v2 row_newbcast:6 row_mask:0xf bank_mask:0xc
  s_add_u32 m0, s76, 57344
  s_nop 0
  buffer_load_dwordx4 v64, s[32:35], 0 offen lds
  v_add_u32_dpp v65, v53, v2 row_newbcast:0 row_mask:0xf bank_mask:0x3
  s_nop 1
  v_add_u32_dpp v65, v55, v2 row_newbcast:6 row_mask:0xf bank_mask:0xc
  s_add_u32 m0, s76, 59392
  s_nop 0
  buffer_load_dwordx4 v65, s[32:35], 0 offen lds
  s_waitcnt vmcnt(10)
  s_barrier
  s_add_u32 m0, s75, 147456
  s_nop 0
  buffer_load_dwordx4 v4, s[44:47], s74 offen lds
  s_add_u32 m0, s75, 148480
  s_nop 0
  buffer_load_dwordx4 v5, s[44:47], s74 offen lds
  s_add_u32 s74, s74, 106496
  s_add_u32 m0, s75, 155648
  s_nop 0
  buffer_load_dwordx4 v4, s[44:47], s74 offen lds
  s_add_u32 m0, s75, 156672
  s_nop 0
  buffer_load_dwordx4 v5, s[44:47], s74 offen lds
  s_add_u32 s74, s74, 106496
  v_add_u32_dpp v56, v18, v2 row_newbcast:0 row_mask:0xf bank_mask:0x3
  v_add_u32_dpp v57, v22, v2 row_newbcast:0 row_mask:0xf bank_mask:0x3
  v_add_u32_dpp v58, v26, v2 row_newbcast:0 row_mask:0xf bank_mask:0x3
  v_add_u32_dpp v59, v30, v2 row_newbcast:0 row_mask:0xf bank_mask:0x3
  v_add_u32_dpp v60, v34, v2 row_newbcast:0 row_mask:0xf bank_mask:0x3
  v_add_u32_dpp v61, v38, v2 row_newbcast:0 row_mask:0xf bank_mask:0x3
  v_add_u32_dpp v62, v42, v2 row_newbcast:0 row_mask:0xf bank_mask:0x3
  v_add_u32_dpp v63, v46, v2 row_newbcast:0 row_mask:0xf bank_mask:0x3
  v_add_u32_dpp v64, v50, v2 row_newbcast:0 row_mask:0xf bank_mask:0x3
  v_add_u32_dpp v65, v54, v2 row_newbcast:0 row_mask:0xf bank_mask:0x3
  v_add_u32_dpp v56, v16, v2 row_newbcast:7 row_mask:0xf bank_mask:0xc
  v_add_u32_dpp v57, v20, v2 row_newbcast:7 row_mask:0xf bank_mask:0xc
  v_add_u32_dpp v58, v24, v2 row_newbcast:7 row_mask:0xf bank_mask:0xc
  v_add_u32_dpp v59, v28, v2 row_newbcast:7 row_mask:0xf bank_mask:0xc
  v_add_u32_dpp v60, v32, v2 row_newbcast:7 row_mask:0xf bank_mask:0xc
  v_add_u32_dpp v61, v36, v2 row_newbcast:7 row_mask:0xf bank_mask:0xc
  v_add_u32_dpp v62, v40, v2 row_newbcast:7 row_mask:0xf bank_mask:0xc
  v_add_u32_dpp v63, v44, v2 row_newbcast:7 row_mask:0xf bank_mask:0xc
  v_add_u32_dpp v64, v48, v2 row_newbcast:7 row_mask:0xf bank_mask:0xc
  v_add_u32_dpp v65, v52, v2 row_newbcast:7 row_mask:0xf bank_mask:0xc
  buffer_load_dword v70, v7, s[28:31], s84 offen offset:32
  buffer_load_dword v71, v7, s[28:31], s84 offen offset:48
  buffer_load_dword v72, v7, s[28:31], s84 offen offset:64
  buffer_load_dword v73, v7, s[28:31], s84 offen offset:80
  buffer_load_dword v74, v7, s[28:31], s84 offen offset:88
  s_add_u32 m0, s76, 81920
  s_nop 0
  buffer_load_dwordx4 v56, s[32:35], 0 offen lds
  s_add_u32 m0, s76, 83968
  s_nop 0
  buffer_load_dwordx4 v57, s[32:35], 0 offen lds
  s_add_u32 m0, s76, 86016
  s_nop 0
  buffer_load_dwordx4 v58, s[32:35], 0 offen lds
  s_add_u32 m0, s76, 88064
  s_nop 0
  buffer_load_dwordx4 v59, s[32:35], 0 offen lds
  s_add_u32 m0, s76, 90112
  s_nop 0
  buffer_load_dwordx4 v60, s[32:35], 0 offen lds
  s_add_u32 m0, s76, 92160
  s_nop 0
  buffer_load_dwordx4 v61, s[32:35], 0 offen lds
  s_add_u32 m0, s76, 94208
  s_nop 0
  buffer_load_dwordx4 v62, s[32:35], 0 offen lds
  s_add_u32 m0, s76, 96256
  s_nop 0
  buffer_load_dwordx4 v63, s[32:35], 0 offen lds
  s_waitcnt vmcnt(13)
  s_barrier
  s_add_u32 m0, s76, 98304
  s_nop 0
  buffer_load_dwordx4 v64, s[32:35], 0 offen lds
  s_add_u32 m0, s76, 100352
  s_nop 0
  buffer_load_dwordx4 v65, s[32:35], 0 offen lds
  v_add_u32_dpp v56, v19, v2 row_newbcast:0 row_mask:0xf bank_mask:0x3
  v_add_u32_dpp v57, v23, v2 row_newbcast:0 row_mask:0xf bank_mask:0x3
  v_add_u32_dpp v58, v27, v2 row_newbcast:0 row_mask:0xf bank_mask:0x3
  v_add_u32_dpp v59, v31, v2 row_newbcast:0 row_mask:0xf bank_mask:0x3
  v_add_u32_dpp v60, v35, v2 row_newbcast:0 row_mask:0xf bank_mask:0x3
  v_add_u32_dpp v61, v39, v2 row_newbcast:0 row_mask:0xf bank_mask:0x3
  v_add_u32_dpp v62, v43, v2 row_newbcast:0 row_mask:0xf bank_mask:0x3
  v_add_u32_dpp v63, v47, v2 row_newbcast:0 row_mask:0xf bank_mask:0x3
  v_add_u32_dpp v64, v51, v2 row_newbcast:0 row_mask:0xf bank_mask:0x3
  v_add_u32_dpp v65, v55, v2 row_newbcast:0 row_mask:0xf bank_mask:0x3
  v_add_u32_dpp v56, v17, v2 row_newbcast:7 row_mask:0xf bank_mask:0xc
  v_add_u32_dpp v57, v21, v2 row_newbcast:7 row_mask:0xf bank_mask:0xc
  v_add_u32_dpp v58, v25, v2 row_newbcast:7 row_mask:0xf bank_mask:0xc
  v_add_u32_dpp v59, v29, v2 row_newbcast:7 row_mask:0xf bank_mask:0xc
  v_add_u32_dpp v60, v33, v2 row_newbcast:7 row_mask:0xf bank_mask:0xc
  v_add_u32_dpp v61, v37, v2 row_newbcast:7 row_mask:0xf bank_mask:0xc
  v_add_u32_dpp v62, v41, v2 row_newbcast:7 row_mask:0xf bank_mask:0xc
  v_add_u32_dpp v63, v45, v2 row_newbcast:7 row_mask:0xf bank_mask:0xc
  v_add_u32_dpp v64, v49, v2 row_newbcast:7 row_mask:0xf bank_mask:0xc
  v_add_u32_dpp v65, v53, v2 row_newbcast:7 row_mask:0xf bank_mask:0xc
  s_setprio 0
  s_branch L_ld_in
L_cmp:
  s_and_b32 s68, s3, 1
  s_lshr_b32 s69, s3, 1
  v_bfe_u32 v117, v0, 2, 2
  v_lshl_add_u32 v118, v116, 3, v117
  v_lshlrev_b32 v118, 8, v118
  v_bfe_u32 v117, v0, 2, 3
  s_lshl_b32 s70, s69, 2
  v_xor_b32 v117, s70, v117
  v_lshl_add_u32 v118, v117, 5, v118
  v_and_b32 v117, 3, v0
  v_lshl_add_u32 v118, v117, 3, v118
  v_add_u32 v1, 131072, v118
  v_xor_b32 v2, 32, v1
  v_xor_b32 v3, 64, v1
  v_xor_b32 v4, 96, v1
  s_lshl_b32 s70, s69, 7
  s_add_u32 s70, s70, 122880
  v_lshlrev_b32 v118, 3, v116
  v_add_u32 v9, s70, v118
  v_and_b32 v118, 15, v0
  v_lshlrev_b32 v118, 7, v118
  v_bfe_u32 v117, v0, 1, 3
  v_xor_b32 v117, v117, v116
  v_lshl_add_u32 v118, v117, 4, v118
  s_mul_i32 s70, s68, 20480
  v_add_u32 v5, s70, v118
  v_xor_b32 v7, 64, v5
  v_add_u32 v6, 81920, v5
  v_add_u32 v8, 81920, v7
  s_mul_i32 s70, s3, 640
  s_add_u32 s70, s70, 123392
  v_and_b32 v118, 15, v0
  v_lshlrev_b32 v118, 2, v118
  v_add_u32 v118, s70, v118
  v_lshrrev_b32 v117, 5, v0
  v_lshl_add_u32 v118, v117, 6, v118
  v_bfe_u32 v117, v0, 4, 1
  v_lshl_add_u32 v10, v117, 7, v118
  s_mov_b32 s72, 0
  v_mov_b32 v12, 0xc0135761
  v_mov_b32 v13, 0xc0135761
  v_mov_b32 v14, 0xbdd2d3e8
  v_mov_b32 v15, 0xbdd2d3e8
  s_waitcnt vmcnt(2)
  v_lshlrev_b32 v100, 7, v100
  buffer_load_dword v200, v100, s[32:35], 0 offen
  v_lshlrev_b32 v102, 7, v102
  buffer_load_dword v202, v102, s[32:35], 0 offen
  s_barrier
  ds_read_b64_tr_b16 v[16:17], v1 offset:0
  ds_read_b64_tr_b16 v[18:19], v1 offset:1024
  ds_read_b64_tr_b16 v[32:33], v1 offset:8192
  ds_read_b64_tr_b16 v[34:35], v1 offset:9216
  ds_read_b64_tr_b16 v[20:21], v2 offset:0
  ds_read_b64_tr_b16 v[22:23], v2 offset:1024
  ds_read_b64_tr_b16 v[36:37], v2 offset:8192
  ds_read_b64_tr_b16 v[38:39], v2 offset:9216
  ds_read_b64_tr_b16 v[24:25], v3 offset:0
  ds_read_b64_tr_b16 v[26:27], v3 offset:1024
  ds_read_b64_tr_b16 v[40:41], v3 offset:8192
  ds_read_b64_tr_b16 v[42:43], v3 offset:9216
  ds_read_b64_tr_b16 v[28:29], v4 offset:0
  ds_read_b64_tr_b16 v[30:31], v4 offset:1024
  ds_read_b64_tr_b16 v[44:45], v4 offset:8192
  ds_read_b64_tr_b16 v[46:47], v4 offset:9216
  s_waitcnt vmcnt(3)
  ds_read_b64 v[234:235], v9 offset:0
  ds_read_b64 v[238:239], v9 offset:32
  ds_read_b64 v[242:243], v9 offset:64
  ds_read_b64 v[246:247], v9 offset:96
  s_waitcnt lgkmcnt(3)
  v_lshlrev_b32 v232, 16, v234
  v_and_b32 v233, 0xffff0000, v234
  v_lshlrev_b32 v234, 16, v235
  v_and_b32 v235, 0xffff0000, v235
  s_waitcnt lgkmcnt(2)
  v_lshlrev_b32 v236, 16, v238
  v_and_b32 v237, 0xffff0000, v238
  v_lshlrev_b32 v238, 16, v239
  v_and_b32 v239, 0xffff0000, v239
  s_waitcnt lgkmcnt(1)
  v_lshlrev_b32 v240, 16, v242
  v_and_b32 v241, 0xffff0000, v242
  v_lshlrev_b32_e64 v242, 16, v243
  v_and_b32 v243, 0xffff0000, v243
  s_waitcnt lgkmcnt(0)
  v_lshlrev_b32 v244, 16, v246
  v_and_b32 v245, 0xffff0000, v246
  v_lshlrev_b32 v246, 16, v247
  v_and_b32 v247, 0xffff0000, v247
  v_mov_b64 v[216:217], v[232:233]
  v_mov_b64 v[218:219], v[234:235]
  v_mov_b64 v[220:221], v[236:237]
  v_mov_b64 v[222:223], v[238:239]
  v_mov_b64 v[224:225], v[240:241]
  v_mov_b64 v[226:227], v[242:243]
  v_mov_b64 v[228:229], v[244:245]
  v_mov_b64 v[230:231], v[246:247]
  s_waitcnt lgkmcnt(0)
  s_setprio 1
  s_barrier
  ds_read_b128 v[48:51], v5 offset:0
  ds_read_b128 v[52:55], v7 offset:0
  ds_read_b128 v[56:59], v5 offset:2048
  ds_read_b128 v[60:63], v7 offset:2048
  ds_read_b128 v[64:67], v5 offset:4096
  ds_read_b128 v[68:71], v7 offset:4096
  ds_read_b128 v[72:75], v5 offset:6144
  ds_read_b128 v[76:79], v7 offset:6144
  s_waitcnt lgkmcnt(7)
  v_mfma_f32_16x16x32_bf16 v[88:91], v[16:19], v[48:51], v[232:235]
  s_waitcnt lgkmcnt(4)
  v_mfma_f32_16x16x32_bf16 v[88:91], v[32:35], v[52:55], v[88:91]
  v_mfma_f32_16x16x32_bf16 v[104:107], v[32:35], v[60:63], v[232:235]
  v_mfma_f32_16x16x32_bf16 v[104:107], v[16:19], v[56:59], v[104:107]
  v_mfma_f32_16x16x32_bf16 v[108:111], v[20:23], v[56:59], v[236:239]
  v_mfma_f32_16x16x32_bf16 v[108:111], v[36:39], v[60:63], v[108:111]
  v_mfma_f32_16x16x32_bf16 v[92:95], v[36:39], v[52:55], v[236:239]
  v_mfma_f32_16x16x32_bf16 v[92:95], v[20:23], v[48:51], v[92:95]
  v_mfma_f32_16x16x32_bf16 v[96:99], v[24:27], v[48:51], v[240:243]
  v_xor_b32 v1, 16384, v1
  v_mfma_f32_16x16x32_bf16 v[96:99], v[40:43], v[52:55], v[96:99]
  v_xor_b32 v2, 16384, v2
  v_mfma_f32_16x16x32_bf16 v[112:115], v[40:43], v[60:63], v[240:243]
  v_xor_b32 v3, 16384, v3
  v_mfma_f32_16x16x32_bf16 v[112:115], v[24:27], v[56:59], v[112:115]
  v_xor_b32 v4, 16384, v4
  v_mfma_f32_16x16x32_bf16 v[116:119], v[28:31], v[56:59], v[244:247]
  v_mfma_f32_16x16x32_bf16 v[116:119], v[44:47], v[60:63], v[116:119]
  v_mfma_f32_16x16x32_bf16 v[100:103], v[44:47], v[52:55], v[244:247]
  s_waitcnt lgkmcnt(2)
  v_mfma_f32_16x16x32_bf16 v[100:103], v[28:31], v[48:51], v[100:103]
  s_nop 0
  v_mfma_f32_16x16x32_bf16 v[120:123], v[16:19], v[64:67], v[232:235]
  s_barrier
  s_waitcnt lgkmcnt(0)
  v_mfma_f32_16x16x32_bf16 v[120:123], v[32:35], v[68:71], v[120:123]
  ds_read_b128 v[80:83], v5 offset:8192
  v_mfma_f32_16x16x32_bf16 v[136:139], v[32:35], v[76:79], v[232:235]
  ds_read_b128 v[84:87], v7 offset:8192
  v_mfma_f32_16x16x32_bf16 v[136:139], v[16:19], v[72:75], v[136:139]
  ds_read_b128 v[48:51], v5 offset:10240
  v_mfma_f32_16x16x32_bf16 v[140:143], v[20:23], v[72:75], v[236:239]
  ds_read_b128 v[52:55], v7 offset:10240
  v_mfma_f32_16x16x32_bf16 v[140:143], v[36:39], v[76:79], v[140:143]
  ds_read_b128 v[56:59], v5 offset:12288
  v_mfma_f32_16x16x32_bf16 v[124:127], v[36:39], v[68:71], v[236:239]
  ds_read_b128 v[60:63], v7 offset:12288
  v_mfma_f32_16x16x32_bf16 v[124:127], v[20:23], v[64:67], v[124:127]
  v_mfma_f32_16x16x32_bf16 v[128:131], v[24:27], v[64:67], v[240:243]
  v_mfma_f32_16x16x32_bf16 v[128:131], v[40:43], v[68:71], v[128:131]
  v_mfma_f32_16x16x32_bf16 v[144:147], v[40:43], v[76:79], v[240:243]
  v_mfma_f32_16x16x32_bf16 v[144:147], v[24:27], v[72:75], v[144:147]
  v_mfma_f32_16x16x32_bf16 v[148:151], v[28:31], v[72:75], v[244:247]
  ds_read_b128 v[72:75], v5 offset:16384
  v_mfma_f32_16x16x32_bf16 v[148:151], v[44:47], v[76:79], v[148:151]
  ds_read_b128 v[76:79], v7 offset:16384
  v_mfma_f32_16x16x32_bf16 v[132:135], v[44:47], v[68:71], v[244:247]
  ds_read_b128 v[68:71], v7 offset:14336
  s_waitcnt lgkmcnt(7)
  v_mfma_f32_16x16x32_bf16 v[132:135], v[28:31], v[64:67], v[132:135]
  ds_read_b128 v[64:67], v5 offset:14336
  v_mfma_f32_16x16x32_bf16 v[152:155], v[16:19], v[80:83], v[232:235]
  s_waitcnt lgkmcnt(6)
  v_mfma_f32_16x16x32_bf16 v[152:155], v[32:35], v[84:87], v[152:155]
  v_mfma_f32_16x16x32_bf16 v[168:171], v[32:35], v[52:55], v[232:235]
  v_mfma_f32_16x16x32_bf16 v[168:171], v[16:19], v[48:51], v[168:171]
  v_mfma_f32_16x16x32_bf16 v[172:175], v[20:23], v[48:51], v[236:239]
  v_mfma_f32_16x16x32_bf16 v[172:175], v[36:39], v[52:55], v[172:175]
  v_mfma_f32_16x16x32_bf16 v[156:159], v[36:39], v[84:87], v[236:239]
  v_mfma_f32_16x16x32_bf16 v[156:159], v[20:23], v[80:83], v[156:159]
  v_mfma_f32_16x16x32_bf16 v[160:163], v[24:27], v[80:83], v[240:243]
  v_mfma_f32_16x16x32_bf16 v[160:163], v[40:43], v[84:87], v[160:163]
  v_mfma_f32_16x16x32_bf16 v[176:179], v[40:43], v[52:55], v[240:243]
  v_mfma_f32_16x16x32_bf16 v[176:179], v[24:27], v[48:51], v[176:179]
  v_mfma_f32_16x16x32_bf16 v[180:183], v[28:31], v[48:51], v[244:247]
  v_mfma_f32_16x16x32_bf16 v[180:183], v[44:47], v[52:55], v[180:183]
  v_mfma_f32_16x16x32_bf16 v[164:167], v[44:47], v[84:87], v[244:247]
  ds_read_b128 v[84:87], v7 offset:18432
  s_waitcnt lgkmcnt(5)
  v_mfma_f32_16x16x32_bf16 v[164:167], v[28:31], v[80:83], v[164:167]
  ds_read_b128 v[80:83], v5 offset:18432
  v_mfma_f32_16x16x32_bf16 v[184:187], v[16:19], v[56:59], v[232:235]
  s_waitcnt lgkmcnt(2)
  v_mfma_f32_16x16x32_bf16 v[184:187], v[32:35], v[60:63], v[184:187]
  s_waitcnt vmcnt(0)
  v_mfma_f32_16x16x32_bf16 v[200:203], v[32:35], v[68:71], v[232:235]
  v_mfma_f32_16x16x32_bf16 v[200:203], v[16:19], v[64:67], v[200:203]
  v_mfma_f32_16x16x32_bf16 v[204:207], v[20:23], v[64:67], v[236:239]
  v_mfma_f32_16x16x32_bf16 v[204:207], v[36:39], v[68:71], v[204:207]
  s_waitcnt lgkmcnt(0)
  s_barrier
  v_mfma_f32_16x16x32_bf16 v[188:191], v[36:39], v[60:63], v[236:239]
  s_nop 0
  ds_read_b128 v[48:51], v5 offset:40960
  v_mfma_f32_16x16x32_bf16 v[188:191], v[20:23], v[56:59], v[188:191]
  ds_read_b128 v[52:55], v7 offset:40960
  v_mfma_f32_16x16x32_bf16 v[192:195], v[24:27], v[56:59], v[240:243]
  v_mfma_f32_16x16x32_bf16 v[192:195], v[40:43], v[60:63], v[192:195]
  v_mfma_f32_16x16x32_bf16 v[208:211], v[40:43], v[68:71], v[240:243]
  v_mfma_f32_16x16x32_bf16 v[208:211], v[24:27], v[64:67], v[208:211]
  v_mfma_f32_16x16x32_bf16 v[212:215], v[28:31], v[64:67], v[244:247]
  ds_read_b128 v[64:67], v5 offset:45056
  v_mfma_f32_16x16x32_bf16 v[212:215], v[44:47], v[68:71], v[212:215]
  ds_read_b128 v[68:71], v7 offset:45056
  v_mfma_f32_16x16x32_bf16 v[196:199], v[44:47], v[60:63], v[244:247]
  ds_read_b128 v[60:63], v7 offset:43008
  v_mfma_f32_16x16x32_bf16 v[196:199], v[28:31], v[56:59], v[196:199]
  ds_read_b128 v[56:59], v5 offset:43008
  v_mfma_f32_16x16x32_bf16 v[216:219], v[32:35], v[76:79], v[216:219]
  v_mfma_f32_16x16x32_bf16 v[216:219], v[16:19], v[72:75], v[216:219]
  v_mfma_f32_16x16x32_bf16 v[232:235], v[16:19], v[80:83], v[232:235]
  ds_read_b64_tr_b16 v[16:17], v1 offset:0
  v_mfma_f32_16x16x32_bf16 v[232:235], v[32:35], v[84:87], v[232:235]
  ds_read_b64_tr_b16 v[18:19], v1 offset:1024
  v_mfma_f32_16x16x32_bf16 v[236:239], v[36:39], v[84:87], v[236:239]
  ds_read_b64_tr_b16 v[32:33], v1 offset:8192
  v_mfma_f32_16x16x32_bf16 v[236:239], v[20:23], v[80:83], v[236:239]
  ds_read_b64_tr_b16 v[34:35], v1 offset:9216
  v_mfma_f32_16x16x32_bf16 v[220:223], v[20:23], v[72:75], v[220:223]
  ds_read_b64_tr_b16 v[20:21], v2 offset:0
  v_mfma_f32_16x16x32_bf16 v[220:223], v[36:39], v[76:79], v[220:223]
  ds_read_b64_tr_b16 v[22:23], v2 offset:1024
  v_mfma_f32_16x16x32_bf16 v[224:227], v[40:43], v[76:79], v[224:227]
  ds_read_b64_tr_b16 v[36:37], v2 offset:8192
  v_mfma_f32_16x16x32_bf16 v[224:227], v[24:27], v[72:75], v[224:227]
  ds_read_b64_tr_b16 v[38:39], v2 offset:9216
  v_mfma_f32_16x16x32_bf16 v[240:243], v[24:27], v[80:83], v[240:243]
  ds_read_b64_tr_b16 v[24:25], v3 offset:0
  v_mfma_f32_16x16x32_bf16 v[240:243], v[40:43], v[84:87], v[240:243]
  ds_read_b64_tr_b16 v[26:27], v3 offset:1024
  v_mfma_f32_16x16x32_bf16 v[244:247], v[44:47], v[84:87], v[244:247]
  ds_read_b64_tr_b16 v[40:41], v3 offset:8192
  v_mfma_f32_16x16x32_bf16 v[244:247], v[28:31], v[80:83], v[244:247]
  ds_read_b64_tr_b16 v[42:43], v3 offset:9216
  v_mfma_f32_16x16x32_bf16 v[228:231], v[28:31], v[72:75], v[228:231]
  ds_read_b64_tr_b16 v[28:29], v4 offset:0
  s_waitcnt lgkmcnt(9)
  v_mfma_f32_16x16x32_bf16 v[228:231], v[44:47], v[76:79], v[228:231]
  ds_read_b64_tr_b16 v[30:31], v4 offset:1024
L_dnn_loop0:
  v_mfma_f32_16x16x32_bf16 v[88:91], v[16:19], v[48:51], v[88:91]
  s_nop 0
  ds_read_b64_tr_b16 v[44:45], v4 offset:8192
  v_mfma_f32_16x16x32_bf16 v[88:91], v[32:35], v[52:55], v[88:91]
  ds_read_b64_tr_b16 v[46:47], v4 offset:9216
  v_mfma_f32_16x16x32_bf16 v[104:107], v[32:35], v[60:63], v[104:107]
  ds_read_b128 v[72:75], v5 offset:47104
  s_waitcnt lgkmcnt(9)
  v_mfma_f32_16x16x32_bf16 v[104:107], v[16:19], v[56:59], v[104:107]
  ds_read_b128 v[76:79], v7 offset:47104
  v_mfma_f32_16x16x32_bf16 v[108:111], v[20:23], v[56:59], v[108:111]
  s_nop 0
  ds_read_b128 v[80:83], v5 offset:49152
  v_mfma_f32_16x16x32_bf16 v[108:111], v[36:39], v[60:63], v[108:111]
  ds_read_b128 v[84:87], v7 offset:49152
  v_mfma_f32_16x16x32_bf16 v[92:95], v[36:39], v[52:55], v[92:95]
  s_waitcnt lgkmcnt(8)
  v_mfma_f32_16x16x32_bf16 v[92:95], v[20:23], v[48:51], v[92:95]
  v_mfma_f32_16x16x32_bf16 v[96:99], v[24:27], v[48:51], v[96:99]
  s_nop 0
  v_xor_b32 v1, 16384, v1
  v_mfma_f32_16x16x32_bf16 v[96:99], v[40:43], v[52:55], v[96:99]
  v_xor_b32 v2, 16384, v2
  v_mfma_f32_16x16x32_bf16 v[112:115], v[40:43], v[60:63], v[112:115]
  v_xor_b32 v3, 16384, v3
  s_waitcnt lgkmcnt(4)
  v_mfma_f32_16x16x32_bf16 v[112:115], v[24:27], v[56:59], v[112:115]
  v_xor_b32 v4, 16384, v4
  v_mfma_f32_16x16x32_bf16 v[116:119], v[28:31], v[56:59], v[116:119]
  s_nop 0
  ds_read_b128 v[56:59], v5 offset:53248
  v_mfma_f32_16x16x32_bf16 v[116:119], v[44:47], v[60:63], v[116:119]
  ds_read_b128 v[60:63], v7 offset:53248
  v_mfma_f32_16x16x32_bf16 v[100:103], v[44:47], v[52:55], v[100:103]
  ds_read_b128 v[52:55], v7 offset:51200
  v_mfma_f32_16x16x32_bf16 v[100:103], v[28:31], v[48:51], v[100:103]
  ds_read_b128 v[48:51], v5 offset:51200
  v_mfma_f32_16x16x32_bf16 v[120:123], v[16:19], v[64:67], v[120:123]
  s_waitcnt lgkmcnt(6)
  v_mfma_f32_16x16x32_bf16 v[120:123], v[32:35], v[68:71], v[120:123]
  v_mfma_f32_16x16x32_bf16 v[136:139], v[32:35], v[76:79], v[136:139]
  v_mfma_f32_16x16x32_bf16 v[136:139], v[16:19], v[72:75], v[136:139]
  v_mfma_f32_16x16x32_bf16 v[140:143], v[20:23], v[72:75], v[140:143]
  v_mfma_f32_16x16x32_bf16 v[140:143], v[36:39], v[76:79], v[140:143]
  v_mfma_f32_16x16x32_bf16 v[124:127], v[36:39], v[68:71], v[124:127]
  v_mfma_f32_16x16x32_bf16 v[124:127], v[20:23], v[64:67], v[124:127]
  s_nop 0
  v_mfma_f32_16x16x32_bf16 v[128:131], v[24:27], v[64:67], v[128:131]
  v_mfma_f32_16x16x32_bf16 v[128:131], v[40:43], v[68:71], v[128:131]
  v_mfma_f32_16x16x32_bf16 v[144:147], v[40:43], v[76:79], v[144:147]
  v_mfma_f32_16x16x32_bf16 v[144:147], v[24:27], v[72:75], v[144:147]
  v_mfma_f32_16x16x32_bf16 v[148:151], v[28:31], v[72:75], v[148:151]
  ds_read_b128 v[72:75], v5 offset:57344
  v_mfma_f32_16x16x32_bf16 v[148:151], v[44:47], v[76:79], v[148:151]
  ds_read_b128 v[76:79], v7 offset:57344
  v_mfma_f32_16x16x32_bf16 v[132:135], v[44:47], v[68:71], v[132:135]
  ds_read_b128 v[68:71], v7 offset:55296
  s_waitcnt lgkmcnt(7)
  v_mfma_f32_16x16x32_bf16 v[132:135], v[28:31], v[64:67], v[132:135]
  ds_read_b128 v[64:67], v5 offset:55296
  v_mfma_f32_16x16x32_bf16 v[152:155], v[16:19], v[80:83], v[152:155]
  s_waitcnt lgkmcnt(4)
  v_mfma_f32_16x16x32_bf16 v[152:155], v[32:35], v[84:87], v[152:155]
  v_mfma_f32_16x16x32_bf16 v[168:171], v[32:35], v[52:55], v[168:171]
  v_mfma_f32_16x16x32_bf16 v[168:171], v[16:19], v[48:51], v[168:171]
  v_mfma_f32_16x16x32_bf16 v[172:175], v[20:23], v[48:51], v[172:175]
  v_mfma_f32_16x16x32_bf16 v[172:175], v[36:39], v[52:55], v[172:175]
  v_mfma_f32_16x16x32_bf16 v[156:159], v[36:39], v[84:87], v[156:159]
  v_mfma_f32_16x16x32_bf16 v[156:159], v[20:23], v[80:83], v[156:159]
  v_mfma_f32_16x16x32_bf16 v[160:163], v[24:27], v[80:83], v[160:163]
  v_mfma_f32_16x16x32_bf16 v[160:163], v[40:43], v[84:87], v[160:163]
  v_mfma_f32_16x16x32_bf16 v[176:179], v[40:43], v[52:55], v[176:179]
  v_mfma_f32_16x16x32_bf16 v[176:179], v[24:27], v[48:51], v[176:179]
  v_mfma_f32_16x16x32_bf16 v[180:183], v[28:31], v[48:51], v[180:183]
  v_mfma_f32_16x16x32_bf16 v[180:183], v[44:47], v[52:55], v[180:183]
  v_mfma_f32_16x16x32_bf16 v[164:167], v[44:47], v[84:87], v[164:167]
  ds_read_b128 v[84:87], v7 offset:59392
  v_mfma_f32_16x16x32_bf16 v[164:167], v[28:31], v[80:83], v[164:167]
  ds_read_b128 v[80:83], v5 offset:59392
  v_mfma_f32_16x16x32_bf16 v[184:187], v[16:19], v[56:59], v[184:187]
  s_waitcnt lgkmcnt(2)
  v_mfma_f32_16x16x32_bf16 v[184:187], v[32:35], v[60:63], v[184:187]
  v_mfma_f32_16x16x32_bf16 v[200:203], v[32:35], v[68:71], v[200:203]
  v_mfma_f32_16x16x32_bf16 v[200:203], v[16:19], v[64:67], v[200:203]
  v_mfma_f32_16x16x32_bf16 v[204:207], v[20:23], v[64:67], v[204:207]
  v_mfma_f32_16x16x32_bf16 v[204:207], v[36:39], v[68:71], v[204:207]
  s_waitcnt lgkmcnt(0)
  s_barrier
  v_mfma_f32_16x16x32_bf16 v[188:191], v[36:39], v[60:63], v[188:191]
  s_nop 0
  ds_read_b128 v[48:51], v6 offset:0
  v_mfma_f32_16x16x32_bf16 v[188:191], v[20:23], v[56:59], v[188:191]
  ds_read_b128 v[52:55], v8 offset:0
  v_mfma_f32_16x16x32_bf16 v[192:195], v[24:27], v[56:59], v[192:195]
  v_mfma_f32_16x16x32_bf16 v[192:195], v[40:43], v[60:63], v[192:195]
  v_mfma_f32_16x16x32_bf16 v[208:211], v[40:43], v[68:71], v[208:211]
  v_mfma_f32_16x16x32_bf16 v[208:211], v[24:27], v[64:67], v[208:211]
  v_mfma_f32_16x16x32_bf16 v[212:215], v[28:31], v[64:67], v[212:215]
  ds_read_b128 v[64:67], v6 offset:4096
  v_mfma_f32_16x16x32_bf16 v[212:215], v[44:47], v[68:71], v[212:215]
  ds_read_b128 v[68:71], v8 offset:4096
  v_mfma_f32_16x16x32_bf16 v[196:199], v[44:47], v[60:63], v[196:199]
  ds_read_b128 v[60:63], v8 offset:2048
  v_mfma_f32_16x16x32_bf16 v[196:199], v[28:31], v[56:59], v[196:199]
  ds_read_b128 v[56:59], v6 offset:2048
  v_mfma_f32_16x16x32_bf16 v[216:219], v[32:35], v[76:79], v[216:219]
  v_mfma_f32_16x16x32_bf16 v[216:219], v[16:19], v[72:75], v[216:219]
  v_mfma_f32_16x16x32_bf16 v[232:235], v[16:19], v[80:83], v[232:235]
  ds_read_b64_tr_b16 v[16:17], v1 offset:0
  v_mfma_f32_16x16x32_bf16 v[232:235], v[32:35], v[84:87], v[232:235]
  ds_read_b64_tr_b16 v[18:19], v1 offset:1024
  v_mfma_f32_16x16x32_bf16 v[236:239], v[36:39], v[84:87], v[236:239]
  ds_read_b64_tr_b16 v[32:33], v1 offset:8192
  v_mfma_f32_16x16x32_bf16 v[236:239], v[20:23], v[80:83], v[236:239]
  ds_read_b64_tr_b16 v[34:35], v1 offset:9216
  v_mfma_f32_16x16x32_bf16 v[220:223], v[20:23], v[72:75], v[220:223]
  ds_read_b64_tr_b16 v[20:21], v2 offset:0
  v_mfma_f32_16x16x32_bf16 v[220:223], v[36:39], v[76:79], v[220:223]
  ds_read_b64_tr_b16 v[22:23], v2 offset:1024
  v_mfma_f32_16x16x32_bf16 v[224:227], v[40:43], v[76:79], v[224:227]
  ds_read_b64_tr_b16 v[36:37], v2 offset:8192
  v_mfma_f32_16x16x32_bf16 v[224:227], v[24:27], v[72:75], v[224:227]
  ds_read_b64_tr_b16 v[38:39], v2 offset:9216
  v_mfma_f32_16x16x32_bf16 v[240:243], v[24:27], v[80:83], v[240:243]
  ds_read_b64_tr_b16 v[24:25], v3 offset:0
  v_mfma_f32_16x16x32_bf16 v[240:243], v[40:43], v[84:87], v[240:243]
  ds_read_b64_tr_b16 v[26:27], v3 offset:1024
  v_mfma_f32_16x16x32_bf16 v[244:247], v[44:47], v[84:87], v[244:247]
  ds_read_b64_tr_b16 v[40:41], v3 offset:8192
  v_mfma_f32_16x16x32_bf16 v[244:247], v[28:31], v[80:83], v[244:247]
  ds_read_b64_tr_b16 v[42:43], v3 offset:9216
  v_mfma_f32_16x16x32_bf16 v[228:231], v[28:31], v[72:75], v[228:231]
  ds_read_b64_tr_b16 v[28:29], v4 offset:0
  s_waitcnt lgkmcnt(9)
  v_mfma_f32_16x16x32_bf16 v[228:231], v[44:47], v[76:79], v[228:231]
  ds_read_b64_tr_b16 v[30:31], v4 offset:1024
  v_mfma_f32_16x16x32_bf16 v[88:91], v[16:19], v[48:51], v[88:91]
  s_nop 0
  ds_read_b64_tr_b16 v[44:45], v4 offset:8192
  v_mfma_f32_16x16x32_bf16 v[88:91], v[32:35], v[52:55], v[88:91]
  ds_read_b64_tr_b16 v[46:47], v4 offset:9216
  v_mfma_f32_16x16x32_bf16 v[104:107], v[32:35], v[60:63], v[104:107]
  ds_read_b128 v[72:75], v6 offset:6144
  s_waitcnt lgkmcnt(9)
  v_mfma_f32_16x16x32_bf16 v[104:107], v[16:19], v[56:59], v[104:107]
  ds_read_b128 v[76:79], v8 offset:6144
  v_mfma_f32_16x16x32_bf16 v[108:111], v[20:23], v[56:59], v[108:111]
  s_nop 0
  ds_read_b128 v[80:83], v6 offset:8192
  v_mfma_f32_16x16x32_bf16 v[108:111], v[36:39], v[60:63], v[108:111]
  ds_read_b128 v[84:87], v8 offset:8192
  v_mfma_f32_16x16x32_bf16 v[92:95], v[36:39], v[52:55], v[92:95]
  s_waitcnt lgkmcnt(8)
  v_mfma_f32_16x16x32_bf16 v[92:95], v[20:23], v[48:51], v[92:95]
  v_mfma_f32_16x16x32_bf16 v[96:99], v[24:27], v[48:51], v[96:99]
  s_nop 0
  v_xor_b32 v1, 16384, v1
  v_mfma_f32_16x16x32_bf16 v[96:99], v[40:43], v[52:55], v[96:99]
  v_xor_b32 v2, 16384, v2
  v_mfma_f32_16x16x32_bf16 v[112:115], v[40:43], v[60:63], v[112:115]
  v_xor_b32 v3, 16384, v3
  s_waitcnt lgkmcnt(4)
  v_mfma_f32_16x16x32_bf16 v[112:115], v[24:27], v[56:59], v[112:115]
  v_xor_b32 v4, 16384, v4
  v_mfma_f32_16x16x32_bf16 v[116:119], v[28:31], v[56:59], v[116:119]
  s_nop 0
  ds_read_b128 v[56:59], v6 offset:12288
  v_mfma_f32_16x16x32_bf16 v[116:119], v[44:47], v[60:63], v[116:119]
  ds_read_b128 v[60:63], v8 offset:12288
  v_mfma_f32_16x16x32_bf16 v[100:103], v[44:47], v[52:55], v[100:103]
  ds_read_b128 v[52:55], v8 offset:10240
  v_mfma_f32_16x16x32_bf16 v[100:103], v[28:31], v[48:51], v[100:103]
  ds_read_b128 v[48:51], v6 offset:10240
  v_mfma_f32_16x16x32_bf16 v[120:123], v[16:19], v[64:67], v[120:123]
  s_waitcnt lgkmcnt(6)
  v_mfma_f32_16x16x32_bf16 v[120:123], v[32:35], v[68:71], v[120:123]
  v_mfma_f32_16x16x32_bf16 v[136:139], v[32:35], v[76:79], v[136:139]
  v_mfma_f32_16x16x32_bf16 v[136:139], v[16:19], v[72:75], v[136:139]
  v_mfma_f32_16x16x32_bf16 v[140:143], v[20:23], v[72:75], v[140:143]
  v_mfma_f32_16x16x32_bf16 v[140:143], v[36:39], v[76:79], v[140:143]
  v_mfma_f32_16x16x32_bf16 v[124:127], v[36:39], v[68:71], v[124:127]
  v_mfma_f32_16x16x32_bf16 v[124:127], v[20:23], v[64:67], v[124:127]
  s_nop 0
  v_mfma_f32_16x16x32_bf16 v[128:131], v[24:27], v[64:67], v[128:131]
  v_mfma_f32_16x16x32_bf16 v[128:131], v[40:43], v[68:71], v[128:131]
  v_mfma_f32_16x16x32_bf16 v[144:147], v[40:43], v[76:79], v[144:147]
  v_mfma_f32_16x16x32_bf16 v[144:147], v[24:27], v[72:75], v[144:147]
  v_mfma_f32_16x16x32_bf16 v[148:151], v[28:31], v[72:75], v[148:151]
  ds_read_b128 v[72:75], v6 offset:16384
  v_mfma_f32_16x16x32_bf16 v[148:151], v[44:47], v[76:79], v[148:151]
  ds_read_b128 v[76:79], v8 offset:16384
  v_mfma_f32_16x16x32_bf16 v[132:135], v[44:47], v[68:71], v[132:135]
  ds_read_b128 v[68:71], v8 offset:14336
  s_waitcnt lgkmcnt(7)
  v_mfma_f32_16x16x32_bf16 v[132:135], v[28:31], v[64:67], v[132:135]
  ds_read_b128 v[64:67], v6 offset:14336
  v_mfma_f32_16x16x32_bf16 v[152:155], v[16:19], v[80:83], v[152:155]
  s_waitcnt lgkmcnt(4)
  v_mfma_f32_16x16x32_bf16 v[152:155], v[32:35], v[84:87], v[152:155]
  v_mfma_f32_16x16x32_bf16 v[168:171], v[32:35], v[52:55], v[168:171]
  v_mfma_f32_16x16x32_bf16 v[168:171], v[16:19], v[48:51], v[168:171]
  v_mfma_f32_16x16x32_bf16 v[172:175], v[20:23], v[48:51], v[172:175]
  v_mfma_f32_16x16x32_bf16 v[172:175], v[36:39], v[52:55], v[172:175]
  v_mfma_f32_16x16x32_bf16 v[156:159], v[36:39], v[84:87], v[156:159]
  v_mfma_f32_16x16x32_bf16 v[156:159], v[20:23], v[80:83], v[156:159]
  v_mfma_f32_16x16x32_bf16 v[160:163], v[24:27], v[80:83], v[160:163]
  v_mfma_f32_16x16x32_bf16 v[160:163], v[40:43], v[84:87], v[160:163]
  v_mfma_f32_16x16x32_bf16 v[176:179], v[40:43], v[52:55], v[176:179]
  v_mfma_f32_16x16x32_bf16 v[176:179], v[24:27], v[48:51], v[176:179]
  v_mfma_f32_16x16x32_bf16 v[180:183], v[28:31], v[48:51], v[180:183]
  v_mfma_f32_16x16x32_bf16 v[180:183], v[44:47], v[52:55], v[180:183]
  v_mfma_f32_16x16x32_bf16 v[164:167], v[44:47], v[84:87], v[164:167]
  ds_read_b128 v[84:87], v8 offset:18432
  v_mfma_f32_16x16x32_bf16 v[164:167], v[28:31], v[80:83], v[164:167]
  ds_read_b128 v[80:83], v6 offset:18432
  v_mfma_f32_16x16x32_bf16 v[184:187], v[16:19], v[56:59], v[184:187]
  s_waitcnt lgkmcnt(2)
  v_mfma_f32_16x16x32_bf16 v[184:187], v[32:35], v[60:63], v[184:187]
  v_mfma_f32_16x16x32_bf16 v[200:203], v[32:35], v[68:71], v[200:203]
  v_mfma_f32_16x16x32_bf16 v[200:203], v[16:19], v[64:67], v[200:203]
  v_mfma_f32_16x16x32_bf16 v[204:207], v[20:23], v[64:67], v[204:207]
  v_mfma_f32_16x16x32_bf16 v[204:207], v[36:39], v[68:71], v[204:207]
  s_waitcnt lgkmcnt(0)
  s_barrier
  v_mfma_f32_16x16x32_bf16 v[188:191], v[36:39], v[60:63], v[188:191]
  s_nop 0
  ds_read_b128 v[48:51], v5 offset:0
  v_mfma_f32_16x16x32_bf16 v[188:191], v[20:23], v[56:59], v[188:191]
  ds_read_b128 v[52:55], v7 offset:0
  v_mfma_f32_16x16x32_bf16 v[192:195], v[24:27], v[56:59], v[192:195]
  v_mfma_f32_16x16x32_bf16 v[192:195], v[40:43], v[60:63], v[192:195]
  v_mfma_f32_16x16x32_bf16 v[208:211], v[40:43], v[68:71], v[208:211]
  v_mfma_f32_16x16x32_bf16 v[208:211], v[24:27], v[64:67], v[208:211]
  v_mfma_f32_16x16x32_bf16 v[212:215], v[28:31], v[64:67], v[212:215]
  ds_read_b128 v[64:67], v5 offset:4096
  v_mfma_f32_16x16x32_bf16 v[212:215], v[44:47], v[68:71], v[212:215]
  ds_read_b128 v[68:71], v7 offset:4096
  v_mfma_f32_16x16x32_bf16 v[196:199], v[44:47], v[60:63], v[196:199]
  ds_read_b128 v[60:63], v7 offset:2048
  v_mfma_f32_16x16x32_bf16 v[196:199], v[28:31], v[56:59], v[196:199]
  ds_read_b128 v[56:59], v5 offset:2048
  v_mfma_f32_16x16x32_bf16 v[216:219], v[32:35], v[76:79], v[216:219]
  v_mfma_f32_16x16x32_bf16 v[216:219], v[16:19], v[72:75], v[216:219]
  v_mfma_f32_16x16x32_bf16 v[232:235], v[16:19], v[80:83], v[232:235]
  ds_read_b64_tr_b16 v[16:17], v1 offset:0
  v_mfma_f32_16x16x32_bf16 v[232:235], v[32:35], v[84:87], v[232:235]
  ds_read_b64_tr_b16 v[18:19], v1 offset:1024
  v_mfma_f32_16x16x32_bf16 v[236:239], v[36:39], v[84:87], v[236:239]
  ds_read_b64_tr_b16 v[32:33], v1 offset:8192
  v_mfma_f32_16x16x32_bf16 v[236:239], v[20:23], v[80:83], v[236:239]
  ds_read_b64_tr_b16 v[34:35], v1 offset:9216
  v_mfma_f32_16x16x32_bf16 v[220:223], v[20:23], v[72:75], v[220:223]
  ds_read_b64_tr_b16 v[20:21], v2 offset:0
  v_mfma_f32_16x16x32_bf16 v[220:223], v[36:39], v[76:79], v[220:223]
  ds_read_b64_tr_b16 v[22:23], v2 offset:1024
  v_mfma_f32_16x16x32_bf16 v[224:227], v[40:43], v[76:79], v[224:227]
  ds_read_b64_tr_b16 v[36:37], v2 offset:8192
  v_mfma_f32_16x16x32_bf16 v[224:227], v[24:27], v[72:75], v[224:227]
  ds_read_b64_tr_b16 v[38:39], v2 offset:9216
  v_mfma_f32_16x16x32_bf16 v[240:243], v[24:27], v[80:83], v[240:243]
  ds_read_b64_tr_b16 v[24:25], v3 offset:0
  v_mfma_f32_16x16x32_bf16 v[240:243], v[40:43], v[84:87], v[240:243]
  ds_read_b64_tr_b16 v[26:27], v3 offset:1024
  v_mfma_f32_16x16x32_bf16 v[244:247], v[44:47], v[84:87], v[244:247]
  ds_read_b64_tr_b16 v[40:41], v3 offset:8192
  v_mfma_f32_16x16x32_bf16 v[244:247], v[28:31], v[80:83], v[244:247]
  ds_read_b64_tr_b16 v[42:43], v3 offset:9216
  v_mfma_f32_16x16x32_bf16 v[228:231], v[28:31], v[72:75], v[228:231]
  ds_read_b64_tr_b16 v[28:29], v4 offset:0
  s_waitcnt lgkmcnt(9)
  v_mfma_f32_16x16x32_bf16 v[228:231], v[44:47], v[76:79], v[228:231]
  ds_read_b64_tr_b16 v[30:31], v4 offset:1024
  v_mfma_f32_16x16x32_bf16 v[88:91], v[16:19], v[48:51], v[88:91]
  s_nop 0
  ds_read_b64_tr_b16 v[44:45], v4 offset:8192
  v_mfma_f32_16x16x32_bf16 v[88:91], v[32:35], v[52:55], v[88:91]
  ds_read_b64_tr_b16 v[46:47], v4 offset:9216
  v_mfma_f32_16x16x32_bf16 v[104:107], v[32:35], v[60:63], v[104:107]
  ds_read_b128 v[72:75], v5 offset:6144
  s_waitcnt lgkmcnt(9)
  v_mfma_f32_16x16x32_bf16 v[104:107], v[16:19], v[56:59], v[104:107]
  ds_read_b128 v[76:79], v7 offset:6144
  v_mfma_f32_16x16x32_bf16 v[108:111], v[20:23], v[56:59], v[108:111]
  s_nop 0
  ds_read_b128 v[80:83], v5 offset:8192
  v_mfma_f32_16x16x32_bf16 v[108:111], v[36:39], v[60:63], v[108:111]
  ds_read_b128 v[84:87], v7 offset:8192
  v_mfma_f32_16x16x32_bf16 v[92:95], v[36:39], v[52:55], v[92:95]
  s_waitcnt lgkmcnt(8)
  v_mfma_f32_16x16x32_bf16 v[92:95], v[20:23], v[48:51], v[92:95]
  v_mfma_f32_16x16x32_bf16 v[96:99], v[24:27], v[48:51], v[96:99]
  s_nop 0
  v_xor_b32 v1, 16384, v1
  v_mfma_f32_16x16x32_bf16 v[96:99], v[40:43], v[52:55], v[96:99]
  v_xor_b32 v2, 16384, v2
  v_mfma_f32_16x16x32_bf16 v[112:115], v[40:43], v[60:63], v[112:115]
  v_xor_b32 v3, 16384, v3
  s_waitcnt lgkmcnt(4)
  v_mfma_f32_16x16x32_bf16 v[112:115], v[24:27], v[56:59], v[112:115]
  v_xor_b32 v4, 16384, v4
  v_mfma_f32_16x16x32_bf16 v[116:119], v[28:31], v[56:59], v[116:119]
  s_nop 0
  ds_read_b128 v[56:59], v5 offset:12288
  v_mfma_f32_16x16x32_bf16 v[116:119], v[44:47], v[60:63], v[116:119]
  ds_read_b128 v[60:63], v7 offset:12288
  v_mfma_f32_16x16x32_bf16 v[100:103], v[44:47], v[52:55], v[100:103]
  ds_read_b128 v[52:55], v7 offset:10240
  v_mfma_f32_16x16x32_bf16 v[100:103], v[28:31], v[48:51], v[100:103]
  ds_read_b128 v[48:51], v5 offset:10240
  v_mfma_f32_16x16x32_bf16 v[120:123], v[16:19], v[64:67], v[120:123]
  s_waitcnt lgkmcnt(6)
  v_mfma_f32_16x16x32_bf16 v[120:123], v[32:35], v[68:71], v[120:123]
  v_mfma_f32_16x16x32_bf16 v[136:139], v[32:35], v[76:79], v[136:139]
  v_mfma_f32_16x16x32_bf16 v[136:139], v[16:19], v[72:75], v[136:139]
  v_mfma_f32_16x16x32_bf16 v[140:143], v[20:23], v[72:75], v[140:143]
  v_mfma_f32_16x16x32_bf16 v[140:143], v[36:39], v[76:79], v[140:143]
  v_mfma_f32_16x16x32_bf16 v[124:127], v[36:39], v[68:71], v[124:127]
  v_mfma_f32_16x16x32_bf16 v[124:127], v[20:23], v[64:67], v[124:127]
  s_nop 0
  v_mfma_f32_16x16x32_bf16 v[128:131], v[24:27], v[64:67], v[128:131]
  v_mfma_f32_16x16x32_bf16 v[128:131], v[40:43], v[68:71], v[128:131]
  v_mfma_f32_16x16x32_bf16 v[144:147], v[40:43], v[76:79], v[144:147]
  v_mfma_f32_16x16x32_bf16 v[144:147], v[24:27], v[72:75], v[144:147]
  v_mfma_f32_16x16x32_bf16 v[148:151], v[28:31], v[72:75], v[148:151]
  ds_read_b128 v[72:75], v5 offset:16384
  v_mfma_f32_16x16x32_bf16 v[148:151], v[44:47], v[76:79], v[148:151]
  ds_read_b128 v[76:79], v7 offset:16384
  v_mfma_f32_16x16x32_bf16 v[132:135], v[44:47], v[68:71], v[132:135]
  ds_read_b128 v[68:71], v7 offset:14336
  s_waitcnt lgkmcnt(7)
  v_mfma_f32_16x16x32_bf16 v[132:135], v[28:31], v[64:67], v[132:135]
  ds_read_b128 v[64:67], v5 offset:14336
  v_mfma_f32_16x16x32_bf16 v[152:155], v[16:19], v[80:83], v[152:155]
  s_waitcnt lgkmcnt(4)
  v_mfma_f32_16x16x32_bf16 v[152:155], v[32:35], v[84:87], v[152:155]
  v_mfma_f32_16x16x32_bf16 v[168:171], v[32:35], v[52:55], v[168:171]
  v_mfma_f32_16x16x32_bf16 v[168:171], v[16:19], v[48:51], v[168:171]
  v_mfma_f32_16x16x32_bf16 v[172:175], v[20:23], v[48:51], v[172:175]
  v_mfma_f32_16x16x32_bf16 v[172:175], v[36:39], v[52:55], v[172:175]
  v_mfma_f32_16x16x32_bf16 v[156:159], v[36:39], v[84:87], v[156:159]
  v_mfma_f32_16x16x32_bf16 v[156:159], v[20:23], v[80:83], v[156:159]
  v_mfma_f32_16x16x32_bf16 v[160:163], v[24:27], v[80:83], v[160:163]
  v_mfma_f32_16x16x32_bf16 v[160:163], v[40:43], v[84:87], v[160:163]
  v_mfma_f32_16x16x32_bf16 v[176:179], v[40:43], v[52:55], v[176:179]
  v_mfma_f32_16x16x32_bf16 v[176:179], v[24:27], v[48:51], v[176:179]
  v_mfma_f32_16x16x32_bf16 v[180:183], v[28:31], v[48:51], v[180:183]
  v_mfma_f32_16x16x32_bf16 v[180:183], v[44:47], v[52:55], v[180:183]
  v_mfma_f32_16x16x32_bf16 v[164:167], v[44:47], v[84:87], v[164:167]
  ds_read_b128 v[84:87], v7 offset:18432
  v_mfma_f32_16x16x32_bf16 v[164:167], v[28:31], v[80:83], v[164:167]
  ds_read_b128 v[80:83], v5 offset:18432
  v_mfma_f32_16x16x32_bf16 v[184:187], v[16:19], v[56:59], v[184:187]
  s_waitcnt lgkmcnt(2)
  s_add_u32 s72, s72, 1
  s_cmp_lt_u32 s72, 8
  v_mfma_f32_16x16x32_bf16 v[184:187], v[32:35], v[60:63], v[184:187]
  v_mfma_f32_16x16x32_bf16 v[200:203], v[32:35], v[68:71], v[200:203]
  v_mfma_f32_16x16x32_bf16 v[200:203], v[16:19], v[64:67], v[200:203]
  v_mfma_f32_16x16x32_bf16 v[204:207], v[20:23], v[64:67], v[204:207]
  s_nop 0
  v_mfma_f32_16x16x32_bf16 v[204:207], v[36:39], v[68:71], v[204:207]
  s_waitcnt lgkmcnt(0)
  s_barrier
  v_mfma_f32_16x16x32_bf16 v[188:191], v[36:39], v[60:63], v[188:191]
  ds_read_b128 v[48:51], v5 offset:40960
  v_mfma_f32_16x16x32_bf16 v[188:191], v[20:23], v[56:59], v[188:191]
  ds_read_b128 v[52:55], v7 offset:40960
  v_mfma_f32_16x16x32_bf16 v[192:195], v[24:27], v[56:59], v[192:195]
  v_mfma_f32_16x16x32_bf16 v[192:195], v[40:43], v[60:63], v[192:195]
  v_mfma_f32_16x16x32_bf16 v[208:211], v[40:43], v[68:71], v[208:211]
  v_mfma_f32_16x16x32_bf16 v[208:211], v[24:27], v[64:67], v[208:211]
  v_mfma_f32_16x16x32_bf16 v[212:215], v[28:31], v[64:67], v[212:215]
  ds_read_b128 v[64:67], v5 offset:45056
  v_mfma_f32_16x16x32_bf16 v[212:215], v[44:47], v[68:71], v[212:215]
  ds_read_b128 v[68:71], v7 offset:45056
  v_mfma_f32_16x16x32_bf16 v[196:199], v[44:47], v[60:63], v[196:199]
  ds_read_b128 v[60:63], v7 offset:43008
  v_mfma_f32_16x16x32_bf16 v[196:199], v[28:31], v[56:59], v[196:199]
  ds_read_b128 v[56:59], v5 offset:43008
  v_mfma_f32_16x16x32_bf16 v[216:219], v[32:35], v[76:79], v[216:219]
  v_mfma_f32_16x16x32_bf16 v[216:219], v[16:19], v[72:75], v[216:219]
  v_mfma_f32_16x16x32_bf16 v[232:235], v[16:19], v[80:83], v[232:235]
  ds_read_b64_tr_b16 v[16:17], v1 offset:0
  v_mfma_f32_16x16x32_bf16 v[232:235], v[32:35], v[84:87], v[232:235]
  ds_read_b64_tr_b16 v[18:19], v1 offset:1024
  v_mfma_f32_16x16x32_bf16 v[236:239], v[36:39], v[84:87], v[236:239]
  ds_read_b64_tr_b16 v[32:33], v1 offset:8192
  v_mfma_f32_16x16x32_bf16 v[236:239], v[20:23], v[80:83], v[236:239]
  ds_read_b64_tr_b16 v[34:35], v1 offset:9216
  v_mfma_f32_16x16x32_bf16 v[220:223], v[20:23], v[72:75], v[220:223]
  ds_read_b64_tr_b16 v[20:21], v2 offset:0
  v_mfma_f32_16x16x32_bf16 v[220:223], v[36:39], v[76:79], v[220:223]
  ds_read_b64_tr_b16 v[22:23], v2 offset:1024
  v_mfma_f32_16x16x32_bf16 v[224:227], v[40:43], v[76:79], v[224:227]
  ds_read_b64_tr_b16 v[36:37], v2 offset:8192
  v_mfma_f32_16x16x32_bf16 v[224:227], v[24:27], v[72:75], v[224:227]
  ds_read_b64_tr_b16 v[38:39], v2 offset:9216
  v_mfma_f32_16x16x32_bf16 v[240:243], v[24:27], v[80:83], v[240:243]
  ds_read_b64_tr_b16 v[24:25], v3 offset:0
  v_mfma_f32_16x16x32_bf16 v[240:243], v[40:43], v[84:87], v[240:243]
  ds_read_b64_tr_b16 v[26:27], v3 offset:1024
  v_mfma_f32_16x16x32_bf16 v[244:247], v[44:47], v[84:87], v[244:247]
  ds_read_b64_tr_b16 v[40:41], v3 offset:8192
  v_mfma_f32_16x16x32_bf16 v[244:247], v[28:31], v[80:83], v[244:247]
  ds_read_b64_tr_b16 v[42:43], v3 offset:9216
  v_mfma_f32_16x16x32_bf16 v[228:231], v[28:31], v[72:75], v[228:231]
  ds_read_b64_tr_b16 v[28:29], v4 offset:0
  s_waitcnt lgkmcnt(9)
  v_mfma_f32_16x16x32_bf16 v[228:231], v[44:47], v[76:79], v[228:231]
  ds_read_b64_tr_b16 v[30:31], v4 offset:1024
  s_cbranch_scc1 L_dnn_loop0
L_tail:
  v_mfma_f32_16x16x32_bf16 v[88:91], v[16:19], v[48:51], v[88:91]
  ds_read_b64_tr_b16 v[44:45], v4 offset:8192
  v_mfma_f32_16x16x32_bf16 v[88:91], v[32:35], v[52:55], v[88:91]
  ds_read_b64_tr_b16 v[46:47], v4 offset:9216
  v_mfma_f32_16x16x32_bf16 v[104:107], v[32:35], v[60:63], v[104:107]
  ds_read_b128 v[72:75], v5 offset:47104
  s_waitcnt lgkmcnt(9)
  v_mfma_f32_16x16x32_bf16 v[104:107], v[16:19], v[56:59], v[104:107]
  s_nop 0
  ds_read_b128 v[76:79], v7 offset:47104
  v_mfma_f32_16x16x32_bf16 v[108:111], v[20:23], v[56:59], v[108:111]
  ds_read_b128 v[80:83], v5 offset:49152
  v_mfma_f32_16x16x32_bf16 v[108:111], v[36:39], v[60:63], v[108:111]
  ds_read_b128 v[84:87], v7 offset:49152
  v_mul_f32 v11, v88, v88
  v_mfma_f32_16x16x32_bf16 v[92:95], v[36:39], v[52:55], v[92:95]
  s_waitcnt lgkmcnt(8)
  v_mul_f32 v248, v89, v89
  v_mul_f32 v249, v90, v90
  v_mfma_f32_16x16x32_bf16 v[92:95], v[20:23], v[48:51], v[92:95]
  v_mul_f32 v250, v91, v91
  v_fma_f32 v11, v11, v14, v12
  v_mfma_f32_16x16x32_bf16 v[96:99], v[24:27], v[48:51], v[96:99]
  v_fma_f32 v248, v248, v14, v12
  v_fma_f32 v249, v249, v14, v12
  v_mfma_f32_16x16x32_bf16 v[96:99], v[40:43], v[52:55], v[96:99]
  v_fma_f32 v250, v250, v14, v12
  v_mul_f32 v11, v11, v88
  v_mfma_f32_16x16x32_bf16 v[112:115], v[40:43], v[60:63], v[112:115]
  s_waitcnt lgkmcnt(4)
  v_mul_f32 v248, v248, v89
  v_mul_f32 v249, v249, v90
  v_mfma_f32_16x16x32_bf16 v[112:115], v[24:27], v[56:59], v[112:115]
  v_mul_f32 v250, v250, v91
  v_mfma_f32_16x16x32_bf16 v[116:119], v[28:31], v[56:59], v[116:119]
  ds_read_b128 v[56:59], v5 offset:53248
  v_mfma_f32_16x16x32_bf16 v[116:119], v[44:47], v[60:63], v[116:119]
  ds_read_b128 v[60:63], v7 offset:53248
  v_mfma_f32_16x16x32_bf16 v[100:103], v[44:47], v[52:55], v[100:103]
  ds_read_b128 v[52:55], v7 offset:51200
  v_mfma_f32_16x16x32_bf16 v[100:103], v[28:31], v[48:51], v[100:103]
  ds_read_b128 v[48:51], v5 offset:51200
  v_mfma_f32_16x16x32_bf16 v[120:123], v[16:19], v[64:67], v[120:123]
  s_waitcnt lgkmcnt(6)
  v_exp_f32 v11, v11
  v_mfma_f32_16x16x32_bf16 v[120:123], v[32:35], v[68:71], v[120:123]
  v_exp_f32 v248, v248
  v_mfma_f32_16x16x32_bf16 v[136:139], v[32:35], v[76:79], v[136:139]
  v_exp_f32 v249, v249
  v_mfma_f32_16x16x32_bf16 v[136:139], v[16:19], v[72:75], v[136:139]
  v_exp_f32 v250, v250
  v_mfma_f32_16x16x32_bf16 v[140:143], v[20:23], v[72:75], v[140:143]
  v_add_f32 v11, 1.0, v11
  v_add_f32 v248, 1.0, v248
  v_mfma_f32_16x16x32_bf16 v[140:143], v[36:39], v[76:79], v[140:143]
  v_add_f32 v249, 1.0, v249
  v_add_f32 v250, 1.0, v250
  v_mfma_f32_16x16x32_bf16 v[124:127], v[36:39], v[68:71], v[124:127]
  v_rcp_f32 v11, v11
  v_mfma_f32_16x16x32_bf16 v[124:127], v[20:23], v[64:67], v[124:127]
  v_rcp_f32 v248, v248
  v_mfma_f32_16x16x32_bf16 v[128:131], v[24:27], v[64:67], v[128:131]
  v_rcp_f32 v249, v249
  v_mfma_f32_16x16x32_bf16 v[128:131], v[40:43], v[68:71], v[128:131]
  v_rcp_f32 v250, v250
  v_mfma_f32_16x16x32_bf16 v[144:147], v[40:43], v[76:79], v[144:147]
  v_mul_f32 v88, v88, v11
  v_mul_f32 v89, v89, v248
  v_mfma_f32_16x16x32_bf16 v[144:147], v[24:27], v[72:75], v[144:147]
  v_mul_f32 v90, v90, v249
  v_mul_f32_e64 v91, v91, v250
  v_mfma_f32_16x16x32_bf16 v[148:151], v[28:31], v[72:75], v[148:151]
  ds_read_b128 v[72:75], v5 offset:57344
  v_mul_f32 v11, v92, v92
  v_mfma_f32_16x16x32_bf16 v[148:151], v[44:47], v[76:79], v[148:151]
  ds_read_b128 v[76:79], v7 offset:57344
  v_mul_f32 v248, v93, v93
  v_mfma_f32_16x16x32_bf16 v[132:135], v[44:47], v[68:71], v[132:135]
  ds_read_b128 v[68:71], v7 offset:55296
  s_waitcnt lgkmcnt(7)
  v_mul_f32 v249, v94, v94
  v_mfma_f32_16x16x32_bf16 v[132:135], v[28:31], v[64:67], v[132:135]
  ds_read_b128 v[64:67], v5 offset:55296
  v_mul_f32 v250, v95, v95
  v_mfma_f32_16x16x32_bf16 v[152:155], v[16:19], v[80:83], v[152:155]
  s_waitcnt lgkmcnt(4)
  v_fma_f32 v11, v11, v14, v12
  v_fma_f32 v248, v248, v14, v12
  v_mfma_f32_16x16x32_bf16 v[152:155], v[32:35], v[84:87], v[152:155]
  v_fma_f32 v249, v249, v14, v12
  v_fma_f32 v250, v250, v14, v12
  v_mfma_f32_16x16x32_bf16 v[168:171], v[32:35], v[52:55], v[168:171]
  v_mul_f32 v11, v11, v92
  v_mul_f32 v248, v248, v93
  v_mfma_f32_16x16x32_bf16 v[168:171], v[16:19], v[48:51], v[168:171]
  v_mul_f32 v249, v249, v94
  v_mul_f32 v250, v250, v95
  v_mfma_f32_16x16x32_bf16 v[172:175], v[20:23], v[48:51], v[172:175]
  v_exp_f32 v11, v11
  v_mfma_f32_16x16x32_bf16 v[172:175], v[36:39], v[52:55], v[172:175]
  v_exp_f32 v248, v248
  v_mfma_f32_16x16x32_bf16 v[156:159], v[36:39], v[84:87], v[156:159]
  v_exp_f32 v249, v249
  v_mfma_f32_16x16x32_bf16 v[156:159], v[20:23], v[80:83], v[156:159]
  v_exp_f32 v250, v250
  v_mfma_f32_16x16x32_bf16 v[160:163], v[24:27], v[80:83], v[160:163]
  v_add_f32 v11, 1.0, v11
  v_add_f32 v248, 1.0, v248
  v_mfma_f32_16x16x32_bf16 v[160:163], v[40:43], v[84:87], v[160:163]
  v_add_f32 v249, 1.0, v249
  v_add_f32 v250, 1.0, v250
  v_mfma_f32_16x16x32_bf16 v[176:179], v[40:43], v[52:55], v[176:179]
  v_rcp_f32 v11, v11
  v_mfma_f32_16x16x32_bf16 v[176:179], v[24:27], v[48:51], v[176:179]
  v_rcp_f32 v248, v248
  v_mfma_f32_16x16x32_bf16 v[180:183], v[28:31], v[48:51], v[180:183]
  v_rcp_f32 v249, v249
  v_mfma_f32_16x16x32_bf16 v[180:183], v[44:47], v[52:55], v[180:183]
  v_rcp_f32 v250, v250
  v_mfma_f32_16x16x32_bf16 v[164:167], v[44:47], v[84:87], v[164:167]
  ds_read_b128 v[84:87], v7 offset:59392
  v_mul_f32_e64 v92, v92, v11
  v_mfma_f32_16x16x32_bf16 v[164:167], v[28:31], v[80:83], v[164:167]
  ds_read_b128 v[80:83], v5 offset:59392
  v_mul_f32 v93, v93, v248
  v_mfma_f32_16x16x32_bf16 v[184:187], v[16:19], v[56:59], v[184:187]
  s_waitcnt lgkmcnt(2)
  v_mul_f32 v94, v94, v249
  v_mul_f32 v95, v95, v250
  v_mfma_f32_16x16x32_bf16 v[184:187], v[32:35], v[60:63], v[184:187]
  v_mul_f32 v11, v96, v96
  v_mul_f32 v248, v97, v97
  v_mfma_f32_16x16x32_bf16 v[200:203], v[32:35], v[68:71], v[200:203]
  v_mul_f32 v249, v98, v98
  v_mul_f32 v250, v99, v99
  v_mfma_f32_16x16x32_bf16 v[200:203], v[16:19], v[64:67], v[200:203]
  v_fma_f32 v11, v11, v14, v12
  v_fma_f32 v248, v248, v14, v12
  v_mfma_f32_16x16x32_bf16 v[204:207], v[20:23], v[64:67], v[204:207]
  v_fma_f32 v249, v249, v14, v12
  v_fma_f32 v250, v250, v14, v12
  v_mfma_f32_16x16x32_bf16 v[204:207], v[36:39], v[68:71], v[204:207]
  v_mul_f32 v11, v11, v96
  v_mul_f32 v248, v248, v97
  v_mfma_f32_16x16x32_bf16 v[188:191], v[36:39], v[60:63], v[188:191]
  v_mul_f32 v249, v249, v98
  v_mul_f32 v250, v250, v99
  v_mfma_f32_16x16x32_bf16 v[188:191], v[20:23], v[56:59], v[188:191]
  v_exp_f32 v11, v11
  v_mfma_f32_16x16x32_bf16 v[192:195], v[24:27], v[56:59], v[192:195]
  v_exp_f32 v248, v248
  v_mfma_f32_16x16x32_bf16 v[192:195], v[40:43], v[60:63], v[192:195]
  v_exp_f32_e64 v249, v249
  v_mfma_f32_16x16x32_bf16 v[208:211], v[40:43], v[68:71], v[208:211]
  v_exp_f32 v250, v250
  v_mfma_f32_16x16x32_bf16 v[208:211], v[24:27], v[64:67], v[208:211]
  v_add_f32 v11, 1.0, v11
  v_add_f32 v248, 1.0, v248
  v_mfma_f32_16x16x32_bf16 v[212:215], v[28:31], v[64:67], v[212:215]
  v_add_f32 v249, 1.0, v249
  v_add_f32 v250, 1.0, v250
  v_mfma_f32_16x16x32_bf16 v[212:215], v[44:47], v[68:71], v[212:215]
  v_rcp_f32 v11, v11
  v_mfma_f32_16x16x32_bf16 v[196:199], v[44:47], v[60:63], v[196:199]
  v_rcp_f32 v248, v248
  v_mfma_f32_16x16x32_bf16 v[196:199], v[28:31], v[56:59], v[196:199]
  v_rcp_f32 v249, v249
  v_mfma_f32_16x16x32_bf16 v[216:219], v[32:35], v[76:79], v[216:219]
  s_waitcnt lgkmcnt(0)
  v_rcp_f32 v250, v250
  v_mfma_f32_16x16x32_bf16 v[216:219], v[16:19], v[72:75], v[216:219]
  v_mul_f32 v96, v96, v11
  v_mul_f32 v97, v97, v248
  v_mfma_f32_16x16x32_bf16 v[232:235], v[16:19], v[80:83], v[232:235]
  v_mul_f32 v98, v98, v249
  v_mul_f32 v99, v99, v250
  v_mfma_f32_16x16x32_bf16 v[232:235], v[32:35], v[84:87], v[232:235]
  v_mul_f32 v11, v100, v100
  v_mul_f32 v248, v101, v101
  v_mfma_f32_16x16x32_bf16 v[236:239], v[36:39], v[84:87], v[236:239]
  v_mul_f32 v249, v102, v102
  v_mul_f32 v250, v103, v103
  v_mfma_f32_16x16x32_bf16 v[236:239], v[20:23], v[80:83], v[236:239]
  v_fma_f32 v11, v11, v14, v12
  v_fma_f32 v248, v248, v14, v12
  v_mfma_f32_16x16x32_bf16 v[220:223], v[20:23], v[72:75], v[220:223]
  v_fma_f32 v249, v249, v14, v12
  v_fma_f32 v250, v250, v14, v12
  v_mfma_f32_16x16x32_bf16 v[220:223], v[36:39], v[76:79], v[220:223]
  v_mul_f32 v11, v11, v100
  v_mul_f32 v248, v248, v101
  v_mfma_f32_16x16x32_bf16 v[224:227], v[40:43], v[76:79], v[224:227]
  v_mul_f32 v249, v249, v102
  v_mul_f32 v250, v250, v103
  v_mfma_f32_16x16x32_bf16 v[224:227], v[24:27], v[72:75], v[224:227]
  v_exp_f32_e64 v11, v11
  v_mfma_f32_16x16x32_bf16 v[240:243], v[24:27], v[80:83], v[240:243]
  v_exp_f32 v248, v248
  v_mfma_f32_16x16x32_bf16 v[240:243], v[40:43], v[84:87], v[240:243]
  v_exp_f32 v249, v249
  v_mfma_f32_16x16x32_bf16 v[244:247], v[44:47], v[84:87], v[244:247]
  v_exp_f32 v250, v250
  v_mfma_f32_16x16x32_bf16 v[244:247], v[28:31], v[80:83], v[244:247]
  v_add_f32 v11, 1.0, v11
  v_add_f32 v248, 1.0, v248
  v_mfma_f32_16x16x32_bf16 v[228:231], v[28:31], v[72:75], v[228:231]
  v_add_f32 v249, 1.0, v249
  v_add_f32 v250, 1.0, v250
  v_mfma_f32_16x16x32_bf16 v[228:231], v[44:47], v[76:79], v[228:231]
  v_rcp_f32 v11, v11
  v_rcp_f32 v248, v248
  v_rcp_f32 v249, v249
  v_rcp_f32 v250, v250
  v_mul_f32 v100, v100, v11
  v_mul_f32 v101, v101, v248
  v_mul_f32 v102, v102, v249
  v_mul_f32_e64 v103, v103, v250
  ds_read_b64 v[18:19], v9 offset:256
  ds_read_b64 v[22:23], v9 offset:288
  ds_read_b64 v[26:27], v9 offset:320
  ds_read_b64 v[30:31], v9 offset:352
  v_mov_b32 v248, 1.0
  v_mov_b32 v249, 1.0
L_epi:
  v_mov_b32 v84, 0xc1c00000
  v_mov_b32 v85, 0xc1c00000
  v_mov_b32 v86, 0x4b800000
  v_mov_b32 v87, 0x4b800000
  v_pk_mul_f32 v[52:53], v[104:105], v[104:105]
  v_pk_mul_f32 v[56:57], v[106:107], v[106:107]
  v_pk_mul_f32 v[60:61], v[108:109], v[108:109]
  v_pk_mul_f32 v[64:65], v[110:111], v[110:111]
  v_pk_mul_f32 v[68:69], v[120:121], v[120:121]
  v_pk_mul_f32 v[72:73], v[122:123], v[122:123]
  v_pk_mul_f32 v[76:77], v[124:125], v[124:125]
  v_pk_mul_f32 v[80:81], v[126:127], v[126:127]
  v_pk_fma_f32 v[52:53], v[52:53], v[14:15], v[12:13]
  v_pk_fma_f32 v[56:57], v[56:57], v[14:15], v[12:13]
  v_pk_fma_f32 v[60:61], v[60:61], v[14:15], v[12:13]
  v_pk_fma_f32 v[64:65], v[64:65], v[14:15], v[12:13]
  v_pk_fma_f32 v[68:69], v[68:69], v[14:15], v[12:13]
  v_pk_fma_f32 v[72:73], v[72:73], v[14:15], v[12:13]
  v_pk_fma_f32 v[76:77], v[76:77], v[14:15], v[12:13]
  v_pk_fma_f32 v[80:81], v[80:81], v[14:15], v[12:13]
  v_pk_fma_f32 v[52:53], v[52:53], v[104:105], v[84:85]
  v_pk_fma_f32 v[56:57], v[56:57], v[106:107], v[84:85]
  v_pk_fma_f32 v[60:61], v[60:61], v[108:109], v[84:85]
  v_pk_fma_f32 v[64:65], v[64:65], v[110:111], v[84:85]
  v_pk_fma_f32 v[68:69], v[68:69], v[120:121], v[84:85]
  v_pk_fma_f32 v[72:73], v[72:73], v[122:123], v[84:85]
  v_pk_fma_f32 v[76:77], v[76:77], v[124:125], v[84:85]
  v_pk_fma_f32 v[80:81], v[80:81], v[126:127], v[84:85]
  v_exp_f32 v52, v52 clamp
  v_exp_f32 v53, v53 clamp
  v_exp_f32 v56, v56 clamp
  v_exp_f32 v57, v57 clamp
  v_exp_f32 v60, v60 clamp
  v_exp_f32 v61, v61 clamp
  v_exp_f32 v64, v64 clamp
  v_exp_f32 v65, v65 clamp
  v_exp_f32 v68, v68 clamp
  v_exp_f32 v69, v69 clamp
  v_exp_f32 v72, v72 clamp
  v_exp_f32 v73, v73 clamp
  v_exp_f32 v76, v76 clamp
  v_exp_f32 v77, v77 clamp
  v_exp_f32 v80, v80 clamp
  v_exp_f32 v81, v81 clamp
  s_waitcnt lgkmcnt(3)
  v_lshlrev_b32 v16, 16, v18
  v_and_b32 v17, 0xffff0000, v18
  v_lshlrev_b32 v18, 16, v19
  v_and_b32 v19, 0xffff0000, v19
  s_waitcnt lgkmcnt(2)
  v_lshlrev_b32 v20, 16, v22
  v_and_b32 v21, 0xffff0000, v22
  v_lshlrev_b32 v22, 16, v23
  v_and_b32 v23, 0xffff0000, v23
  s_waitcnt lgkmcnt(1)
  v_lshlrev_b32 v24, 16, v26
  v_and_b32 v25, 0xffff0000, v26
  v_lshlrev_b32 v26, 16, v27
  v_and_b32 v27, 0xffff0000, v27
  s_waitcnt lgkmcnt(0)
  v_lshlrev_b32 v28, 16, v30
  v_and_b32 v29, 0xffff0000, v30
  v_lshlrev_b32 v30, 16, v31
  v_and_b32 v31, 0xffff0000, v31
  v_pk_mul_f32 v[54:55], v[104:105], v[16:17]
  v_pk_mul_f32 v[58:59], v[106:107], v[18:19]
  v_pk_mul_f32 v[62:63], v[108:109], v[20:21]
  v_pk_mul_f32 v[66:67], v[110:111], v[22:23]
  v_pk_mul_f32 v[70:71], v[120:121], v[16:17]
  v_pk_mul_f32 v[74:75], v[122:123], v[18:19]
  v_pk_mul_f32 v[78:79], v[124:125], v[20:21]
  v_pk_mul_f32 v[82:83], v[126:127], v[22:23]
  v_pk_fma_f32 v[52:53], v[52:53], v[86:87], v[248:249]
  v_pk_fma_f32 v[56:57], v[56:57], v[86:87], v[248:249]
  v_pk_fma_f32 v[60:61], v[60:61], v[86:87], v[248:249]
  v_pk_fma_f32 v[64:65], v[64:65], v[86:87], v[248:249]
  v_pk_fma_f32 v[68:69], v[68:69], v[86:87], v[248:249]
  v_pk_fma_f32 v[72:73], v[72:73], v[86:87], v[248:249]
  v_pk_fma_f32 v[76:77], v[76:77], v[86:87], v[248:249]
  v_pk_fma_f32 v[80:81], v[80:81], v[86:87], v[248:249]
  v_pk_mul_f32 v[54:55], v[54:55], v[56:57]
  v_pk_mul_f32 v[62:63], v[62:63], v[64:65]
  v_pk_mul_f32 v[70:71], v[70:71], v[72:73]
  v_pk_mul_f32 v[78:79], v[78:79], v[80:81]
  v_pk_fma_f32 v[54:55], v[58:59], v[52:53], v[54:55]
  v_pk_fma_f32 v[62:63], v[66:67], v[60:61], v[62:63]
  v_pk_fma_f32 v[70:71], v[74:75], v[68:69], v[70:71]
  v_pk_fma_f32 v[78:79], v[82:83], v[76:77], v[78:79]
  v_pk_mul_f32 v[52:53], v[52:53], v[56:57]
  v_pk_mul_f32 v[60:61], v[60:61], v[64:65]
  v_pk_mul_f32 v[68:69], v[68:69], v[72:73]
  v_pk_mul_f32 v[76:77], v[76:77], v[80:81]
  v_pk_mul_f32 v[54:55], v[54:55], v[60:61]
  v_pk_mul_f32 v[70:71], v[70:71], v[76:77]
  v_pk_fma_f32 v[54:55], v[62:63], v[52:53], v[54:55]
  v_pk_fma_f32 v[70:71], v[78:79], v[68:69], v[70:71]
  v_pk_mul_f32 v[52:53], v[52:53], v[60:61]
  v_pk_mul_f32 v[68:69], v[68:69], v[76:77]
  v_rcp_f32 v52, v52
  v_rcp_f32 v53, v53
  v_rcp_f32 v68, v68
  v_rcp_f32 v69, v69
  v_pk_mul_f32 v[34:35], v[52:53], v[54:55]
  v_pk_mul_f32 v[36:37], v[68:69], v[70:71]
  v_pk_mul_f32 v[52:53], v[112:113], v[112:113]
  v_pk_mul_f32 v[56:57], v[114:115], v[114:115]
  v_pk_mul_f32 v[60:61], v[116:117], v[116:117]
  v_pk_mul_f32 v[64:65], v[118:119], v[118:119]
  v_pk_mul_f32 v[68:69], v[128:129], v[128:129]
  v_pk_mul_f32 v[72:73], v[130:131], v[130:131]
  v_pk_mul_f32 v[76:77], v[132:133], v[132:133]
  v_pk_mul_f32 v[80:81], v[134:135], v[134:135]
  v_pk_fma_f32 v[52:53], v[52:53], v[14:15], v[12:13]
  v_pk_fma_f32 v[56:57], v[56:57], v[14:15], v[12:13]
  v_pk_fma_f32 v[60:61], v[60:61], v[14:15], v[12:13]
  v_pk_fma_f32 v[64:65], v[64:65], v[14:15], v[12:13]
  v_pk_fma_f32 v[68:69], v[68:69], v[14:15], v[12:13]
  v_pk_fma_f32 v[72:73], v[72:73], v[14:15], v[12:13]
  v_pk_fma_f32 v[76:77], v[76:77], v[14:15], v[12:13]
  v_pk_fma_f32 v[80:81], v[80:81], v[14:15], v[12:13]
  v_pk_fma_f32 v[52:53], v[52:53], v[112:113], v[84:85]
  v_pk_fma_f32 v[56:57], v[56:57], v[114:115], v[84:85]
  v_pk_fma_f32 v[60:61], v[60:61], v[116:117], v[84:85]
  v_pk_fma_f32 v[64:65], v[64:65], v[118:119], v[84:85]
  v_pk_fma_f32 v[68:69], v[68:69], v[128:129], v[84:85]
  v_pk_fma_f32 v[72:73], v[72:73], v[130:131], v[84:85]
  v_pk_fma_f32 v[76:77], v[76:77], v[132:133], v[84:85]
  v_pk_fma_f32 v[80:81], v[80:81], v[134:135], v[84:85]
  v_exp_f32 v52, v52 clamp
  v_exp_f32 v53, v53 clamp
  v_exp_f32 v56, v56 clamp
  v_exp_f32 v57, v57 clamp
  v_exp_f32 v60, v60 clamp
  v_exp_f32 v61, v61 clamp
  v_exp_f32 v64, v64 clamp
  v_exp_f32 v65, v65 clamp
  v_exp_f32 v68, v68 clamp
  v_exp_f32 v69, v69 clamp
  v_exp_f32 v72, v72 clamp
  v_exp_f32 v73, v73 clamp
  v_exp_f32 v76, v76 clamp
  v_exp_f32 v77, v77 clamp
  v_exp_f32 v80, v80 clamp
  v_exp_f32 v81, v81 clamp
  v_pk_mul_f32 v[54:55], v[112:113], v[24:25]
  v_pk_mul_f32 v[58:59], v[114:115], v[26:27]
  v_pk_mul_f32 v[62:63], v[116:117], v[28:29]
  v_pk_mul_f32 v[66:67], v[118:119], v[30:31]
  v_pk_mul_f32 v[70:71], v[128:129], v[24:25]
  v_pk_mul_f32 v[74:75], v[130:131], v[26:27]
  v_pk_mul_f32 v[78:79], v[132:133], v[28:29]
  v_pk_mul_f32 v[82:83], v[134:135], v[30:31]
  v_pk_fma_f32 v[52:53], v[52:53], v[86:87], v[248:249]
  v_pk_fma_f32 v[56:57], v[56:57], v[86:87], v[248:249]
  v_pk_fma_f32 v[60:61], v[60:61], v[86:87], v[248:249]
  v_pk_fma_f32 v[64:65], v[64:65], v[86:87], v[248:249]
  v_pk_fma_f32 v[68:69], v[68:69], v[86:87], v[248:249]
  v_pk_fma_f32 v[72:73], v[72:73], v[86:87], v[248:249]
  v_pk_fma_f32 v[76:77], v[76:77], v[86:87], v[248:249]
  v_pk_fma_f32 v[80:81], v[80:81], v[86:87], v[248:249]
  v_pk_mul_f32 v[54:55], v[54:55], v[56:57]
  v_pk_mul_f32 v[62:63], v[62:63], v[64:65]
  v_pk_mul_f32 v[70:71], v[70:71], v[72:73]
  v_pk_mul_f32 v[78:79], v[78:79], v[80:81]
  v_pk_fma_f32 v[54:55], v[58:59], v[52:53], v[54:55]
  v_pk_fma_f32 v[62:63], v[66:67], v[60:61], v[62:63]
  v_pk_fma_f32 v[70:71], v[74:75], v[68:69], v[70:71]
  v_pk_fma_f32 v[78:79], v[82:83], v[76:77], v[78:79]
  v_pk_mul_f32 v[52:53], v[52:53], v[56:57]
  v_pk_mul_f32 v[60:61], v[60:61], v[64:65]
  v_pk_mul_f32 v[68:69], v[68:69], v[72:73]
  v_pk_mul_f32 v[76:77], v[76:77], v[80:81]
  v_pk_mul_f32 v[54:55], v[54:55], v[60:61]
  v_pk_mul_f32 v[70:71], v[70:71], v[76:77]
  v_pk_fma_f32 v[54:55], v[62:63], v[52:53], v[54:55]
  v_pk_fma_f32 v[70:71], v[78:79], v[68:69], v[70:71]
  v_pk_mul_f32 v[52:53], v[52:53], v[60:61]
  v_pk_mul_f32 v[68:69], v[68:69], v[76:77]
  v_rcp_f32 v52, v52
  v_rcp_f32 v53, v53
  v_rcp_f32 v68, v68
  v_rcp_f32 v69, v69
  v_pk_fma_f32 v[34:35], v[52:53], v[54:55], v[34:35]
  v_pk_fma_f32 v[36:37], v[68:69], v[70:71], v[36:37]
  v_pk_mul_f32 v[52:53], v[136:137], v[136:137]
  v_pk_mul_f32 v[56:57], v[138:139], v[138:139]
  v_pk_mul_f32 v[60:61], v[140:141], v[140:141]
  v_pk_mul_f32 v[64:65], v[142:143], v[142:143]
  v_pk_mul_f32 v[68:69], v[152:153], v[152:153]
  v_pk_mul_f32 v[72:73], v[154:155], v[154:155]
  v_pk_mul_f32 v[76:77], v[156:157], v[156:157]
  v_pk_mul_f32 v[80:81], v[158:159], v[158:159]
  v_pk_fma_f32 v[52:53], v[52:53], v[14:15], v[12:13]
  v_pk_fma_f32 v[56:57], v[56:57], v[14:15], v[12:13]
  v_pk_fma_f32 v[60:61], v[60:61], v[14:15], v[12:13]
  v_pk_fma_f32 v[64:65], v[64:65], v[14:15], v[12:13]
  v_pk_fma_f32 v[68:69], v[68:69], v[14:15], v[12:13]
  v_pk_fma_f32 v[72:73], v[72:73], v[14:15], v[12:13]
  v_pk_fma_f32 v[76:77], v[76:77], v[14:15], v[12:13]
  v_pk_fma_f32 v[80:81], v[80:81], v[14:15], v[12:13]
  v_pk_fma_f32 v[52:53], v[52:53], v[136:137], v[84:85]
  v_pk_fma_f32 v[56:57], v[56:57], v[138:139], v[84:85]
  v_pk_fma_f32 v[60:61], v[60:61], v[140:141], v[84:85]
  v_pk_fma_f32 v[64:65], v[64:65], v[142:143], v[84:85]
  v_pk_fma_f32 v[68:69], v[68:69], v[152:153], v[84:85]
  v_pk_fma_f32 v[72:73], v[72:73], v[154:155], v[84:85]
  v_pk_fma_f32 v[76:77], v[76:77], v[156:157], v[84:85]
  v_pk_fma_f32 v[80:81], v[80:81], v[158:159], v[84:85]
  v_exp_f32 v52, v52 clamp
  v_exp_f32 v53, v53 clamp
  v_exp_f32 v56, v56 clamp
  v_exp_f32 v57, v57 clamp
  v_exp_f32 v60, v60 clamp
  v_exp_f32 v61, v61 clamp
  v_exp_f32 v64, v64 clamp
  v_exp_f32 v65, v65 clamp
  v_exp_f32 v68, v68 clamp
  v_exp_f32 v69, v69 clamp
  v_exp_f32 v72, v72 clamp
  v_exp_f32 v73, v73 clamp
  v_exp_f32 v76, v76 clamp
  v_exp_f32 v77, v77 clamp
  v_exp_f32 v80, v80 clamp
  v_exp_f32 v81, v81 clamp
  v_pk_mul_f32 v[54:55], v[136:137], v[16:17]
  v_pk_mul_f32 v[58:59], v[138:139], v[18:19]
  v_pk_mul_f32 v[62:63], v[140:141], v[20:21]
  v_pk_mul_f32 v[66:67], v[142:143], v[22:23]
  v_pk_mul_f32 v[70:71], v[152:153], v[16:17]
  v_pk_mul_f32 v[74:75], v[154:155], v[18:19]
  v_pk_mul_f32 v[78:79], v[156:157], v[20:21]
  v_pk_mul_f32 v[82:83], v[158:159], v[22:23]
  v_pk_fma_f32 v[52:53], v[52:53], v[86:87], v[248:249]
  v_pk_fma_f32 v[56:57], v[56:57], v[86:87], v[248:249]
  v_pk_fma_f32 v[60:61], v[60:61], v[86:87], v[248:249]
  v_pk_fma_f32 v[64:65], v[64:65], v[86:87], v[248:249]
  v_pk_fma_f32 v[68:69], v[68:69], v[86:87], v[248:249]
  v_pk_fma_f32 v[72:73], v[72:73], v[86:87], v[248:249]
  v_pk_fma_f32 v[76:77], v[76:77], v[86:87], v[248:249]
  v_pk_fma_f32 v[80:81], v[80:81], v[86:87], v[248:249]
  v_pk_mul_f32 v[54:55], v[54:55], v[56:57]
  v_pk_mul_f32 v[62:63], v[62:63], v[64:65]
  v_pk_mul_f32 v[70:71], v[70:71], v[72:73]
  v_pk_mul_f32 v[78:79], v[78:79], v[80:81]
  v_pk_fma_f32 v[54:55], v[58:59], v[52:53], v[54:55]
  v_pk_fma_f32 v[62:63], v[66:67], v[60:61], v[62:63]
  v_pk_fma_f32 v[70:71], v[74:75], v[68:69], v[70:71]
  v_pk_fma_f32 v[78:79], v[82:83], v[76:77], v[78:79]
  v_pk_mul_f32 v[52:53], v[52:53], v[56:57]
  v_pk_mul_f32 v[60:61], v[60:61], v[64:65]
  v_pk_mul_f32 v[68:69], v[68:69], v[72:73]
  v_pk_mul_f32 v[76:77], v[76:77], v[80:81]
  v_pk_mul_f32 v[54:55], v[54:55], v[60:61]
  v_pk_mul_f32 v[70:71], v[70:71], v[76:77]
  v_pk_fma_f32 v[54:55], v[62:63], v[52:53], v[54:55]
  v_pk_fma_f32 v[70:71], v[78:79], v[68:69], v[70:71]
  v_pk_mul_f32 v[52:53], v[52:53], v[60:61]
  v_pk_mul_f32 v[68:69], v[68:69], v[76:77]
  v_rcp_f32 v52, v52
  v_rcp_f32 v53, v53
  v_rcp_f32 v68, v68
  v_rcp_f32 v69, v69
  v_pk_mul_f32 v[38:39], v[52:53], v[54:55]
  v_pk_mul_f32 v[40:41], v[68:69], v[70:71]
  v_pk_mul_f32 v[52:53], v[144:145], v[144:145]
  v_pk_mul_f32 v[56:57], v[146:147], v[146:147]
  v_pk_mul_f32 v[60:61], v[148:149], v[148:149]
  v_pk_mul_f32 v[64:65], v[150:151], v[150:151]
  v_pk_mul_f32 v[68:69], v[160:161], v[160:161]
  v_pk_mul_f32 v[72:73], v[162:163], v[162:163]
  v_pk_mul_f32 v[76:77], v[164:165], v[164:165]
  v_pk_mul_f32 v[80:81], v[166:167], v[166:167]
  v_pk_fma_f32 v[52:53], v[52:53], v[14:15], v[12:13]
  v_pk_fma_f32 v[56:57], v[56:57], v[14:15], v[12:13]
  v_pk_fma_f32 v[60:61], v[60:61], v[14:15], v[12:13]
  v_pk_fma_f32 v[64:65], v[64:65], v[14:15], v[12:13]
  v_pk_fma_f32 v[68:69], v[68:69], v[14:15], v[12:13]
  v_pk_fma_f32 v[72:73], v[72:73], v[14:15], v[12:13]
  v_pk_fma_f32 v[76:77], v[76:77], v[14:15], v[12:13]
  v_pk_fma_f32 v[80:81], v[80:81], v[14:15], v[12:13]
  v_pk_fma_f32 v[52:53], v[52:53], v[144:145], v[84:85]
  v_pk_fma_f32 v[56:57], v[56:57], v[146:147], v[84:85]
  v_pk_fma_f32 v[60:61], v[60:61], v[148:149], v[84:85]
  v_pk_fma_f32 v[64:65], v[64:65], v[150:151], v[84:85]
  v_pk_fma_f32 v[68:69], v[68:69], v[160:161], v[84:85]
  v_pk_fma_f32 v[72:73], v[72:73], v[162:163], v[84:85]
  v_pk_fma_f32 v[76:77], v[76:77], v[164:165], v[84:85]
  v_pk_fma_f32 v[80:81], v[80:81], v[166:167], v[84:85]
  v_exp_f32 v52, v52 clamp
  v_exp_f32 v53, v53 clamp
  v_exp_f32 v56, v56 clamp
  v_exp_f32 v57, v57 clamp
  v_exp_f32 v60, v60 clamp
  v_exp_f32 v61, v61 clamp
  v_exp_f32 v64, v64 clamp
  v_exp_f32 v65, v65 clamp
  v_exp_f32 v68, v68 clamp
  v_exp_f32 v69, v69 clamp
  v_exp_f32 v72, v72 clamp
  v_exp_f32 v73, v73 clamp
  v_exp_f32 v76, v76 clamp
  v_exp_f32 v77, v77 clamp
  v_exp_f32 v80, v80 clamp
  v_exp_f32 v81, v81 clamp
  v_pk_mul_f32 v[54:55], v[144:145], v[24:25]
  v_pk_mul_f32 v[58:59], v[146:147], v[26:27]
  v_pk_mul_f32 v[62:63], v[148:149], v[28:29]
  v_pk_mul_f32 v[66:67], v[150:151], v[30:31]
  v_pk_mul_f32 v[70:71], v[160:161], v[24:25]
  v_pk_mul_f32 v[74:75], v[162:163], v[26:27]
  v_pk_mul_f32 v[78:79], v[164:165], v[28:29]
  v_pk_mul_f32 v[82:83], v[166:167], v[30:31]
  v_pk_fma_f32 v[52:53], v[52:53], v[86:87], v[248:249]
  v_pk_fma_f32 v[56:57], v[56:57], v[86:87], v[248:249]
  v_pk_fma_f32 v[60:61], v[60:61], v[86:87], v[248:249]
  v_pk_fma_f32 v[64:65], v[64:65], v[86:87], v[248:249]
  v_pk_fma_f32 v[68:69], v[68:69], v[86:87], v[248:249]
  v_pk_fma_f32 v[72:73], v[72:73], v[86:87], v[248:249]
  v_pk_fma_f32 v[76:77], v[76:77], v[86:87], v[248:249]
  v_pk_fma_f32 v[80:81], v[80:81], v[86:87], v[248:249]
  v_pk_mul_f32 v[54:55], v[54:55], v[56:57]
  v_pk_mul_f32 v[62:63], v[62:63], v[64:65]
  v_pk_mul_f32 v[70:71], v[70:71], v[72:73]
  v_pk_mul_f32 v[78:79], v[78:79], v[80:81]
  v_pk_fma_f32 v[54:55], v[58:59], v[52:53], v[54:55]
  v_pk_fma_f32 v[62:63], v[66:67], v[60:61], v[62:63]
  v_pk_fma_f32 v[70:71], v[74:75], v[68:69], v[70:71]
  v_pk_fma_f32 v[78:79], v[82:83], v[76:77], v[78:79]
  v_pk_mul_f32 v[52:53], v[52:53], v[56:57]
  v_pk_mul_f32 v[60:61], v[60:61], v[64:65]
  v_pk_mul_f32 v[68:69], v[68:69], v[72:73]
  v_pk_mul_f32 v[76:77], v[76:77], v[80:81]
  v_pk_mul_f32 v[54:55], v[54:55], v[60:61]
  v_pk_mul_f32 v[70:71], v[70:71], v[76:77]
  v_pk_fma_f32 v[54:55], v[62:63], v[52:53], v[54:55]
  v_pk_fma_f32 v[70:71], v[78:79], v[68:69], v[70:71]
  v_pk_mul_f32 v[52:53], v[52:53], v[60:61]
  v_pk_mul_f32 v[68:69], v[68:69], v[76:77]
  v_rcp_f32 v52, v52
  v_rcp_f32 v53, v53
  v_rcp_f32 v68, v68
  v_rcp_f32 v69, v69
  v_pk_fma_f32 v[38:39], v[52:53], v[54:55], v[38:39]
  v_pk_fma_f32 v[40:41], v[68:69], v[70:71], v[40:41]
  v_pk_mul_f32 v[52:53], v[168:169], v[168:169]
  v_pk_mul_f32 v[56:57], v[170:171], v[170:171]
  v_pk_mul_f32 v[60:61], v[172:173], v[172:173]
  v_pk_mul_f32 v[64:65], v[174:175], v[174:175]
  v_pk_mul_f32 v[68:69], v[184:185], v[184:185]
  v_pk_mul_f32 v[72:73], v[186:187], v[186:187]
  v_pk_mul_f32 v[76:77], v[188:189], v[188:189]
  v_pk_mul_f32 v[80:81], v[190:191], v[190:191]
  v_pk_fma_f32 v[52:53], v[52:53], v[14:15], v[12:13]
  v_pk_fma_f32 v[56:57], v[56:57], v[14:15], v[12:13]
  v_pk_fma_f32 v[60:61], v[60:61], v[14:15], v[12:13]
  v_pk_fma_f32 v[64:65], v[64:65], v[14:15], v[12:13]
  v_pk_fma_f32 v[68:69], v[68:69], v[14:15], v[12:13]
  v_pk_fma_f32 v[72:73], v[72:73], v[14:15], v[12:13]
  v_pk_fma_f32 v[76:77], v[76:77], v[14:15], v[12:13]
  v_pk_fma_f32 v[80:81], v[80:81], v[14:15], v[12:13]
  v_pk_fma_f32 v[52:53], v[52:53], v[168:169], v[84:85]
  v_pk_fma_f32 v[56:57], v[56:57], v[170:171], v[84:85]
  v_pk_fma_f32 v[60:61], v[60:61], v[172:173], v[84:85]
  v_pk_fma_f32 v[64:65], v[64:65], v[174:175], v[84:85]
  v_pk_fma_f32 v[68:69], v[68:69], v[184:185], v[84:85]
  v_pk_fma_f32 v[72:73], v[72:73], v[186:187], v[84:85]
  v_pk_fma_f32 v[76:77], v[76:77], v[188:189], v[84:85]
  v_pk_fma_f32 v[80:81], v[80:81], v[190:191], v[84:85]
  v_exp_f32 v52, v52 clamp
  v_exp_f32 v53, v53 clamp
  v_exp_f32 v56, v56 clamp
  v_exp_f32 v57, v57 clamp
  v_exp_f32 v60, v60 clamp
  v_exp_f32 v61, v61 clamp
  v_exp_f32 v64, v64 clamp
  v_exp_f32 v65, v65 clamp
  v_exp_f32 v68, v68 clamp
  v_exp_f32 v69, v69 clamp
  v_exp_f32 v72, v72 clamp
  v_exp_f32 v73, v73 clamp
  v_exp_f32 v76, v76 clamp
  v_exp_f32 v77, v77 clamp
  v_exp_f32 v80, v80 clamp
  v_exp_f32 v81, v81 clamp
  v_pk_mul_f32 v[54:55], v[168:169], v[16:17]
  v_pk_mul_f32 v[58:59], v[170:171], v[18:19]
  v_pk_mul_f32 v[62:63], v[172:173], v[20:21]
  v_pk_mul_f32 v[66:67], v[174:175], v[22:23]
  v_pk_mul_f32 v[70:71], v[184:185], v[16:17]
  v_pk_mul_f32 v[74:75], v[186:187], v[18:19]
  v_pk_mul_f32 v[78:79], v[188:189], v[20:21]
  v_pk_mul_f32 v[82:83], v[190:191], v[22:23]
  v_pk_fma_f32 v[52:53], v[52:53], v[86:87], v[248:249]
  v_pk_fma_f32 v[56:57], v[56:57], v[86:87], v[248:249]
  v_pk_fma_f32 v[60:61], v[60:61], v[86:87], v[248:249]
  v_pk_fma_f32 v[64:65], v[64:65], v[86:87], v[248:249]
  v_pk_fma_f32 v[68:69], v[68:69], v[86:87], v[248:249]
  v_pk_fma_f32 v[72:73], v[72:73], v[86:87], v[248:249]
  v_pk_fma_f32 v[76:77], v[76:77], v[86:87], v[248:249]
  v_pk_fma_f32 v[80:81], v[80:81], v[86:87], v[248:249]
  v_pk_mul_f32 v[54:55], v[54:55], v[56:57]
  v_pk_mul_f32 v[62:63], v[62:63], v[64:65]
  v_pk_mul_f32 v[70:71], v[70:71], v[72:73]
  v_pk_mul_f32 v[78:79], v[78:79], v[80:81]
  v_pk_fma_f32 v[54:55], v[58:59], v[52:53], v[54:55]
  v_pk_fma_f32 v[62:63], v[66:67], v[60:61], v[62:63]
  v_pk_fma_f32 v[70:71], v[74:75], v[68:69], v[70:71]
  v_pk_fma_f32 v[78:79], v[82:83], v[76:77], v[78:79]
  v_pk_mul_f32 v[52:53], v[52:53], v[56:57]
  v_pk_mul_f32 v[60:61], v[60:61], v[64:65]
  v_pk_mul_f32 v[68:69], v[68:69], v[72:73]
  v_pk_mul_f32 v[76:77], v[76:77], v[80:81]
  v_pk_mul_f32 v[54:55], v[54:55], v[60:61]
  v_pk_mul_f32 v[70:71], v[70:71], v[76:77]
  v_pk_fma_f32 v[54:55], v[62:63], v[52:53], v[54:55]
  v_pk_fma_f32 v[70:71], v[78:79], v[68:69], v[70:71]
  v_pk_mul_f32 v[52:53], v[52:53], v[60:61]
  v_pk_mul_f32 v[68:69], v[68:69], v[76:77]
  v_rcp_f32 v52, v52
  v_rcp_f32 v53, v53
  v_rcp_f32 v68, v68
  v_rcp_f32 v69, v69
  v_pk_mul_f32 v[42:43], v[52:53], v[54:55]
  v_pk_mul_f32 v[44:45], v[68:69], v[70:71]
  v_pk_mul_f32 v[52:53], v[176:177], v[176:177]
  v_pk_mul_f32 v[56:57], v[178:179], v[178:179]
  v_pk_mul_f32 v[60:61], v[180:181], v[180:181]
  v_pk_mul_f32 v[64:65], v[182:183], v[182:183]
  v_pk_mul_f32 v[68:69], v[192:193], v[192:193]
  v_pk_mul_f32 v[72:73], v[194:195], v[194:195]
  v_pk_mul_f32 v[76:77], v[196:197], v[196:197]
  v_pk_mul_f32 v[80:81], v[198:199], v[198:199]
  v_pk_fma_f32 v[52:53], v[52:53], v[14:15], v[12:13]
  v_pk_fma_f32 v[56:57], v[56:57], v[14:15], v[12:13]
  v_pk_fma_f32 v[60:61], v[60:61], v[14:15], v[12:13]
  v_pk_fma_f32 v[64:65], v[64:65], v[14:15], v[12:13]
  v_pk_fma_f32 v[68:69], v[68:69], v[14:15], v[12:13]
  v_pk_fma_f32 v[72:73], v[72:73], v[14:15], v[12:13]
  v_pk_fma_f32 v[76:77], v[76:77], v[14:15], v[12:13]
  v_pk_fma_f32 v[80:81], v[80:81], v[14:15], v[12:13]
  v_pk_fma_f32 v[52:53], v[52:53], v[176:177], v[84:85]
  v_pk_fma_f32 v[56:57], v[56:57], v[178:179], v[84:85]
  v_pk_fma_f32 v[60:61], v[60:61], v[180:181], v[84:85]
  v_pk_fma_f32 v[64:65], v[64:65], v[182:183], v[84:85]
  v_pk_fma_f32 v[68:69], v[68:69], v[192:193], v[84:85]
  v_pk_fma_f32 v[72:73], v[72:73], v[194:195], v[84:85]
  v_pk_fma_f32 v[76:77], v[76:77], v[196:197], v[84:85]
  v_pk_fma_f32 v[80:81], v[80:81], v[198:199], v[84:85]
  v_exp_f32 v52, v52 clamp
  v_exp_f32 v53, v53 clamp
  v_exp_f32 v56, v56 clamp
  v_exp_f32 v57, v57 clamp
  v_exp_f32 v60, v60 clamp
  v_exp_f32 v61, v61 clamp
  v_exp_f32 v64, v64 clamp
  v_exp_f32 v65, v65 clamp
  v_exp_f32 v68, v68 clamp
  v_exp_f32 v69, v69 clamp
  v_exp_f32 v72, v72 clamp
  v_exp_f32 v73, v73 clamp
  v_exp_f32 v76, v76 clamp
  v_exp_f32 v77, v77 clamp
  v_exp_f32 v80, v80 clamp
  v_exp_f32 v81, v81 clamp
  v_pk_mul_f32 v[54:55], v[176:177], v[24:25]
  v_pk_mul_f32 v[58:59], v[178:179], v[26:27]
  v_pk_mul_f32 v[62:63], v[180:181], v[28:29]
  v_pk_mul_f32 v[66:67], v[182:183], v[30:31]
  v_pk_mul_f32 v[70:71], v[192:193], v[24:25]
  v_pk_mul_f32 v[74:75], v[194:195], v[26:27]
  v_pk_mul_f32 v[78:79], v[196:197], v[28:29]
  v_pk_mul_f32 v[82:83], v[198:199], v[30:31]
  v_pk_fma_f32 v[52:53], v[52:53], v[86:87], v[248:249]
  v_pk_fma_f32 v[56:57], v[56:57], v[86:87], v[248:249]
  v_pk_fma_f32 v[60:61], v[60:61], v[86:87], v[248:249]
  v_pk_fma_f32 v[64:65], v[64:65], v[86:87], v[248:249]
  v_pk_fma_f32 v[68:69], v[68:69], v[86:87], v[248:249]
  v_pk_fma_f32 v[72:73], v[72:73], v[86:87], v[248:249]
  v_pk_fma_f32 v[76:77], v[76:77], v[86:87], v[248:249]
  v_pk_fma_f32 v[80:81], v[80:81], v[86:87], v[248:249]
  v_pk_mul_f32 v[54:55], v[54:55], v[56:57]
  v_pk_mul_f32 v[62:63], v[62:63], v[64:65]
  v_pk_mul_f32 v[70:71], v[70:71], v[72:73]
  v_pk_mul_f32 v[78:79], v[78:79], v[80:81]
  v_pk_fma_f32 v[54:55], v[58:59], v[52:53], v[54:55]
  v_pk_fma_f32 v[62:63], v[66:67], v[60:61], v[62:63]
  v_pk_fma_f32 v[70:71], v[74:75], v[68:69], v[70:71]
  v_pk_fma_f32 v[78:79], v[82:83], v[76:77], v[78:79]
  v_pk_mul_f32 v[52:53], v[52:53], v[56:57]
  v_pk_mul_f32 v[60:61], v[60:61], v[64:65]
  v_pk_mul_f32 v[68:69], v[68:69], v[72:73]
  v_pk_mul_f32 v[76:77], v[76:77], v[80:81]
  v_pk_mul_f32 v[54:55], v[54:55], v[60:61]
  v_pk_mul_f32 v[70:71], v[70:71], v[76:77]
  v_pk_fma_f32 v[54:55], v[62:63], v[52:53], v[54:55]
  v_pk_fma_f32 v[70:71], v[78:79], v[68:69], v[70:71]
  v_pk_mul_f32 v[52:53], v[52:53], v[60:61]
  v_pk_mul_f32 v[68:69], v[68:69], v[76:77]
  v_rcp_f32 v52, v52
  v_rcp_f32 v53, v53
  v_rcp_f32 v68, v68
  v_rcp_f32 v69, v69
  v_pk_fma_f32 v[42:43], v[52:53], v[54:55], v[42:43]
  v_pk_fma_f32 v[44:45], v[68:69], v[70:71], v[44:45]
  v_pk_mul_f32 v[52:53], v[200:201], v[200:201]
  v_pk_mul_f32 v[56:57], v[202:203], v[202:203]
  v_pk_mul_f32 v[60:61], v[204:205], v[204:205]
  v_pk_mul_f32 v[64:65], v[206:207], v[206:207]
  v_pk_mul_f32 v[68:69], v[216:217], v[216:217]
  v_pk_mul_f32 v[72:73], v[218:219], v[218:219]
  v_pk_mul_f32 v[76:77], v[220:221], v[220:221]
  v_pk_mul_f32 v[80:81], v[222:223], v[222:223]
  v_pk_fma_f32 v[52:53], v[52:53], v[14:15], v[12:13]
  v_pk_fma_f32 v[56:57], v[56:57], v[14:15], v[12:13]
  v_pk_fma_f32 v[60:61], v[60:61], v[14:15], v[12:13]
  v_pk_fma_f32 v[64:65], v[64:65], v[14:15], v[12:13]
  v_pk_fma_f32 v[68:69], v[68:69], v[14:15], v[12:13]
  v_pk_fma_f32 v[72:73], v[72:73], v[14:15], v[12:13]
  v_pk_fma_f32 v[76:77], v[76:77], v[14:15], v[12:13]
  v_pk_fma_f32 v[80:81], v[80:81], v[14:15], v[12:13]
  v_pk_fma_f32 v[52:53], v[52:53], v[200:201], v[84:85]
  v_pk_fma_f32 v[56:57], v[56:57], v[202:203], v[84:85]
  v_pk_fma_f32 v[60:61], v[60:61], v[204:205], v[84:85]
  v_pk_fma_f32 v[64:65], v[64:65], v[206:207], v[84:85]
  v_pk_fma_f32 v[68:69], v[68:69], v[216:217], v[84:85]
  v_pk_fma_f32 v[72:73], v[72:73], v[218:219], v[84:85]
  v_pk_fma_f32 v[76:77], v[76:77], v[220:221], v[84:85]
  v_pk_fma_f32 v[80:81], v[80:81], v[222:223], v[84:85]
  v_exp_f32 v52, v52 clamp
  v_exp_f32 v53, v53 clamp
  v_exp_f32 v56, v56 clamp
  v_exp_f32 v57, v57 clamp
  v_exp_f32 v60, v60 clamp
  v_exp_f32 v61, v61 clamp
  v_exp_f32 v64, v64 clamp
  v_exp_f32 v65, v65 clamp
  v_exp_f32 v68, v68 clamp
  v_exp_f32 v69, v69 clamp
  v_exp_f32 v72, v72 clamp
  v_exp_f32 v73, v73 clamp
  v_exp_f32 v76, v76 clamp
  v_exp_f32 v77, v77 clamp
  v_exp_f32 v80, v80 clamp
  v_exp_f32 v81, v81 clamp
  v_pk_mul_f32 v[54:55], v[200:201], v[16:17]
  v_pk_mul_f32 v[58:59], v[202:203], v[18:19]
  v_pk_mul_f32 v[62:63], v[204:205], v[20:21]
  v_pk_mul_f32 v[66:67], v[206:207], v[22:23]
  v_pk_mul_f32 v[70:71], v[216:217], v[16:17]
  v_pk_mul_f32 v[74:75], v[218:219], v[18:19]
  v_pk_mul_f32 v[78:79], v[220:221], v[20:21]
  v_pk_mul_f32 v[82:83], v[222:223], v[22:23]
  v_pk_fma_f32 v[52:53], v[52:53], v[86:87], v[248:249]
  v_pk_fma_f32 v[56:57], v[56:57], v[86:87], v[248:249]
  v_pk_fma_f32 v[60:61], v[60:61], v[86:87], v[248:249]
  v_pk_fma_f32 v[64:65], v[64:65], v[86:87], v[248:249]
  v_pk_fma_f32 v[68:69], v[68:69], v[86:87], v[248:249]
  v_pk_fma_f32 v[72:73], v[72:73], v[86:87], v[248:249]
  v_pk_fma_f32 v[76:77], v[76:77], v[86:87], v[248:249]
  v_pk_fma_f32 v[80:81], v[80:81], v[86:87], v[248:249]
  v_pk_mul_f32 v[54:55], v[54:55], v[56:57]
  v_pk_mul_f32 v[62:63], v[62:63], v[64:65]
  v_pk_mul_f32 v[70:71], v[70:71], v[72:73]
  v_pk_mul_f32 v[78:79], v[78:79], v[80:81]
  v_pk_fma_f32 v[54:55], v[58:59], v[52:53], v[54:55]
  v_pk_fma_f32 v[62:63], v[66:67], v[60:61], v[62:63]
  v_pk_fma_f32 v[70:71], v[74:75], v[68:69], v[70:71]
  v_pk_fma_f32 v[78:79], v[82:83], v[76:77], v[78:79]
  v_pk_mul_f32 v[52:53], v[52:53], v[56:57]
  v_pk_mul_f32 v[60:61], v[60:61], v[64:65]
  v_pk_mul_f32 v[68:69], v[68:69], v[72:73]
  v_pk_mul_f32 v[76:77], v[76:77], v[80:81]
  v_pk_mul_f32 v[54:55], v[54:55], v[60:61]
  v_pk_mul_f32 v[70:71], v[70:71], v[76:77]
  v_pk_fma_f32 v[54:55], v[62:63], v[52:53], v[54:55]
  v_pk_fma_f32 v[70:71], v[78:79], v[68:69], v[70:71]
  v_pk_mul_f32 v[52:53], v[52:53], v[60:61]
  v_pk_mul_f32 v[68:69], v[68:69], v[76:77]
  v_rcp_f32 v52, v52
  v_rcp_f32 v53, v53
  v_rcp_f32 v68, v68
  v_rcp_f32 v69, v69
  v_pk_mul_f32 v[46:47], v[52:53], v[54:55]
  v_pk_mul_f32 v[48:49], v[68:69], v[70:71]
  v_pk_mul_f32 v[52:53], v[208:209], v[208:209]
  v_pk_mul_f32 v[56:57], v[210:211], v[210:211]
  v_pk_mul_f32 v[60:61], v[212:213], v[212:213]
  v_pk_mul_f32 v[64:65], v[214:215], v[214:215]
  v_pk_mul_f32 v[68:69], v[224:225], v[224:225]
  v_pk_mul_f32 v[72:73], v[226:227], v[226:227]
  v_pk_mul_f32 v[76:77], v[228:229], v[228:229]
  v_pk_mul_f32 v[80:81], v[230:231], v[230:231]
  v_pk_fma_f32 v[52:53], v[52:53], v[14:15], v[12:13]
  v_pk_fma_f32 v[56:57], v[56:57], v[14:15], v[12:13]
  v_pk_fma_f32 v[60:61], v[60:61], v[14:15], v[12:13]
  v_pk_fma_f32 v[64:65], v[64:65], v[14:15], v[12:13]
  v_pk_fma_f32 v[68:69], v[68:69], v[14:15], v[12:13]
  v_pk_fma_f32 v[72:73], v[72:73], v[14:15], v[12:13]
  v_pk_fma_f32 v[76:77], v[76:77], v[14:15], v[12:13]
  v_pk_fma_f32 v[80:81], v[80:81], v[14:15], v[12:13]
  v_pk_fma_f32 v[52:53], v[52:53], v[208:209], v[84:85]
  v_pk_fma_f32 v[56:57], v[56:57], v[210:211], v[84:85]
  v_pk_fma_f32 v[60:61], v[60:61], v[212:213], v[84:85]
  v_pk_fma_f32 v[64:65], v[64:65], v[214:215], v[84:85]
  v_pk_fma_f32 v[68:69], v[68:69], v[224:225], v[84:85]
  v_pk_fma_f32 v[72:73], v[72:73], v[226:227], v[84:85]
  v_pk_fma_f32 v[76:77], v[76:77], v[228:229], v[84:85]
  v_pk_fma_f32 v[80:81], v[80:81], v[230:231], v[84:85]
  v_exp_f32 v52, v52 clamp
  v_exp_f32 v53, v53 clamp
  v_exp_f32 v56, v56 clamp
  v_exp_f32 v57, v57 clamp
  v_exp_f32 v60, v60 clamp
  v_exp_f32 v61, v61 clamp
  v_exp_f32 v64, v64 clamp
  v_exp_f32 v65, v65 clamp
  v_exp_f32 v68, v68 clamp
  v_exp_f32 v69, v69 clamp
  v_exp_f32 v72, v72 clamp
  v_exp_f32 v73, v73 clamp
  v_exp_f32 v76, v76 clamp
  v_exp_f32 v77, v77 clamp
  v_exp_f32 v80, v80 clamp
  v_exp_f32 v81, v81 clamp
  v_pk_mul_f32 v[54:55], v[208:209], v[24:25]
  v_pk_mul_f32 v[58:59], v[210:211], v[26:27]
  v_pk_mul_f32 v[62:63], v[212:213], v[28:29]
  v_pk_mul_f32 v[66:67], v[214:215], v[30:31]
  v_pk_mul_f32 v[70:71], v[224:225], v[24:25]
  v_pk_mul_f32 v[74:75], v[226:227], v[26:27]
  v_pk_mul_f32 v[78:79], v[228:229], v[28:29]
  v_pk_mul_f32 v[82:83], v[230:231], v[30:31]
  v_pk_fma_f32 v[52:53], v[52:53], v[86:87], v[248:249]
  v_pk_fma_f32 v[56:57], v[56:57], v[86:87], v[248:249]
  v_pk_fma_f32 v[60:61], v[60:61], v[86:87], v[248:249]
  v_pk_fma_f32 v[64:65], v[64:65], v[86:87], v[248:249]
  v_pk_fma_f32 v[68:69], v[68:69], v[86:87], v[248:249]
  v_pk_fma_f32 v[72:73], v[72:73], v[86:87], v[248:249]
  v_pk_fma_f32 v[76:77], v[76:77], v[86:87], v[248:249]
  v_pk_fma_f32 v[80:81], v[80:81], v[86:87], v[248:249]
  v_pk_mul_f32 v[54:55], v[54:55], v[56:57]
  v_pk_mul_f32 v[62:63], v[62:63], v[64:65]
  v_pk_mul_f32 v[70:71], v[70:71], v[72:73]
  v_pk_mul_f32 v[78:79], v[78:79], v[80:81]
  v_pk_fma_f32 v[54:55], v[58:59], v[52:53], v[54:55]
  v_pk_fma_f32 v[62:63], v[66:67], v[60:61], v[62:63]
  v_pk_fma_f32 v[70:71], v[74:75], v[68:69], v[70:71]
  v_pk_fma_f32 v[78:79], v[82:83], v[76:77], v[78:79]
  v_pk_mul_f32 v[52:53], v[52:53], v[56:57]
  v_pk_mul_f32 v[60:61], v[60:61], v[64:65]
  v_pk_mul_f32 v[68:69], v[68:69], v[72:73]
  v_pk_mul_f32 v[76:77], v[76:77], v[80:81]
  v_pk_mul_f32 v[54:55], v[54:55], v[60:61]
  v_pk_mul_f32 v[70:71], v[70:71], v[76:77]
  v_pk_fma_f32 v[54:55], v[62:63], v[52:53], v[54:55]
  v_pk_fma_f32 v[70:71], v[78:79], v[68:69], v[70:71]
  v_pk_mul_f32 v[52:53], v[52:53], v[60:61]
  v_pk_mul_f32 v[68:69], v[68:69], v[76:77]
  v_rcp_f32 v52, v52
  v_rcp_f32 v53, v53
  v_rcp_f32 v68, v68
  v_rcp_f32 v69, v69
  v_pk_fma_f32 v[46:47], v[52:53], v[54:55], v[46:47]
  v_pk_fma_f32 v[48:49], v[68:69], v[70:71], v[48:49]
  v_pk_mul_f32 v[52:53], v[232:233], v[232:233]
  v_pk_mul_f32 v[56:57], v[234:235], v[234:235]
  v_pk_mul_f32 v[60:61], v[236:237], v[236:237]
  v_pk_mul_f32 v[64:65], v[238:239], v[238:239]
  v_pk_mul_f32 v[68:69], v[240:241], v[240:241]
  v_pk_mul_f32 v[72:73], v[242:243], v[242:243]
  v_pk_mul_f32 v[76:77], v[244:245], v[244:245]
  v_pk_mul_f32 v[80:81], v[246:247], v[246:247]
  v_pk_fma_f32 v[52:53], v[52:53], v[14:15], v[12:13]
  v_pk_fma_f32 v[56:57], v[56:57], v[14:15], v[12:13]
  v_pk_fma_f32 v[60:61], v[60:61], v[14:15], v[12:13]
  v_pk_fma_f32 v[64:65], v[64:65], v[14:15], v[12:13]
  v_pk_fma_f32 v[68:69], v[68:69], v[14:15], v[12:13]
  v_pk_fma_f32 v[72:73], v[72:73], v[14:15], v[12:13]
  v_pk_fma_f32 v[76:77], v[76:77], v[14:15], v[12:13]
  v_pk_fma_f32 v[80:81], v[80:81], v[14:15], v[12:13]
  v_pk_fma_f32 v[52:53], v[52:53], v[232:233], v[84:85]
  v_pk_fma_f32 v[56:57], v[56:57], v[234:235], v[84:85]
  v_pk_fma_f32 v[60:61], v[60:61], v[236:237], v[84:85]
  v_pk_fma_f32 v[64:65], v[64:65], v[238:239], v[84:85]
  v_pk_fma_f32 v[68:69], v[68:69], v[240:241], v[84:85]
  v_pk_fma_f32 v[72:73], v[72:73], v[242:243], v[84:85]
  v_pk_fma_f32 v[76:77], v[76:77], v[244:245], v[84:85]
  v_pk_fma_f32 v[80:81], v[80:81], v[246:247], v[84:85]
  v_exp_f32 v52, v52 clamp
  v_exp_f32 v53, v53 clamp
  v_exp_f32 v56, v56 clamp
  v_exp_f32 v57, v57 clamp
  v_exp_f32 v60, v60 clamp
  v_exp_f32 v61, v61 clamp
  v_exp_f32 v64, v64 clamp
  v_exp_f32 v65, v65 clamp
  v_exp_f32 v68, v68 clamp
  v_exp_f32 v69, v69 clamp
  v_exp_f32 v72, v72 clamp
  v_exp_f32 v73, v73 clamp
  v_exp_f32 v76, v76 clamp
  v_exp_f32 v77, v77 clamp
  v_exp_f32 v80, v80 clamp
  v_exp_f32 v81, v81 clamp
  v_pk_mul_f32 v[54:55], v[232:233], v[16:17]
  v_pk_mul_f32 v[58:59], v[234:235], v[18:19]
  v_pk_mul_f32 v[62:63], v[236:237], v[20:21]
  v_pk_mul_f32 v[66:67], v[238:239], v[22:23]
  v_pk_mul_f32 v[70:71], v[240:241], v[24:25]
  v_pk_mul_f32 v[74:75], v[242:243], v[26:27]
  v_pk_mul_f32 v[78:79], v[244:245], v[28:29]
  v_pk_mul_f32 v[82:83], v[246:247], v[30:31]
  v_pk_fma_f32 v[52:53], v[52:53], v[86:87], v[248:249]
  v_pk_fma_f32 v[56:57], v[56:57], v[86:87], v[248:249]
  v_pk_fma_f32 v[60:61], v[60:61], v[86:87], v[248:249]
  v_pk_fma_f32 v[64:65], v[64:65], v[86:87], v[248:249]
  v_pk_fma_f32 v[68:69], v[68:69], v[86:87], v[248:249]
  v_pk_fma_f32 v[72:73], v[72:73], v[86:87], v[248:249]
  v_pk_fma_f32 v[76:77], v[76:77], v[86:87], v[248:249]
  v_pk_fma_f32 v[80:81], v[80:81], v[86:87], v[248:249]
  v_pk_mul_f32 v[54:55], v[54:55], v[56:57]
  v_pk_mul_f32 v[62:63], v[62:63], v[64:65]
  v_pk_mul_f32 v[70:71], v[70:71], v[72:73]
  v_pk_mul_f32 v[78:79], v[78:79], v[80:81]
  v_pk_fma_f32 v[54:55], v[58:59], v[52:53], v[54:55]
  v_pk_fma_f32 v[62:63], v[66:67], v[60:61], v[62:63]
  v_pk_fma_f32 v[70:71], v[74:75], v[68:69], v[70:71]
  v_pk_fma_f32 v[78:79], v[82:83], v[76:77], v[78:79]
  v_pk_mul_f32 v[52:53], v[52:53], v[56:57]
  v_pk_mul_f32 v[60:61], v[60:61], v[64:65]
  v_pk_mul_f32 v[68:69], v[68:69], v[72:73]
  v_pk_mul_f32 v[76:77], v[76:77], v[80:81]
  v_pk_mul_f32 v[54:55], v[54:55], v[60:61]
  v_pk_mul_f32 v[70:71], v[70:71], v[76:77]
  v_pk_fma_f32 v[54:55], v[62:63], v[52:53], v[54:55]
  v_pk_fma_f32 v[70:71], v[78:79], v[68:69], v[70:71]
  v_pk_mul_f32 v[52:53], v[52:53], v[60:61]
  v_pk_mul_f32 v[68:69], v[68:69], v[76:77]
  v_rcp_f32 v52, v52
  v_rcp_f32 v53, v53
  v_rcp_f32 v68, v68
  v_rcp_f32 v69, v69
  v_pk_mul_f32 v[50:51], v[52:53], v[54:55]
  v_pk_fma_f32 v[50:51], v[68:69], v[70:71], v[50:51]
  v_pk_mul_f32 v[32:33], v[88:89], v[16:17]
  v_pk_fma_f32 v[32:33], v[90:91], v[18:19], v[32:33]
  v_pk_fma_f32 v[32:33], v[92:93], v[20:21], v[32:33]
  v_pk_fma_f32 v[32:33], v[94:95], v[22:23], v[32:33]
  v_pk_fma_f32 v[32:33], v[96:97], v[24:25], v[32:33]
  v_pk_fma_f32 v[32:33], v[98:99], v[26:27], v[32:33]
  v_pk_fma_f32 v[32:33], v[100:101], v[28:29], v[32:33]
  v_pk_fma_f32 v[32:33], v[102:103], v[30:31], v[32:33]
  v_add_f32 v32, v32, v33
  v_add_f32 v34, v34, v35
  v_add_f32 v36, v36, v37
  v_add_f32 v38, v38, v39
  v_add_f32 v40, v40, v41
  v_add_f32 v42, v42, v43
  v_add_f32 v44, v44, v45
  v_add_f32 v46, v46, v47
  v_add_f32 v48, v48, v49
  v_add_f32 v50, v50, v51
  v_permlane32_swap_b32 v32, v34
  v_permlane32_swap_b32 v36, v38
  v_permlane32_swap_b32 v40, v42
  v_permlane32_swap_b32 v44, v46
  v_permlane32_swap_b32 v48, v50
  v_add_f32 v48, v48, v50
  v_add_f32 v32, v32, v34
  v_add_f32 v36, v36, v38
  v_add_f32 v40, v40, v42
  v_add_f32 v44, v44, v46
  v_mov_b32 v50, v48
  v_permlane16_swap_b32 v32, v36
  v_permlane16_swap_b32 v40, v44
  v_permlane16_swap_b32 v48, v50
  v_add_f32 v32, v32, v36
  v_add_f32 v40, v40, v44
  v_add_f32 v48, v48, v50
  ds_write_b32 v10, v32
  ds_write_b32 v10, v40 offset:256
  s_mov_b32 exec_lo, 0xffff
  s_mov_b32 exec_hi, 0xffff
  ds_write_b32 v10, v48 offset:512
  s_mov_b64 exec, -1
  s_waitcnt lgkmcnt(0)
  s_barrier
  s_endpgm
L_ld_tail0:
  s_waitcnt vmcnt(0)
L_ld_tail:
  s_barrier
  s_mov_b32 s60, s24
  s_and_b32 s61, s25, 0xffff
  s_mov_b32 s62, 268435456
  s_mov_b32 s63, 0x20000
  s_mov_b32 s56, s20
  s_and_b32 s57, s21, 0xffff
  s_mov_b32 s58, 8192
  s_mov_b32 s59, 0x20000
  s_mov_b32 s64, s22
  s_and_b32 s65, s23, 0xffff
  s_mov_b32 s66, 256
  s_mov_b32 s67, 0x20000
  s_load_dword s80, s[18:19], 0
  v_mov_b32 v100, 0
  s_mov_b64 exec, 1
  s_mov_b32 s81, 0x80000
  buffer_load_dword v101, v100, s[60:63], s81 offen
  buffer_load_dword v102, v100, s[56:59], 0 offen
  s_mov_b64 exec, -1
  s_mov_b64 exec, 1
  buffer_load_dword v250, v100, s[64:67], 0 offen offset:240 sc1
  s_mov_b64 exec, -1
  s_cmp_lg_u32 s3, 4
  s_cbranch_scc1 L_end
  v_lshlrev_b32 v3, 4, v0
  v_lshlrev_b32 v4, 2, v0
  v_add_u32 v1, 123392, v3
  v_add_u32 v2, 124416, v4
  v_add_u32 v4, 1024, v4
  v_mov_b32 v5, 32
  v_mov_b32 v7, s26
  s_mul_i32 s68, s26, 1280
  s_mul_i32 s69, s27, 16640
  s_add_u32 s69, s69, s68
  s_setprio 3
  v_mov_b32 v64, -1
  v_mov_b32 v65, -1
  v_mov_b32 v66, -1
  v_mov_b32 v67, -1
  buffer_store_dwordx4 v[64:67], v3, s[60:63], s69 offen sc1
  buffer_store_dword v64, v4, s[60:63], s69 offen sc1
  s_waitcnt vmcnt(0)
  s_barrier
  ds_read_b128 v[64:67], v1
  ds_read_b128 v[72:75], v1 offset:1280
  ds_read2st64_b32 v[68:69], v2 offset0:0 offset1:5
  s_waitcnt lgkmcnt(0)
  v_pk_add_f32 v[64:65], v[64:65], v[72:73]
  v_pk_add_f32 v[66:67], v[66:67], v[74:75]
  v_add_f32 v68, v68, v69
  v_min_u32 v64, -2, v64
  v_min_u32 v65, -2, v65
  v_min_u32 v66, -2, v66
  v_min_u32 v67, -2, v67
  v_min_u32 v68, -2, v68
  buffer_store_dwordx4 v[64:67], v3, s[60:63], s69 offen sc1
  buffer_store_dword v68, v4, s[60:63], s69 offen sc1
  s_mov_b64 exec, 1
L_pub:
  v_lshlrev_b32 v6, 4, v7
  s_mov_b32 s70, 0x60000
  v_mov_b32 v13, v5
  buffer_atomic_add v5, v6, s[64:67], 0 offen sc0
  v_cmp_eq_u32 vcc, 12, v7
  v_mov_b32 v8, 0x1b4
  v_mov_b32 v9, 0x1b2
  v_cndmask_b32 v8, v8, v9, vcc
  v_sub_u32 v8, v8, v13
  s_waitcnt vmcnt(0) lgkmcnt(0)
  v_cmp_eq_u32 s[82:83], v5, v8
  s_mov_b64 exec, -1
  s_lshl_b32 s80, s80, 16
  v_lshrrev_b32 v1, 1, v3
  v_lshrrev_b32_e64 v2, 1, v4
L_fin:
  s_cmp_eq_u32 s82, 0
  s_cbranch_scc1 L_done
  s_ff1_i32_b32 s70, s82
  s_bitset0_b32 s82, s70
  v_readlane_b32 s71, v7, s70
  s_waitcnt vmcnt(0)
L_again:
  s_mul_i32 s68, s71, 1280
  buffer_load_dwordx4 v[64:67], v3, s[60:63], s68 offen sc1
  buffer_load_dword v68, v4, s[60:63], s68 offen sc1
  s_add_u32 s68, s68, 16640
  buffer_load_dwordx4 v[72:75], v3, s[60:63], s68 offen sc1
  buffer_load_dword v76, v4, s[60:63], s68 offen sc1
  s_add_u32 s68, s68, 16640
  buffer_load_dwordx4 v[80:83], v3, s[60:63], s68 offen sc1
  buffer_load_dword v84, v4, s[60:63], s68 offen sc1
  s_add_u32 s68, s68, 16640
  buffer_load_dwordx4 v[88:91], v3, s[60:63], s68 offen sc1
  buffer_load_dword v92, v4, s[60:63], s68 offen sc1
  s_add_u32 s68, s68, 16640
  buffer_load_dwordx4 v[96:99], v3, s[60:63], s68 offen sc1
  buffer_load_dword v100, v4, s[60:63], s68 offen sc1
  s_add_u32 s68, s68, 16640
  buffer_load_dwordx4 v[104:107], v3, s[60:63], s68 offen sc1
  buffer_load_dword v108, v4, s[60:63], s68 offen sc1
  s_add_u32 s68, s68, 16640
  buffer_load_dwordx4 v[112:115], v3, s[60:63], s68 offen sc1
  buffer_load_dword v116, v4, s[60:63], s68 offen sc1
  s_add_u32 s68, s68, 16640
  buffer_load_dwordx4 v[120:123], v3, s[60:63], s68 offen sc1
  buffer_load_dword v124, v4, s[60:63], s68 offen sc1
  s_add_u32 s68, s68, 16640
  buffer_load_dwordx4 v[128:131], v3, s[60:63], s68 offen sc1
  buffer_load_dword v132, v4, s[60:63], s68 offen sc1
  s_add_u32 s68, s68, 16640
  buffer_load_dwordx4 v[136:139], v3, s[60:63], s68 offen sc1
  buffer_load_dword v140, v4, s[60:63], s68 offen sc1
  s_add_u32 s68, s68, 16640
  buffer_load_dwordx4 v[144:147], v3, s[60:63], s68 offen sc1
  buffer_load_dword v148, v4, s[60:63], s68 offen sc1
  s_add_u32 s68, s68, 16640
  buffer_load_dwordx4 v[152:155], v3, s[60:63], s68 offen sc1
  buffer_load_dword v156, v4, s[60:63], s68 offen sc1
  s_add_u32 s68, s68, 16640
  buffer_load_dwordx4 v[160:163], v3, s[60:63], s68 offen sc1
  buffer_load_dword v164, v4, s[60:63], s68 offen sc1
  s_add_u32 s68, s68, 16640
  buffer_load_dwordx4 v[168:171], v3, s[60:63], s68 offen sc1
  buffer_load_dword v172, v4, s[60:63], s68 offen sc1
  s_add_u32 s68, s68, 16640
L_sum:
  s_waitcnt vmcnt(25)
  v_pk_add_f32 v[56:57], v[64:65], v[72:73]
  v_pk_add_f32 v[58:59], v[66:67], v[74:75]
  s_waitcnt vmcnt(24)
  v_add_f32 v60, v68, v76
  s_waitcnt vmcnt(23)
  v_pk_add_f32 v[56:57], v[56:57], v[80:81]
  v_pk_add_f32 v[58:59], v[58:59], v[82:83]
  s_waitcnt vmcnt(22)
  v_add_f32 v60, v60, v84
  s_waitcnt vmcnt(21)
  v_pk_add_f32 v[56:57], v[56:57], v[88:89]
  v_pk_add_f32 v[58:59], v[58:59], v[90:91]
  s_waitcnt vmcnt(20)
  v_add_f32_e64 v60, v60, v92
  s_waitcnt vmcnt(19)
  v_pk_add_f32 v[56:57], v[56:57], v[96:97]
  v_pk_add_f32 v[58:59], v[58:59], v[98:99]
  s_waitcnt vmcnt(18)
  v_add_f32 v60, v60, v100
  s_waitcnt vmcnt(17)
  v_pk_add_f32 v[56:57], v[56:57], v[104:105]
  v_pk_add_f32 v[58:59], v[58:59], v[106:107]
  s_waitcnt vmcnt(16)
  v_add_f32 v60, v60, v108
  s_waitcnt vmcnt(15)
  v_pk_add_f32 v[56:57], v[56:57], v[112:113]
  v_pk_add_f32 v[58:59], v[58:59], v[114:115]
  s_waitcnt vmcnt(14)
  v_add_f32 v60, v60, v116
  s_waitcnt vmcnt(13)
  v_pk_add_f32 v[56:57], v[56:57], v[120:121]
  v_pk_add_f32 v[58:59], v[58:59], v[122:123]
  s_waitcnt vmcnt(12)
  v_add_f32 v60, v60, v124
  s_waitcnt vmcnt(11)
  v_pk_add_f32 v[56:57], v[56:57], v[128:129]
  v_pk_add_f32 v[58:59], v[58:59], v[130:131]
  s_waitcnt vmcnt(10)
  v_add_f32 v60, v60, v132
  s_waitcnt vmcnt(9)
  v_pk_add_f32 v[56:57], v[56:57], v[136:137]
  v_pk_add_f32 v[58:59], v[58:59], v[138:139]
  s_waitcnt vmcnt(8)
  v_add_f32 v60, v60, v140
  s_waitcnt vmcnt(7)
  v_pk_add_f32 v[56:57], v[56:57], v[144:145]
  v_pk_add_f32 v[58:59], v[58:59], v[146:147]
  s_waitcnt vmcnt(6)
  v_add_f32 v60, v60, v148
  s_waitcnt vmcnt(5)
  v_pk_add_f32 v[56:57], v[56:57], v[152:153]
  v_pk_add_f32 v[58:59], v[58:59], v[154:155]
  s_waitcnt vmcnt(4)
  v_add_f32 v60, v60, v156
  s_waitcnt vmcnt(3)
  v_pk_add_f32 v[56:57], v[56:57], v[160:161]
  v_pk_add_f32 v[58:59], v[58:59], v[162:163]
  s_waitcnt vmcnt(2)
  v_add_f32_e64 v60, v60, v164
  s_waitcnt vmcnt(1)
  v_pk_add_f32 v[56:57], v[56:57], v[168:169]
  v_pk_add_f32 v[58:59], v[58:59], v[170:171]
  s_waitcnt vmcnt(0)
  v_add_f32_e64 v60, v60, v172
  v_cmp_u_f32 vcc, v56, v57
  v_cmp_u_f32 s[92:93], v58, v59
  s_nop 0
  s_or_b64 s[92:93], s[92:93], vcc
  v_cmp_u_f32 vcc, v60, v60
  s_nop 0
  s_or_b64 vcc, s[92:93], vcc
  s_cbranch_vccnz L_chk
L_ok:
  s_mul_i32 s71, s71, 640
  v_add_f32 v56, s80, v56
  v_add_f32 v57, s80, v57
  v_add_f32 v58, s80, v58
  v_add_f32 v59, s80, v59
  v_add_f32_e64 v60, s80, v60
  v_cvt_pk_bf16_f32 v10, v56, v57
  v_cvt_pk_bf16_f32 v11, v58, v59
  v_cvt_pk_bf16_f32 v12, v60, v60
  buffer_store_dwordx2 v[10:11], v1, s[56:59], s71 offen
  buffer_store_short v12, v2, s[56:59], s71 offen
  s_branch L_fin
L_chk:
  v_mov_b32 v14, 0
  v_mov_b32 v15, 0
  v_max3_u32 v14, v14, v64, v65
  v_max3_u32 v14, v14, v66, v67
  v_max_u32 v15, v15, v68
  v_max3_u32 v14, v14, v72, v73
  v_max3_u32 v14, v14, v74, v75
  v_max_u32_e64 v15, v15, v76
  v_max3_u32 v14, v14, v80, v81
  v_max3_u32 v14, v14, v82, v83
  v_max_u32 v15, v15, v84
  v_max3_u32 v14, v14, v88, v89
  v_max3_u32 v14, v14, v90, v91
  v_max_u32 v15, v15, v92
  v_max3_u32 v14, v14, v96, v97
  v_max3_u32 v14, v14, v98, v99
  v_max_u32_e64 v15, v15, v100
  v_max3_u32 v14, v14, v104, v105
  v_max3_u32 v14, v14, v106, v107
  v_max_u32 v15, v15, v108
  v_max3_u32 v14, v14, v112, v113
  v_max3_u32 v14, v14, v114, v115
  v_max_u32 v15, v15, v116
  v_max3_u32 v14, v14, v120, v121
  v_max3_u32 v14, v14, v122, v123
  v_max_u32_e64 v15, v15, v124
  v_max3_u32 v14, v14, v128, v129
  v_max3_u32 v14, v14, v130, v131
  v_max_u32 v15, v15, v132
  v_max3_u32 v14, v14, v136, v137
  v_max3_u32 v14, v14, v138, v139
  v_max_u32 v15, v15, v140
  v_max3_u32 v14, v14, v144, v145
  v_max3_u32 v14, v14, v146, v147
  v_max_u32_e64 v15, v15, v148
  v_max3_u32 v14, v14, v152, v153
  v_max3_u32 v14, v14, v154, v155
  v_max_u32 v15, v15, v156
  v_max3_u32 v14, v14, v160, v161
  v_max3_u32 v14, v14, v162, v163
  v_max_u32 v15, v15, v164
  v_max3_u32 v14, v14, v168, v169
  v_max3_u32 v14, v14, v170, v171
  v_max_u32 v15, v15, v172
  s_cmp_eq_u32 s71, 12
  s_cselect_b32 s68, 0, -1
  v_and_b32 v15, s68, v15
  v_max_u32 v14, v14, v15
  v_cmp_eq_u32 vcc, -1, v14
  s_cbranch_vccnz L_again
  s_branch L_ok
L_done:
  s_endpgm
L_cin_done:
  s_mul_i32 s98, s3, 1536
  s_add_u32 s98, s98, 116736
  v_lshlrev_b32 v120, 5, v0
  v_add_u32_e64 v120, s98, v120
  ds_read_b128 v[60:63], v120
  ds_read_b128 v[64:67], v120 offset:16
  v_mul_f32 v116, v184, v192
  v_mul_f32 v117, v185, v193
  v_mul_f32 v118, v186, v194
  v_mul_f32 v119, v187, v195
  v_fmac_f32 v116, v188, v191
  v_fmac_f32 v117, v200, v208
  v_fmac_f32 v118, v201, v209
  v_fmac_f32 v119, v202, v210
  v_fmac_f32 v116, v203, v211
  v_fmac_f32 v117, v204, v207
  v_fmac_f32 v118, v216, v224
  v_fmac_f32 v119, v217, v225
  v_fmac_f32 v116, v218, v226
  v_fmac_f32 v117, v219, v227
  v_fmac_f32 v118, v220, v223
  v_fmac_f32 v119, v232, v240
  v_fmac_f32 v116, v233, v241
  v_fmac_f32 v117, v234, v242
  v_fmac_f32 v118, v235, v243
  v_fmac_f32 v119, v236, v239
  v_fmac_f32 v116, v189, v196
  v_fmac_f32 v117, v189, v197
  v_fmac_f32 v118, v190, v198
  v_fmac_f32 v119, v190, v199
  v_fmac_f32 v116, v205, v212
  v_fmac_f32 v117, v205, v213
  v_fmac_f32 v118, v206, v214
  v_fmac_f32 v119, v206, v215
  v_fmac_f32 v116, v221, v228
  v_fmac_f32 v117, v221, v229
  v_fmac_f32 v118, v222, v230
  v_fmac_f32 v119, v222, v231
  v_fmac_f32 v116, v237, v244
  v_fmac_f32 v117, v237, v245
  v_fmac_f32 v118, v238, v246
  v_fmac_f32 v119, v238, v247
  v_add_f32 v116, v116, v117
  v_add_f32 v118, v118, v119
  v_add_f32 v116, v116, v118
  v_mul_f32 v116, s74, v116
  v_mul_f32 v116, s75, v116
  s_nop 1
  v_add_f32_dpp v116, v116, v116 row_shr:1 row_mask:0xf bank_mask:0xf
  v_subrev_u32 v122, s98, v7
  v_lshrrev_b32 v122, 8, v122
  v_lshrrev_b32 v121, 3, v0
  v_add_f32_dpp v116, v116, v116 row_shr:2 row_mask:0xf bank_mask:0xf
  v_cmp_gt_u32 vcc, v122, v121
  v_min_u32 v121, v121, v122
  v_lshlrev_b32 v121, 4, v121
  v_add_f32_dpp v116, v116, v116 row_shr:4 row_mask:0xf bank_mask:0xf
  v_add_u32 v121, s85, v121
  s_waitcnt lgkmcnt(1)
  v_add_f32 v60, v60, v61
  v_add_f32 v62, v62, v63
  v_add_f32_dpp v116, v116, v116 row_shr:8 row_mask:0xf bank_mask:0xf
  s_waitcnt lgkmcnt(0)
  v_add_f32 v64, v64, v65
  v_add_f32 v66, v66, v67
  v_add_f32 v60, v60, v62
  v_add_f32_dpp v116, v116, v116 row_bcast:15 row_mask:0xa bank_mask:0xf
  v_add_f32 v64, v64, v66
  v_add_f32_e64 v60, v60, v64
  s_nop 1
  v_add_f32_dpp v60, v60, v60 quad_perm:[1,0,3,2] row_mask:0xf bank_mask:0xf
  v_add_f32_dpp v116, v116, v116 row_bcast:31 row_mask:0xc bank_mask:0xf
  s_nop 0
  v_add_f32_dpp v60, v60, v60 quad_perm:[2,3,0,1] row_mask:0xf bank_mask:0xf
  s_nop 1
  v_add_f32_dpp v60, v60, v60 row_half_mirror row_mask:0xf bank_mask:0xf
  v_cndmask_b32 v60, v116, v60, vcc
  s_bitset1_b32 vcc_hi, 31
  s_mov_b64 exec, vcc
  ds_write_b32 v121, v60
  s_mov_b64 exec, -1
  s_cmp_eq_u32 s3, 0
  s_cbranch_scc1 L_cpub
  s_waitcnt lgkmcnt(0)
  s_barrier
  s_endpgm
L_cpub:
  s_load_dword s80, s[18:19], 0
  s_mov_b32 s60, s24
  s_and_b32 s61, s25, 0xffff
  s_mov_b32 s62, 268435456
  s_mov_b32 s63, 0x20000
  s_mov_b32 s56, s20
  s_and_b32 s57, s21, 0xffff
  s_mov_b32 s58, 8192
  s_mov_b32 s59, 0x20000
  s_mov_b32 s64, s22
  s_and_b32 s65, s23, 0xffff
  s_mov_b32 s66, 256
  s_mov_b32 s67, 0x20000
  v_lshlrev_b32 v6, 2, v0
  v_add_u32 v2, 129728, v6
  v_add_u32 v4, 1024, v6
  s_mul_i32 s69, s26, 192
  s_add_u32 s69, s69, 216320
  v_mov_b32 v13, -1
  s_mov_b32 exec_hi, 0xffff
  buffer_store_dword v13, v6, s[60:63], s69 offen sc1
  s_mov_b64 exec, 1
  buffer_load_dword v250, v6, s[56:59], 0 offen
  buffer_load_dword v251, v6, s[64:67], 0 offen offset:240 sc1
  s_mov_b64 exec, -1
  s_mul_i32 s68, s26, 3
  s_mul_i32 s70, s68, 3277
  s_lshr_b32 s70, s70, 16
  v_add_u32 v7, s70, v0
  s_mul_i32 s70, s70, 20
  s_add_u32 s70, s70, 20
  s_sub_u32 s70, s70, s68
  s_min_u32 s70, s70, 3
  s_sub_u32 s68, 3, s70
  v_mov_b32 v5, s68
  v_writelane_b32 v5, s70, 0
  s_cmp_eq_u32 s68, 0
  s_cselect_b32 s68, 1, 3
  v_lshlrev_b32 v3, 4, v0
  s_mov_b32 exec_hi, 0xffff
  s_waitcnt vmcnt(0) lgkmcnt(0)
  s_barrier
  ds_read_b32 v64, v2
  s_waitcnt lgkmcnt(0)
  v_min_u32 v64, -2, v64
  buffer_store_dword v64, v6, s[60:63], s69 offen sc1
  s_mov_b32 exec_lo, s68
  s_mov_b32 exec_hi, 0
  s_branch L_pub
L_dnn_loop1:
  s_barrier
L_ld_in:
  s_add_u32 m0, s75, 131072
  s_nop 0
  buffer_load_dwordx4 v4, s[44:47], s74 offen lds
  s_add_u32 m0, s75, 132096
  s_nop 0
  buffer_load_dwordx4 v5, s[44:47], s74 offen lds
  s_add_u32 s74, s74, 106496
  s_add_u32 m0, s75, 139264
  s_nop 0
  buffer_load_dwordx4 v4, s[44:47], s74 offen lds
  s_add_u32 m0, s75, 140288
  s_nop 0
  buffer_load_dwordx4 v5, s[44:47], s74 offen lds
  s_add_u32 s74, s74, 106496
  s_add_u32 m0, s76, 0
  s_nop 0
  buffer_load_dwordx4 v56, s[32:35], 0 offen lds
  s_add_u32 m0, s76, 2048
  v_add_u32_dpp v56, v16, v2 row_newbcast:1 row_mask:0xf bank_mask:0x3
  buffer_load_dwordx4 v57, s[32:35], 0 offen lds
  s_nop 0
  v_add_u32_dpp v56, v18, v2 row_newbcast:7 row_mask:0xf bank_mask:0xc
  s_add_u32 m0, s76, 4096
  v_add_u32_dpp v57, v20, v2 row_newbcast:1 row_mask:0xf bank_mask:0x3
  buffer_load_dwordx4 v58, s[32:35], 0 offen lds
  s_nop 0
  v_add_u32_dpp v57, v22, v2 row_newbcast:7 row_mask:0xf bank_mask:0xc
  s_add_u32 m0, s76, 6144
  v_add_u32_dpp v58, v24, v2 row_newbcast:1 row_mask:0xf bank_mask:0x3
  buffer_load_dwordx4 v59, s[32:35], 0 offen lds
  s_nop 0
  v_add_u32_dpp v58, v26, v2 row_newbcast:7 row_mask:0xf bank_mask:0xc
  s_add_u32 m0, s76, 8192
  v_add_u32_dpp v59, v28, v2 row_newbcast:1 row_mask:0xf bank_mask:0x3
  buffer_load_dwordx4 v60, s[32:35], 0 offen lds
  s_nop 0
  v_add_u32_dpp v59, v30, v2 row_newbcast:7 row_mask:0xf bank_mask:0xc
  s_add_u32 m0, s76, 10240
  v_add_u32_dpp v60, v32, v2 row_newbcast:1 row_mask:0xf bank_mask:0x3
  buffer_load_dwordx4 v61, s[32:35], 0 offen lds
  s_nop 0
  v_add_u32_dpp v60, v34, v2 row_newbcast:7 row_mask:0xf bank_mask:0xc
  s_add_u32 m0, s76, 12288
  v_add_u32_dpp v61, v36, v2 row_newbcast:1 row_mask:0xf bank_mask:0x3
  buffer_load_dwordx4 v62, s[32:35], 0 offen lds
  s_nop 0
  v_add_u32_dpp v61, v38, v2 row_newbcast:7 row_mask:0xf bank_mask:0xc
  s_add_u32 m0, s76, 14336
  v_add_u32_dpp v62, v40, v2 row_newbcast:1 row_mask:0xf bank_mask:0x3
  buffer_load_dwordx4 v63, s[32:35], 0 offen lds
  s_nop 0
  v_add_u32_dpp v62, v42, v2 row_newbcast:7 row_mask:0xf bank_mask:0xc
  s_add_u32 m0, s76, 16384
  v_add_u32_dpp v63, v44, v2 row_newbcast:1 row_mask:0xf bank_mask:0x3
  buffer_load_dwordx4 v64, s[32:35], 0 offen lds
  s_nop 0
  v_add_u32_dpp v63, v46, v2 row_newbcast:7 row_mask:0xf bank_mask:0xc
  s_add_u32 m0, s76, 18432
  v_add_u32_dpp v64, v48, v2 row_newbcast:1 row_mask:0xf bank_mask:0x3
  buffer_load_dwordx4 v65, s[32:35], 0 offen lds
  s_nop 0
  v_add_u32_dpp v64, v50, v2 row_newbcast:7 row_mask:0xf bank_mask:0xc
  v_add_u32_dpp v65, v52, v2 row_newbcast:1 row_mask:0xf bank_mask:0x3
  s_nop 1
  v_add_u32_dpp v65, v54, v2 row_newbcast:7 row_mask:0xf bank_mask:0xc
  s_mov_b64 exec, 0x3ff
  buffer_load_dword v103, v84, s[44:47], s85 offen
  s_mov_b64 exec, -1
  s_add_u32 s85, s85, 865280
  s_waitcnt vmcnt(11)
  s_barrier
  s_add_u32 m0, s75, 147456
  s_nop 0
  buffer_load_dwordx4 v4, s[44:47], s74 offen lds
  s_add_u32 m0, s75, 148480
  s_nop 0
  buffer_load_dwordx4 v5, s[44:47], s74 offen lds
  s_add_u32 s74, s74, 106496
  s_add_u32 m0, s75, 155648
  s_nop 0
  buffer_load_dwordx4 v4, s[44:47], s74 offen lds
  s_add_u32 m0, s75, 156672
  s_nop 0
  buffer_load_dwordx4 v5, s[44:47], s74 offen lds
  s_add_u32 s74, s74, 106496
  s_add_u32 m0, s76, 40960
  s_nop 0
  buffer_load_dwordx4 v56, s[32:35], 0 offen lds
  s_add_u32 m0, s76, 43008
  v_add_u32_dpp v56, v17, v2 row_newbcast:1 row_mask:0xf bank_mask:0x3
  buffer_load_dwordx4 v57, s[32:35], 0 offen lds
  s_nop 0
  v_add_u32_dpp v56, v19, v2 row_newbcast:7 row_mask:0xf bank_mask:0xc
  s_add_u32 m0, s76, 45056
  v_add_u32_dpp v57, v21, v2 row_newbcast:1 row_mask:0xf bank_mask:0x3
  buffer_load_dwordx4 v58, s[32:35], 0 offen lds
  s_nop 0
  v_add_u32_dpp v57, v23, v2 row_newbcast:7 row_mask:0xf bank_mask:0xc
  s_add_u32 m0, s76, 47104
  v_add_u32_dpp v58, v25, v2 row_newbcast:1 row_mask:0xf bank_mask:0x3
  buffer_load_dwordx4 v59, s[32:35], 0 offen lds
  s_nop 0
  v_add_u32_dpp v58, v27, v2 row_newbcast:7 row_mask:0xf bank_mask:0xc
  s_add_u32 m0, s76, 49152
  v_add_u32_dpp v59, v29, v2 row_newbcast:1 row_mask:0xf bank_mask:0x3
  buffer_load_dwordx4 v60, s[32:35], 0 offen lds
  s_nop 0
  v_add_u32_dpp v59, v31, v2 row_newbcast:7 row_mask:0xf bank_mask:0xc
  s_add_u32 m0, s76, 51200
  v_add_u32_dpp v60, v33, v2 row_newbcast:1 row_mask:0xf bank_mask:0x3
  buffer_load_dwordx4 v61, s[32:35], 0 offen lds
  s_nop 0
  v_add_u32_dpp v60, v35, v2 row_newbcast:7 row_mask:0xf bank_mask:0xc
  s_add_u32 m0, s76, 53248
  v_add_u32_dpp v61, v37, v2 row_newbcast:1 row_mask:0xf bank_mask:0x3
  buffer_load_dwordx4 v62, s[32:35], 0 offen lds
  s_nop 0
  v_add_u32_dpp v61, v39, v2 row_newbcast:7 row_mask:0xf bank_mask:0xc
  s_add_u32 m0, s76, 55296
  v_add_u32_dpp v62, v41, v2 row_newbcast:1 row_mask:0xf bank_mask:0x3
  buffer_load_dwordx4 v63, s[32:35], 0 offen lds
  s_nop 0
  v_add_u32_dpp v62, v43, v2 row_newbcast:7 row_mask:0xf bank_mask:0xc
  s_add_u32 m0, s76, 57344
  v_add_u32_dpp v63, v45, v2 row_newbcast:1 row_mask:0xf bank_mask:0x3
  buffer_load_dwordx4 v64, s[32:35], 0 offen lds
  s_nop 0
  v_add_u32_dpp v63, v47, v2 row_newbcast:7 row_mask:0xf bank_mask:0xc
  s_add_u32 m0, s76, 59392
  v_add_u32_dpp v64, v49, v2 row_newbcast:1 row_mask:0xf bank_mask:0x3
  buffer_load_dwordx4 v65, s[32:35], 0 offen lds
  s_nop 0
  v_add_u32_dpp v64, v51, v2 row_newbcast:7 row_mask:0xf bank_mask:0xc
  v_add_u32_dpp v65, v53, v2 row_newbcast:1 row_mask:0xf bank_mask:0x3
  s_nop 1
  v_add_u32_dpp v65, v55, v2 row_newbcast:7 row_mask:0xf bank_mask:0xc
  s_waitcnt vmcnt(10)
  s_barrier
  s_add_u32 m0, s75, 131072
  s_nop 0
  buffer_load_dwordx4 v4, s[44:47], s74 offen lds
  s_add_u32 m0, s75, 132096
  s_nop 0
  buffer_load_dwordx4 v5, s[44:47], s74 offen lds
  s_add_u32 s74, s74, 106496
  s_add_u32 m0, s75, 139264
  s_nop 0
  buffer_load_dwordx4 v4, s[44:47], s74 offen lds
  s_add_u32 m0, s75, 140288
  s_nop 0
  buffer_load_dwordx4 v5, s[44:47], s74 offen lds
  s_add_u32 s74, s74, 106496
  s_add_u32 m0, s76, 81920
  s_nop 0
  buffer_load_dwordx4 v56, s[32:35], 0 offen lds
  s_add_u32 m0, s76, 83968
  v_add_u32_dpp v56, v18, v2 row_newbcast:1 row_mask:0xf bank_mask:0x3
  buffer_load_dwordx4 v57, s[32:35], 0 offen lds
  s_nop 0
  v_add_u32_dpp v56, v16, v2 row_newbcast:8 row_mask:0xf bank_mask:0xc
  s_add_u32 m0, s76, 86016
  v_add_u32_dpp v57, v22, v2 row_newbcast:1 row_mask:0xf bank_mask:0x3
  buffer_load_dwordx4 v58, s[32:35], 0 offen lds
  s_nop 0
  v_add_u32_dpp v57, v20, v2 row_newbcast:8 row_mask:0xf bank_mask:0xc
  s_add_u32 m0, s76, 88064
  v_add_u32_dpp v58, v26, v2 row_newbcast:1 row_mask:0xf bank_mask:0x3
  buffer_load_dwordx4 v59, s[32:35], 0 offen lds
  s_nop 0
  v_add_u32_dpp v58, v24, v2 row_newbcast:8 row_mask:0xf bank_mask:0xc
  s_add_u32 m0, s76, 90112
  v_add_u32_dpp v59, v30, v2 row_newbcast:1 row_mask:0xf bank_mask:0x3
  buffer_load_dwordx4 v60, s[32:35], 0 offen lds
  s_nop 0
  v_add_u32_dpp v59, v28, v2 row_newbcast:8 row_mask:0xf bank_mask:0xc
  s_add_u32 m0, s76, 92160
  v_add_u32_dpp v60, v34, v2 row_newbcast:1 row_mask:0xf bank_mask:0x3
  buffer_load_dwordx4 v61, s[32:35], 0 offen lds
  s_nop 0
  v_add_u32_dpp v60, v32, v2 row_newbcast:8 row_mask:0xf bank_mask:0xc
  s_add_u32 m0, s76, 94208
  v_add_u32_dpp v61, v38, v2 row_newbcast:1 row_mask:0xf bank_mask:0x3
  buffer_load_dwordx4 v62, s[32:35], 0 offen lds
  s_nop 0
  v_add_u32_dpp v61, v36, v2 row_newbcast:8 row_mask:0xf bank_mask:0xc
  s_add_u32 m0, s76, 96256
  v_add_u32_dpp v62, v42, v2 row_newbcast:1 row_mask:0xf bank_mask:0x3
  buffer_load_dwordx4 v63, s[32:35], 0 offen lds
  s_nop 0
  v_add_u32_dpp v62, v40, v2 row_newbcast:8 row_mask:0xf bank_mask:0xc
  s_add_u32 m0, s76, 98304
  v_add_u32_dpp v63, v46, v2 row_newbcast:1 row_mask:0xf bank_mask:0x3
  buffer_load_dwordx4 v64, s[32:35], 0 offen lds
  s_nop 0
  v_add_u32_dpp v63, v44, v2 row_newbcast:8 row_mask:0xf bank_mask:0xc
  s_add_u32 m0, s76, 100352
  v_add_u32_dpp v64, v50, v2 row_newbcast:1 row_mask:0xf bank_mask:0x3
  buffer_load_dwordx4 v65, s[32:35], 0 offen lds
  s_nop 0
  v_add_u32_dpp v64, v48, v2 row_newbcast:8 row_mask:0xf bank_mask:0xc
  v_add_u32_dpp v65, v54, v2 row_newbcast:1 row_mask:0xf bank_mask:0x3
  s_nop 1
  v_add_u32_dpp v65, v52, v2 row_newbcast:8 row_mask:0xf bank_mask:0xc
  v_lshlrev_b32 v101, 7, v70
  s_mov_b32 exec_lo, 0xffffffff
  s_mov_b32 exec_hi, 0x0
  buffer_load_dword v102, v101, s[32:35], 0 offen
  s_mov_b64 exec, -1
  v_mov_b32 v70, v71
  v_mov_b32 v71, v72
  v_mov_b32 v72, v73
  v_mov_b32_e64 v73, v74
  v_mov_b32 v74, 0xffffff
  s_waitcnt vmcnt(11)
  s_barrier
  s_add_u32 m0, s75, 147456
  s_nop 0
  buffer_load_dwordx4 v4, s[44:47], s74 offen lds
  s_add_u32 m0, s75, 148480
  s_nop 0
  buffer_load_dwordx4 v5, s[44:47], s74 offen lds
  s_add_u32 s74, s74, 106496
  s_add_u32 m0, s75, 155648
  s_nop 0
  buffer_load_dwordx4 v4, s[44:47], s74 offen lds
  s_add_u32 m0, s75, 156672
  s_nop 0
  buffer_load_dwordx4 v5, s[44:47], s74 offen lds
  s_add_u32 s74, s74, 106496
  s_add_u32 m0, s76, 0
  s_nop 0
  buffer_load_dwordx4 v56, s[32:35], 0 offen lds
  s_add_u32 m0, s76, 2048
  v_add_u32_dpp v56, v19, v2 row_newbcast:1 row_mask:0xf bank_mask:0x3
  buffer_load_dwordx4 v57, s[32:35], 0 offen lds
  s_nop 0
  v_add_u32_dpp v56, v17, v2 row_newbcast:8 row_mask:0xf bank_mask:0xc
  s_add_u32 m0, s76, 4096
  v_add_u32_dpp v57, v23, v2 row_newbcast:1 row_mask:0xf bank_mask:0x3
  buffer_load_dwordx4 v58, s[32:35], 0 offen lds
  s_nop 0
  v_add_u32_dpp v57, v21, v2 row_newbcast:8 row_mask:0xf bank_mask:0xc
  s_add_u32 m0, s76, 6144
  v_add_u32_dpp v58, v27, v2 row_newbcast:1 row_mask:0xf bank_mask:0x3
  buffer_load_dwordx4 v59, s[32:35], 0 offen lds
  s_nop 0
  v_add_u32_dpp v58, v25, v2 row_newbcast:8 row_mask:0xf bank_mask:0xc
  s_add_u32 m0, s76, 8192
  v_add_u32_dpp v59, v31, v2 row_newbcast:1 row_mask:0xf bank_mask:0x3
  buffer_load_dwordx4 v60, s[32:35], 0 offen lds
  s_nop 0
  v_add_u32_dpp v59, v29, v2 row_newbcast:8 row_mask:0xf bank_mask:0xc
  s_add_u32 m0, s76, 10240
  v_add_u32_dpp v60, v35, v2 row_newbcast:1 row_mask:0xf bank_mask:0x3
  buffer_load_dwordx4 v61, s[32:35], 0 offen lds
  s_nop 0
  v_add_u32_dpp v60, v33, v2 row_newbcast:8 row_mask:0xf bank_mask:0xc
  s_add_u32 m0, s76, 12288
  v_add_u32_dpp v61, v39, v2 row_newbcast:1 row_mask:0xf bank_mask:0x3
  buffer_load_dwordx4 v62, s[32:35], 0 offen lds
  s_nop 0
  v_add_u32_dpp v61, v37, v2 row_newbcast:8 row_mask:0xf bank_mask:0xc
  s_add_u32 m0, s76, 14336
  v_add_u32_dpp v62, v43, v2 row_newbcast:1 row_mask:0xf bank_mask:0x3
  buffer_load_dwordx4 v63, s[32:35], 0 offen lds
  s_nop 0
  v_add_u32_dpp v62, v41, v2 row_newbcast:8 row_mask:0xf bank_mask:0xc
  s_add_u32 m0, s76, 16384
  v_add_u32_dpp v63, v47, v2 row_newbcast:1 row_mask:0xf bank_mask:0x3
  buffer_load_dwordx4 v64, s[32:35], 0 offen lds
  s_nop 0
  v_add_u32_dpp v63, v45, v2 row_newbcast:8 row_mask:0xf bank_mask:0xc
  s_add_u32 m0, s76, 18432
  v_add_u32_dpp v64, v51, v2 row_newbcast:1 row_mask:0xf bank_mask:0x3
  buffer_load_dwordx4 v65, s[32:35], 0 offen lds
  s_nop 0
  v_add_u32_dpp v64, v49, v2 row_newbcast:8 row_mask:0xf bank_mask:0xc
  v_add_u32_dpp v65, v55, v2 row_newbcast:1 row_mask:0xf bank_mask:0x3
  s_nop 1
  v_add_u32_dpp v65, v53, v2 row_newbcast:8 row_mask:0xf bank_mask:0xc
  s_waitcnt vmcnt(10)
  s_barrier
  s_add_u32 m0, s75, 131072
  s_nop 0
  buffer_load_dwordx4 v4, s[44:47], s74 offen lds
  s_add_u32 m0, s75, 132096
  s_nop 0
  buffer_load_dwordx4 v5, s[44:47], s74 offen lds
  s_add_u32 s74, s74, 106496
  s_add_u32 m0, s75, 139264
  s_nop 0
  buffer_load_dwordx4 v4, s[44:47], s74 offen lds
  s_add_u32 m0, s75, 140288
  s_nop 0
  buffer_load_dwordx4 v5, s[44:47], s74 offen lds
  s_add_u32 s74, s74, 106496
  s_add_u32 m0, s76, 40960
  s_nop 0
  buffer_load_dwordx4 v56, s[32:35], 0 offen lds
  s_add_u32 m0, s76, 43008
  v_add_u32_dpp v56, v16, v2 row_newbcast:2 row_mask:0xf bank_mask:0x3
  buffer_load_dwordx4 v57, s[32:35], 0 offen lds
  s_nop 0
  v_add_u32_dpp v56, v18, v2 row_newbcast:8 row_mask:0xf bank_mask:0xc
  s_add_u32 m0, s76, 45056
  v_add_u32_dpp v57, v20, v2 row_newbcast:2 row_mask:0xf bank_mask:0x3
  buffer_load_dwordx4 v58, s[32:35], 0 offen lds
  s_nop 0
  v_add_u32_dpp v57, v22, v2 row_newbcast:8 row_mask:0xf bank_mask:0xc
  s_add_u32 m0, s76, 47104
  v_add_u32_dpp v58, v24, v2 row_newbcast:2 row_mask:0xf bank_mask:0x3
  buffer_load_dwordx4 v59, s[32:35], 0 offen lds
  s_nop 0
  v_add_u32_dpp v58, v26, v2 row_newbcast:8 row_mask:0xf bank_mask:0xc
  s_add_u32 m0, s76, 49152
  v_add_u32_dpp v59, v28, v2 row_newbcast:2 row_mask:0xf bank_mask:0x3
  buffer_load_dwordx4 v60, s[32:35], 0 offen lds
  s_nop 0
  v_add_u32_dpp v59, v30, v2 row_newbcast:8 row_mask:0xf bank_mask:0xc
  s_add_u32 m0, s76, 51200
  v_add_u32_dpp v60, v32, v2 row_newbcast:2 row_mask:0xf bank_mask:0x3
  buffer_load_dwordx4 v61, s[32:35], 0 offen lds
  s_nop 0
  v_add_u32_dpp v60, v34, v2 row_newbcast:8 row_mask:0xf bank_mask:0xc
  s_add_u32 m0, s76, 53248
  v_add_u32_dpp v61, v36, v2 row_newbcast:2 row_mask:0xf bank_mask:0x3
  buffer_load_dwordx4 v62, s[32:35], 0 offen lds
  s_nop 0
  v_add_u32_dpp v61, v38, v2 row_newbcast:8 row_mask:0xf bank_mask:0xc
  s_add_u32 m0, s76, 55296
  v_add_u32_dpp v62, v40, v2 row_newbcast:2 row_mask:0xf bank_mask:0x3
  buffer_load_dwordx4 v63, s[32:35], 0 offen lds
  s_nop 0
  v_add_u32_dpp v62, v42, v2 row_newbcast:8 row_mask:0xf bank_mask:0xc
  s_add_u32 m0, s76, 57344
  v_add_u32_dpp v63, v44, v2 row_newbcast:2 row_mask:0xf bank_mask:0x3
  buffer_load_dwordx4 v64, s[32:35], 0 offen lds
  s_nop 0
  v_add_u32_dpp v63, v46, v2 row_newbcast:8 row_mask:0xf bank_mask:0xc
  s_add_u32 m0, s76, 59392
  v_add_u32_dpp v64, v48, v2 row_newbcast:2 row_mask:0xf bank_mask:0x3
  buffer_load_dwordx4 v65, s[32:35], 0 offen lds
  s_nop 0
  v_add_u32_dpp v64, v50, v2 row_newbcast:8 row_mask:0xf bank_mask:0xc
  v_add_u32_dpp v65, v52, v2 row_newbcast:2 row_mask:0xf bank_mask:0x3
  s_nop 1
  v_add_u32_dpp v65, v54, v2 row_newbcast:8 row_mask:0xf bank_mask:0xc
  s_mov_b64 exec, 0x3ff
  buffer_load_dword v103, v84, s[44:47], s85 offen
  s_mov_b64 exec, -1
  s_add_u32 s85, s85, 865280
  s_waitcnt vmcnt(11)
  s_barrier
  s_add_u32 m0, s75, 147456
  s_nop 0
  buffer_load_dwordx4 v4, s[44:47], s74 offen lds
  s_add_u32 m0, s75, 148480
  s_nop 0
  buffer_load_dwordx4 v5, s[44:47], s74 offen lds
  s_add_u32 s74, s74, 106496
  s_add_u32 m0, s75, 155648
  s_nop 0
  buffer_load_dwordx4 v4, s[44:47], s74 offen lds
  s_add_u32 m0, s75, 156672
  s_nop 0
  buffer_load_dwordx4 v5, s[44:47], s74 offen lds
  s_add_u32 s74, s74, 106496
  s_add_u32 m0, s76, 81920
  s_nop 0
  buffer_load_dwordx4 v56, s[32:35], 0 offen lds
  s_add_u32 m0, s76, 83968
  v_add_u32_dpp v56, v17, v2 row_newbcast:2 row_mask:0xf bank_mask:0x3
  buffer_load_dwordx4 v57, s[32:35], 0 offen lds
  s_nop 0
  v_add_u32_dpp v56, v19, v2 row_newbcast:8 row_mask:0xf bank_mask:0xc
  s_add_u32 m0, s76, 86016
  v_add_u32_dpp v57, v21, v2 row_newbcast:2 row_mask:0xf bank_mask:0x3
  buffer_load_dwordx4 v58, s[32:35], 0 offen lds
  s_nop 0
  v_add_u32_dpp v57, v23, v2 row_newbcast:8 row_mask:0xf bank_mask:0xc
  s_add_u32 m0, s76, 88064
  v_add_u32_dpp v58, v25, v2 row_newbcast:2 row_mask:0xf bank_mask:0x3
  buffer_load_dwordx4 v59, s[32:35], 0 offen lds
  s_nop 0
  v_add_u32_dpp v58, v27, v2 row_newbcast:8 row_mask:0xf bank_mask:0xc
  s_add_u32 m0, s76, 90112
  v_add_u32_dpp v59, v29, v2 row_newbcast:2 row_mask:0xf bank_mask:0x3
  buffer_load_dwordx4 v60, s[32:35], 0 offen lds
  s_nop 0
  v_add_u32_dpp v59, v31, v2 row_newbcast:8 row_mask:0xf bank_mask:0xc
  s_add_u32 m0, s76, 92160
  v_add_u32_dpp v60, v33, v2 row_newbcast:2 row_mask:0xf bank_mask:0x3
  buffer_load_dwordx4 v61, s[32:35], 0 offen lds
  s_nop 0
  v_add_u32_dpp v60, v35, v2 row_newbcast:8 row_mask:0xf bank_mask:0xc
  s_add_u32 m0, s76, 94208
  v_add_u32_dpp v61, v37, v2 row_newbcast:2 row_mask:0xf bank_mask:0x3
  buffer_load_dwordx4 v62, s[32:35], 0 offen lds
  s_nop 0
  v_add_u32_dpp v61, v39, v2 row_newbcast:8 row_mask:0xf bank_mask:0xc
  s_add_u32 m0, s76, 96256
  v_add_u32_dpp v62, v41, v2 row_newbcast:2 row_mask:0xf bank_mask:0x3
  buffer_load_dwordx4 v63, s[32:35], 0 offen lds
  s_nop 0
  v_add_u32_dpp v62, v43, v2 row_newbcast:8 row_mask:0xf bank_mask:0xc
  s_add_u32 m0, s76, 98304
  v_add_u32_dpp v63, v45, v2 row_newbcast:2 row_mask:0xf bank_mask:0x3
  buffer_load_dwordx4 v64, s[32:35], 0 offen lds
  s_nop 0
  v_add_u32_dpp v63, v47, v2 row_newbcast:8 row_mask:0xf bank_mask:0xc
  s_add_u32 m0, s76, 100352
  v_add_u32_dpp v64, v49, v2 row_newbcast:2 row_mask:0xf bank_mask:0x3
  buffer_load_dwordx4 v65, s[32:35], 0 offen lds
  s_nop 0
  v_add_u32_dpp v64, v51, v2 row_newbcast:8 row_mask:0xf bank_mask:0xc
  v_add_u32_dpp v65, v53, v2 row_newbcast:2 row_mask:0xf bank_mask:0x3
  s_nop 1
  v_add_u32_dpp v65, v55, v2 row_newbcast:8 row_mask:0xf bank_mask:0xc
  s_waitcnt vmcnt(10)
  s_barrier
  s_add_u32 m0, s75, 131072
  s_nop 0
  buffer_load_dwordx4 v4, s[44:47], s74 offen lds
  s_add_u32 m0, s75, 132096
  s_nop 0
  buffer_load_dwordx4 v5, s[44:47], s74 offen lds
  s_add_u32 s74, s74, 106496
  s_add_u32 m0, s75, 139264
  s_nop 0
  buffer_load_dwordx4 v4, s[44:47], s74 offen lds
  s_add_u32 m0, s75, 140288
  s_nop 0
  buffer_load_dwordx4 v5, s[44:47], s74 offen lds
  s_add_u32 s74, s74, 106496
  s_add_u32 m0, s76, 0
  s_nop 0
  buffer_load_dwordx4 v56, s[32:35], 0 offen lds
  s_add_u32 m0, s76, 2048
  v_add_u32_dpp v56, v18, v2 row_newbcast:2 row_mask:0xf bank_mask:0x3
  buffer_load_dwordx4 v57, s[32:35], 0 offen lds
  s_nop 0
  v_add_u32_dpp v56, v16, v2 row_newbcast:9 row_mask:0xf bank_mask:0xc
  s_add_u32 m0, s76, 4096
  v_add_u32_dpp v57, v22, v2 row_newbcast:2 row_mask:0xf bank_mask:0x3
  buffer_load_dwordx4 v58, s[32:35], 0 offen lds
  s_nop 0
  v_add_u32_dpp v57, v20, v2 row_newbcast:9 row_mask:0xf bank_mask:0xc
  s_add_u32 m0, s76, 6144
  v_add_u32_dpp v58, v26, v2 row_newbcast:2 row_mask:0xf bank_mask:0x3
  buffer_load_dwordx4 v59, s[32:35], 0 offen lds
  s_nop 0
  v_add_u32_dpp v58, v24, v2 row_newbcast:9 row_mask:0xf bank_mask:0xc
  s_add_u32 m0, s76, 8192
  v_add_u32_dpp v59, v30, v2 row_newbcast:2 row_mask:0xf bank_mask:0x3
  buffer_load_dwordx4 v60, s[32:35], 0 offen lds
  s_nop 0
  v_add_u32_dpp v59, v28, v2 row_newbcast:9 row_mask:0xf bank_mask:0xc
  s_add_u32 m0, s76, 10240
  v_add_u32_dpp v60, v34, v2 row_newbcast:2 row_mask:0xf bank_mask:0x3
  buffer_load_dwordx4 v61, s[32:35], 0 offen lds
  s_nop 0
  v_add_u32_dpp v60, v32, v2 row_newbcast:9 row_mask:0xf bank_mask:0xc
  s_add_u32 m0, s76, 12288
  v_add_u32_dpp v61, v38, v2 row_newbcast:2 row_mask:0xf bank_mask:0x3
  buffer_load_dwordx4 v62, s[32:35], 0 offen lds
  s_nop 0
  v_add_u32_dpp v61, v36, v2 row_newbcast:9 row_mask:0xf bank_mask:0xc
  s_add_u32 m0, s76, 14336
  v_add_u32_dpp v62, v42, v2 row_newbcast:2 row_mask:0xf bank_mask:0x3
  buffer_load_dwordx4 v63, s[32:35], 0 offen lds
  s_nop 0
  v_add_u32_dpp v62, v40, v2 row_newbcast:9 row_mask:0xf bank_mask:0xc
  s_add_u32 m0, s76, 16384
  v_add_u32_dpp v63, v46, v2 row_newbcast:2 row_mask:0xf bank_mask:0x3
  buffer_load_dwordx4 v64, s[32:35], 0 offen lds
  s_nop 0
  v_add_u32_dpp v63, v44, v2 row_newbcast:9 row_mask:0xf bank_mask:0xc
  s_add_u32 m0, s76, 18432
  v_add_u32_dpp v64, v50, v2 row_newbcast:2 row_mask:0xf bank_mask:0x3
  buffer_load_dwordx4 v65, s[32:35], 0 offen lds
  s_nop 0
  v_add_u32_dpp v64, v48, v2 row_newbcast:9 row_mask:0xf bank_mask:0xc
  v_add_u32_dpp v65, v54, v2 row_newbcast:2 row_mask:0xf bank_mask:0x3
  s_nop 1
  v_add_u32_dpp v65, v52, v2 row_newbcast:9 row_mask:0xf bank_mask:0xc
  v_lshlrev_b32 v101, 7, v70
  s_mov_b32 exec_lo, 0xffffffff
  s_mov_b32 exec_hi, 0x0
  buffer_load_dword v102, v101, s[32:35], 0 offen
  s_mov_b64 exec, -1
  v_mov_b32 v70, v71
  v_mov_b32 v71, v72
  v_mov_b32 v72, v73
  v_mov_b32 v73, v74
  v_mov_b32 v74, 0xffffff
  s_waitcnt vmcnt(11)
  s_barrier
  s_add_u32 m0, s75, 147456
  s_nop 0
  buffer_load_dwordx4 v4, s[44:47], s74 offen lds
  s_add_u32 m0, s75, 148480
  s_nop 0
  buffer_load_dwordx4 v5, s[44:47], s74 offen lds
  s_add_u32 s74, s74, 106496
  s_add_u32 m0, s75, 155648
  s_nop 0
  buffer_load_dwordx4 v4, s[44:47], s74 offen lds
  s_add_u32 m0, s75, 156672
  s_nop 0
  buffer_load_dwordx4 v5, s[44:47], s74 offen lds
  s_add_u32 s74, s74, 106496
  s_add_u32 m0, s76, 40960
  s_nop 0
  buffer_load_dwordx4 v56, s[32:35], 0 offen lds
  s_add_u32 m0, s76, 43008
  v_add_u32_dpp v56, v19, v2 row_newbcast:2 row_mask:0xf bank_mask:0x3
  buffer_load_dwordx4 v57, s[32:35], 0 offen lds
  s_nop 0
  v_add_u32_dpp v56, v17, v2 row_newbcast:9 row_mask:0xf bank_mask:0xc
  s_add_u32 m0, s76, 45056
  v_add_u32_dpp v57, v23, v2 row_newbcast:2 row_mask:0xf bank_mask:0x3
  buffer_load_dwordx4 v58, s[32:35], 0 offen lds
  s_nop 0
  v_add_u32_dpp v57, v21, v2 row_newbcast:9 row_mask:0xf bank_mask:0xc
  s_add_u32 m0, s76, 47104
  v_add_u32_dpp v58, v27, v2 row_newbcast:2 row_mask:0xf bank_mask:0x3
  buffer_load_dwordx4 v59, s[32:35], 0 offen lds
  s_nop 0
  v_add_u32_dpp v58, v25, v2 row_newbcast:9 row_mask:0xf bank_mask:0xc
  s_add_u32 m0, s76, 49152
  v_add_u32_dpp v59, v31, v2 row_newbcast:2 row_mask:0xf bank_mask:0x3
  buffer_load_dwordx4 v60, s[32:35], 0 offen lds
  s_nop 0
  v_add_u32_dpp v59, v29, v2 row_newbcast:9 row_mask:0xf bank_mask:0xc
  s_add_u32 m0, s76, 51200
  v_add_u32_dpp v60, v35, v2 row_newbcast:2 row_mask:0xf bank_mask:0x3
  buffer_load_dwordx4 v61, s[32:35], 0 offen lds
  s_nop 0
  v_add_u32_dpp v60, v33, v2 row_newbcast:9 row_mask:0xf bank_mask:0xc
  s_add_u32 m0, s76, 53248
  v_add_u32_dpp v61, v39, v2 row_newbcast:2 row_mask:0xf bank_mask:0x3
  buffer_load_dwordx4 v62, s[32:35], 0 offen lds
  s_nop 0
  v_add_u32_dpp v61, v37, v2 row_newbcast:9 row_mask:0xf bank_mask:0xc
  s_add_u32 m0, s76, 55296
  v_add_u32_dpp v62, v43, v2 row_newbcast:2 row_mask:0xf bank_mask:0x3
  buffer_load_dwordx4 v63, s[32:35], 0 offen lds
  s_nop 0
  v_add_u32_dpp v62, v41, v2 row_newbcast:9 row_mask:0xf bank_mask:0xc
  s_add_u32 m0, s76, 57344
  v_add_u32_dpp v63, v47, v2 row_newbcast:2 row_mask:0xf bank_mask:0x3
  buffer_load_dwordx4 v64, s[32:35], 0 offen lds
  s_nop 0
  v_add_u32_dpp v63, v45, v2 row_newbcast:9 row_mask:0xf bank_mask:0xc
  s_add_u32 m0, s76, 59392
  v_add_u32_dpp v64, v51, v2 row_newbcast:2 row_mask:0xf bank_mask:0x3
  buffer_load_dwordx4 v65, s[32:35], 0 offen lds
  s_nop 0
  v_add_u32_dpp v64, v49, v2 row_newbcast:9 row_mask:0xf bank_mask:0xc
  v_add_u32_dpp v65, v55, v2 row_newbcast:2 row_mask:0xf bank_mask:0x3
  s_nop 1
  v_add_u32_dpp v65, v53, v2 row_newbcast:9 row_mask:0xf bank_mask:0xc
  s_waitcnt vmcnt(10)
  s_cmp_lg_u32 s72, 1
  s_cbranch_scc1 L_nolpf
  s_mov_b64 exec, 1048575
  global_load_dword v10, v[8:9], off
  s_mov_b64 exec, -1
  s_mov_b32 m0, 123136
  s_mov_b64 exec, 0xffff
  buffer_load_dwordx4 v11, s[52:55], s77 offen lds
  s_mov_b64 exec, -1
L_nolpf:
  s_barrier
  s_add_u32 m0, s75, 131072
  s_nop 0
  buffer_load_dwordx4 v4, s[44:47], s74 offen lds
  s_add_u32 m0, s75, 132096
  s_nop 0
  buffer_load_dwordx4 v5, s[44:47], s74 offen lds
  s_add_u32 s74, s74, 106496
  s_add_u32 m0, s75, 139264
  s_nop 0
  buffer_load_dwordx4 v4, s[44:47], s74 offen lds
  s_add_u32 m0, s75, 140288
  s_nop 0
  buffer_load_dwordx4 v5, s[44:47], s74 offen lds
  s_add_u32 s74, s74, 106496
  s_add_u32 m0, s76, 81920
  s_nop 0
  buffer_load_dwordx4 v56, s[32:35], 0 offen lds
  s_add_u32 m0, s76, 83968
  v_add_u32_dpp v56, v16, v2 row_newbcast:3 row_mask:0xf bank_mask:0x3
  buffer_load_dwordx4 v57, s[32:35], 0 offen lds
  s_nop 0
  v_add_u32_dpp v56, v18, v2 row_newbcast:9 row_mask:0xf bank_mask:0xc
  s_add_u32 m0, s76, 86016
  v_add_u32_dpp v57, v20, v2 row_newbcast:3 row_mask:0xf bank_mask:0x3
  buffer_load_dwordx4 v58, s[32:35], 0 offen lds
  s_nop 0
  v_add_u32_dpp v57, v22, v2 row_newbcast:9 row_mask:0xf bank_mask:0xc
  s_add_u32 m0, s76, 88064
  v_add_u32_dpp v58, v24, v2 row_newbcast:3 row_mask:0xf bank_mask:0x3
  buffer_load_dwordx4 v59, s[32:35], 0 offen lds
  s_nop 0
  v_add_u32_dpp v58, v26, v2 row_newbcast:9 row_mask:0xf bank_mask:0xc
  s_add_u32 m0, s76, 90112
  v_add_u32_dpp v59, v28, v2 row_newbcast:3 row_mask:0xf bank_mask:0x3
  buffer_load_dwordx4 v60, s[32:35], 0 offen lds
  s_nop 0
  v_add_u32_dpp v59, v30, v2 row_newbcast:9 row_mask:0xf bank_mask:0xc
  s_add_u32 m0, s76, 92160
  v_add_u32_dpp v60, v32, v2 row_newbcast:3 row_mask:0xf bank_mask:0x3
  buffer_load_dwordx4 v61, s[32:35], 0 offen lds
  s_nop 0
  v_add_u32_dpp v60, v34, v2 row_newbcast:9 row_mask:0xf bank_mask:0xc
  s_add_u32 m0, s76, 94208
  v_add_u32_dpp v61, v36, v2 row_newbcast:3 row_mask:0xf bank_mask:0x3
  buffer_load_dwordx4 v62, s[32:35], 0 offen lds
  s_nop 0
  v_add_u32_dpp v61, v38, v2 row_newbcast:9 row_mask:0xf bank_mask:0xc
  s_add_u32 m0, s76, 96256
  v_add_u32_dpp v62, v40, v2 row_newbcast:3 row_mask:0xf bank_mask:0x3
  buffer_load_dwordx4 v63, s[32:35], 0 offen lds
  s_nop 0
  v_add_u32_dpp v62, v42, v2 row_newbcast:9 row_mask:0xf bank_mask:0xc
  s_add_u32 m0, s76, 98304
  v_add_u32_dpp v63, v44, v2 row_newbcast:3 row_mask:0xf bank_mask:0x3
  buffer_load_dwordx4 v64, s[32:35], 0 offen lds
  s_nop 0
  v_add_u32_dpp v63, v46, v2 row_newbcast:9 row_mask:0xf bank_mask:0xc
  s_add_u32 m0, s76, 100352
  v_add_u32_dpp v64, v48, v2 row_newbcast:3 row_mask:0xf bank_mask:0x3
  buffer_load_dwordx4 v65, s[32:35], 0 offen lds
  s_nop 0
  v_add_u32_dpp v64, v50, v2 row_newbcast:9 row_mask:0xf bank_mask:0xc
  v_add_u32_dpp v65, v52, v2 row_newbcast:3 row_mask:0xf bank_mask:0x3
  s_nop 1
  v_add_u32_dpp v65, v54, v2 row_newbcast:9 row_mask:0xf bank_mask:0xc
  s_mov_b64 exec, 0x3ff
  buffer_load_dword v103, v84, s[44:47], s85 offen
  s_mov_b64 exec, -1
  s_add_u32 s85, s85, 865280
  s_waitcnt vmcnt(11)
  s_barrier
  s_add_u32 m0, s75, 147456
  s_nop 0
  buffer_load_dwordx4 v4, s[44:47], s74 offen lds
  s_add_u32 m0, s75, 148480
  s_nop 0
  buffer_load_dwordx4 v5, s[44:47], s74 offen lds
  s_add_u32 s74, s74, 106496
  s_add_u32 m0, s75, 155648
  s_nop 0
  buffer_load_dwordx4 v4, s[44:47], s74 offen lds
  s_add_u32 m0, s75, 156672
  s_nop 0
  buffer_load_dwordx4 v5, s[44:47], s74 offen lds
  s_add_u32 s74, s74, 106496
  s_add_u32 m0, s76, 0
  s_nop 0
  buffer_load_dwordx4 v56, s[32:35], 0 offen lds
  s_add_u32 m0, s76, 2048
  v_add_u32_dpp v56, v17, v2 row_newbcast:3 row_mask:0xf bank_mask:0x3
  buffer_load_dwordx4 v57, s[32:35], 0 offen lds
  s_nop 0
  v_add_u32_dpp v56, v19, v2 row_newbcast:9 row_mask:0xf bank_mask:0xc
  s_add_u32 m0, s76, 4096
  v_add_u32_dpp v57, v21, v2 row_newbcast:3 row_mask:0xf bank_mask:0x3
  buffer_load_dwordx4 v58, s[32:35], 0 offen lds
  s_nop 0
  v_add_u32_dpp v57, v23, v2 row_newbcast:9 row_mask:0xf bank_mask:0xc
  s_add_u32 m0, s76, 6144
  v_add_u32_dpp v58, v25, v2 row_newbcast:3 row_mask:0xf bank_mask:0x3
  buffer_load_dwordx4 v59, s[32:35], 0 offen lds
  s_nop 0
  v_add_u32_dpp v58, v27, v2 row_newbcast:9 row_mask:0xf bank_mask:0xc
  s_add_u32 m0, s76, 8192
  v_add_u32_dpp v59, v29, v2 row_newbcast:3 row_mask:0xf bank_mask:0x3
  buffer_load_dwordx4 v60, s[32:35], 0 offen lds
  s_nop 0
  v_add_u32_dpp v59, v31, v2 row_newbcast:9 row_mask:0xf bank_mask:0xc
  s_add_u32 m0, s76, 10240
  v_add_u32_dpp v60, v33, v2 row_newbcast:3 row_mask:0xf bank_mask:0x3
  buffer_load_dwordx4 v61, s[32:35], 0 offen lds
  s_nop 0
  v_add_u32_dpp v60, v35, v2 row_newbcast:9 row_mask:0xf bank_mask:0xc
  s_add_u32 m0, s76, 12288
  v_add_u32_dpp v61, v37, v2 row_newbcast:3 row_mask:0xf bank_mask:0x3
  buffer_load_dwordx4 v62, s[32:35], 0 offen lds
  s_nop 0
  v_add_u32_dpp v61, v39, v2 row_newbcast:9 row_mask:0xf bank_mask:0xc
  s_add_u32 m0, s76, 14336
  v_add_u32_dpp v62, v41, v2 row_newbcast:3 row_mask:0xf bank_mask:0x3
  buffer_load_dwordx4 v63, s[32:35], 0 offen lds
  s_nop 0
  v_add_u32_dpp v62, v43, v2 row_newbcast:9 row_mask:0xf bank_mask:0xc
  s_add_u32 m0, s76, 16384
  v_add_u32_dpp v63, v45, v2 row_newbcast:3 row_mask:0xf bank_mask:0x3
  buffer_load_dwordx4 v64, s[32:35], 0 offen lds
  s_nop 0
  v_add_u32_dpp v63, v47, v2 row_newbcast:9 row_mask:0xf bank_mask:0xc
  s_add_u32 m0, s76, 18432
  v_add_u32_dpp v64, v49, v2 row_newbcast:3 row_mask:0xf bank_mask:0x3
  buffer_load_dwordx4 v65, s[32:35], 0 offen lds
  s_nop 0
  v_add_u32_dpp v64, v51, v2 row_newbcast:9 row_mask:0xf bank_mask:0xc
  v_add_u32_dpp v65, v53, v2 row_newbcast:3 row_mask:0xf bank_mask:0x3
  s_nop 1
  v_add_u32_dpp v65, v55, v2 row_newbcast:9 row_mask:0xf bank_mask:0xc
  s_waitcnt vmcnt(10)
  s_barrier
  s_add_u32 m0, s75, 131072
  s_nop 0
  buffer_load_dwordx4 v4, s[44:47], s74 offen lds
  s_add_u32 m0, s75, 132096
  s_nop 0
  buffer_load_dwordx4 v5, s[44:47], s74 offen lds
  s_add_u32 s74, s74, 106496
  s_add_u32 m0, s75, 139264
  s_nop 0
  buffer_load_dwordx4 v4, s[44:47], s74 offen lds
  s_add_u32 m0, s75, 140288
  s_nop 0
  buffer_load_dwordx4 v5, s[44:47], s74 offen lds
  s_add_u32 s74, s74, 106496
  s_add_u32 m0, s76, 40960
  s_nop 0
  buffer_load_dwordx4 v56, s[32:35], 0 offen lds
  s_add_u32 m0, s76, 43008
  v_add_u32_dpp v56, v18, v2 row_newbcast:3 row_mask:0xf bank_mask:0x3
  buffer_load_dwordx4 v57, s[32:35], 0 offen lds
  s_nop 0
  v_add_u32_dpp v56, v16, v2 row_newbcast:10 row_mask:0xf bank_mask:0xc
  s_add_u32 m0, s76, 45056
  v_add_u32_dpp v57, v22, v2 row_newbcast:3 row_mask:0xf bank_mask:0x3
  buffer_load_dwordx4 v58, s[32:35], 0 offen lds
  s_nop 0
  v_add_u32_dpp v57, v20, v2 row_newbcast:10 row_mask:0xf bank_mask:0xc
  s_add_u32 m0, s76, 47104
  v_add_u32_dpp v58, v26, v2 row_newbcast:3 row_mask:0xf bank_mask:0x3
  buffer_load_dwordx4 v59, s[32:35], 0 offen lds
  s_nop 0
  v_add_u32_dpp v58, v24, v2 row_newbcast:10 row_mask:0xf bank_mask:0xc
  s_add_u32 m0, s76, 49152
  v_add_u32_dpp v59, v30, v2 row_newbcast:3 row_mask:0xf bank_mask:0x3
  buffer_load_dwordx4 v60, s[32:35], 0 offen lds
  s_nop 0
  v_add_u32_dpp v59, v28, v2 row_newbcast:10 row_mask:0xf bank_mask:0xc
  s_add_u32 m0, s76, 51200
  v_add_u32_dpp v60, v34, v2 row_newbcast:3 row_mask:0xf bank_mask:0x3
  buffer_load_dwordx4 v61, s[32:35], 0 offen lds
  s_nop 0
  v_add_u32_dpp v60, v32, v2 row_newbcast:10 row_mask:0xf bank_mask:0xc
  s_add_u32 m0, s76, 53248
  v_add_u32_dpp v61, v38, v2 row_newbcast:3 row_mask:0xf bank_mask:0x3
  buffer_load_dwordx4 v62, s[32:35], 0 offen lds
  s_nop 0
  v_add_u32_dpp v61, v36, v2 row_newbcast:10 row_mask:0xf bank_mask:0xc
  s_add_u32 m0, s76, 55296
  v_add_u32_dpp v62, v42, v2 row_newbcast:3 row_mask:0xf bank_mask:0x3
  buffer_load_dwordx4 v63, s[32:35], 0 offen lds
  s_nop 0
  v_add_u32_dpp v62, v40, v2 row_newbcast:10 row_mask:0xf bank_mask:0xc
  s_add_u32 m0, s76, 57344
  v_add_u32_dpp v63, v46, v2 row_newbcast:3 row_mask:0xf bank_mask:0x3
  buffer_load_dwordx4 v64, s[32:35], 0 offen lds
  s_nop 0
  v_add_u32_dpp v63, v44, v2 row_newbcast:10 row_mask:0xf bank_mask:0xc
  s_add_u32 m0, s76, 59392
  v_add_u32_dpp v64, v50, v2 row_newbcast:3 row_mask:0xf bank_mask:0x3
  buffer_load_dwordx4 v65, s[32:35], 0 offen lds
  s_nop 0
  v_add_u32_dpp v64, v48, v2 row_newbcast:10 row_mask:0xf bank_mask:0xc
  v_add_u32_dpp v65, v54, v2 row_newbcast:3 row_mask:0xf bank_mask:0x3
  s_nop 1
  v_add_u32_dpp v65, v52, v2 row_newbcast:10 row_mask:0xf bank_mask:0xc
  v_mov_b32_dpp v16, v16 row_shl:3 row_mask:0xf bank_mask:0xf
  v_mov_b32_dpp v18, v18 row_shl:3 row_mask:0xf bank_mask:0xf
  v_mov_b32_dpp v20, v20 row_shl:3 row_mask:0xf bank_mask:0xf
  v_mov_b32_dpp v22, v22 row_shl:3 row_mask:0xf bank_mask:0xf
  v_mov_b32_dpp v24, v24 row_shl:3 row_mask:0xf bank_mask:0xf
  v_mov_b32_dpp v26, v26 row_shl:3 row_mask:0xf bank_mask:0xf
  v_mov_b32_dpp v28, v28 row_shl:3 row_mask:0xf bank_mask:0xf
  v_mov_b32_dpp v30, v30 row_shl:3 row_mask:0xf bank_mask:0xf
  v_mov_b32_dpp v32, v32 row_shl:3 row_mask:0xf bank_mask:0xf
  v_mov_b32_dpp v34, v34 row_shl:3 row_mask:0xf bank_mask:0xf
  v_mov_b32_dpp v36, v36 row_shl:3 row_mask:0xf bank_mask:0xf
  v_mov_b32_dpp v38, v38 row_shl:3 row_mask:0xf bank_mask:0xf
  v_mov_b32_dpp v40, v40 row_shl:3 row_mask:0xf bank_mask:0xf
  v_mov_b32_dpp v42, v42 row_shl:3 row_mask:0xf bank_mask:0xf
  v_mov_b32_dpp v44, v44 row_shl:3 row_mask:0xf bank_mask:0xf
  v_mov_b32_dpp v46, v46 row_shl:3 row_mask:0xf bank_mask:0xf
  v_mov_b32_dpp v48, v48 row_shl:3 row_mask:0xf bank_mask:0xf
  v_mov_b32_dpp v50, v50 row_shl:3 row_mask:0xf bank_mask:0xf
  v_mov_b32_dpp v52, v52 row_shl:3 row_mask:0xf bank_mask:0xf
  v_mov_b32_dpp v54, v54 row_shl:3 row_mask:0xf bank_mask:0xf
  v_lshlrev_b32 v101, 7, v70
  s_mov_b32 exec_lo, 0xffffffff
  s_mov_b32 exec_hi, 0x0
  buffer_load_dword v102, v101, s[32:35], 0 offen
  s_mov_b64 exec, -1
  v_mov_b32 v70, v71
  v_mov_b32 v71, v72
  v_mov_b32 v72, v73
  v_mov_b32 v73, v74
  v_mov_b32 v74, 0xffffff
  s_waitcnt vmcnt(11)
  s_barrier
  s_add_u32 m0, s75, 147456
  s_nop 0
  buffer_load_dwordx4 v4, s[44:47], s74 offen lds
  s_add_u32 m0, s75, 148480
  s_nop 0
  buffer_load_dwordx4 v5, s[44:47], s74 offen lds
  s_add_u32 s74, s74, 106496
  s_add_u32 m0, s75, 155648
  s_nop 0
  buffer_load_dwordx4 v4, s[44:47], s74 offen lds
  s_add_u32 m0, s75, 156672
  s_nop 0
  buffer_load_dwordx4 v5, s[44:47], s74 offen lds
  s_add_u32 s74, s74, 106496
  s_cmp_eq_u32 s72, 1
  s_cbranch_scc1 L_ld_tail0
  s_add_u32 m0, s76, 81920
  s_nop 0
  buffer_load_dwordx4 v56, s[32:35], 0 offen lds
  s_add_u32 m0, s76, 83968
  v_add_u32_dpp v56, v19, v2 row_newbcast:3 row_mask:0xf bank_mask:0x3
  buffer_load_dwordx4 v57, s[32:35], 0 offen lds
  s_nop 0
  v_add_u32_dpp v56, v17, v2 row_newbcast:10 row_mask:0xf bank_mask:0xc
  s_add_u32 m0, s76, 86016
  v_add_u32_dpp v57, v23, v2 row_newbcast:3 row_mask:0xf bank_mask:0x3
  buffer_load_dwordx4 v58, s[32:35], 0 offen lds
  s_nop 0
  v_add_u32_dpp v57, v21, v2 row_newbcast:10 row_mask:0xf bank_mask:0xc
  s_add_u32 m0, s76, 88064
  v_add_u32_dpp v58, v27, v2 row_newbcast:3 row_mask:0xf bank_mask:0x3
  buffer_load_dwordx4 v59, s[32:35], 0 offen lds
  s_nop 0
  v_add_u32_dpp v58, v25, v2 row_newbcast:10 row_mask:0xf bank_mask:0xc
  s_add_u32 m0, s76, 90112
  v_add_u32_dpp v59, v31, v2 row_newbcast:3 row_mask:0xf bank_mask:0x3
  buffer_load_dwordx4 v60, s[32:35], 0 offen lds
  s_nop 0
  v_add_u32_dpp v59, v29, v2 row_newbcast:10 row_mask:0xf bank_mask:0xc
  s_add_u32 m0, s76, 92160
  v_add_u32_dpp v60, v35, v2 row_newbcast:3 row_mask:0xf bank_mask:0x3
  buffer_load_dwordx4 v61, s[32:35], 0 offen lds
  s_nop 0
  v_add_u32_dpp v60, v33, v2 row_newbcast:10 row_mask:0xf bank_mask:0xc
  s_add_u32 m0, s76, 94208
  v_add_u32_dpp v61, v39, v2 row_newbcast:3 row_mask:0xf bank_mask:0x3
  buffer_load_dwordx4 v62, s[32:35], 0 offen lds
  s_nop 0
  v_add_u32_dpp v61, v37, v2 row_newbcast:10 row_mask:0xf bank_mask:0xc
  s_add_u32 m0, s76, 96256
  v_add_u32_dpp v62, v43, v2 row_newbcast:3 row_mask:0xf bank_mask:0x3
  buffer_load_dwordx4 v63, s[32:35], 0 offen lds
  s_nop 0
  v_add_u32_dpp v62, v41, v2 row_newbcast:10 row_mask:0xf bank_mask:0xc
  s_add_u32 m0, s76, 98304
  v_add_u32_dpp v63, v47, v2 row_newbcast:3 row_mask:0xf bank_mask:0x3
  buffer_load_dwordx4 v64, s[32:35], 0 offen lds
  s_nop 0
  v_add_u32_dpp v63, v45, v2 row_newbcast:10 row_mask:0xf bank_mask:0xc
  s_add_u32 m0, s76, 100352
  v_add_u32_dpp v64, v51, v2 row_newbcast:3 row_mask:0xf bank_mask:0x3
  buffer_load_dwordx4 v65, s[32:35], 0 offen lds
  s_nop 0
  v_add_u32_dpp v64, v49, v2 row_newbcast:10 row_mask:0xf bank_mask:0xc
  v_add_u32_dpp v65, v55, v2 row_newbcast:3 row_mask:0xf bank_mask:0x3
  s_nop 1
  v_add_u32_dpp v65, v53, v2 row_newbcast:10 row_mask:0xf bank_mask:0xc
  v_mov_b32_dpp v17, v17 row_shl:3 row_mask:0xf bank_mask:0xf
  v_mov_b32_dpp v19, v19 row_shl:3 row_mask:0xf bank_mask:0xf
  v_mov_b32_dpp v21, v21 row_shl:3 row_mask:0xf bank_mask:0xf
  v_mov_b32_dpp v23, v23 row_shl:3 row_mask:0xf bank_mask:0xf
  v_mov_b32_dpp v25, v25 row_shl:3 row_mask:0xf bank_mask:0xf
  v_mov_b32_dpp v27, v27 row_shl:3 row_mask:0xf bank_mask:0xf
  v_mov_b32_dpp v29, v29 row_shl:3 row_mask:0xf bank_mask:0xf
  v_mov_b32_dpp v31, v31 row_shl:3 row_mask:0xf bank_mask:0xf
  v_mov_b32_dpp v33, v33 row_shl:3 row_mask:0xf bank_mask:0xf
  v_mov_b32_dpp v35, v35 row_shl:3 row_mask:0xf bank_mask:0xf
  v_mov_b32_dpp v37, v37 row_shl:3 row_mask:0xf bank_mask:0xf
  v_mov_b32_dpp v39, v39 row_shl:3 row_mask:0xf bank_mask:0xf
  v_mov_b32_dpp v41, v41 row_shl:3 row_mask:0xf bank_mask:0xf
  v_mov_b32_dpp v43, v43 row_shl:3 row_mask:0xf bank_mask:0xf
  v_mov_b32_dpp v45, v45 row_shl:3 row_mask:0xf bank_mask:0xf
  v_mov_b32_dpp v47, v47 row_shl:3 row_mask:0xf bank_mask:0xf
  v_mov_b32_dpp v49, v49 row_shl:3 row_mask:0xf bank_mask:0xf
  v_mov_b32_dpp v51, v51 row_shl:3 row_mask:0xf bank_mask:0xf
  v_mov_b32_dpp v53, v53 row_shl:3 row_mask:0xf bank_mask:0xf
  v_mov_b32_dpp v55, v55 row_shl:3 row_mask:0xf bank_mask:0xf
  s_add_u32 s72, s72, 1
  s_cmp_lt_u32 s72, 2
  s_waitcnt vmcnt(10)
  s_cbranch_scc1 L_dnn_loop1
  s_branch L_ld_tail
L_cin:
  v_lshlrev_b32 v1, 4, v0
  s_and_b32 s79, s3, 3
  s_lshr_b32 s84, s3, 2
  s_lshl_b32 s95, s79, 10
  s_mul_i32 s26, s68, 11
  s_add_u32 s26, s26, s69
  s_sub_u32 s26, s26, 22
  s_cmp_eq_u32 s26, 86
  s_cbranch_scc1 L_end
  s_cmp_eq_u32 s84, 0
  s_cbranch_scc1 L_sc
  s_setprio 2
  v_add_u32 v2, L_tables-L_pc+4096, v1
  v_mov_b32 v3, s93
  v_add_co_u32 v2, vcc, s92, v2
  s_nop 1
  v_addc_co_u32 v3, vcc, 0, v3, vcc
  v_add_co_u32 v32, vcc, s95, v2
  s_nop 1
  v_addc_co_u32 v33, vcc, 0, v3, vcc
  global_load_dwordx4 v[224:227], v[2:3], off offset:-4096
  v_add_co_u32 v2, vcc, 0x1800, v2
  s_nop 1
  v_addc_co_u32 v3, vcc, 0, v3, vcc
  global_load_dwordx4 v[240:243], v[2:3], off
  s_cmp_lt_u32 s79, 3
  s_mov_b32 s70, 122176
  s_cselect_b32 s70, 81920, s70
  s_add_u32 m0, s95, 81920
  s_nop 0
  global_load_lds_dwordx4 v[32:33], off offset:-4096
  s_add_u32 m0, s95, s70
  s_nop 0
  global_load_lds_dwordx4 v[32:33], off offset:0
  v_add_co_u32 v32, vcc, 0x2000, v32
  s_nop 1
  v_addc_co_u32 v33, vcc, 0, v33, vcc
  s_add_u32 m0, s95, 2048
  s_nop 0
  global_load_lds_dwordx4 v[32:33], off offset:0
  s_add_u32 m0, s95, 130368
  s_cmp_ge_u32 s79, 2
  s_cbranch_scc1 L_sc
  global_load_lds_dwordx4 v[32:33], off offset:-4096
L_sc:
  s_mul_i32 s85, s84, 20
  s_add_u32 s85, s85, s3
  s_mul_i32 s94, s26, 48
  s_add_u32 s94, s94, s85
  s_mul_i32 s94, s94, 104
  v_lshrrev_b32 v30, 3, v0
  v_lshlrev_b32 v30, 4, v30
  v_and_b32 v29, 0x70, v1
  s_mul_i32 s76, s3, 4064
  s_add_u32 s76, s76, 131136
  s_cmp_eq_u32 s84, 0
  s_cbranch_scc1 L_g0
  s_sub_u32 s68, s71, 22
  s_min_u32 s68, s68, 9
  s_lshl_b32 s68, s68, 2
  s_add_u32 s68, s68, s79
  s_lshl_b32 s68, s68, 7
  v_mul_u32_u24 v31, 5120, v0
  s_waitcnt lgkmcnt(0)
  s_mov_b32 s36, s8
  s_and_b32 s37, s9, 0xffff
  s_mov_b32 s38, 105456
  s_mov_b32 s39, 0x20000
  buffer_load_dword v107, v31, s[36:39], s68 offen
  s_waitcnt lgkmcnt(0)
  s_mov_b32 s40, s10
  s_and_b32 s41, s11, 0xffff
  s_mov_b32 s42, 156
  s_mov_b32 s43, 0x20000
  s_mov_b32 m0, 129472
  s_mov_b64 exec, 0x7ff
  buffer_load_dwordx4 v1, s[40:43], 0 offen lds
  s_mov_b64 exec, -1
  s_barrier
  s_lshl_b32 s85, s85, 2
  s_add_u32 s85, s85, 129728
  s_mul_i32 s72, s84, 3
  s_sub_u32 s72, 4, s72
  s_cmp_eq_u32 s26, 85
  s_cselect_b32 s72, s72, 6
  s_lshl_b32 s52, s3, 7
  s_mul_i32 s53, s3, 5280
  s_lshl_b32 s54, s3, 2
  s_lshl_b32 s55, s3, 1
  s_lshl_b32 s82, s3, 12
  s_and_b32 s98, s3, 1
  s_lshr_b32 s99, s3, 1
  s_mul_i32 s68, s99, 3072
  s_lshl_b32 s83, s98, 3
  s_add_u32 s68, s68, s83
  v_add_u32_e64 v59, s68, v1
  s_lshl_b32 s69, s99, 3
  s_lshr_b32 s69, 0x05030200, s69
  s_and_b32 s69, s69, 0xff
  s_lshl_b32 s69, s69, 9
  s_lshl_b32 s70, s98, 2
  s_add_u32 s91, s69, s70
  s_mov_b32 s99, 0x05040100
  s_mov_b32 s100, 0x07060302
  v_mov_b32 v2, 129664
  v_mov_b32 v109, 0
  v_mov_b32 v108, 0
  v_mov_b64 v[32:33], 0
  v_mov_b64 v[34:35], 0
  v_mov_b64 v[36:37], 0
  v_mov_b64 v[38:39], 0
  v_mov_b64 v[40:41], 0
  v_mov_b64 v[42:43], 0
  v_mov_b64 v[44:45], 0
  v_mov_b64 v[46:47], 0
  v_mov_b64 v[48:49], 0
  v_mov_b64 v[50:51], 0
  v_mov_b64 v[52:53], 0
  v_mov_b64 v[54:55], 0
  v_mov_b64 v[56:57], 0
  v_add_u32 v250, 77824, v1
  s_waitcnt vmcnt(7)
  v_add_u32 v251, 125248, v1
  v_lshrrev_b32 v3, 5, v0
  v_lshl_add_u32 v3, v3, 2, v2
  s_mov_b32 s28, s4
  s_and_b32 s29, s5, 0xffff
  s_mov_b32 s30, 425984
  s_mov_b32 s31, 0x20000
  s_mov_b32 s32, s6
  s_and_b32 s33, s7, 0xffff
  s_mov_b32 s34, 12800000
  s_mov_b32 s35, 0x20000
  v_and_b32 v13, 31, v0
  v_min_u32 v13, 25, v13
  v_lshrrev_b32 v14, 5, v0
  v_mul_u32_u24 v14, 416, v14
  v_lshl_add_u32 v13, v13, 2, v14
  buffer_load_dword v14, v13, s[28:31], s94 offen
  v_min_u32 v12, 47, v0
  v_mul_u32_u24 v15, 16384, v12
  v_lshrrev_b32_e64 v15, 16, v15
  v_mul_u32_u24 v15, 88, v15
  v_lshl_add_u32 v12, v12, 2, v15
  s_lshl_b32 s68, s26, 2
  s_add_u32 s68, s68, s79
  s_mul_i32 s68, s68, 1248
  buffer_load_dword v15, v12, s[28:31], s68 offen offset:16
  ds_write_b128 v2, v[32:35] offset:16
  s_lshl_b32 s68, s79, 6
  v_add_u32 v29, s68, v0
  v_mul_u32_u24 v30, 2521, v29
  v_lshrrev_b32 v30, 16, v30
  v_mul_u32_u24 v30, 12, v30
  v_lshl_add_u32 v28, v29, 1, v30
  v_add_u32 v29, 256, v29
  v_mul_u32_u24 v30, 2521, v29
  v_lshrrev_b32 v30, 16, v30
  v_mul_u32_u24 v30, 12, v30
  v_lshl_add_u32 v58, v29, 1, v30
  v_add_u32 v29, 256, v29
  v_mul_u32_u24 v30, 2521, v29
  v_lshrrev_b32 v30, 16, v30
  v_mul_u32_u24 v30, 12, v30
  v_lshl_add_u32 v111, v29, 1, v30
  v_cmp_gt_u32 vcc, 676, v29
  s_nop 0
  s_mov_b64 s[92:93], vcc
  v_lshlrev_b32_e64 v29, 3, v0
  s_mov_b32 exec_hi, 0xffff
  ds_write_b64 v29, v[32:33] offset:1664
  s_mov_b32 exec_hi, -1
  s_waitcnt vmcnt(7)
  ds_write_b32 v243, v32
  ds_write_b32 v243, v32 offset:43328
  s_waitcnt vmcnt(2)
  ds_read_b64 v[112:113], v240 offset:0
  ds_read_b64 v[114:115], v240 offset:8
  ds_read_b64 v[116:117], v240 offset:32
  ds_read_b64 v[118:119], v240 offset:40
  ds_read_u16 v110, v241
  s_mov_b64 exec, 0x3ffffff
  s_waitcnt lgkmcnt(0)
  ds_write_b16 v242, v110
  v_lshlrev_b32 v109, 17, v110
  v_lshrrev_b32 v109, 1, v109
  s_mov_b64 exec, -1
  v_add_u32 v225, s52, v225
  v_add_u32 v226, s52, v226
  v_add_u32 v227, s52, v227
  s_waitcnt lgkmcnt(0)
  s_barrier
  ds_read_b64_tr_b16 v[60:61], v225 offset:35328
  ds_read_b64_tr_b16 v[62:63], v225 offset:40736
  ds_read_b64_tr_b16 v[64:65], v226 offset:35328
  ds_read_b64_tr_b16 v[66:67], v227 offset:35328
  ds_read_b64_tr_b16 v[68:69], v225 offset:35392
  ds_read_b64_tr_b16 v[70:71], v225 offset:40800
  ds_read_b64_tr_b16 v[72:73], v226 offset:35392
  ds_read_b64_tr_b16 v[74:75], v227 offset:35392
  ds_read_b64_tr_b16 v[76:77], v225 offset:35840
  ds_read_b64_tr_b16 v[78:79], v225 offset:41248
  ds_read_b64_tr_b16 v[80:81], v226 offset:35840
  ds_read_b64_tr_b16 v[82:83], v227 offset:35840
  ds_read_b64_tr_b16 v[84:85], v225 offset:35904
  ds_read_b64_tr_b16 v[86:87], v225 offset:41312
  ds_read_b64_tr_b16 v[88:89], v226 offset:35904
  ds_read_b64_tr_b16 v[90:91], v227 offset:35904
  s_waitcnt lgkmcnt(14)
  v_mfma_f32_32x32x16_bf16 v[120:135], v[112:115], v[60:63], 0
  s_waitcnt lgkmcnt(12)
  v_mfma_f32_32x32x16_bf16 v[120:135], v[116:119], v[64:67], v[120:135]
  ds_read_b64_tr_b16 v[92:93], v225 offset:36352
  ds_read_b64_tr_b16 v[94:95], v225 offset:41760
  ds_read_b64_tr_b16 v[96:97], v226 offset:36352
  ds_read_b64_tr_b16 v[98:99], v227 offset:36352
  s_waitcnt lgkmcnt(14)
  v_mfma_f32_32x32x16_bf16 v[136:151], v[112:115], v[68:71], 0
  s_waitcnt lgkmcnt(12)
  v_mfma_f32_32x32x16_bf16 v[136:151], v[116:119], v[72:75], v[136:151]
  ds_read_b64_tr_b16 v[100:101], v225 offset:36416
  ds_read_b64_tr_b16 v[102:103], v225 offset:41824
  ds_read_b64_tr_b16 v[104:105], v226 offset:36416
  ds_read_b64_tr_b16 v[106:107], v227 offset:36416
  s_waitcnt lgkmcnt(14)
  v_mfma_f32_32x32x16_bf16 v[152:167], v[112:115], v[76:79], 0
  s_waitcnt lgkmcnt(12)
  v_mfma_f32_32x32x16_bf16 v[152:167], v[116:119], v[80:83], v[152:167]
  s_waitcnt lgkmcnt(10)
  v_mfma_f32_32x32x16_bf16 v[168:183], v[112:115], v[84:87], 0
  s_waitcnt lgkmcnt(8)
  v_mfma_f32_32x32x16_bf16 v[168:183], v[116:119], v[88:91], v[168:183]
  ds_read_b128 v[228:231], v250 offset:6144
  ds_read_b128 v[232:235], v251 offset:0
  ds_read_b128 v[4:7], v250 offset:3072
  ds_read_b128 v[8:11], v251 offset:2048
  ds_read_b128 v[20:23], v250 offset:1024
  ds_read_b128 v[24:27], v250 offset:2048
  ds_read_b128 v[216:219], v250 offset:4096
  ds_read_b128 v[220:223], v250 offset:5120
  ds_read_b128 v[236:239], v251 offset:1024
  s_waitcnt lgkmcnt(14)
  v_mfma_f32_32x32x16_bf16 v[184:199], v[112:115], v[92:95], 0
  s_waitcnt lgkmcnt(13)
  v_mfma_f32_32x32x16_bf16 v[184:199], v[116:119], v[96:99], v[184:199]
  s_waitcnt lgkmcnt(11)
  v_mfma_f32_32x32x16_bf16 v[200:215], v[112:115], v[100:103], 0
  s_waitcnt lgkmcnt(9)
  v_mfma_f32_32x32x16_bf16 v[200:215], v[116:119], v[104:107], v[200:215]
  s_waitcnt lgkmcnt(8)
  v_add_u32 v228, s54, v228
  v_add_u32 v229, s54, v229
  v_add_u32 v231, s83, v231
  v_add_u32 v230, s91, v230
  s_waitcnt lgkmcnt(7)
  v_mad_u32_u24 v232, v233, s3, v232
  v_add_u32 v234, s55, v234
  v_mad_u32_u24 v233, v233, 8, v232
  v_add_u32 v246, s82, v235
  v_add_u32 v247, 2048, v246
  v_add_u32 v31, 0, v234
  v_and_b32 v31, 3, v31
  v_lshl_add_u32 v244, v31, 4, v232
  v_add_u32 v31, 1, v234
  v_and_b32 v31, 3, v31
  v_lshl_add_u32 v245, v31, 4, v232
  v_add_u32 v245, 1664, v245
  v_add_u32 v31, 0, v234
  v_and_b32 v31, 3, v31
  v_lshl_add_u32 v248, v31, 4, v233
  v_add_u32 v31, 1, v234
  v_and_b32 v31, 3, v31
  v_lshl_add_u32 v249, v31, 4, v233
  v_add_u32 v249, 1664, v249
  s_waitcnt lgkmcnt(5)
  v_add_u32 v10, s76, v10
  v_add_u32 v4, s76, v4
  v_add_u32 v5, s76, v5
  ds_write_b32 v10, v7 offset:2880
  v_add_u32 v11, s53, v11
  s_waitcnt lgkmcnt(5)
  v_add_u32 v20, s53, v20
  v_add_u32 v21, s53, v21
  v_add_u32 v22, s53, v22
  v_add_u32 v23, s53, v23
  s_waitcnt lgkmcnt(4)
  v_add_u32 v24, s53, v24
  v_add_u32 v25, s53, v25
  v_add_u32 v26, s53, v26
  v_add_u32 v27, s53, v27
  s_mov_b32 exec_lo, 0
  v_mov_b32 v120, v136
  s_mov_b32 exec_lo, -1
  v_cvt_pk_bf16_f32 v60, 0, v120
  ds_write_b16_d16_hi v28, v60
  v_max_f32 v108, |v60|, v108
  s_mov_b32 exec_lo, 0
  v_mov_b32_e64 v152, v168
  s_mov_b32 exec_lo, -1
  v_cvt_pk_bf16_f32 v61, 0, v152
  ds_write_b16_d16_hi v58, v61
  v_max_f32 v108, |v61|, v108
  s_mov_b32 exec_lo, 0
  v_mov_b32 v184, v200
  s_mov_b32 exec_lo, -1
  v_cvt_pk_bf16_f32 v62, 0, v184
  s_mov_b64 exec, s[92:93]
  ds_write_b16_d16_hi v111, v62
  v_max_f32 v108, |v62|, v108
  s_mov_b64 exec, -1
  s_nop 0
  v_permlane32_swap_b32 v108, v109
  v_max_u32 v108, v108, v109
  s_nop 1
  v_max_u32_dpp v108, v108, v108 row_shr:1 row_mask:0xf bank_mask:0xf
  s_nop 1
  v_max_u32_dpp v108, v108, v108 row_shr:2 row_mask:0xf bank_mask:0xf
  s_nop 1
  v_max_u32_dpp v108, v108, v108 row_shr:4 row_mask:0xf bank_mask:0xf
  s_nop 1
  v_max_u32_dpp v108, v108, v108 row_shr:8 row_mask:0xf bank_mask:0xf
  s_nop 1
  v_max_u32_dpp v108, v108, v108 row_bcast:15 row_mask:0xa bank_mask:0xf
  s_mov_b32 exec_lo, 0x80000000
  s_mov_b32 exec_hi, 0x80000000
  ds_max_u32 v3, v108 offset:24
  s_mov_b64 exec, -1
  s_setprio 0
  s_waitcnt vmcnt(0)
  v_lshlrev_b32 v15, 7, v15
  buffer_load_dword v12, v15, s[32:35], 0 offen
  v_lshlrev_b32 v14, 7, v14
  buffer_load_dword v13, v14, s[32:35], 0 offen
  s_waitcnt lgkmcnt(0)
  s_barrier
  s_branch L_w2
L_g0:
  s_waitcnt lgkmcnt(0)
  s_mov_b32 s36, s8
  s_and_b32 s37, s9, 0xffff
  s_mov_b32 s38, 105456
  s_mov_b32 s39, 0x20000
  s_barrier
  s_add_u32 m0, s95, 41984
  s_add_u32 s81, s95, 70304
  buffer_load_dwordx4 v1, s[36:39], s81 offen lds
  s_add_u32 m0, s95, 46080
  s_add_u32 s81, s95, 74400
  buffer_load_dwordx4 v1, s[36:39], s81 offen lds
  s_add_u32 m0, s95, 50176
  s_add_u32 s81, s95, 78496
  buffer_load_dwordx4 v1, s[36:39], s81 offen lds
  s_add_u32 m0, s95, 54272
  s_add_u32 s81, s95, 82592
  buffer_load_dwordx4 v1, s[36:39], s81 offen lds
  s_add_u32 m0, s95, 58368
  s_add_u32 s81, s95, 86688
  buffer_load_dwordx4 v1, s[36:39], s81 offen lds
  s_add_u32 m0, s95, 62464
  s_add_u32 s81, s95, 90784
  buffer_load_dwordx4 v1, s[36:39], s81 offen lds
  s_add_u32 m0, s95, 66560
  s_add_u32 s81, s95, 94880
  buffer_load_dwordx4 v1, s[36:39], s81 offen lds
  s_add_u32 m0, s95, 70656
  s_add_u32 s81, s95, 98976
  buffer_load_dwordx4 v1, s[36:39], s81 offen lds
  s_cmp_eq_u32 s79, 3
  s_cbranch_scc1 L_st3
  s_add_u32 m0, s95, 74752
  s_add_u32 s81, s95, 103072
  buffer_load_dwordx4 v1, s[36:39], s81 offen lds
L_st3:
  s_mov_b32 s28, s4
  s_and_b32 s29, s5, 0xffff
  s_mov_b32 s30, 425984
  s_mov_b32 s31, 0x20000
  buffer_load_dwordx4 v[16:19], v30, s[28:31], s94 offen
  s_add_u32 s94, s94, 416
  buffer_load_dwordx4 v[12:15], v30, s[28:31], s94 offen
  s_add_u32 s94, s94, 416
  s_mov_b32 s32, s6
  s_and_b32 s33, s7, 0xffff
  s_mov_b32 s34, 12800000
  s_mov_b32 s35, 0x20000
  s_mul_i32 s96, s79, 3072
  s_mul_i32 s97, s79, 2704
  v_lshrrev_b32 v31, 5, v0
  v_mul_u32_u24 v31, 184, v31
  v_sub_u32_e64 v31, v1, v31
  s_add_u32 m0, s96, 85312
  s_add_u32 s81, s97, 35152
  buffer_load_dwordx4 v1, s[36:39], s81 offen lds
  s_lshl_b32 s85, s85, 2
  s_add_u32 s85, s85, 129728
  s_mul_i32 s72, s84, 3
  s_sub_u32 s72, 4, s72
  s_cmp_eq_u32 s26, 85
  s_cselect_b32 s72, s72, 6
  s_add_u32 m0, s96, 86336
  s_add_u32 s81, s97, 36176
  buffer_load_dwordx4 v31, s[36:39], s81 offen lds
  s_lshl_b32 s52, s3, 7
  s_mul_i32 s53, s3, 5280
  s_lshl_b32 s54, s3, 2
  s_lshl_b32 s55, s3, 1
  s_lshl_b32 s82, s3, 12
  s_add_u32 m0, s96, 87360
  s_add_u32 s81, s97, 37016
  buffer_load_dwordx4 v1, s[36:39], s81 offen lds
  s_and_b32 s98, s3, 1
  s_lshr_b32 s99, s3, 1
  s_mul_i32 s68, s99, 3072
  s_lshl_b32 s83, s98, 3
  s_add_u32 s68, s68, s83
  s_add_u32 m0, s96, 97600
  s_add_u32 s81, s97, 45968
  buffer_load_dwordx4 v1, s[36:39], s81 offen lds
  v_add_u32 v59, s68, v1
  s_lshl_b32 s69, s99, 3
  s_lshr_b32 s69, 0x05030200, s69
  s_and_b32 s69, s69, 0xff
  s_lshl_b32 s69, s69, 9
  s_add_u32 m0, s96, 98624
  s_add_u32 s81, s97, 46992
  buffer_load_dwordx4 v31, s[36:39], s81 offen lds
  s_lshl_b32 s70, s98, 2
  s_add_u32 s91, s69, s70
  s_mov_b32 s99, 0x05040100
  s_mov_b32 s100, 0x07060302
  v_mov_b32 v2, 129664
  s_add_u32 m0, s96, 99648
  s_add_u32 s81, s97, 47832
  buffer_load_dwordx4 v1, s[36:39], s81 offen lds
  v_mov_b32 v109, 0
  v_mov_b32 v108, 0
  v_mov_b64 v[32:33], 0
  v_mov_b64 v[34:35], 0
  v_mov_b64 v[36:37], 0
  s_add_u32 m0, s96, 109888
  s_add_u32 s81, s97, 56784
  buffer_load_dwordx4 v1, s[36:39], s81 offen lds
  v_mov_b64 v[38:39], 0
  v_mov_b64 v[40:41], 0
  v_mov_b64 v[42:43], 0
  v_mov_b64 v[44:45], 0
  v_mov_b64 v[46:47], 0
  s_add_u32 m0, s96, 110912
  s_add_u32 s81, s97, 57808
  buffer_load_dwordx4 v31, s[36:39], s81 offen lds
  v_mov_b64 v[48:49], 0
  v_mov_b64 v[50:51], 0
  v_mov_b64 v[52:53], 0
  v_mov_b64 v[54:55], 0
  v_mov_b64 v[56:57], 0
  s_add_u32 m0, s96, 111936
  s_add_u32 s81, s97, 58648
  buffer_load_dwordx4 v1, s[36:39], s81 offen lds
  v_add_u32 v250, 77824, v1
  s_waitcnt vmcnt(19)
  v_add_u32 v251, 125248, v1
  v_lshrrev_b32_e64 v3, 5, v0
  v_lshl_add_u32 v3, v3, 2, v2
  s_cmp_lg_u32 s79, 0
  s_cbranch_scc1 L_st2
  s_add_u32 m0, s96, 122176
  s_add_u32 s81, s97, 67600
  buffer_load_dwordx4 v1, s[36:39], s81 offen lds
  s_add_u32 m0, s96, 123200
  s_add_u32 s81, s97, 68624
  buffer_load_dwordx4 v31, s[36:39], s81 offen lds
  s_add_u32 m0, s96, 124224
  s_add_u32 s81, s97, 69464
  buffer_load_dwordx4 v1, s[36:39], s81 offen lds
L_st2:
  s_add_u32 m0, s95, 6144
  s_add_u32 s81, s95, 0
  buffer_load_dwordx4 v1, s[36:39], s81 offen lds
  s_add_u32 m0, s95, 10240
  s_add_u32 s81, s95, 4096
  buffer_load_dwordx4 v1, s[36:39], s81 offen lds
  s_add_u32 m0, s95, 14336
  s_add_u32 s81, s95, 8192
  buffer_load_dwordx4 v1, s[36:39], s81 offen lds
  s_add_u32 m0, s95, 18432
  s_add_u32 s81, s95, 12288
  buffer_load_dwordx4 v1, s[36:39], s81 offen lds
  s_waitcnt vmcnt(15)
  s_barrier
  ds_read_b128 v[224:227], v250 offset:0
  ds_read_b128 v[228:231], v250 offset:6144
  ds_read_b128 v[232:235], v251 offset:0
  ds_read_b128 v[4:7], v250 offset:3072
  ds_read_b128 v[8:11], v251 offset:2048
  ds_read_b128 v[20:23], v250 offset:1024
  ds_read_b128 v[24:27], v250 offset:2048
  ds_read_b128 v[216:219], v250 offset:4096
  ds_read_b128 v[220:223], v250 offset:5120
  ds_read_b128 v[236:239], v251 offset:1024
  s_add_u32 m0, s95, 22528
  s_add_u32 s81, s95, 16384
  buffer_load_dwordx4 v1, s[36:39], s81 offen lds
  s_add_u32 m0, s95, 26624
  s_add_u32 s81, s95, 20480
  buffer_load_dwordx4 v1, s[36:39], s81 offen lds
  s_add_u32 m0, s95, 30720
  s_add_u32 s81, s95, 24576
  buffer_load_dwordx4 v1, s[36:39], s81 offen lds
  s_add_u32 m0, s95, 34816
  s_add_u32 s81, s95, 28672
  buffer_load_dwordx4 v1, s[36:39], s81 offen lds
  s_cmp_eq_u32 s79, 3
  s_cbranch_scc1 L_st1
  s_add_u32 m0, s95, 38912
  s_add_u32 s81, s95, 32768
  buffer_load_dwordx4 v1, s[36:39], s81 offen lds
L_st1:
  s_waitcnt lgkmcnt(9)
  v_add_u32 v225, s52, v225
  v_add_u32 v226, s52, v226
  v_add_u32 v227, s52, v227
  s_waitcnt lgkmcnt(8)
  v_add_u32 v228, s54, v228
  v_add_u32 v229, s54, v229
  v_add_u32 v231, s83, v231
  v_add_u32 v230, s91, v230
  s_waitcnt lgkmcnt(7)
  v_mad_u32_u24 v232, v233, s3, v232
  v_add_u32 v234, s55, v234
  v_mad_u32_u24 v233, v233, 8, v232
  v_add_u32 v246, s82, v235
  v_add_u32 v247, 2048, v246
  v_add_u32 v31, 0, v234
  v_and_b32 v31, 3, v31
  v_lshl_add_u32 v244, v31, 4, v232
  v_add_u32 v31, 1, v234
  v_and_b32_e64 v31, 3, v31
  v_lshl_add_u32 v245, v31, 4, v232
  v_add_u32 v245, 1664, v245
  v_add_u32 v31, 0, v234
  v_and_b32 v31, 3, v31
  v_lshl_add_u32 v248, v31, 4, v233
  v_add_u32 v31, 1, v234
  v_and_b32 v31, 3, v31
  v_lshl_add_u32 v249, v31, 4, v233
  v_add_u32 v249, 1664, v249
  s_waitcnt lgkmcnt(5)
  v_add_u32 v10, s76, v10
  v_add_u32 v4, s76, v4
  v_add_u32 v5, s76, v5
  ds_write_b32 v10, v7 offset:2880
  v_add_u32 v11, s53, v11
  s_waitcnt lgkmcnt(5)
  v_add_u32 v20, s53, v20
  v_add_u32 v21, s53, v21
  v_add_u32 v22, s53, v22
  v_add_u32 v23, s53, v23
  s_waitcnt lgkmcnt(4)
  v_add_u32 v24, s53, v24
  v_add_u32 v25, s53, v25
  v_add_u32 v26, s53, v26
  v_add_u32 v27, s53, v27
  s_waitcnt vmcnt(18)
  v_lshl_add_u32 v16, v16, 7, v29
  v_lshl_add_u32 v17, v17, 7, v29
  v_lshl_add_u32 v18, v18, 7, v29
  v_lshl_add_u32 v19, v19, 7, v29
  s_add_u32 m0, s76, 0
  s_mov_b32 exec_hi, 0xffffff
  buffer_load_dwordx4 v16, s[32:35], 0 offen lds
  s_add_u32 m0, s76, 1056
  s_nop 0
  buffer_load_dwordx4 v17, s[32:35], 0 offen lds
  s_add_u32 m0, s76, 2112
  s_mov_b32 exec_hi, 0xffff
  buffer_load_dwordx4 v18, s[32:35], 0 offen lds
  s_add_u32 m0, s76, 3168
  s_nop 0
  buffer_load_dwordx4 v19, s[32:35], 0 offen lds
  s_mov_b32 exec_hi, -1
  s_waitcnt vmcnt(4)
  s_barrier
L_w2:
  ds_read2st64_b32 v[60:61], v228 offset0:0 offset1:6
  ds_read2st64_b32 v[62:63], v228 offset0:12 offset1:18
  ds_read2st64_b32 v[64:65], v228 offset0:24 offset1:30
  ds_read2st64_b32 v[66:67], v228 offset0:36 offset1:42
  ds_read2st64_b32 v[68:69], v228 offset0:96 offset1:102
  ds_read2st64_b32 v[70:71], v229 offset0:108 offset1:114
  ds_read2st64_b32 v[72:73], v229 offset0:120 offset1:126
  ds_read2st64_b32 v[74:75], v229 offset0:132 offset1:138
  s_cmp_ge_u32 s3, 5
  s_cbranch_scc1 L_u0
  v_add_u32 v228, 32, v228
  v_add_u32 v229, 32, v229
  ds_read2st64_b32 v[92:93], v228 offset0:0 offset1:6
  ds_read2st64_b32 v[94:95], v228 offset0:12 offset1:18
  ds_read2st64_b32 v[96:97], v228 offset0:24 offset1:30
  ds_read2st64_b32 v[98:99], v228 offset0:36 offset1:42
  ds_read2st64_b32 v[100:101], v228 offset0:96 offset1:102
  ds_read2st64_b32 v[102:103], v229 offset0:108 offset1:114
  ds_read2st64_b32 v[104:105], v229 offset0:120 offset1:126
  ds_read2st64_b32 v[106:107], v229 offset0:132 offset1:138
  ds_read_b64_tr_b16 v[76:77], v225 offset:0
  ds_read_b64_tr_b16 v[78:79], v225 offset:5408
  ds_read_b64_tr_b16 v[80:81], v226 offset:0
  ds_read_b64_tr_b16 v[82:83], v227 offset:0
  ds_read_b64_tr_b16 v[84:85], v225 offset:64
  ds_read_b64_tr_b16 v[86:87], v225 offset:5472
  ds_read_b64_tr_b16 v[88:89], v226 offset:64
  ds_read_b64_tr_b16 v[90:91], v227 offset:64
  ds_read_b64_tr_b16 v[112:113], v224 offset:0
  ds_read_b64_tr_b16 v[114:115], v224 offset:256
  ds_read_b64_tr_b16 v[116:117], v224 offset:1024
  ds_read_b64_tr_b16 v[118:119], v224 offset:1280
  s_waitcnt lgkmcnt(14)
  v_mfma_f32_16x16x32_bf16 v[108:111], v[60:63], v[60:63], 0
  s_nop 0
  v_mfma_f32_16x16x32_bf16 v[108:111], v[64:67], v[64:67], v[108:111]
  v_mfma_f32_16x16x32_bf16 v[108:111], v[68:71], v[68:71], v[108:111]
  v_mfma_f32_16x16x32_bf16 v[108:111], v[72:75], v[72:75], v[108:111]
  v_perm_b32 v184, v61, v60, s99
  v_perm_b32 v185, v63, v62, s99
  v_perm_b32 v186, v65, v64, s99
  v_perm_b32 v187, v67, v66, s99
  v_perm_b32 v188, v69, v68, s99
  v_perm_b32 v189, v71, v70, s99
  v_perm_b32 v190, v73, v72, s99
  v_perm_b32 v191, v75, v74, s99
  v_mfma_f32_16x16x32_bf16 v[108:111], v[92:95], v[92:95], v[108:111]
  v_mfma_f32_16x16x32_bf16 v[108:111], v[96:99], v[96:99], v[108:111]
  v_mfma_f32_16x16x32_bf16 v[108:111], v[100:103], v[100:103], v[108:111]
  s_waitcnt lgkmcnt(12)
  v_mfma_f32_16x16x32_bf16 v[108:111], v[104:107], v[104:107], v[108:111]
  s_waitcnt lgkmcnt(10)
  v_mfma_f32_16x16x32_bf16 v[28:31], v[76:79], v[76:79], 0
  s_waitcnt lgkmcnt(8)
  v_mfma_f32_16x16x32_bf16 v[28:31], v[80:83], v[80:83], v[28:31]
  s_waitcnt lgkmcnt(6)
  v_mfma_f32_16x16x32_bf16 v[28:31], v[84:87], v[84:87], v[28:31]
  s_nop 0
  s_waitcnt lgkmcnt(4)
  v_mfma_f32_16x16x32_bf16 v[28:31], v[88:91], v[88:91], v[28:31]
  v_perm_b32 v192, v61, v60, s100
  v_perm_b32 v193, v63, v62, s100
  v_perm_b32 v194, v65, v64, s100
  v_perm_b32 v195, v67, v66, s100
  v_perm_b32 v196, v69, v68, s100
  v_perm_b32 v197, v71, v70, s100
  v_perm_b32 v198, v73, v72, s100
  v_perm_b32 v199, v75, v74, s100
  v_max3_f32 v28, v28, v29, 0
  v_perm_b32 v60, v93, v92, s99
  v_perm_b32 v61, v95, v94, s99
  v_max3_f32 v108, v108, v109, 0
  v_perm_b32 v62, v97, v96, s99
  v_max3_f32 v28, v28, v30, v31
  v_perm_b32 v63, v99, v98, s99
  v_max3_f32 v108, v108, v110, v111
  v_perm_b32 v64, v101, v100, s99
  v_perm_b32 v65, v103, v102, s99
  v_permlane32_swap_b32 v28, v108
  v_perm_b32 v66, v105, v104, s99
  v_max_u32_e64 v28, v28, v108
  v_perm_b32 v67, v107, v106, s99
  s_nop 0
  v_max_u32_dpp v28, v28, v28 row_shr:1 row_mask:0xf bank_mask:0xf
  v_perm_b32 v68, v93, v92, s100
  v_perm_b32 v69, v95, v94, s100
  v_max_u32_dpp v28, v28, v28 row_shr:2 row_mask:0xf bank_mask:0xf
  v_perm_b32 v70, v97, v96, s100
  s_nop 0
  v_max_u32_dpp v28, v28, v28 row_shr:4 row_mask:0xf bank_mask:0xf
  v_perm_b32 v71, v99, v98, s100
  s_nop 0
  v_max_u32_dpp v28, v28, v28 row_shr:8 row_mask:0xf bank_mask:0xf
  v_perm_b32 v72, v101, v100, s100
  v_perm_b32 v73, v103, v102, s100
  v_max_u32_dpp v28, v28, v28 row_bcast:15 row_mask:0xa bank_mask:0xf
  v_perm_b32 v74, v105, v104, s100
  s_mov_b32 exec_lo, 0x80000000
  s_mov_b32 exec_hi, 0x80000000
  ds_max_u32 v3, v28 offset:16
  s_mov_b64 exec, -1
  v_perm_b32 v75, v107, v106, s100
  s_branch L_u1
L_u0:
  ds_read_b64_tr_b16 v[76:77], v225 offset:0
  ds_read_b64_tr_b16 v[78:79], v225 offset:5408
  ds_read_b64_tr_b16 v[80:81], v226 offset:0
  ds_read_b64_tr_b16 v[82:83], v227 offset:0
  ds_read_b64_tr_b16 v[84:85], v225 offset:64
  ds_read_b64_tr_b16 v[86:87], v225 offset:5472
  ds_read_b64_tr_b16 v[88:89], v226 offset:64
  ds_read_b64_tr_b16 v[90:91], v227 offset:64
  ds_read_b64_tr_b16 v[92:93], v225 offset:384
  ds_read_b64_tr_b16 v[94:95], v225 offset:5792
  ds_read_b64_tr_b16 v[96:97], v226 offset:384
  ds_read_b64_tr_b16 v[98:99], v227 offset:384
  ds_read_b64_tr_b16 v[100:101], v225 offset:448
  ds_read_b64_tr_b16 v[102:103], v225 offset:5856
  ds_read_b64_tr_b16 v[104:105], v226 offset:448
  ds_read_b64_tr_b16 v[106:107], v227 offset:448
  ds_read_b64_tr_b16 v[112:113], v224 offset:0
  ds_read_b64_tr_b16 v[114:115], v224 offset:256
  ds_read_b64_tr_b16 v[116:117], v224 offset:1024
  ds_read_b64_tr_b16 v[118:119], v224 offset:1280
  s_waitcnt lgkmcnt(14)
  v_mfma_f32_16x16x32_bf16 v[108:111], v[60:63], v[60:63], 0
  v_mfma_f32_16x16x32_bf16 v[108:111], v[64:67], v[64:67], v[108:111]
  v_mfma_f32_16x16x32_bf16 v[108:111], v[68:71], v[68:71], v[108:111]
  v_mfma_f32_16x16x32_bf16 v[108:111], v[72:75], v[72:75], v[108:111]
  v_mfma_f32_16x16x32_bf16 v[28:31], v[76:79], v[76:79], 0
  s_nop 0
  v_mfma_f32_16x16x32_bf16 v[28:31], v[80:83], v[80:83], v[28:31]
  v_mfma_f32_16x16x32_bf16 v[28:31], v[84:87], v[84:87], v[28:31]
  s_waitcnt lgkmcnt(12)
  v_mfma_f32_16x16x32_bf16 v[28:31], v[88:91], v[88:91], v[28:31]
  s_waitcnt lgkmcnt(10)
  v_mfma_f32_16x16x32_bf16 v[28:31], v[92:95], v[92:95], v[28:31]
  s_waitcnt lgkmcnt(8)
  v_mfma_f32_16x16x32_bf16 v[28:31], v[96:99], v[96:99], v[28:31]
  s_waitcnt lgkmcnt(6)
  v_mfma_f32_16x16x32_bf16 v[28:31], v[100:103], v[100:103], v[28:31]
  s_waitcnt lgkmcnt(4)
  v_mfma_f32_16x16x32_bf16 v[28:31], v[104:107], v[104:107], v[28:31]
  v_perm_b32 v184, v61, v60, s99
  v_perm_b32 v185, v63, v62, s99
  v_perm_b32 v186, v65, v64, s99
  v_perm_b32 v187, v67, v66, s99
  s_nop 3
  v_max3_f32 v28, v28, v29, 0
  v_perm_b32 v188, v69, v68, s99
  v_max3_f32 v108, v108, v109, 0
  v_perm_b32 v189, v71, v70, s99
  v_max3_f32 v28, v28, v30, v31
  v_perm_b32 v190, v73, v72, s99
  v_max3_f32 v108, v108, v110, v111
  v_perm_b32 v191, v75, v74, s99
  s_nop 0
  v_permlane32_swap_b32 v28, v108
  v_perm_b32 v192, v61, v60, s100
  v_max_u32 v28, v28, v108
  v_perm_b32 v193, v63, v62, s100
  s_nop 0
  v_max_u32_dpp v28, v28, v28 row_shr:1 row_mask:0xf bank_mask:0xf
  v_perm_b32 v194, v65, v64, s100
  s_nop 0
  v_max_u32_dpp v28, v28, v28 row_shr:2 row_mask:0xf bank_mask:0xf
  v_perm_b32 v195, v67, v66, s100
  s_nop 0
  v_max_u32_dpp v28, v28, v28 row_shr:4 row_mask:0xf bank_mask:0xf
  v_perm_b32 v196, v69, v68, s100
  s_nop 0
  v_max_u32_dpp v28, v28, v28 row_shr:8 row_mask:0xf bank_mask:0xf
  v_perm_b32 v197, v71, v70, s100
  s_nop 0
  v_max_u32_dpp v28, v28, v28 row_bcast:15 row_mask:0xa bank_mask:0xf
  v_perm_b32 v198, v73, v72, s100
  s_mov_b32 exec_lo, 0x80000000
  s_mov_b32 exec_hi, 0x80000000
  ds_max_u32 v3, v28 offset:16
  s_mov_b64 exec, -1
  v_perm_b32 v199, v75, v74, s100
  v_add_u32 v248, 12288, v246
  v_add_u32 v249, 12288, v247
  s_cmp_lg_u32 s3, 7
  s_cbranch_scc1 L_u1
  s_mov_b32 exec_lo, 0xfffffff0
  s_mov_b32 exec_hi, 0xfffffff0
  v_mov_b32 v249, 1048576
  s_mov_b64 exec, -1
L_u1:
  s_waitcnt lgkmcnt(0)
  s_barrier
  ds_read_b128 v[108:111], v2 offset:16
  s_mul_i32 s68, s3, 384
  v_lshrrev_b32 v29, 2, v0
  v_mul_u32_u24 v29, 24, v29
  v_add_u32 v29, s68, v29
  v_and_b32 v30, 3, v0
  v_lshlrev_b32_e64 v30, 3, v30
  ds_read_b64 v[224:225], v29 offset:2048
  ds_read_b64 v[226:227], v29 offset:2056
  ds_read_b64 v[228:229], v29 offset:2064
  s_waitcnt lgkmcnt(3)
  v_add_u32 v108, 0x3f800000, v108
  v_add_u32 v109, 0x3f800000, v109
  v_lshrrev_b32 v108, 24, v108
  v_lshrrev_b32 v109, 24, v109
  v_sub_u32 v108, 267, v108
  s_mov_b32 vcc_lo, 0x4000000
  v_min_u32 v108, 167, v108
  s_mov_b32 vcc_hi, 0x4000000
  v_readfirstlane_b32 s74, v108
  v_cndmask_b32 v250, v110, v111, vcc
  v_mul_u32_u24 v108, 0x800080, v108
  v_lshrrev_b32 v250, 23, v250
  v_and_b32 v216, v216, v108
  v_and_b32 v217, v217, v108
  v_and_b32 v218, v218, v108
  v_and_b32 v219, v219, v108
  v_and_b32 v220, v220, v108
  v_and_b32 v221, v221, v108
  v_and_b32 v222, v222, v108
  v_and_b32 v223, v223, v108
  v_mfma_f32_32x32x16_bf16 v[152:167], v[216:219], v[76:79], 0
  v_add_u32_e64 v250, v250, v109
  v_sub_u32 v250, 388, v250
  v_mfma_f32_32x32x16_bf16 v[168:183], v[216:219], v[84:87], 0
  s_movk_i32 s98, 167
  v_med3_i32 v250, v250, 1, s98
  v_mfma_f32_32x32x16_bf16 v[152:167], v[220:223], v[80:83], v[152:167]
  v_subrev_u32 v110, 127, v250
  v_lshlrev_b32_e64 v250, 23, v250
  v_mfma_f32_32x32x16_bf16 v[168:183], v[220:223], v[88:91], v[168:183]
  v_cmp_gt_i32 vcc, 0, v110
  v_mul_u32_u24 v110, 0x800080, v110
  s_cbranch_vccnz L_sdown
  v_add_u32 v112, v112, v110
  v_add_u32 v113, v113, v110
  v_add_u32 v114, v114, v110
  v_add_u32 v115, v115, v110
  v_add_u32 v116, v116, v110
  v_add_u32 v117, v117, v110
  v_add_u32 v118, v118, v110
  v_add_u32_e64 v119, v119, v110
L_scaled:
  v_mfma_f32_32x32x16_bf16 v[120:135], v[184:187], v[112:115], 0
  v_cvt_pk_f16_f32 v152, v152, v153
  v_cvt_pk_f16_f32 v153, v154, v155
  v_cvt_pk_f16_f32 v154, v156, v157
  v_cvt_pk_f16_f32 v155, v158, v159
  ds_write_b128 v246, v[152:155]
  v_xor_b32_e64 v246, 16, v246
  v_mfma_f32_32x32x16_bf16 v[120:135], v[188:191], v[116:119], v[120:135]
  v_cvt_pk_f16_f32 v156, v160, v161
  v_cvt_pk_f16_f32 v157, v162, v163
  v_cvt_pk_f16_f32 v158, v164, v165
  v_cvt_pk_f16_f32 v159, v166, v167
  ds_write_b128 v246, v[156:159]
  v_mfma_f32_32x32x16_bf16 v[136:151], v[192:195], v[112:115], 0
  v_cvt_pk_f16_f32 v168, v168, v169
  v_cvt_pk_f16_f32 v169, v170, v171
  v_cvt_pk_f16_f32 v170, v172, v173
  v_cvt_pk_f16_f32 v171, v174, v175
  ds_write_b128 v247, v[168:171]
  v_xor_b32 v247, 16, v247
  v_mfma_f32_32x32x16_bf16 v[136:151], v[196:199], v[116:119], v[136:151]
  v_cvt_pk_f16_f32 v172, v176, v177
  v_cvt_pk_f16_f32 v173, v178, v179
  v_cvt_pk_f16_f32 v174, v180, v181
  v_cvt_pk_f16_f32 v175, v182, v183
  ds_write_b128 v247, v[172:175]
  s_cmp_ge_u32 s3, 5
  s_cbranch_scc1 L_u2
  v_mfma_f32_32x32x16_bf16 v[184:199], v[60:63], v[112:115], 0
  v_cvt_pk_f16_f32 v120, v120, v121
  v_cvt_pk_f16_f32 v121, v122, v123
  v_cvt_pk_f16_f32 v122, v124, v125
  v_mfma_f32_32x32x16_bf16 v[184:199], v[64:67], v[116:119], v[184:199]
  v_cvt_pk_f16_f32 v123, v126, v127
  ds_write_b128 v244, v[120:123]
  v_xor_b32 v244, 16, v244
  v_mfma_f32_32x32x16_bf16 v[200:215], v[68:71], v[112:115], 0
  v_cvt_pk_f16_f32 v124, v128, v129
  v_cvt_pk_f16_f32 v125, v130, v131
  v_cvt_pk_f16_f32 v126, v132, v133
  v_mfma_f32_32x32x16_bf16 v[200:215], v[72:75], v[116:119], v[200:215]
  v_cvt_pk_f16_f32 v127, v134, v135
  ds_write_b128 v244, v[124:127]
  s_branch L_u3
L_u2:
  v_mfma_f32_32x32x16_bf16 v[184:199], v[216:219], v[92:95], 0
  v_cvt_pk_f16_f32 v120, v120, v121
  v_cvt_pk_f16_f32 v121, v122, v123
  v_cvt_pk_f16_f32 v122, v124, v125
  v_mfma_f32_32x32x16_bf16 v[184:199], v[220:223], v[96:99], v[184:199]
  v_cvt_pk_f16_f32 v123, v126, v127
  ds_write_b128 v244, v[120:123]
  v_xor_b32 v244, 16, v244
  v_mfma_f32_32x32x16_bf16 v[200:215], v[216:219], v[100:103], 0
  v_cvt_pk_f16_f32 v124, v128, v129
  v_cvt_pk_f16_f32 v125, v130, v131
  v_cvt_pk_f16_f32 v126, v132, v133
  v_mfma_f32_32x32x16_bf16 v[200:215], v[220:223], v[104:107], v[200:215]
  v_cvt_pk_f16_f32 v127, v134, v135
  ds_write_b128 v244, v[124:127]
L_u3:
  buffer_load_dwordx4 v[16:19], v6, s[28:31], s94 offen
  s_add_u32 s94, s94, 416
  buffer_load_dwordx4 v[112:115], v6, s[28:31], s94 offen
  s_add_u32 s94, s94, 416
  s_cmp_lg_u32 s84, 0
  s_cbranch_scc1 L_hu1
  v_lshl_add_u32 v12, v12, 7, v8
  v_lshl_add_u32 v13, v13, 7, v8
  v_lshl_add_u32 v14, v14, 7, v8
  v_lshl_add_u32 v15, v15, 7, v8
  s_add_u32 m0, s76, 16256
  s_mov_b32 exec_hi, 0xffffff
  buffer_load_dwordx4 v12, s[32:35], 0 offen lds
  s_add_u32 m0, s76, 17312
  s_nop 0
  buffer_load_dwordx4 v13, s[32:35], 0 offen lds
  s_add_u32 m0, s76, 18368
  s_mov_b32 exec_hi, 0xffff
  buffer_load_dwordx4 v14, s[32:35], 0 offen lds
  s_add_u32 m0, s76, 19424
  s_nop 0
  buffer_load_dwordx4 v15, s[32:35], 0 offen lds
  s_mov_b32 exec_hi, -1
  s_branch L_hu2
L_hu1:
L_hu2:
  v_cvt_pk_f16_f32 v136, v136, v137
  s_waitcnt lgkmcnt(8)
  v_xor_b32 v224, v224, v30
  v_cvt_pk_f16_f32 v137, v138, v139
  v_cvt_pk_f16_f32 v138, v140, v141
  v_xor_b32_e64 v232, 32, v224
  v_cvt_pk_f16_f32 v139, v142, v143
  ds_write_b128 v245, v[136:139]
  v_xor_b32 v245, 16, v245
  v_xor_b32 v225, v225, v30
  v_cvt_pk_f16_f32 v140, v144, v145
  v_cvt_pk_f16_f32 v141, v146, v147
  v_cvt_pk_f16_f32 v142, v148, v149
  v_xor_b32_e64 v233, 32, v225
  v_cvt_pk_f16_f32 v143, v150, v151
  ds_write_b128 v245, v[140:143]
  v_cvt_pk_f16_f32 v184, v184, v185
  s_waitcnt lgkmcnt(9)
  v_xor_b32 v226, v226, v30
  v_cvt_pk_f16_f32 v185, v186, v187
  v_cvt_pk_f16_f32 v186, v188, v189
  v_xor_b32 v234, 32, v226
  v_cvt_pk_f16_f32 v187, v190, v191
  ds_write_b128 v248, v[184:187]
  v_xor_b32 v248, 16, v248
  v_xor_b32 v227, v227, v30
  v_cvt_pk_f16_f32 v188, v192, v193
  v_cvt_pk_f16_f32 v189, v194, v195
  v_cvt_pk_f16_f32 v190, v196, v197
  v_xor_b32 v235, 32, v227
  v_cvt_pk_f16_f32 v191, v198, v199
  ds_write_b128 v248, v[188:191]
  v_cvt_pk_f16_f32 v200, v200, v201
  s_waitcnt lgkmcnt(10)
  v_xor_b32 v228, v228, v30
  v_cvt_pk_f16_f32 v201, v202, v203
  v_cvt_pk_f16_f32 v202, v204, v205
  v_xor_b32 v240, 32, v228
  v_cvt_pk_f16_f32 v203, v206, v207
  ds_write_b128 v249, v[200:203]
  v_xor_b32 v249, 16, v249
  v_xor_b32_e64 v229, v229, v30
  v_cvt_pk_f16_f32 v204, v208, v209
  v_cvt_pk_f16_f32 v205, v210, v211
  v_cvt_pk_f16_f32 v206, v212, v213
  v_xor_b32_e64 v241, 32, v229
  v_cvt_pk_f16_f32 v207, v214, v215
  ds_write_b128 v249, v[204:207]
  v_readlane_b32 s0, v250, 0
  v_readlane_b32 s1, v250, 26
  s_sub_u32 s75, 0x7f000000, s0
  s_sub_u32 s1, 0x7f000000, s1
  s_sub_u32 s74, 254, s74
  s_lshl_b32 s74, s74, 23
  s_mov_b32 s92, 0x88888888
  s_mov_b32 s93, 0x88888888
  s_waitcnt lgkmcnt(0)
  s_barrier
  ds_read_b64_tr_b16 v[60:61], v224 offset:0
  ds_read_b64_tr_b16 v[62:63], v225 offset:0
  ds_read_b64_tr_b16 v[64:65], v232 offset:0
  ds_read_b64_tr_b16 v[66:67], v233 offset:0
  ds_read_b64_tr_b16 v[68:69], v224 offset:43328
  ds_read_b64_tr_b16 v[70:71], v225 offset:43328
  ds_read_b64_tr_b16 v[72:73], v232 offset:43328
  ds_read_b64_tr_b16 v[74:75], v233 offset:43328
  ds_read_b64_tr_b16 v[76:77], v226 offset:0
  ds_read_b64_tr_b16 v[78:79], v227 offset:0
  ds_read_b64_tr_b16 v[80:81], v234 offset:0
  ds_read_b64_tr_b16 v[82:83], v235 offset:0
  ds_read_b64_tr_b16 v[84:85], v226 offset:43328
  ds_read_b64_tr_b16 v[86:87], v227 offset:43328
  ds_read_b64_tr_b16 v[88:89], v234 offset:43328
  ds_read_b64_tr_b16 v[90:91], v235 offset:43328
  s_cmp_ge_u32 s3, 6
  s_cbranch_scc1 L_lin
  ds_read_b64_tr_b16 v[92:93], v228 offset:0
  ds_read_b64_tr_b16 v[94:95], v229 offset:0
  ds_read_b64_tr_b16 v[96:97], v240 offset:0
  ds_read_b64_tr_b16 v[98:99], v241 offset:0
  ds_read_b64_tr_b16 v[100:101], v228 offset:43328
  ds_read_b64_tr_b16 v[102:103], v229 offset:43328
  ds_read_b64_tr_b16 v[104:105], v240 offset:43328
  ds_read_b64_tr_b16 v[106:107], v241 offset:43328
  s_waitcnt lgkmcnt(6)
  v_pk_add_f16 v92, v92, v94
  v_pk_add_f16 v93, v93, v95
  ds_write_b64 v59, v[92:93] offset:30720
  s_waitcnt lgkmcnt(5)
  v_pk_add_f16 v96, v96, v98
  v_pk_add_f16 v97, v97, v99
  s_waitcnt lgkmcnt(3)
  v_pk_add_f16 v100, v100, v102
  v_pk_add_f16 v101, v101, v103
  ds_write_b64 v59, v[100:101] offset:32768
  s_waitcnt lgkmcnt(2)
  v_pk_add_f16 v104, v104, v106
  v_pk_add_f16 v105, v105, v107
  v_cndmask_b32 v96, v96, v104, s[92:93]
  v_cndmask_b32 v97, v97, v105, s[92:93]
  ds_write_b64 v59, v[96:97] offset:31744
  ds_write_b32 v230, v104 offset:3072
  ds_write_b32 v230, v105 offset:3088
  s_branch L_p2
L_lin:
  s_and_b32 s98, s3, 1
  s_cselect_b64 vcc, -1, 0
  s_lshl_b32 s99, s98, 5
  v_mov_b32 v31, 0
  v_xor_b32 v236, s99, v236
  v_xor_b32 v237, s99, v237
  v_cndmask_b32 v238, v238, v239, vcc
  ds_read_b64_tr_b16 v[92:93], v236
  ds_read_b64_tr_b16 v[94:95], v237
  ds_read_u16_d16_hi v31, v238
  s_lshl_b32 s98, s98, 10
  v_add_u32 v29, s98, v1
  s_waitcnt lgkmcnt(2)
  v_cvt_f32_f16_e64 v96, v92
  v_cvt_f32_f16_sdwa v97, v92 dst_sel:DWORD dst_unused:UNUSED_PAD src0_sel:WORD_1
  v_mul_f32 v96, s1, v96
  v_mul_f32 v97, s1, v97
  v_mul_f32 v96, s0, v96
  v_mul_f32 v97, s0, v97
  v_cvt_pk_bf16_f32 v92, v96, v97
  v_cvt_f32_f16 v98, v93
  v_cvt_f32_f16_sdwa v99, v93 dst_sel:DWORD dst_unused:UNUSED_PAD src0_sel:WORD_1
  v_mul_f32 v98, s1, v98
  v_mul_f32 v99, s1, v99
  v_mul_f32 v98, s0, v98
  v_mul_f32_e64 v99, s0, v99
  v_cvt_pk_bf16_f32 v93, v98, v99
  s_waitcnt lgkmcnt(1)
  v_cvt_f32_f16 v100, v94
  v_cvt_f32_f16_sdwa v101, v94 dst_sel:DWORD dst_unused:UNUSED_PAD src0_sel:WORD_1
  v_mul_f32 v100, s1, v100
  v_mul_f32 v101, s1, v101
  v_mul_f32 v100, s0, v100
  v_mul_f32 v101, s0, v101
  v_cvt_pk_bf16_f32 v94, v100, v101
  v_cvt_f32_f16 v102, v95
  v_cvt_f32_f16_sdwa v103, v95 dst_sel:DWORD dst_unused:UNUSED_PAD src0_sel:WORD_1
  v_mul_f32 v102, s1, v102
  v_mul_f32 v103, s1, v103
  s_mov_b32 exec_lo, 0
  s_mov_b32 exec_hi, 0xffff
  s_waitcnt lgkmcnt(0)
  v_mov_b32 v102, v31
  s_mov_b64 exec, -1
  v_mul_f32 v102, s0, v102
  v_mul_f32_e64 v103, s0, v103
  v_cvt_pk_bf16_f32 v95, v102, v103
  ds_write_b128 v29, v[92:95] offset:39936
L_p2:
  v_pk_add_f16 v76, v76, v78
  v_pk_add_f16 v77, v77, v79
  ds_write_b64 v59, v[76:77] offset:18432
  v_pk_add_f16 v80, v80, v82
  v_pk_add_f16 v81, v81, v83
  v_pk_add_f16 v84, v84, v86
  v_pk_add_f16 v85, v85, v87
  ds_write_b64 v59, v[84:85] offset:20480
  v_pk_add_f16 v88, v88, v90
  v_pk_add_f16 v89, v89, v91
  v_cndmask_b32 v80, v80, v88, s[92:93]
  v_cndmask_b32 v81, v81, v89, s[92:93]
  ds_write_b64 v59, v[80:81] offset:19456
  ds_write_b32 v230, v88 offset:1024
  ds_write_b32 v230, v89 offset:1040
  v_pk_add_f16 v60, v60, v62
  v_pk_add_f16 v61, v61, v63
  ds_write_b64 v59, v[60:61] offset:6144
  v_pk_add_f16 v64, v64, v66
  v_pk_add_f16 v65, v65, v67
  v_pk_add_f16 v68, v68, v70
  v_pk_add_f16 v69, v69, v71
  ds_write_b64 v59, v[68:69] offset:8192
  v_pk_add_f16 v72, v72, v74
  v_pk_add_f16 v73, v73, v75
  v_cndmask_b32 v64, v64, v72, s[92:93]
  v_cndmask_b32 v65, v65, v73, s[92:93]
  ds_write_b64 v59, v[64:65] offset:7168
  s_cmp_lt_u32 s3, 2
  s_cbranch_scc1 L_p2d
  v_subrev_u32 v230, 1024, v230
  ds_write_b32 v230, v72 offset:0
  ds_write_b32 v230, v73 offset:16
  s_branch L_built
L_p2d:
  ds_write_b64 v231, v[72:73] offset:5120
L_built:
  s_mov_b32 s0, s74
  s_mov_b32 s1, s75
  s_mov_b32 s96, 0x3e000000
  s_mov_b32 s97, 0x43000000
  s_mov_b32 s51, 1
  s_mul_i32 s98, s3, 1536
  s_add_u32 s98, s98, 116736
  s_cmp_lg_u32 s84, 0
  s_cbranch_scc1 L_g1c
  s_sub_u32 s94, s94, 416
  s_waitcnt vmcnt(4)
  ds_read_u16_d16_hi v32, v10 offset:0
  ds_read_u16_d16_hi v33, v10 offset:2
  ds_read_u16_d16_hi v34, v10 offset:2112
  ds_read_u16_d16_hi v35, v10 offset:2114
  ds_read_u16_d16_hi v36, v10 offset:128
  ds_read_u16_d16_hi v37, v10 offset:130
  ds_read_u16_d16_hi v38, v10 offset:2240
  ds_read_u16_d16_hi v39, v10 offset:2242
  ds_read_u16_d16_hi v40, v10 offset:256
  ds_read_u16_d16_hi v41, v10 offset:258
  ds_read_u16_d16_hi v42, v10 offset:2368
  ds_read_u16_d16_hi v43, v10 offset:2370
  ds_read_u16_d16_hi v44, v10 offset:384
  ds_read_u16_d16_hi v45, v10 offset:386
  ds_read_u16_d16_hi v46, v10 offset:2496
  ds_read_u16_d16_hi v47, v10 offset:2498
  ds_read_u16_d16_hi v48, v10 offset:512
  ds_read_u16_d16_hi v49, v10 offset:514
  ds_read_u16_d16_hi v50, v10 offset:2624
  ds_read_u16_d16_hi v51, v10 offset:2626
  ds_read_u16_d16_hi v52, v10 offset:640
  ds_read_u16_d16_hi v53, v10 offset:642
  ds_read_u16_d16_hi v54, v10 offset:2752
  ds_read_u16_d16_hi v55, v10 offset:2754
  ds_read_u16_d16_hi v56, v10 offset:768
  ds_read_u16_d16_hi v57, v10 offset:770
  s_waitcnt lgkmcnt(14)
  v_max3_f32 v58, |v32|, |v33|, 0
  v_cvt_pk_f16_f32 v184, v32, v33
  v_max3_f32 v58, |v34|, |v35|, v58
  v_cvt_pk_f16_f32 v185, v34, v35
  v_max3_f32 v58, |v36|, |v37|, v58
  v_cvt_pk_f16_f32 v186, v36, v37
  v_max3_f32 v58, |v38|, |v39|, v58
  v_cvt_pk_f16_f32 v187, v38, v39
  v_max3_f32 v58, |v40|, |v41|, v58
  v_cvt_pk_f16_f32 v188, v40, v41
  v_max3_f32 v58, |v42|, |v43|, v58
  v_cvt_pk_f16_f32 v189, v42, v43
  s_waitcnt lgkmcnt(12)
  v_max3_f32 v58, |v44|, |v45|, v58
  v_cvt_pk_f16_f32 v190, v44, v45
  s_waitcnt lgkmcnt(10)
  v_max3_f32 v58, |v46|, |v47|, v58
  v_cvt_pk_f16_f32 v191, v46, v47
  s_waitcnt lgkmcnt(8)
  v_max3_f32 v58, |v48|, |v49|, v58
  v_cvt_pk_f16_f32 v192, v48, v49
  s_waitcnt lgkmcnt(6)
  v_max3_f32 v58, |v50|, |v51|, v58
  v_cvt_pk_f16_f32 v193, v50, v51
  s_waitcnt lgkmcnt(4)
  v_max3_f32 v58, |v52|, |v53|, v58
  v_cvt_pk_f16_f32 v194, v52, v53
  s_waitcnt lgkmcnt(2)
  v_max3_f32 v58, |v54|, |v55|, v58
  v_cvt_pk_f16_f32 v195, v54, v55
  s_waitcnt lgkmcnt(0)
  v_max3_f32 v58, |v56|, |v57|, v58
  v_cvt_pk_f16_f32 v196, v56, v57
  s_waitcnt lgkmcnt(0)
  s_barrier
  s_branch L_cin_go
L_g1c:
  s_waitcnt lgkmcnt(0)
  s_barrier
  s_add_u32 s76, s76, -63168
  s_waitcnt vmcnt(1)
  v_lshl_add_u32 v16, v16, 7, v8
  v_lshl_add_u32 v17, v17, 7, v8
  v_lshl_add_u32 v18, v18, 7, v8
  v_lshl_add_u32 v19, v19, 7, v8
  s_add_u32 m0, s76, 0
  s_mov_b32 exec_hi, 0xffffff
  buffer_load_dwordx4 v16, s[32:35], 0 offen lds
  s_add_u32 m0, s76, 1056
  s_nop 0
  buffer_load_dwordx4 v17, s[32:35], 0 offen lds
  s_add_u32 m0, s76, 2112
  s_mov_b32 exec_hi, 0xffff
  buffer_load_dwordx4 v18, s[32:35], 0 offen lds
  s_add_u32 m0, s76, 3168
  s_nop 0
  buffer_load_dwordx4 v19, s[32:35], 0 offen lds
  s_mov_b32 exec_hi, -1
  s_waitcnt vmcnt(4)
  v_lshl_add_u32 v112, v112, 7, v8
  v_lshl_add_u32 v113, v113, 7, v8
  v_lshl_add_u32 v114, v114, 7, v8
  v_lshl_add_u32 v115, v115, 7, v8
  s_add_u32 m0, s76, 16256
  s_mov_b32 exec_hi, 0xffffff
  buffer_load_dwordx4 v112, s[32:35], 0 offen lds
  s_add_u32 m0, s76, 17312
  s_nop 0
  buffer_load_dwordx4 v113, s[32:35], 0 offen lds
  s_add_u32 m0, s76, 18368
  s_mov_b32 exec_hi, 0xffff
  buffer_load_dwordx4 v114, s[32:35], 0 offen lds
  s_add_u32 m0, s76, 19424
  s_nop 0
  buffer_load_dwordx4 v115, s[32:35], 0 offen lds
  s_mov_b32 exec_hi, -1
  buffer_load_dwordx4 v[16:19], v6, s[28:31], s94 offen
  s_add_u32 s94, s94, 416
  v_add_u32 v10, -63168, v10
  v_add_u32 v4, -63168, v4
  v_add_u32 v5, -63168, v5
  ds_write_b32 v10, v7 offset:2880
  ds_write_b32 v10, v7 offset:19136
L_g1d:
  s_waitcnt vmcnt(5)
  ds_read_u16_d16_hi v32, v10 offset:0
  ds_read_u16_d16_hi v33, v10 offset:2
  ds_read_u16_d16_hi v34, v10 offset:2112
  ds_read_u16_d16_hi v35, v10 offset:2114
  ds_read_u16_d16_hi v36, v10 offset:128
  ds_read_u16_d16_hi v37, v10 offset:130
  ds_read_u16_d16_hi v38, v10 offset:2240
  ds_read_u16_d16_hi v39, v10 offset:2242
  ds_read_u16_d16_hi v40, v10 offset:256
  ds_read_u16_d16_hi v41, v10 offset:258
  ds_read_u16_d16_hi v42, v10 offset:2368
  ds_read_u16_d16_hi v43, v10 offset:2370
  ds_read_u16_d16_hi v44, v10 offset:384
  ds_read_u16_d16_hi v45, v10 offset:386
  ds_read_u16_d16_hi v46, v10 offset:2496
  ds_read_u16_d16_hi v47, v10 offset:2498
  ds_read_u16_d16_hi v48, v10 offset:512
  ds_read_u16_d16_hi v49, v10 offset:514
  ds_read_u16_d16_hi v50, v10 offset:2624
  ds_read_u16_d16_hi v51, v10 offset:2626
  ds_read_u16_d16_hi v52, v10 offset:640
  ds_read_u16_d16_hi v53, v10 offset:642
  ds_read_u16_d16_hi v54, v10 offset:2752
  ds_read_u16_d16_hi v55, v10 offset:2754
  ds_read_u16_d16_hi v56, v10 offset:768
  ds_read_u16_d16_hi v57, v10 offset:770
  s_waitcnt lgkmcnt(14)
  v_max3_f32 v58, |v32|, |v33|, 0
  v_cvt_pk_f16_f32 v184, v32, v33
  v_max3_f32 v58, |v34|, |v35|, v58
  v_cvt_pk_f16_f32 v185, v34, v35
  v_max3_f32 v58, |v36|, |v37|, v58
  v_cvt_pk_f16_f32 v186, v36, v37
  v_max3_f32 v58, |v38|, |v39|, v58
  v_cvt_pk_f16_f32 v187, v38, v39
  v_max3_f32 v58, |v40|, |v41|, v58
  v_cvt_pk_f16_f32 v188, v40, v41
  v_max3_f32 v58, |v42|, |v43|, v58
  v_cvt_pk_f16_f32 v189, v42, v43
  s_waitcnt lgkmcnt(12)
  v_max3_f32 v58, |v44|, |v45|, v58
  v_cvt_pk_f16_f32 v190, v44, v45
  s_waitcnt lgkmcnt(10)
  v_max3_f32 v58, |v46|, |v47|, v58
  v_cvt_pk_f16_f32 v191, v46, v47
  s_waitcnt lgkmcnt(8)
  v_max3_f32 v58, |v48|, |v49|, v58
  v_cvt_pk_f16_f32 v192, v48, v49
  s_waitcnt lgkmcnt(6)
  v_max3_f32 v58, |v50|, |v51|, v58
  v_cvt_pk_f16_f32 v193, v50, v51
  s_waitcnt lgkmcnt(4)
  v_max3_f32 v58, |v52|, |v53|, v58
  v_cvt_pk_f16_f32 v194, v52, v53
  s_waitcnt lgkmcnt(2)
  v_max3_f32 v58, |v54|, |v55|, v58
  v_cvt_pk_f16_f32 v195, v54, v55
  s_waitcnt lgkmcnt(0)
  v_max3_f32 v58, |v56|, |v57|, v58
  v_cvt_pk_f16_f32 v196, v56, v57
L_cin_go:
  ds_write_b32 v11, v184 offset:0
  ds_write_b32 v11, v185 offset:160
  ds_write_b32 v11, v186 offset:320
  ds_write_b32 v11, v187 offset:480
  ds_write_b32 v11, v188 offset:640
  ds_write_b32 v11, v189 offset:800
  ds_write_b32 v11, v190 offset:960
  ds_write_b32 v11, v191 offset:1120
  ds_write_b32 v11, v192 offset:1280
  ds_write_b32 v11, v193 offset:1440
  ds_write_b32 v11, v194 offset:1600
  ds_write_b32 v11, v195 offset:1760
  ds_write_b32 v11, v196 offset:1920
  s_mov_b32 s81, 16256
  s_add_u32 s76, s76, 16256
  v_lshlrev_b32 v7, 2, v0
  v_add_u32 v7, s98, v7
L_cin_loop:
  v_cmp_le_f32 s[90:91], s97, v58
  v_cmp_le_f32 vcc, s96, v58
  s_mov_b32 s49, s74
  s_mov_b32 s50, s75
  s_cmp_lg_u64 s[90:91], 0
  s_cbranch_scc1 L_cslow
  s_cbranch_vccz L_cslow
L_cconv:
  s_cmp_lg_u32 s51, 0
  s_cbranch_scc1 L_first
  ds_read_b64_tr_b16 v[60:61], v20 offset:0
  v_mul_f32 v116, v184, v192
  v_mul_f32 v117, v185, v193
  ds_read_b64_tr_b16 v[74:75], v20 offset:32
  v_mul_f32 v118, v186, v194
  ds_read_b64_tr_b16 v[88:89], v20 offset:64
  v_mul_f32 v119, v187, v195
  ds_read_b64_tr_b16 v[102:103], v20 offset:96
  v_fmac_f32 v116, v188, v191
  ds_read_b64_tr_b16 v[66:67], v23 offset:0
  v_fmac_f32 v117, v200, v208
  ds_read_b64_tr_b16 v[80:81], v23 offset:32
  v_fmac_f32 v118, v201, v209
  ds_read_b64_tr_b16 v[94:95], v23 offset:64
  v_fmac_f32 v119, v202, v210
  ds_read_b64_tr_b16 v[108:109], v23 offset:96
  v_fmac_f32 v116, v203, v211
  ds_read_b64_tr_b16 v[68:69], v24 offset:0
  v_fmac_f32 v117, v204, v207
  ds_read_b64_tr_b16 v[82:83], v24 offset:32
  v_fmac_f32_e64 v118, v216, v224
  ds_read_b64_tr_b16 v[96:97], v24 offset:64
  v_fmac_f32 v119, v217, v225
  ds_read_b64_tr_b16 v[110:111], v24 offset:96
  v_fmac_f32 v116, v218, v226
  ds_read_b64_tr_b16 v[124:125], v4 offset:0
  v_fmac_f32 v117, v219, v227
  ds_read_b64_tr_b16 v[126:127], v5 offset:0
  v_fmac_f32 v118, v220, v223
  v_fmac_f32 v119, v232, v240
  ds_read_b64_tr_b16 v[136:137], v4 offset:32
  v_fmac_f32 v116, v233, v241
  ds_read_b64_tr_b16 v[138:139], v5 offset:32
  v_fmac_f32 v117, v234, v242
  ds_read_b64_tr_b16 v[148:149], v4 offset:64
  v_fmac_f32 v118, v235, v243
  ds_read_b64_tr_b16 v[150:151], v5 offset:64
  v_fmac_f32 v119, v236, v239
  ds_read_b64_tr_b16 v[160:161], v4 offset:96
  v_fmac_f32 v116, v189, v196
  ds_read_b64_tr_b16 v[162:163], v5 offset:96
  v_fmac_f32_e64 v117, v189, v197
  ds_read_b128 v[164:167], v1 offset:39936
  v_fmac_f32 v118, v190, v198
  ds_read_b128 v[168:171], v1 offset:40960
  v_fmac_f32 v119, v190, v199
  ds_read_b128 v[172:175], v1 offset:8192
  v_fmac_f32 v116, v205, v212
  ds_read_b128 v[176:179], v1 offset:6144
  v_fmac_f32 v117, v205, v213
  ds_read_b64_tr_b16 v[70:71], v25 offset:0
  v_fmac_f32_e64 v118, v206, v214
  ds_read_b64_tr_b16 v[84:85], v25 offset:32
  v_fmac_f32 v119, v206, v215
  ds_read_b64_tr_b16 v[98:99], v25 offset:64
  v_fmac_f32 v116, v221, v228
  v_fmac_f32 v117, v221, v229
  ds_read_b64_tr_b16 v[112:113], v25 offset:96
  v_fmac_f32 v118, v222, v230
  ds_read_b64_tr_b16 v[72:73], v26 offset:0
  v_fmac_f32 v119, v222, v231
  ds_read_b64_tr_b16 v[86:87], v26 offset:32
  v_fmac_f32 v116, v237, v244
  ds_read_b64_tr_b16 v[100:101], v26 offset:64
  v_fmac_f32 v117, v237, v245
  ds_read_b64_tr_b16 v[114:115], v26 offset:96
  v_fmac_f32 v118, v238, v246
  ds_read_b64_tr_b16 v[62:63], v21 offset:0
  v_fmac_f32 v119, v238, v247
  ds_read_b64_tr_b16 v[76:77], v21 offset:32
  v_add_f32 v116, v116, v117
  ds_read_b64_tr_b16 v[90:91], v21 offset:64
  v_add_f32_e64 v118, v118, v119
  ds_read_b64_tr_b16 v[104:105], v21 offset:96
  v_add_f32 v116, v116, v118
  ds_read_b64_tr_b16 v[64:65], v22 offset:0
  v_mul_f32 v116, s49, v116
  ds_read_b64_tr_b16 v[78:79], v22 offset:32
  v_mul_f32_e64 v116, s50, v116
  ds_read_b64_tr_b16 v[92:93], v22 offset:64
  ds_write_b32 v7, v116
  ds_read_b64_tr_b16 v[106:107], v22 offset:96
  v_add_u32 v7, 256, v7
  s_waitcnt lgkmcnt(14)
  v_pk_mul_f16 v120, v60, v67 op_sel:[0,0] op_sel_hi:[0,1]
  v_pk_mul_f16 v121, v60, v67 op_sel:[1,0] op_sel_hi:[1,1]
  v_pk_mul_f16 v122, v60, v68 op_sel:[0,0] op_sel_hi:[0,1]
  v_pk_mul_f16 v123, v60, v68 op_sel:[1,0] op_sel_hi:[1,1]
  v_pk_mul_f16 v132, v74, v81 op_sel:[0,0] op_sel_hi:[0,1]
  v_pk_mul_f16 v133, v74, v81 op_sel:[1,0] op_sel_hi:[1,1]
  v_pk_mul_f16 v134, v74, v82 op_sel:[0,0] op_sel_hi:[0,1]
  v_pk_mul_f16 v135, v74, v82 op_sel:[1,0] op_sel_hi:[1,1]
  v_pk_mul_f16 v144, v88, v95 op_sel:[0,0] op_sel_hi:[0,1]
  v_pk_mul_f16 v145, v88, v95 op_sel:[1,0] op_sel_hi:[1,1]
  v_pk_mul_f16 v146, v88, v96 op_sel:[0,0] op_sel_hi:[0,1]
  v_pk_mul_f16 v147, v88, v96 op_sel:[1,0] op_sel_hi:[1,1]
  v_pk_mul_f16 v156, v102, v109 op_sel:[0,0] op_sel_hi:[0,1]
  v_pk_mul_f16 v157, v102, v109 op_sel:[1,0] op_sel_hi:[1,1]
  v_pk_mul_f16 v158, v102, v110 op_sel:[0,0] op_sel_hi:[0,1]
  v_pk_mul_f16 v159, v102, v110 op_sel:[1,0] op_sel_hi:[1,1]
  s_waitcnt vmcnt(0)
  v_lshl_add_u32 v16, v16, 7, v8
  v_lshl_add_u32 v17, v17, 7, v8
  v_lshl_add_u32 v18, v18, 7, v8
  v_lshl_add_u32 v19, v19, 7, v8
  s_add_u32 m0, s76, 0
  s_mov_b32 exec_hi, 0xffffff
  buffer_load_dwordx4 v16, s[32:35], 0 offen lds
  s_add_u32 m0, s76, 1056
  s_nop 0
  buffer_load_dwordx4 v17, s[32:35], 0 offen lds
  s_add_u32 m0, s76, 2112
  s_mov_b32 exec_hi, 0xffff
  buffer_load_dwordx4 v18, s[32:35], 0 offen lds
  s_add_u32 m0, s76, 3168
  s_nop 0
  buffer_load_dwordx4 v19, s[32:35], 0 offen lds
  s_mov_b32 exec_hi, -1
  buffer_load_dwordx4 v[16:19], v6, s[28:31], s94 offen
  s_add_u32 s94, s94, 416
L_novm:
  v_add_u32 v10, s81, v10
  v_add_u32 v4, s81, v4
  v_add_u32 v5, s81, v5
  s_sub_u32 s76, s76, s81
  s_sub_u32 s81, 0, s81
  s_mov_b32 s51, 0
  s_waitcnt lgkmcnt(14)
  s_cmp_eq_u32 s84, 0
  s_cbranch_scc1 L_np1
  s_setprio 1
L_np1:
  v_mfma_f32_16x16x32_bf16 v[184:187], v[164:167], v[124:127], 0
  ds_read_b128 v[180:183], v1 offset:7168
  v_pk_mul_f16 v116, v60, v69 op_sel:[0,0] op_sel_hi:[0,1]
  v_mfma_f32_16x16x32_bf16 v[200:203], v[164:167], v[136:139], 0
  v_pk_mul_f16 v117, v60, v69 op_sel:[1,0] op_sel_hi:[1,1]
  v_mfma_f32_16x16x32_bf16 v[216:219], v[164:167], v[148:151], 0
  v_pk_mul_f16 v118, v60, v70 op_sel:[0,0] op_sel_hi:[0,1]
  v_mfma_f32_16x16x32_bf16 v[232:235], v[164:167], v[160:163], 0
  v_pk_mul_f16 v119, v60, v70 op_sel:[1,0] op_sel_hi:[1,1]
  v_mfma_f32_16x16x32_bf16 v[236:239], v[168:171], v[160:163], 0
  ds_read_b128 v[164:167], v1 offset:5120
  v_pk_mul_f16 v128, v74, v83 op_sel:[0,0] op_sel_hi:[0,1]
  v_mfma_f32_16x16x32_bf16 v[220:223], v[168:171], v[148:151], 0
  v_pk_mul_f16 v129, v74, v83 op_sel:[1,0] op_sel_hi:[1,1]
  v_mfma_f32_16x16x32_bf16 v[204:207], v[168:171], v[136:139], 0
  v_pk_mul_f16 v130, v74, v84 op_sel:[0,0] op_sel_hi:[0,1]
  v_mfma_f32_16x16x32_bf16 v[188:191], v[168:171], v[124:127], 0
  v_pk_mul_f16 v131, v74, v84 op_sel:[1,0] op_sel_hi:[1,1]
  v_mfma_f32_16x16x32_f16 v[192:195], v[172:175], v[120:123], 0
  ds_read_b128 v[168:171], v1 offset:11264
  v_pk_mul_f16 v140, v88, v97 op_sel:[0,0] op_sel_hi:[0,1]
  v_mfma_f32_16x16x32_f16 v[208:211], v[172:175], v[132:135], 0
  v_pk_mul_f16 v141, v88, v97 op_sel:[1,0] op_sel_hi:[1,1]
  v_mfma_f32_16x16x32_f16 v[224:227], v[172:175], v[144:147], 0
  s_waitcnt lgkmcnt(14)
  v_pk_mul_f16 v142, v88, v98 op_sel:[0,0] op_sel_hi:[0,1]
  v_mfma_f32_16x16x32_f16 v[240:243], v[172:175], v[156:159], 0
  v_pk_mul_f16 v143, v88, v98 op_sel:[1,0] op_sel_hi:[1,1]
  v_mfma_f32_16x16x32_f16 v[232:235], v[176:179], v[156:159], v[232:235]
  ds_read_b128 v[172:175], v1 offset:9216
  v_pk_mul_f16 v152, v102, v111 op_sel:[0,0] op_sel_hi:[0,1]
  v_mfma_f32_16x16x32_f16 v[216:219], v[176:179], v[144:147], v[216:219]
  s_nop 0
  v_pk_mul_f16 v153, v102, v111 op_sel:[1,0] op_sel_hi:[1,1]
  v_mfma_f32_16x16x32_f16 v[200:203], v[176:179], v[132:135], v[200:203]
  s_waitcnt lgkmcnt(14)
  v_pk_mul_f16 v154, v102, v112 op_sel:[0,0] op_sel_hi:[0,1]
  v_mfma_f32_16x16x32_f16 v[184:187], v[176:179], v[120:123], v[184:187]
  s_waitcnt lgkmcnt(3)
  v_pk_mul_f16 v155, v102, v112 op_sel:[1,0] op_sel_hi:[1,1]
  v_mfma_f32_16x16x32_f16 v[188:191], v[180:183], v[120:123], v[188:191]
  ds_read_b128 v[176:179], v1 offset:10240
  v_pk_mul_f16 v124, v61, v68 op_sel:[0,0] op_sel_hi:[0,1]
  v_mfma_f32_16x16x32_f16 v[204:207], v[180:183], v[132:135], v[204:207]
  v_pk_mul_f16 v125, v61, v68 op_sel:[1,0] op_sel_hi:[1,1]
  v_mfma_f32_16x16x32_f16 v[220:223], v[180:183], v[144:147], v[220:223]
  v_pk_mul_f16 v126, v61, v69 op_sel:[0,0] op_sel_hi:[0,1]
  v_mfma_f32_16x16x32_f16 v[236:239], v[180:183], v[156:159], v[236:239]
  s_nop 0
  s_waitcnt lgkmcnt(3)
  v_pk_mul_f16 v127, v61, v69 op_sel:[1,0] op_sel_hi:[1,1]
  v_mfma_f32_16x16x32_f16 v[196:199], v[164:167], v[120:123], 0
  ds_read_b128 v[180:183], v1 offset:14336
  v_pk_mul_f16 v136, v75, v82 op_sel:[0,0] op_sel_hi:[0,1]
  v_mfma_f32_16x16x32_f16 v[212:215], v[164:167], v[132:135], 0
  v_pk_mul_f16 v120, v60, v71 op_sel:[0,0] op_sel_hi:[0,1]
  v_mfma_f32_16x16x32_f16 v[228:231], v[164:167], v[144:147], 0
  v_pk_mul_f16 v121, v60, v71 op_sel:[1,0] op_sel_hi:[1,1]
  v_mfma_f32_16x16x32_f16 v[244:247], v[164:167], v[156:159], 0
  s_waitcnt lgkmcnt(3)
  v_pk_mul_f16 v122, v60, v66 op_sel:[0,1] op_sel_hi:[0,0]
  v_mfma_f32_16x16x32_f16 v[192:195], v[168:171], v[116:119], v[192:195]
  ds_read_b128 v[164:167], v1 offset:12288
  v_pk_mul_f16 v123, v60, v72 op_sel:[0,0] op_sel_hi:[1,0]
  v_mfma_f32_16x16x32_f16 v[208:211], v[168:171], v[128:131], v[208:211]
  v_pk_mul_f16 v132, v74, v85 op_sel:[0,0] op_sel_hi:[0,1]
  v_mfma_f32_16x16x32_f16 v[224:227], v[168:171], v[140:143], v[224:227]
  s_nop 0
  v_pk_mul_f16 v133, v74, v85 op_sel:[1,0] op_sel_hi:[1,1]
  v_mfma_f32_16x16x32_f16 v[240:243], v[168:171], v[152:155], v[240:243]
  s_waitcnt lgkmcnt(3)
  v_pk_mul_f16 v134, v74, v80 op_sel:[0,1] op_sel_hi:[0,0]
  v_mfma_f32_16x16x32_f16 v[232:235], v[172:175], v[152:155], v[232:235]
  ds_read_b128 v[168:171], v1 offset:13312
  v_pk_mul_f16 v135, v74, v86 op_sel:[0,0] op_sel_hi:[1,0]
  v_mfma_f32_16x16x32_f16 v[216:219], v[172:175], v[140:143], v[216:219]
  s_nop 0
  v_pk_mul_f16 v144, v88, v99 op_sel:[0,0] op_sel_hi:[0,1]
  v_mfma_f32_16x16x32_f16 v[200:203], v[172:175], v[128:131], v[200:203]
  s_setprio 2
  v_pk_mul_f16 v145, v88, v99 op_sel:[1,0] op_sel_hi:[1,1]
  v_mfma_f32_16x16x32_f16 v[184:187], v[172:175], v[116:119], v[184:187]
  s_waitcnt lgkmcnt(3)
  v_pk_mul_f16 v146, v88, v94 op_sel:[0,1] op_sel_hi:[0,0]
  v_mfma_f32_16x16x32_f16 v[188:191], v[176:179], v[116:119], v[188:191]
  ds_read_b128 v[172:175], v1 offset:0
  v_pk_mul_f16 v147, v88, v100 op_sel:[0,0] op_sel_hi:[1,0]
  v_mfma_f32_16x16x32_f16 v[204:207], v[176:179], v[128:131], v[204:207]
  v_pk_mul_f16 v156, v102, v113 op_sel:[0,0] op_sel_hi:[0,1]
  v_mfma_f32_16x16x32_f16 v[220:223], v[176:179], v[140:143], v[220:223]
  v_pk_mul_f16 v157, v102, v113 op_sel:[1,0] op_sel_hi:[1,1]
  v_mfma_f32_16x16x32_f16 v[236:239], v[176:179], v[152:155], v[236:239]
  s_nop 0
  s_waitcnt lgkmcnt(3)
  v_pk_mul_f16 v158, v102, v108 op_sel:[0,1] op_sel_hi:[0,0]
  v_mfma_f32_16x16x32_f16 v[192:195], v[180:183], v[120:123], v[192:195]
  ds_read_b128 v[176:179], v1 offset:17408
  v_pk_mul_f16 v159, v102, v114 op_sel:[0,0] op_sel_hi:[1,0]
  v_mfma_f32_16x16x32_f16 v[208:211], v[180:183], v[132:135], v[208:211]
  v_pk_mul_f16 v137, v75, v82 op_sel:[1,0] op_sel_hi:[1,1]
  v_mfma_f32_16x16x32_f16 v[224:227], v[180:183], v[144:147], v[224:227]
  v_pk_mul_f16 v138, v75, v83 op_sel:[0,0] op_sel_hi:[0,1]
  v_mfma_f32_16x16x32_f16 v[240:243], v[180:183], v[156:159], v[240:243]
  s_waitcnt lgkmcnt(3)
  v_pk_mul_f16 v139, v75, v83 op_sel:[1,0] op_sel_hi:[1,1]
  v_mfma_f32_16x16x32_f16 v[232:235], v[164:167], v[156:159], v[232:235]
  ds_read_b128 v[180:183], v1 offset:15360
  v_pk_mul_f16 v148, v89, v96 op_sel:[0,0] op_sel_hi:[0,1]
  v_mfma_f32_16x16x32_f16 v[216:219], v[164:167], v[144:147], v[216:219]
  v_pk_mul_f16 v149, v89, v96 op_sel:[1,0] op_sel_hi:[1,1]
  v_mfma_f32_16x16x32_f16 v[200:203], v[164:167], v[132:135], v[200:203]
  s_nop 0
  v_pk_mul_f16 v150, v89, v97 op_sel:[0,0] op_sel_hi:[0,1]
  v_mfma_f32_16x16x32_f16 v[184:187], v[164:167], v[120:123], v[184:187]
  s_waitcnt lgkmcnt(3)
  v_pk_mul_f16 v151, v89, v97 op_sel:[1,0] op_sel_hi:[1,1]
  v_mfma_f32_16x16x32_f16 v[188:191], v[168:171], v[120:123], v[188:191]
  ds_read_b128 v[164:167], v1 offset:16384
  v_pk_mul_f16 v160, v103, v110 op_sel:[0,0] op_sel_hi:[0,1]
  v_mfma_f32_16x16x32_f16 v[204:207], v[168:171], v[132:135], v[204:207]
  s_nop 0
  v_pk_mul_f16 v161, v103, v110 op_sel:[1,0] op_sel_hi:[1,1]
  v_mfma_f32_16x16x32_f16 v[220:223], v[168:171], v[144:147], v[220:223]
  v_pk_mul_f16 v162, v103, v111 op_sel:[0,0] op_sel_hi:[0,1]
  v_mfma_f32_16x16x32_f16 v[236:239], v[168:171], v[156:159], v[236:239]
  s_waitcnt lgkmcnt(3)
  v_pk_mul_f16 v163, v103, v111 op_sel:[1,0] op_sel_hi:[1,1]
  v_smfmac_f32_16x16x64_f16 v[196:199], v[172:175], v[116:123], v9
  s_nop 0
  ds_read_b128 v[168:171], v1 offset:20480
  v_smfmac_f32_16x16x64_f16 v[212:215], v[172:175], v[128:135], v9
  v_pk_mul_f16 v120, v61, v70 op_sel:[0,0] op_sel_hi:[0,1]
  v_smfmac_f32_16x16x64_f16 v[228:231], v[172:175], v[140:147], v9
  v_pk_mul_f16 v121, v61, v70 op_sel:[1,0] op_sel_hi:[1,1]
  v_smfmac_f32_16x16x64_f16 v[244:247], v[172:175], v[152:159], v9
  s_nop 0
  s_waitcnt lgkmcnt(3)
  v_pk_mul_f16 v122, v61, v71 op_sel:[0,0] op_sel_hi:[0,1]
  v_mfma_f32_16x16x32_f16 v[192:195], v[176:179], v[124:127], v[192:195]
  ds_read_b128 v[172:175], v1 offset:18432
  v_pk_mul_f16 v123, v61, v71 op_sel:[1,0] op_sel_hi:[1,1]
  v_mfma_f32_16x16x32_f16 v[208:211], v[176:179], v[136:139], v[208:211]
  v_pk_mul_f16 v132, v75, v84 op_sel:[0,0] op_sel_hi:[0,1]
  v_mfma_f32_16x16x32_f16 v[224:227], v[176:179], v[148:151], v[224:227]
  v_pk_mul_f16 v133, v75, v84 op_sel:[1,0] op_sel_hi:[1,1]
  v_mfma_f32_16x16x32_f16 v[240:243], v[176:179], v[160:163], v[240:243]
  s_nop 0
  s_waitcnt lgkmcnt(3)
  v_pk_mul_f16 v134, v75, v85 op_sel:[0,0] op_sel_hi:[0,1]
  v_mfma_f32_16x16x32_f16 v[232:235], v[180:183], v[160:163], v[232:235]
  ds_read_b128 v[176:179], v1 offset:19456
  v_pk_mul_f16 v135, v75, v85 op_sel:[1,0] op_sel_hi:[1,1]
  v_mfma_f32_16x16x32_f16 v[216:219], v[180:183], v[148:151], v[216:219]
  v_pk_mul_f16 v144, v89, v98 op_sel:[0,0] op_sel_hi:[0,1]
  v_mfma_f32_16x16x32_f16 v[200:203], v[180:183], v[136:139], v[200:203]
  v_pk_mul_f16 v145, v89, v98 op_sel:[1,0] op_sel_hi:[1,1]
  v_mfma_f32_16x16x32_f16 v[184:187], v[180:183], v[124:127], v[184:187]
  s_waitcnt lgkmcnt(3)
  v_pk_mul_f16 v146, v89, v99 op_sel:[0,0] op_sel_hi:[0,1]
  v_mfma_f32_16x16x32_f16 v[188:191], v[164:167], v[124:127], v[188:191]
  ds_read_b128 v[180:183], v1 offset:1024
  v_pk_mul_f16 v147, v89, v99 op_sel:[1,0] op_sel_hi:[1,1]
  v_mfma_f32_16x16x32_f16 v[204:207], v[164:167], v[136:139], v[204:207]
  s_waitcnt vmcnt(0)
  ds_read_u16_d16_hi v32, v10 offset:0
  v_pk_mul_f16 v156, v103, v112 op_sel:[0,0] op_sel_hi:[0,1]
  v_mfma_f32_16x16x32_f16 v[220:223], v[164:167], v[148:151], v[220:223]
  ds_read_u16_d16_hi v33, v10 offset:2
  v_pk_mul_f16 v157, v103, v112 op_sel:[1,0] op_sel_hi:[1,1]
  v_mfma_f32_16x16x32_f16 v[236:239], v[164:167], v[160:163], v[236:239]
  s_nop 0
  s_waitcnt lgkmcnt(5)
  v_pk_mul_f16 v158, v103, v113 op_sel:[0,0] op_sel_hi:[0,1]
  v_mfma_f32_16x16x32_f16 v[192:195], v[168:171], v[120:123], v[192:195]
  ds_read_b128 v[164:167], v1 offset:23552
  v_pk_mul_f16 v159, v103, v113 op_sel:[1,0] op_sel_hi:[1,1]
  v_mfma_f32_16x16x32_f16 v[208:211], v[168:171], v[132:135], v[208:211]
  ds_read_u16_d16_hi v34, v10 offset:2112
  v_pk_mul_f16 v116, v61, v67 op_sel:[0,1] op_sel_hi:[0,0]
  v_mfma_f32_16x16x32_f16 v[224:227], v[168:171], v[144:147], v[224:227]
  ds_read_u16_d16_hi v35, v10 offset:2114
  v_pk_mul_f16 v117, v61, v72 op_sel:[0,0] op_sel_hi:[1,0]
  v_mfma_f32_16x16x32_f16 v[240:243], v[168:171], v[156:159], v[240:243]
  s_nop 0
  s_waitcnt lgkmcnt(7)
  v_pk_mul_f16 v118, v62, v69 op_sel:[0,0] op_sel_hi:[0,1]
  v_mfma_f32_16x16x32_f16 v[232:235], v[172:175], v[156:159], v[232:235]
  ds_read_b128 v[168:171], v1 offset:21504
  v_pk_mul_f16 v119, v62, v69 op_sel:[1,0] op_sel_hi:[1,1]
  v_mfma_f32_16x16x32_f16 v[216:219], v[172:175], v[144:147], v[216:219]
  ds_read_b64_tr_b16 v[60:61], v27 offset:0
  v_pk_mul_f16 v128, v75, v81 op_sel:[0,1] op_sel_hi:[0,0]
  v_mfma_f32_16x16x32_f16 v[200:203], v[172:175], v[132:135], v[200:203]
  ds_read_u16_d16_hi v36, v10 offset:128
  v_pk_mul_f16 v129, v75, v86 op_sel:[0,0] op_sel_hi:[1,0]
  v_mfma_f32_16x16x32_f16 v[184:187], v[172:175], v[120:123], v[184:187]
  s_waitcnt lgkmcnt(9)
  v_pk_mul_f16 v130, v76, v83 op_sel:[0,0] op_sel_hi:[0,1]
  v_pk_mul_f16 v131, v76, v83 op_sel:[1,0] op_sel_hi:[1,1]
  v_mfma_f32_16x16x32_f16 v[188:191], v[176:179], v[120:123], v[188:191]
  ds_read_b128 v[172:175], v1 offset:22528
  v_pk_mul_f16 v140, v89, v95 op_sel:[0,1] op_sel_hi:[0,0]
  v_mfma_f32_16x16x32_f16 v[204:207], v[176:179], v[132:135], v[204:207]
  ds_read_b64_tr_b16 v[74:75], v27 offset:32
  v_pk_mul_f16 v141, v89, v100 op_sel:[0,0] op_sel_hi:[1,0]
  v_mfma_f32_16x16x32_f16 v[220:223], v[176:179], v[144:147], v[220:223]
  ds_read_b64_tr_b16 v[88:89], v27 offset:64
  v_pk_mul_f16 v142, v90, v97 op_sel:[0,0] op_sel_hi:[0,1]
  v_mfma_f32_16x16x32_f16 v[236:239], v[176:179], v[156:159], v[236:239]
  s_waitcnt lgkmcnt(11)
  v_pk_mul_f16 v143, v90, v97 op_sel:[1,0] op_sel_hi:[1,1]
  v_pk_mul_f16 v152, v103, v109 op_sel:[0,1] op_sel_hi:[0,0]
  v_smfmac_f32_16x16x64_f16 v[196:199], v[180:183], v[120:127], v9
  ds_read_b128 v[176:179], v1 offset:26624
  v_pk_mul_f16 v153, v103, v114 op_sel:[0,0] op_sel_hi:[1,0]
  v_smfmac_f32_16x16x64_f16 v[212:215], v[180:183], v[132:139], v9
  ds_read_b64_tr_b16 v[102:103], v27 offset:96
  v_pk_mul_f16 v154, v104, v111 op_sel:[0,0] op_sel_hi:[0,1]
  v_smfmac_f32_16x16x64_f16 v[228:231], v[180:183], v[144:151], v9
  ds_read_u16_d16_hi v37, v10 offset:130
  v_pk_mul_f16 v155, v104, v111 op_sel:[1,0] op_sel_hi:[1,1]
  v_smfmac_f32_16x16x64_f16 v[244:247], v[180:183], v[156:163], v9
  s_nop 0
  s_waitcnt lgkmcnt(11)
  v_pk_mul_f16 v120, v62, v70 op_sel:[0,0] op_sel_hi:[0,1]
  v_mfma_f32_16x16x32_f16 v[192:195], v[164:167], v[116:119], v[192:195]
  ds_read_b128 v[180:183], v1 offset:24576
  v_pk_mul_f16 v121, v62, v70 op_sel:[1,0] op_sel_hi:[1,1]
  v_mfma_f32_16x16x32_f16 v[208:211], v[164:167], v[128:131], v[208:211]
  ds_read_u16_d16_hi v38, v10 offset:2240
  v_pk_mul_f16 v122, v62, v71 op_sel:[0,0] op_sel_hi:[0,1]
  v_mfma_f32_16x16x32_f16 v[224:227], v[164:167], v[140:143], v[224:227]
  ds_read_u16_d16_hi v39, v10 offset:2242
  v_pk_mul_f16 v123, v62, v71 op_sel:[1,0] op_sel_hi:[1,1]
  v_mfma_f32_16x16x32_f16 v[240:243], v[164:167], v[152:155], v[240:243]
  s_waitcnt lgkmcnt(11)
  v_pk_mul_f16 v132, v76, v84 op_sel:[0,0] op_sel_hi:[0,1]
  v_max3_f32 v58, |v32|, |v33|, 0
  v_mfma_f32_16x16x32_f16 v[232:235], v[168:171], v[152:155], v[232:235]
  ds_read_b128 v[164:167], v1 offset:25600
  v_pk_mul_f16 v133, v76, v84 op_sel:[1,0] op_sel_hi:[1,1]
  v_mfma_f32_16x16x32_f16 v[216:219], v[168:171], v[140:143], v[216:219]
  ds_read_u16_d16_hi v40, v10 offset:256
  v_pk_mul_f16 v134, v76, v85 op_sel:[0,0] op_sel_hi:[0,1]
  v_mfma_f32_16x16x32_f16 v[200:203], v[168:171], v[128:131], v[200:203]
  ds_read_u16_d16_hi v41, v10 offset:258
  v_pk_mul_f16 v135, v76, v85 op_sel:[1,0] op_sel_hi:[1,1]
  v_mfma_f32_16x16x32_f16 v[184:187], v[168:171], v[116:119], v[184:187]
  s_waitcnt lgkmcnt(11)
  v_pk_mul_f16 v144, v90, v98 op_sel:[0,0] op_sel_hi:[0,1]
  v_max3_f32 v58, |v34|, |v35|, v58
  v_mfma_f32_16x16x32_f16 v[188:191], v[172:175], v[116:119], v[188:191]
  ds_read_b128 v[168:171], v1 offset:2048
  v_pk_mul_f16 v145, v90, v98 op_sel:[1,0] op_sel_hi:[1,1]
  v_mfma_f32_16x16x32_f16 v[204:207], v[172:175], v[128:131], v[204:207]
  ds_read_u16_d16_hi v42, v10 offset:2368
  v_pk_mul_f16 v146, v90, v99 op_sel:[0,0] op_sel_hi:[0,1]
  v_mfma_f32_16x16x32_f16 v[220:223], v[172:175], v[140:143], v[220:223]
  ds_read_u16_d16_hi v43, v10 offset:2370
  v_pk_mul_f16 v147, v90, v99 op_sel:[1,0] op_sel_hi:[1,1]
  v_mfma_f32_16x16x32_f16 v[236:239], v[172:175], v[152:155], v[236:239]
  s_nop 0
  s_waitcnt lgkmcnt(11)
  v_pk_mul_f16 v156, v104, v112 op_sel:[0,0] op_sel_hi:[0,1]
  v_mfma_f32_16x16x32_f16 v[192:195], v[176:179], v[120:123], v[192:195]
  ds_read_b128 v[172:175], v1 offset:29696
  v_pk_mul_f16 v157, v104, v112 op_sel:[1,0] op_sel_hi:[1,1]
  v_mfma_f32_16x16x32_f16 v[208:211], v[176:179], v[132:135], v[208:211]
  ds_read_u16_d16_hi v44, v10 offset:384
  v_pk_mul_f16 v158, v104, v113 op_sel:[0,0] op_sel_hi:[0,1]
  v_mfma_f32_16x16x32_f16 v[224:227], v[176:179], v[144:147], v[224:227]
  ds_read_u16_d16_hi v45, v10 offset:386
  v_pk_mul_f16 v159, v104, v113 op_sel:[1,0] op_sel_hi:[1,1]
  s_nop 1
  v_mfma_f32_16x16x32_f16 v[240:243], v[176:179], v[156:159], v[240:243]
  s_waitcnt lgkmcnt(11)
  v_pk_mul_f16 v124, v62, v68 op_sel:[0,1] op_sel_hi:[0,0]
  v_mfma_f32_16x16x32_f16 v[232:235], v[180:183], v[156:159], v[232:235]
  ds_read_b128 v[176:179], v1 offset:27648
  v_pk_mul_f16 v125, v62, v72 op_sel:[0,0] op_sel_hi:[1,0]
  v_mfma_f32_16x16x32_f16 v[216:219], v[180:183], v[144:147], v[216:219]
  ds_read_u16_d16_hi v46, v10 offset:2496
  v_pk_mul_f16 v126, v63, v70 op_sel:[0,0] op_sel_hi:[0,1]
  v_mfma_f32_16x16x32_f16 v[200:203], v[180:183], v[132:135], v[200:203]
  ds_read_u16_d16_hi v47, v10 offset:2498
  v_pk_mul_f16 v127, v63, v70 op_sel:[1,0] op_sel_hi:[1,1]
  v_mfma_f32_16x16x32_f16 v[184:187], v[180:183], v[120:123], v[184:187]
  s_waitcnt lgkmcnt(11)
  v_pk_mul_f16 v136, v76, v82 op_sel:[0,1] op_sel_hi:[0,0]
  v_pk_mul_f16 v137, v76, v86 op_sel:[0,0] op_sel_hi:[1,0]
  v_mfma_f32_16x16x32_f16 v[188:191], v[164:167], v[120:123], v[188:191]
  ds_read_b128 v[180:183], v1 offset:28672
  v_pk_mul_f16 v138, v77, v84 op_sel:[0,0] op_sel_hi:[0,1]
  v_mfma_f32_16x16x32_f16 v[204:207], v[164:167], v[132:135], v[204:207]
  ds_read_u16_d16_hi v48, v10 offset:512
  v_pk_mul_f16 v139, v77, v84 op_sel:[1,0] op_sel_hi:[1,1]
  v_mfma_f32_16x16x32_f16 v[220:223], v[164:167], v[144:147], v[220:223]
  ds_read_u16_d16_hi v49, v10 offset:514
  v_pk_mul_f16 v148, v90, v96 op_sel:[0,1] op_sel_hi:[0,0]
  v_mfma_f32_16x16x32_f16 v[236:239], v[164:167], v[156:159], v[236:239]
  s_waitcnt lgkmcnt(11)
  v_pk_mul_f16 v149, v90, v100 op_sel:[0,0] op_sel_hi:[1,0]
  v_pk_mul_f16 v150, v91, v98 op_sel:[0,0] op_sel_hi:[0,1]
  v_smfmac_f32_16x16x64_f16 v[196:199], v[168:171], v[116:123], v9
  ds_read_b128 v[164:167], v1 offset:32768
  v_pk_mul_f16 v151, v91, v98 op_sel:[1,0] op_sel_hi:[1,1]
  v_smfmac_f32_16x16x64_f16 v[212:215], v[168:171], v[128:135], v9
  ds_read_u16_d16_hi v50, v10 offset:2624
  v_pk_mul_f16 v160, v104, v110 op_sel:[0,1] op_sel_hi:[0,0]
  v_smfmac_f32_16x16x64_f16 v[228:231], v[168:171], v[140:147], v9
  ds_read_u16_d16_hi v51, v10 offset:2626
  v_pk_mul_f16 v161, v104, v114 op_sel:[0,0] op_sel_hi:[1,0]
  v_smfmac_f32_16x16x64_f16 v[244:247], v[168:171], v[152:159], v9
  s_nop 0
  s_waitcnt lgkmcnt(11)
  v_pk_mul_f16 v162, v105, v112 op_sel:[0,0] op_sel_hi:[0,1]
  v_mfma_f32_16x16x32_f16 v[192:195], v[172:175], v[124:127], v[192:195]
  ds_read_b128 v[168:171], v1 offset:30720
  v_pk_mul_f16 v163, v105, v112 op_sel:[1,0] op_sel_hi:[1,1]
  v_mfma_f32_16x16x32_f16 v[208:211], v[172:175], v[136:139], v[208:211]
  ds_read_u16_d16_hi v52, v10 offset:640
  v_pk_mul_f16 v120, v63, v71 op_sel:[0,0] op_sel_hi:[0,1]
  v_mfma_f32_16x16x32_f16 v[224:227], v[172:175], v[148:151], v[224:227]
  ds_read_u16_d16_hi v53, v10 offset:642
  v_pk_mul_f16 v121, v63, v71 op_sel:[1,0] op_sel_hi:[1,1]
  v_mfma_f32_16x16x32_f16 v[240:243], v[172:175], v[160:163], v[240:243]
  s_waitcnt lgkmcnt(11)
  v_pk_mul_f16 v122, v63, v69 op_sel:[0,1] op_sel_hi:[1,1]
  v_pk_mul_f16 v123, v63, v72 op_sel:[0,0] op_sel_hi:[1,0]
  v_mfma_f32_16x16x32_f16 v[232:235], v[176:179], v[160:163], v[232:235]
  ds_read_b128 v[172:175], v1 offset:31744
  v_pk_mul_f16 v132, v77, v85 op_sel:[0,0] op_sel_hi:[0,1]
  v_mfma_f32_16x16x32_f16 v[216:219], v[176:179], v[148:151], v[216:219]
  ds_read_u16_d16_hi v54, v10 offset:2752
  v_pk_mul_f16 v133, v77, v85 op_sel:[1,0] op_sel_hi:[1,1]
  v_mfma_f32_16x16x32_f16 v[200:203], v[176:179], v[136:139], v[200:203]
  ds_read_u16_d16_hi v55, v10 offset:2754
  v_pk_mul_f16 v134, v77, v83 op_sel:[0,1] op_sel_hi:[1,1]
  v_mfma_f32_16x16x32_f16 v[184:187], v[176:179], v[124:127], v[184:187]
  s_waitcnt lgkmcnt(11)
  v_pk_mul_f16 v135, v77, v86 op_sel:[0,0] op_sel_hi:[1,0]
  v_pk_mul_f16 v144, v91, v99 op_sel:[0,0] op_sel_hi:[0,1]
  v_mfma_f32_16x16x32_f16 v[188:191], v[180:183], v[124:127], v[188:191]
  ds_read_b128 v[176:179], v1 offset:3072
  v_pk_mul_f16 v145, v91, v99 op_sel:[1,0] op_sel_hi:[1,1]
  v_mfma_f32_16x16x32_f16 v[204:207], v[180:183], v[136:139], v[204:207]
  ds_read_u16_d16_hi v56, v10 offset:768
  v_pk_mul_f16 v146, v91, v97 op_sel:[0,1] op_sel_hi:[1,1]
  v_mfma_f32_16x16x32_f16 v[220:223], v[180:183], v[148:151], v[220:223]
  ds_read_u16_d16_hi v57, v10 offset:770
  v_pk_mul_f16 v147, v91, v100 op_sel:[0,0] op_sel_hi:[1,0]
  v_mfma_f32_16x16x32_f16 v[236:239], v[180:183], v[160:163], v[236:239]
  s_waitcnt lgkmcnt(11)
  v_pk_mul_f16 v156, v105, v113 op_sel:[0,0] op_sel_hi:[0,1]
  v_max3_f32 v58, |v36|, |v37|, v58
  v_mfma_f32_16x16x32_f16 v[192:195], v[164:167], v[120:123], v[192:195]
  ds_read_b128 v[180:183], v1 offset:35840
  v_pk_mul_f16 v157, v105, v113 op_sel:[1,0] op_sel_hi:[1,1]
  v_mfma_f32_16x16x32_f16 v[208:211], v[164:167], v[132:135], v[208:211]
  s_nop 0
  v_pk_mul_f16 v158, v105, v111 op_sel:[0,1] op_sel_hi:[1,1]
  v_max3_f32 v58, |v38|, |v39|, v58
  v_mfma_f32_16x16x32_f16 v[224:227], v[164:167], v[144:147], v[224:227]
  v_pk_mul_f16 v159, v105, v114 op_sel:[0,0] op_sel_hi:[1,0]
  v_max3_f32 v58, |v40|, |v41|, v58
  s_nop 0
  v_mfma_f32_16x16x32_f16 v[240:243], v[164:167], v[156:159], v[240:243]
  s_waitcnt lgkmcnt(9)
  v_pk_mul_f16 v116, v64, v71 op_sel:[0,0] op_sel_hi:[0,1]
  v_mfma_f32_16x16x32_f16 v[232:235], v[168:171], v[156:159], v[232:235]
  ds_read_b128 v[164:167], v1 offset:33792
  v_pk_mul_f16 v117, v64, v71 op_sel:[1,0] op_sel_hi:[1,1]
  v_mfma_f32_16x16x32_f16 v[216:219], v[168:171], v[144:147], v[216:219]
  v_pk_mul_f16 v118, v64, v70 op_sel:[0,1] op_sel_hi:[1,1]
  v_max3_f32 v58, |v42|, |v43|, v58
  v_mfma_f32_16x16x32_f16 v[200:203], v[168:171], v[132:135], v[200:203]
  v_pk_mul_f16 v119, v64, v72 op_sel:[0,0] op_sel_hi:[1,0]
  v_pk_mul_f16 v128, v78, v85 op_sel:[0,0] op_sel_hi:[0,1]
  v_mfma_f32_16x16x32_f16 v[184:187], v[168:171], v[120:123], v[184:187]
  s_waitcnt lgkmcnt(7)
  v_pk_mul_f16 v129, v78, v85 op_sel:[1,0] op_sel_hi:[1,1]
  v_pk_mul_f16 v130, v78, v84 op_sel:[0,1] op_sel_hi:[1,1]
  v_mfma_f32_16x16x32_f16 v[188:191], v[172:175], v[120:123], v[188:191]
  ds_read_b128 v[168:171], v1 offset:34816
  v_pk_mul_f16 v131, v78, v86 op_sel:[0,0] op_sel_hi:[1,0]
  v_mfma_f32_16x16x32_f16 v[204:207], v[172:175], v[132:135], v[204:207]
  v_pk_mul_f16 v140, v92, v99 op_sel:[0,0] op_sel_hi:[0,1]
  v_pk_mul_f16 v141, v92, v99 op_sel:[1,0] op_sel_hi:[1,1]
  v_mfma_f32_16x16x32_f16 v[220:223], v[172:175], v[144:147], v[220:223]
  v_pk_mul_f16 v142, v92, v98 op_sel:[0,1] op_sel_hi:[1,1]
  v_pk_mul_f16 v143, v92, v100 op_sel:[0,0] op_sel_hi:[1,0]
  v_mfma_f32_16x16x32_f16 v[236:239], v[172:175], v[156:159], v[236:239]
  s_waitcnt lgkmcnt(5)
  v_pk_mul_f16 v152, v106, v113 op_sel:[0,0] op_sel_hi:[0,1]
  v_smfmac_f32_16x16x64_f16 v[196:199], v[176:179], v[120:127], v9
  ds_read_b128 v[172:175], v1 offset:38912
  v_pk_mul_f16 v153, v106, v113 op_sel:[1,0] op_sel_hi:[1,1]
  v_smfmac_f32_16x16x64_f16 v[212:215], v[176:179], v[132:139], v9
  v_pk_mul_f16 v154, v106, v112 op_sel:[0,1] op_sel_hi:[1,1]
  v_smfmac_f32_16x16x64_f16 v[228:231], v[176:179], v[144:151], v9
  v_pk_mul_f16 v155, v106, v114 op_sel:[0,0] op_sel_hi:[1,0]
  v_smfmac_f32_16x16x64_f16 v[244:247], v[176:179], v[156:163], v9
  s_waitcnt lgkmcnt(3)
  v_pk_mul_f16 v120, v65, v71 op_sel:[0,1] op_sel_hi:[1,1]
  v_mfma_f32_16x16x32_f16 v[192:195], v[180:183], v[116:119], v[192:195]
  ds_read_b128 v[176:179], v1 offset:36864
  v_pk_mul_f16 v121, v65, v72 op_sel:[0,0] op_sel_hi:[1,0]
  v_mfma_f32_16x16x32_f16 v[208:211], v[180:183], v[128:131], v[208:211]
  s_nop 0
  v_pk_mul_f16 v122, v72, v72 op_sel:[0,0] op_sel_hi:[1,1]
  v_max3_f32 v58, |v44|, |v45|, v58
  v_mfma_f32_16x16x32_f16 v[224:227], v[180:183], v[140:143], v[224:227]
  v_pk_mul_f16 v123, v60, v61 op_sel:[0,0] op_sel_hi:[1,1]
  v_max3_f32 v58, |v46|, |v47|, v58
  v_mfma_f32_16x16x32_f16 v[240:243], v[180:183], v[152:155], v[240:243]
  s_nop 0
  s_waitcnt lgkmcnt(3)
  v_pk_mul_f16 v132, v79, v85 op_sel:[0,1] op_sel_hi:[1,1]
  v_mfma_f32_16x16x32_f16 v[232:235], v[164:167], v[152:155], v[232:235]
  ds_read_b128 v[180:183], v1 offset:37888
  v_pk_mul_f16 v133, v79, v86 op_sel:[0,0] op_sel_hi:[1,0]
  v_mfma_f32_16x16x32_f16 v[216:219], v[164:167], v[140:143], v[216:219]
  v_pk_mul_f16 v134, v86, v86 op_sel:[0,0] op_sel_hi:[1,1]
  v_max3_f32 v58, |v48|, |v49|, v58
  v_mfma_f32_16x16x32_f16 v[200:203], v[164:167], v[128:131], v[200:203]
  v_pk_mul_f16 v135, v74, v75 op_sel:[0,0] op_sel_hi:[1,1]
  v_max3_f32 v58, |v50|, |v51|, v58
  v_mfma_f32_16x16x32_f16 v[184:187], v[164:167], v[116:119], v[184:187]
  s_waitcnt lgkmcnt(3)
  v_pk_mul_f16 v144, v93, v99 op_sel:[0,1] op_sel_hi:[1,1]
  v_mfma_f32_16x16x32_f16 v[188:191], v[168:171], v[116:119], v[188:191]
  ds_read_b128 v[164:167], v1 offset:4096
  v_pk_mul_f16 v145, v93, v100 op_sel:[0,0] op_sel_hi:[1,0]
  v_mfma_f32_16x16x32_f16 v[204:207], v[168:171], v[128:131], v[204:207]
  s_nop 0
  v_pk_mul_f16 v146, v100, v100 op_sel:[0,0] op_sel_hi:[1,1]
  v_max3_f32 v58, |v52|, |v53|, v58
  v_mfma_f32_16x16x32_f16 v[220:223], v[168:171], v[140:143], v[220:223]
  v_pk_mul_f16 v147, v88, v89 op_sel:[0,0] op_sel_hi:[1,1]
  v_max3_f32 v58, |v54|, |v55|, v58
  v_mfma_f32_16x16x32_f16 v[236:239], v[168:171], v[152:155], v[236:239]
  s_waitcnt lgkmcnt(3)
  v_pk_mul_f16 v156, v107, v113 op_sel:[0,1] op_sel_hi:[1,1]
  v_mfma_f32_16x16x32_f16 v[192:195], v[172:175], v[120:123], v[192:195]
  s_nop 0
  v_pk_mul_f16 v157, v107, v114 op_sel:[0,0] op_sel_hi:[1,0]
  v_max3_f32 v58, |v56|, |v57|, v58
  v_mfma_f32_16x16x32_f16 v[208:211], v[172:175], v[132:135], v[208:211]
  v_pk_mul_f16 v158, v114, v114 op_sel:[0,0] op_sel_hi:[1,1]
  v_cvt_pk_f16_f32 v62, v32, v33
  v_mfma_f32_16x16x32_f16 v[224:227], v[172:175], v[144:147], v[224:227]
  v_pk_mul_f16 v159, v102, v103 op_sel:[0,0] op_sel_hi:[1,1]
  s_nop 1
  v_mfma_f32_16x16x32_f16 v[240:243], v[172:175], v[156:159], v[240:243]
  s_waitcnt lgkmcnt(2)
  v_cvt_pk_f16_f32 v76, v34, v35
  v_cvt_pk_f16_f32 v90, v36, v37
  v_mfma_f32_16x16x32_f16 v[232:235], v[176:179], v[156:159], v[232:235]
  ds_write_b32 v11, v62 offset:0
  v_mfma_f32_16x16x32_f16 v[216:219], v[176:179], v[144:147], v[216:219]
  ds_write_b32 v11, v76 offset:160
  v_mfma_f32_16x16x32_f16 v[200:203], v[176:179], v[132:135], v[200:203]
  ds_write_b32 v11, v90 offset:320
  v_mfma_f32_16x16x32_f16 v[184:187], v[176:179], v[120:123], v[184:187]
  s_waitcnt lgkmcnt(4)
  v_cvt_pk_f16_f32 v104, v38, v39
  v_cvt_pk_f16_f32 v63, v40, v41
  v_mfma_f32_16x16x32_f16 v[188:191], v[180:183], v[120:123], v[188:191]
  ds_write_b32 v11, v104 offset:480
  v_mfma_f32_16x16x32_f16 v[204:207], v[180:183], v[132:135], v[204:207]
  ds_write_b32 v11, v63 offset:640
  v_mfma_f32_16x16x32_f16 v[220:223], v[180:183], v[144:147], v[220:223]
  v_cvt_pk_f16_f32 v77, v42, v43
  v_cvt_pk_f16_f32 v91, v44, v45
  v_mfma_f32_16x16x32_f16 v[236:239], v[180:183], v[156:159], v[236:239]
  s_waitcnt lgkmcnt(5)
  v_cvt_pk_f16_f32 v105, v46, v47
  v_cvt_pk_f16_f32 v66, v48, v49
  v_smfmac_f32_16x16x64_f16 v[196:199], v[164:167], v[116:123], v9
  ds_write_b32 v11, v77 offset:800
  v_smfmac_f32_16x16x64_f16 v[212:215], v[164:167], v[128:135], v9
  ds_write_b32 v11, v91 offset:960
  v_smfmac_f32_16x16x64_f16 v[228:231], v[164:167], v[140:147], v9
  ds_write_b32 v11, v105 offset:1120
  v_smfmac_f32_16x16x64_f16 v[244:247], v[164:167], v[152:159], v9
  ds_write_b32 v11, v66 offset:1280
  s_setprio 0
  s_sub_u32 s72, s72, 1
  s_cmp_eq_u32 s72, 0
  s_cbranch_scc1 L_cin_done
  v_cvt_pk_f16_f32 v80, v50, v51
  v_cvt_pk_f16_f32 v94, v52, v53
  v_cvt_pk_f16_f32 v108, v54, v55
  v_cvt_pk_f16_f32 v67, v56, v57
  ds_write_b32 v11, v80 offset:1440
  ds_write_b32 v11, v94 offset:1600
  ds_write_b32 v11, v108 offset:1760
  ds_write_b32 v11, v67 offset:1920
  s_branch L_cin_loop
L_cslow:
  v_max_f32_dpp v58, v58, v58 row_shr:1 row_mask:0xf bank_mask:0xf
  s_nop 1
  v_max_f32_dpp v58, v58, v58 row_shr:2 row_mask:0xf bank_mask:0xf
  s_nop 1
  v_max_f32_dpp v58, v58, v58 row_shr:4 row_mask:0xf bank_mask:0xf
  s_nop 1
  v_max_f32_dpp v58, v58, v58 row_shr:8 row_mask:0xf bank_mask:0xf
  s_nop 1
  v_max_f32_dpp v58, v58, v58 row_bcast:15 row_mask:0xa bank_mask:0xf
  s_nop 1
  v_max_f32_dpp v58, v58, v58 row_bcast:31 row_mask:0xc bank_mask:0xf
  s_nop 0
  v_readlane_b32 s98, v58, 63
  s_mov_b32 s97, 0
  s_lshr_b32 s98, s98, 23
  s_min_u32 s98, s98, 182
  s_lshr_b32 s99, s1, 23
  s_sub_u32 s99, s99, 47
  s_lshr_b32 s99, s99, 1
  s_min_u32 s99, s99, 59
  s_sub_u32 s99, 131, s99
  s_max_u32 s98, s98, s99
  s_sub_u32 s99, 258, s98
  s_lshl_b32 s100, s99, 1
  s_sub_u32 s100, s100, 127
  s_sub_u32 s95, 254, s100
  s_lshl_b32 s95, s95, 23
  v_mov_b32 v60, s95
  v_mul_f32 v61, s0, v60
  v_mul_f32 v60, s1, v60
  v_readfirstlane_b32 s74, v61
  v_readfirstlane_b32 s75, v60
  s_lshl_b32 s99, s99, 23
  s_lshl_b32 s100, s100, 23
  v_mul_f32 v60, s99, v32
  v_mul_f32 v61, s99, v33
  v_mul_f32 v62, s100, v32
  v_mul_f32 v63, s100, v33
  v_cvt_pk_f16_f32 v80, v60, v61
  v_cvt_pk_bf16_f32 v64, v62, v63
  ds_write_b32 v11, v80 offset:0
  ds_write_b32 v10, v64 offset:0
  v_mul_f32 v60, s99, v34
  v_mul_f32 v61, s99, v35
  v_mul_f32 v62, s100, v34
  v_mul_f32_e64 v63, s100, v35
  v_cvt_pk_f16_f32 v81, v60, v61
  v_cvt_pk_bf16_f32 v65, v62, v63
  ds_write_b32 v11, v81 offset:160
  ds_write_b32 v10, v65 offset:2112
  v_mul_f32 v60, s99, v36
  v_mul_f32 v61, s99, v37
  v_mul_f32 v62, s100, v36
  v_mul_f32 v63, s100, v37
  v_cvt_pk_f16_f32 v82, v60, v61
  v_cvt_pk_bf16_f32 v66, v62, v63
  ds_write_b32 v11, v82 offset:320
  ds_write_b32 v10, v66 offset:128
  v_mul_f32 v60, s99, v38
  v_mul_f32 v61, s99, v39
  v_mul_f32 v62, s100, v38
  v_mul_f32 v63, s100, v39
  v_cvt_pk_f16_f32 v83, v60, v61
  v_cvt_pk_bf16_f32 v67, v62, v63
  ds_write_b32 v11, v83 offset:480
  ds_write_b32 v10, v67 offset:2240
  v_mul_f32 v60, s99, v40
  v_mul_f32 v61, s99, v41
  v_mul_f32 v62, s100, v40
  v_mul_f32 v63, s100, v41
  v_cvt_pk_f16_f32 v84, v60, v61
  v_cvt_pk_bf16_f32 v68, v62, v63
  ds_write_b32 v11, v84 offset:640
  ds_write_b32 v10, v68 offset:256
  v_mul_f32 v60, s99, v42
  v_mul_f32 v61, s99, v43
  v_mul_f32 v62, s100, v42
  v_mul_f32 v63, s100, v43
  v_cvt_pk_f16_f32 v85, v60, v61
  v_cvt_pk_bf16_f32 v69, v62, v63
  ds_write_b32 v11, v85 offset:800
  ds_write_b32 v10, v69 offset:2368
  v_mul_f32 v60, s99, v44
  v_mul_f32 v61, s99, v45
  v_mul_f32 v62, s100, v44
  v_mul_f32 v63, s100, v45
  v_cvt_pk_f16_f32 v86, v60, v61
  v_cvt_pk_bf16_f32 v70, v62, v63
  ds_write_b32 v11, v86 offset:960
  ds_write_b32 v10, v70 offset:384
  v_mul_f32 v60, s99, v46
  v_mul_f32 v61, s99, v47
  v_mul_f32 v62, s100, v46
  v_mul_f32 v63, s100, v47
  v_cvt_pk_f16_f32 v87, v60, v61
  v_cvt_pk_bf16_f32 v71, v62, v63
  ds_write_b32 v11, v87 offset:1120
  ds_write_b32 v10, v71 offset:2496
  v_mul_f32 v60, s99, v48
  v_mul_f32 v61, s99, v49
  v_mul_f32 v62, s100, v48
  v_mul_f32 v63, s100, v49
  v_cvt_pk_f16_f32 v88, v60, v61
  v_cvt_pk_bf16_f32 v72, v62, v63
  ds_write_b32 v11, v88 offset:1280
  ds_write_b32 v10, v72 offset:512
  v_mul_f32 v60, s99, v50
  v_mul_f32 v61, s99, v51
  v_mul_f32 v62, s100, v50
  v_mul_f32 v63, s100, v51
  v_cvt_pk_f16_f32 v89, v60, v61
  v_cvt_pk_bf16_f32 v73, v62, v63
  ds_write_b32 v11, v89 offset:1440
  ds_write_b32 v10, v73 offset:2624
  v_mul_f32 v60, s99, v52
  v_mul_f32 v61, s99, v53
  v_mul_f32 v62, s100, v52
  v_mul_f32 v63, s100, v53
  v_cvt_pk_f16_f32 v90, v60, v61
  v_cvt_pk_bf16_f32 v74, v62, v63
  ds_write_b32 v11, v90 offset:1600
  ds_write_b32 v10, v74 offset:640
  v_mul_f32 v60, s99, v54
  v_mul_f32 v61, s99, v55
  v_mul_f32 v62, s100, v54
  v_mul_f32 v63, s100, v55
  v_cvt_pk_f16_f32 v91, v60, v61
  v_cvt_pk_bf16_f32 v75, v62, v63
  ds_write_b32 v11, v91 offset:1760
  ds_write_b32 v10, v75 offset:2752
  v_mul_f32 v60, s99, v56
  v_mul_f32 v61, s99, v57
  v_mul_f32 v62, s100, v56
  v_mul_f32 v63, s100, v57
  v_cvt_pk_f16_f32 v92, v60, v61
  v_cvt_pk_bf16_f32 v76, v62, v63
  ds_write_b32 v11, v92 offset:1920
  ds_write_b32 v10, v76 offset:768
  v_mov_b32 v60, s100
  v_cvt_pk_bf16_f32 v60, v60, v60
  s_mov_b32 exec_hi, 0
  ds_write_b32 v10, v60 offset:2880
  s_mov_b32 exec_hi, -1
  s_waitcnt lgkmcnt(0)
  s_branch L_cconv
L_sdown:
  v_lshlrev_b32 v108, 16, v112
  v_and_b32 v109, 0xffff0000, v112
  v_mul_f32 v108, v108, v250
  v_mul_f32 v109, v109, v250
  v_cvt_pk_bf16_f32 v112, v108, v109
  v_lshlrev_b32 v108, 16, v113
  v_and_b32 v109, 0xffff0000, v113
  v_mul_f32 v108, v108, v250
  v_mul_f32 v109, v109, v250
  v_cvt_pk_bf16_f32 v113, v108, v109
  v_lshlrev_b32 v108, 16, v114
  v_and_b32 v109, 0xffff0000, v114
  v_mul_f32 v108, v108, v250
  v_mul_f32 v109, v109, v250
  v_cvt_pk_bf16_f32 v114, v108, v109
  v_lshlrev_b32 v108, 16, v115
  v_and_b32 v109, 0xffff0000, v115
  v_mul_f32 v108, v108, v250
  v_mul_f32_e64 v109, v109, v250
  v_cvt_pk_bf16_f32 v115, v108, v109
  v_lshlrev_b32 v108, 16, v116
  v_and_b32 v109, 0xffff0000, v116
  v_mul_f32 v108, v108, v250
  v_mul_f32 v109, v109, v250
  v_cvt_pk_bf16_f32 v116, v108, v109
  v_lshlrev_b32 v108, 16, v117
  v_and_b32 v109, 0xffff0000, v117
  v_mul_f32 v108, v108, v250
  v_mul_f32 v109, v109, v250
  v_cvt_pk_bf16_f32 v117, v108, v109
  v_lshlrev_b32 v108, 16, v118
  v_and_b32 v109, 0xffff0000, v118
  v_mul_f32 v108, v108, v250
  v_mul_f32 v109, v109, v250
  v_cvt_pk_bf16_f32 v118, v108, v109
  v_lshlrev_b32 v108, 16, v119
  v_and_b32 v109, 0xffff0000, v119
  v_mul_f32 v108, v108, v250
  v_mul_f32_e64 v109, v109, v250
  v_cvt_pk_bf16_f32 v119, v108, v109
  s_branch L_scaled
L_first:
  ds_read_b64_tr_b16 v[60:61], v20 offset:0
  ds_read_b64_tr_b16 v[74:75], v20 offset:32
  ds_read_b64_tr_b16 v[88:89], v20 offset:64
  ds_read_b64_tr_b16 v[102:103], v20 offset:96
  ds_read_b64_tr_b16 v[66:67], v23 offset:0
  ds_read_b64_tr_b16 v[80:81], v23 offset:32
  ds_read_b64_tr_b16 v[94:95], v23 offset:64
  ds_read_b64_tr_b16 v[108:109], v23 offset:96
  ds_read_b64_tr_b16 v[68:69], v24 offset:0
  ds_read_b64_tr_b16 v[82:83], v24 offset:32
  ds_read_b64_tr_b16 v[96:97], v24 offset:64
  ds_read_b64_tr_b16 v[110:111], v24 offset:96
  ds_read_b64_tr_b16 v[124:125], v4 offset:0
  ds_read_b64_tr_b16 v[126:127], v5 offset:0
  ds_read_b64_tr_b16 v[136:137], v4 offset:32
  ds_read_b64_tr_b16 v[138:139], v5 offset:32
  ds_read_b64_tr_b16 v[148:149], v4 offset:64
  ds_read_b64_tr_b16 v[150:151], v5 offset:64
  ds_read_b64_tr_b16 v[160:161], v4 offset:96
  ds_read_b64_tr_b16 v[162:163], v5 offset:96
  ds_read_b128 v[164:167], v1 offset:39936
  ds_read_b128 v[168:171], v1 offset:40960
  ds_read_b128 v[172:175], v1 offset:8192
  ds_read_b128 v[176:179], v1 offset:6144
  ds_read_b64_tr_b16 v[70:71], v25 offset:0
  ds_read_b64_tr_b16 v[84:85], v25 offset:32
  ds_read_b64_tr_b16 v[98:99], v25 offset:64
  ds_read_b64_tr_b16 v[112:113], v25 offset:96
  ds_read_b64_tr_b16 v[72:73], v26 offset:0
  s_waitcnt lgkmcnt(14)
  v_pk_mul_f16 v120, v60, v67 op_sel:[0,0] op_sel_hi:[0,1]
  v_pk_mul_f16 v121, v60, v67 op_sel:[1,0] op_sel_hi:[1,1]
  ds_read_b64_tr_b16 v[86:87], v26 offset:32
  v_pk_mul_f16 v122, v60, v68 op_sel:[0,0] op_sel_hi:[0,1]
  ds_read_b64_tr_b16 v[100:101], v26 offset:64
  v_pk_mul_f16 v123, v60, v68 op_sel:[1,0] op_sel_hi:[1,1]
  ds_read_b64_tr_b16 v[114:115], v26 offset:96
  v_pk_mul_f16 v132, v74, v81 op_sel:[0,0] op_sel_hi:[0,1]
  v_pk_mul_f16 v133, v74, v81 op_sel:[1,0] op_sel_hi:[1,1]
  ds_read_b64_tr_b16 v[62:63], v21 offset:0
  v_pk_mul_f16 v134, v74, v82 op_sel:[0,0] op_sel_hi:[0,1]
  ds_read_b64_tr_b16 v[76:77], v21 offset:32
  v_pk_mul_f16 v135, v74, v82 op_sel:[1,0] op_sel_hi:[1,1]
  ds_read_b64_tr_b16 v[90:91], v21 offset:64
  v_pk_mul_f16 v144, v88, v95 op_sel:[0,0] op_sel_hi:[0,1]
  v_pk_mul_f16 v145, v88, v95 op_sel:[1,0] op_sel_hi:[1,1]
  ds_read_b64_tr_b16 v[104:105], v21 offset:96
  v_pk_mul_f16 v146, v88, v96 op_sel:[0,0] op_sel_hi:[0,1]
  ds_read_b64_tr_b16 v[64:65], v22 offset:0
  v_pk_mul_f16 v147, v88, v96 op_sel:[1,0] op_sel_hi:[1,1]
  ds_read_b64_tr_b16 v[78:79], v22 offset:32
  v_pk_mul_f16 v156, v102, v109 op_sel:[0,0] op_sel_hi:[0,1]
  v_pk_mul_f16 v157, v102, v109 op_sel:[1,0] op_sel_hi:[1,1]
  ds_read_b64_tr_b16 v[92:93], v22 offset:64
  v_pk_mul_f16 v158, v102, v110 op_sel:[0,0] op_sel_hi:[0,1]
  ds_read_b64_tr_b16 v[106:107], v22 offset:96
  v_pk_mul_f16 v159, v102, v110 op_sel:[1,0] op_sel_hi:[1,1]
  s_branch L_novm
L_end:
  s_endpgm
.p2align 8
L_tables:
.long 0x0, 0x1800, 0x6c80, 0x81a0, 0x8, 0x1808, 0x6c88, 0x81a8
.long 0x10, 0x1810, 0x6c90, 0x81b0, 0x18, 0x1818, 0x6c98, 0x81b8
.long 0x40, 0x1d48, 0x71c8, 0x86e8, 0x48, 0x1d50, 0x71d0, 0x86f0
.long 0x50, 0x1d58, 0x71d8, 0x86f8, 0x58, 0x1d60, 0x71e0, 0x8700
.long 0x80, 0x2290, 0x7710, 0x8c30, 0x88, 0x2298, 0x7718, 0x8c38
.long 0x90, 0x22a0, 0x7720, 0x8c40, 0x98, 0x22a8, 0x7728, 0x8c48
.long 0xc0, 0x27d8, 0x7c58, 0x9178, 0xc8, 0x27e0, 0x7c60, 0x9180
.long 0xd0, 0x27e8, 0x7c68, 0x9188, 0xd8, 0x27f0, 0x7c70, 0x9190
.long 0x20, 0x1820, 0x6ca0, 0x81c0, 0x28, 0x1828, 0x6ca8, 0x81c8
.long 0x30, 0x1830, 0x6cb0, 0x81d0, 0x38, 0x1838, 0x6cb8, 0x81d8
.long 0x60, 0x1d68, 0x71e8, 0x8708, 0x68, 0x1d70, 0x71f0, 0x8710
.long 0x70, 0x1d78, 0x71f8, 0x8718, 0x78, 0x1d80, 0x7200, 0x8720
.long 0xa0, 0x22b0, 0x7730, 0x8c50, 0xa8, 0x22b8, 0x7738, 0x8c58
.long 0xb0, 0x22c0, 0x7740, 0x8c60, 0xb8, 0x22c8, 0x7748, 0x8c68
.long 0xe0, 0x27f8, 0x7c78, 0x9198, 0xe8, 0x2800, 0x7c80, 0x91a0
.long 0xf0, 0x2808, 0x7c88, 0x91a8, 0xf8, 0x2810, 0x7c90, 0x91b0
.long 0x200, 0x4240, 0x96c0, 0x9c08, 0x208, 0x4248, 0x96c8, 0x9c10
.long 0x210, 0x4250, 0x96d0, 0x9c18, 0x218, 0x4258, 0x96d8, 0x9c20
.long 0x240, 0x4788, 0x9c08, 0x9c08, 0x248, 0x4790, 0x9c10, 0x9c10
.long 0x250, 0x4798, 0x9c18, 0x9c18, 0x258, 0x47a0, 0x9c20, 0x9c20
.long 0x280, 0x4cd0, 0x9c08, 0x9c08, 0x288, 0x4cd8, 0x9c10, 0x9c10
.long 0x290, 0x4ce0, 0x9c18, 0x9c18, 0x298, 0x4ce8, 0x9c20, 0x9c20
.long 0x2c0, 0x5218, 0x9c08, 0x9c08, 0x2c8, 0x5220, 0x9c10, 0x9c10
.long 0x2d0, 0x5228, 0x9c18, 0x9c18, 0x2d8, 0x5230, 0x9c20, 0x9c20
.long 0x220, 0x4260, 0x96e0, 0x9c28, 0x228, 0x4268, 0x96e8, 0x9c30
.long 0x230, 0x4270, 0x96f0, 0x9c38, 0x238, 0x4278, 0x96f8, 0x9c40
.long 0x260, 0x47a8, 0x9c28, 0x9c28, 0x268, 0x47b0, 0x9c30, 0x9c30
.long 0x270, 0x47b8, 0x9c38, 0x9c38, 0x278, 0x47c0, 0x9c40, 0x9c40
.long 0x2a0, 0x4cf0, 0x9c28, 0x9c28, 0x2a8, 0x4cf8, 0x9c30, 0x9c30
.long 0x2b0, 0x4d00, 0x9c38, 0x9c38, 0x2b8, 0x4d08, 0x9c40, 0x9c40
.long 0x2e0, 0x5238, 0x9c28, 0x9c28, 0x2e8, 0x5240, 0x9c30, 0x9c30
.long 0x2f0, 0x5248, 0x9c38, 0x9c38, 0x2f8, 0x5250, 0x9c40, 0x9c40
.long 0xaae0, 0xa680, 0xa900, 0xaae0, 0xaae8, 0xa688, 0xa908, 0xaae8
.long 0xaaf0, 0xa690, 0xa910, 0xaaf0, 0xaaf8, 0xa698, 0xa918, 0xaaf8
.long 0xaa40, 0xa860, 0xa9a0, 0xaa40, 0xaa48, 0xa868, 0xa9a8, 0xaa48
.long 0xaa50, 0xa870, 0xa9b0, 0xaa50, 0xaa58, 0xa878, 0xa9b8, 0xaa58
.long 0xa400, 0xa7c0, 0xa540, 0xa400, 0xa408, 0xa7c8, 0xa548, 0xa408
.long 0xa410, 0xa7d0, 0xa550, 0xa410, 0xa418, 0xa7d8, 0xa558, 0xa418
.long 0xa4a0, 0xa720, 0xa5e0, 0xa4a0, 0xa4a8, 0xa728, 0xa5e8, 0xa4a8
.long 0xa4b0, 0xa730, 0xa5f0, 0xa4b0, 0xa4b8, 0xa738, 0xa5f8, 0xa4b8
.long 0xb260, 0xb4e0, 0xb6c0, 0xb260, 0xb268, 0xb4e8, 0xb6c8, 0xb268
.long 0xb270, 0xb4f0, 0xb6d0, 0xb270, 0xb278, 0xb4f8, 0xb6d8, 0xb278
.long 0xb1c0, 0xb300, 0xb760, 0xb1c0, 0xb1c8, 0xb308, 0xb768, 0xb1c8
.long 0xb1d0, 0xb310, 0xb770, 0xb1d0, 0xb1d8, 0xb318, 0xb778, 0xb1d8
.long 0xb580, 0xb440, 0xb080, 0xb580, 0xb588, 0xb448, 0xb088, 0xb588
.long 0xb590, 0xb450, 0xb090, 0xb590, 0xb598, 0xb458, 0xb098, 0xb598
.long 0xb620, 0xb3a0, 0xb120, 0xb620, 0xb628, 0xb3a8, 0xb128, 0xb628
.long 0xb630, 0xb3b0, 0xb130, 0xb630, 0xb638, 0xb3b8, 0xb138, 0xb638
.long 0xa900, 0xa400, 0xaae0, 0xb620, 0xa908, 0xa408, 0xaae8, 0xb628
.long 0xa910, 0xa410, 0xaaf0, 0xb630, 0xa918, 0xa418, 0xaaf8, 0xb638
.long 0xa9a0, 0xa4a0, 0xab80, 0xb800, 0xa9a8, 0xa4a8, 0xab88, 0xb808
.long 0xa9b0, 0xa4b0, 0xab90, 0xb810, 0xa9b8, 0xa4b8, 0xab98, 0xb818
.long 0xaa40, 0xa680, 0xa860, 0xb3a0, 0xaa48, 0xa688, 0xa868, 0xb3a8
.long 0xaa50, 0xa690, 0xa870, 0xb3b0, 0xaa58, 0xa698, 0xa878, 0xb3b8
.long 0xa720, 0xa540, 0xa7c0, 0xb1c0, 0xa728, 0xa548, 0xa7c8, 0xb1c8
.long 0xa730, 0xa550, 0xa7d0, 0xb1d0, 0xa738, 0xa558, 0xa7d8, 0xb1d8
.long 0xa5e0, 0xaae0, 0xa400, 0xb080, 0xa5e8, 0xaae8, 0xa408, 0xb088
.long 0xa5f0, 0xaaf0, 0xa410, 0xb090, 0xa5f8, 0xaaf8, 0xa418, 0xb098
.long 0xa7c0, 0xa540, 0xa720, 0xb760, 0xa7c8, 0xa548, 0xa728, 0xb768
.long 0xa7d0, 0xa550, 0xa730, 0xb770, 0xa7d8, 0xa558, 0xa738, 0xb778
.long 0xa860, 0xa680, 0xaa40, 0xb440, 0xa868, 0xa688, 0xaa48, 0xb448
.long 0xa870, 0xa690, 0xaa50, 0xb450, 0xa878, 0xa698, 0xaa58, 0xb458
.long 0xab80, 0xa4a0, 0xa9a0, 0xb4e0, 0xab88, 0xa4a8, 0xa9a8, 0xb4e8
.long 0xab90, 0xa4b0, 0xa9b0, 0xb4f0, 0xab98, 0xa4b8, 0xa9b8, 0xb4f8
.long 0xa680, 0xa900, 0xab80, 0xa4a0, 0xa688, 0xa908, 0xab88, 0xa4a8
.long 0xa690, 0xa910, 0xab90, 0xa4b0, 0xa698, 0xa918, 0xab98, 0xa4b8
.long 0xa860, 0xa9a0, 0xb1c0, 0xb440, 0xa868, 0xa9a8, 0xb1c8, 0xb448
.long 0xa870, 0xa9b0, 0xb1d0, 0xb450, 0xa878, 0xa9b8, 0xb1d8, 0xb458
.long 0xa7c0, 0xa540, 0xab80, 0xa4a0, 0xa7c8, 0xa548, 0xab88, 0xa4a8
.long 0xa7d0, 0xa550, 0xab90, 0xa4b0, 0xa7d8, 0xa558, 0xab98, 0xa4b8
.long 0xa720, 0xa5e0, 0xb1c0, 0xb440, 0xa728, 0xa5e8, 0xb1c8, 0xb448
.long 0xa730, 0xa5f0, 0xb1d0, 0xb450, 0xa738, 0xa5f8, 0xb1d8, 0xb458
.long 0xb4e0, 0xb6c0, 0xb800, 0xa860, 0xb4e8, 0xb6c8, 0xb808, 0xa868
.long 0xb4f0, 0xb6d0, 0xb810, 0xa870, 0xb4f8, 0xb6d8, 0xb818, 0xa878
.long 0xb300, 0xb760, 0xa540, 0xa900, 0xb308, 0xb768, 0xa548, 0xa908
.long 0xb310, 0xb770, 0xa550, 0xa910, 0xb318, 0xb778, 0xa558, 0xa918
.long 0xb440, 0xb080, 0xb800, 0xa860, 0xb448, 0xb088, 0xb808, 0xa868
.long 0xb450, 0xb090, 0xb810, 0xa870, 0xb458, 0xb098, 0xb818, 0xa878
.long 0xb3a0, 0xb120, 0xa540, 0xa900, 0xb3a8, 0xb128, 0xa548, 0xa908
.long 0xb3b0, 0xb130, 0xa550, 0xa910, 0xb3b8, 0xb138, 0xa558, 0xa918
.long 0xb120, 0xb580, 0xb080, 0xb300, 0xb128, 0xb588, 0xb088, 0xb308
.long 0xb130, 0xb590, 0xb090, 0xb310, 0xb138, 0xb598, 0xb098, 0xb318
.long 0xb6c0, 0xb4e0, 0xaa40, 0xb6c0, 0xb6c8, 0xb4e8, 0xaa48, 0xb6c8
.long 0xb6d0, 0xb4f0, 0xaa50, 0xb6d0, 0xb6d8, 0xb4f8, 0xaa58, 0xb6d8
.long 0xb300, 0xb440, 0xb080, 0xb300, 0xb308, 0xb448, 0xb088, 0xb308
.long 0xb310, 0xb450, 0xb090, 0xb310, 0xb318, 0xb458, 0xb098, 0xb318
.long 0xb260, 0xb760, 0xaa40, 0xb6c0, 0xb268, 0xb768, 0xaa48, 0xb6c8
.long 0xb270, 0xb770, 0xaa50, 0xb6d0, 0xb278, 0xb778, 0xaa58, 0xb6d8
.long 0xb580, 0xb120, 0xb620, 0xa680, 0xb588, 0xb128, 0xb628, 0xa688
.long 0xb590, 0xb130, 0xb630, 0xa690, 0xb598, 0xb138, 0xb638, 0xa698
.long 0xb260, 0xb1c0, 0xa7c0, 0xa680, 0xb268, 0xb1c8, 0xa7c8, 0xa688
.long 0xb270, 0xb1d0, 0xa7d0, 0xa690, 0xb278, 0xb1d8, 0xa7d8, 0xa698
.long 0xb300, 0xb3a0, 0xb620, 0xb300, 0xb308, 0xb3a8, 0xb628, 0xb308
.long 0xb310, 0xb3b0, 0xb630, 0xb310, 0xb318, 0xb3b8, 0xb638, 0xb318
.long 0xb6c0, 0xb800, 0xa7c0, 0xb300, 0xb6c8, 0xb808, 0xa7c8, 0xb308
.long 0xb6d0, 0xb810, 0xa7d0, 0xb310, 0xb6d8, 0xb818, 0xa7d8, 0xb318
.long 0x0, 0x200, 0x0, 0x3f803f80, 0x8, 0x208, 0x0, 0x3f803f80
.long 0x10, 0x210, 0x0, 0x3f803f80, 0x18, 0x218, 0x0, 0x3f803f80
.long 0x420, 0x620, 0x0, 0x3f803f80, 0x428, 0x628, 0x0, 0x3f803f80
.long 0x430, 0x630, 0x0, 0x3f803f80, 0x438, 0x638, 0x0, 0x3f803f80
.long 0x840, 0xa40, 0x10, 0x3f803f80, 0x848, 0xa48, 0x10, 0x3f803f80
.long 0x850, 0xa50, 0x10, 0x3f803f80, 0x858, 0xa58, 0x10, 0x3f803f80
.long 0xc60, 0xe60, 0x10, 0x3f803f80, 0xc68, 0xe68, 0x10, 0x3f803f80
.long 0xc70, 0xe70, 0x10, 0x3f803f80, 0xc78, 0xe78, 0x10, 0x3f803f80
.long 0x80, 0x280, 0x20, 0x3f803f80, 0x88, 0x288, 0x20, 0x3f803f80
.long 0x90, 0x290, 0x20, 0x3f803f80, 0x98, 0x298, 0x20, 0x3f803f80
.long 0x4a0, 0x6a0, 0x20, 0x3f803f80, 0x4a8, 0x6a8, 0x20, 0x3f803f80
.long 0x4b0, 0x6b0, 0x20, 0x3f803f80, 0x4b8, 0x6b8, 0x20, 0x3f803f80
.long 0x8c0, 0xac0, 0x30, 0x3f803f80, 0x8c8, 0xac8, 0x30, 0x3f803f80
.long 0x8d0, 0xad0, 0x30, 0x3f803f80, 0x8d8, 0xad8, 0x30, 0x3f803f80
.long 0xce0, 0xee0, 0x30, 0x3f803f80, 0xce8, 0xee8, 0x30, 0x3f803f80
.long 0xcf0, 0xef0, 0x30, 0x3f803f80, 0xcf8, 0xef8, 0x30, 0x3f803f80
.long 0x100, 0x300, 0x40, 0x0, 0x108, 0x308, 0x40, 0x0
.long 0x110, 0x310, 0x40, 0x0, 0x118, 0x318, 0x40, 0x0
.long 0x520, 0x720, 0x40, 0x0, 0x528, 0x728, 0x40, 0x0
.long 0x530, 0x730, 0x40, 0x0, 0x538, 0x738, 0x40, 0x0
.long 0x940, 0xb40, 0x50, 0x0, 0x948, 0xb48, 0x50, 0x0
.long 0x950, 0xb50, 0x50, 0x0, 0x958, 0xb58, 0x50, 0x0
.long 0xd60, 0xf60, 0x50, 0x0, 0xd68, 0xf68, 0x50, 0x0
.long 0xd70, 0xf70, 0x50, 0x0, 0xd78, 0xf78, 0x50, 0x0
.long 0x180, 0xf60, 0x60, 0x0, 0x188, 0xf68, 0x60, 0x0
.long 0x190, 0xf70, 0x60, 0x0, 0x198, 0xf78, 0x60, 0x0
.long 0x5a0, 0xf60, 0x60, 0x0, 0x5a8, 0xf68, 0x60, 0x0
.long 0x5b0, 0xf70, 0x60, 0x0, 0x5b8, 0xf78, 0x60, 0x0
.long 0x9c0, 0xf60, 0x70, 0x0, 0x9c8, 0xf68, 0x70, 0x0
.long 0x9d0, 0xf70, 0x70, 0x0, 0x9d8, 0xf78, 0x70, 0x0
.long 0xde0, 0xf60, 0x70, 0x0, 0xde8, 0xf68, 0x70, 0x0
.long 0xdf0, 0xf70, 0x70, 0x0, 0xdf8, 0xf78, 0x70, 0x0
.long 0xffff, 0x0, 0x0, 0x0, 0x0, 0x0, 0xffff, 0x0
.long 0x0, 0x0, 0x0, 0x0, 0x0, 0x0, 0x0, 0x0
.long 0x0, 0x0, 0x0, 0x0, 0x0, 0x0, 0x0, 0x0
.long 0x0, 0x0, 0x0, 0x0, 0x0, 0x0, 0x0, 0x0
.long 0xffff0000, 0x0, 0x0, 0x0, 0x0, 0x0, 0xffff0000, 0x0
.long 0x0, 0x0, 0x0, 0x0, 0x0, 0x0, 0x0, 0x0
.long 0x0, 0x0, 0x0, 0x0, 0x0, 0x0, 0x0, 0x0
.long 0x0, 0x0, 0x0, 0x0, 0x0, 0x0, 0x0, 0x0
.long 0x0, 0xffff, 0x0, 0x0, 0x0, 0x0, 0x0, 0xffff
.long 0x0, 0x0, 0x0, 0x0, 0x0, 0x0, 0x0, 0x0
.long 0x0, 0x0, 0x0, 0x0, 0x0, 0x0, 0x0, 0x0
.long 0x0, 0x0, 0x0, 0x0, 0x0, 0x0, 0x0, 0x0
.long 0x0, 0xffff0000, 0x0, 0x0, 0x0, 0x0, 0x0, 0xffff0000
.long 0x0, 0x0, 0x0, 0x0, 0x0, 0x0, 0x0, 0x0
.long 0x0, 0x0, 0x0, 0x0, 0x0, 0x0, 0x0, 0x0
.long 0x0, 0x0, 0x0, 0x0, 0x0, 0x0, 0x0, 0x0
.long 0x0, 0x0, 0x0, 0x0, 0x0, 0x0, 0x0, 0x0
.long 0xffff, 0x0, 0x0, 0x0, 0x0, 0x0, 0xffff, 0x0
.long 0x0, 0x0, 0x0, 0x0, 0x0, 0x0, 0x0, 0x0
.long 0x0, 0x0, 0x0, 0x0, 0x0, 0x0, 0x0, 0x0
.long 0x0, 0x0, 0x0, 0x0, 0x0, 0x0, 0x0, 0x0
.long 0xffff0000, 0x0, 0x0, 0x0, 0x0, 0x0, 0xffff0000, 0x0
.long 0x0, 0x0, 0x0, 0x0, 0x0, 0x0, 0x0, 0x0
.long 0x0, 0x0, 0x0, 0x0, 0x0, 0x0, 0x0, 0x0
.long 0x0, 0x0, 0x0, 0x0, 0x0, 0x0, 0x0, 0x0
.long 0x0, 0xffff, 0x0, 0x0, 0x0, 0x0, 0x0, 0xffff
.long 0x0, 0x0, 0x0, 0x0, 0x0, 0x0, 0x0, 0x0
.long 0x0, 0x0, 0x0, 0x0, 0x0, 0x0, 0x0, 0x0
.long 0x0, 0x0, 0x0, 0x0, 0x0, 0x0, 0x0, 0x0
.long 0x0, 0xffff0000, 0x0, 0x0, 0x0, 0x0, 0x0, 0xffff0000
.long 0x0, 0x0, 0x0, 0x0, 0x0, 0x0, 0x0, 0x0
.long 0x0, 0x0, 0x0, 0x0, 0x0, 0x0, 0x0, 0x0
.long 0x0, 0x0, 0x0, 0x0, 0x0, 0x0, 0x0, 0x0
.long 0x0, 0x0, 0x0, 0x0, 0x0, 0x0, 0x0, 0x0
.long 0x0, 0x0, 0xffff, 0x0, 0x0, 0x0, 0x0, 0x0
.long 0x0, 0x0, 0x0, 0x0, 0xffff, 0x0, 0x0, 0x0
.long 0x0, 0x0, 0x0, 0x0, 0x0, 0x0, 0x0, 0x0
.long 0x0, 0x0, 0x0, 0x0, 0x0, 0x0, 0x0, 0x0
.long 0x0, 0x0, 0xffff0000, 0x0, 0x0, 0x0, 0x0, 0x0
.long 0x0, 0x0, 0x0, 0x0, 0xffff0000, 0x0, 0x0, 0x0
.long 0x0, 0x0, 0x0, 0x0, 0x0, 0x0, 0x0, 0x0
.long 0x0, 0x0, 0x0, 0x0, 0x0, 0x0, 0x0, 0x0
.long 0x0, 0x0, 0x0, 0xffff, 0x0, 0x0, 0x0, 0x0
.long 0x0, 0x0, 0x0, 0x0, 0x0, 0xffff, 0x0, 0x0
.long 0x0, 0x0, 0x0, 0x0, 0x0, 0x0, 0x0, 0x0
.long 0x0, 0x0, 0x0, 0x0, 0x0, 0x0, 0x0, 0x0
.long 0x0, 0x0, 0x0, 0xffff0000, 0x0, 0x0, 0x0, 0x0
.long 0x0, 0x0, 0x0, 0x0, 0x0, 0xffff0000, 0x0, 0x0
.long 0x0, 0x0, 0x0, 0x0, 0x0, 0x0, 0x0, 0x0
.long 0x0, 0x0, 0x0, 0x0, 0x0, 0x0, 0x0, 0x0
.long 0x0, 0x0, 0x0, 0x0, 0xffff, 0x0, 0x0, 0x0
.long 0x0, 0x0, 0x0, 0x0, 0x0, 0x0, 0x0, 0x0
.long 0x0, 0x0, 0x0, 0x0, 0x0, 0x0, 0x0, 0x0
.long 0x0, 0x0, 0x0, 0x0, 0x0, 0x0, 0x0, 0x0
.long 0x0, 0x0, 0x0, 0x0, 0xffff0000, 0x0, 0x0, 0x0
.long 0x0, 0x0, 0x0, 0x0, 0x0, 0x0, 0x0, 0x0
.long 0x0, 0x0, 0x0, 0x0, 0x0, 0x0, 0x0, 0x0
.long 0x0, 0x0, 0x0, 0x0, 0x0, 0x0, 0x0, 0x0
.long 0x0, 0x0, 0x0, 0x0, 0x0, 0x0, 0x0, 0x0
.long 0x0, 0x0, 0x0, 0x0, 0x0, 0x0, 0x0, 0x0
.long 0x0, 0x0, 0x0, 0x0, 0x0, 0x0, 0x0, 0x0
.long 0x0, 0x0, 0x0, 0x0, 0x0, 0x0, 0x0, 0x0
.long 0x0, 0x0, 0x0, 0x0, 0x0, 0x0, 0x0, 0x0
.long 0x0, 0x0, 0x0, 0x0, 0x0, 0x0, 0x0, 0x0
.long 0x14d40, 0x14d40, 0x0, 0x0, 0x14e10, 0x14e10, 0x20, 0x20
.long 0x14ee0, 0x14ee0, 0x100000, 0x100000, 0x14fb0, 0x14fb0, 0x100020, 0x100020
.long 0x15080, 0x15080, 0x40, 0x40, 0x15150, 0x15150, 0x60, 0x60
.long 0x15220, 0x15220, 0x100040, 0x100040, 0x100000, 0x100000, 0x100060, 0x100060
.long 0x14d74, 0x14d74, 0x80, 0x80, 0x14e44, 0x14e44, 0xa0, 0xa0
.long 0x14f14, 0x14f14, 0x100080, 0x100080, 0x14fe4, 0x14fe4, 0x1000a0, 0x1000a0
.long 0x150b4, 0x150b4, 0xc0, 0xc0, 0x15184, 0x15184, 0xe0, 0xe0
.long 0x15254, 0x15254, 0x1000c0, 0x1000c0, 0x100000, 0x100000, 0x1000e0, 0x1000e0
.long 0x14da8, 0x14da8, 0x8, 0x100, 0x14e78, 0x14e78, 0x28, 0x120
.long 0x14f48, 0x14f48, 0x100008, 0x100100, 0x15018, 0x15018, 0x100028, 0x100120
.long 0x150e8, 0x150e8, 0x48, 0x140, 0x151b8, 0x151b8, 0x68, 0x160
.long 0x100000, 0x100000, 0x100048, 0x100140, 0x100000, 0x100000, 0x100068, 0x100160
.long 0x14ddc, 0x14ddc, 0x88, 0x180, 0x14eac, 0x14eac, 0xa8, 0x1a0
.long 0x14f7c, 0x14f7c, 0x100088, 0x100180, 0x1504c, 0x1504c, 0x1000a8, 0x1001a0
.long 0x1511c, 0x1511c, 0xc8, 0x1c0, 0x151ec, 0x151ec, 0xe8, 0x1e0
.long 0x100000, 0x100000, 0x1000c8, 0x1001c0, 0x100000, 0x100000, 0x1000e8, 0x1001e0
.long 0x17d40, 0x114d40, 0x100, 0x200, 0x17e10, 0x114e10, 0x120, 0x220
.long 0x17ee0, 0x114ee0, 0x100100, 0x100200, 0x17fb0, 0x114fb0, 0x100120, 0x100220
.long 0x18080, 0x115080, 0x140, 0x240, 0x18150, 0x115150, 0x160, 0x260
.long 0x18220, 0x115220, 0x100140, 0x100240, 0x103000, 0x200000, 0x100160, 0x100260
.long 0x17d74, 0x114d74, 0x180, 0x280, 0x17e44, 0x114e44, 0x1a0, 0x2a0
.long 0x17f14, 0x114f14, 0x100180, 0x100280, 0x17fe4, 0x114fe4, 0x1001a0, 0x1002a0
.long 0x180b4, 0x1150b4, 0x1c0, 0x2c0, 0x18184, 0x115184, 0x1e0, 0x2e0
.long 0x18254, 0x115254, 0x1001c0, 0x1002c0, 0x103000, 0x200000, 0x1001e0, 0x1002e0
.long 0x17da8, 0x114da8, 0x108, 0x300, 0x17e78, 0x114e78, 0x128, 0x320
.long 0x17f48, 0x114f48, 0x100108, 0x100300, 0x18018, 0x115018, 0x100128, 0x100320
.long 0x180e8, 0x1150e8, 0x148, 0x340, 0x181b8, 0x1151b8, 0x168, 0x360
.long 0x103000, 0x200000, 0x100148, 0x100340, 0x103000, 0x200000, 0x100168, 0x100360
.long 0x17ddc, 0x114ddc, 0x188, 0x380, 0x17eac, 0x114eac, 0x1a8, 0x3a0
.long 0x17f7c, 0x114f7c, 0x100188, 0x100380, 0x1804c, 0x11504c, 0x1001a8, 0x1003a0
.long 0x1811c, 0x11511c, 0x1c8, 0x3c0, 0x181ec, 0x1151ec, 0x1e8, 0x3e0
.long 0x103000, 0x200000, 0x1001c8, 0x1003c0, 0x103000, 0x200000, 0x1001e8, 0x1003e0
.long 0xa400, 0xd00, 0x0, 0x14d40, 0xa440, 0xd00, 0x0, 0x14d80
.long 0xa480, 0xd00, 0x1, 0x14dd0, 0xa4c0, 0xd00, 0x1, 0x14e10
.long 0xa500, 0xd00, 0x2, 0x14e60, 0xa540, 0xd00, 0x2, 0x14ea0
.long 0xa580, 0xd00, 0x3, 0x14ef0, 0xa5c0, 0xd00, 0x3, 0x14f30
.long 0xa600, 0xd00, 0x4, 0x14f40, 0xa640, 0xd00, 0x4, 0x14f80
.long 0xa680, 0xd00, 0x5, 0x14fd0, 0xa6c0, 0xd00, 0x5, 0x15010
.long 0xa700, 0xd00, 0x6, 0x15060, 0xa740, 0xd00, 0x6, 0x150a0
.long 0xa780, 0xd00, 0x7, 0x150f0, 0xa7c0, 0xd00, 0x7, 0x15130
.long 0xa800, 0xd00, 0x8, 0x15140, 0xa840, 0xd00, 0x8, 0x15180
.long 0xa880, 0xd00, 0x9, 0x151d0, 0xa8c0, 0xd00, 0x9, 0x15210
.long 0xa900, 0xd00, 0xa, 0x15260, 0xa940, 0xd00, 0xa, 0x152a0
.long 0xa980, 0xd00, 0xb, 0x152f0, 0xa9c0, 0xd00, 0xb, 0x15330
.long 0xaa00, 0xd00, 0xc, 0x15340, 0xaa40, 0xd00, 0xc, 0x15380
.long 0x1f680, 0x40, 0xd, 0x153d0, 0x100000, 0xd00, 0xd, 0x15410
.long 0x100000, 0xd00, 0xe, 0x15460, 0x100000, 0xd00, 0xe, 0x154a0
.long 0x100000, 0xd00, 0xf, 0x154f0, 0x100000, 0xd00, 0xf, 0x15530
.long 0xa400, 0xd00, 0x2, 0x14d60, 0xa440, 0xd00, 0x2, 0x14da0
.long 0xa480, 0xd00, 0x3, 0x14df0, 0xa4c0, 0xd00, 0x3, 0x14e30
.long 0xa500, 0xd00, 0x4, 0x14e40, 0xa540, 0xd00, 0x4, 0x14e80
.long 0xa580, 0xd00, 0x5, 0x14ed0, 0xa5c0, 0xd00, 0x5, 0x14f10
.long 0xa600, 0xd00, 0x6, 0x14f60, 0xa640, 0xd00, 0x6, 0x14fa0
.long 0xa680, 0xd00, 0x7, 0x14ff0, 0xa6c0, 0xd00, 0x7, 0x15030
.long 0xa700, 0xd00, 0x8, 0x15040, 0xa740, 0xd00, 0x8, 0x15080
.long 0xa780, 0xd00, 0x9, 0x150d0, 0xa7c0, 0xd00, 0x9, 0x15110
.long 0xa800, 0xd00, 0xa, 0x15160, 0xa840, 0xd00, 0xa, 0x151a0
.long 0xa880, 0xd00, 0xb, 0x151f0, 0xa8c0, 0xd00, 0xb, 0x15230
.long 0xa900, 0xd00, 0xc, 0x15240, 0xa940, 0xd00, 0xc, 0x15280
.long 0xa980, 0xd00, 0xd, 0x152d0, 0xa9c0, 0xd00, 0xd, 0x15310
.long 0xaa00, 0xd00, 0xe, 0x15360, 0xaa40, 0xd00, 0xe, 0x153a0
.long 0x1f680, 0x40, 0xf, 0x153f0, 0x100000, 0xd00, 0xf, 0x15430
.long 0x100000, 0xd00, 0x10, 0x15440, 0x100000, 0xd00, 0x10, 0x15480
.long 0x100000, 0xd00, 0x11, 0x154d0, 0x100000, 0xd00, 0x11, 0x15510
.long 0x1f690, 0x1f890, 0x1f9c0, 0x1f9e0, 0x1f698, 0x1f898, 0x1f9c8, 0x1f9e8
.long 0x1f680, 0x1f880, 0x1f9d0, 0x1f9f0, 0x1f688, 0x1f888, 0x1f9d8, 0x100000
.long 0x1fd20, 0x1ff20, 0x1f9c2, 0x1f9e2, 0x1fd28, 0x1ff28, 0x1f9ca, 0x1f9ea
.long 0x1fd30, 0x1ff30, 0x1f9d2, 0x1f9f2, 0x1fd38, 0x1ff38, 0x1f9da, 0x100000
.long 0x1f6f0, 0x1f8f0, 0x1f9c4, 0x1f9e4, 0x1f6f8, 0x1f8f8, 0x1f9cc, 0x1f9ec
.long 0x1f6e0, 0x1f8e0, 0x1f9d4, 0x100000, 0x1f6e8, 0x1f8e8, 0x1f9dc, 0x100000
.long 0x1fd40, 0x1ff40, 0x1f9c6, 0x1f9e6, 0x1fd48, 0x1ff48, 0x1f9ce, 0x1f9ee
.long 0x1fd50, 0x1ff50, 0x1f9d6, 0x100000, 0x1fd58, 0x1ff58, 0x1f9de, 0x100000
.long 0x1f710, 0x1f910, 0x1f9c0, 0x1f9e0, 0x1f718, 0x1f918, 0x1f9c8, 0x1f9e8
.long 0x1f700, 0x1f900, 0x1f9d0, 0x1f9f0, 0x1f708, 0x1f908, 0x1f9d8, 0x100000
.long 0x1fda0, 0x1ffa0, 0x1f9c2, 0x1f9e2, 0x1fda8, 0x1ffa8, 0x1f9ca, 0x1f9ea
.long 0x1fdb0, 0x1ffb0, 0x1f9d2, 0x1f9f2, 0x1fdb8, 0x1ffb8, 0x1f9da, 0x100000
.long 0x1f770, 0x1f970, 0x1f9c4, 0x1f9e4, 0x1f778, 0x1f978, 0x1f9cc, 0x1f9ec
.long 0x1f760, 0x1f960, 0x1f9d4, 0x100000, 0x1f768, 0x1f968, 0x1f9dc, 0x100000
.long 0x1fdc0, 0x1ffc0, 0x1f9c6, 0x1f9e6, 0x1fdc8, 0x1ffc8, 0x1f9ce, 0x1f9ee
.long 0x1fdd0, 0x1ffd0, 0x1f9d6, 0x100000, 0x1fdd8, 0x1ffd8, 0x1f9de, 0x100000
.long 0x1f790, 0x1f990, 0x1f9c0, 0x1f9e0, 0x1f798, 0x1f998, 0x1f9c8, 0x1f9e8
.long 0x1f780, 0x1f980, 0x1f9d0, 0x1f9f0, 0x1f788, 0x1f988, 0x1f9d8, 0x100000
.long 0x1fe20, 0x20020, 0x1f9c2, 0x1f9e2, 0x1fe28, 0x20028, 0x1f9ca, 0x1f9ea
.long 0x1fe30, 0x20030, 0x1f9d2, 0x1f9f2, 0x1fe38, 0x20038, 0x1f9da, 0x100000
.long 0x1f7f0, 0x14d00, 0x1f9c4, 0x1f9e4, 0x1f7f8, 0x14d08, 0x1f9cc, 0x1f9ec
.long 0x1f7e0, 0x14d10, 0x1f9d4, 0x100000, 0x1f7e8, 0x14d18, 0x1f9dc, 0x100000
.long 0x1fe40, 0x14d00, 0x1f9c6, 0x1f9e6, 0x1fe48, 0x14d08, 0x1f9ce, 0x1f9ee
.long 0x1fe50, 0x14d10, 0x1f9d6, 0x100000, 0x1fe58, 0x14d18, 0x1f9de, 0x100000
.long 0x1f810, 0x14d00, 0x1f9c0, 0x1f9e0, 0x1f818, 0x14d08, 0x1f9c8, 0x1f9e8
.long 0x1f800, 0x14d10, 0x1f9d0, 0x1f9f0, 0x1f808, 0x14d18, 0x1f9d8, 0x100000
.long 0x1fea0, 0x14d00, 0x1f9c2, 0x1f9e2, 0x1fea8, 0x14d08, 0x1f9ca, 0x1f9ea
.long 0x1feb0, 0x14d10, 0x1f9d2, 0x1f9f2, 0x1feb8, 0x14d18, 0x1f9da, 0x100000
.long 0x1f870, 0x14d00, 0x1f9c4, 0x1f9e4, 0x1f878, 0x14d08, 0x1f9cc, 0x1f9ec
.long 0x1f860, 0x14d10, 0x1f9d4, 0x100000, 0x1f868, 0x14d18, 0x1f9dc, 0x100000
.long 0x1fec0, 0x14d00, 0x1f9c6, 0x1f9e6, 0x1fec8, 0x14d08, 0x1f9ce, 0x1f9ee
.long 0x1fed0, 0x14d10, 0x1f9d6, 0x100000, 0x1fed8, 0x14d18, 0x1f9de, 0x100000
.long 0x0, 0x4444, 0x0, 0xa400, 0x10, 0xeeee, 0x4, 0xa404
.long 0x20, 0x4444, 0x8, 0xa408, 0x30, 0xeeee, 0xc, 0xa40c
.long 0x40, 0x4444, 0x10, 0xa410, 0x50, 0xeeee, 0x14, 0xa414
.long 0x60, 0x4444, 0x18, 0xa418, 0x70, 0xeeee, 0x1c, 0xa41c
.long 0x0, 0x4444, 0x20, 0xa420, 0x10, 0xeeee, 0x24, 0xa424
.long 0x20, 0x4444, 0x28, 0xa428, 0x30, 0xeeee, 0x2c, 0xa42c
.long 0x40, 0x4444, 0x30, 0xa430, 0x50, 0xeeee, 0x34, 0xa434
.long 0x60, 0x4444, 0x38, 0xa438, 0x70, 0xeeee, 0x3c, 0xa43c
.long 0x0, 0x4444, 0x40, 0xa440, 0x10, 0xeeee, 0x44, 0xa444
.long 0x20, 0x4444, 0x48, 0xa448, 0x30, 0xeeee, 0x4c, 0xa44c
.long 0x40, 0x4444, 0x50, 0xa450, 0x50, 0xeeee, 0x54, 0xa454
.long 0x60, 0x4444, 0x58, 0xa458, 0x70, 0xeeee, 0x5c, 0xa45c
.long 0x0, 0x4444, 0x60, 0xa460, 0x10, 0xeeee, 0x64, 0xa464
.long 0x20, 0x4444, 0x68, 0xa468, 0x30, 0xeeee, 0x6c, 0xa46c
.long 0x40, 0x4444, 0x70, 0xa470, 0x50, 0xeeee, 0x74, 0xa474
.long 0x60, 0x4444, 0x78, 0xa478, 0x70, 0xeeee, 0x7c, 0xa47c
.long 0x0, 0x4444, 0x420, 0xb080, 0x10, 0xeeee, 0x424, 0xb084
.long 0x20, 0x4444, 0x428, 0xb088, 0x30, 0xeeee, 0x42c, 0xb08c
.long 0x40, 0x4444, 0x430, 0xb090, 0x50, 0xeeee, 0x434, 0xb094
.long 0x60, 0x4444, 0x438, 0xb098, 0x70, 0xeeee, 0x43c, 0xb09c
.long 0x0, 0x4444, 0x440, 0xb0a0, 0x10, 0xeeee, 0x444, 0xb0a4
.long 0x20, 0x4444, 0x448, 0xb0a8, 0x30, 0xeeee, 0x44c, 0xb0ac
.long 0x40, 0x4444, 0x450, 0xb0b0, 0x50, 0xeeee, 0x454, 0xb0b4
.long 0x60, 0x4444, 0x458, 0xb0b8, 0x70, 0xeeee, 0x45c, 0xb0bc
.long 0x0, 0x4444, 0x460, 0xb0c0, 0x10, 0xeeee, 0x464, 0xb0c4
.long 0x20, 0x4444, 0x468, 0xb0c8, 0x30, 0xeeee, 0x46c, 0xb0cc
.long 0x40, 0x4444, 0x470, 0xb0d0, 0x50, 0xeeee, 0x474, 0xb0d4
.long 0x60, 0x4444, 0x478, 0xb0d8, 0x70, 0xeeee, 0x47c, 0xb0dc
.long 0x0, 0x4444, 0x480, 0xb0e0, 0x10, 0xeeee, 0x484, 0xb0e4
.long 0x20, 0x4444, 0x488, 0xb0e8, 0x30, 0xeeee, 0x48c, 0xb0ec
.long 0x40, 0x4444, 0x490, 0xb0f0, 0x50, 0xeeee, 0x494, 0xb0f4
.long 0x60, 0x4444, 0x498, 0xb0f8, 0x70, 0xeeee, 0x49c, 0xb0fc
.long 0x1fa28, 0x1f9f4, 0x34, 0x14d00, 0x1fa28, 0x1f9f6, 0x74, 0x14d04
.long 0x1fa28, 0x1f9f8, 0xb4, 0x14d08, 0x1fa28, 0x1f9fa, 0xf4, 0x14d0c
.long 0x1fa28, 0x1f9fc, 0x134, 0x14d10, 0x1fa28, 0x1f9fe, 0x174, 0x14d14
.long 0x1fa28, 0x1fa00, 0x1b4, 0x14d18, 0x1fa28, 0x1fa02, 0x1f4, 0x14d1c
.long 0x1fa28, 0x1fa04, 0x234, 0x14d20, 0x1fa28, 0x1fa06, 0x274, 0x14d24
.long 0x1fa28, 0x1fa08, 0x2b4, 0x14d28, 0x1fa28, 0x1fa0a, 0x2f4, 0x14d2c
.long 0x1fa28, 0x1fa0c, 0x334, 0x14d30, 0x1fa28, 0x1fa0e, 0x374, 0x14d34
.long 0x1fa28, 0x1fa10, 0x3b4, 0x14d38, 0x1fa28, 0x1fa12, 0x3f4, 0x14d3c
.long 0x1fa28, 0x1fa14, 0x434, 0x14d00, 0x1fa28, 0x1fa16, 0x474, 0x14d04
.long 0x1fa28, 0x1fa18, 0x4b4, 0x14d08, 0x1fa28, 0x1fa1a, 0x4f4, 0x14d0c
.long 0x1fa28, 0x1fa1c, 0x534, 0x14d10, 0x1fa28, 0x1fa1e, 0x574, 0x14d14
.long 0x1fa28, 0x1fa20, 0x5b4, 0x14d18, 0x1fa28, 0x1fa22, 0x5f4, 0x14d1c
.long 0x1fa28, 0x1fa24, 0x634, 0x14d20, 0x1fa28, 0x1fa26, 0x674, 0x14d24
.long 0x1fa28, 0x1fa28, 0x6b4, 0x14d28, 0x1fa28, 0x1fa2a, 0x6f4, 0x14d2c
.long 0x1fa28, 0x1fa2c, 0x734, 0x14d30, 0x1fa28, 0x1fa2e, 0x774, 0x14d34
.long 0x1fa28, 0x1fa30, 0x7b4, 0x14d38, 0x1fa28, 0x1fa32, 0x7f4, 0x14d3c
.long 0x1fa38, 0x1fa34, 0x834, 0x14d00, 0x1fa38, 0x1fa36, 0x874, 0x14d04
.long 0x1fa38, 0x1fa38, 0x8b4, 0x14d08, 0x1fa38, 0x1fa3a, 0x8f4, 0x14d0c
.long 0x1fa38, 0x1fa3c, 0x934, 0x14d10, 0x1fa38, 0x1fa3e, 0x974, 0x14d14
.long 0x1fa38, 0x1fa40, 0x9b4, 0x14d18, 0x1fa38, 0x1fa42, 0x9f4, 0x14d1c
.long 0x1fa38, 0x1fa44, 0xa34, 0x14d20, 0x1fa38, 0x1fa46, 0xa74, 0x14d24
.long 0x1fa38, 0x1fa48, 0xab4, 0x14d28, 0x1fa38, 0x1fa4a, 0xaf4, 0x14d2c
.long 0x1fa38, 0x1fa4c, 0xb34, 0x14d30, 0x1fa38, 0x1fa4e, 0xb74, 0x14d34
.long 0x1fa38, 0x1fa50, 0xbb4, 0x14d38, 0x1fa38, 0x1fa52, 0xbf4, 0x14d3c
.long 0x1fa38, 0x1fa54, 0xc34, 0x14d00, 0x1fa38, 0x1fa56, 0xc74, 0x14d04
.long 0x1fa38, 0x1fa58, 0xcb4, 0x14d08, 0x1fa38, 0x1fa5a, 0xcf4, 0x14d0c
.long 0x1fa38, 0x1fa5c, 0xd34, 0x14d10, 0x1fa38, 0x1fa5e, 0xd74, 0x14d14
.long 0x1fa38, 0x1fa60, 0xdb4, 0x14d18, 0x1fa38, 0x1fa62, 0xdf4, 0x14d1c
.long 0x1fa38, 0x1fa64, 0xe34, 0x14d20, 0x1fa38, 0x1fa66, 0xe74, 0x14d24
.long 0x1fa38, 0x1fa68, 0xeb4, 0x14d28, 0x1fa38, 0x1fa6a, 0xef4, 0x14d2c
.long 0x1fa38, 0x1fa6c, 0xf34, 0x14d30, 0x1fa38, 0x1fa6e, 0xf74, 0x14d34
.long 0x1fa38, 0x1fa70, 0xfb4, 0x14d38, 0x1fa38, 0x1fa72, 0xff4, 0x14d3c
.long 0x0, 0x0, 0x0, 0x0, 0x0, 0x0, 0x0, 0x0
.long 0x0, 0x0, 0x0, 0x0, 0x0, 0x0, 0x0, 0x0
.long 0x0, 0x0, 0x0, 0x0, 0x0, 0x0, 0x0, 0x0
.long 0x0, 0x0, 0x0, 0x0, 0x0, 0x0, 0x0, 0x0
.long 0x0, 0x0, 0x0, 0x0, 0x0, 0x0, 0x0, 0x0
.long 0x0, 0x0, 0x0, 0x0, 0x0, 0x0, 0x0, 0x0
.long 0x0, 0x0, 0x0, 0x0, 0x0, 0x0, 0x0, 0x0
.long 0x0, 0x0, 0x0, 0x0, 0x0, 0x0, 0x0, 0x0
.long 0x0, 0x0, 0x0, 0x0, 0x0, 0x0, 0x0, 0x0
.long 0x0, 0x0, 0x0, 0x0, 0x0, 0x0, 0x0, 0x0
.long 0x0, 0x0, 0x0, 0x0, 0x0, 0x0, 0x0, 0x0
.long 0x0, 0x0, 0x0, 0x0, 0x0, 0x0, 0x0, 0x0
.long 0x0, 0x0, 0x0, 0x0, 0x0, 0x0, 0x0, 0x0
.long 0x0, 0x0, 0x0, 0x0, 0x0, 0x0, 0x0, 0x0
.long 0x0, 0x0, 0x0, 0x0, 0x0, 0x0, 0x0, 0x0
.long 0x0, 0x0, 0x0, 0x0, 0x0, 0x0, 0x0, 0x0
.long 0x0, 0x0, 0x0, 0x0, 0x0, 0x0, 0x0, 0x0
.long 0x0, 0x0, 0x0, 0x0, 0x0, 0x0, 0x0, 0x0
.long 0x0, 0x0, 0x0, 0x0, 0x0, 0x0, 0x0, 0x0
.long 0x0, 0x0, 0x0, 0x0, 0x0, 0x0, 0x0, 0x0
.long 0x0, 0x0, 0x0, 0x0, 0x0, 0x0, 0x0, 0x0
.long 0x0, 0x0, 0x0, 0x0, 0x0, 0x0, 0x0, 0x0
.long 0x0, 0x0, 0x0, 0x0, 0x0, 0x0, 0x0, 0x0
.long 0x0, 0x0, 0x0, 0x0, 0x0, 0x0, 0x0, 0x0
.long 0x0, 0x0, 0x0, 0x0, 0x0, 0x0, 0x0, 0x0
.long 0x0, 0x0, 0x0, 0x0, 0x0, 0x0, 0x0, 0x0
.long 0x0, 0x0, 0x0, 0x0, 0x0, 0x0, 0x0, 0x0
.long 0x0, 0x0, 0x0, 0x0, 0x0, 0x0, 0x0, 0x0
.long 0x0, 0x0, 0x0, 0x0, 0x0, 0x0, 0x0, 0x0
.long 0x0, 0x0, 0x0, 0x0, 0x0, 0x0, 0x0, 0x0
.long 0x0, 0x0, 0x0, 0x0, 0x0, 0x0, 0x0, 0x0
.long 0x0, 0x0, 0x0, 0x0, 0x0, 0x0, 0x0, 0x0
.long 0x13320, 0xa9b0, 0xa800, 0x10c00, 0xf320, 0xc120, 0x133b0, 0xb690
.long 0xa890, 0x11920, 0xf3b0, 0xce00, 0x12600, 0xa920, 0xb520, 0x10c90
.long 0xe600, 0xc090, 0x12690, 0xb600, 0xb5b0, 0x119b0, 0xe690, 0xcdb0
.long 0xd5f0, 0x11440, 0x117f0, 0x130d0, 0xf8d0, 0xadf0, 0xd640, 0x12160
.long 0x11840, 0x13df0, 0xf960, 0xbad0, 0xc8d0, 0x113f0, 0x124d0, 0x13160
.long 0xebf0, 0xad60, 0xc960, 0x120d0, 0x12560, 0x13e40, 0xec40, 0xba40
.long 0xefb0, 0x10ed0, 0x117b0, 0x12a40, 0xfa90, 0xdb60, 0xc890, 0x10d60
.long 0x10a90, 0x129f0, 0x13bb0, 0xddf0, 0xf000, 0x11bf0, 0x11520, 0xe960
.long 0xc160, 0xf9b0, 0xc920, 0x11a40, 0x10800, 0xe8d0, 0xc3f0, 0x13a90
.long 0xce40, 0xfa00, 0xfff0, 0xbb20, 0xedb0, 0xdad0, 0xced0, 0x10720
.long 0x10040, 0xc800, 0x14890, 0xde40, 0xf560, 0xfbb0, 0x140d0, 0xbdb0
.long 0xb3f0, 0xec00, 0xf5f0, 0x10890, 0x14160, 0xca90, 0xb760, 0x14720
.long 0x13520, 0xddb0, 0xa520, 0xbe00, 0xf490, 0xe800, 0x13690, 0x10490
.long 0xa5b0, 0xcb20, 0xe7b0, 0x14d00, 0x12800, 0xdd20, 0xb200, 0xbe90
.long 0xf800, 0x14320, 0x129b0, 0x10400, 0xb290, 0xcbb0, 0xeb20, 0x14290
.long 0xd560, 0x10760, 0x112d0, 0xaed0, 0xfb60, 0xeed0, 0xd3f0, 0xe040
.long 0x11360, 0xbbf0, 0xee40, 0x14d00, 0xc840, 0x106d0, 0x11ff0, 0xaf60
.long 0xfed0, 0x149f0, 0xc6d0, 0xdff0, 0x12040, 0xbc40, 0xf1f0, 0x14960
.long 0xbbb0, 0x10cd0, 0xfdb0, 0x12960, 0xd3b0, 0xd9f0, 0x13090, 0x11160
.long 0x13e90, 0x12bf0, 0xbff0, 0xd290, 0xbc00, 0x119f0, 0xfb20, 0xe840
.long 0xac90, 0xd840, 0x13120, 0x11e40, 0x13c00, 0xead0, 0xbe40, 0xabb0
.long 0xcf60, 0x11400, 0x101f0, 0xef20, 0x12e90, 0xdd60, 0xccd0, 0xd320
.long 0x10560, 0x14a00, 0xb640, 0x12d20, 0xf640, 0x115b0, 0x142d0, 0xf1b0
.long 0x121b0, 0xdcd0, 0xf3f0, 0xd490, 0x14640, 0x14c90, 0xb5f0, 0x12000
.long 0x13600, 0xf7b0, 0xa490, 0xb120, 0x10d20, 0xc200, 0x135b0, 0xea90
.long 0xa400, 0x14d00, 0x10db0, 0xcf20, 0x12920, 0xf720, 0xaa00, 0x14000
.long 0x11a00, 0xc290, 0x12890, 0xea00, 0xb720, 0x14090, 0x11a90, 0xcfb0
.long 0xd4d0, 0xfa40, 0x11760, 0x123f0, 0x12cd0, 0xaff0, 0xd440, 0xed60
.long 0x116d0, 0x14d00, 0x12d60, 0xbcd0, 0xc7f0, 0xf9f0, 0x118d0, 0x14ad0
.long 0x139f0, 0xb040, 0xc760, 0xecd0, 0x125f0, 0x14b60, 0x13a40, 0xbd60
.long 0xe290, 0x10e40, 0xc9b0, 0x12760, 0xfe00, 0x13640, 0x10df0, 0xd5b0
.long 0xf090, 0x128d0, 0x13f20, 0x138d0, 0xe320, 0x11b60, 0x12640, 0xafb0
.long 0xfe90, 0x14360, 0x11ad0, 0xd600, 0xe560, 0xad20, 0x13fb0, 0x145f0
.long 0xe000, 0xcd60, 0x10920, 0x102d0, 0xa6d0, 0xebb0, 0xd040, 0x12e00
.long 0xfc00, 0x10240, 0xaa40, 0x14690, 0xe1b0, 0xf440, 0x103f0, 0x12320
.long 0xe7f0, 0xee00, 0xf760, 0x12fb0, 0x144d0, 0x125b0, 0xeb60, 0x14920
.long 0x13720, 0x111b0, 0xdb20, 0xf400, 0x11090, 0x11d20, 0x137b0, 0x11e90
.long 0xda90, 0xe720, 0x11db0, 0x14d00, 0x12a00, 0x11120, 0x10200, 0xf5b0
.long 0x11200, 0x14400, 0x12a90, 0x11e00, 0x101b0, 0xe890, 0x11f20, 0x14490
.long 0xd6d0, 0x12e40, 0x108d0, 0xfc40, 0x13240, 0x13ed0, 0xd760, 0x13b60
.long 0x10840, 0xef60, 0x13f60, 0x14d00, 0xc9f0, 0x12df0, 0xe1f0, 0xfad0
.long 0x132d0, 0x14bf0, 0xca40, 0x13ad0, 0xe160, 0xedf0, 0x13ff0, 0x14c40
.long 0x11690, 0x11040, 0xde90, 0xa640, 0x10b20, 0x136d0, 0x109b0, 0x10ff0
.long 0xa5f0, 0xd1b0, 0x10bb0, 0x143f0, 0x11720, 0x11d60, 0xdf20, 0xb360
.long 0xb000, 0x13360, 0x10a00, 0x11cd0, 0xb2d0, 0xd200, 0xb090, 0x14040
.long 0xcbf0, 0xb920, 0xe400, 0x13560, 0xa560, 0xc490, 0xcc40, 0xc600
.long 0x13840, 0x13200, 0xe640, 0xc720, 0xf2d0, 0xba90, 0xdfb0, 0xc040
.long 0xa8d0, 0x11fb0, 0xf360, 0xc7b0, 0xc360, 0x12db0, 0xe9f0, 0x12200
.long 0x13400, 0xc3b0, 0xdc00, 0x10e00, 0xbfb0, 0xcc00, 0x13490, 0xd090
.long 0xdc90, 0x11b20, 0xcc90, 0x14d00, 0x12720, 0xc320, 0x10320, 0x10fb0
.long 0xc400, 0x14120, 0x127b0, 0xd000, 0x103b0, 0x11c90, 0xd120, 0x141b0
.long 0xd1f0, 0xac40, 0x10ad0, 0x13040, 0xab60, 0xb7f0, 0xd240, 0xb960
.long 0x10b60, 0x13d60, 0xb840, 0x14d00, 0xc4d0, 0xabf0, 0xe3f0, 0x12ed0
.long 0xb0d0, 0x146d0, 0xc560, 0xb8d0, 0xe440, 0x13bf0, 0xbdf0, 0x14760
.long 0xfc90, 0x10f60, 0x11290, 0xa840, 0x13d20, 0x104d0, 0x13db0, 0x111f0
.long 0x105b0, 0xa7f0, 0x13c90, 0xf7f0, 0xfd20, 0x11c40, 0x11320, 0xb560
.long 0xae00, 0xff60, 0x13e00, 0x11ed0, 0x10600, 0xb4d0, 0xadb0, 0xf240
.long 0xcdf0, 0xed20, 0x133f0, 0xbd20, 0x12c40, 0x14bb0, 0xd160, 0x14800
.long 0x13440, 0xca00, 0x11f60, 0x14b20, 0xf4d0, 0xee90, 0xbed0, 0xb890
.long 0x12ad0, 0x12490, 0xf840, 0x149b0, 0xbf60, 0xc5b0, 0x11df0, 0x12400
.long 0x12bb0, 0x13800, 0xd920, 0xc000, 0x14600, 0x14d00, 0x13890, 0x14d00
.long 0xd9b0, 0xcd20, 0xc5f0, 0x14d00, 0x13920, 0x145b0, 0x10000, 0xc1b0
.long 0xb1b0, 0x14d00, 0x12c00, 0x14520, 0x10090, 0xce90, 0xfbf0, 0x14d00
.long 0xc640, 0xd2d0, 0x105f0, 0xae40, 0x14cd0, 0x14d00, 0xd360, 0x14d00
.long 0x10640, 0xbb60, 0xbf20, 0x14d00, 0xd7f0, 0x14840, 0xded0, 0xacd0
.long 0x10290, 0x14d00, 0xcad0, 0x147f0, 0xdf60, 0xb9f0, 0x11000, 0x14d00
.long 0x14a90, 0x11240, 0xf890, 0xa760, 0x14d00, 0xaad0, 0x123b0, 0x110d0
.long 0x139b0, 0xa9f0, 0x14d00, 0x12b20, 0x10c40, 0xae90, 0xf920, 0xb440
.long 0xe0d0, 0x14d00, 0x11960, 0xaf20, 0x13a00, 0xb6d0, 0x131f0, 0x14d00
.long 0x13b20, 0xd0d0, 0x135f0, 0xf120, 0x14d00, 0x12440, 0xac00, 0xcb60
.long 0x13960, 0x14c00, 0xf520, 0x14d00, 0xcff0, 0x12120, 0xc0d0, 0xec90
.long 0xda40, 0xe090, 0xf6d0, 0x12290, 0xc440, 0x147b0, 0x14d00, 0x14d00
.long 0xa600, 0xd800, 0xdbb0, 0x10120, 0x0, 0x0, 0xa7b0, 0xff20
.long 0xda00, 0x14d00, 0x0, 0x0, 0xb320, 0xd890, 0xde00, 0x14200
.long 0x0, 0x0, 0xb490, 0xffb0, 0x10520, 0x143b0, 0x0, 0x0
.long 0x11640, 0x109f0, 0x107f0, 0xe240, 0x0, 0x0, 0x114d0, 0xe2d0
.long 0x10960, 0x14d00, 0x0, 0x0, 0x12360, 0x10a40, 0x10bf0, 0x14a40
.long 0x0, 0x0, 0x121f0, 0xe360, 0xe4d0, 0x148d0, 0x0, 0x0
.long 0xbc90, 0x126d0, 0x12c90, 0xa960, 0x0, 0x0, 0x131b0, 0x12b60
.long 0xb7b0, 0xa4d0, 0x0, 0x0, 0xba00, 0xe5f0, 0xa440, 0xaa90
.long 0x0, 0x0, 0x12f20, 0xea40, 0xb160, 0xab20, 0x0, 0x0
.long 0x10360, 0x11600, 0xd720, 0x134d0, 0x0, 0x0, 0x100d0, 0xd520
.long 0x11800, 0x13760, 0x0, 0x0, 0x14440, 0x11890, 0x137f0, 0x12520
.long 0x0, 0x0, 0x141f0, 0xd7b0, 0xc2d0, 0x12090, 0x0, 0x0
.long 0xa720, 0xf200, 0xf600, 0x10f20, 0x0, 0x0, 0xa690, 0xe520
.long 0xf690, 0x11c00, 0x0, 0x0, 0xb400, 0xf290, 0xe920, 0x10e90
.long 0x0, 0x0, 0xb3b0, 0xe5b0, 0xe9b0, 0x11bb0, 0x0, 0x0
.long 0x115f0, 0xfcd0, 0xfdf0, 0x12ff0, 0x0, 0x0, 0x11560, 0xeff0
.long 0xfe40, 0x13cd0, 0x0, 0x0, 0x122d0, 0xfd60, 0xf0d0, 0x12f60
.long 0x0, 0x0, 0x12240, 0xf040, 0xf160, 0x13c40, 0x0, 0x0
.long 0xe3b0, 0x12840, 0x11490, 0xdc40, 0x0, 0x0, 0x127f0, 0xd690
.long 0x107b0, 0xdbf0, 0x0, 0x0, 0xe120, 0xe760, 0xc240, 0x113b0
.long 0x0, 0x0, 0xe6d0, 0xd400, 0xc1f0, 0x10690, 0x0, 0x0
.long 0xe200, 0x10160, 0xb9b0, 0xd8d0, 0x0, 0x0, 0x10440, 0x13000
.long 0xc690, 0xd960, 0x0, 0x0, 0xe490, 0x14240, 0xb1f0, 0xb800
.long 0x0, 0x0, 0x14560, 0x13290, 0xb240, 0xc520, 0x0, 0x0
.long 0x0, 0x0, 0x0, 0x0, 0x0, 0x0, 0x0, 0x0
.long 0x0, 0x0, 0x0, 0x0, 0x0, 0x0, 0x0, 0x0
.long 0x0, 0x0, 0x0, 0x0, 0x0, 0x0, 0x0, 0x0
.long 0x0, 0x0, 0x0, 0x0, 0x0, 0x0, 0x0, 0x0
.long 0x0, 0x0, 0x0, 0x0, 0x0, 0x0, 0x0, 0x0
.long 0x0, 0x0, 0x0, 0x0, 0x0, 0x0, 0x0, 0x0
.long 0x0, 0x0, 0x0, 0x0, 0x0, 0x0, 0x0, 0x0
.long 0x0, 0x0, 0x0, 0x0, 0x0, 0x0, 0x0, 0x0
.long 0x0, 0x0, 0x0, 0x0, 0x0, 0x0, 0x0, 0x0
.long 0x0, 0x0, 0x0, 0x0, 0x0, 0x0, 0x0, 0x0
.long 0x0, 0x0, 0x0, 0x0, 0x0, 0x0, 0x0, 0x0
.long 0x0, 0x0, 0x0, 0x0, 0x0, 0x0, 0x0, 0x0
.long 0x0, 0x0, 0x0, 0x0, 0x0, 0x0, 0x0, 0x0
.long 0x0, 0x0, 0x0, 0x0, 0x0, 0x0, 0x0, 0x0
.long 0x0, 0x0, 0x0, 0x0, 0x0, 0x0, 0x0, 0x0
.long 0x0, 0x0, 0x0, 0x0, 0x0, 0x0, 0x0, 0x0
.long 0x0, 0x0, 0x0, 0x0, 0x0, 0x0, 0x0, 0x0
.long 0x0, 0x0, 0x0, 0x0, 0x0, 0x0, 0x0, 0x0
.long 0x0, 0x0, 0x0, 0x0, 0x0, 0x0, 0x0, 0x0
.long 0x0, 0x0, 0x0, 0x0, 0x0, 0x0, 0x0, 0x0
.long 0x0, 0x0, 0x0, 0x0, 0x0, 0x0, 0x0, 0x0
.long 0x0, 0x0, 0x0, 0x0, 0x0, 0x0, 0x0, 0x0
.long 0x0, 0x0, 0x0, 0x0, 0x0, 0x0, 0x0, 0x0
.long 0x0, 0x0, 0x0, 0x0, 0x0, 0x0, 0x0, 0x0
.long 0x0, 0x0, 0x0, 0x0, 0x0, 0x0, 0x0, 0x0
.long 0x0, 0x0, 0x0, 0x0, 0x0, 0x0, 0x0, 0x0
.long 0x0, 0x0, 0x0, 0x0, 0x0, 0x0, 0x0, 0x0
.long 0x0, 0x0, 0x0, 0x0, 0x0, 0x0, 0x0, 0x0
.long 0x0, 0x0, 0x0, 0x0, 0x0, 0x0, 0x0, 0x0
.long 0x0, 0x0, 0x0, 0x0, 0x0, 0x0, 0x0, 0x0
.long 0x0, 0x0, 0x0, 0x0, 0x0, 0x0, 0x0, 0x0
.long 0x0, 0x0, 0x0, 0x0, 0x0, 0x0, 0x0, 0x0
.section .rodata,"a"
.p2align 6
.amdhsa_kernel standalone__deep_cross_xdeepfm__recsys_kernel
  .amdhsa_next_free_vgpr 256
  .amdhsa_next_free_sgpr 102
  .amdhsa_accum_offset 256
  .amdhsa_group_segment_fixed_size 0
  .amdhsa_kernarg_size 88
  .amdhsa_user_sgpr_count 2
  .amdhsa_user_sgpr_kernarg_segment_ptr 1
  .amdhsa_system_sgpr_workgroup_id_x 1
  .amdhsa_float_denorm_mode_32 3
.end_amdhsa_kernel
```

```asm
; @launch grid=(256,1,1) block=(512,1,1) lds=163840
.amdgcn_target "amdgcn-amd-amdhsa--gfx950"
.text
.globl standalone__deep_cross_xdeepfm__recsys_kernel
.p2align 8
.type standalone__deep_cross_xdeepfm__recsys_kernel,@function
standalone__deep_cross_xdeepfm__recsys_kernel:
  s_cmp_ge_u32 s2, 256
  s_cbranch_scc1 L_end
  s_load_dwordx16 s[4:19], s[0:1], 0
  s_load_dwordx4 s[20:23], s[0:1], 64
  s_load_dwordx2 s[24:25], s[0:1], 80
  v_lshrrev_b32 v1, 6, v0
  s_getpc_b64 s[92:93]
L_pc:
  s_and_b32 s68, s2, 0xf8
  v_add_u32 v2, s68, v1
  v_and_b32_e64 v3, 32, v0
  v_lshl_add_u32 v2, v3, 3, v2
  v_lshlrev_b32 v2, 7, v2
  v_min_u32 v2, L_end-L_pc, v2
  v_mov_b32 v3, s93
  v_add_co_u32 v2, vcc, s92, v2
  s_nop 1
  v_addc_co_u32 v3, vcc, 0, v3, vcc
  global_load_dword v251, v[2:3], off
  v_and_b32 v0, 63, v0
  v_readfirstlane_b32 s3, v1
  s_and_b32 s68, s2, 7
  s_lshr_b32 s69, s2, 3
  s_xor_b32 s69, s69, 31
  s_and_b32 s80, s2, 0xf8
  s_add_u32 s80, s80, s3
  s_lshl_b32 s80, s80, 0
  s_min_u32 s70, s68, 1
  s_add_u32 s71, s69, s70
  s_cmp_ge_u32 s71, 22
  s_cbranch_scc1 L_cin
  s_mul_i32 s68, s68, 21
  s_add_u32 s68, s68, s71
  s_mul_i32 s26, s68, 5042
  s_lshr_b32 s26, s26, 16
  s_mul_i32 s69, s26, 13
  s_sub_u32 s27, s68, s69
  s_lshl_b32 s77, s27, 8
  s_mul_i32 s71, s26, 320
  v_lshrrev_b32 v116, 4, v0
  v_lshlrev_b32 v11, 4, v0
  s_and_b32 s79, s3, 3
  s_cmp_ge_u32 s3, 4
  s_cbranch_scc1 L_ld
  s_mul_i32 s70, s3, 13
  v_min_u32 v118, 12, v0
  v_add_u32 v118, s70, v118
  v_lshrrev_b32 v117, 1, v118
  v_mul_u32_u24 v117, 96, v117
  v_lshl_add_u32 v118, v118, 2, v117
  s_mul_i32 s78, s27, 25
  s_min_u32 s78, s78, 294
  s_add_u32 s78, s78, s71
  s_mul_i32 s78, s78, 104
  s_lshl_b32 s70, s26, 2
  s_add_u32 s70, s70, s3
  s_add_u32 s70, s70, 64
  s_mul_i32 s70, s70, 3328
  s_add_u32 s70, s70, s77
  s_mov_b32 s81, 173056
  v_lshrrev_b32 v112, 1, v0
  v_mul_lo_u32 v112, s81, v112
  v_and_b32 v117, 1, v0
  v_lshl_add_u32 v112, v117, 7, v112
  v_add_u32_e64 v112, s70, v112
  s_waitcnt lgkmcnt(0)
  s_mov_b32 s28, s4
  s_and_b32 s29, s5, 0xffff
  s_mov_b32 s30, 425984
  s_mov_b32 s31, 0x20000
  buffer_load_dwordx4 v[100:103], v118, s[28:31], s78 offen
  s_mov_b32 s32, s6
  s_and_b32 s33, s7, 0xffff
  s_mov_b32 s34, 12800000
  s_mov_b32 s35, 0x20000
  s_mov_b32 s48, s14
  s_and_b32 s49, s15, 0xffff
  s_mov_b32 s50, 3328
  s_mov_b32 s51, 0x20000
  s_mov_b32 m0, 122880
  s_mov_b64 exec, 0xffff
  buffer_load_dwordx4 v11, s[48:51], s77 offen lds
  s_mov_b64 exec, -1
  s_mov_b32 s44, s12
  s_and_b32 s45, s13, 0xffff
  s_mov_b32 s46, 5537792
  s_mov_b32 s47, 0x20000
  s_mov_b64 exec, 255
  buffer_load_dword v209, v112, s[44:47], 0 offen
  s_mov_b64 exec, -1
  s_barrier
  s_branch L_cmp
L_ld:
  s_lshr_b32 s68, s79, 1
  s_mul_i32 s68, s68, 20
  s_and_b32 s69, s79, 1
  s_add_u32 s68, s68, s69
  s_lshl_b32 s76, s68, 10
  s_mul_i32 s78, s71, 104
  s_mul_i32 s68, s68, 832
  s_add_u32 s94, s78, s68
  v_mul_u32_u24 v118, 48, v116
  v_sub_u32 v12, v11, v118
  s_add_u32 s95, s94, 3328
  s_add_u32 s96, s94, 6656
  s_add_u32 s97, s94, 9984
  s_add_u32 s98, s94, 13312
  s_and_b32 s70, s79, 1
  s_lshl_b32 s70, s70, 3
  v_lshlrev_b32 v117, 1, v116
  v_or_b32 v117, s70, v117
  v_xor_b32 v117, v117, v0
  v_and_b32 v117, 15, v117
  v_mul_u32_u24 v4, 3328, v116
  v_lshl_add_u32 v4, v117, 4, v4
  v_add_u32 v5, 13312, v4
  s_mul_i32 s74, s79, 26624
  s_add_u32 s74, s74, s77
  s_lshl_b32 s75, s79, 11
  s_waitcnt lgkmcnt(0)
  s_mov_b32 s28, s4
  s_and_b32 s29, s5, 0xffff
  s_mov_b32 s30, 425984
  s_mov_b32 s31, 0x20000
  buffer_load_dwordx4 v[16:19], v12, s[28:31], s94 offen offset:0
  s_mov_b32 s32, s6
  s_and_b32 s33, s7, 0xffff
  s_mov_b32 s34, 12800000
  s_mov_b32 s35, 0x20000
  s_mov_b32 s44, s12
  s_and_b32 s45, s13, 0xffff
  s_mov_b32 s46, 5537792
  s_mov_b32 s47, 0x20000
  s_add_u32 m0, s75, 131072
  s_nop 0
  buffer_load_dwordx4 v4, s[44:47], s74 offen lds
  s_add_u32 m0, s75, 132096
  s_nop 0
  buffer_load_dwordx4 v5, s[44:47], s74 offen lds
  s_add_u32 s74, s74, 106496
  s_add_u32 m0, s75, 139264
  s_nop 0
  buffer_load_dwordx4 v4, s[44:47], s74 offen lds
  s_add_u32 m0, s75, 140288
  s_nop 0
  buffer_load_dwordx4 v5, s[44:47], s74 offen lds
  s_add_u32 s74, s74, 106496
  s_barrier
  buffer_load_dwordx4 v[20:23], v12, s[28:31], s94 offen offset:1664
  buffer_load_dwordx4 v[24:27], v12, s[28:31], s95 offen offset:0
  buffer_load_dwordx4 v[28:31], v12, s[28:31], s95 offen offset:1664
  buffer_load_dwordx4 v[32:35], v12, s[28:31], s96 offen offset:0
  buffer_load_dwordx4 v[36:39], v12, s[28:31], s96 offen offset:1664
  buffer_load_dwordx4 v[40:43], v12, s[28:31], s97 offen offset:0
  buffer_load_dwordx4 v[44:47], v12, s[28:31], s97 offen offset:1664
  buffer_load_dwordx4 v[48:51], v12, s[28:31], s98 offen offset:0
  buffer_load_dwordx4 v[52:55], v12, s[28:31], s98 offen offset:1664
  s_lshl_b32 s70, s69, 6
  v_and_b32 v118, 7, v0
  v_xor_b32 v118, v118, v116
  v_lshlrev_b32 v118, 4, v118
  v_xor_b32 v2, s70, v118
  v_xor_b32 v3, 64, v2
  s_mov_b32 s72, 0
  s_mul_i32 s70, s79, 13
  s_add_u32 s70, s70, s27
  s_min_u32 s70, s70, 39
  s_lshl_b32 s70, s70, 3
  s_add_u32 s70, s70, s71
  s_mul_i32 s84, s70, 104
  v_lshrrev_b32 v118, 2, v0
  v_min_u32 v118, 7, v118
  v_mul_u32_u24 v118, 104, v118
  v_and_b32 v117, 3, v0
  v_lshl_add_u32 v7, v117, 2, v118
  s_lshl_b32 s70, s26, 2
  s_add_u32 s70, s70, s79
  s_add_u32 s70, s70, 256
  s_mul_i32 s85, s70, 3328
  s_add_u32 s85, s85, s77
  s_mov_b32 s70, 173056
  v_lshrrev_b32 v118, 1, v0
  v_mul_lo_u32 v118, s70, v118
  v_and_b32 v117, 1, v0
  v_lshl_add_u32 v84, v117, 7, v118
  s_mov_b32 s52, s16
  s_and_b32 s53, s17, 0xffff
  s_mov_b32 s54, 3328
  s_mov_b32 s55, 0x20000
  s_mul_i32 s70, s79, 2560
  s_add_u32 s70, s70, L_tail-L_pc
  v_lshlrev_b32 v8, 7, v0
  v_add_u32 v8, s70, v8
  v_mov_b32 v9, s93
  v_add_co_u32 v8, vcc, s92, v8
  s_nop 1
  v_addc_co_u32 v9, vcc, 0, v9, vcc
  s_waitcnt vmcnt(13)
  v_lshlrev_b32 v16, 7, v16
  v_lshlrev_b32 v18, 7, v18
  v_lshlrev_b32 v17, 7, v17
  v_lshlrev_b32 v19, 7, v19
  v_add_u32_dpp v56, v16, v2 row_newbcast:0 row_mask:0xf bank_mask:0x3
  s_nop 1
  v_add_u32_dpp v56, v18, v2 row_newbcast:6 row_mask:0xf bank_mask:0xc
  s_add_u32 m0, s76, 0
  s_nop 0
  buffer_load_dwordx4 v56, s[32:35], 0 offen lds
  s_waitcnt vmcnt(10)
  s_barrier
  s_waitcnt vmcnt(9)
  v_lshlrev_b32 v20, 7, v20
  v_lshlrev_b32 v22, 7, v22
  v_lshlrev_b32 v21, 7, v21
  v_lshlrev_b32 v23, 7, v23
  v_add_u32_dpp v57, v20, v2 row_newbcast:0 row_mask:0xf bank_mask:0x3
  s_nop 1
  v_add_u32_dpp v57, v22, v2 row_newbcast:6 row_mask:0xf bank_mask:0xc
  s_add_u32 m0, s76, 2048
  s_nop 0
  buffer_load_dwordx4 v57, s[32:35], 0 offen lds
  s_waitcnt vmcnt(9)
  v_lshlrev_b32 v24, 7, v24
  v_lshlrev_b32 v26, 7, v26
  v_lshlrev_b32 v25, 7, v25
  v_lshlrev_b32 v27, 7, v27
  v_add_u32_dpp v58, v24, v2 row_newbcast:0 row_mask:0xf bank_mask:0x3
  s_nop 1
  v_add_u32_dpp v58, v26, v2 row_newbcast:6 row_mask:0xf bank_mask:0xc
  s_add_u32 m0, s76, 4096
  s_nop 0
  buffer_load_dwordx4 v58, s[32:35], 0 offen lds
  s_waitcnt vmcnt(9)
  v_lshlrev_b32 v28, 7, v28
  v_lshlrev_b32 v30, 7, v30
  v_lshlrev_b32 v29, 7, v29
  v_lshlrev_b32 v31, 7, v31
  v_add_u32_dpp v59, v28, v2 row_newbcast:0 row_mask:0xf bank_mask:0x3
  s_nop 1
  v_add_u32_dpp v59, v30, v2 row_newbcast:6 row_mask:0xf bank_mask:0xc
  s_add_u32 m0, s76, 6144
  s_nop 0
  buffer_load_dwordx4 v59, s[32:35], 0 offen lds
  s_waitcnt vmcnt(9)
  v_lshlrev_b32 v32, 7, v32
  v_lshlrev_b32 v34, 7, v34
  v_lshlrev_b32 v33, 7, v33
  v_lshlrev_b32 v35, 7, v35
  v_add_u32_dpp v60, v32, v2 row_newbcast:0 row_mask:0xf bank_mask:0x3
  s_nop 1
  v_add_u32_dpp v60, v34, v2 row_newbcast:6 row_mask:0xf bank_mask:0xc
  s_add_u32 m0, s76, 8192
  s_nop 0
  buffer_load_dwordx4 v60, s[32:35], 0 offen lds
  s_waitcnt vmcnt(9)
  v_lshlrev_b32 v36, 7, v36
  v_lshlrev_b32 v38, 7, v38
  v_lshlrev_b32 v37, 7, v37
  v_lshlrev_b32_e64 v39, 7, v39
  v_add_u32_dpp v61, v36, v2 row_newbcast:0 row_mask:0xf bank_mask:0x3
  s_nop 1
  v_add_u32_dpp v61, v38, v2 row_newbcast:6 row_mask:0xf bank_mask:0xc
  s_add_u32 m0, s76, 10240
  s_nop 0
  buffer_load_dwordx4 v61, s[32:35], 0 offen lds
  s_waitcnt vmcnt(9)
  v_lshlrev_b32 v40, 7, v40
  v_lshlrev_b32 v42, 7, v42
  v_lshlrev_b32 v41, 7, v41
  v_lshlrev_b32_e64 v43, 7, v43
  v_add_u32_dpp v62, v40, v2 row_newbcast:0 row_mask:0xf bank_mask:0x3
  s_nop 1
  v_add_u32_dpp v62, v42, v2 row_newbcast:6 row_mask:0xf bank_mask:0xc
  s_add_u32 m0, s76, 12288
  s_nop 0
  buffer_load_dwordx4 v62, s[32:35], 0 offen lds
  s_waitcnt vmcnt(9)
  v_lshlrev_b32 v44, 7, v44
  v_lshlrev_b32 v46, 7, v46
  v_lshlrev_b32 v45, 7, v45
  v_lshlrev_b32_e64 v47, 7, v47
  v_add_u32_dpp v63, v44, v2 row_newbcast:0 row_mask:0xf bank_mask:0x3
  s_nop 1
  v_add_u32_dpp v63, v46, v2 row_newbcast:6 row_mask:0xf bank_mask:0xc
  s_add_u32 m0, s76, 14336
  s_nop 0
  buffer_load_dwordx4 v63, s[32:35], 0 offen lds
  s_waitcnt vmcnt(9)
  v_lshlrev_b32 v48, 7, v48
  v_lshlrev_b32 v50, 7, v50
  v_lshlrev_b32 v49, 7, v49
  v_lshlrev_b32_e64 v51, 7, v51
  v_add_u32_dpp v64, v48, v2 row_newbcast:0 row_mask:0xf bank_mask:0x3
  s_nop 1
  v_add_u32_dpp v64, v50, v2 row_newbcast:6 row_mask:0xf bank_mask:0xc
  s_add_u32 m0, s76, 16384
  s_nop 0
  buffer_load_dwordx4 v64, s[32:35], 0 offen lds
  s_waitcnt vmcnt(9)
  v_lshlrev_b32 v52, 7, v52
  v_lshlrev_b32 v54, 7, v54
  v_lshlrev_b32 v53, 7, v53
  v_lshlrev_b32_e64 v55, 7, v55
  v_add_u32_dpp v65, v52, v2 row_newbcast:0 row_mask:0xf bank_mask:0x3
  s_nop 1
  v_add_u32_dpp v65, v54, v2 row_newbcast:6 row_mask:0xf bank_mask:0xc
  s_add_u32 m0, s76, 18432
  s_nop 0
  buffer_load_dwordx4 v65, s[32:35], 0 offen lds
  v_add_u32_dpp v56, v17, v2 row_newbcast:0 row_mask:0xf bank_mask:0x3
  s_nop 1
  v_add_u32_dpp v56, v19, v2 row_newbcast:6 row_mask:0xf bank_mask:0xc
  s_add_u32 m0, s76, 40960
  s_nop 0
  buffer_load_dwordx4 v56, s[32:35], 0 offen lds
  v_add_u32_dpp v57, v21, v2 row_newbcast:0 row_mask:0xf bank_mask:0x3
  s_nop 1
  v_add_u32_dpp v57, v23, v2 row_newbcast:6 row_mask:0xf bank_mask:0xc
  s_add_u32 m0, s76, 43008
  s_nop 0
  buffer_load_dwordx4 v57, s[32:35], 0 offen lds
  v_add_u32_dpp v58, v25, v2 row_newbcast:0 row_mask:0xf bank_mask:0x3
  s_nop 1
  v_add_u32_dpp v58, v27, v2 row_newbcast:6 row_mask:0xf bank_mask:0xc
  s_add_u32 m0, s76, 45056
  s_nop 0
  buffer_load_dwordx4 v58, s[32:35], 0 offen lds
  v_add_u32_dpp v59, v29, v2 row_newbcast:0 row_mask:0xf bank_mask:0x3
  s_nop 1
  v_add_u32_dpp v59, v31, v2 row_newbcast:6 row_mask:0xf bank_mask:0xc
  s_add_u32 m0, s76, 47104
  s_nop 0
  buffer_load_dwordx4 v59, s[32:35], 0 offen lds
  v_add_u32_dpp v60, v33, v2 row_newbcast:0 row_mask:0xf bank_mask:0x3
  s_nop 1
  v_add_u32_dpp v60, v35, v2 row_newbcast:6 row_mask:0xf bank_mask:0xc
  s_add_u32 m0, s76, 49152
  s_nop 0
  buffer_load_dwordx4 v60, s[32:35], 0 offen lds
  s_waitcnt vmcnt(11)
  s_barrier
  v_add_u32_dpp v61, v37, v2 row_newbcast:0 row_mask:0xf bank_mask:0x3
  s_nop 1
  v_add_u32_dpp v61, v39, v2 row_newbcast:6 row_mask:0xf bank_mask:0xc
  s_add_u32 m0, s76, 51200
  s_nop 0
  buffer_load_dwordx4 v61, s[32:35], 0 offen lds
  v_add_u32_dpp v62, v41, v2 row_newbcast:0 row_mask:0xf bank_mask:0x3
  s_nop 1
  v_add_u32_dpp v62, v43, v2 row_newbcast:6 row_mask:0xf bank_mask:0xc
  s_add_u32 m0, s76, 53248
  s_nop 0
  buffer_load_dwordx4 v62, s[32:35], 0 offen lds
  v_add_u32_dpp v63, v45, v2 row_newbcast:0 row_mask:0xf bank_mask:0x3
  s_nop 1
  v_add_u32_dpp v63, v47, v2 row_newbcast:6 row_mask:0xf bank_mask:0xc
  s_add_u32 m0, s76, 55296
  s_nop 0
  buffer_load_dwordx4 v63, s[32:35], 0 offen lds
  v_add_u32_dpp v64, v49, v2 row_newbcast:0 row_mask:0xf bank_mask:0x3
  s_nop 1
  v_add_u32_dpp v64, v51, v2 row_newbcast:6 row_mask:0xf bank_mask:0xc
  s_add_u32 m0, s76, 57344
  s_nop 0
  buffer_load_dwordx4 v64, s[32:35], 0 offen lds
  v_add_u32_dpp v65, v53, v2 row_newbcast:0 row_mask:0xf bank_mask:0x3
  s_nop 1
  v_add_u32_dpp v65, v55, v2 row_newbcast:6 row_mask:0xf bank_mask:0xc
  s_add_u32 m0, s76, 59392
  s_nop 0
  buffer_load_dwordx4 v65, s[32:35], 0 offen lds
  s_waitcnt vmcnt(10)
  s_barrier
  s_add_u32 m0, s75, 147456
  s_nop 0
  buffer_load_dwordx4 v4, s[44:47], s74 offen lds
  s_add_u32 m0, s75, 148480
  s_nop 0
  buffer_load_dwordx4 v5, s[44:47], s74 offen lds
  s_add_u32 s74, s74, 106496
  s_add_u32 m0, s75, 155648
  s_nop 0
  buffer_load_dwordx4 v4, s[44:47], s74 offen lds
  s_add_u32 m0, s75, 156672
  s_nop 0
  buffer_load_dwordx4 v5, s[44:47], s74 offen lds
  s_add_u32 s74, s74, 106496
  v_add_u32_dpp v56, v18, v2 row_newbcast:0 row_mask:0xf bank_mask:0x3
  v_add_u32_dpp v57, v22, v2 row_newbcast:0 row_mask:0xf bank_mask:0x3
  v_add_u32_dpp v58, v26, v2 row_newbcast:0 row_mask:0xf bank_mask:0x3
  v_add_u32_dpp v59, v30, v2 row_newbcast:0 row_mask:0xf bank_mask:0x3
  v_add_u32_dpp v60, v34, v2 row_newbcast:0 row_mask:0xf bank_mask:0x3
  v_add_u32_dpp v61, v38, v2 row_newbcast:0 row_mask:0xf bank_mask:0x3
  v_add_u32_dpp v62, v42, v2 row_newbcast:0 row_mask:0xf bank_mask:0x3
  v_add_u32_dpp v63, v46, v2 row_newbcast:0 row_mask:0xf bank_mask:0x3
  v_add_u32_dpp v64, v50, v2 row_newbcast:0 row_mask:0xf bank_mask:0x3
  v_add_u32_dpp v65, v54, v2 row_newbcast:0 row_mask:0xf bank_mask:0x3
  v_add_u32_dpp v56, v16, v2 row_newbcast:7 row_mask:0xf bank_mask:0xc
  v_add_u32_dpp v57, v20, v2 row_newbcast:7 row_mask:0xf bank_mask:0xc
  v_add_u32_dpp v58, v24, v2 row_newbcast:7 row_mask:0xf bank_mask:0xc
  v_add_u32_dpp v59, v28, v2 row_newbcast:7 row_mask:0xf bank_mask:0xc
  v_add_u32_dpp v60, v32, v2 row_newbcast:7 row_mask:0xf bank_mask:0xc
  v_add_u32_dpp v61, v36, v2 row_newbcast:7 row_mask:0xf bank_mask:0xc
  v_add_u32_dpp v62, v40, v2 row_newbcast:7 row_mask:0xf bank_mask:0xc
  v_add_u32_dpp v63, v44, v2 row_newbcast:7 row_mask:0xf bank_mask:0xc
  v_add_u32_dpp v64, v48, v2 row_newbcast:7 row_mask:0xf bank_mask:0xc
  v_add_u32_dpp v65, v52, v2 row_newbcast:7 row_mask:0xf bank_mask:0xc
  buffer_load_dword v70, v7, s[28:31], s84 offen offset:32
  buffer_load_dword v71, v7, s[28:31], s84 offen offset:48
  buffer_load_dword v72, v7, s[28:31], s84 offen offset:64
  buffer_load_dword v73, v7, s[28:31], s84 offen offset:80
  buffer_load_dword v74, v7, s[28:31], s84 offen offset:88
  s_add_u32 m0, s76, 81920
  s_nop 0
  buffer_load_dwordx4 v56, s[32:35], 0 offen lds
  s_add_u32 m0, s76, 83968
  s_nop 0
  buffer_load_dwordx4 v57, s[32:35], 0 offen lds
  s_add_u32 m0, s76, 86016
  s_nop 0
  buffer_load_dwordx4 v58, s[32:35], 0 offen lds
  s_add_u32 m0, s76, 88064
  s_nop 0
  buffer_load_dwordx4 v59, s[32:35], 0 offen lds
  s_add_u32 m0, s76, 90112
  s_nop 0
  buffer_load_dwordx4 v60, s[32:35], 0 offen lds
  s_add_u32 m0, s76, 92160
  s_nop 0
  buffer_load_dwordx4 v61, s[32:35], 0 offen lds
  s_add_u32 m0, s76, 94208
  s_nop 0
  buffer_load_dwordx4 v62, s[32:35], 0 offen lds
  s_add_u32 m0, s76, 96256
  s_nop 0
  buffer_load_dwordx4 v63, s[32:35], 0 offen lds
  s_waitcnt vmcnt(13)
  s_barrier
  s_add_u32 m0, s76, 98304
  s_nop 0
  buffer_load_dwordx4 v64, s[32:35], 0 offen lds
  s_add_u32 m0, s76, 100352
  s_nop 0
  buffer_load_dwordx4 v65, s[32:35], 0 offen lds
  v_add_u32_dpp v56, v19, v2 row_newbcast:0 row_mask:0xf bank_mask:0x3
  v_add_u32_dpp v57, v23, v2 row_newbcast:0 row_mask:0xf bank_mask:0x3
  v_add_u32_dpp v58, v27, v2 row_newbcast:0 row_mask:0xf bank_mask:0x3
  v_add_u32_dpp v59, v31, v2 row_newbcast:0 row_mask:0xf bank_mask:0x3
  v_add_u32_dpp v60, v35, v2 row_newbcast:0 row_mask:0xf bank_mask:0x3
  v_add_u32_dpp v61, v39, v2 row_newbcast:0 row_mask:0xf bank_mask:0x3
  v_add_u32_dpp v62, v43, v2 row_newbcast:0 row_mask:0xf bank_mask:0x3
  v_add_u32_dpp v63, v47, v2 row_newbcast:0 row_mask:0xf bank_mask:0x3
  v_add_u32_dpp v64, v51, v2 row_newbcast:0 row_mask:0xf bank_mask:0x3
  v_add_u32_dpp v65, v55, v2 row_newbcast:0 row_mask:0xf bank_mask:0x3
  v_add_u32_dpp v56, v17, v2 row_newbcast:7 row_mask:0xf bank_mask:0xc
  v_add_u32_dpp v57, v21, v2 row_newbcast:7 row_mask:0xf bank_mask:0xc
  v_add_u32_dpp v58, v25, v2 row_newbcast:7 row_mask:0xf bank_mask:0xc
  v_add_u32_dpp v59, v29, v2 row_newbcast:7 row_mask:0xf bank_mask:0xc
  v_add_u32_dpp v60, v33, v2 row_newbcast:7 row_mask:0xf bank_mask:0xc
  v_add_u32_dpp v61, v37, v2 row_newbcast:7 row_mask:0xf bank_mask:0xc
  v_add_u32_dpp v62, v41, v2 row_newbcast:7 row_mask:0xf bank_mask:0xc
  v_add_u32_dpp v63, v45, v2 row_newbcast:7 row_mask:0xf bank_mask:0xc
  v_add_u32_dpp v64, v49, v2 row_newbcast:7 row_mask:0xf bank_mask:0xc
  v_add_u32_dpp v65, v53, v2 row_newbcast:7 row_mask:0xf bank_mask:0xc
  s_setprio 0
  s_branch L_ld_in
L_cmp:
  s_and_b32 s68, s3, 1
  s_lshr_b32 s69, s3, 1
  v_bfe_u32 v117, v0, 2, 2
  v_lshl_add_u32 v118, v116, 3, v117
  v_lshlrev_b32 v118, 8, v118
  v_bfe_u32 v117, v0, 2, 3
  s_lshl_b32 s70, s69, 2
  v_xor_b32 v117, s70, v117
  v_lshl_add_u32 v118, v117, 5, v118
  v_and_b32 v117, 3, v0
  v_lshl_add_u32 v118, v117, 3, v118
  v_add_u32 v1, 131072, v118
  v_xor_b32 v2, 32, v1
  v_xor_b32 v3, 64, v1
  v_xor_b32 v4, 96, v1
  s_lshl_b32 s70, s69, 7
  s_add_u32 s70, s70, 122880
  v_lshlrev_b32 v118, 3, v116
  v_add_u32 v9, s70, v118
  v_and_b32 v118, 15, v0
  v_lshlrev_b32 v118, 7, v118
  v_bfe_u32 v117, v0, 1, 3
  v_xor_b32 v117, v117, v116
  v_lshl_add_u32 v118, v117, 4, v118
  s_mul_i32 s70, s68, 20480
  v_add_u32 v5, s70, v118
  v_xor_b32 v7, 64, v5
  v_add_u32 v6, 81920, v5
  v_add_u32 v8, 81920, v7
  s_mul_i32 s70, s3, 640
  s_add_u32 s70, s70, 123392
  v_and_b32 v118, 15, v0
  v_lshlrev_b32 v118, 2, v118
  v_add_u32 v118, s70, v118
  v_lshrrev_b32 v117, 5, v0
  v_lshl_add_u32 v118, v117, 6, v118
  v_bfe_u32 v117, v0, 4, 1
  v_lshl_add_u32 v10, v117, 7, v118
  s_mov_b32 s72, 0
  v_mov_b32 v12, 0xc0135761
  v_mov_b32 v13, 0xc0135761
  v_mov_b32 v14, 0xbdd2d3e8
  v_mov_b32 v15, 0xbdd2d3e8
  s_waitcnt vmcnt(2)
  v_lshlrev_b32 v100, 7, v100
  buffer_load_dword v200, v100, s[32:35], 0 offen
  v_lshlrev_b32 v102, 7, v102
  buffer_load_dword v202, v102, s[32:35], 0 offen
  s_barrier
  ds_read_b64_tr_b16 v[16:17], v1 offset:0
  ds_read_b64_tr_b16 v[18:19], v1 offset:1024
  ds_read_b64_tr_b16 v[32:33], v1 offset:8192
  ds_read_b64_tr_b16 v[34:35], v1 offset:9216
  ds_read_b64_tr_b16 v[20:21], v2 offset:0
  ds_read_b64_tr_b16 v[22:23], v2 offset:1024
  ds_read_b64_tr_b16 v[36:37], v2 offset:8192
  ds_read_b64_tr_b16 v[38:39], v2 offset:9216
  ds_read_b64_tr_b16 v[24:25], v3 offset:0
  ds_read_b64_tr_b16 v[26:27], v3 offset:1024
  ds_read_b64_tr_b16 v[40:41], v3 offset:8192
  ds_read_b64_tr_b16 v[42:43], v3 offset:9216
  ds_read_b64_tr_b16 v[28:29], v4 offset:0
  ds_read_b64_tr_b16 v[30:31], v4 offset:1024
  ds_read_b64_tr_b16 v[44:45], v4 offset:8192
  ds_read_b64_tr_b16 v[46:47], v4 offset:9216
  s_waitcnt vmcnt(3)
  ds_read_b64 v[234:235], v9 offset:0
  ds_read_b64 v[238:239], v9 offset:32
  ds_read_b64 v[242:243], v9 offset:64
  ds_read_b64 v[246:247], v9 offset:96
  s_waitcnt lgkmcnt(3)
  v_lshlrev_b32 v232, 16, v234
  v_and_b32 v233, 0xffff0000, v234
  v_lshlrev_b32 v234, 16, v235
  v_and_b32 v235, 0xffff0000, v235
  s_waitcnt lgkmcnt(2)
  v_lshlrev_b32 v236, 16, v238
  v_and_b32 v237, 0xffff0000, v238
  v_lshlrev_b32 v238, 16, v239
  v_and_b32 v239, 0xffff0000, v239
  s_waitcnt lgkmcnt(1)
  v_lshlrev_b32 v240, 16, v242
  v_and_b32 v241, 0xffff0000, v242
  v_lshlrev_b32_e64 v242, 16, v243
  v_and_b32 v243, 0xffff0000, v243
  s_waitcnt lgkmcnt(0)
  v_lshlrev_b32 v244, 16, v246
  v_and_b32 v245, 0xffff0000, v246
  v_lshlrev_b32 v246, 16, v247
  v_and_b32 v247, 0xffff0000, v247
  v_mov_b64 v[216:217], v[232:233]
  v_mov_b64 v[218:219], v[234:235]
  v_mov_b64 v[220:221], v[236:237]
  v_mov_b64 v[222:223], v[238:239]
  v_mov_b64 v[224:225], v[240:241]
  v_mov_b64 v[226:227], v[242:243]
  v_mov_b64 v[228:229], v[244:245]
  v_mov_b64 v[230:231], v[246:247]
  s_waitcnt lgkmcnt(0)
  s_setprio 1
  s_barrier
  ds_read_b128 v[48:51], v5 offset:0
  ds_read_b128 v[52:55], v7 offset:0
  ds_read_b128 v[56:59], v5 offset:2048
  ds_read_b128 v[60:63], v7 offset:2048
  ds_read_b128 v[64:67], v5 offset:4096
  ds_read_b128 v[68:71], v7 offset:4096
  ds_read_b128 v[72:75], v5 offset:6144
  ds_read_b128 v[76:79], v7 offset:6144
  s_waitcnt lgkmcnt(7)
  v_mfma_f32_16x16x32_bf16 v[88:91], v[16:19], v[48:51], v[232:235]
  s_waitcnt lgkmcnt(4)
  v_mfma_f32_16x16x32_bf16 v[88:91], v[32:35], v[52:55], v[88:91]
  v_mfma_f32_16x16x32_bf16 v[104:107], v[32:35], v[60:63], v[232:235]
  v_mfma_f32_16x16x32_bf16 v[104:107], v[16:19], v[56:59], v[104:107]
  v_mfma_f32_16x16x32_bf16 v[108:111], v[20:23], v[56:59], v[236:239]
  v_mfma_f32_16x16x32_bf16 v[108:111], v[36:39], v[60:63], v[108:111]
  v_mfma_f32_16x16x32_bf16 v[92:95], v[36:39], v[52:55], v[236:239]
  v_mfma_f32_16x16x32_bf16 v[92:95], v[20:23], v[48:51], v[92:95]
  v_mfma_f32_16x16x32_bf16 v[96:99], v[24:27], v[48:51], v[240:243]
  v_xor_b32 v1, 16384, v1
  v_mfma_f32_16x16x32_bf16 v[96:99], v[40:43], v[52:55], v[96:99]
  v_xor_b32 v2, 16384, v2
  v_mfma_f32_16x16x32_bf16 v[112:115], v[40:43], v[60:63], v[240:243]
  v_xor_b32 v3, 16384, v3
  v_mfma_f32_16x16x32_bf16 v[112:115], v[24:27], v[56:59], v[112:115]
  v_xor_b32 v4, 16384, v4
  v_mfma_f32_16x16x32_bf16 v[116:119], v[28:31], v[56:59], v[244:247]
  v_mfma_f32_16x16x32_bf16 v[116:119], v[44:47], v[60:63], v[116:119]
  v_mfma_f32_16x16x32_bf16 v[100:103], v[44:47], v[52:55], v[244:247]
  s_waitcnt lgkmcnt(2)
  v_mfma_f32_16x16x32_bf16 v[100:103], v[28:31], v[48:51], v[100:103]
  v_mfma_f32_16x16x32_bf16 v[120:123], v[16:19], v[64:67], v[232:235]
  s_barrier
  s_waitcnt lgkmcnt(0)
  v_mfma_f32_16x16x32_bf16 v[120:123], v[32:35], v[68:71], v[120:123]
  ds_read_b128 v[80:83], v5 offset:8192
  v_mfma_f32_16x16x32_bf16 v[136:139], v[32:35], v[76:79], v[232:235]
  ds_read_b128 v[84:87], v7 offset:8192
  v_mfma_f32_16x16x32_bf16 v[136:139], v[16:19], v[72:75], v[136:139]
  ds_read_b128 v[48:51], v5 offset:10240
  v_mfma_f32_16x16x32_bf16 v[140:143], v[20:23], v[72:75], v[236:239]
  ds_read_b128 v[52:55], v7 offset:10240
  v_mfma_f32_16x16x32_bf16 v[140:143], v[36:39], v[76:79], v[140:143]
  ds_read_b128 v[56:59], v5 offset:12288
  v_mfma_f32_16x16x32_bf16 v[124:127], v[36:39], v[68:71], v[236:239]
  ds_read_b128 v[60:63], v7 offset:12288
  v_mfma_f32_16x16x32_bf16 v[124:127], v[20:23], v[64:67], v[124:127]
  v_mfma_f32_16x16x32_bf16 v[128:131], v[24:27], v[64:67], v[240:243]
  v_mfma_f32_16x16x32_bf16 v[128:131], v[40:43], v[68:71], v[128:131]
  v_mfma_f32_16x16x32_bf16 v[144:147], v[40:43], v[76:79], v[240:243]
  v_mfma_f32_16x16x32_bf16 v[144:147], v[24:27], v[72:75], v[144:147]
  v_mfma_f32_16x16x32_bf16 v[148:151], v[28:31], v[72:75], v[244:247]
  ds_read_b128 v[72:75], v5 offset:16384
  v_mfma_f32_16x16x32_bf16 v[148:151], v[44:47], v[76:79], v[148:151]
  ds_read_b128 v[76:79], v7 offset:16384
  v_mfma_f32_16x16x32_bf16 v[132:135], v[44:47], v[68:71], v[244:247]
  ds_read_b128 v[68:71], v7 offset:14336
  s_waitcnt lgkmcnt(7)
  v_mfma_f32_16x16x32_bf16 v[132:135], v[28:31], v[64:67], v[132:135]
  ds_read_b128 v[64:67], v5 offset:14336
  v_mfma_f32_16x16x32_bf16 v[152:155], v[16:19], v[80:83], v[232:235]
  s_waitcnt lgkmcnt(6)
  v_mfma_f32_16x16x32_bf16 v[152:155], v[32:35], v[84:87], v[152:155]
  v_mfma_f32_16x16x32_bf16 v[168:171], v[32:35], v[52:55], v[232:235]
  v_mfma_f32_16x16x32_bf16 v[168:171], v[16:19], v[48:51], v[168:171]
  v_mfma_f32_16x16x32_bf16 v[172:175], v[20:23], v[48:51], v[236:239]
  v_mfma_f32_16x16x32_bf16 v[172:175], v[36:39], v[52:55], v[172:175]
  v_mfma_f32_16x16x32_bf16 v[156:159], v[36:39], v[84:87], v[236:239]
  v_mfma_f32_16x16x32_bf16 v[156:159], v[20:23], v[80:83], v[156:159]
  v_mfma_f32_16x16x32_bf16 v[160:163], v[24:27], v[80:83], v[240:243]
  v_mfma_f32_16x16x32_bf16 v[160:163], v[40:43], v[84:87], v[160:163]
  v_mfma_f32_16x16x32_bf16 v[176:179], v[40:43], v[52:55], v[240:243]
  v_mfma_f32_16x16x32_bf16 v[176:179], v[24:27], v[48:51], v[176:179]
  v_mfma_f32_16x16x32_bf16 v[180:183], v[28:31], v[48:51], v[244:247]
  v_mfma_f32_16x16x32_bf16 v[180:183], v[44:47], v[52:55], v[180:183]
  v_mfma_f32_16x16x32_bf16 v[164:167], v[44:47], v[84:87], v[244:247]
  ds_read_b128 v[84:87], v7 offset:18432
  s_waitcnt lgkmcnt(5)
  v_mfma_f32_16x16x32_bf16 v[164:167], v[28:31], v[80:83], v[164:167]
  ds_read_b128 v[80:83], v5 offset:18432
  v_mfma_f32_16x16x32_bf16 v[184:187], v[16:19], v[56:59], v[232:235]
  s_waitcnt lgkmcnt(2)
  v_mfma_f32_16x16x32_bf16 v[184:187], v[32:35], v[60:63], v[184:187]
  s_waitcnt vmcnt(0)
  v_mfma_f32_16x16x32_bf16 v[200:203], v[32:35], v[68:71], v[232:235]
  v_mfma_f32_16x16x32_bf16 v[200:203], v[16:19], v[64:67], v[200:203]
  v_mfma_f32_16x16x32_bf16 v[204:207], v[20:23], v[64:67], v[236:239]
  v_mfma_f32_16x16x32_bf16 v[204:207], v[36:39], v[68:71], v[204:207]
  s_waitcnt lgkmcnt(0)
  s_barrier
  v_mfma_f32_16x16x32_bf16 v[188:191], v[36:39], v[60:63], v[236:239]
  ds_read_b128 v[48:51], v5 offset:40960
  v_mfma_f32_16x16x32_bf16 v[188:191], v[20:23], v[56:59], v[188:191]
  ds_read_b128 v[52:55], v7 offset:40960
  v_mfma_f32_16x16x32_bf16 v[192:195], v[24:27], v[56:59], v[240:243]
  v_mfma_f32_16x16x32_bf16 v[192:195], v[40:43], v[60:63], v[192:195]
  v_mfma_f32_16x16x32_bf16 v[208:211], v[40:43], v[68:71], v[240:243]
  v_mfma_f32_16x16x32_bf16 v[208:211], v[24:27], v[64:67], v[208:211]
  v_mfma_f32_16x16x32_bf16 v[212:215], v[28:31], v[64:67], v[244:247]
  ds_read_b128 v[64:67], v5 offset:45056
  v_mfma_f32_16x16x32_bf16 v[212:215], v[44:47], v[68:71], v[212:215]
  ds_read_b128 v[68:71], v7 offset:45056
  v_mfma_f32_16x16x32_bf16 v[196:199], v[44:47], v[60:63], v[244:247]
  ds_read_b128 v[60:63], v7 offset:43008
  v_mfma_f32_16x16x32_bf16 v[196:199], v[28:31], v[56:59], v[196:199]
  ds_read_b128 v[56:59], v5 offset:43008
  v_mfma_f32_16x16x32_bf16 v[216:219], v[32:35], v[76:79], v[216:219]
  v_mfma_f32_16x16x32_bf16 v[216:219], v[16:19], v[72:75], v[216:219]
  v_mfma_f32_16x16x32_bf16 v[232:235], v[16:19], v[80:83], v[232:235]
  ds_read_b64_tr_b16 v[16:17], v1 offset:0
  v_mfma_f32_16x16x32_bf16 v[232:235], v[32:35], v[84:87], v[232:235]
  ds_read_b64_tr_b16 v[18:19], v1 offset:1024
  v_mfma_f32_16x16x32_bf16 v[236:239], v[36:39], v[84:87], v[236:239]
  ds_read_b64_tr_b16 v[32:33], v1 offset:8192
  v_mfma_f32_16x16x32_bf16 v[236:239], v[20:23], v[80:83], v[236:239]
  ds_read_b64_tr_b16 v[34:35], v1 offset:9216
  v_mfma_f32_16x16x32_bf16 v[220:223], v[20:23], v[72:75], v[220:223]
  ds_read_b64_tr_b16 v[20:21], v2 offset:0
  v_mfma_f32_16x16x32_bf16 v[220:223], v[36:39], v[76:79], v[220:223]
  ds_read_b64_tr_b16 v[22:23], v2 offset:1024
  v_mfma_f32_16x16x32_bf16 v[224:227], v[40:43], v[76:79], v[224:227]
  ds_read_b64_tr_b16 v[36:37], v2 offset:8192
  v_mfma_f32_16x16x32_bf16 v[224:227], v[24:27], v[72:75], v[224:227]
  ds_read_b64_tr_b16 v[38:39], v2 offset:9216
  v_mfma_f32_16x16x32_bf16 v[240:243], v[24:27], v[80:83], v[240:243]
  ds_read_b64_tr_b16 v[24:25], v3 offset:0
  v_mfma_f32_16x16x32_bf16 v[240:243], v[40:43], v[84:87], v[240:243]
  ds_read_b64_tr_b16 v[26:27], v3 offset:1024
  v_mfma_f32_16x16x32_bf16 v[244:247], v[44:47], v[84:87], v[244:247]
  ds_read_b64_tr_b16 v[40:41], v3 offset:8192
  v_mfma_f32_16x16x32_bf16 v[244:247], v[28:31], v[80:83], v[244:247]
  ds_read_b64_tr_b16 v[42:43], v3 offset:9216
  v_mfma_f32_16x16x32_bf16 v[228:231], v[28:31], v[72:75], v[228:231]
  ds_read_b64_tr_b16 v[28:29], v4 offset:0
  s_waitcnt lgkmcnt(9)
  v_mfma_f32_16x16x32_bf16 v[228:231], v[44:47], v[76:79], v[228:231]
  ds_read_b64_tr_b16 v[30:31], v4 offset:1024
L_dnn_loop0:
  v_mfma_f32_16x16x32_bf16 v[88:91], v[16:19], v[48:51], v[88:91]
  ds_read_b64_tr_b16 v[44:45], v4 offset:8192
  v_mfma_f32_16x16x32_bf16 v[88:91], v[32:35], v[52:55], v[88:91]
  ds_read_b64_tr_b16 v[46:47], v4 offset:9216
  v_mfma_f32_16x16x32_bf16 v[104:107], v[32:35], v[60:63], v[104:107]
  ds_read_b128 v[72:75], v5 offset:47104
  s_waitcnt lgkmcnt(9)
  v_mfma_f32_16x16x32_bf16 v[104:107], v[16:19], v[56:59], v[104:107]
  ds_read_b128 v[76:79], v7 offset:47104
  v_mfma_f32_16x16x32_bf16 v[108:111], v[20:23], v[56:59], v[108:111]
  ds_read_b128 v[80:83], v5 offset:49152
  v_mfma_f32_16x16x32_bf16 v[108:111], v[36:39], v[60:63], v[108:111]
  ds_read_b128 v[84:87], v7 offset:49152
  v_mfma_f32_16x16x32_bf16 v[92:95], v[36:39], v[52:55], v[92:95]
  s_waitcnt lgkmcnt(8)
  v_mfma_f32_16x16x32_bf16 v[92:95], v[20:23], v[48:51], v[92:95]
  v_mfma_f32_16x16x32_bf16 v[96:99], v[24:27], v[48:51], v[96:99]
  v_xor_b32 v1, 16384, v1
  v_mfma_f32_16x16x32_bf16 v[96:99], v[40:43], v[52:55], v[96:99]
  v_xor_b32 v2, 16384, v2
  v_mfma_f32_16x16x32_bf16 v[112:115], v[40:43], v[60:63], v[112:115]
  v_xor_b32 v3, 16384, v3
  s_waitcnt lgkmcnt(4)
  v_mfma_f32_16x16x32_bf16 v[112:115], v[24:27], v[56:59], v[112:115]
  v_xor_b32 v4, 16384, v4
  v_mfma_f32_16x16x32_bf16 v[116:119], v[28:31], v[56:59], v[116:119]
  ds_read_b128 v[56:59], v5 offset:53248
  v_mfma_f32_16x16x32_bf16 v[116:119], v[44:47], v[60:63], v[116:119]
  ds_read_b128 v[60:63], v7 offset:53248
  v_mfma_f32_16x16x32_bf16 v[100:103], v[44:47], v[52:55], v[100:103]
  ds_read_b128 v[52:55], v7 offset:51200
  v_mfma_f32_16x16x32_bf16 v[100:103], v[28:31], v[48:51], v[100:103]
  ds_read_b128 v[48:51], v5 offset:51200
  v_mfma_f32_16x16x32_bf16 v[120:123], v[16:19], v[64:67], v[120:123]
  s_waitcnt lgkmcnt(6)
  v_mfma_f32_16x16x32_bf16 v[120:123], v[32:35], v[68:71], v[120:123]
  v_mfma_f32_16x16x32_bf16 v[136:139], v[32:35], v[76:79], v[136:139]
  v_mfma_f32_16x16x32_bf16 v[136:139], v[16:19], v[72:75], v[136:139]
  v_mfma_f32_16x16x32_bf16 v[140:143], v[20:23], v[72:75], v[140:143]
  v_mfma_f32_16x16x32_bf16 v[140:143], v[36:39], v[76:79], v[140:143]
  v_mfma_f32_16x16x32_bf16 v[124:127], v[36:39], v[68:71], v[124:127]
  v_mfma_f32_16x16x32_bf16 v[124:127], v[20:23], v[64:67], v[124:127]
  v_mfma_f32_16x16x32_bf16 v[128:131], v[24:27], v[64:67], v[128:131]
  v_mfma_f32_16x16x32_bf16 v[128:131], v[40:43], v[68:71], v[128:131]
  v_mfma_f32_16x16x32_bf16 v[144:147], v[40:43], v[76:79], v[144:147]
  v_mfma_f32_16x16x32_bf16 v[144:147], v[24:27], v[72:75], v[144:147]
  v_mfma_f32_16x16x32_bf16 v[148:151], v[28:31], v[72:75], v[148:151]
  ds_read_b128 v[72:75], v5 offset:57344
  v_mfma_f32_16x16x32_bf16 v[148:151], v[44:47], v[76:79], v[148:151]
  ds_read_b128 v[76:79], v7 offset:57344
  v_mfma_f32_16x16x32_bf16 v[132:135], v[44:47], v[68:71], v[132:135]
  ds_read_b128 v[68:71], v7 offset:55296
  s_waitcnt lgkmcnt(7)
  v_mfma_f32_16x16x32_bf16 v[132:135], v[28:31], v[64:67], v[132:135]
  ds_read_b128 v[64:67], v5 offset:55296
  v_mfma_f32_16x16x32_bf16 v[152:155], v[16:19], v[80:83], v[152:155]
  s_waitcnt lgkmcnt(4)
  v_mfma_f32_16x16x32_bf16 v[152:155], v[32:35], v[84:87], v[152:155]
  v_mfma_f32_16x16x32_bf16 v[168:171], v[32:35], v[52:55], v[168:171]
  v_mfma_f32_16x16x32_bf16 v[168:171], v[16:19], v[48:51], v[168:171]
  v_mfma_f32_16x16x32_bf16 v[172:175], v[20:23], v[48:51], v[172:175]
  v_mfma_f32_16x16x32_bf16 v[172:175], v[36:39], v[52:55], v[172:175]
  v_mfma_f32_16x16x32_bf16 v[156:159], v[36:39], v[84:87], v[156:159]
  v_mfma_f32_16x16x32_bf16 v[156:159], v[20:23], v[80:83], v[156:159]
  v_mfma_f32_16x16x32_bf16 v[160:163], v[24:27], v[80:83], v[160:163]
  v_mfma_f32_16x16x32_bf16 v[160:163], v[40:43], v[84:87], v[160:163]
  v_mfma_f32_16x16x32_bf16 v[176:179], v[40:43], v[52:55], v[176:179]
  v_mfma_f32_16x16x32_bf16 v[176:179], v[24:27], v[48:51], v[176:179]
  v_mfma_f32_16x16x32_bf16 v[180:183], v[28:31], v[48:51], v[180:183]
  v_mfma_f32_16x16x32_bf16 v[180:183], v[44:47], v[52:55], v[180:183]
  v_mfma_f32_16x16x32_bf16 v[164:167], v[44:47], v[84:87], v[164:167]
  ds_read_b128 v[84:87], v7 offset:59392
  v_mfma_f32_16x16x32_bf16 v[164:167], v[28:31], v[80:83], v[164:167]
  ds_read_b128 v[80:83], v5 offset:59392
  v_mfma_f32_16x16x32_bf16 v[184:187], v[16:19], v[56:59], v[184:187]
  s_waitcnt lgkmcnt(2)
  v_mfma_f32_16x16x32_bf16 v[184:187], v[32:35], v[60:63], v[184:187]
  v_mfma_f32_16x16x32_bf16 v[200:203], v[32:35], v[68:71], v[200:203]
  v_mfma_f32_16x16x32_bf16 v[200:203], v[16:19], v[64:67], v[200:203]
  v_mfma_f32_16x16x32_bf16 v[204:207], v[20:23], v[64:67], v[204:207]
  v_mfma_f32_16x16x32_bf16 v[204:207], v[36:39], v[68:71], v[204:207]
  s_waitcnt lgkmcnt(0)
  s_barrier
  v_mfma_f32_16x16x32_bf16 v[188:191], v[36:39], v[60:63], v[188:191]
  ds_read_b128 v[48:51], v6 offset:0
  v_mfma_f32_16x16x32_bf16 v[188:191], v[20:23], v[56:59], v[188:191]
  ds_read_b128 v[52:55], v8 offset:0
  v_mfma_f32_16x16x32_bf16 v[192:195], v[24:27], v[56:59], v[192:195]
  v_mfma_f32_16x16x32_bf16 v[192:195], v[40:43], v[60:63], v[192:195]
  v_mfma_f32_16x16x32_bf16 v[208:211], v[40:43], v[68:71], v[208:211]
  v_mfma_f32_16x16x32_bf16 v[208:211], v[24:27], v[64:67], v[208:211]
  v_mfma_f32_16x16x32_bf16 v[212:215], v[28:31], v[64:67], v[212:215]
  ds_read_b128 v[64:67], v6 offset:4096
  v_mfma_f32_16x16x32_bf16 v[212:215], v[44:47], v[68:71], v[212:215]
  ds_read_b128 v[68:71], v8 offset:4096
  v_mfma_f32_16x16x32_bf16 v[196:199], v[44:47], v[60:63], v[196:199]
  ds_read_b128 v[60:63], v8 offset:2048
  v_mfma_f32_16x16x32_bf16 v[196:199], v[28:31], v[56:59], v[196:199]
  ds_read_b128 v[56:59], v6 offset:2048
  v_mfma_f32_16x16x32_bf16 v[216:219], v[32:35], v[76:79], v[216:219]
  v_mfma_f32_16x16x32_bf16 v[216:219], v[16:19], v[72:75], v[216:219]
  v_mfma_f32_16x16x32_bf16 v[232:235], v[16:19], v[80:83], v[232:235]
  ds_read_b64_tr_b16 v[16:17], v1 offset:0
  v_mfma_f32_16x16x32_bf16 v[232:235], v[32:35], v[84:87], v[232:235]
  ds_read_b64_tr_b16 v[18:19], v1 offset:1024
  v_mfma_f32_16x16x32_bf16 v[236:239], v[36:39], v[84:87], v[236:239]
  ds_read_b64_tr_b16 v[32:33], v1 offset:8192
  v_mfma_f32_16x16x32_bf16 v[236:239], v[20:23], v[80:83], v[236:239]
  ds_read_b64_tr_b16 v[34:35], v1 offset:9216
  v_mfma_f32_16x16x32_bf16 v[220:223], v[20:23], v[72:75], v[220:223]
  ds_read_b64_tr_b16 v[20:21], v2 offset:0
  v_mfma_f32_16x16x32_bf16 v[220:223], v[36:39], v[76:79], v[220:223]
  ds_read_b64_tr_b16 v[22:23], v2 offset:1024
  v_mfma_f32_16x16x32_bf16 v[224:227], v[40:43], v[76:79], v[224:227]
  ds_read_b64_tr_b16 v[36:37], v2 offset:8192
  v_mfma_f32_16x16x32_bf16 v[224:227], v[24:27], v[72:75], v[224:227]
  ds_read_b64_tr_b16 v[38:39], v2 offset:9216
  v_mfma_f32_16x16x32_bf16 v[240:243], v[24:27], v[80:83], v[240:243]
  ds_read_b64_tr_b16 v[24:25], v3 offset:0
  v_mfma_f32_16x16x32_bf16 v[240:243], v[40:43], v[84:87], v[240:243]
  ds_read_b64_tr_b16 v[26:27], v3 offset:1024
  v_mfma_f32_16x16x32_bf16 v[244:247], v[44:47], v[84:87], v[244:247]
  ds_read_b64_tr_b16 v[40:41], v3 offset:8192
  v_mfma_f32_16x16x32_bf16 v[244:247], v[28:31], v[80:83], v[244:247]
  ds_read_b64_tr_b16 v[42:43], v3 offset:9216
  v_mfma_f32_16x16x32_bf16 v[228:231], v[28:31], v[72:75], v[228:231]
  ds_read_b64_tr_b16 v[28:29], v4 offset:0
  s_waitcnt lgkmcnt(9)
  v_mfma_f32_16x16x32_bf16 v[228:231], v[44:47], v[76:79], v[228:231]
  ds_read_b64_tr_b16 v[30:31], v4 offset:1024
  v_mfma_f32_16x16x32_bf16 v[88:91], v[16:19], v[48:51], v[88:91]
  ds_read_b64_tr_b16 v[44:45], v4 offset:8192
  v_mfma_f32_16x16x32_bf16 v[88:91], v[32:35], v[52:55], v[88:91]
  ds_read_b64_tr_b16 v[46:47], v4 offset:9216
  v_mfma_f32_16x16x32_bf16 v[104:107], v[32:35], v[60:63], v[104:107]
  ds_read_b128 v[72:75], v6 offset:6144
  s_waitcnt lgkmcnt(9)
  v_mfma_f32_16x16x32_bf16 v[104:107], v[16:19], v[56:59], v[104:107]
  ds_read_b128 v[76:79], v8 offset:6144
  v_mfma_f32_16x16x32_bf16 v[108:111], v[20:23], v[56:59], v[108:111]
  ds_read_b128 v[80:83], v6 offset:8192
  v_mfma_f32_16x16x32_bf16 v[108:111], v[36:39], v[60:63], v[108:111]
  ds_read_b128 v[84:87], v8 offset:8192
  v_mfma_f32_16x16x32_bf16 v[92:95], v[36:39], v[52:55], v[92:95]
  s_waitcnt lgkmcnt(8)
  v_mfma_f32_16x16x32_bf16 v[92:95], v[20:23], v[48:51], v[92:95]
  v_mfma_f32_16x16x32_bf16 v[96:99], v[24:27], v[48:51], v[96:99]
  v_xor_b32 v1, 16384, v1
  v_mfma_f32_16x16x32_bf16 v[96:99], v[40:43], v[52:55], v[96:99]
  v_xor_b32 v2, 16384, v2
  v_mfma_f32_16x16x32_bf16 v[112:115], v[40:43], v[60:63], v[112:115]
  v_xor_b32 v3, 16384, v3
  s_waitcnt lgkmcnt(4)
  v_mfma_f32_16x16x32_bf16 v[112:115], v[24:27], v[56:59], v[112:115]
  v_xor_b32 v4, 16384, v4
  v_mfma_f32_16x16x32_bf16 v[116:119], v[28:31], v[56:59], v[116:119]
  ds_read_b128 v[56:59], v6 offset:12288
  v_mfma_f32_16x16x32_bf16 v[116:119], v[44:47], v[60:63], v[116:119]
  ds_read_b128 v[60:63], v8 offset:12288
  v_mfma_f32_16x16x32_bf16 v[100:103], v[44:47], v[52:55], v[100:103]
  ds_read_b128 v[52:55], v8 offset:10240
  v_mfma_f32_16x16x32_bf16 v[100:103], v[28:31], v[48:51], v[100:103]
  ds_read_b128 v[48:51], v6 offset:10240
  v_mfma_f32_16x16x32_bf16 v[120:123], v[16:19], v[64:67], v[120:123]
  s_waitcnt lgkmcnt(6)
  v_mfma_f32_16x16x32_bf16 v[120:123], v[32:35], v[68:71], v[120:123]
  v_mfma_f32_16x16x32_bf16 v[136:139], v[32:35], v[76:79], v[136:139]
  v_mfma_f32_16x16x32_bf16 v[136:139], v[16:19], v[72:75], v[136:139]
  v_mfma_f32_16x16x32_bf16 v[140:143], v[20:23], v[72:75], v[140:143]
  v_mfma_f32_16x16x32_bf16 v[140:143], v[36:39], v[76:79], v[140:143]
  v_mfma_f32_16x16x32_bf16 v[124:127], v[36:39], v[68:71], v[124:127]
  v_mfma_f32_16x16x32_bf16 v[124:127], v[20:23], v[64:67], v[124:127]
  v_mfma_f32_16x16x32_bf16 v[128:131], v[24:27], v[64:67], v[128:131]
  v_mfma_f32_16x16x32_bf16 v[128:131], v[40:43], v[68:71], v[128:131]
  v_mfma_f32_16x16x32_bf16 v[144:147], v[40:43], v[76:79], v[144:147]
  v_mfma_f32_16x16x32_bf16 v[144:147], v[24:27], v[72:75], v[144:147]
  v_mfma_f32_16x16x32_bf16 v[148:151], v[28:31], v[72:75], v[148:151]
  ds_read_b128 v[72:75], v6 offset:16384
  v_mfma_f32_16x16x32_bf16 v[148:151], v[44:47], v[76:79], v[148:151]
  ds_read_b128 v[76:79], v8 offset:16384
  v_mfma_f32_16x16x32_bf16 v[132:135], v[44:47], v[68:71], v[132:135]
  ds_read_b128 v[68:71], v8 offset:14336
  s_waitcnt lgkmcnt(7)
  v_mfma_f32_16x16x32_bf16 v[132:135], v[28:31], v[64:67], v[132:135]
  ds_read_b128 v[64:67], v6 offset:14336
  v_mfma_f32_16x16x32_bf16 v[152:155], v[16:19], v[80:83], v[152:155]
  s_waitcnt lgkmcnt(4)
  v_mfma_f32_16x16x32_bf16 v[152:155], v[32:35], v[84:87], v[152:155]
  v_mfma_f32_16x16x32_bf16 v[168:171], v[32:35], v[52:55], v[168:171]
  v_mfma_f32_16x16x32_bf16 v[168:171], v[16:19], v[48:51], v[168:171]
  v_mfma_f32_16x16x32_bf16 v[172:175], v[20:23], v[48:51], v[172:175]
  v_mfma_f32_16x16x32_bf16 v[172:175], v[36:39], v[52:55], v[172:175]
  v_mfma_f32_16x16x32_bf16 v[156:159], v[36:39], v[84:87], v[156:159]
  v_mfma_f32_16x16x32_bf16 v[156:159], v[20:23], v[80:83], v[156:159]
  v_mfma_f32_16x16x32_bf16 v[160:163], v[24:27], v[80:83], v[160:163]
  v_mfma_f32_16x16x32_bf16 v[160:163], v[40:43], v[84:87], v[160:163]
  v_mfma_f32_16x16x32_bf16 v[176:179], v[40:43], v[52:55], v[176:179]
  v_mfma_f32_16x16x32_bf16 v[176:179], v[24:27], v[48:51], v[176:179]
  v_mfma_f32_16x16x32_bf16 v[180:183], v[28:31], v[48:51], v[180:183]
  v_mfma_f32_16x16x32_bf16 v[180:183], v[44:47], v[52:55], v[180:183]
  v_mfma_f32_16x16x32_bf16 v[164:167], v[44:47], v[84:87], v[164:167]
  ds_read_b128 v[84:87], v8 offset:18432
  v_mfma_f32_16x16x32_bf16 v[164:167], v[28:31], v[80:83], v[164:167]
  ds_read_b128 v[80:83], v6 offset:18432
  v_mfma_f32_16x16x32_bf16 v[184:187], v[16:19], v[56:59], v[184:187]
  s_waitcnt lgkmcnt(2)
  v_mfma_f32_16x16x32_bf16 v[184:187], v[32:35], v[60:63], v[184:187]
  v_mfma_f32_16x16x32_bf16 v[200:203], v[32:35], v[68:71], v[200:203]
  v_mfma_f32_16x16x32_bf16 v[200:203], v[16:19], v[64:67], v[200:203]
  v_mfma_f32_16x16x32_bf16 v[204:207], v[20:23], v[64:67], v[204:207]
  v_mfma_f32_16x16x32_bf16 v[204:207], v[36:39], v[68:71], v[204:207]
  s_waitcnt lgkmcnt(0)
  s_barrier
  v_mfma_f32_16x16x32_bf16 v[188:191], v[36:39], v[60:63], v[188:191]
  ds_read_b128 v[48:51], v5 offset:0
  v_mfma_f32_16x16x32_bf16 v[188:191], v[20:23], v[56:59], v[188:191]
  ds_read_b128 v[52:55], v7 offset:0
  v_mfma_f32_16x16x32_bf16 v[192:195], v[24:27], v[56:59], v[192:195]
  v_mfma_f32_16x16x32_bf16 v[192:195], v[40:43], v[60:63], v[192:195]
  v_mfma_f32_16x16x32_bf16 v[208:211], v[40:43], v[68:71], v[208:211]
  v_mfma_f32_16x16x32_bf16 v[208:211], v[24:27], v[64:67], v[208:211]
  v_mfma_f32_16x16x32_bf16 v[212:215], v[28:31], v[64:67], v[212:215]
  ds_read_b128 v[64:67], v5 offset:4096
  v_mfma_f32_16x16x32_bf16 v[212:215], v[44:47], v[68:71], v[212:215]
  ds_read_b128 v[68:71], v7 offset:4096
  v_mfma_f32_16x16x32_bf16 v[196:199], v[44:47], v[60:63], v[196:199]
  ds_read_b128 v[60:63], v7 offset:2048
  v_mfma_f32_16x16x32_bf16 v[196:199], v[28:31], v[56:59], v[196:199]
  ds_read_b128 v[56:59], v5 offset:2048
  v_mfma_f32_16x16x32_bf16 v[216:219], v[32:35], v[76:79], v[216:219]
  v_mfma_f32_16x16x32_bf16 v[216:219], v[16:19], v[72:75], v[216:219]
  v_mfma_f32_16x16x32_bf16 v[232:235], v[16:19], v[80:83], v[232:235]
  ds_read_b64_tr_b16 v[16:17], v1 offset:0
  v_mfma_f32_16x16x32_bf16 v[232:235], v[32:35], v[84:87], v[232:235]
  ds_read_b64_tr_b16 v[18:19], v1 offset:1024
  v_mfma_f32_16x16x32_bf16 v[236:239], v[36:39], v[84:87], v[236:239]
  ds_read_b64_tr_b16 v[32:33], v1 offset:8192
  v_mfma_f32_16x16x32_bf16 v[236:239], v[20:23], v[80:83], v[236:239]
  ds_read_b64_tr_b16 v[34:35], v1 offset:9216
  v_mfma_f32_16x16x32_bf16 v[220:223], v[20:23], v[72:75], v[220:223]
  ds_read_b64_tr_b16 v[20:21], v2 offset:0
  v_mfma_f32_16x16x32_bf16 v[220:223], v[36:39], v[76:79], v[220:223]
  ds_read_b64_tr_b16 v[22:23], v2 offset:1024
  v_mfma_f32_16x16x32_bf16 v[224:227], v[40:43], v[76:79], v[224:227]
  ds_read_b64_tr_b16 v[36:37], v2 offset:8192
  v_mfma_f32_16x16x32_bf16 v[224:227], v[24:27], v[72:75], v[224:227]
  ds_read_b64_tr_b16 v[38:39], v2 offset:9216
  v_mfma_f32_16x16x32_bf16 v[240:243], v[24:27], v[80:83], v[240:243]
  ds_read_b64_tr_b16 v[24:25], v3 offset:0
  v_mfma_f32_16x16x32_bf16 v[240:243], v[40:43], v[84:87], v[240:243]
  ds_read_b64_tr_b16 v[26:27], v3 offset:1024
  v_mfma_f32_16x16x32_bf16 v[244:247], v[44:47], v[84:87], v[244:247]
  ds_read_b64_tr_b16 v[40:41], v3 offset:8192
  v_mfma_f32_16x16x32_bf16 v[244:247], v[28:31], v[80:83], v[244:247]
  ds_read_b64_tr_b16 v[42:43], v3 offset:9216
  v_mfma_f32_16x16x32_bf16 v[228:231], v[28:31], v[72:75], v[228:231]
  ds_read_b64_tr_b16 v[28:29], v4 offset:0
  s_waitcnt lgkmcnt(9)
  v_mfma_f32_16x16x32_bf16 v[228:231], v[44:47], v[76:79], v[228:231]
  ds_read_b64_tr_b16 v[30:31], v4 offset:1024
  v_mfma_f32_16x16x32_bf16 v[88:91], v[16:19], v[48:51], v[88:91]
  ds_read_b64_tr_b16 v[44:45], v4 offset:8192
  v_mfma_f32_16x16x32_bf16 v[88:91], v[32:35], v[52:55], v[88:91]
  ds_read_b64_tr_b16 v[46:47], v4 offset:9216
  v_mfma_f32_16x16x32_bf16 v[104:107], v[32:35], v[60:63], v[104:107]
  ds_read_b128 v[72:75], v5 offset:6144
  s_waitcnt lgkmcnt(9)
  v_mfma_f32_16x16x32_bf16 v[104:107], v[16:19], v[56:59], v[104:107]
  ds_read_b128 v[76:79], v7 offset:6144
  v_mfma_f32_16x16x32_bf16 v[108:111], v[20:23], v[56:59], v[108:111]
  ds_read_b128 v[80:83], v5 offset:8192
  v_mfma_f32_16x16x32_bf16 v[108:111], v[36:39], v[60:63], v[108:111]
  ds_read_b128 v[84:87], v7 offset:8192
  v_mfma_f32_16x16x32_bf16 v[92:95], v[36:39], v[52:55], v[92:95]
  s_waitcnt lgkmcnt(8)
  v_mfma_f32_16x16x32_bf16 v[92:95], v[20:23], v[48:51], v[92:95]
  v_mfma_f32_16x16x32_bf16 v[96:99], v[24:27], v[48:51], v[96:99]
  v_xor_b32 v1, 16384, v1
  v_mfma_f32_16x16x32_bf16 v[96:99], v[40:43], v[52:55], v[96:99]
  v_xor_b32 v2, 16384, v2
  v_mfma_f32_16x16x32_bf16 v[112:115], v[40:43], v[60:63], v[112:115]
  v_xor_b32 v3, 16384, v3
  s_waitcnt lgkmcnt(4)
  v_mfma_f32_16x16x32_bf16 v[112:115], v[24:27], v[56:59], v[112:115]
  v_xor_b32 v4, 16384, v4
  v_mfma_f32_16x16x32_bf16 v[116:119], v[28:31], v[56:59], v[116:119]
  ds_read_b128 v[56:59], v5 offset:12288
  v_mfma_f32_16x16x32_bf16 v[116:119], v[44:47], v[60:63], v[116:119]
  ds_read_b128 v[60:63], v7 offset:12288
  v_mfma_f32_16x16x32_bf16 v[100:103], v[44:47], v[52:55], v[100:103]
  ds_read_b128 v[52:55], v7 offset:10240
  v_mfma_f32_16x16x32_bf16 v[100:103], v[28:31], v[48:51], v[100:103]
  ds_read_b128 v[48:51], v5 offset:10240
  v_mfma_f32_16x16x32_bf16 v[120:123], v[16:19], v[64:67], v[120:123]
  s_waitcnt lgkmcnt(6)
  v_mfma_f32_16x16x32_bf16 v[120:123], v[32:35], v[68:71], v[120:123]
  v_mfma_f32_16x16x32_bf16 v[136:139], v[32:35], v[76:79], v[136:139]
  v_mfma_f32_16x16x32_bf16 v[136:139], v[16:19], v[72:75], v[136:139]
  v_mfma_f32_16x16x32_bf16 v[140:143], v[20:23], v[72:75], v[140:143]
  v_mfma_f32_16x16x32_bf16 v[140:143], v[36:39], v[76:79], v[140:143]
  v_mfma_f32_16x16x32_bf16 v[124:127], v[36:39], v[68:71], v[124:127]
  v_mfma_f32_16x16x32_bf16 v[124:127], v[20:23], v[64:67], v[124:127]
  v_mfma_f32_16x16x32_bf16 v[128:131], v[24:27], v[64:67], v[128:131]
  v_mfma_f32_16x16x32_bf16 v[128:131], v[40:43], v[68:71], v[128:131]
  v_mfma_f32_16x16x32_bf16 v[144:147], v[40:43], v[76:79], v[144:147]
  v_mfma_f32_16x16x32_bf16 v[144:147], v[24:27], v[72:75], v[144:147]
  v_mfma_f32_16x16x32_bf16 v[148:151], v[28:31], v[72:75], v[148:151]
  ds_read_b128 v[72:75], v5 offset:16384
  v_mfma_f32_16x16x32_bf16 v[148:151], v[44:47], v[76:79], v[148:151]
  ds_read_b128 v[76:79], v7 offset:16384
  v_mfma_f32_16x16x32_bf16 v[132:135], v[44:47], v[68:71], v[132:135]
  ds_read_b128 v[68:71], v7 offset:14336
  s_waitcnt lgkmcnt(7)
  v_mfma_f32_16x16x32_bf16 v[132:135], v[28:31], v[64:67], v[132:135]
  ds_read_b128 v[64:67], v5 offset:14336
  v_mfma_f32_16x16x32_bf16 v[152:155], v[16:19], v[80:83], v[152:155]
  s_waitcnt lgkmcnt(4)
  v_mfma_f32_16x16x32_bf16 v[152:155], v[32:35], v[84:87], v[152:155]
  v_mfma_f32_16x16x32_bf16 v[168:171], v[32:35], v[52:55], v[168:171]
  v_mfma_f32_16x16x32_bf16 v[168:171], v[16:19], v[48:51], v[168:171]
  v_mfma_f32_16x16x32_bf16 v[172:175], v[20:23], v[48:51], v[172:175]
  v_mfma_f32_16x16x32_bf16 v[172:175], v[36:39], v[52:55], v[172:175]
  v_mfma_f32_16x16x32_bf16 v[156:159], v[36:39], v[84:87], v[156:159]
  v_mfma_f32_16x16x32_bf16 v[156:159], v[20:23], v[80:83], v[156:159]
  v_mfma_f32_16x16x32_bf16 v[160:163], v[24:27], v[80:83], v[160:163]
  v_mfma_f32_16x16x32_bf16 v[160:163], v[40:43], v[84:87], v[160:163]
  v_mfma_f32_16x16x32_bf16 v[176:179], v[40:43], v[52:55], v[176:179]
  v_mfma_f32_16x16x32_bf16 v[176:179], v[24:27], v[48:51], v[176:179]
  v_mfma_f32_16x16x32_bf16 v[180:183], v[28:31], v[48:51], v[180:183]
  v_mfma_f32_16x16x32_bf16 v[180:183], v[44:47], v[52:55], v[180:183]
  v_mfma_f32_16x16x32_bf16 v[164:167], v[44:47], v[84:87], v[164:167]
  ds_read_b128 v[84:87], v7 offset:18432
  v_mfma_f32_16x16x32_bf16 v[164:167], v[28:31], v[80:83], v[164:167]
  ds_read_b128 v[80:83], v5 offset:18432
  v_mfma_f32_16x16x32_bf16 v[184:187], v[16:19], v[56:59], v[184:187]
  s_waitcnt lgkmcnt(2)
  s_add_u32 s72, s72, 1
  s_cmp_lt_u32 s72, 8
  v_mfma_f32_16x16x32_bf16 v[184:187], v[32:35], v[60:63], v[184:187]
  v_mfma_f32_16x16x32_bf16 v[200:203], v[32:35], v[68:71], v[200:203]
  v_mfma_f32_16x16x32_bf16 v[200:203], v[16:19], v[64:67], v[200:203]
  v_mfma_f32_16x16x32_bf16 v[204:207], v[20:23], v[64:67], v[204:207]
  v_mfma_f32_16x16x32_bf16 v[204:207], v[36:39], v[68:71], v[204:207]
  s_waitcnt lgkmcnt(0)
  s_barrier
  v_mfma_f32_16x16x32_bf16 v[188:191], v[36:39], v[60:63], v[188:191]
  ds_read_b128 v[48:51], v5 offset:40960
  v_mfma_f32_16x16x32_bf16 v[188:191], v[20:23], v[56:59], v[188:191]
  ds_read_b128 v[52:55], v7 offset:40960
  v_mfma_f32_16x16x32_bf16 v[192:195], v[24:27], v[56:59], v[192:195]
  v_mfma_f32_16x16x32_bf16 v[192:195], v[40:43], v[60:63], v[192:195]
  v_mfma_f32_16x16x32_bf16 v[208:211], v[40:43], v[68:71], v[208:211]
  v_mfma_f32_16x16x32_bf16 v[208:211], v[24:27], v[64:67], v[208:211]
  v_mfma_f32_16x16x32_bf16 v[212:215], v[28:31], v[64:67], v[212:215]
  ds_read_b128 v[64:67], v5 offset:45056
  v_mfma_f32_16x16x32_bf16 v[212:215], v[44:47], v[68:71], v[212:215]
  ds_read_b128 v[68:71], v7 offset:45056
  v_mfma_f32_16x16x32_bf16 v[196:199], v[44:47], v[60:63], v[196:199]
  ds_read_b128 v[60:63], v7 offset:43008
  v_mfma_f32_16x16x32_bf16 v[196:199], v[28:31], v[56:59], v[196:199]
  ds_read_b128 v[56:59], v5 offset:43008
  v_mfma_f32_16x16x32_bf16 v[216:219], v[32:35], v[76:79], v[216:219]
  v_mfma_f32_16x16x32_bf16 v[216:219], v[16:19], v[72:75], v[216:219]
  v_mfma_f32_16x16x32_bf16 v[232:235], v[16:19], v[80:83], v[232:235]
  ds_read_b64_tr_b16 v[16:17], v1 offset:0
  v_mfma_f32_16x16x32_bf16 v[232:235], v[32:35], v[84:87], v[232:235]
  ds_read_b64_tr_b16 v[18:19], v1 offset:1024
  v_mfma_f32_16x16x32_bf16 v[236:239], v[36:39], v[84:87], v[236:239]
  ds_read_b64_tr_b16 v[32:33], v1 offset:8192
  v_mfma_f32_16x16x32_bf16 v[236:239], v[20:23], v[80:83], v[236:239]
  ds_read_b64_tr_b16 v[34:35], v1 offset:9216
  v_mfma_f32_16x16x32_bf16 v[220:223], v[20:23], v[72:75], v[220:223]
  ds_read_b64_tr_b16 v[20:21], v2 offset:0
  v_mfma_f32_16x16x32_bf16 v[220:223], v[36:39], v[76:79], v[220:223]
  ds_read_b64_tr_b16 v[22:23], v2 offset:1024
  v_mfma_f32_16x16x32_bf16 v[224:227], v[40:43], v[76:79], v[224:227]
  ds_read_b64_tr_b16 v[36:37], v2 offset:8192
  v_mfma_f32_16x16x32_bf16 v[224:227], v[24:27], v[72:75], v[224:227]
  ds_read_b64_tr_b16 v[38:39], v2 offset:9216
  v_mfma_f32_16x16x32_bf16 v[240:243], v[24:27], v[80:83], v[240:243]
  ds_read_b64_tr_b16 v[24:25], v3 offset:0
  v_mfma_f32_16x16x32_bf16 v[240:243], v[40:43], v[84:87], v[240:243]
  ds_read_b64_tr_b16 v[26:27], v3 offset:1024
  v_mfma_f32_16x16x32_bf16 v[244:247], v[44:47], v[84:87], v[244:247]
  ds_read_b64_tr_b16 v[40:41], v3 offset:8192
  v_mfma_f32_16x16x32_bf16 v[244:247], v[28:31], v[80:83], v[244:247]
  ds_read_b64_tr_b16 v[42:43], v3 offset:9216
  v_mfma_f32_16x16x32_bf16 v[228:231], v[28:31], v[72:75], v[228:231]
  ds_read_b64_tr_b16 v[28:29], v4 offset:0
  s_waitcnt lgkmcnt(9)
  v_mfma_f32_16x16x32_bf16 v[228:231], v[44:47], v[76:79], v[228:231]
  ds_read_b64_tr_b16 v[30:31], v4 offset:1024
  s_cbranch_scc1 L_dnn_loop0
L_tail:
  v_mfma_f32_16x16x32_bf16 v[88:91], v[16:19], v[48:51], v[88:91]
  ds_read_b64_tr_b16 v[44:45], v4 offset:8192
  v_mfma_f32_16x16x32_bf16 v[88:91], v[32:35], v[52:55], v[88:91]
  ds_read_b64_tr_b16 v[46:47], v4 offset:9216
  v_mfma_f32_16x16x32_bf16 v[104:107], v[32:35], v[60:63], v[104:107]
  ds_read_b128 v[72:75], v5 offset:47104
  s_waitcnt lgkmcnt(9)
  v_mfma_f32_16x16x32_bf16 v[104:107], v[16:19], v[56:59], v[104:107]
  ds_read_b128 v[76:79], v7 offset:47104
  v_mfma_f32_16x16x32_bf16 v[108:111], v[20:23], v[56:59], v[108:111]
  ds_read_b128 v[80:83], v5 offset:49152
  v_mfma_f32_16x16x32_bf16 v[108:111], v[36:39], v[60:63], v[108:111]
  ds_read_b128 v[84:87], v7 offset:49152
  v_mul_f32 v11, v88, v88
  v_mfma_f32_16x16x32_bf16 v[92:95], v[36:39], v[52:55], v[92:95]
  s_waitcnt lgkmcnt(8)
  v_mul_f32 v248, v89, v89
  v_mul_f32 v249, v90, v90
  v_mfma_f32_16x16x32_bf16 v[92:95], v[20:23], v[48:51], v[92:95]
  v_mul_f32 v250, v91, v91
  v_fma_f32 v11, v11, v14, v12
  v_mfma_f32_16x16x32_bf16 v[96:99], v[24:27], v[48:51], v[96:99]
  v_fma_f32 v248, v248, v14, v12
  v_fma_f32 v249, v249, v14, v12
  v_mfma_f32_16x16x32_bf16 v[96:99], v[40:43], v[52:55], v[96:99]
  v_fma_f32 v250, v250, v14, v12
  v_mul_f32 v11, v11, v88
  v_mfma_f32_16x16x32_bf16 v[112:115], v[40:43], v[60:63], v[112:115]
  s_waitcnt lgkmcnt(4)
  v_mul_f32 v248, v248, v89
  v_mul_f32 v249, v249, v90
  v_mfma_f32_16x16x32_bf16 v[112:115], v[24:27], v[56:59], v[112:115]
  v_mul_f32_e64 v250, v250, v91
  v_mfma_f32_16x16x32_bf16 v[116:119], v[28:31], v[56:59], v[116:119]
  ds_read_b128 v[56:59], v5 offset:53248
  v_mfma_f32_16x16x32_bf16 v[116:119], v[44:47], v[60:63], v[116:119]
  ds_read_b128 v[60:63], v7 offset:53248
  v_mfma_f32_16x16x32_bf16 v[100:103], v[44:47], v[52:55], v[100:103]
  ds_read_b128 v[52:55], v7 offset:51200
  v_mfma_f32_16x16x32_bf16 v[100:103], v[28:31], v[48:51], v[100:103]
  ds_read_b128 v[48:51], v5 offset:51200
  v_mfma_f32_16x16x32_bf16 v[120:123], v[16:19], v[64:67], v[120:123]
  s_waitcnt lgkmcnt(6)
  v_exp_f32 v11, v11
  v_mfma_f32_16x16x32_bf16 v[120:123], v[32:35], v[68:71], v[120:123]
  v_exp_f32 v248, v248
  v_mfma_f32_16x16x32_bf16 v[136:139], v[32:35], v[76:79], v[136:139]
  v_exp_f32 v249, v249
  v_mfma_f32_16x16x32_bf16 v[136:139], v[16:19], v[72:75], v[136:139]
  v_exp_f32_e64 v250, v250
  v_mfma_f32_16x16x32_bf16 v[140:143], v[20:23], v[72:75], v[140:143]
  v_add_f32 v11, 1.0, v11
  v_add_f32 v248, 1.0, v248
  v_mfma_f32_16x16x32_bf16 v[140:143], v[36:39], v[76:79], v[140:143]
  v_add_f32 v249, 1.0, v249
  v_add_f32 v250, 1.0, v250
  v_mfma_f32_16x16x32_bf16 v[124:127], v[36:39], v[68:71], v[124:127]
  v_rcp_f32 v11, v11
  v_mfma_f32_16x16x32_bf16 v[124:127], v[20:23], v[64:67], v[124:127]
  v_rcp_f32 v248, v248
  v_mfma_f32_16x16x32_bf16 v[128:131], v[24:27], v[64:67], v[128:131]
  v_rcp_f32 v249, v249
  v_mfma_f32_16x16x32_bf16 v[128:131], v[40:43], v[68:71], v[128:131]
  v_rcp_f32 v250, v250
  v_mfma_f32_16x16x32_bf16 v[144:147], v[40:43], v[76:79], v[144:147]
  v_mul_f32 v88, v88, v11
  v_mul_f32 v89, v89, v248
  v_mfma_f32_16x16x32_bf16 v[144:147], v[24:27], v[72:75], v[144:147]
  v_mul_f32 v90, v90, v249
  v_mul_f32 v91, v91, v250
  v_mfma_f32_16x16x32_bf16 v[148:151], v[28:31], v[72:75], v[148:151]
  ds_read_b128 v[72:75], v5 offset:57344
  v_mul_f32 v11, v92, v92
  v_mfma_f32_16x16x32_bf16 v[148:151], v[44:47], v[76:79], v[148:151]
  ds_read_b128 v[76:79], v7 offset:57344
  v_mul_f32 v248, v93, v93
  v_mfma_f32_16x16x32_bf16 v[132:135], v[44:47], v[68:71], v[132:135]
  ds_read_b128 v[68:71], v7 offset:55296
  s_waitcnt lgkmcnt(7)
  v_mul_f32 v249, v94, v94
  v_mfma_f32_16x16x32_bf16 v[132:135], v[28:31], v[64:67], v[132:135]
  ds_read_b128 v[64:67], v5 offset:55296
  v_mul_f32 v250, v95, v95
  v_mfma_f32_16x16x32_bf16 v[152:155], v[16:19], v[80:83], v[152:155]
  s_waitcnt lgkmcnt(4)
  v_fma_f32 v11, v11, v14, v12
  v_fma_f32 v248, v248, v14, v12
  v_mfma_f32_16x16x32_bf16 v[152:155], v[32:35], v[84:87], v[152:155]
  v_fma_f32 v249, v249, v14, v12
  v_fma_f32 v250, v250, v14, v12
  v_mfma_f32_16x16x32_bf16 v[168:171], v[32:35], v[52:55], v[168:171]
  v_mul_f32 v11, v11, v92
  v_mul_f32 v248, v248, v93
  v_mfma_f32_16x16x32_bf16 v[168:171], v[16:19], v[48:51], v[168:171]
  v_mul_f32 v249, v249, v94
  v_mul_f32 v250, v250, v95
  v_mfma_f32_16x16x32_bf16 v[172:175], v[20:23], v[48:51], v[172:175]
  v_exp_f32 v11, v11
  v_mfma_f32_16x16x32_bf16 v[172:175], v[36:39], v[52:55], v[172:175]
  v_exp_f32 v248, v248
  v_mfma_f32_16x16x32_bf16 v[156:159], v[36:39], v[84:87], v[156:159]
  v_exp_f32_e64 v249, v249
  v_mfma_f32_16x16x32_bf16 v[156:159], v[20:23], v[80:83], v[156:159]
  v_exp_f32 v250, v250
  v_mfma_f32_16x16x32_bf16 v[160:163], v[24:27], v[80:83], v[160:163]
  v_add_f32 v11, 1.0, v11
  v_add_f32 v248, 1.0, v248
  v_mfma_f32_16x16x32_bf16 v[160:163], v[40:43], v[84:87], v[160:163]
  v_add_f32 v249, 1.0, v249
  v_add_f32 v250, 1.0, v250
  v_mfma_f32_16x16x32_bf16 v[176:179], v[40:43], v[52:55], v[176:179]
  v_rcp_f32 v11, v11
  v_mfma_f32_16x16x32_bf16 v[176:179], v[24:27], v[48:51], v[176:179]
  v_rcp_f32 v248, v248
  v_mfma_f32_16x16x32_bf16 v[180:183], v[28:31], v[48:51], v[180:183]
  v_rcp_f32 v249, v249
  v_mfma_f32_16x16x32_bf16 v[180:183], v[44:47], v[52:55], v[180:183]
  v_rcp_f32 v250, v250
  v_mfma_f32_16x16x32_bf16 v[164:167], v[44:47], v[84:87], v[164:167]
  ds_read_b128 v[84:87], v7 offset:59392
  v_mul_f32 v92, v92, v11
  v_mfma_f32_16x16x32_bf16 v[164:167], v[28:31], v[80:83], v[164:167]
  ds_read_b128 v[80:83], v5 offset:59392
  v_mul_f32 v93, v93, v248
  v_mfma_f32_16x16x32_bf16 v[184:187], v[16:19], v[56:59], v[184:187]
  s_waitcnt lgkmcnt(2)
  v_mul_f32 v94, v94, v249
  v_mul_f32 v95, v95, v250
  v_mfma_f32_16x16x32_bf16 v[184:187], v[32:35], v[60:63], v[184:187]
  v_mul_f32 v11, v96, v96
  v_mul_f32 v248, v97, v97
  v_mfma_f32_16x16x32_bf16 v[200:203], v[32:35], v[68:71], v[200:203]
  v_mul_f32 v249, v98, v98
  v_mul_f32 v250, v99, v99
  v_mfma_f32_16x16x32_bf16 v[200:203], v[16:19], v[64:67], v[200:203]
  v_fma_f32 v11, v11, v14, v12
  v_fma_f32 v248, v248, v14, v12
  v_mfma_f32_16x16x32_bf16 v[204:207], v[20:23], v[64:67], v[204:207]
  v_fma_f32 v249, v249, v14, v12
  v_fma_f32 v250, v250, v14, v12
  v_mfma_f32_16x16x32_bf16 v[204:207], v[36:39], v[68:71], v[204:207]
  v_mul_f32 v11, v11, v96
  v_mul_f32 v248, v248, v97
  v_mfma_f32_16x16x32_bf16 v[188:191], v[36:39], v[60:63], v[188:191]
  v_mul_f32 v249, v249, v98
  v_mul_f32 v250, v250, v99
  v_mfma_f32_16x16x32_bf16 v[188:191], v[20:23], v[56:59], v[188:191]
  v_exp_f32 v11, v11
  v_mfma_f32_16x16x32_bf16 v[192:195], v[24:27], v[56:59], v[192:195]
  v_exp_f32 v248, v248
  v_mfma_f32_16x16x32_bf16 v[192:195], v[40:43], v[60:63], v[192:195]
  v_exp_f32 v249, v249
  v_mfma_f32_16x16x32_bf16 v[208:211], v[40:43], v[68:71], v[208:211]
  v_exp_f32 v250, v250
  v_mfma_f32_16x16x32_bf16 v[208:211], v[24:27], v[64:67], v[208:211]
  v_add_f32 v11, 1.0, v11
  v_add_f32 v248, 1.0, v248
  v_mfma_f32_16x16x32_bf16 v[212:215], v[28:31], v[64:67], v[212:215]
  v_add_f32 v249, 1.0, v249
  v_add_f32 v250, 1.0, v250
  v_mfma_f32_16x16x32_bf16 v[212:215], v[44:47], v[68:71], v[212:215]
  v_rcp_f32 v11, v11
  v_mfma_f32_16x16x32_bf16 v[196:199], v[44:47], v[60:63], v[196:199]
  v_rcp_f32 v248, v248
  v_mfma_f32_16x16x32_bf16 v[196:199], v[28:31], v[56:59], v[196:199]
  v_rcp_f32_e64 v249, v249
  v_mfma_f32_16x16x32_bf16 v[216:219], v[32:35], v[76:79], v[216:219]
  s_waitcnt lgkmcnt(0)
  v_rcp_f32 v250, v250
  v_mfma_f32_16x16x32_bf16 v[216:219], v[16:19], v[72:75], v[216:219]
  v_mul_f32 v96, v96, v11
  v_mul_f32 v97, v97, v248
  v_mfma_f32_16x16x32_bf16 v[232:235], v[16:19], v[80:83], v[232:235]
  v_mul_f32 v98, v98, v249
  v_mul_f32 v99, v99, v250
  v_mfma_f32_16x16x32_bf16 v[232:235], v[32:35], v[84:87], v[232:235]
  v_mul_f32 v11, v100, v100
  v_mul_f32 v248, v101, v101
  v_mfma_f32_16x16x32_bf16 v[236:239], v[36:39], v[84:87], v[236:239]
  v_mul_f32 v249, v102, v102
  v_mul_f32 v250, v103, v103
  v_mfma_f32_16x16x32_bf16 v[236:239], v[20:23], v[80:83], v[236:239]
  v_fma_f32 v11, v11, v14, v12
  v_fma_f32 v248, v248, v14, v12
  v_mfma_f32_16x16x32_bf16 v[220:223], v[20:23], v[72:75], v[220:223]
  v_fma_f32 v249, v249, v14, v12
  v_fma_f32 v250, v250, v14, v12
  v_mfma_f32_16x16x32_bf16 v[220:223], v[36:39], v[76:79], v[220:223]
  v_mul_f32 v11, v11, v100
  v_mul_f32 v248, v248, v101
  v_mfma_f32_16x16x32_bf16 v[224:227], v[40:43], v[76:79], v[224:227]
  v_mul_f32 v249, v249, v102
  v_mul_f32 v250, v250, v103
  v_mfma_f32_16x16x32_bf16 v[224:227], v[24:27], v[72:75], v[224:227]
  v_exp_f32 v11, v11
  v_mfma_f32_16x16x32_bf16 v[240:243], v[24:27], v[80:83], v[240:243]
  v_exp_f32 v248, v248
  v_mfma_f32_16x16x32_bf16 v[240:243], v[40:43], v[84:87], v[240:243]
  v_exp_f32 v249, v249
  v_mfma_f32_16x16x32_bf16 v[244:247], v[44:47], v[84:87], v[244:247]
  v_exp_f32 v250, v250
  v_mfma_f32_16x16x32_bf16 v[244:247], v[28:31], v[80:83], v[244:247]
  v_add_f32 v11, 1.0, v11
  v_add_f32 v248, 1.0, v248
  v_mfma_f32_16x16x32_bf16 v[228:231], v[28:31], v[72:75], v[228:231]
  v_add_f32 v249, 1.0, v249
  v_add_f32 v250, 1.0, v250
  v_mfma_f32_16x16x32_bf16 v[228:231], v[44:47], v[76:79], v[228:231]
  v_rcp_f32 v11, v11
  v_rcp_f32 v248, v248
  v_rcp_f32 v249, v249
  v_rcp_f32 v250, v250
  v_mul_f32 v100, v100, v11
  v_mul_f32 v101, v101, v248
  v_mul_f32 v102, v102, v249
  v_mul_f32 v103, v103, v250
  ds_read_b64 v[18:19], v9 offset:256
  ds_read_b64 v[22:23], v9 offset:288
  ds_read_b64 v[26:27], v9 offset:320
  ds_read_b64 v[30:31], v9 offset:352
  v_mov_b32 v248, 1.0
  v_mov_b32 v249, 1.0
L_epi:
  v_mov_b32 v84, 0xc1c00000
  v_mov_b32 v85, 0xc1c00000
  v_mov_b32 v86, 0x4b800000
  v_mov_b32 v87, 0x4b800000
  v_pk_mul_f32 v[52:53], v[104:105], v[104:105]
  v_pk_mul_f32 v[56:57], v[106:107], v[106:107]
  v_pk_mul_f32 v[60:61], v[108:109], v[108:109]
  v_pk_mul_f32 v[64:65], v[110:111], v[110:111]
  v_pk_mul_f32 v[68:69], v[120:121], v[120:121]
  v_pk_mul_f32 v[72:73], v[122:123], v[122:123]
  v_pk_mul_f32 v[76:77], v[124:125], v[124:125]
  v_pk_mul_f32 v[80:81], v[126:127], v[126:127]
  v_pk_fma_f32 v[52:53], v[52:53], v[14:15], v[12:13]
  v_pk_fma_f32 v[56:57], v[56:57], v[14:15], v[12:13]
  v_pk_fma_f32 v[60:61], v[60:61], v[14:15], v[12:13]
  v_pk_fma_f32 v[64:65], v[64:65], v[14:15], v[12:13]
  v_pk_fma_f32 v[68:69], v[68:69], v[14:15], v[12:13]
  v_pk_fma_f32 v[72:73], v[72:73], v[14:15], v[12:13]
  v_pk_fma_f32 v[76:77], v[76:77], v[14:15], v[12:13]
  v_pk_fma_f32 v[80:81], v[80:81], v[14:15], v[12:13]
  v_pk_fma_f32 v[52:53], v[52:53], v[104:105], v[84:85]
  v_pk_fma_f32 v[56:57], v[56:57], v[106:107], v[84:85]
  v_pk_fma_f32 v[60:61], v[60:61], v[108:109], v[84:85]
  v_pk_fma_f32 v[64:65], v[64:65], v[110:111], v[84:85]
  v_pk_fma_f32 v[68:69], v[68:69], v[120:121], v[84:85]
  v_pk_fma_f32 v[72:73], v[72:73], v[122:123], v[84:85]
  v_pk_fma_f32 v[76:77], v[76:77], v[124:125], v[84:85]
  v_pk_fma_f32 v[80:81], v[80:81], v[126:127], v[84:85]
  v_exp_f32 v52, v52 clamp
  v_exp_f32 v53, v53 clamp
  v_exp_f32 v56, v56 clamp
  v_exp_f32 v57, v57 clamp
  v_exp_f32 v60, v60 clamp
  v_exp_f32 v61, v61 clamp
  v_exp_f32 v64, v64 clamp
  v_exp_f32 v65, v65 clamp
  v_exp_f32 v68, v68 clamp
  v_exp_f32 v69, v69 clamp
  v_exp_f32 v72, v72 clamp
  v_exp_f32 v73, v73 clamp
  v_exp_f32 v76, v76 clamp
  v_exp_f32 v77, v77 clamp
  v_exp_f32 v80, v80 clamp
  v_exp_f32 v81, v81 clamp
  s_waitcnt lgkmcnt(3)
  v_lshlrev_b32 v16, 16, v18
  v_and_b32 v17, 0xffff0000, v18
  v_lshlrev_b32 v18, 16, v19
  v_and_b32 v19, 0xffff0000, v19
  s_waitcnt lgkmcnt(2)
  v_lshlrev_b32 v20, 16, v22
  v_and_b32 v21, 0xffff0000, v22
  v_lshlrev_b32 v22, 16, v23
  v_and_b32 v23, 0xffff0000, v23
  s_waitcnt lgkmcnt(1)
  v_lshlrev_b32 v24, 16, v26
  v_and_b32 v25, 0xffff0000, v26
  v_lshlrev_b32 v26, 16, v27
  v_and_b32 v27, 0xffff0000, v27
  s_waitcnt lgkmcnt(0)
  v_lshlrev_b32_e64 v28, 16, v30
  v_and_b32 v29, 0xffff0000, v30
  v_lshlrev_b32_e64 v30, 16, v31
  v_and_b32 v31, 0xffff0000, v31
  v_pk_mul_f32 v[54:55], v[104:105], v[16:17]
  v_pk_mul_f32 v[58:59], v[106:107], v[18:19]
  v_pk_mul_f32 v[62:63], v[108:109], v[20:21]
  v_pk_mul_f32 v[66:67], v[110:111], v[22:23]
  v_pk_mul_f32 v[70:71], v[120:121], v[16:17]
  v_pk_mul_f32 v[74:75], v[122:123], v[18:19]
  v_pk_mul_f32 v[78:79], v[124:125], v[20:21]
  v_pk_mul_f32 v[82:83], v[126:127], v[22:23]
  v_pk_fma_f32 v[52:53], v[52:53], v[86:87], v[248:249]
  v_pk_fma_f32 v[56:57], v[56:57], v[86:87], v[248:249]
  v_pk_fma_f32 v[60:61], v[60:61], v[86:87], v[248:249]
  v_pk_fma_f32 v[64:65], v[64:65], v[86:87], v[248:249]
  v_pk_fma_f32 v[68:69], v[68:69], v[86:87], v[248:249]
  v_pk_fma_f32 v[72:73], v[72:73], v[86:87], v[248:249]
  v_pk_fma_f32 v[76:77], v[76:77], v[86:87], v[248:249]
  v_pk_fma_f32 v[80:81], v[80:81], v[86:87], v[248:249]
  v_pk_mul_f32 v[54:55], v[54:55], v[56:57]
  v_pk_mul_f32 v[62:63], v[62:63], v[64:65]
  v_pk_mul_f32 v[70:71], v[70:71], v[72:73]
  v_pk_mul_f32 v[78:79], v[78:79], v[80:81]
  v_pk_fma_f32 v[54:55], v[58:59], v[52:53], v[54:55]
  v_pk_fma_f32 v[62:63], v[66:67], v[60:61], v[62:63]
  v_pk_fma_f32 v[70:71], v[74:75], v[68:69], v[70:71]
  v_pk_fma_f32 v[78:79], v[82:83], v[76:77], v[78:79]
  v_pk_mul_f32 v[52:53], v[52:53], v[56:57]
  v_pk_mul_f32 v[60:61], v[60:61], v[64:65]
  v_pk_mul_f32 v[68:69], v[68:69], v[72:73]
  v_pk_mul_f32 v[76:77], v[76:77], v[80:81]
  v_pk_mul_f32 v[54:55], v[54:55], v[60:61]
  v_pk_mul_f32 v[70:71], v[70:71], v[76:77]
  v_pk_fma_f32 v[54:55], v[62:63], v[52:53], v[54:55]
  v_pk_fma_f32 v[70:71], v[78:79], v[68:69], v[70:71]
  v_pk_mul_f32 v[52:53], v[52:53], v[60:61]
  v_pk_mul_f32 v[68:69], v[68:69], v[76:77]
  v_rcp_f32 v52, v52
  v_rcp_f32 v53, v53
  v_rcp_f32 v68, v68
  v_rcp_f32 v69, v69
  v_pk_mul_f32 v[34:35], v[52:53], v[54:55]
  v_pk_mul_f32 v[36:37], v[68:69], v[70:71]
  v_pk_mul_f32 v[52:53], v[112:113], v[112:113]
  v_pk_mul_f32 v[56:57], v[114:115], v[114:115]
  v_pk_mul_f32 v[60:61], v[116:117], v[116:117]
  v_pk_mul_f32 v[64:65], v[118:119], v[118:119]
  v_pk_mul_f32 v[68:69], v[128:129], v[128:129]
  v_pk_mul_f32 v[72:73], v[130:131], v[130:131]
  v_pk_mul_f32 v[76:77], v[132:133], v[132:133]
  v_pk_mul_f32 v[80:81], v[134:135], v[134:135]
  v_pk_fma_f32 v[52:53], v[52:53], v[14:15], v[12:13]
  v_pk_fma_f32 v[56:57], v[56:57], v[14:15], v[12:13]
  v_pk_fma_f32 v[60:61], v[60:61], v[14:15], v[12:13]
  v_pk_fma_f32 v[64:65], v[64:65], v[14:15], v[12:13]
  v_pk_fma_f32 v[68:69], v[68:69], v[14:15], v[12:13]
  v_pk_fma_f32 v[72:73], v[72:73], v[14:15], v[12:13]
  v_pk_fma_f32 v[76:77], v[76:77], v[14:15], v[12:13]
  v_pk_fma_f32 v[80:81], v[80:81], v[14:15], v[12:13]
  v_pk_fma_f32 v[52:53], v[52:53], v[112:113], v[84:85]
  v_pk_fma_f32 v[56:57], v[56:57], v[114:115], v[84:85]
  v_pk_fma_f32 v[60:61], v[60:61], v[116:117], v[84:85]
  v_pk_fma_f32 v[64:65], v[64:65], v[118:119], v[84:85]
  v_pk_fma_f32 v[68:69], v[68:69], v[128:129], v[84:85]
  v_pk_fma_f32 v[72:73], v[72:73], v[130:131], v[84:85]
  v_pk_fma_f32 v[76:77], v[76:77], v[132:133], v[84:85]
  v_pk_fma_f32 v[80:81], v[80:81], v[134:135], v[84:85]
  v_exp_f32 v52, v52 clamp
  v_exp_f32 v53, v53 clamp
  v_exp_f32 v56, v56 clamp
  v_exp_f32 v57, v57 clamp
  v_exp_f32 v60, v60 clamp
  v_exp_f32 v61, v61 clamp
  v_exp_f32 v64, v64 clamp
  v_exp_f32 v65, v65 clamp
  v_exp_f32 v68, v68 clamp
  v_exp_f32 v69, v69 clamp
  v_exp_f32 v72, v72 clamp
  v_exp_f32 v73, v73 clamp
  v_exp_f32 v76, v76 clamp
  v_exp_f32 v77, v77 clamp
  v_exp_f32 v80, v80 clamp
  v_exp_f32 v81, v81 clamp
  v_pk_mul_f32 v[54:55], v[112:113], v[24:25]
  v_pk_mul_f32 v[58:59], v[114:115], v[26:27]
  v_pk_mul_f32 v[62:63], v[116:117], v[28:29]
  v_pk_mul_f32 v[66:67], v[118:119], v[30:31]
  v_pk_mul_f32 v[70:71], v[128:129], v[24:25]
  v_pk_mul_f32 v[74:75], v[130:131], v[26:27]
  v_pk_mul_f32 v[78:79], v[132:133], v[28:29]
  v_pk_mul_f32 v[82:83], v[134:135], v[30:31]
  v_pk_fma_f32 v[52:53], v[52:53], v[86:87], v[248:249]
  v_pk_fma_f32 v[56:57], v[56:57], v[86:87], v[248:249]
  v_pk_fma_f32 v[60:61], v[60:61], v[86:87], v[248:249]
  v_pk_fma_f32 v[64:65], v[64:65], v[86:87], v[248:249]
  v_pk_fma_f32 v[68:69], v[68:69], v[86:87], v[248:249]
  v_pk_fma_f32 v[72:73], v[72:73], v[86:87], v[248:249]
  v_pk_fma_f32 v[76:77], v[76:77], v[86:87], v[248:249]
  v_pk_fma_f32 v[80:81], v[80:81], v[86:87], v[248:249]
  v_pk_mul_f32 v[54:55], v[54:55], v[56:57]
  v_pk_mul_f32 v[62:63], v[62:63], v[64:65]
  v_pk_mul_f32 v[70:71], v[70:71], v[72:73]
  v_pk_mul_f32 v[78:79], v[78:79], v[80:81]
  v_pk_fma_f32 v[54:55], v[58:59], v[52:53], v[54:55]
  v_pk_fma_f32 v[62:63], v[66:67], v[60:61], v[62:63]
  v_pk_fma_f32 v[70:71], v[74:75], v[68:69], v[70:71]
  v_pk_fma_f32 v[78:79], v[82:83], v[76:77], v[78:79]
  v_pk_mul_f32 v[52:53], v[52:53], v[56:57]
  v_pk_mul_f32 v[60:61], v[60:61], v[64:65]
  v_pk_mul_f32 v[68:69], v[68:69], v[72:73]
  v_pk_mul_f32 v[76:77], v[76:77], v[80:81]
  v_pk_mul_f32 v[54:55], v[54:55], v[60:61]
  v_pk_mul_f32 v[70:71], v[70:71], v[76:77]
  v_pk_fma_f32 v[54:55], v[62:63], v[52:53], v[54:55]
  v_pk_fma_f32 v[70:71], v[78:79], v[68:69], v[70:71]
  v_pk_mul_f32 v[52:53], v[52:53], v[60:61]
  v_pk_mul_f32 v[68:69], v[68:69], v[76:77]
  v_rcp_f32 v52, v52
  v_rcp_f32 v53, v53
  v_rcp_f32 v68, v68
  v_rcp_f32 v69, v69
  v_pk_fma_f32 v[34:35], v[52:53], v[54:55], v[34:35]
  v_pk_fma_f32 v[36:37], v[68:69], v[70:71], v[36:37]
  v_pk_mul_f32 v[52:53], v[136:137], v[136:137]
  v_pk_mul_f32 v[56:57], v[138:139], v[138:139]
  v_pk_mul_f32 v[60:61], v[140:141], v[140:141]
  v_pk_mul_f32 v[64:65], v[142:143], v[142:143]
  v_pk_mul_f32 v[68:69], v[152:153], v[152:153]
  v_pk_mul_f32 v[72:73], v[154:155], v[154:155]
  v_pk_mul_f32 v[76:77], v[156:157], v[156:157]
  v_pk_mul_f32 v[80:81], v[158:159], v[158:159]
  v_pk_fma_f32 v[52:53], v[52:53], v[14:15], v[12:13]
  v_pk_fma_f32 v[56:57], v[56:57], v[14:15], v[12:13]
  v_pk_fma_f32 v[60:61], v[60:61], v[14:15], v[12:13]
  v_pk_fma_f32 v[64:65], v[64:65], v[14:15], v[12:13]
  v_pk_fma_f32 v[68:69], v[68:69], v[14:15], v[12:13]
  v_pk_fma_f32 v[72:73], v[72:73], v[14:15], v[12:13]
  v_pk_fma_f32 v[76:77], v[76:77], v[14:15], v[12:13]
  v_pk_fma_f32 v[80:81], v[80:81], v[14:15], v[12:13]
  v_pk_fma_f32 v[52:53], v[52:53], v[136:137], v[84:85]
  v_pk_fma_f32 v[56:57], v[56:57], v[138:139], v[84:85]
  v_pk_fma_f32 v[60:61], v[60:61], v[140:141], v[84:85]
  v_pk_fma_f32 v[64:65], v[64:65], v[142:143], v[84:85]
  v_pk_fma_f32 v[68:69], v[68:69], v[152:153], v[84:85]
  v_pk_fma_f32 v[72:73], v[72:73], v[154:155], v[84:85]
  v_pk_fma_f32 v[76:77], v[76:77], v[156:157], v[84:85]
  v_pk_fma_f32 v[80:81], v[80:81], v[158:159], v[84:85]
  v_exp_f32 v52, v52 clamp
  v_exp_f32 v53, v53 clamp
  v_exp_f32 v56, v56 clamp
  v_exp_f32 v57, v57 clamp
  v_exp_f32 v60, v60 clamp
  v_exp_f32 v61, v61 clamp
  v_exp_f32 v64, v64 clamp
  v_exp_f32 v65, v65 clamp
  v_exp_f32 v68, v68 clamp
  v_exp_f32 v69, v69 clamp
  v_exp_f32 v72, v72 clamp
  v_exp_f32 v73, v73 clamp
  v_exp_f32 v76, v76 clamp
  v_exp_f32 v77, v77 clamp
  v_exp_f32 v80, v80 clamp
  v_exp_f32 v81, v81 clamp
  v_pk_mul_f32 v[54:55], v[136:137], v[16:17]
  v_pk_mul_f32 v[58:59], v[138:139], v[18:19]
  v_pk_mul_f32 v[62:63], v[140:141], v[20:21]
  v_pk_mul_f32 v[66:67], v[142:143], v[22:23]
  v_pk_mul_f32 v[70:71], v[152:153], v[16:17]
  v_pk_mul_f32 v[74:75], v[154:155], v[18:19]
  v_pk_mul_f32 v[78:79], v[156:157], v[20:21]
  v_pk_mul_f32 v[82:83], v[158:159], v[22:23]
  v_pk_fma_f32 v[52:53], v[52:53], v[86:87], v[248:249]
  v_pk_fma_f32 v[56:57], v[56:57], v[86:87], v[248:249]
  v_pk_fma_f32 v[60:61], v[60:61], v[86:87], v[248:249]
  v_pk_fma_f32 v[64:65], v[64:65], v[86:87], v[248:249]
  v_pk_fma_f32 v[68:69], v[68:69], v[86:87], v[248:249]
  v_pk_fma_f32 v[72:73], v[72:73], v[86:87], v[248:249]
  v_pk_fma_f32 v[76:77], v[76:77], v[86:87], v[248:249]
  v_pk_fma_f32 v[80:81], v[80:81], v[86:87], v[248:249]
  v_pk_mul_f32 v[54:55], v[54:55], v[56:57]
  v_pk_mul_f32 v[62:63], v[62:63], v[64:65]
  v_pk_mul_f32 v[70:71], v[70:71], v[72:73]
  v_pk_mul_f32 v[78:79], v[78:79], v[80:81]
  v_pk_fma_f32 v[54:55], v[58:59], v[52:53], v[54:55]
  v_pk_fma_f32 v[62:63], v[66:67], v[60:61], v[62:63]
  v_pk_fma_f32 v[70:71], v[74:75], v[68:69], v[70:71]
  v_pk_fma_f32 v[78:79], v[82:83], v[76:77], v[78:79]
  v_pk_mul_f32 v[52:53], v[52:53], v[56:57]
  v_pk_mul_f32 v[60:61], v[60:61], v[64:65]
  v_pk_mul_f32 v[68:69], v[68:69], v[72:73]
  v_pk_mul_f32 v[76:77], v[76:77], v[80:81]
  v_pk_mul_f32 v[54:55], v[54:55], v[60:61]
  v_pk_mul_f32 v[70:71], v[70:71], v[76:77]
  v_pk_fma_f32 v[54:55], v[62:63], v[52:53], v[54:55]
  v_pk_fma_f32 v[70:71], v[78:79], v[68:69], v[70:71]
  v_pk_mul_f32 v[52:53], v[52:53], v[60:61]
  v_pk_mul_f32 v[68:69], v[68:69], v[76:77]
  v_rcp_f32 v52, v52
  v_rcp_f32 v53, v53
  v_rcp_f32 v68, v68
  v_rcp_f32 v69, v69
  v_pk_mul_f32 v[38:39], v[52:53], v[54:55]
  v_pk_mul_f32 v[40:41], v[68:69], v[70:71]
  v_pk_mul_f32 v[52:53], v[144:145], v[144:145]
  v_pk_mul_f32 v[56:57], v[146:147], v[146:147]
  v_pk_mul_f32 v[60:61], v[148:149], v[148:149]
  v_pk_mul_f32 v[64:65], v[150:151], v[150:151]
  v_pk_mul_f32 v[68:69], v[160:161], v[160:161]
  v_pk_mul_f32 v[72:73], v[162:163], v[162:163]
  v_pk_mul_f32 v[76:77], v[164:165], v[164:165]
  v_pk_mul_f32 v[80:81], v[166:167], v[166:167]
  v_pk_fma_f32 v[52:53], v[52:53], v[14:15], v[12:13]
  v_pk_fma_f32 v[56:57], v[56:57], v[14:15], v[12:13]
  v_pk_fma_f32 v[60:61], v[60:61], v[14:15], v[12:13]
  v_pk_fma_f32 v[64:65], v[64:65], v[14:15], v[12:13]
  v_pk_fma_f32 v[68:69], v[68:69], v[14:15], v[12:13]
  v_pk_fma_f32 v[72:73], v[72:73], v[14:15], v[12:13]
  v_pk_fma_f32 v[76:77], v[76:77], v[14:15], v[12:13]
  v_pk_fma_f32 v[80:81], v[80:81], v[14:15], v[12:13]
  v_pk_fma_f32 v[52:53], v[52:53], v[144:145], v[84:85]
  v_pk_fma_f32 v[56:57], v[56:57], v[146:147], v[84:85]
  v_pk_fma_f32 v[60:61], v[60:61], v[148:149], v[84:85]
  v_pk_fma_f32 v[64:65], v[64:65], v[150:151], v[84:85]
  v_pk_fma_f32 v[68:69], v[68:69], v[160:161], v[84:85]
  v_pk_fma_f32 v[72:73], v[72:73], v[162:163], v[84:85]
  v_pk_fma_f32 v[76:77], v[76:77], v[164:165], v[84:85]
  v_pk_fma_f32 v[80:81], v[80:81], v[166:167], v[84:85]
  v_exp_f32 v52, v52 clamp
  v_exp_f32 v53, v53 clamp
  v_exp_f32 v56, v56 clamp
  v_exp_f32 v57, v57 clamp
  v_exp_f32 v60, v60 clamp
  v_exp_f32 v61, v61 clamp
  v_exp_f32 v64, v64 clamp
  v_exp_f32 v65, v65 clamp
  v_exp_f32 v68, v68 clamp
  v_exp_f32 v69, v69 clamp
  v_exp_f32 v72, v72 clamp
  v_exp_f32 v73, v73 clamp
  v_exp_f32 v76, v76 clamp
  v_exp_f32 v77, v77 clamp
  v_exp_f32 v80, v80 clamp
  v_exp_f32 v81, v81 clamp
  v_pk_mul_f32 v[54:55], v[144:145], v[24:25]
  v_pk_mul_f32 v[58:59], v[146:147], v[26:27]
  v_pk_mul_f32 v[62:63], v[148:149], v[28:29]
  v_pk_mul_f32 v[66:67], v[150:151], v[30:31]
  v_pk_mul_f32 v[70:71], v[160:161], v[24:25]
  v_pk_mul_f32 v[74:75], v[162:163], v[26:27]
  v_pk_mul_f32 v[78:79], v[164:165], v[28:29]
  v_pk_mul_f32 v[82:83], v[166:167], v[30:31]
  v_pk_fma_f32 v[52:53], v[52:53], v[86:87], v[248:249]
  v_pk_fma_f32 v[56:57], v[56:57], v[86:87], v[248:249]
  v_pk_fma_f32 v[60:61], v[60:61], v[86:87], v[248:249]
  v_pk_fma_f32 v[64:65], v[64:65], v[86:87], v[248:249]
  v_pk_fma_f32 v[68:69], v[68:69], v[86:87], v[248:249]
  v_pk_fma_f32 v[72:73], v[72:73], v[86:87], v[248:249]
  v_pk_fma_f32 v[76:77], v[76:77], v[86:87], v[248:249]
  v_pk_fma_f32 v[80:81], v[80:81], v[86:87], v[248:249]
  v_pk_mul_f32 v[54:55], v[54:55], v[56:57]
  v_pk_mul_f32 v[62:63], v[62:63], v[64:65]
  v_pk_mul_f32 v[70:71], v[70:71], v[72:73]
  v_pk_mul_f32 v[78:79], v[78:79], v[80:81]
  v_pk_fma_f32 v[54:55], v[58:59], v[52:53], v[54:55]
  v_pk_fma_f32 v[62:63], v[66:67], v[60:61], v[62:63]
  v_pk_fma_f32 v[70:71], v[74:75], v[68:69], v[70:71]
  v_pk_fma_f32 v[78:79], v[82:83], v[76:77], v[78:79]
  v_pk_mul_f32 v[52:53], v[52:53], v[56:57]
  v_pk_mul_f32 v[60:61], v[60:61], v[64:65]
  v_pk_mul_f32 v[68:69], v[68:69], v[72:73]
  v_pk_mul_f32 v[76:77], v[76:77], v[80:81]
  v_pk_mul_f32 v[54:55], v[54:55], v[60:61]
  v_pk_mul_f32 v[70:71], v[70:71], v[76:77]
  v_pk_fma_f32 v[54:55], v[62:63], v[52:53], v[54:55]
  v_pk_fma_f32 v[70:71], v[78:79], v[68:69], v[70:71]
  v_pk_mul_f32 v[52:53], v[52:53], v[60:61]
  v_pk_mul_f32 v[68:69], v[68:69], v[76:77]
  v_rcp_f32 v52, v52
  v_rcp_f32 v53, v53
  v_rcp_f32 v68, v68
  v_rcp_f32 v69, v69
  v_pk_fma_f32 v[38:39], v[52:53], v[54:55], v[38:39]
  v_pk_fma_f32 v[40:41], v[68:69], v[70:71], v[40:41]
  v_pk_mul_f32 v[52:53], v[168:169], v[168:169]
  v_pk_mul_f32 v[56:57], v[170:171], v[170:171]
  v_pk_mul_f32 v[60:61], v[172:173], v[172:173]
  v_pk_mul_f32 v[64:65], v[174:175], v[174:175]
  v_pk_mul_f32 v[68:69], v[184:185], v[184:185]
  v_pk_mul_f32 v[72:73], v[186:187], v[186:187]
  v_pk_mul_f32 v[76:77], v[188:189], v[188:189]
  v_pk_mul_f32 v[80:81], v[190:191], v[190:191]
  v_pk_fma_f32 v[52:53], v[52:53], v[14:15], v[12:13]
  v_pk_fma_f32 v[56:57], v[56:57], v[14:15], v[12:13]
  v_pk_fma_f32 v[60:61], v[60:61], v[14:15], v[12:13]
  v_pk_fma_f32 v[64:65], v[64:65], v[14:15], v[12:13]
  v_pk_fma_f32 v[68:69], v[68:69], v[14:15], v[12:13]
  v_pk_fma_f32 v[72:73], v[72:73], v[14:15], v[12:13]
  v_pk_fma_f32 v[76:77], v[76:77], v[14:15], v[12:13]
  v_pk_fma_f32 v[80:81], v[80:81], v[14:15], v[12:13]
  v_pk_fma_f32 v[52:53], v[52:53], v[168:169], v[84:85]
  v_pk_fma_f32 v[56:57], v[56:57], v[170:171], v[84:85]
  v_pk_fma_f32 v[60:61], v[60:61], v[172:173], v[84:85]
  v_pk_fma_f32 v[64:65], v[64:65], v[174:175], v[84:85]
  v_pk_fma_f32 v[68:69], v[68:69], v[184:185], v[84:85]
  v_pk_fma_f32 v[72:73], v[72:73], v[186:187], v[84:85]
  v_pk_fma_f32 v[76:77], v[76:77], v[188:189], v[84:85]
  v_pk_fma_f32 v[80:81], v[80:81], v[190:191], v[84:85]
  v_exp_f32 v52, v52 clamp
  v_exp_f32 v53, v53 clamp
  v_exp_f32 v56, v56 clamp
  v_exp_f32 v57, v57 clamp
  v_exp_f32 v60, v60 clamp
  v_exp_f32 v61, v61 clamp
  v_exp_f32 v64, v64 clamp
  v_exp_f32 v65, v65 clamp
  v_exp_f32 v68, v68 clamp
  v_exp_f32 v69, v69 clamp
  v_exp_f32 v72, v72 clamp
  v_exp_f32 v73, v73 clamp
  v_exp_f32 v76, v76 clamp
  v_exp_f32 v77, v77 clamp
  v_exp_f32 v80, v80 clamp
  v_exp_f32 v81, v81 clamp
  v_pk_mul_f32 v[54:55], v[168:169], v[16:17]
  v_pk_mul_f32 v[58:59], v[170:171], v[18:19]
  v_pk_mul_f32 v[62:63], v[172:173], v[20:21]
  v_pk_mul_f32 v[66:67], v[174:175], v[22:23]
  v_pk_mul_f32 v[70:71], v[184:185], v[16:17]
  v_pk_mul_f32 v[74:75], v[186:187], v[18:19]
  v_pk_mul_f32 v[78:79], v[188:189], v[20:21]
  v_pk_mul_f32 v[82:83], v[190:191], v[22:23]
  v_pk_fma_f32 v[52:53], v[52:53], v[86:87], v[248:249]
  v_pk_fma_f32 v[56:57], v[56:57], v[86:87], v[248:249]
  v_pk_fma_f32 v[60:61], v[60:61], v[86:87], v[248:249]
  v_pk_fma_f32 v[64:65], v[64:65], v[86:87], v[248:249]
  v_pk_fma_f32 v[68:69], v[68:69], v[86:87], v[248:249]
  v_pk_fma_f32 v[72:73], v[72:73], v[86:87], v[248:249]
  v_pk_fma_f32 v[76:77], v[76:77], v[86:87], v[248:249]
  v_pk_fma_f32 v[80:81], v[80:81], v[86:87], v[248:249]
  v_pk_mul_f32 v[54:55], v[54:55], v[56:57]
  v_pk_mul_f32 v[62:63], v[62:63], v[64:65]
  v_pk_mul_f32 v[70:71], v[70:71], v[72:73]
  v_pk_mul_f32 v[78:79], v[78:79], v[80:81]
  v_pk_fma_f32 v[54:55], v[58:59], v[52:53], v[54:55]
  v_pk_fma_f32 v[62:63], v[66:67], v[60:61], v[62:63]
  v_pk_fma_f32 v[70:71], v[74:75], v[68:69], v[70:71]
  v_pk_fma_f32 v[78:79], v[82:83], v[76:77], v[78:79]
  v_pk_mul_f32 v[52:53], v[52:53], v[56:57]
  v_pk_mul_f32 v[60:61], v[60:61], v[64:65]
  v_pk_mul_f32 v[68:69], v[68:69], v[72:73]
  v_pk_mul_f32 v[76:77], v[76:77], v[80:81]
  v_pk_mul_f32 v[54:55], v[54:55], v[60:61]
  v_pk_mul_f32 v[70:71], v[70:71], v[76:77]
  v_pk_fma_f32 v[54:55], v[62:63], v[52:53], v[54:55]
  v_pk_fma_f32 v[70:71], v[78:79], v[68:69], v[70:71]
  v_pk_mul_f32 v[52:53], v[52:53], v[60:61]
  v_pk_mul_f32 v[68:69], v[68:69], v[76:77]
  v_rcp_f32 v52, v52
  v_rcp_f32 v53, v53
  v_rcp_f32 v68, v68
  v_rcp_f32 v69, v69
  v_pk_mul_f32 v[42:43], v[52:53], v[54:55]
  v_pk_mul_f32 v[44:45], v[68:69], v[70:71]
  v_pk_mul_f32 v[52:53], v[176:177], v[176:177]
  v_pk_mul_f32 v[56:57], v[178:179], v[178:179]
  v_pk_mul_f32 v[60:61], v[180:181], v[180:181]
  v_pk_mul_f32 v[64:65], v[182:183], v[182:183]
  v_pk_mul_f32 v[68:69], v[192:193], v[192:193]
  v_pk_mul_f32 v[72:73], v[194:195], v[194:195]
  v_pk_mul_f32 v[76:77], v[196:197], v[196:197]
  v_pk_mul_f32 v[80:81], v[198:199], v[198:199]
  v_pk_fma_f32 v[52:53], v[52:53], v[14:15], v[12:13]
  v_pk_fma_f32 v[56:57], v[56:57], v[14:15], v[12:13]
  v_pk_fma_f32 v[60:61], v[60:61], v[14:15], v[12:13]
  v_pk_fma_f32 v[64:65], v[64:65], v[14:15], v[12:13]
  v_pk_fma_f32 v[68:69], v[68:69], v[14:15], v[12:13]
  v_pk_fma_f32 v[72:73], v[72:73], v[14:15], v[12:13]
  v_pk_fma_f32 v[76:77], v[76:77], v[14:15], v[12:13]
  v_pk_fma_f32 v[80:81], v[80:81], v[14:15], v[12:13]
  v_pk_fma_f32 v[52:53], v[52:53], v[176:177], v[84:85]
  v_pk_fma_f32 v[56:57], v[56:57], v[178:179], v[84:85]
  v_pk_fma_f32 v[60:61], v[60:61], v[180:181], v[84:85]
  v_pk_fma_f32 v[64:65], v[64:65], v[182:183], v[84:85]
  v_pk_fma_f32 v[68:69], v[68:69], v[192:193], v[84:85]
  v_pk_fma_f32 v[72:73], v[72:73], v[194:195], v[84:85]
  v_pk_fma_f32 v[76:77], v[76:77], v[196:197], v[84:85]
  v_pk_fma_f32 v[80:81], v[80:81], v[198:199], v[84:85]
  v_exp_f32 v52, v52 clamp
  v_exp_f32 v53, v53 clamp
  v_exp_f32 v56, v56 clamp
  v_exp_f32 v57, v57 clamp
  v_exp_f32 v60, v60 clamp
  v_exp_f32 v61, v61 clamp
  v_exp_f32 v64, v64 clamp
  v_exp_f32 v65, v65 clamp
  v_exp_f32 v68, v68 clamp
  v_exp_f32 v69, v69 clamp
  v_exp_f32 v72, v72 clamp
  v_exp_f32 v73, v73 clamp
  v_exp_f32 v76, v76 clamp
  v_exp_f32 v77, v77 clamp
  v_exp_f32 v80, v80 clamp
  v_exp_f32 v81, v81 clamp
  v_pk_mul_f32 v[54:55], v[176:177], v[24:25]
  v_pk_mul_f32 v[58:59], v[178:179], v[26:27]
  v_pk_mul_f32 v[62:63], v[180:181], v[28:29]
  v_pk_mul_f32 v[66:67], v[182:183], v[30:31]
  v_pk_mul_f32 v[70:71], v[192:193], v[24:25]
  v_pk_mul_f32 v[74:75], v[194:195], v[26:27]
  v_pk_mul_f32 v[78:79], v[196:197], v[28:29]
  v_pk_mul_f32 v[82:83], v[198:199], v[30:31]
  v_pk_fma_f32 v[52:53], v[52:53], v[86:87], v[248:249]
  v_pk_fma_f32 v[56:57], v[56:57], v[86:87], v[248:249]
  v_pk_fma_f32 v[60:61], v[60:61], v[86:87], v[248:249]
  v_pk_fma_f32 v[64:65], v[64:65], v[86:87], v[248:249]
  v_pk_fma_f32 v[68:69], v[68:69], v[86:87], v[248:249]
  v_pk_fma_f32 v[72:73], v[72:73], v[86:87], v[248:249]
  v_pk_fma_f32 v[76:77], v[76:77], v[86:87], v[248:249]
  v_pk_fma_f32 v[80:81], v[80:81], v[86:87], v[248:249]
  v_pk_mul_f32 v[54:55], v[54:55], v[56:57]
  v_pk_mul_f32 v[62:63], v[62:63], v[64:65]
  v_pk_mul_f32 v[70:71], v[70:71], v[72:73]
  v_pk_mul_f32 v[78:79], v[78:79], v[80:81]
  v_pk_fma_f32 v[54:55], v[58:59], v[52:53], v[54:55]
  v_pk_fma_f32 v[62:63], v[66:67], v[60:61], v[62:63]
  v_pk_fma_f32 v[70:71], v[74:75], v[68:69], v[70:71]
  v_pk_fma_f32 v[78:79], v[82:83], v[76:77], v[78:79]
  v_pk_mul_f32 v[52:53], v[52:53], v[56:57]
  v_pk_mul_f32 v[60:61], v[60:61], v[64:65]
  v_pk_mul_f32 v[68:69], v[68:69], v[72:73]
  v_pk_mul_f32 v[76:77], v[76:77], v[80:81]
  v_pk_mul_f32 v[54:55], v[54:55], v[60:61]
  v_pk_mul_f32 v[70:71], v[70:71], v[76:77]
  v_pk_fma_f32 v[54:55], v[62:63], v[52:53], v[54:55]
  v_pk_fma_f32 v[70:71], v[78:79], v[68:69], v[70:71]
  v_pk_mul_f32 v[52:53], v[52:53], v[60:61]
  v_pk_mul_f32 v[68:69], v[68:69], v[76:77]
  v_rcp_f32 v52, v52
  v_rcp_f32 v53, v53
  v_rcp_f32 v68, v68
  v_rcp_f32 v69, v69
  v_pk_fma_f32 v[42:43], v[52:53], v[54:55], v[42:43]
  v_pk_fma_f32 v[44:45], v[68:69], v[70:71], v[44:45]
  v_pk_mul_f32 v[52:53], v[200:201], v[200:201]
  v_pk_mul_f32 v[56:57], v[202:203], v[202:203]
  v_pk_mul_f32 v[60:61], v[204:205], v[204:205]
  v_pk_mul_f32 v[64:65], v[206:207], v[206:207]
  v_pk_mul_f32 v[68:69], v[216:217], v[216:217]
  v_pk_mul_f32 v[72:73], v[218:219], v[218:219]
  v_pk_mul_f32 v[76:77], v[220:221], v[220:221]
  v_pk_mul_f32 v[80:81], v[222:223], v[222:223]
  v_pk_fma_f32 v[52:53], v[52:53], v[14:15], v[12:13]
  v_pk_fma_f32 v[56:57], v[56:57], v[14:15], v[12:13]
  v_pk_fma_f32 v[60:61], v[60:61], v[14:15], v[12:13]
  v_pk_fma_f32 v[64:65], v[64:65], v[14:15], v[12:13]
  v_pk_fma_f32 v[68:69], v[68:69], v[14:15], v[12:13]
  v_pk_fma_f32 v[72:73], v[72:73], v[14:15], v[12:13]
  v_pk_fma_f32 v[76:77], v[76:77], v[14:15], v[12:13]
  v_pk_fma_f32 v[80:81], v[80:81], v[14:15], v[12:13]
  v_pk_fma_f32 v[52:53], v[52:53], v[200:201], v[84:85]
  v_pk_fma_f32 v[56:57], v[56:57], v[202:203], v[84:85]
  v_pk_fma_f32 v[60:61], v[60:61], v[204:205], v[84:85]
  v_pk_fma_f32 v[64:65], v[64:65], v[206:207], v[84:85]
  v_pk_fma_f32 v[68:69], v[68:69], v[216:217], v[84:85]
  v_pk_fma_f32 v[72:73], v[72:73], v[218:219], v[84:85]
  v_pk_fma_f32 v[76:77], v[76:77], v[220:221], v[84:85]
  v_pk_fma_f32 v[80:81], v[80:81], v[222:223], v[84:85]
  v_exp_f32 v52, v52 clamp
  v_exp_f32 v53, v53 clamp
  v_exp_f32 v56, v56 clamp
  v_exp_f32 v57, v57 clamp
  v_exp_f32 v60, v60 clamp
  v_exp_f32 v61, v61 clamp
  v_exp_f32 v64, v64 clamp
  v_exp_f32 v65, v65 clamp
  v_exp_f32 v68, v68 clamp
  v_exp_f32 v69, v69 clamp
  v_exp_f32 v72, v72 clamp
  v_exp_f32 v73, v73 clamp
  v_exp_f32 v76, v76 clamp
  v_exp_f32 v77, v77 clamp
  v_exp_f32 v80, v80 clamp
  v_exp_f32 v81, v81 clamp
  v_pk_mul_f32 v[54:55], v[200:201], v[16:17]
  v_pk_mul_f32 v[58:59], v[202:203], v[18:19]
  v_pk_mul_f32 v[62:63], v[204:205], v[20:21]
  v_pk_mul_f32 v[66:67], v[206:207], v[22:23]
  v_pk_mul_f32 v[70:71], v[216:217], v[16:17]
  v_pk_mul_f32 v[74:75], v[218:219], v[18:19]
  v_pk_mul_f32 v[78:79], v[220:221], v[20:21]
  v_pk_mul_f32 v[82:83], v[222:223], v[22:23]
  v_pk_fma_f32 v[52:53], v[52:53], v[86:87], v[248:249]
  v_pk_fma_f32 v[56:57], v[56:57], v[86:87], v[248:249]
  v_pk_fma_f32 v[60:61], v[60:61], v[86:87], v[248:249]
  v_pk_fma_f32 v[64:65], v[64:65], v[86:87], v[248:249]
  v_pk_fma_f32 v[68:69], v[68:69], v[86:87], v[248:249]
  v_pk_fma_f32 v[72:73], v[72:73], v[86:87], v[248:249]
  v_pk_fma_f32 v[76:77], v[76:77], v[86:87], v[248:249]
  v_pk_fma_f32 v[80:81], v[80:81], v[86:87], v[248:249]
  v_pk_mul_f32 v[54:55], v[54:55], v[56:57]
  v_pk_mul_f32 v[62:63], v[62:63], v[64:65]
  v_pk_mul_f32 v[70:71], v[70:71], v[72:73]
  v_pk_mul_f32 v[78:79], v[78:79], v[80:81]
  v_pk_fma_f32 v[54:55], v[58:59], v[52:53], v[54:55]
  v_pk_fma_f32 v[62:63], v[66:67], v[60:61], v[62:63]
  v_pk_fma_f32 v[70:71], v[74:75], v[68:69], v[70:71]
  v_pk_fma_f32 v[78:79], v[82:83], v[76:77], v[78:79]
  v_pk_mul_f32 v[52:53], v[52:53], v[56:57]
  v_pk_mul_f32 v[60:61], v[60:61], v[64:65]
  v_pk_mul_f32 v[68:69], v[68:69], v[72:73]
  v_pk_mul_f32 v[76:77], v[76:77], v[80:81]
  v_pk_mul_f32 v[54:55], v[54:55], v[60:61]
  v_pk_mul_f32 v[70:71], v[70:71], v[76:77]
  v_pk_fma_f32 v[54:55], v[62:63], v[52:53], v[54:55]
  v_pk_fma_f32 v[70:71], v[78:79], v[68:69], v[70:71]
  v_pk_mul_f32 v[52:53], v[52:53], v[60:61]
  v_pk_mul_f32 v[68:69], v[68:69], v[76:77]
  v_rcp_f32 v52, v52
  v_rcp_f32 v53, v53
  v_rcp_f32 v68, v68
  v_rcp_f32 v69, v69
  v_pk_mul_f32 v[46:47], v[52:53], v[54:55]
  v_pk_mul_f32 v[48:49], v[68:69], v[70:71]
  v_pk_mul_f32 v[52:53], v[208:209], v[208:209]
  v_pk_mul_f32 v[56:57], v[210:211], v[210:211]
  v_pk_mul_f32 v[60:61], v[212:213], v[212:213]
  v_pk_mul_f32 v[64:65], v[214:215], v[214:215]
  v_pk_mul_f32 v[68:69], v[224:225], v[224:225]
  v_pk_mul_f32 v[72:73], v[226:227], v[226:227]
  v_pk_mul_f32 v[76:77], v[228:229], v[228:229]
  v_pk_mul_f32 v[80:81], v[230:231], v[230:231]
  v_pk_fma_f32 v[52:53], v[52:53], v[14:15], v[12:13]
  v_pk_fma_f32 v[56:57], v[56:57], v[14:15], v[12:13]
  v_pk_fma_f32 v[60:61], v[60:61], v[14:15], v[12:13]
  v_pk_fma_f32 v[64:65], v[64:65], v[14:15], v[12:13]
  v_pk_fma_f32 v[68:69], v[68:69], v[14:15], v[12:13]
  v_pk_fma_f32 v[72:73], v[72:73], v[14:15], v[12:13]
  v_pk_fma_f32 v[76:77], v[76:77], v[14:15], v[12:13]
  v_pk_fma_f32 v[80:81], v[80:81], v[14:15], v[12:13]
  v_pk_fma_f32 v[52:53], v[52:53], v[208:209], v[84:85]
  v_pk_fma_f32 v[56:57], v[56:57], v[210:211], v[84:85]
  v_pk_fma_f32 v[60:61], v[60:61], v[212:213], v[84:85]
  v_pk_fma_f32 v[64:65], v[64:65], v[214:215], v[84:85]
  v_pk_fma_f32 v[68:69], v[68:69], v[224:225], v[84:85]
  v_pk_fma_f32 v[72:73], v[72:73], v[226:227], v[84:85]
  v_pk_fma_f32 v[76:77], v[76:77], v[228:229], v[84:85]
  v_pk_fma_f32 v[80:81], v[80:81], v[230:231], v[84:85]
  v_exp_f32 v52, v52 clamp
  v_exp_f32 v53, v53 clamp
  v_exp_f32 v56, v56 clamp
  v_exp_f32 v57, v57 clamp
  v_exp_f32 v60, v60 clamp
  v_exp_f32 v61, v61 clamp
  v_exp_f32 v64, v64 clamp
  v_exp_f32 v65, v65 clamp
  v_exp_f32 v68, v68 clamp
  v_exp_f32 v69, v69 clamp
  v_exp_f32 v72, v72 clamp
  v_exp_f32 v73, v73 clamp
  v_exp_f32 v76, v76 clamp
  v_exp_f32 v77, v77 clamp
  v_exp_f32 v80, v80 clamp
  v_exp_f32 v81, v81 clamp
  v_pk_mul_f32 v[54:55], v[208:209], v[24:25]
  v_pk_mul_f32 v[58:59], v[210:211], v[26:27]
  v_pk_mul_f32 v[62:63], v[212:213], v[28:29]
  v_pk_mul_f32 v[66:67], v[214:215], v[30:31]
  v_pk_mul_f32 v[70:71], v[224:225], v[24:25]
  v_pk_mul_f32 v[74:75], v[226:227], v[26:27]
  v_pk_mul_f32 v[78:79], v[228:229], v[28:29]
  v_pk_mul_f32 v[82:83], v[230:231], v[30:31]
  v_pk_fma_f32 v[52:53], v[52:53], v[86:87], v[248:249]
  v_pk_fma_f32 v[56:57], v[56:57], v[86:87], v[248:249]
  v_pk_fma_f32 v[60:61], v[60:61], v[86:87], v[248:249]
  v_pk_fma_f32 v[64:65], v[64:65], v[86:87], v[248:249]
  v_pk_fma_f32 v[68:69], v[68:69], v[86:87], v[248:249]
  v_pk_fma_f32 v[72:73], v[72:73], v[86:87], v[248:249]
  v_pk_fma_f32 v[76:77], v[76:77], v[86:87], v[248:249]
  v_pk_fma_f32 v[80:81], v[80:81], v[86:87], v[248:249]
  v_pk_mul_f32 v[54:55], v[54:55], v[56:57]
  v_pk_mul_f32 v[62:63], v[62:63], v[64:65]
  v_pk_mul_f32 v[70:71], v[70:71], v[72:73]
  v_pk_mul_f32 v[78:79], v[78:79], v[80:81]
  v_pk_fma_f32 v[54:55], v[58:59], v[52:53], v[54:55]
  v_pk_fma_f32 v[62:63], v[66:67], v[60:61], v[62:63]
  v_pk_fma_f32 v[70:71], v[74:75], v[68:69], v[70:71]
  v_pk_fma_f32 v[78:79], v[82:83], v[76:77], v[78:79]
  v_pk_mul_f32 v[52:53], v[52:53], v[56:57]
  v_pk_mul_f32 v[60:61], v[60:61], v[64:65]
  v_pk_mul_f32 v[68:69], v[68:69], v[72:73]
  v_pk_mul_f32 v[76:77], v[76:77], v[80:81]
  v_pk_mul_f32 v[54:55], v[54:55], v[60:61]
  v_pk_mul_f32 v[70:71], v[70:71], v[76:77]
  v_pk_fma_f32 v[54:55], v[62:63], v[52:53], v[54:55]
  v_pk_fma_f32 v[70:71], v[78:79], v[68:69], v[70:71]
  v_pk_mul_f32 v[52:53], v[52:53], v[60:61]
  v_pk_mul_f32 v[68:69], v[68:69], v[76:77]
  v_rcp_f32 v52, v52
  v_rcp_f32 v53, v53
  v_rcp_f32 v68, v68
  v_rcp_f32 v69, v69
  v_pk_fma_f32 v[46:47], v[52:53], v[54:55], v[46:47]
  v_pk_fma_f32 v[48:49], v[68:69], v[70:71], v[48:49]
  v_pk_mul_f32 v[52:53], v[232:233], v[232:233]
  v_pk_mul_f32 v[56:57], v[234:235], v[234:235]
  v_pk_mul_f32 v[60:61], v[236:237], v[236:237]
  v_pk_mul_f32 v[64:65], v[238:239], v[238:239]
  v_pk_mul_f32 v[68:69], v[240:241], v[240:241]
  v_pk_mul_f32 v[72:73], v[242:243], v[242:243]
  v_pk_mul_f32 v[76:77], v[244:245], v[244:245]
  v_pk_mul_f32 v[80:81], v[246:247], v[246:247]
  v_pk_fma_f32 v[52:53], v[52:53], v[14:15], v[12:13]
  v_pk_fma_f32 v[56:57], v[56:57], v[14:15], v[12:13]
  v_pk_fma_f32 v[60:61], v[60:61], v[14:15], v[12:13]
  v_pk_fma_f32 v[64:65], v[64:65], v[14:15], v[12:13]
  v_pk_fma_f32 v[68:69], v[68:69], v[14:15], v[12:13]
  v_pk_fma_f32 v[72:73], v[72:73], v[14:15], v[12:13]
  v_pk_fma_f32 v[76:77], v[76:77], v[14:15], v[12:13]
  v_pk_fma_f32 v[80:81], v[80:81], v[14:15], v[12:13]
  v_pk_fma_f32 v[52:53], v[52:53], v[232:233], v[84:85]
  v_pk_fma_f32 v[56:57], v[56:57], v[234:235], v[84:85]
  v_pk_fma_f32 v[60:61], v[60:61], v[236:237], v[84:85]
  v_pk_fma_f32 v[64:65], v[64:65], v[238:239], v[84:85]
  v_pk_fma_f32 v[68:69], v[68:69], v[240:241], v[84:85]
  v_pk_fma_f32 v[72:73], v[72:73], v[242:243], v[84:85]
  v_pk_fma_f32 v[76:77], v[76:77], v[244:245], v[84:85]
  v_pk_fma_f32 v[80:81], v[80:81], v[246:247], v[84:85]
  v_exp_f32 v52, v52 clamp
  v_exp_f32 v53, v53 clamp
  v_exp_f32 v56, v56 clamp
  v_exp_f32 v57, v57 clamp
  v_exp_f32 v60, v60 clamp
  v_exp_f32 v61, v61 clamp
  v_exp_f32 v64, v64 clamp
  v_exp_f32 v65, v65 clamp
  v_exp_f32 v68, v68 clamp
  v_exp_f32 v69, v69 clamp
  v_exp_f32 v72, v72 clamp
  v_exp_f32 v73, v73 clamp
  v_exp_f32 v76, v76 clamp
  v_exp_f32 v77, v77 clamp
  v_exp_f32 v80, v80 clamp
  v_exp_f32 v81, v81 clamp
  v_pk_mul_f32 v[54:55], v[232:233], v[16:17]
  v_pk_mul_f32 v[58:59], v[234:235], v[18:19]
  v_pk_mul_f32 v[62:63], v[236:237], v[20:21]
  v_pk_mul_f32 v[66:67], v[238:239], v[22:23]
  v_pk_mul_f32 v[70:71], v[240:241], v[24:25]
  v_pk_mul_f32 v[74:75], v[242:243], v[26:27]
  v_pk_mul_f32 v[78:79], v[244:245], v[28:29]
  v_pk_mul_f32 v[82:83], v[246:247], v[30:31]
  v_pk_fma_f32 v[52:53], v[52:53], v[86:87], v[248:249]
  v_pk_fma_f32 v[56:57], v[56:57], v[86:87], v[248:249]
  v_pk_fma_f32 v[60:61], v[60:61], v[86:87], v[248:249]
  v_pk_fma_f32 v[64:65], v[64:65], v[86:87], v[248:249]
  v_pk_fma_f32 v[68:69], v[68:69], v[86:87], v[248:249]
  v_pk_fma_f32 v[72:73], v[72:73], v[86:87], v[248:249]
  v_pk_fma_f32 v[76:77], v[76:77], v[86:87], v[248:249]
  v_pk_fma_f32 v[80:81], v[80:81], v[86:87], v[248:249]
  v_pk_mul_f32 v[54:55], v[54:55], v[56:57]
  v_pk_mul_f32 v[62:63], v[62:63], v[64:65]
  v_pk_mul_f32 v[70:71], v[70:71], v[72:73]
  v_pk_mul_f32 v[78:79], v[78:79], v[80:81]
  v_pk_fma_f32 v[54:55], v[58:59], v[52:53], v[54:55]
  v_pk_fma_f32 v[62:63], v[66:67], v[60:61], v[62:63]
  v_pk_fma_f32 v[70:71], v[74:75], v[68:69], v[70:71]
  v_pk_fma_f32 v[78:79], v[82:83], v[76:77], v[78:79]
  v_pk_mul_f32 v[52:53], v[52:53], v[56:57]
  v_pk_mul_f32 v[60:61], v[60:61], v[64:65]
  v_pk_mul_f32 v[68:69], v[68:69], v[72:73]
  v_pk_mul_f32 v[76:77], v[76:77], v[80:81]
  v_pk_mul_f32 v[54:55], v[54:55], v[60:61]
  v_pk_mul_f32 v[70:71], v[70:71], v[76:77]
  v_pk_fma_f32 v[54:55], v[62:63], v[52:53], v[54:55]
  v_pk_fma_f32 v[70:71], v[78:79], v[68:69], v[70:71]
  v_pk_mul_f32 v[52:53], v[52:53], v[60:61]
  v_pk_mul_f32 v[68:69], v[68:69], v[76:77]
  v_rcp_f32 v52, v52
  v_rcp_f32 v53, v53
  v_rcp_f32 v68, v68
  v_rcp_f32 v69, v69
  v_pk_mul_f32 v[50:51], v[52:53], v[54:55]
  v_pk_fma_f32 v[50:51], v[68:69], v[70:71], v[50:51]
  v_pk_mul_f32 v[32:33], v[88:89], v[16:17]
  v_pk_fma_f32 v[32:33], v[90:91], v[18:19], v[32:33]
  v_pk_fma_f32 v[32:33], v[92:93], v[20:21], v[32:33]
  v_pk_fma_f32 v[32:33], v[94:95], v[22:23], v[32:33]
  v_pk_fma_f32 v[32:33], v[96:97], v[24:25], v[32:33]
  v_pk_fma_f32 v[32:33], v[98:99], v[26:27], v[32:33]
  v_pk_fma_f32 v[32:33], v[100:101], v[28:29], v[32:33]
  v_pk_fma_f32 v[32:33], v[102:103], v[30:31], v[32:33]
  v_add_f32 v32, v32, v33
  v_add_f32 v34, v34, v35
  v_add_f32 v36, v36, v37
  v_add_f32 v38, v38, v39
  v_add_f32 v40, v40, v41
  v_add_f32 v42, v42, v43
  v_add_f32 v44, v44, v45
  v_add_f32 v46, v46, v47
  v_add_f32 v48, v48, v49
  v_add_f32 v50, v50, v51
  v_permlane32_swap_b32 v32, v34
  v_permlane32_swap_b32 v36, v38
  v_permlane32_swap_b32 v40, v42
  v_permlane32_swap_b32 v44, v46
  v_permlane32_swap_b32 v48, v50
  v_add_f32 v48, v48, v50
  v_add_f32 v32, v32, v34
  v_add_f32 v36, v36, v38
  v_add_f32 v40, v40, v42
  v_add_f32 v44, v44, v46
  v_mov_b32 v50, v48
  v_permlane16_swap_b32 v32, v36
  v_permlane16_swap_b32 v40, v44
  v_permlane16_swap_b32 v48, v50
  v_add_f32 v32, v32, v36
  v_add_f32 v40, v40, v44
  v_add_f32_e64 v48, v48, v50
  ds_write_b32 v10, v32
  ds_write_b32 v10, v40 offset:256
  s_mov_b32 exec_lo, 0xffff
  s_mov_b32 exec_hi, 0xffff
  ds_write_b32 v10, v48 offset:512
  s_mov_b64 exec, -1
  s_waitcnt lgkmcnt(0)
  s_barrier
  s_endpgm
L_ld_tail0:
  s_waitcnt vmcnt(0)
L_ld_tail:
  s_barrier
  s_mov_b32 s60, s24
  s_and_b32 s61, s25, 0xffff
  s_mov_b32 s62, 268435456
  s_mov_b32 s63, 0x20000
  s_mov_b32 s56, s20
  s_and_b32 s57, s21, 0xffff
  s_mov_b32 s58, 8192
  s_mov_b32 s59, 0x20000
  s_mov_b32 s64, s22
  s_and_b32 s65, s23, 0xffff
  s_mov_b32 s66, 256
  s_mov_b32 s67, 0x20000
  s_load_dword s80, s[18:19], 0
  v_mov_b32_e64 v100, 0
  s_mov_b64 exec, 1
  s_mov_b32 s81, 0x80000
  buffer_load_dword v101, v100, s[60:63], s81 offen
  buffer_load_dword v102, v100, s[56:59], 0 offen
  s_mov_b64 exec, -1
  s_mov_b64 exec, 1
  buffer_load_dword v250, v100, s[64:67], 0 offen offset:128 sc1
  s_mov_b64 exec, -1
  s_cmp_lg_u32 s3, 4
  s_cbranch_scc1 L_end
  v_lshlrev_b32 v3, 4, v0
  v_lshlrev_b32 v4, 2, v0
  v_add_u32 v1, 123392, v3
  v_add_u32 v2, 124416, v4
  v_add_u32 v4, 1024, v4
  v_mov_b32 v5, 32
  v_mov_b32_e64 v7, s26
  s_mul_i32 s68, s26, 1280
  s_mul_i32 s69, s27, 16640
  s_add_u32 s69, s69, s68
  s_setprio 3
  v_mov_b32 v64, -1
  v_mov_b32 v65, -1
  v_mov_b32 v66, -1
  v_mov_b32 v67, -1
  buffer_store_dwordx4 v[64:67], v3, s[60:63], s69 offen sc1
  buffer_store_dword v64, v4, s[60:63], s69 offen sc1
  s_waitcnt vmcnt(0)
  v_readfirstlane_b32 s81, v250
  s_nop 0
  s_cmp_eq_u32 s81, 0
  s_cbranch_scc1 L_cid
L_crd:
  s_barrier
  ds_read_b128 v[64:67], v1
  ds_read_b128 v[72:75], v1 offset:1280
  ds_read2st64_b32 v[68:69], v2 offset0:0 offset1:5
  s_waitcnt lgkmcnt(0)
  v_pk_add_f32 v[64:65], v[64:65], v[72:73]
  v_pk_add_f32 v[66:67], v[66:67], v[74:75]
  v_add_f32 v68, v68, v69
  v_min_u32 v64, -2, v64
  v_min_u32 v65, -2, v65
  v_min_u32 v66, -2, v66
  v_min_u32 v67, -2, v67
  v_min_u32 v68, -2, v68
  buffer_store_dwordx4 v[64:67], v3, s[60:63], s69 offen sc1
  buffer_store_dword v68, v4, s[60:63], s69 offen sc1
  s_mov_b64 exec, 1
L_pub:
  v_lshlrev_b32 v6, 8, v7
  s_mov_b32 s70, 0x60000
  v_mov_b32 v13, v5
  buffer_atomic_add v5, v6, s[60:63], s70 offen sc0
  v_cmp_eq_u32 vcc, 12, v7
  v_mov_b32 v8, 0x1b4
  v_mov_b32 v9, 0x1b2
  v_cndmask_b32 v8, v8, v9, vcc
  v_sub_u32 v8, v8, v13
  s_waitcnt vmcnt(0) lgkmcnt(0)
  v_cmp_eq_u32 s[82:83], v5, v8
  s_mov_b64 exec, -1
  s_lshl_b32 s80, s80, 16
  v_lshrrev_b32 v1, 1, v3
  v_lshrrev_b32 v2, 1, v4
L_fin:
  s_cmp_eq_u32 s82, 0
  s_cbranch_scc1 L_done
  s_ff1_i32_b32 s70, s82
  s_bitset0_b32 s82, s70
  v_readlane_b32 s71, v7, s70
  s_waitcnt vmcnt(0)
L_again:
  s_mul_i32 s68, s71, 1280
  buffer_load_dwordx4 v[64:67], v3, s[60:63], s68 offen sc1
  buffer_load_dword v68, v4, s[60:63], s68 offen sc1
  s_add_u32 s68, s68, 16640
  buffer_load_dwordx4 v[72:75], v3, s[60:63], s68 offen sc1
  buffer_load_dword v76, v4, s[60:63], s68 offen sc1
  s_add_u32 s68, s68, 16640
  buffer_load_dwordx4 v[80:83], v3, s[60:63], s68 offen sc1
  buffer_load_dword v84, v4, s[60:63], s68 offen sc1
  s_add_u32 s68, s68, 16640
  buffer_load_dwordx4 v[88:91], v3, s[60:63], s68 offen sc1
  buffer_load_dword v92, v4, s[60:63], s68 offen sc1
  s_add_u32 s68, s68, 16640
  buffer_load_dwordx4 v[96:99], v3, s[60:63], s68 offen sc1
  buffer_load_dword v100, v4, s[60:63], s68 offen sc1
  s_add_u32 s68, s68, 16640
  buffer_load_dwordx4 v[104:107], v3, s[60:63], s68 offen sc1
  buffer_load_dword v108, v4, s[60:63], s68 offen sc1
  s_add_u32 s68, s68, 16640
  buffer_load_dwordx4 v[112:115], v3, s[60:63], s68 offen sc1
  buffer_load_dword v116, v4, s[60:63], s68 offen sc1
  s_add_u32 s68, s68, 16640
  buffer_load_dwordx4 v[120:123], v3, s[60:63], s68 offen sc1
  buffer_load_dword v124, v4, s[60:63], s68 offen sc1
  s_add_u32 s68, s68, 16640
  buffer_load_dwordx4 v[128:131], v3, s[60:63], s68 offen sc1
  buffer_load_dword v132, v4, s[60:63], s68 offen sc1
  s_add_u32 s68, s68, 16640
  buffer_load_dwordx4 v[136:139], v3, s[60:63], s68 offen sc1
  buffer_load_dword v140, v4, s[60:63], s68 offen sc1
  s_add_u32 s68, s68, 16640
  buffer_load_dwordx4 v[144:147], v3, s[60:63], s68 offen sc1
  buffer_load_dword v148, v4, s[60:63], s68 offen sc1
  s_add_u32 s68, s68, 16640
  buffer_load_dwordx4 v[152:155], v3, s[60:63], s68 offen sc1
  buffer_load_dword v156, v4, s[60:63], s68 offen sc1
  s_add_u32 s68, s68, 16640
  buffer_load_dwordx4 v[160:163], v3, s[60:63], s68 offen sc1
  buffer_load_dword v164, v4, s[60:63], s68 offen sc1
  s_add_u32 s68, s68, 16640
  buffer_load_dwordx4 v[168:171], v3, s[60:63], s68 offen sc1
  buffer_load_dword v172, v4, s[60:63], s68 offen sc1
  s_add_u32 s68, s68, 16640
L_sum:
  s_waitcnt vmcnt(25)
  v_pk_add_f32 v[56:57], v[64:65], v[72:73]
  v_pk_add_f32 v[58:59], v[66:67], v[74:75]
  s_waitcnt vmcnt(24)
  v_add_f32 v60, v68, v76
  s_waitcnt vmcnt(23)
  v_pk_add_f32 v[56:57], v[56:57], v[80:81]
  v_pk_add_f32 v[58:59], v[58:59], v[82:83]
  s_waitcnt vmcnt(22)
  v_add_f32 v60, v60, v84
  s_waitcnt vmcnt(21)
  v_pk_add_f32 v[56:57], v[56:57], v[88:89]
  v_pk_add_f32 v[58:59], v[58:59], v[90:91]
  s_waitcnt vmcnt(20)
  v_add_f32 v60, v60, v92
  s_waitcnt vmcnt(19)
  v_pk_add_f32 v[56:57], v[56:57], v[96:97]
  v_pk_add_f32 v[58:59], v[58:59], v[98:99]
  s_waitcnt vmcnt(18)
  v_add_f32 v60, v60, v100
  s_waitcnt vmcnt(17)
  v_pk_add_f32 v[56:57], v[56:57], v[104:105]
  v_pk_add_f32 v[58:59], v[58:59], v[106:107]
  s_waitcnt vmcnt(16)
  v_add_f32_e64 v60, v60, v108
  s_waitcnt vmcnt(15)
  v_pk_add_f32 v[56:57], v[56:57], v[112:113]
  v_pk_add_f32 v[58:59], v[58:59], v[114:115]
  s_waitcnt vmcnt(14)
  v_add_f32 v60, v60, v116
  s_waitcnt vmcnt(13)
  v_pk_add_f32 v[56:57], v[56:57], v[120:121]
  v_pk_add_f32 v[58:59], v[58:59], v[122:123]
  s_waitcnt vmcnt(12)
  v_add_f32 v60, v60, v124
  s_waitcnt vmcnt(11)
  v_pk_add_f32 v[56:57], v[56:57], v[128:129]
  v_pk_add_f32 v[58:59], v[58:59], v[130:131]
  s_waitcnt vmcnt(10)
  v_add_f32 v60, v60, v132
  s_waitcnt vmcnt(9)
  v_pk_add_f32 v[56:57], v[56:57], v[136:137]
  v_pk_add_f32 v[58:59], v[58:59], v[138:139]
  s_waitcnt vmcnt(8)
  v_add_f32 v60, v60, v140
  s_waitcnt vmcnt(7)
  v_pk_add_f32 v[56:57], v[56:57], v[144:145]
  v_pk_add_f32 v[58:59], v[58:59], v[146:147]
  s_waitcnt vmcnt(6)
  v_add_f32 v60, v60, v148
  s_waitcnt vmcnt(5)
  v_pk_add_f32 v[56:57], v[56:57], v[152:153]
  v_pk_add_f32 v[58:59], v[58:59], v[154:155]
  s_waitcnt vmcnt(4)
  v_add_f32 v60, v60, v156
  s_waitcnt vmcnt(3)
  v_pk_add_f32 v[56:57], v[56:57], v[160:161]
  v_pk_add_f32 v[58:59], v[58:59], v[162:163]
  s_waitcnt vmcnt(2)
  v_add_f32 v60, v60, v164
  s_waitcnt vmcnt(1)
  v_pk_add_f32 v[56:57], v[56:57], v[168:169]
  v_pk_add_f32 v[58:59], v[58:59], v[170:171]
  s_waitcnt vmcnt(0)
  v_add_f32 v60, v60, v172
  v_cmp_u_f32 vcc, v56, v57
  v_cmp_u_f32 s[92:93], v58, v59
  s_nop 0
  s_or_b64 s[92:93], s[92:93], vcc
  v_cmp_u_f32 vcc, v60, v60
  s_nop 0
  s_or_b64 vcc, s[92:93], vcc
  s_cbranch_vccnz L_chk
L_ok:
  s_mul_i32 s71, s71, 640
  v_add_f32 v56, s80, v56
  v_add_f32 v57, s80, v57
  v_add_f32 v58, s80, v58
  v_add_f32 v59, s80, v59
  v_add_f32_e64 v60, s80, v60
  v_cvt_pk_bf16_f32 v10, v56, v57
  v_cvt_pk_bf16_f32 v11, v58, v59
  v_cvt_pk_bf16_f32 v12, v60, v60
  buffer_store_dwordx2 v[10:11], v1, s[56:59], s71 offen
  buffer_store_short v12, v2, s[56:59], s71 offen
  s_branch L_fin
L_chk:
  v_mov_b32 v14, 0
  v_mov_b32 v15, 0
  v_max3_u32 v14, v14, v64, v65
  v_max3_u32 v14, v14, v66, v67
  v_max_u32 v15, v15, v68
  v_max3_u32 v14, v14, v72, v73
  v_max3_u32 v14, v14, v74, v75
  v_max_u32_e64 v15, v15, v76
  v_max3_u32 v14, v14, v80, v81
  v_max3_u32 v14, v14, v82, v83
  v_max_u32 v15, v15, v84
  v_max3_u32 v14, v14, v88, v89
  v_max3_u32 v14, v14, v90, v91
  v_max_u32 v15, v15, v92
  v_max3_u32 v14, v14, v96, v97
  v_max3_u32 v14, v14, v98, v99
  v_max_u32_e64 v15, v15, v100
  v_max3_u32 v14, v14, v104, v105
  v_max3_u32 v14, v14, v106, v107
  v_max_u32 v15, v15, v108
  v_max3_u32 v14, v14, v112, v113
  v_max3_u32 v14, v14, v114, v115
  v_max_u32 v15, v15, v116
  v_max3_u32 v14, v14, v120, v121
  v_max3_u32 v14, v14, v122, v123
  v_max_u32_e64 v15, v15, v124
  v_max3_u32 v14, v14, v128, v129
  v_max3_u32 v14, v14, v130, v131
  v_max_u32 v15, v15, v132
  v_max3_u32 v14, v14, v136, v137
  v_max3_u32 v14, v14, v138, v139
  v_max_u32 v15, v15, v140
  v_max3_u32 v14, v14, v144, v145
  v_max3_u32 v14, v14, v146, v147
  v_max_u32_e64 v15, v15, v148
  v_max3_u32 v14, v14, v152, v153
  v_max3_u32 v14, v14, v154, v155
  v_max_u32 v15, v15, v156
  v_max3_u32 v14, v14, v160, v161
  v_max3_u32 v14, v14, v162, v163
  v_max_u32 v15, v15, v164
  v_max3_u32 v14, v14, v168, v169
  v_max3_u32 v14, v14, v170, v171
  v_max_u32 v15, v15, v172
  s_cmp_eq_u32 s71, 12
  s_cselect_b32 s68, 0, -1
  v_and_b32 v15, s68, v15
  v_max_u32 v14, v14, v15
  v_cmp_eq_u32 vcc, -1, v14
  s_cbranch_vccnz L_again
  s_branch L_ok
L_done:
  s_endpgm
L_cin_done:
  s_mul_i32 s98, s3, 1536
  s_add_u32 s98, s98, 116736
  v_lshlrev_b32 v120, 5, v0
  v_add_u32_e64 v120, s98, v120
  ds_read_b128 v[60:63], v120
  ds_read_b128 v[64:67], v120 offset:16
  v_mul_f32 v116, v184, v192
  v_mul_f32 v117, v185, v193
  v_mul_f32 v118, v186, v194
  v_mul_f32 v119, v187, v195
  v_fmac_f32 v116, v188, v191
  v_fmac_f32 v117, v200, v208
  v_fmac_f32 v118, v201, v209
  v_fmac_f32 v119, v202, v210
  v_fmac_f32 v116, v203, v211
  v_fmac_f32 v117, v204, v207
  v_fmac_f32 v118, v216, v224
  v_fmac_f32 v119, v217, v225
  v_fmac_f32 v116, v218, v226
  v_fmac_f32 v117, v219, v227
  v_fmac_f32 v118, v220, v223
  v_fmac_f32 v119, v232, v240
  v_fmac_f32 v116, v233, v241
  v_fmac_f32 v117, v234, v242
  v_fmac_f32 v118, v235, v243
  v_fmac_f32 v119, v236, v239
  v_fmac_f32 v116, v189, v196
  v_fmac_f32 v117, v189, v197
  v_fmac_f32 v118, v190, v198
  v_fmac_f32 v119, v190, v199
  v_fmac_f32 v116, v205, v212
  v_fmac_f32 v117, v205, v213
  v_fmac_f32 v118, v206, v214
  v_fmac_f32 v119, v206, v215
  v_fmac_f32 v116, v221, v228
  v_fmac_f32 v117, v221, v229
  v_fmac_f32 v118, v222, v230
  v_fmac_f32 v119, v222, v231
  v_fmac_f32 v116, v237, v244
  v_fmac_f32 v117, v237, v245
  v_fmac_f32 v118, v238, v246
  v_fmac_f32 v119, v238, v247
  v_add_f32 v116, v116, v117
  v_add_f32 v118, v118, v119
  v_add_f32 v116, v116, v118
  v_mul_f32 v116, s74, v116
  v_mul_f32 v116, s75, v116
  s_nop 1
  v_add_f32_dpp v116, v116, v116 row_shr:1 row_mask:0xf bank_mask:0xf
  v_subrev_u32 v122, s98, v7
  v_lshrrev_b32 v122, 8, v122
  v_lshrrev_b32 v121, 3, v0
  v_add_f32_dpp v116, v116, v116 row_shr:2 row_mask:0xf bank_mask:0xf
  v_cmp_gt_u32 vcc, v122, v121
  v_min_u32 v121, v121, v122
  v_lshlrev_b32 v121, 4, v121
  v_add_f32_dpp v116, v116, v116 row_shr:4 row_mask:0xf bank_mask:0xf
  v_add_u32 v121, s85, v121
  s_waitcnt lgkmcnt(1)
  v_add_f32 v60, v60, v61
  v_add_f32 v62, v62, v63
  v_add_f32_dpp v116, v116, v116 row_shr:8 row_mask:0xf bank_mask:0xf
  s_waitcnt lgkmcnt(0)
  v_add_f32 v64, v64, v65
  v_add_f32 v66, v66, v67
  v_add_f32 v60, v60, v62
  v_add_f32_dpp v116, v116, v116 row_bcast:15 row_mask:0xa bank_mask:0xf
  v_add_f32 v64, v64, v66
  v_add_f32_e64 v60, v60, v64
  s_nop 1
  v_add_f32_dpp v60, v60, v60 quad_perm:[1,0,3,2] row_mask:0xf bank_mask:0xf
  v_add_f32_dpp v116, v116, v116 row_bcast:31 row_mask:0xc bank_mask:0xf
  s_nop 0
  v_add_f32_dpp v60, v60, v60 quad_perm:[2,3,0,1] row_mask:0xf bank_mask:0xf
  s_nop 1
  v_add_f32_dpp v60, v60, v60 row_half_mirror row_mask:0xf bank_mask:0xf
  v_cndmask_b32 v60, v116, v60, vcc
  s_bitset1_b32 vcc_hi, 31
  s_mov_b64 exec, vcc
  ds_write_b32 v121, v60
  s_mov_b64 exec, -1
  s_cmp_eq_u32 s3, 0
  s_cbranch_scc1 L_cpub
  s_waitcnt lgkmcnt(0)
  s_barrier
  s_endpgm
L_cpub:
  s_load_dword s80, s[18:19], 0
  s_mov_b32 s60, s24
  s_and_b32 s61, s25, 0xffff
  s_mov_b32 s62, 268435456
  s_mov_b32 s63, 0x20000
  s_mov_b32 s56, s20
  s_and_b32 s57, s21, 0xffff
  s_mov_b32 s58, 8192
  s_mov_b32 s59, 0x20000
  s_mov_b32 s64, s22
  s_and_b32 s65, s23, 0xffff
  s_mov_b32 s66, 256
  s_mov_b32 s67, 0x20000
  v_lshlrev_b32 v6, 2, v0
  v_add_u32 v2, 129728, v6
  v_add_u32 v4, 1024, v6
  s_mul_i32 s69, s26, 192
  s_add_u32 s69, s69, 216320
  v_mov_b32 v13, -1
  s_mov_b32 exec_hi, 0xffff
  buffer_store_dword v13, v6, s[60:63], s69 offen sc1
  s_mov_b64 exec, 1
  buffer_load_dword v250, v6, s[56:59], 0 offen
  buffer_load_dword v251, v6, s[64:67], 0 offen offset:128 sc1
  s_mov_b64 exec, -1
  s_mul_i32 s68, s26, 3
  s_mul_i32 s70, s68, 3277
  s_lshr_b32 s70, s70, 16
  v_add_u32 v7, s70, v0
  s_mul_i32 s70, s70, 20
  s_add_u32 s70, s70, 20
  s_sub_u32 s70, s70, s68
  s_min_u32 s70, s70, 3
  s_sub_u32 s68, 3, s70
  v_mov_b32 v5, s68
  v_writelane_b32 v5, s70, 0
  s_cmp_eq_u32 s68, 0
  s_cselect_b32 s68, 1, 3
  v_lshlrev_b32 v3, 4, v0
  s_waitcnt vmcnt(0) lgkmcnt(0)
  v_readfirstlane_b32 s81, v251
  s_nop 0
  s_cmp_eq_u32 s81, 0
  s_cbranch_scc1 L_cic
L_crc:
  s_mov_b32 exec_hi, 0xffff
  s_barrier
  ds_read_b32 v64, v2
  s_waitcnt lgkmcnt(0)
  v_min_u32_e64 v64, -2, v64
  buffer_store_dword v64, v6, s[60:63], s69 offen sc1
  s_mov_b32 exec_lo, s68
  s_mov_b32 exec_hi, 0
  s_branch L_pub
L_dnn_loop1:
  s_barrier
L_ld_in:
  s_add_u32 m0, s75, 131072
  s_nop 0
  buffer_load_dwordx4 v4, s[44:47], s74 offen lds
  s_add_u32 m0, s75, 132096
  s_nop 0
  buffer_load_dwordx4 v5, s[44:47], s74 offen lds
  s_add_u32 s74, s74, 106496
  s_add_u32 m0, s75, 139264
  s_nop 0
  buffer_load_dwordx4 v4, s[44:47], s74 offen lds
  s_add_u32 m0, s75, 140288
  s_nop 0
  buffer_load_dwordx4 v5, s[44:47], s74 offen lds
  s_add_u32 s74, s74, 106496
  s_add_u32 m0, s76, 0
  s_nop 0
  buffer_load_dwordx4 v56, s[32:35], 0 offen lds
  s_add_u32 m0, s76, 2048
  v_add_u32_dpp v56, v16, v2 row_newbcast:1 row_mask:0xf bank_mask:0x3
  buffer_load_dwordx4 v57, s[32:35], 0 offen lds
  s_nop 0
  v_add_u32_dpp v56, v18, v2 row_newbcast:7 row_mask:0xf bank_mask:0xc
  s_add_u32 m0, s76, 4096
  v_add_u32_dpp v57, v20, v2 row_newbcast:1 row_mask:0xf bank_mask:0x3
  buffer_load_dwordx4 v58, s[32:35], 0 offen lds
  s_nop 0
  v_add_u32_dpp v57, v22, v2 row_newbcast:7 row_mask:0xf bank_mask:0xc
  s_add_u32 m0, s76, 6144
  v_add_u32_dpp v58, v24, v2 row_newbcast:1 row_mask:0xf bank_mask:0x3
  buffer_load_dwordx4 v59, s[32:35], 0 offen lds
  s_nop 0
  v_add_u32_dpp v58, v26, v2 row_newbcast:7 row_mask:0xf bank_mask:0xc
  s_add_u32 m0, s76, 8192
  v_add_u32_dpp v59, v28, v2 row_newbcast:1 row_mask:0xf bank_mask:0x3
  buffer_load_dwordx4 v60, s[32:35], 0 offen lds
  s_nop 0
  v_add_u32_dpp v59, v30, v2 row_newbcast:7 row_mask:0xf bank_mask:0xc
  s_add_u32 m0, s76, 10240
  v_add_u32_dpp v60, v32, v2 row_newbcast:1 row_mask:0xf bank_mask:0x3
  buffer_load_dwordx4 v61, s[32:35], 0 offen lds
  s_nop 0
  v_add_u32_dpp v60, v34, v2 row_newbcast:7 row_mask:0xf bank_mask:0xc
  s_add_u32 m0, s76, 12288
  v_add_u32_dpp v61, v36, v2 row_newbcast:1 row_mask:0xf bank_mask:0x3
  buffer_load_dwordx4 v62, s[32:35], 0 offen lds
  s_nop 0
  v_add_u32_dpp v61, v38, v2 row_newbcast:7 row_mask:0xf bank_mask:0xc
  s_add_u32 m0, s76, 14336
  v_add_u32_dpp v62, v40, v2 row_newbcast:1 row_mask:0xf bank_mask:0x3
  buffer_load_dwordx4 v63, s[32:35], 0 offen lds
  s_nop 0
  v_add_u32_dpp v62, v42, v2 row_newbcast:7 row_mask:0xf bank_mask:0xc
  s_add_u32 m0, s76, 16384
  v_add_u32_dpp v63, v44, v2 row_newbcast:1 row_mask:0xf bank_mask:0x3
  buffer_load_dwordx4 v64, s[32:35], 0 offen lds
  s_nop 0
  v_add_u32_dpp v63, v46, v2 row_newbcast:7 row_mask:0xf bank_mask:0xc
  s_add_u32 m0, s76, 18432
  v_add_u32_dpp v64, v48, v2 row_newbcast:1 row_mask:0xf bank_mask:0x3
  buffer_load_dwordx4 v65, s[32:35], 0 offen lds
  s_nop 0
  v_add_u32_dpp v64, v50, v2 row_newbcast:7 row_mask:0xf bank_mask:0xc
  v_add_u32_dpp v65, v52, v2 row_newbcast:1 row_mask:0xf bank_mask:0x3
  s_nop 1
  v_add_u32_dpp v65, v54, v2 row_newbcast:7 row_mask:0xf bank_mask:0xc
  s_mov_b64 exec, 0x3ff
  buffer_load_dword v103, v84, s[44:47], s85 offen
  s_mov_b64 exec, -1
  s_add_u32 s85, s85, 865280
  s_waitcnt vmcnt(11)
  s_barrier
  s_add_u32 m0, s75, 147456
  s_nop 0
  buffer_load_dwordx4 v4, s[44:47], s74 offen lds
  s_add_u32 m0, s75, 148480
  s_nop 0
  buffer_load_dwordx4 v5, s[44:47], s74 offen lds
  s_add_u32 s74, s74, 106496
  s_add_u32 m0, s75, 155648
  s_nop 0
  buffer_load_dwordx4 v4, s[44:47], s74 offen lds
  s_add_u32 m0, s75, 156672
  s_nop 0
  buffer_load_dwordx4 v5, s[44:47], s74 offen lds
  s_add_u32 s74, s74, 106496
  s_add_u32 m0, s76, 40960
  s_nop 0
  buffer_load_dwordx4 v56, s[32:35], 0 offen lds
  s_add_u32 m0, s76, 43008
  v_add_u32_dpp v56, v17, v2 row_newbcast:1 row_mask:0xf bank_mask:0x3
  buffer_load_dwordx4 v57, s[32:35], 0 offen lds
  s_nop 0
  v_add_u32_dpp v56, v19, v2 row_newbcast:7 row_mask:0xf bank_mask:0xc
  s_add_u32 m0, s76, 45056
  v_add_u32_dpp v57, v21, v2 row_newbcast:1 row_mask:0xf bank_mask:0x3
  buffer_load_dwordx4 v58, s[32:35], 0 offen lds
  s_nop 0
  v_add_u32_dpp v57, v23, v2 row_newbcast:7 row_mask:0xf bank_mask:0xc
  s_add_u32 m0, s76, 47104
  v_add_u32_dpp v58, v25, v2 row_newbcast:1 row_mask:0xf bank_mask:0x3
  buffer_load_dwordx4 v59, s[32:35], 0 offen lds
  s_nop 0
  v_add_u32_dpp v58, v27, v2 row_newbcast:7 row_mask:0xf bank_mask:0xc
  s_add_u32 m0, s76, 49152
  v_add_u32_dpp v59, v29, v2 row_newbcast:1 row_mask:0xf bank_mask:0x3
  buffer_load_dwordx4 v60, s[32:35], 0 offen lds
  s_nop 0
  v_add_u32_dpp v59, v31, v2 row_newbcast:7 row_mask:0xf bank_mask:0xc
  s_add_u32 m0, s76, 51200
  v_add_u32_dpp v60, v33, v2 row_newbcast:1 row_mask:0xf bank_mask:0x3
  buffer_load_dwordx4 v61, s[32:35], 0 offen lds
  s_nop 0
  v_add_u32_dpp v60, v35, v2 row_newbcast:7 row_mask:0xf bank_mask:0xc
  s_add_u32 m0, s76, 53248
  v_add_u32_dpp v61, v37, v2 row_newbcast:1 row_mask:0xf bank_mask:0x3
  buffer_load_dwordx4 v62, s[32:35], 0 offen lds
  s_nop 0
  v_add_u32_dpp v61, v39, v2 row_newbcast:7 row_mask:0xf bank_mask:0xc
  s_add_u32 m0, s76, 55296
  v_add_u32_dpp v62, v41, v2 row_newbcast:1 row_mask:0xf bank_mask:0x3
  buffer_load_dwordx4 v63, s[32:35], 0 offen lds
  s_nop 0
  v_add_u32_dpp v62, v43, v2 row_newbcast:7 row_mask:0xf bank_mask:0xc
  s_add_u32 m0, s76, 57344
  v_add_u32_dpp v63, v45, v2 row_newbcast:1 row_mask:0xf bank_mask:0x3
  buffer_load_dwordx4 v64, s[32:35], 0 offen lds
  s_nop 0
  v_add_u32_dpp v63, v47, v2 row_newbcast:7 row_mask:0xf bank_mask:0xc
  s_add_u32 m0, s76, 59392
  v_add_u32_dpp v64, v49, v2 row_newbcast:1 row_mask:0xf bank_mask:0x3
  buffer_load_dwordx4 v65, s[32:35], 0 offen lds
  s_nop 0
  v_add_u32_dpp v64, v51, v2 row_newbcast:7 row_mask:0xf bank_mask:0xc
  v_add_u32_dpp v65, v53, v2 row_newbcast:1 row_mask:0xf bank_mask:0x3
  s_nop 1
  v_add_u32_dpp v65, v55, v2 row_newbcast:7 row_mask:0xf bank_mask:0xc
  s_waitcnt vmcnt(10)
  s_barrier
  s_add_u32 m0, s75, 131072
  s_nop 0
  buffer_load_dwordx4 v4, s[44:47], s74 offen lds
  s_add_u32 m0, s75, 132096
  s_nop 0
  buffer_load_dwordx4 v5, s[44:47], s74 offen lds
  s_add_u32 s74, s74, 106496
  s_add_u32 m0, s75, 139264
  s_nop 0
  buffer_load_dwordx4 v4, s[44:47], s74 offen lds
  s_add_u32 m0, s75, 140288
  s_nop 0
  buffer_load_dwordx4 v5, s[44:47], s74 offen lds
  s_add_u32 s74, s74, 106496
  s_add_u32 m0, s76, 81920
  s_nop 0
  buffer_load_dwordx4 v56, s[32:35], 0 offen lds
  s_add_u32 m0, s76, 83968
  v_add_u32_dpp v56, v18, v2 row_newbcast:1 row_mask:0xf bank_mask:0x3
  buffer_load_dwordx4 v57, s[32:35], 0 offen lds
  s_nop 0
  v_add_u32_dpp v56, v16, v2 row_newbcast:8 row_mask:0xf bank_mask:0xc
  s_add_u32 m0, s76, 86016
  v_add_u32_dpp v57, v22, v2 row_newbcast:1 row_mask:0xf bank_mask:0x3
  buffer_load_dwordx4 v58, s[32:35], 0 offen lds
  s_nop 0
  v_add_u32_dpp v57, v20, v2 row_newbcast:8 row_mask:0xf bank_mask:0xc
  s_add_u32 m0, s76, 88064
  v_add_u32_dpp v58, v26, v2 row_newbcast:1 row_mask:0xf bank_mask:0x3
  buffer_load_dwordx4 v59, s[32:35], 0 offen lds
  s_nop 0
  v_add_u32_dpp v58, v24, v2 row_newbcast:8 row_mask:0xf bank_mask:0xc
  s_add_u32 m0, s76, 90112
  v_add_u32_dpp v59, v30, v2 row_newbcast:1 row_mask:0xf bank_mask:0x3
  buffer_load_dwordx4 v60, s[32:35], 0 offen lds
  s_nop 0
  v_add_u32_dpp v59, v28, v2 row_newbcast:8 row_mask:0xf bank_mask:0xc
  s_add_u32 m0, s76, 92160
  v_add_u32_dpp v60, v34, v2 row_newbcast:1 row_mask:0xf bank_mask:0x3
  buffer_load_dwordx4 v61, s[32:35], 0 offen lds
  s_nop 0
  v_add_u32_dpp v60, v32, v2 row_newbcast:8 row_mask:0xf bank_mask:0xc
  s_add_u32 m0, s76, 94208
  v_add_u32_dpp v61, v38, v2 row_newbcast:1 row_mask:0xf bank_mask:0x3
  buffer_load_dwordx4 v62, s[32:35], 0 offen lds
  s_nop 0
  v_add_u32_dpp v61, v36, v2 row_newbcast:8 row_mask:0xf bank_mask:0xc
  s_add_u32 m0, s76, 96256
  v_add_u32_dpp v62, v42, v2 row_newbcast:1 row_mask:0xf bank_mask:0x3
  buffer_load_dwordx4 v63, s[32:35], 0 offen lds
  s_nop 0
  v_add_u32_dpp v62, v40, v2 row_newbcast:8 row_mask:0xf bank_mask:0xc
  s_add_u32 m0, s76, 98304
  v_add_u32_dpp v63, v46, v2 row_newbcast:1 row_mask:0xf bank_mask:0x3
  buffer_load_dwordx4 v64, s[32:35], 0 offen lds
  s_nop 0
  v_add_u32_dpp v63, v44, v2 row_newbcast:8 row_mask:0xf bank_mask:0xc
  s_add_u32 m0, s76, 100352
  v_add_u32_dpp v64, v50, v2 row_newbcast:1 row_mask:0xf bank_mask:0x3
  buffer_load_dwordx4 v65, s[32:35], 0 offen lds
  s_nop 0
  v_add_u32_dpp v64, v48, v2 row_newbcast:8 row_mask:0xf bank_mask:0xc
  v_add_u32_dpp v65, v54, v2 row_newbcast:1 row_mask:0xf bank_mask:0x3
  s_nop 1
  v_add_u32_dpp v65, v52, v2 row_newbcast:8 row_mask:0xf bank_mask:0xc
  v_lshlrev_b32 v101, 7, v70
  s_mov_b32 exec_lo, 0xffffffff
  s_mov_b32 exec_hi, 0x0
  buffer_load_dword v102, v101, s[32:35], 0 offen
  s_mov_b64 exec, -1
  v_mov_b32 v70, v71
  v_mov_b32 v71, v72
  v_mov_b32 v72, v73
  v_mov_b32_e64 v73, v74
  v_mov_b32 v74, 0xffffff
  s_waitcnt vmcnt(11)
  s_barrier
  s_add_u32 m0, s75, 147456
  s_nop 0
  buffer_load_dwordx4 v4, s[44:47], s74 offen lds
  s_add_u32 m0, s75, 148480
  s_nop 0
  buffer_load_dwordx4 v5, s[44:47], s74 offen lds
  s_add_u32 s74, s74, 106496
  s_add_u32 m0, s75, 155648
  s_nop 0
  buffer_load_dwordx4 v4, s[44:47], s74 offen lds
  s_add_u32 m0, s75, 156672
  s_nop 0
  buffer_load_dwordx4 v5, s[44:47], s74 offen lds
  s_add_u32 s74, s74, 106496
  s_add_u32 m0, s76, 0
  s_nop 0
  buffer_load_dwordx4 v56, s[32:35], 0 offen lds
  s_add_u32 m0, s76, 2048
  v_add_u32_dpp v56, v19, v2 row_newbcast:1 row_mask:0xf bank_mask:0x3
  buffer_load_dwordx4 v57, s[32:35], 0 offen lds
  s_nop 0
  v_add_u32_dpp v56, v17, v2 row_newbcast:8 row_mask:0xf bank_mask:0xc
  s_add_u32 m0, s76, 4096
  v_add_u32_dpp v57, v23, v2 row_newbcast:1 row_mask:0xf bank_mask:0x3
  buffer_load_dwordx4 v58, s[32:35], 0 offen lds
  s_nop 0
  v_add_u32_dpp v57, v21, v2 row_newbcast:8 row_mask:0xf bank_mask:0xc
  s_add_u32 m0, s76, 6144
  v_add_u32_dpp v58, v27, v2 row_newbcast:1 row_mask:0xf bank_mask:0x3
  buffer_load_dwordx4 v59, s[32:35], 0 offen lds
  s_nop 0
  v_add_u32_dpp v58, v25, v2 row_newbcast:8 row_mask:0xf bank_mask:0xc
  s_add_u32 m0, s76, 8192
  v_add_u32_dpp v59, v31, v2 row_newbcast:1 row_mask:0xf bank_mask:0x3
  buffer_load_dwordx4 v60, s[32:35], 0 offen lds
  s_nop 0
  v_add_u32_dpp v59, v29, v2 row_newbcast:8 row_mask:0xf bank_mask:0xc
  s_add_u32 m0, s76, 10240
  v_add_u32_dpp v60, v35, v2 row_newbcast:1 row_mask:0xf bank_mask:0x3
  buffer_load_dwordx4 v61, s[32:35], 0 offen lds
  s_nop 0
  v_add_u32_dpp v60, v33, v2 row_newbcast:8 row_mask:0xf bank_mask:0xc
  s_add_u32 m0, s76, 12288
  v_add_u32_dpp v61, v39, v2 row_newbcast:1 row_mask:0xf bank_mask:0x3
  buffer_load_dwordx4 v62, s[32:35], 0 offen lds
  s_nop 0
  v_add_u32_dpp v61, v37, v2 row_newbcast:8 row_mask:0xf bank_mask:0xc
  s_add_u32 m0, s76, 14336
  v_add_u32_dpp v62, v43, v2 row_newbcast:1 row_mask:0xf bank_mask:0x3
  buffer_load_dwordx4 v63, s[32:35], 0 offen lds
  s_nop 0
  v_add_u32_dpp v62, v41, v2 row_newbcast:8 row_mask:0xf bank_mask:0xc
  s_add_u32 m0, s76, 16384
  v_add_u32_dpp v63, v47, v2 row_newbcast:1 row_mask:0xf bank_mask:0x3
  buffer_load_dwordx4 v64, s[32:35], 0 offen lds
  s_nop 0
  v_add_u32_dpp v63, v45, v2 row_newbcast:8 row_mask:0xf bank_mask:0xc
  s_add_u32 m0, s76, 18432
  v_add_u32_dpp v64, v51, v2 row_newbcast:1 row_mask:0xf bank_mask:0x3
  buffer_load_dwordx4 v65, s[32:35], 0 offen lds
  s_nop 0
  v_add_u32_dpp v64, v49, v2 row_newbcast:8 row_mask:0xf bank_mask:0xc
  v_add_u32_dpp v65, v55, v2 row_newbcast:1 row_mask:0xf bank_mask:0x3
  s_nop 1
  v_add_u32_dpp v65, v53, v2 row_newbcast:8 row_mask:0xf bank_mask:0xc
  s_waitcnt vmcnt(10)
  s_barrier
  s_add_u32 m0, s75, 131072
  s_nop 0
  buffer_load_dwordx4 v4, s[44:47], s74 offen lds
  s_add_u32 m0, s75, 132096
  s_nop 0
  buffer_load_dwordx4 v5, s[44:47], s74 offen lds
  s_add_u32 s74, s74, 106496
  s_add_u32 m0, s75, 139264
  s_nop 0
  buffer_load_dwordx4 v4, s[44:47], s74 offen lds
  s_add_u32 m0, s75, 140288
  s_nop 0
  buffer_load_dwordx4 v5, s[44:47], s74 offen lds
  s_add_u32 s74, s74, 106496
  s_add_u32 m0, s76, 40960
  s_nop 0
  buffer_load_dwordx4 v56, s[32:35], 0 offen lds
  s_add_u32 m0, s76, 43008
  v_add_u32_dpp v56, v16, v2 row_newbcast:2 row_mask:0xf bank_mask:0x3
  buffer_load_dwordx4 v57, s[32:35], 0 offen lds
  s_nop 0
  v_add_u32_dpp v56, v18, v2 row_newbcast:8 row_mask:0xf bank_mask:0xc
  s_add_u32 m0, s76, 45056
  v_add_u32_dpp v57, v20, v2 row_newbcast:2 row_mask:0xf bank_mask:0x3
  buffer_load_dwordx4 v58, s[32:35], 0 offen lds
  s_nop 0
  v_add_u32_dpp v57, v22, v2 row_newbcast:8 row_mask:0xf bank_mask:0xc
  s_add_u32 m0, s76, 47104
  v_add_u32_dpp v58, v24, v2 row_newbcast:2 row_mask:0xf bank_mask:0x3
  buffer_load_dwordx4 v59, s[32:35], 0 offen lds
  s_nop 0
  v_add_u32_dpp v58, v26, v2 row_newbcast:8 row_mask:0xf bank_mask:0xc
  s_add_u32 m0, s76, 49152
  v_add_u32_dpp v59, v28, v2 row_newbcast:2 row_mask:0xf bank_mask:0x3
  buffer_load_dwordx4 v60, s[32:35], 0 offen lds
  s_nop 0
  v_add_u32_dpp v59, v30, v2 row_newbcast:8 row_mask:0xf bank_mask:0xc
  s_add_u32 m0, s76, 51200
  v_add_u32_dpp v60, v32, v2 row_newbcast:2 row_mask:0xf bank_mask:0x3
  buffer_load_dwordx4 v61, s[32:35], 0 offen lds
  s_nop 0
  v_add_u32_dpp v60, v34, v2 row_newbcast:8 row_mask:0xf bank_mask:0xc
  s_add_u32 m0, s76, 53248
  v_add_u32_dpp v61, v36, v2 row_newbcast:2 row_mask:0xf bank_mask:0x3
  buffer_load_dwordx4 v62, s[32:35], 0 offen lds
  s_nop 0
  v_add_u32_dpp v61, v38, v2 row_newbcast:8 row_mask:0xf bank_mask:0xc
  s_add_u32 m0, s76, 55296
  v_add_u32_dpp v62, v40, v2 row_newbcast:2 row_mask:0xf bank_mask:0x3
  buffer_load_dwordx4 v63, s[32:35], 0 offen lds
  s_nop 0
  v_add_u32_dpp v62, v42, v2 row_newbcast:8 row_mask:0xf bank_mask:0xc
  s_add_u32 m0, s76, 57344
  v_add_u32_dpp v63, v44, v2 row_newbcast:2 row_mask:0xf bank_mask:0x3
  buffer_load_dwordx4 v64, s[32:35], 0 offen lds
  s_nop 0
  v_add_u32_dpp v63, v46, v2 row_newbcast:8 row_mask:0xf bank_mask:0xc
  s_add_u32 m0, s76, 59392
  v_add_u32_dpp v64, v48, v2 row_newbcast:2 row_mask:0xf bank_mask:0x3
  buffer_load_dwordx4 v65, s[32:35], 0 offen lds
  s_nop 0
  v_add_u32_dpp v64, v50, v2 row_newbcast:8 row_mask:0xf bank_mask:0xc
  v_add_u32_dpp v65, v52, v2 row_newbcast:2 row_mask:0xf bank_mask:0x3
  s_nop 1
  v_add_u32_dpp v65, v54, v2 row_newbcast:8 row_mask:0xf bank_mask:0xc
  s_mov_b64 exec, 0x3ff
  buffer_load_dword v103, v84, s[44:47], s85 offen
  s_mov_b64 exec, -1
  s_add_u32 s85, s85, 865280
  s_waitcnt vmcnt(11)
  s_barrier
  s_add_u32 m0, s75, 147456
  s_nop 0
  buffer_load_dwordx4 v4, s[44:47], s74 offen lds
  s_add_u32 m0, s75, 148480
  s_nop 0
  buffer_load_dwordx4 v5, s[44:47], s74 offen lds
  s_add_u32 s74, s74, 106496
  s_add_u32 m0, s75, 155648
  s_nop 0
  buffer_load_dwordx4 v4, s[44:47], s74 offen lds
  s_add_u32 m0, s75, 156672
  s_nop 0
  buffer_load_dwordx4 v5, s[44:47], s74 offen lds
  s_add_u32 s74, s74, 106496
  s_add_u32 m0, s76, 81920
  s_nop 0
  buffer_load_dwordx4 v56, s[32:35], 0 offen lds
  s_add_u32 m0, s76, 83968
  v_add_u32_dpp v56, v17, v2 row_newbcast:2 row_mask:0xf bank_mask:0x3
  buffer_load_dwordx4 v57, s[32:35], 0 offen lds
  s_nop 0
  v_add_u32_dpp v56, v19, v2 row_newbcast:8 row_mask:0xf bank_mask:0xc
  s_add_u32 m0, s76, 86016
  v_add_u32_dpp v57, v21, v2 row_newbcast:2 row_mask:0xf bank_mask:0x3
  buffer_load_dwordx4 v58, s[32:35], 0 offen lds
  s_nop 0
  v_add_u32_dpp v57, v23, v2 row_newbcast:8 row_mask:0xf bank_mask:0xc
  s_add_u32 m0, s76, 88064
  v_add_u32_dpp v58, v25, v2 row_newbcast:2 row_mask:0xf bank_mask:0x3
  buffer_load_dwordx4 v59, s[32:35], 0 offen lds
  s_nop 0
  v_add_u32_dpp v58, v27, v2 row_newbcast:8 row_mask:0xf bank_mask:0xc
  s_add_u32 m0, s76, 90112
  v_add_u32_dpp v59, v29, v2 row_newbcast:2 row_mask:0xf bank_mask:0x3
  buffer_load_dwordx4 v60, s[32:35], 0 offen lds
  s_nop 0
  v_add_u32_dpp v59, v31, v2 row_newbcast:8 row_mask:0xf bank_mask:0xc
  s_add_u32 m0, s76, 92160
  v_add_u32_dpp v60, v33, v2 row_newbcast:2 row_mask:0xf bank_mask:0x3
  buffer_load_dwordx4 v61, s[32:35], 0 offen lds
  s_nop 0
  v_add_u32_dpp v60, v35, v2 row_newbcast:8 row_mask:0xf bank_mask:0xc
  s_add_u32 m0, s76, 94208
  v_add_u32_dpp v61, v37, v2 row_newbcast:2 row_mask:0xf bank_mask:0x3
  buffer_load_dwordx4 v62, s[32:35], 0 offen lds
  s_nop 0
  v_add_u32_dpp v61, v39, v2 row_newbcast:8 row_mask:0xf bank_mask:0xc
  s_add_u32 m0, s76, 96256
  v_add_u32_dpp v62, v41, v2 row_newbcast:2 row_mask:0xf bank_mask:0x3
  buffer_load_dwordx4 v63, s[32:35], 0 offen lds
  s_nop 0
  v_add_u32_dpp v62, v43, v2 row_newbcast:8 row_mask:0xf bank_mask:0xc
  s_add_u32 m0, s76, 98304
  v_add_u32_dpp v63, v45, v2 row_newbcast:2 row_mask:0xf bank_mask:0x3
  buffer_load_dwordx4 v64, s[32:35], 0 offen lds
  s_nop 0
  v_add_u32_dpp v63, v47, v2 row_newbcast:8 row_mask:0xf bank_mask:0xc
  s_add_u32 m0, s76, 100352
  v_add_u32_dpp v64, v49, v2 row_newbcast:2 row_mask:0xf bank_mask:0x3
  buffer_load_dwordx4 v65, s[32:35], 0 offen lds
  s_nop 0
  v_add_u32_dpp v64, v51, v2 row_newbcast:8 row_mask:0xf bank_mask:0xc
  v_add_u32_dpp v65, v53, v2 row_newbcast:2 row_mask:0xf bank_mask:0x3
  s_nop 1
  v_add_u32_dpp v65, v55, v2 row_newbcast:8 row_mask:0xf bank_mask:0xc
  s_waitcnt vmcnt(10)
  s_barrier
  s_add_u32 m0, s75, 131072
  s_nop 0
  buffer_load_dwordx4 v4, s[44:47], s74 offen lds
  s_add_u32 m0, s75, 132096
  s_nop 0
  buffer_load_dwordx4 v5, s[44:47], s74 offen lds
  s_add_u32 s74, s74, 106496
  s_add_u32 m0, s75, 139264
  s_nop 0
  buffer_load_dwordx4 v4, s[44:47], s74 offen lds
  s_add_u32 m0, s75, 140288
  s_nop 0
  buffer_load_dwordx4 v5, s[44:47], s74 offen lds
  s_add_u32 s74, s74, 106496
  s_add_u32 m0, s76, 0
  s_nop 0
  buffer_load_dwordx4 v56, s[32:35], 0 offen lds
  s_add_u32 m0, s76, 2048
  v_add_u32_dpp v56, v18, v2 row_newbcast:2 row_mask:0xf bank_mask:0x3
  buffer_load_dwordx4 v57, s[32:35], 0 offen lds
  s_nop 0
  v_add_u32_dpp v56, v16, v2 row_newbcast:9 row_mask:0xf bank_mask:0xc
  s_add_u32 m0, s76, 4096
  v_add_u32_dpp v57, v22, v2 row_newbcast:2 row_mask:0xf bank_mask:0x3
  buffer_load_dwordx4 v58, s[32:35], 0 offen lds
  s_nop 0
  v_add_u32_dpp v57, v20, v2 row_newbcast:9 row_mask:0xf bank_mask:0xc
  s_add_u32 m0, s76, 6144
  v_add_u32_dpp v58, v26, v2 row_newbcast:2 row_mask:0xf bank_mask:0x3
  buffer_load_dwordx4 v59, s[32:35], 0 offen lds
  s_nop 0
  v_add_u32_dpp v58, v24, v2 row_newbcast:9 row_mask:0xf bank_mask:0xc
  s_add_u32 m0, s76, 8192
  v_add_u32_dpp v59, v30, v2 row_newbcast:2 row_mask:0xf bank_mask:0x3
  buffer_load_dwordx4 v60, s[32:35], 0 offen lds
  s_nop 0
  v_add_u32_dpp v59, v28, v2 row_newbcast:9 row_mask:0xf bank_mask:0xc
  s_add_u32 m0, s76, 10240
  v_add_u32_dpp v60, v34, v2 row_newbcast:2 row_mask:0xf bank_mask:0x3
  buffer_load_dwordx4 v61, s[32:35], 0 offen lds
  s_nop 0
  v_add_u32_dpp v60, v32, v2 row_newbcast:9 row_mask:0xf bank_mask:0xc
  s_add_u32 m0, s76, 12288
  v_add_u32_dpp v61, v38, v2 row_newbcast:2 row_mask:0xf bank_mask:0x3
  buffer_load_dwordx4 v62, s[32:35], 0 offen lds
  s_nop 0
  v_add_u32_dpp v61, v36, v2 row_newbcast:9 row_mask:0xf bank_mask:0xc
  s_add_u32 m0, s76, 14336
  v_add_u32_dpp v62, v42, v2 row_newbcast:2 row_mask:0xf bank_mask:0x3
  buffer_load_dwordx4 v63, s[32:35], 0 offen lds
  s_nop 0
  v_add_u32_dpp v62, v40, v2 row_newbcast:9 row_mask:0xf bank_mask:0xc
  s_add_u32 m0, s76, 16384
  v_add_u32_dpp v63, v46, v2 row_newbcast:2 row_mask:0xf bank_mask:0x3
  buffer_load_dwordx4 v64, s[32:35], 0 offen lds
  s_nop 0
  v_add_u32_dpp v63, v44, v2 row_newbcast:9 row_mask:0xf bank_mask:0xc
  s_add_u32 m0, s76, 18432
  v_add_u32_dpp v64, v50, v2 row_newbcast:2 row_mask:0xf bank_mask:0x3
  buffer_load_dwordx4 v65, s[32:35], 0 offen lds
  s_nop 0
  v_add_u32_dpp v64, v48, v2 row_newbcast:9 row_mask:0xf bank_mask:0xc
  v_add_u32_dpp v65, v54, v2 row_newbcast:2 row_mask:0xf bank_mask:0x3
  s_nop 1
  v_add_u32_dpp v65, v52, v2 row_newbcast:9 row_mask:0xf bank_mask:0xc
  v_lshlrev_b32 v101, 7, v70
  s_mov_b32 exec_lo, 0xffffffff
  s_mov_b32 exec_hi, 0x0
  buffer_load_dword v102, v101, s[32:35], 0 offen
  s_mov_b64 exec, -1
  v_mov_b32 v70, v71
  v_mov_b32 v71, v72
  v_mov_b32 v72, v73
  v_mov_b32 v73, v74
  v_mov_b32 v74, 0xffffff
  s_waitcnt vmcnt(11)
  s_barrier
  s_add_u32 m0, s75, 147456
  s_nop 0
  buffer_load_dwordx4 v4, s[44:47], s74 offen lds
  s_add_u32 m0, s75, 148480
  s_nop 0
  buffer_load_dwordx4 v5, s[44:47], s74 offen lds
  s_add_u32 s74, s74, 106496
  s_add_u32 m0, s75, 155648
  s_nop 0
  buffer_load_dwordx4 v4, s[44:47], s74 offen lds
  s_add_u32 m0, s75, 156672
  s_nop 0
  buffer_load_dwordx4 v5, s[44:47], s74 offen lds
  s_add_u32 s74, s74, 106496
  s_add_u32 m0, s76, 40960
  s_nop 0
  buffer_load_dwordx4 v56, s[32:35], 0 offen lds
  s_add_u32 m0, s76, 43008
  v_add_u32_dpp v56, v19, v2 row_newbcast:2 row_mask:0xf bank_mask:0x3
  buffer_load_dwordx4 v57, s[32:35], 0 offen lds
  s_nop 0
  v_add_u32_dpp v56, v17, v2 row_newbcast:9 row_mask:0xf bank_mask:0xc
  s_add_u32 m0, s76, 45056
  v_add_u32_dpp v57, v23, v2 row_newbcast:2 row_mask:0xf bank_mask:0x3
  buffer_load_dwordx4 v58, s[32:35], 0 offen lds
  s_nop 0
  v_add_u32_dpp v57, v21, v2 row_newbcast:9 row_mask:0xf bank_mask:0xc
  s_add_u32 m0, s76, 47104
  v_add_u32_dpp v58, v27, v2 row_newbcast:2 row_mask:0xf bank_mask:0x3
  buffer_load_dwordx4 v59, s[32:35], 0 offen lds
  s_nop 0
  v_add_u32_dpp v58, v25, v2 row_newbcast:9 row_mask:0xf bank_mask:0xc
  s_add_u32 m0, s76, 49152
  v_add_u32_dpp v59, v31, v2 row_newbcast:2 row_mask:0xf bank_mask:0x3
  buffer_load_dwordx4 v60, s[32:35], 0 offen lds
  s_nop 0
  v_add_u32_dpp v59, v29, v2 row_newbcast:9 row_mask:0xf bank_mask:0xc
  s_add_u32 m0, s76, 51200
  v_add_u32_dpp v60, v35, v2 row_newbcast:2 row_mask:0xf bank_mask:0x3
  buffer_load_dwordx4 v61, s[32:35], 0 offen lds
  s_nop 0
  v_add_u32_dpp v60, v33, v2 row_newbcast:9 row_mask:0xf bank_mask:0xc
  s_add_u32 m0, s76, 53248
  v_add_u32_dpp v61, v39, v2 row_newbcast:2 row_mask:0xf bank_mask:0x3
  buffer_load_dwordx4 v62, s[32:35], 0 offen lds
  s_nop 0
  v_add_u32_dpp v61, v37, v2 row_newbcast:9 row_mask:0xf bank_mask:0xc
  s_add_u32 m0, s76, 55296
  v_add_u32_dpp v62, v43, v2 row_newbcast:2 row_mask:0xf bank_mask:0x3
  buffer_load_dwordx4 v63, s[32:35], 0 offen lds
  s_nop 0
  v_add_u32_dpp v62, v41, v2 row_newbcast:9 row_mask:0xf bank_mask:0xc
  s_add_u32 m0, s76, 57344
  v_add_u32_dpp v63, v47, v2 row_newbcast:2 row_mask:0xf bank_mask:0x3
  buffer_load_dwordx4 v64, s[32:35], 0 offen lds
  s_nop 0
  v_add_u32_dpp v63, v45, v2 row_newbcast:9 row_mask:0xf bank_mask:0xc
  s_add_u32 m0, s76, 59392
  v_add_u32_dpp v64, v51, v2 row_newbcast:2 row_mask:0xf bank_mask:0x3
  buffer_load_dwordx4 v65, s[32:35], 0 offen lds
  s_nop 0
  v_add_u32_dpp v64, v49, v2 row_newbcast:9 row_mask:0xf bank_mask:0xc
  v_add_u32_dpp v65, v55, v2 row_newbcast:2 row_mask:0xf bank_mask:0x3
  s_nop 1
  v_add_u32_dpp v65, v53, v2 row_newbcast:9 row_mask:0xf bank_mask:0xc
  s_waitcnt vmcnt(10)
  s_cmp_lg_u32 s72, 1
  s_cbranch_scc1 L_nolpf
  s_mov_b64 exec, 1048575
  global_load_dword v10, v[8:9], off
  s_mov_b64 exec, -1
  s_mov_b32 m0, 123136
  s_mov_b64 exec, 0xffff
  buffer_load_dwordx4 v11, s[52:55], s77 offen lds
  s_mov_b64 exec, -1
L_nolpf:
  s_barrier
  s_add_u32 m0, s75, 131072
  s_nop 0
  buffer_load_dwordx4 v4, s[44:47], s74 offen lds
  s_add_u32 m0, s75, 132096
  s_nop 0
  buffer_load_dwordx4 v5, s[44:47], s74 offen lds
  s_add_u32 s74, s74, 106496
  s_add_u32 m0, s75, 139264
  s_nop 0
  buffer_load_dwordx4 v4, s[44:47], s74 offen lds
  s_add_u32 m0, s75, 140288
  s_nop 0
  buffer_load_dwordx4 v5, s[44:47], s74 offen lds
  s_add_u32 s74, s74, 106496
  s_add_u32 m0, s76, 81920
  s_nop 0
  buffer_load_dwordx4 v56, s[32:35], 0 offen lds
  s_add_u32 m0, s76, 83968
  v_add_u32_dpp v56, v16, v2 row_newbcast:3 row_mask:0xf bank_mask:0x3
  buffer_load_dwordx4 v57, s[32:35], 0 offen lds
  s_nop 0
  v_add_u32_dpp v56, v18, v2 row_newbcast:9 row_mask:0xf bank_mask:0xc
  s_add_u32 m0, s76, 86016
  v_add_u32_dpp v57, v20, v2 row_newbcast:3 row_mask:0xf bank_mask:0x3
  buffer_load_dwordx4 v58, s[32:35], 0 offen lds
  s_nop 0
  v_add_u32_dpp v57, v22, v2 row_newbcast:9 row_mask:0xf bank_mask:0xc
  s_add_u32 m0, s76, 88064
  v_add_u32_dpp v58, v24, v2 row_newbcast:3 row_mask:0xf bank_mask:0x3
  buffer_load_dwordx4 v59, s[32:35], 0 offen lds
  s_nop 0
  v_add_u32_dpp v58, v26, v2 row_newbcast:9 row_mask:0xf bank_mask:0xc
  s_add_u32 m0, s76, 90112
  v_add_u32_dpp v59, v28, v2 row_newbcast:3 row_mask:0xf bank_mask:0x3
  buffer_load_dwordx4 v60, s[32:35], 0 offen lds
  s_nop 0
  v_add_u32_dpp v59, v30, v2 row_newbcast:9 row_mask:0xf bank_mask:0xc
  s_add_u32 m0, s76, 92160
  v_add_u32_dpp v60, v32, v2 row_newbcast:3 row_mask:0xf bank_mask:0x3
  buffer_load_dwordx4 v61, s[32:35], 0 offen lds
  s_nop 0
  v_add_u32_dpp v60, v34, v2 row_newbcast:9 row_mask:0xf bank_mask:0xc
  s_add_u32 m0, s76, 94208
  v_add_u32_dpp v61, v36, v2 row_newbcast:3 row_mask:0xf bank_mask:0x3
  buffer_load_dwordx4 v62, s[32:35], 0 offen lds
  s_nop 0
  v_add_u32_dpp v61, v38, v2 row_newbcast:9 row_mask:0xf bank_mask:0xc
  s_add_u32 m0, s76, 96256
  v_add_u32_dpp v62, v40, v2 row_newbcast:3 row_mask:0xf bank_mask:0x3
  buffer_load_dwordx4 v63, s[32:35], 0 offen lds
  s_nop 0
  v_add_u32_dpp v62, v42, v2 row_newbcast:9 row_mask:0xf bank_mask:0xc
  s_add_u32 m0, s76, 98304
  v_add_u32_dpp v63, v44, v2 row_newbcast:3 row_mask:0xf bank_mask:0x3
  buffer_load_dwordx4 v64, s[32:35], 0 offen lds
  s_nop 0
  v_add_u32_dpp v63, v46, v2 row_newbcast:9 row_mask:0xf bank_mask:0xc
  s_add_u32 m0, s76, 100352
  v_add_u32_dpp v64, v48, v2 row_newbcast:3 row_mask:0xf bank_mask:0x3
  buffer_load_dwordx4 v65, s[32:35], 0 offen lds
  s_nop 0
  v_add_u32_dpp v64, v50, v2 row_newbcast:9 row_mask:0xf bank_mask:0xc
  v_add_u32_dpp v65, v52, v2 row_newbcast:3 row_mask:0xf bank_mask:0x3
  s_nop 1
  v_add_u32_dpp v65, v54, v2 row_newbcast:9 row_mask:0xf bank_mask:0xc
  s_mov_b64 exec, 0x3ff
  buffer_load_dword v103, v84, s[44:47], s85 offen
  s_mov_b64 exec, -1
  s_add_u32 s85, s85, 865280
  s_waitcnt vmcnt(11)
  s_barrier
  s_add_u32 m0, s75, 147456
  s_nop 0
  buffer_load_dwordx4 v4, s[44:47], s74 offen lds
  s_add_u32 m0, s75, 148480
  s_nop 0
  buffer_load_dwordx4 v5, s[44:47], s74 offen lds
  s_add_u32 s74, s74, 106496
  s_add_u32 m0, s75, 155648
  s_nop 0
  buffer_load_dwordx4 v4, s[44:47], s74 offen lds
  s_add_u32 m0, s75, 156672
  s_nop 0
  buffer_load_dwordx4 v5, s[44:47], s74 offen lds
  s_add_u32 s74, s74, 106496
  s_add_u32 m0, s76, 0
  s_nop 0
  buffer_load_dwordx4 v56, s[32:35], 0 offen lds
  s_add_u32 m0, s76, 2048
  v_add_u32_dpp v56, v17, v2 row_newbcast:3 row_mask:0xf bank_mask:0x3
  buffer_load_dwordx4 v57, s[32:35], 0 offen lds
  s_nop 0
  v_add_u32_dpp v56, v19, v2 row_newbcast:9 row_mask:0xf bank_mask:0xc
  s_add_u32 m0, s76, 4096
  v_add_u32_dpp v57, v21, v2 row_newbcast:3 row_mask:0xf bank_mask:0x3
  buffer_load_dwordx4 v58, s[32:35], 0 offen lds
  s_nop 0
  v_add_u32_dpp v57, v23, v2 row_newbcast:9 row_mask:0xf bank_mask:0xc
  s_add_u32 m0, s76, 6144
  v_add_u32_dpp v58, v25, v2 row_newbcast:3 row_mask:0xf bank_mask:0x3
  buffer_load_dwordx4 v59, s[32:35], 0 offen lds
  s_nop 0
  v_add_u32_dpp v58, v27, v2 row_newbcast:9 row_mask:0xf bank_mask:0xc
  s_add_u32 m0, s76, 8192
  v_add_u32_dpp v59, v29, v2 row_newbcast:3 row_mask:0xf bank_mask:0x3
  buffer_load_dwordx4 v60, s[32:35], 0 offen lds
  s_nop 0
  v_add_u32_dpp v59, v31, v2 row_newbcast:9 row_mask:0xf bank_mask:0xc
  s_add_u32 m0, s76, 10240
  v_add_u32_dpp v60, v33, v2 row_newbcast:3 row_mask:0xf bank_mask:0x3
  buffer_load_dwordx4 v61, s[32:35], 0 offen lds
  s_nop 0
  v_add_u32_dpp v60, v35, v2 row_newbcast:9 row_mask:0xf bank_mask:0xc
  s_add_u32 m0, s76, 12288
  v_add_u32_dpp v61, v37, v2 row_newbcast:3 row_mask:0xf bank_mask:0x3
  buffer_load_dwordx4 v62, s[32:35], 0 offen lds
  s_nop 0
  v_add_u32_dpp v61, v39, v2 row_newbcast:9 row_mask:0xf bank_mask:0xc
  s_add_u32 m0, s76, 14336
  v_add_u32_dpp v62, v41, v2 row_newbcast:3 row_mask:0xf bank_mask:0x3
  buffer_load_dwordx4 v63, s[32:35], 0 offen lds
  s_nop 0
  v_add_u32_dpp v62, v43, v2 row_newbcast:9 row_mask:0xf bank_mask:0xc
  s_add_u32 m0, s76, 16384
  v_add_u32_dpp v63, v45, v2 row_newbcast:3 row_mask:0xf bank_mask:0x3
  buffer_load_dwordx4 v64, s[32:35], 0 offen lds
  s_nop 0
  v_add_u32_dpp v63, v47, v2 row_newbcast:9 row_mask:0xf bank_mask:0xc
  s_add_u32 m0, s76, 18432
  v_add_u32_dpp v64, v49, v2 row_newbcast:3 row_mask:0xf bank_mask:0x3
  buffer_load_dwordx4 v65, s[32:35], 0 offen lds
  s_nop 0
  v_add_u32_dpp v64, v51, v2 row_newbcast:9 row_mask:0xf bank_mask:0xc
  v_add_u32_dpp v65, v53, v2 row_newbcast:3 row_mask:0xf bank_mask:0x3
  s_nop 1
  v_add_u32_dpp v65, v55, v2 row_newbcast:9 row_mask:0xf bank_mask:0xc
  s_waitcnt vmcnt(10)
  s_barrier
  s_add_u32 m0, s75, 131072
  s_nop 0
  buffer_load_dwordx4 v4, s[44:47], s74 offen lds
  s_add_u32 m0, s75, 132096
  s_nop 0
  buffer_load_dwordx4 v5, s[44:47], s74 offen lds
  s_add_u32 s74, s74, 106496
  s_add_u32 m0, s75, 139264
  s_nop 0
  buffer_load_dwordx4 v4, s[44:47], s74 offen lds
  s_add_u32 m0, s75, 140288
  s_nop 0
  buffer_load_dwordx4 v5, s[44:47], s74 offen lds
  s_add_u32 s74, s74, 106496
  s_add_u32 m0, s76, 40960
  s_nop 0
  buffer_load_dwordx4 v56, s[32:35], 0 offen lds
  s_add_u32 m0, s76, 43008
  v_add_u32_dpp v56, v18, v2 row_newbcast:3 row_mask:0xf bank_mask:0x3
  buffer_load_dwordx4 v57, s[32:35], 0 offen lds
  s_nop 0
  v_add_u32_dpp v56, v16, v2 row_newbcast:10 row_mask:0xf bank_mask:0xc
  s_add_u32 m0, s76, 45056
  v_add_u32_dpp v57, v22, v2 row_newbcast:3 row_mask:0xf bank_mask:0x3
  buffer_load_dwordx4 v58, s[32:35], 0 offen lds
  s_nop 0
  v_add_u32_dpp v57, v20, v2 row_newbcast:10 row_mask:0xf bank_mask:0xc
  s_add_u32 m0, s76, 47104
  v_add_u32_dpp v58, v26, v2 row_newbcast:3 row_mask:0xf bank_mask:0x3
  buffer_load_dwordx4 v59, s[32:35], 0 offen lds
  s_nop 0
  v_add_u32_dpp v58, v24, v2 row_newbcast:10 row_mask:0xf bank_mask:0xc
  s_add_u32 m0, s76, 49152
  v_add_u32_dpp v59, v30, v2 row_newbcast:3 row_mask:0xf bank_mask:0x3
  buffer_load_dwordx4 v60, s[32:35], 0 offen lds
  s_nop 0
  v_add_u32_dpp v59, v28, v2 row_newbcast:10 row_mask:0xf bank_mask:0xc
  s_add_u32 m0, s76, 51200
  v_add_u32_dpp v60, v34, v2 row_newbcast:3 row_mask:0xf bank_mask:0x3
  buffer_load_dwordx4 v61, s[32:35], 0 offen lds
  s_nop 0
  v_add_u32_dpp v60, v32, v2 row_newbcast:10 row_mask:0xf bank_mask:0xc
  s_add_u32 m0, s76, 53248
  v_add_u32_dpp v61, v38, v2 row_newbcast:3 row_mask:0xf bank_mask:0x3
  buffer_load_dwordx4 v62, s[32:35], 0 offen lds
  s_nop 0
  v_add_u32_dpp v61, v36, v2 row_newbcast:10 row_mask:0xf bank_mask:0xc
  s_add_u32 m0, s76, 55296
  v_add_u32_dpp v62, v42, v2 row_newbcast:3 row_mask:0xf bank_mask:0x3
  buffer_load_dwordx4 v63, s[32:35], 0 offen lds
  s_nop 0
  v_add_u32_dpp v62, v40, v2 row_newbcast:10 row_mask:0xf bank_mask:0xc
  s_add_u32 m0, s76, 57344
  v_add_u32_dpp v63, v46, v2 row_newbcast:3 row_mask:0xf bank_mask:0x3
  buffer_load_dwordx4 v64, s[32:35], 0 offen lds
  s_nop 0
  v_add_u32_dpp v63, v44, v2 row_newbcast:10 row_mask:0xf bank_mask:0xc
  s_add_u32 m0, s76, 59392
  v_add_u32_dpp v64, v50, v2 row_newbcast:3 row_mask:0xf bank_mask:0x3
  buffer_load_dwordx4 v65, s[32:35], 0 offen lds
  s_nop 0
  v_add_u32_dpp v64, v48, v2 row_newbcast:10 row_mask:0xf bank_mask:0xc
  v_add_u32_dpp v65, v54, v2 row_newbcast:3 row_mask:0xf bank_mask:0x3
  s_nop 1
  v_add_u32_dpp v65, v52, v2 row_newbcast:10 row_mask:0xf bank_mask:0xc
  v_mov_b32_dpp v16, v16 row_shl:3 row_mask:0xf bank_mask:0xf
  v_mov_b32_dpp v18, v18 row_shl:3 row_mask:0xf bank_mask:0xf
  v_mov_b32_dpp v20, v20 row_shl:3 row_mask:0xf bank_mask:0xf
  v_mov_b32_dpp v22, v22 row_shl:3 row_mask:0xf bank_mask:0xf
  v_mov_b32_dpp v24, v24 row_shl:3 row_mask:0xf bank_mask:0xf
  v_mov_b32_dpp v26, v26 row_shl:3 row_mask:0xf bank_mask:0xf
  v_mov_b32_dpp v28, v28 row_shl:3 row_mask:0xf bank_mask:0xf
  v_mov_b32_dpp v30, v30 row_shl:3 row_mask:0xf bank_mask:0xf
  v_mov_b32_dpp v32, v32 row_shl:3 row_mask:0xf bank_mask:0xf
  v_mov_b32_dpp v34, v34 row_shl:3 row_mask:0xf bank_mask:0xf
  v_mov_b32_dpp v36, v36 row_shl:3 row_mask:0xf bank_mask:0xf
  v_mov_b32_dpp v38, v38 row_shl:3 row_mask:0xf bank_mask:0xf
  v_mov_b32_dpp v40, v40 row_shl:3 row_mask:0xf bank_mask:0xf
  v_mov_b32_dpp v42, v42 row_shl:3 row_mask:0xf bank_mask:0xf
  v_mov_b32_dpp v44, v44 row_shl:3 row_mask:0xf bank_mask:0xf
  v_mov_b32_dpp v46, v46 row_shl:3 row_mask:0xf bank_mask:0xf
  v_mov_b32_dpp v48, v48 row_shl:3 row_mask:0xf bank_mask:0xf
  v_mov_b32_dpp v50, v50 row_shl:3 row_mask:0xf bank_mask:0xf
  v_mov_b32_dpp v52, v52 row_shl:3 row_mask:0xf bank_mask:0xf
  v_mov_b32_dpp v54, v54 row_shl:3 row_mask:0xf bank_mask:0xf
  v_lshlrev_b32 v101, 7, v70
  s_mov_b32 exec_lo, 0xffffffff
  s_mov_b32 exec_hi, 0x0
  buffer_load_dword v102, v101, s[32:35], 0 offen
  s_mov_b64 exec, -1
  v_mov_b32 v70, v71
  v_mov_b32 v71, v72
  v_mov_b32 v72, v73
  v_mov_b32 v73, v74
  v_mov_b32 v74, 0xffffff
  s_waitcnt vmcnt(11)
  s_barrier
  s_add_u32 m0, s75, 147456
  s_nop 0
  buffer_load_dwordx4 v4, s[44:47], s74 offen lds
  s_add_u32 m0, s75, 148480
  s_nop 0
  buffer_load_dwordx4 v5, s[44:47], s74 offen lds
  s_add_u32 s74, s74, 106496
  s_add_u32 m0, s75, 155648
  s_nop 0
  buffer_load_dwordx4 v4, s[44:47], s74 offen lds
  s_add_u32 m0, s75, 156672
  s_nop 0
  buffer_load_dwordx4 v5, s[44:47], s74 offen lds
  s_add_u32 s74, s74, 106496
  s_cmp_eq_u32 s72, 1
  s_cbranch_scc1 L_ld_tail0
  s_add_u32 m0, s76, 81920
  s_nop 0
  buffer_load_dwordx4 v56, s[32:35], 0 offen lds
  s_add_u32 m0, s76, 83968
  v_add_u32_dpp v56, v19, v2 row_newbcast:3 row_mask:0xf bank_mask:0x3
  buffer_load_dwordx4 v57, s[32:35], 0 offen lds
  s_nop 0
  v_add_u32_dpp v56, v17, v2 row_newbcast:10 row_mask:0xf bank_mask:0xc
  s_add_u32 m0, s76, 86016
  v_add_u32_dpp v57, v23, v2 row_newbcast:3 row_mask:0xf bank_mask:0x3
  buffer_load_dwordx4 v58, s[32:35], 0 offen lds
  s_nop 0
  v_add_u32_dpp v57, v21, v2 row_newbcast:10 row_mask:0xf bank_mask:0xc
  s_add_u32 m0, s76, 88064
  v_add_u32_dpp v58, v27, v2 row_newbcast:3 row_mask:0xf bank_mask:0x3
  buffer_load_dwordx4 v59, s[32:35], 0 offen lds
  s_nop 0
  v_add_u32_dpp v58, v25, v2 row_newbcast:10 row_mask:0xf bank_mask:0xc
  s_add_u32 m0, s76, 90112
  v_add_u32_dpp v59, v31, v2 row_newbcast:3 row_mask:0xf bank_mask:0x3
  buffer_load_dwordx4 v60, s[32:35], 0 offen lds
  s_nop 0
  v_add_u32_dpp v59, v29, v2 row_newbcast:10 row_mask:0xf bank_mask:0xc
  s_add_u32 m0, s76, 92160
  v_add_u32_dpp v60, v35, v2 row_newbcast:3 row_mask:0xf bank_mask:0x3
  buffer_load_dwordx4 v61, s[32:35], 0 offen lds
  s_nop 0
  v_add_u32_dpp v60, v33, v2 row_newbcast:10 row_mask:0xf bank_mask:0xc
  s_add_u32 m0, s76, 94208
  v_add_u32_dpp v61, v39, v2 row_newbcast:3 row_mask:0xf bank_mask:0x3
  buffer_load_dwordx4 v62, s[32:35], 0 offen lds
  s_nop 0
  v_add_u32_dpp v61, v37, v2 row_newbcast:10 row_mask:0xf bank_mask:0xc
  s_add_u32 m0, s76, 96256
  v_add_u32_dpp v62, v43, v2 row_newbcast:3 row_mask:0xf bank_mask:0x3
  buffer_load_dwordx4 v63, s[32:35], 0 offen lds
  s_nop 0
  v_add_u32_dpp v62, v41, v2 row_newbcast:10 row_mask:0xf bank_mask:0xc
  s_add_u32 m0, s76, 98304
  v_add_u32_dpp v63, v47, v2 row_newbcast:3 row_mask:0xf bank_mask:0x3
  buffer_load_dwordx4 v64, s[32:35], 0 offen lds
  s_nop 0
  v_add_u32_dpp v63, v45, v2 row_newbcast:10 row_mask:0xf bank_mask:0xc
  s_add_u32 m0, s76, 100352
  v_add_u32_dpp v64, v51, v2 row_newbcast:3 row_mask:0xf bank_mask:0x3
  buffer_load_dwordx4 v65, s[32:35], 0 offen lds
  s_nop 0
  v_add_u32_dpp v64, v49, v2 row_newbcast:10 row_mask:0xf bank_mask:0xc
  v_add_u32_dpp v65, v55, v2 row_newbcast:3 row_mask:0xf bank_mask:0x3
  s_nop 1
  v_add_u32_dpp v65, v53, v2 row_newbcast:10 row_mask:0xf bank_mask:0xc
  v_mov_b32_dpp v17, v17 row_shl:3 row_mask:0xf bank_mask:0xf
  v_mov_b32_dpp v19, v19 row_shl:3 row_mask:0xf bank_mask:0xf
  v_mov_b32_dpp v21, v21 row_shl:3 row_mask:0xf bank_mask:0xf
  v_mov_b32_dpp v23, v23 row_shl:3 row_mask:0xf bank_mask:0xf
  v_mov_b32_dpp v25, v25 row_shl:3 row_mask:0xf bank_mask:0xf
  v_mov_b32_dpp v27, v27 row_shl:3 row_mask:0xf bank_mask:0xf
  v_mov_b32_dpp v29, v29 row_shl:3 row_mask:0xf bank_mask:0xf
  v_mov_b32_dpp v31, v31 row_shl:3 row_mask:0xf bank_mask:0xf
  v_mov_b32_dpp v33, v33 row_shl:3 row_mask:0xf bank_mask:0xf
  v_mov_b32_dpp v35, v35 row_shl:3 row_mask:0xf bank_mask:0xf
  v_mov_b32_dpp v37, v37 row_shl:3 row_mask:0xf bank_mask:0xf
  v_mov_b32_dpp v39, v39 row_shl:3 row_mask:0xf bank_mask:0xf
  v_mov_b32_dpp v41, v41 row_shl:3 row_mask:0xf bank_mask:0xf
  v_mov_b32_dpp v43, v43 row_shl:3 row_mask:0xf bank_mask:0xf
  v_mov_b32_dpp v45, v45 row_shl:3 row_mask:0xf bank_mask:0xf
  v_mov_b32_dpp v47, v47 row_shl:3 row_mask:0xf bank_mask:0xf
  v_mov_b32_dpp v49, v49 row_shl:3 row_mask:0xf bank_mask:0xf
  v_mov_b32_dpp v51, v51 row_shl:3 row_mask:0xf bank_mask:0xf
  v_mov_b32_dpp v53, v53 row_shl:3 row_mask:0xf bank_mask:0xf
  v_mov_b32_dpp v55, v55 row_shl:3 row_mask:0xf bank_mask:0xf
  s_add_u32 s72, s72, 1
  s_cmp_lt_u32 s72, 2
  s_waitcnt vmcnt(10)
  s_cbranch_scc1 L_dnn_loop1
  s_branch L_ld_tail
L_cin:
  v_lshlrev_b32 v1, 4, v0
  s_and_b32 s79, s3, 3
  s_lshr_b32 s84, s3, 2
  s_lshl_b32 s95, s79, 10
  s_mul_i32 s26, s68, 11
  s_add_u32 s26, s26, s69
  s_sub_u32 s26, s26, 22
  s_cmp_eq_u32 s26, 86
  s_cbranch_scc1 L_spare
  s_cmp_eq_u32 s84, 0
  s_cbranch_scc1 L_sc
  s_setprio 2
  v_add_u32 v2, L_tables-L_pc+4096, v1
  v_mov_b32 v3, s93
  v_add_co_u32 v2, vcc, s92, v2
  s_nop 1
  v_addc_co_u32 v3, vcc, 0, v3, vcc
  v_add_co_u32 v32, vcc, s95, v2
  s_nop 1
  v_addc_co_u32 v33, vcc, 0, v3, vcc
  global_load_dwordx4 v[224:227], v[2:3], off offset:-4096
  v_add_co_u32 v2, vcc, 0x1800, v2
  s_nop 1
  v_addc_co_u32 v3, vcc, 0, v3, vcc
  global_load_dwordx4 v[240:243], v[2:3], off
  s_cmp_lt_u32 s79, 3
  s_mov_b32 s70, 122176
  s_cselect_b32 s70, 81920, s70
  s_add_u32 m0, s95, 81920
  s_nop 0
  global_load_lds_dwordx4 v[32:33], off offset:-4096
  s_add_u32 m0, s95, s70
  s_nop 0
  global_load_lds_dwordx4 v[32:33], off offset:0
  v_add_co_u32 v32, vcc, 0x2000, v32
  s_nop 1
  v_addc_co_u32 v33, vcc, 0, v33, vcc
  s_add_u32 m0, s95, 2048
  s_nop 0
  global_load_lds_dwordx4 v[32:33], off offset:0
  s_add_u32 m0, s95, 130368
  s_cmp_ge_u32 s79, 2
  s_cbranch_scc1 L_sc
  global_load_lds_dwordx4 v[32:33], off offset:-4096
L_sc:
  s_mul_i32 s85, s84, 20
  s_add_u32 s85, s85, s3
  s_mul_i32 s94, s26, 48
  s_add_u32 s94, s94, s85
  s_mul_i32 s94, s94, 104
  v_lshrrev_b32 v30, 3, v0
  v_lshlrev_b32 v30, 4, v30
  v_and_b32 v29, 0x70, v1
  s_mul_i32 s76, s3, 4064
  s_add_u32 s76, s76, 131136
  s_cmp_eq_u32 s84, 0
  s_cbranch_scc1 L_g0
  s_sub_u32 s68, s71, 22
  s_min_u32 s68, s68, 9
  s_lshl_b32 s68, s68, 2
  s_add_u32 s68, s68, s79
  s_lshl_b32 s68, s68, 7
  v_mul_u32_u24 v31, 5120, v0
  s_waitcnt lgkmcnt(0)
  s_mov_b32 s36, s8
  s_and_b32 s37, s9, 0xffff
  s_mov_b32 s38, 105456
  s_mov_b32 s39, 0x20000
  buffer_load_dword v107, v31, s[36:39], s68 offen
  s_waitcnt lgkmcnt(0)
  s_mov_b32 s40, s10
  s_and_b32 s41, s11, 0xffff
  s_mov_b32 s42, 156
  s_mov_b32 s43, 0x20000
  s_mov_b32 m0, 129472
  s_mov_b64 exec, 0x7ff
  buffer_load_dwordx4 v1, s[40:43], 0 offen lds
  s_mov_b64 exec, -1
  s_barrier
  s_lshl_b32 s85, s85, 2
  s_add_u32 s85, s85, 129728
  s_mul_i32 s72, s84, 3
  s_sub_u32 s72, 4, s72
  s_cmp_eq_u32 s26, 85
  s_cselect_b32 s72, s72, 6
  s_lshl_b32 s52, s3, 7
  s_mul_i32 s53, s3, 5280
  s_lshl_b32 s54, s3, 2
  s_lshl_b32 s55, s3, 1
  s_lshl_b32 s82, s3, 12
  s_and_b32 s98, s3, 1
  s_lshr_b32 s99, s3, 1
  s_mul_i32 s68, s99, 3072
  s_lshl_b32 s83, s98, 3
  s_add_u32 s68, s68, s83
  v_add_u32 v59, s68, v1
  s_lshl_b32 s69, s99, 3
  s_lshr_b32 s69, 0x05030200, s69
  s_and_b32 s69, s69, 0xff
  s_lshl_b32 s69, s69, 9
  s_lshl_b32 s70, s98, 2
  s_add_u32 s91, s69, s70
  s_mov_b32 s99, 0x05040100
  s_mov_b32 s100, 0x07060302
  v_mov_b32 v2, 129664
  v_mov_b32 v109, 0
  v_mov_b32 v108, 0
  v_mov_b64 v[32:33], 0
  v_mov_b64 v[34:35], 0
  v_mov_b64 v[36:37], 0
  v_mov_b64 v[38:39], 0
  v_mov_b64 v[40:41], 0
  v_mov_b64 v[42:43], 0
  v_mov_b64 v[44:45], 0
  v_mov_b64 v[46:47], 0
  v_mov_b64 v[48:49], 0
  v_mov_b64 v[50:51], 0
  v_mov_b64 v[52:53], 0
  v_mov_b64 v[54:55], 0
  v_mov_b64 v[56:57], 0
  v_add_u32 v250, 77824, v1
  s_waitcnt vmcnt(7)
  v_add_u32 v251, 125248, v1
  v_lshrrev_b32 v3, 5, v0
  v_lshl_add_u32 v3, v3, 2, v2
  s_mov_b32 s28, s4
  s_and_b32 s29, s5, 0xffff
  s_mov_b32 s30, 425984
  s_mov_b32 s31, 0x20000
  s_mov_b32 s32, s6
  s_and_b32 s33, s7, 0xffff
  s_mov_b32 s34, 12800000
  s_mov_b32 s35, 0x20000
  v_and_b32 v13, 31, v0
  v_min_u32 v13, 25, v13
  v_lshrrev_b32 v14, 5, v0
  v_mul_u32_u24 v14, 416, v14
  v_lshl_add_u32 v13, v13, 2, v14
  buffer_load_dword v14, v13, s[28:31], s94 offen
  v_min_u32 v12, 47, v0
  v_mul_u32_u24 v15, 16384, v12
  v_lshrrev_b32 v15, 16, v15
  v_mul_u32_u24 v15, 88, v15
  v_lshl_add_u32 v12, v12, 2, v15
  s_lshl_b32 s68, s26, 2
  s_add_u32 s68, s68, s79
  s_mul_i32 s68, s68, 1248
  buffer_load_dword v15, v12, s[28:31], s68 offen offset:16
  ds_write_b128 v2, v[32:35] offset:16
  s_lshl_b32 s68, s79, 6
  v_add_u32_e64 v29, s68, v0
  v_mul_u32_u24 v30, 2521, v29
  v_lshrrev_b32 v30, 16, v30
  v_mul_u32_u24 v30, 12, v30
  v_lshl_add_u32 v28, v29, 1, v30
  v_add_u32 v29, 256, v29
  v_mul_u32_u24 v30, 2521, v29
  v_lshrrev_b32 v30, 16, v30
  v_mul_u32_u24 v30, 12, v30
  v_lshl_add_u32 v58, v29, 1, v30
  v_add_u32 v29, 256, v29
  v_mul_u32_u24 v30, 2521, v29
  v_lshrrev_b32 v30, 16, v30
  v_mul_u32_u24 v30, 12, v30
  v_lshl_add_u32 v111, v29, 1, v30
  v_cmp_gt_u32 vcc, 676, v29
  s_nop 0
  s_mov_b64 s[92:93], vcc
  v_lshlrev_b32 v29, 3, v0
  s_mov_b32 exec_hi, 0xffff
  ds_write_b64 v29, v[32:33] offset:1664
  s_mov_b32 exec_hi, -1
  s_waitcnt vmcnt(7)
  ds_write_b32 v243, v32
  ds_write_b32 v243, v32 offset:43328
  s_waitcnt vmcnt(2)
  ds_read_b64 v[112:113], v240 offset:0
  ds_read_b64 v[114:115], v240 offset:8
  ds_read_b64 v[116:117], v240 offset:32
  ds_read_b64 v[118:119], v240 offset:40
  ds_read_u16 v110, v241
  s_mov_b64 exec, 0x3ffffff
  s_waitcnt lgkmcnt(0)
  ds_write_b16 v242, v110
  v_lshlrev_b32 v109, 17, v110
  v_lshrrev_b32 v109, 1, v109
  s_mov_b64 exec, -1
  v_add_u32 v225, s52, v225
  v_add_u32 v226, s52, v226
  v_add_u32_e64 v227, s52, v227
  s_waitcnt lgkmcnt(0)
  s_barrier
  ds_read_b64_tr_b16 v[60:61], v225 offset:35328
  ds_read_b64_tr_b16 v[62:63], v225 offset:40736
  ds_read_b64_tr_b16 v[64:65], v226 offset:35328
  ds_read_b64_tr_b16 v[66:67], v227 offset:35328
  ds_read_b64_tr_b16 v[68:69], v225 offset:35392
  ds_read_b64_tr_b16 v[70:71], v225 offset:40800
  ds_read_b64_tr_b16 v[72:73], v226 offset:35392
  ds_read_b64_tr_b16 v[74:75], v227 offset:35392
  ds_read_b64_tr_b16 v[76:77], v225 offset:35840
  ds_read_b64_tr_b16 v[78:79], v225 offset:41248
  ds_read_b64_tr_b16 v[80:81], v226 offset:35840
  ds_read_b64_tr_b16 v[82:83], v227 offset:35840
  ds_read_b64_tr_b16 v[84:85], v225 offset:35904
  ds_read_b64_tr_b16 v[86:87], v225 offset:41312
  ds_read_b64_tr_b16 v[88:89], v226 offset:35904
  ds_read_b64_tr_b16 v[90:91], v227 offset:35904
  s_waitcnt lgkmcnt(14)
  v_mfma_f32_32x32x16_bf16 v[120:135], v[112:115], v[60:63], 0
  s_waitcnt lgkmcnt(12)
  v_mfma_f32_32x32x16_bf16 v[120:135], v[116:119], v[64:67], v[120:135]
  ds_read_b64_tr_b16 v[92:93], v225 offset:36352
  ds_read_b64_tr_b16 v[94:95], v225 offset:41760
  ds_read_b64_tr_b16 v[96:97], v226 offset:36352
  ds_read_b64_tr_b16 v[98:99], v227 offset:36352
  s_waitcnt lgkmcnt(14)
  v_mfma_f32_32x32x16_bf16 v[136:151], v[112:115], v[68:71], 0
  s_waitcnt lgkmcnt(12)
  v_mfma_f32_32x32x16_bf16 v[136:151], v[116:119], v[72:75], v[136:151]
  ds_read_b64_tr_b16 v[100:101], v225 offset:36416
  ds_read_b64_tr_b16 v[102:103], v225 offset:41824
  ds_read_b64_tr_b16 v[104:105], v226 offset:36416
  ds_read_b64_tr_b16 v[106:107], v227 offset:36416
  s_waitcnt lgkmcnt(14)
  v_mfma_f32_32x32x16_bf16 v[152:167], v[112:115], v[76:79], 0
  s_waitcnt lgkmcnt(12)
  v_mfma_f32_32x32x16_bf16 v[152:167], v[116:119], v[80:83], v[152:167]
  s_waitcnt lgkmcnt(10)
  v_mfma_f32_32x32x16_bf16 v[168:183], v[112:115], v[84:87], 0
  s_waitcnt lgkmcnt(8)
  v_mfma_f32_32x32x16_bf16 v[168:183], v[116:119], v[88:91], v[168:183]
  ds_read_b128 v[228:231], v250 offset:6144
  ds_read_b128 v[232:235], v251 offset:0
  ds_read_b128 v[4:7], v250 offset:3072
  ds_read_b128 v[8:11], v251 offset:2048
  ds_read_b128 v[20:23], v250 offset:1024
  ds_read_b128 v[24:27], v250 offset:2048
  ds_read_b128 v[216:219], v250 offset:4096
  ds_read_b128 v[220:223], v250 offset:5120
  ds_read_b128 v[236:239], v251 offset:1024
  s_waitcnt lgkmcnt(14)
  v_mfma_f32_32x32x16_bf16 v[184:199], v[112:115], v[92:95], 0
  s_waitcnt lgkmcnt(13)
  v_mfma_f32_32x32x16_bf16 v[184:199], v[116:119], v[96:99], v[184:199]
  s_waitcnt lgkmcnt(11)
  v_mfma_f32_32x32x16_bf16 v[200:215], v[112:115], v[100:103], 0
  s_waitcnt lgkmcnt(9)
  v_mfma_f32_32x32x16_bf16 v[200:215], v[116:119], v[104:107], v[200:215]
  s_waitcnt lgkmcnt(8)
  v_add_u32 v228, s54, v228
  v_add_u32 v229, s54, v229
  v_add_u32 v231, s83, v231
  v_add_u32 v230, s91, v230
  s_waitcnt lgkmcnt(7)
  v_mad_u32_u24 v232, v233, s3, v232
  v_add_u32 v234, s55, v234
  v_mad_u32_u24 v233, v233, 8, v232
  v_add_u32 v246, s82, v235
  v_add_u32 v247, 2048, v246
  v_add_u32 v31, 0, v234
  v_and_b32 v31, 3, v31
  v_lshl_add_u32 v244, v31, 4, v232
  v_add_u32 v31, 1, v234
  v_and_b32 v31, 3, v31
  v_lshl_add_u32 v245, v31, 4, v232
  v_add_u32 v245, 1664, v245
  v_add_u32 v31, 0, v234
  v_and_b32 v31, 3, v31
  v_lshl_add_u32 v248, v31, 4, v233
  v_add_u32 v31, 1, v234
  v_and_b32 v31, 3, v31
  v_lshl_add_u32 v249, v31, 4, v233
  v_add_u32 v249, 1664, v249
  s_waitcnt lgkmcnt(5)
  v_add_u32 v10, s76, v10
  v_add_u32 v4, s76, v4
  v_add_u32 v5, s76, v5
  ds_write_b32 v10, v7 offset:2880
  v_add_u32 v11, s53, v11
  s_waitcnt lgkmcnt(5)
  v_add_u32 v20, s53, v20
  v_add_u32 v21, s53, v21
  v_add_u32 v22, s53, v22
  v_add_u32 v23, s53, v23
  s_waitcnt lgkmcnt(4)
  v_add_u32 v24, s53, v24
  v_add_u32 v25, s53, v25
  v_add_u32 v26, s53, v26
  v_add_u32 v27, s53, v27
  s_mov_b32 exec_lo, 0
  v_mov_b32 v120, v136
  s_mov_b32 exec_lo, -1
  v_cvt_pk_bf16_f32 v60, 0, v120
  ds_write_b16_d16_hi v28, v60
  v_max_f32 v108, |v60|, v108
  s_mov_b32 exec_lo, 0
  v_mov_b32 v152, v168
  s_mov_b32 exec_lo, -1
  v_cvt_pk_bf16_f32 v61, 0, v152
  ds_write_b16_d16_hi v58, v61
  v_max_f32 v108, |v61|, v108
  s_mov_b32 exec_lo, 0
  v_mov_b32_e64 v184, v200
  s_mov_b32 exec_lo, -1
  v_cvt_pk_bf16_f32 v62, 0, v184
  s_mov_b64 exec, s[92:93]
  ds_write_b16_d16_hi v111, v62
  v_max_f32 v108, |v62|, v108
  s_mov_b64 exec, -1
  s_nop 0
  v_permlane32_swap_b32 v108, v109
  v_max_u32_e64 v108, v108, v109
  s_nop 1
  v_max_u32_dpp v108, v108, v108 row_shr:1 row_mask:0xf bank_mask:0xf
  s_nop 1
  v_max_u32_dpp v108, v108, v108 row_shr:2 row_mask:0xf bank_mask:0xf
  s_nop 1
  v_max_u32_dpp v108, v108, v108 row_shr:4 row_mask:0xf bank_mask:0xf
  s_nop 1
  v_max_u32_dpp v108, v108, v108 row_shr:8 row_mask:0xf bank_mask:0xf
  s_nop 1
  v_max_u32_dpp v108, v108, v108 row_bcast:15 row_mask:0xa bank_mask:0xf
  s_mov_b32 exec_lo, 0x80000000
  s_mov_b32 exec_hi, 0x80000000
  ds_max_u32 v3, v108 offset:24
  s_mov_b64 exec, -1
  s_setprio 0
  s_waitcnt vmcnt(0)
  v_lshlrev_b32 v15, 7, v15
  buffer_load_dword v12, v15, s[32:35], 0 offen
  v_lshlrev_b32 v14, 7, v14
  buffer_load_dword v13, v14, s[32:35], 0 offen
  s_waitcnt lgkmcnt(0)
  s_barrier
  s_branch L_w2
L_g0:
  s_waitcnt lgkmcnt(0)
  s_mov_b32 s36, s8
  s_and_b32 s37, s9, 0xffff
  s_mov_b32 s38, 105456
  s_mov_b32 s39, 0x20000
  s_barrier
  s_add_u32 m0, s95, 41984
  s_add_u32 s81, s95, 70304
  buffer_load_dwordx4 v1, s[36:39], s81 offen lds
  s_add_u32 m0, s95, 46080
  s_add_u32 s81, s95, 74400
  buffer_load_dwordx4 v1, s[36:39], s81 offen lds
  s_add_u32 m0, s95, 50176
  s_add_u32 s81, s95, 78496
  buffer_load_dwordx4 v1, s[36:39], s81 offen lds
  s_add_u32 m0, s95, 54272
  s_add_u32 s81, s95, 82592
  buffer_load_dwordx4 v1, s[36:39], s81 offen lds
  s_add_u32 m0, s95, 58368
  s_add_u32 s81, s95, 86688
  buffer_load_dwordx4 v1, s[36:39], s81 offen lds
  s_add_u32 m0, s95, 62464
  s_add_u32 s81, s95, 90784
  buffer_load_dwordx4 v1, s[36:39], s81 offen lds
  s_add_u32 m0, s95, 66560
  s_add_u32 s81, s95, 94880
  buffer_load_dwordx4 v1, s[36:39], s81 offen lds
  s_add_u32 m0, s95, 70656
  s_add_u32 s81, s95, 98976
  buffer_load_dwordx4 v1, s[36:39], s81 offen lds
  s_cmp_eq_u32 s79, 3
  s_cbranch_scc1 L_st3
  s_add_u32 m0, s95, 74752
  s_add_u32 s81, s95, 103072
  buffer_load_dwordx4 v1, s[36:39], s81 offen lds
L_st3:
  s_mov_b32 s28, s4
  s_and_b32 s29, s5, 0xffff
  s_mov_b32 s30, 425984
  s_mov_b32 s31, 0x20000
  buffer_load_dwordx4 v[16:19], v30, s[28:31], s94 offen
  s_add_u32 s94, s94, 416
  buffer_load_dwordx4 v[12:15], v30, s[28:31], s94 offen
  s_add_u32 s94, s94, 416
  s_mov_b32 s32, s6
  s_and_b32 s33, s7, 0xffff
  s_mov_b32 s34, 12800000
  s_mov_b32 s35, 0x20000
  s_mul_i32 s96, s79, 3072
  s_mul_i32 s97, s79, 2704
  v_lshrrev_b32 v31, 5, v0
  v_mul_u32_u24 v31, 184, v31
  v_sub_u32 v31, v1, v31
  s_add_u32 m0, s96, 85312
  s_add_u32 s81, s97, 35152
  buffer_load_dwordx4 v1, s[36:39], s81 offen lds
  s_lshl_b32 s85, s85, 2
  s_add_u32 s85, s85, 129728
  s_mul_i32 s72, s84, 3
  s_sub_u32 s72, 4, s72
  s_cmp_eq_u32 s26, 85
  s_cselect_b32 s72, s72, 6
  s_add_u32 m0, s96, 86336
  s_add_u32 s81, s97, 36176
  buffer_load_dwordx4 v31, s[36:39], s81 offen lds
  s_lshl_b32 s52, s3, 7
  s_mul_i32 s53, s3, 5280
  s_lshl_b32 s54, s3, 2
  s_lshl_b32 s55, s3, 1
  s_lshl_b32 s82, s3, 12
  s_add_u32 m0, s96, 87360
  s_add_u32 s81, s97, 37016
  buffer_load_dwordx4 v1, s[36:39], s81 offen lds
  s_and_b32 s98, s3, 1
  s_lshr_b32 s99, s3, 1
  s_mul_i32 s68, s99, 3072
  s_lshl_b32 s83, s98, 3
  s_add_u32 s68, s68, s83
  s_add_u32 m0, s96, 97600
  s_add_u32 s81, s97, 45968
  buffer_load_dwordx4 v1, s[36:39], s81 offen lds
  v_add_u32 v59, s68, v1
  s_lshl_b32 s69, s99, 3
  s_lshr_b32 s69, 0x05030200, s69
  s_and_b32 s69, s69, 0xff
  s_lshl_b32 s69, s69, 9
  s_add_u32 m0, s96, 98624
  s_add_u32 s81, s97, 46992
  buffer_load_dwordx4 v31, s[36:39], s81 offen lds
  s_lshl_b32 s70, s98, 2
  s_add_u32 s91, s69, s70
  s_mov_b32 s99, 0x05040100
  s_mov_b32 s100, 0x07060302
  v_mov_b32 v2, 129664
  s_add_u32 m0, s96, 99648
  s_add_u32 s81, s97, 47832
  buffer_load_dwordx4 v1, s[36:39], s81 offen lds
  v_mov_b32 v109, 0
  v_mov_b32 v108, 0
  v_mov_b64 v[32:33], 0
  v_mov_b64 v[34:35], 0
  v_mov_b64 v[36:37], 0
  s_add_u32 m0, s96, 109888
  s_add_u32 s81, s97, 56784
  buffer_load_dwordx4 v1, s[36:39], s81 offen lds
  v_mov_b64 v[38:39], 0
  v_mov_b64 v[40:41], 0
  v_mov_b64 v[42:43], 0
  v_mov_b64 v[44:45], 0
  v_mov_b64 v[46:47], 0
  s_add_u32 m0, s96, 110912
  s_add_u32 s81, s97, 57808
  buffer_load_dwordx4 v31, s[36:39], s81 offen lds
  v_mov_b64 v[48:49], 0
  v_mov_b64 v[50:51], 0
  v_mov_b64 v[52:53], 0
  v_mov_b64 v[54:55], 0
  v_mov_b64 v[56:57], 0
  s_add_u32 m0, s96, 111936
  s_add_u32 s81, s97, 58648
  buffer_load_dwordx4 v1, s[36:39], s81 offen lds
  v_add_u32 v250, 77824, v1
  s_waitcnt vmcnt(19)
  v_add_u32 v251, 125248, v1
  v_lshrrev_b32_e64 v3, 5, v0
  v_lshl_add_u32 v3, v3, 2, v2
  s_cmp_lg_u32 s79, 0
  s_cbranch_scc1 L_st2
  s_add_u32 m0, s96, 122176
  s_add_u32 s81, s97, 67600
  buffer_load_dwordx4 v1, s[36:39], s81 offen lds
  s_add_u32 m0, s96, 123200
  s_add_u32 s81, s97, 68624
  buffer_load_dwordx4 v31, s[36:39], s81 offen lds
  s_add_u32 m0, s96, 124224
  s_add_u32 s81, s97, 69464
  buffer_load_dwordx4 v1, s[36:39], s81 offen lds
L_st2:
  s_add_u32 m0, s95, 6144
  s_add_u32 s81, s95, 0
  buffer_load_dwordx4 v1, s[36:39], s81 offen lds
  s_add_u32 m0, s95, 10240
  s_add_u32 s81, s95, 4096
  buffer_load_dwordx4 v1, s[36:39], s81 offen lds
  s_add_u32 m0, s95, 14336
  s_add_u32 s81, s95, 8192
  buffer_load_dwordx4 v1, s[36:39], s81 offen lds
  s_add_u32 m0, s95, 18432
  s_add_u32 s81, s95, 12288
  buffer_load_dwordx4 v1, s[36:39], s81 offen lds
  s_waitcnt vmcnt(15)
  s_barrier
  ds_read_b128 v[224:227], v250 offset:0
  ds_read_b128 v[228:231], v250 offset:6144
  ds_read_b128 v[232:235], v251 offset:0
  ds_read_b128 v[4:7], v250 offset:3072
  ds_read_b128 v[8:11], v251 offset:2048
  ds_read_b128 v[20:23], v250 offset:1024
  ds_read_b128 v[24:27], v250 offset:2048
  ds_read_b128 v[216:219], v250 offset:4096
  ds_read_b128 v[220:223], v250 offset:5120
  ds_read_b128 v[236:239], v251 offset:1024
  s_add_u32 m0, s95, 22528
  s_add_u32 s81, s95, 16384
  buffer_load_dwordx4 v1, s[36:39], s81 offen lds
  s_add_u32 m0, s95, 26624
  s_add_u32 s81, s95, 20480
  buffer_load_dwordx4 v1, s[36:39], s81 offen lds
  s_add_u32 m0, s95, 30720
  s_add_u32 s81, s95, 24576
  buffer_load_dwordx4 v1, s[36:39], s81 offen lds
  s_add_u32 m0, s95, 34816
  s_add_u32 s81, s95, 28672
  buffer_load_dwordx4 v1, s[36:39], s81 offen lds
  s_cmp_eq_u32 s79, 3
  s_cbranch_scc1 L_st1
  s_add_u32 m0, s95, 38912
  s_add_u32 s81, s95, 32768
  buffer_load_dwordx4 v1, s[36:39], s81 offen lds
L_st1:
  s_waitcnt lgkmcnt(9)
  v_add_u32 v225, s52, v225
  v_add_u32 v226, s52, v226
  v_add_u32 v227, s52, v227
  s_waitcnt lgkmcnt(8)
  v_add_u32 v228, s54, v228
  v_add_u32 v229, s54, v229
  v_add_u32 v231, s83, v231
  v_add_u32 v230, s91, v230
  s_waitcnt lgkmcnt(7)
  v_mad_u32_u24 v232, v233, s3, v232
  v_add_u32 v234, s55, v234
  v_mad_u32_u24 v233, v233, 8, v232
  v_add_u32 v246, s82, v235
  v_add_u32 v247, 2048, v246
  v_add_u32 v31, 0, v234
  v_and_b32_e64 v31, 3, v31
  v_lshl_add_u32 v244, v31, 4, v232
  v_add_u32 v31, 1, v234
  v_and_b32 v31, 3, v31
  v_lshl_add_u32 v245, v31, 4, v232
  v_add_u32 v245, 1664, v245
  v_add_u32 v31, 0, v234
  v_and_b32 v31, 3, v31
  v_lshl_add_u32 v248, v31, 4, v233
  v_add_u32 v31, 1, v234
  v_and_b32 v31, 3, v31
  v_lshl_add_u32 v249, v31, 4, v233
  v_add_u32 v249, 1664, v249
  s_waitcnt lgkmcnt(5)
  v_add_u32 v10, s76, v10
  v_add_u32 v4, s76, v4
  v_add_u32 v5, s76, v5
  ds_write_b32 v10, v7 offset:2880
  v_add_u32 v11, s53, v11
  s_waitcnt lgkmcnt(5)
  v_add_u32 v20, s53, v20
  v_add_u32 v21, s53, v21
  v_add_u32 v22, s53, v22
  v_add_u32 v23, s53, v23
  s_waitcnt lgkmcnt(4)
  v_add_u32 v24, s53, v24
  v_add_u32 v25, s53, v25
  v_add_u32 v26, s53, v26
  v_add_u32_e64 v27, s53, v27
  s_waitcnt vmcnt(18)
  v_lshl_add_u32 v16, v16, 7, v29
  v_lshl_add_u32 v17, v17, 7, v29
  v_lshl_add_u32 v18, v18, 7, v29
  v_lshl_add_u32 v19, v19, 7, v29
  s_add_u32 m0, s76, 0
  s_mov_b32 exec_hi, 0xffffff
  buffer_load_dwordx4 v16, s[32:35], 0 offen lds
  s_add_u32 m0, s76, 1056
  s_nop 0
  buffer_load_dwordx4 v17, s[32:35], 0 offen lds
  s_add_u32 m0, s76, 2112
  s_mov_b32 exec_hi, 0xffff
  buffer_load_dwordx4 v18, s[32:35], 0 offen lds
  s_add_u32 m0, s76, 3168
  s_nop 0
  buffer_load_dwordx4 v19, s[32:35], 0 offen lds
  s_mov_b32 exec_hi, -1
  s_waitcnt vmcnt(4)
  s_barrier
L_w2:
  ds_read2st64_b32 v[60:61], v228 offset0:0 offset1:6
  ds_read2st64_b32 v[62:63], v228 offset0:12 offset1:18
  ds_read2st64_b32 v[64:65], v228 offset0:24 offset1:30
  ds_read2st64_b32 v[66:67], v228 offset0:36 offset1:42
  ds_read2st64_b32 v[68:69], v228 offset0:96 offset1:102
  ds_read2st64_b32 v[70:71], v229 offset0:108 offset1:114
  ds_read2st64_b32 v[72:73], v229 offset0:120 offset1:126
  ds_read2st64_b32 v[74:75], v229 offset0:132 offset1:138
  s_cmp_ge_u32 s3, 5
  s_cbranch_scc1 L_u0
  v_add_u32 v228, 32, v228
  v_add_u32_e64 v229, 32, v229
  ds_read2st64_b32 v[92:93], v228 offset0:0 offset1:6
  ds_read2st64_b32 v[94:95], v228 offset0:12 offset1:18
  ds_read2st64_b32 v[96:97], v228 offset0:24 offset1:30
  ds_read2st64_b32 v[98:99], v228 offset0:36 offset1:42
  ds_read2st64_b32 v[100:101], v228 offset0:96 offset1:102
  ds_read2st64_b32 v[102:103], v229 offset0:108 offset1:114
  ds_read2st64_b32 v[104:105], v229 offset0:120 offset1:126
  ds_read2st64_b32 v[106:107], v229 offset0:132 offset1:138
  ds_read_b64_tr_b16 v[76:77], v225 offset:0
  ds_read_b64_tr_b16 v[78:79], v225 offset:5408
  ds_read_b64_tr_b16 v[80:81], v226 offset:0
  ds_read_b64_tr_b16 v[82:83], v227 offset:0
  ds_read_b64_tr_b16 v[84:85], v225 offset:64
  ds_read_b64_tr_b16 v[86:87], v225 offset:5472
  ds_read_b64_tr_b16 v[88:89], v226 offset:64
  ds_read_b64_tr_b16 v[90:91], v227 offset:64
  ds_read_b64_tr_b16 v[112:113], v224 offset:0
  ds_read_b64_tr_b16 v[114:115], v224 offset:256
  ds_read_b64_tr_b16 v[116:117], v224 offset:1024
  ds_read_b64_tr_b16 v[118:119], v224 offset:1280
  s_waitcnt lgkmcnt(14)
  v_mfma_f32_16x16x32_bf16 v[108:111], v[60:63], v[60:63], 0
  v_mfma_f32_16x16x32_bf16 v[108:111], v[64:67], v[64:67], v[108:111]
  v_mfma_f32_16x16x32_bf16 v[108:111], v[68:71], v[68:71], v[108:111]
  v_mfma_f32_16x16x32_bf16 v[108:111], v[72:75], v[72:75], v[108:111]
  v_perm_b32 v184, v61, v60, s99
  v_perm_b32 v185, v63, v62, s99
  v_perm_b32 v186, v65, v64, s99
  v_perm_b32 v187, v67, v66, s99
  v_perm_b32 v188, v69, v68, s99
  v_perm_b32 v189, v71, v70, s99
  v_perm_b32 v190, v73, v72, s99
  v_perm_b32 v191, v75, v74, s99
  v_mfma_f32_16x16x32_bf16 v[108:111], v[92:95], v[92:95], v[108:111]
  v_mfma_f32_16x16x32_bf16 v[108:111], v[96:99], v[96:99], v[108:111]
  v_mfma_f32_16x16x32_bf16 v[108:111], v[100:103], v[100:103], v[108:111]
  s_waitcnt lgkmcnt(12)
  v_mfma_f32_16x16x32_bf16 v[108:111], v[104:107], v[104:107], v[108:111]
  s_waitcnt lgkmcnt(10)
  v_mfma_f32_16x16x32_bf16 v[28:31], v[76:79], v[76:79], 0
  s_waitcnt lgkmcnt(8)
  v_mfma_f32_16x16x32_bf16 v[28:31], v[80:83], v[80:83], v[28:31]
  s_waitcnt lgkmcnt(6)
  v_mfma_f32_16x16x32_bf16 v[28:31], v[84:87], v[84:87], v[28:31]
  s_waitcnt lgkmcnt(4)
  v_mfma_f32_16x16x32_bf16 v[28:31], v[88:91], v[88:91], v[28:31]
  v_perm_b32 v192, v61, v60, s100
  v_perm_b32 v193, v63, v62, s100
  v_perm_b32 v194, v65, v64, s100
  v_perm_b32 v195, v67, v66, s100
  v_perm_b32 v196, v69, v68, s100
  v_perm_b32 v197, v71, v70, s100
  v_perm_b32 v198, v73, v72, s100
  v_perm_b32 v199, v75, v74, s100
  v_max3_f32 v28, v28, v29, 0
  v_perm_b32 v60, v93, v92, s99
  v_perm_b32 v61, v95, v94, s99
  v_max3_f32 v108, v108, v109, 0
  v_perm_b32 v62, v97, v96, s99
  v_max3_f32 v28, v28, v30, v31
  v_perm_b32 v63, v99, v98, s99
  v_max3_f32 v108, v108, v110, v111
  v_perm_b32 v64, v101, v100, s99
  v_perm_b32 v65, v103, v102, s99
  v_permlane32_swap_b32 v28, v108
  v_perm_b32 v66, v105, v104, s99
  v_max_u32_e64 v28, v28, v108
  v_perm_b32 v67, v107, v106, s99
  s_nop 0
  v_max_u32_dpp v28, v28, v28 row_shr:1 row_mask:0xf bank_mask:0xf
  v_perm_b32 v68, v93, v92, s100
  v_perm_b32 v69, v95, v94, s100
  v_max_u32_dpp v28, v28, v28 row_shr:2 row_mask:0xf bank_mask:0xf
  v_perm_b32 v70, v97, v96, s100
  s_nop 0
  v_max_u32_dpp v28, v28, v28 row_shr:4 row_mask:0xf bank_mask:0xf
  v_perm_b32 v71, v99, v98, s100
  s_nop 0
  v_max_u32_dpp v28, v28, v28 row_shr:8 row_mask:0xf bank_mask:0xf
  v_perm_b32 v72, v101, v100, s100
  v_perm_b32 v73, v103, v102, s100
  v_max_u32_dpp v28, v28, v28 row_bcast:15 row_mask:0xa bank_mask:0xf
  v_perm_b32 v74, v105, v104, s100
  s_mov_b32 exec_lo, 0x80000000
  s_mov_b32 exec_hi, 0x80000000
  ds_max_u32 v3, v28 offset:16
  s_mov_b64 exec, -1
  v_perm_b32 v75, v107, v106, s100
  s_branch L_u1
L_u0:
  ds_read_b64_tr_b16 v[76:77], v225 offset:0
  ds_read_b64_tr_b16 v[78:79], v225 offset:5408
  ds_read_b64_tr_b16 v[80:81], v226 offset:0
  ds_read_b64_tr_b16 v[82:83], v227 offset:0
  ds_read_b64_tr_b16 v[84:85], v225 offset:64
  ds_read_b64_tr_b16 v[86:87], v225 offset:5472
  ds_read_b64_tr_b16 v[88:89], v226 offset:64
  ds_read_b64_tr_b16 v[90:91], v227 offset:64
  ds_read_b64_tr_b16 v[92:93], v225 offset:384
  ds_read_b64_tr_b16 v[94:95], v225 offset:5792
  ds_read_b64_tr_b16 v[96:97], v226 offset:384
  ds_read_b64_tr_b16 v[98:99], v227 offset:384
  ds_read_b64_tr_b16 v[100:101], v225 offset:448
  ds_read_b64_tr_b16 v[102:103], v225 offset:5856
  ds_read_b64_tr_b16 v[104:105], v226 offset:448
  ds_read_b64_tr_b16 v[106:107], v227 offset:448
  ds_read_b64_tr_b16 v[112:113], v224 offset:0
  ds_read_b64_tr_b16 v[114:115], v224 offset:256
  ds_read_b64_tr_b16 v[116:117], v224 offset:1024
  ds_read_b64_tr_b16 v[118:119], v224 offset:1280
  s_waitcnt lgkmcnt(14)
  v_mfma_f32_16x16x32_bf16 v[108:111], v[60:63], v[60:63], 0
  v_mfma_f32_16x16x32_bf16 v[108:111], v[64:67], v[64:67], v[108:111]
  v_mfma_f32_16x16x32_bf16 v[108:111], v[68:71], v[68:71], v[108:111]
  v_mfma_f32_16x16x32_bf16 v[108:111], v[72:75], v[72:75], v[108:111]
  v_mfma_f32_16x16x32_bf16 v[28:31], v[76:79], v[76:79], 0
  v_mfma_f32_16x16x32_bf16 v[28:31], v[80:83], v[80:83], v[28:31]
  v_mfma_f32_16x16x32_bf16 v[28:31], v[84:87], v[84:87], v[28:31]
  s_waitcnt lgkmcnt(12)
  v_mfma_f32_16x16x32_bf16 v[28:31], v[88:91], v[88:91], v[28:31]
  s_waitcnt lgkmcnt(10)
  v_mfma_f32_16x16x32_bf16 v[28:31], v[92:95], v[92:95], v[28:31]
  s_waitcnt lgkmcnt(8)
  v_mfma_f32_16x16x32_bf16 v[28:31], v[96:99], v[96:99], v[28:31]
  s_waitcnt lgkmcnt(6)
  v_mfma_f32_16x16x32_bf16 v[28:31], v[100:103], v[100:103], v[28:31]
  s_waitcnt lgkmcnt(4)
  v_mfma_f32_16x16x32_bf16 v[28:31], v[104:107], v[104:107], v[28:31]
  v_perm_b32 v184, v61, v60, s99
  v_perm_b32 v185, v63, v62, s99
  v_perm_b32 v186, v65, v64, s99
  v_perm_b32 v187, v67, v66, s99
  s_nop 3
  v_max3_f32 v28, v28, v29, 0
  v_perm_b32 v188, v69, v68, s99
  v_max3_f32 v108, v108, v109, 0
  v_perm_b32 v189, v71, v70, s99
  v_max3_f32 v28, v28, v30, v31
  v_perm_b32 v190, v73, v72, s99
  v_max3_f32 v108, v108, v110, v111
  v_perm_b32 v191, v75, v74, s99
  s_nop 0
  v_permlane32_swap_b32 v28, v108
  v_perm_b32 v192, v61, v60, s100
  v_max_u32 v28, v28, v108
  v_perm_b32 v193, v63, v62, s100
  s_nop 0
  v_max_u32_dpp v28, v28, v28 row_shr:1 row_mask:0xf bank_mask:0xf
  v_perm_b32 v194, v65, v64, s100
  s_nop 0
  v_max_u32_dpp v28, v28, v28 row_shr:2 row_mask:0xf bank_mask:0xf
  v_perm_b32 v195, v67, v66, s100
  s_nop 0
  v_max_u32_dpp v28, v28, v28 row_shr:4 row_mask:0xf bank_mask:0xf
  v_perm_b32 v196, v69, v68, s100
  s_nop 0
  v_max_u32_dpp v28, v28, v28 row_shr:8 row_mask:0xf bank_mask:0xf
  v_perm_b32 v197, v71, v70, s100
  s_nop 0
  v_max_u32_dpp v28, v28, v28 row_bcast:15 row_mask:0xa bank_mask:0xf
  v_perm_b32 v198, v73, v72, s100
  s_mov_b32 exec_lo, 0x80000000
  s_mov_b32 exec_hi, 0x80000000
  ds_max_u32 v3, v28 offset:16
  s_mov_b64 exec, -1
  v_perm_b32 v199, v75, v74, s100
  v_add_u32 v248, 12288, v246
  v_add_u32 v249, 12288, v247
  s_cmp_lg_u32 s3, 7
  s_cbranch_scc1 L_u1
  s_mov_b32 exec_lo, 0xfffffff0
  s_mov_b32 exec_hi, 0xfffffff0
  v_mov_b32 v249, 1048576
  s_mov_b64 exec, -1
L_u1:
  s_waitcnt lgkmcnt(0)
  s_barrier
  ds_read_b128 v[108:111], v2 offset:16
  s_mul_i32 s68, s3, 384
  v_lshrrev_b32 v29, 2, v0
  v_mul_u32_u24 v29, 24, v29
  v_add_u32 v29, s68, v29
  v_and_b32 v30, 3, v0
  v_lshlrev_b32 v30, 3, v30
  ds_read_b64 v[224:225], v29 offset:2048
  ds_read_b64 v[226:227], v29 offset:2056
  ds_read_b64 v[228:229], v29 offset:2064
  s_waitcnt lgkmcnt(3)
  v_add_u32 v108, 0x3f800000, v108
  v_add_u32 v109, 0x3f800000, v109
  v_lshrrev_b32 v108, 24, v108
  v_lshrrev_b32_e64 v109, 24, v109
  v_sub_u32 v108, 267, v108
  s_mov_b32 vcc_lo, 0x4000000
  v_min_u32 v108, 167, v108
  s_mov_b32 vcc_hi, 0x4000000
  v_readfirstlane_b32 s74, v108
  v_cndmask_b32 v250, v110, v111, vcc
  v_mul_u32_u24 v108, 0x800080, v108
  v_lshrrev_b32 v250, 23, v250
  v_and_b32 v216, v216, v108
  v_and_b32 v217, v217, v108
  v_and_b32 v218, v218, v108
  v_and_b32 v219, v219, v108
  v_and_b32 v220, v220, v108
  v_and_b32 v221, v221, v108
  v_and_b32 v222, v222, v108
  v_and_b32_e64 v223, v223, v108
  v_mfma_f32_32x32x16_bf16 v[152:167], v[216:219], v[76:79], 0
  v_add_u32 v250, v250, v109
  v_sub_u32 v250, 388, v250
  v_mfma_f32_32x32x16_bf16 v[168:183], v[216:219], v[84:87], 0
  s_movk_i32 s98, 167
  v_med3_i32 v250, v250, 1, s98
  v_mfma_f32_32x32x16_bf16 v[152:167], v[220:223], v[80:83], v[152:167]
  v_subrev_u32 v110, 127, v250
  v_lshlrev_b32_e64 v250, 23, v250
  v_mfma_f32_32x32x16_bf16 v[168:183], v[220:223], v[88:91], v[168:183]
  v_cmp_gt_i32 vcc, 0, v110
  v_mul_u32_u24 v110, 0x800080, v110
  s_cbranch_vccnz L_sdown
  v_add_u32 v112, v112, v110
  v_add_u32 v113, v113, v110
  v_add_u32 v114, v114, v110
  v_add_u32 v115, v115, v110
  v_add_u32 v116, v116, v110
  v_add_u32 v117, v117, v110
  v_add_u32 v118, v118, v110
  v_add_u32 v119, v119, v110
L_scaled:
  v_mfma_f32_32x32x16_bf16 v[120:135], v[184:187], v[112:115], 0
  v_cvt_pk_f16_f32 v152, v152, v153
  v_cvt_pk_f16_f32 v153, v154, v155
  v_cvt_pk_f16_f32 v154, v156, v157
  v_cvt_pk_f16_f32 v155, v158, v159
  ds_write_b128 v246, v[152:155]
  v_xor_b32_e64 v246, 16, v246
  v_mfma_f32_32x32x16_bf16 v[120:135], v[188:191], v[116:119], v[120:135]
  v_cvt_pk_f16_f32 v156, v160, v161
  v_cvt_pk_f16_f32 v157, v162, v163
  v_cvt_pk_f16_f32 v158, v164, v165
  v_cvt_pk_f16_f32 v159, v166, v167
  ds_write_b128 v246, v[156:159]
  v_mfma_f32_32x32x16_bf16 v[136:151], v[192:195], v[112:115], 0
  v_cvt_pk_f16_f32 v168, v168, v169
  v_cvt_pk_f16_f32 v169, v170, v171
  v_cvt_pk_f16_f32 v170, v172, v173
  v_cvt_pk_f16_f32 v171, v174, v175
  ds_write_b128 v247, v[168:171]
  v_xor_b32_e64 v247, 16, v247
  v_mfma_f32_32x32x16_bf16 v[136:151], v[196:199], v[116:119], v[136:151]
  v_cvt_pk_f16_f32 v172, v176, v177
  v_cvt_pk_f16_f32 v173, v178, v179
  v_cvt_pk_f16_f32 v174, v180, v181
  v_cvt_pk_f16_f32 v175, v182, v183
  ds_write_b128 v247, v[172:175]
  s_cmp_ge_u32 s3, 5
  s_cbranch_scc1 L_u2
  v_mfma_f32_32x32x16_bf16 v[184:199], v[60:63], v[112:115], 0
  v_cvt_pk_f16_f32 v120, v120, v121
  v_cvt_pk_f16_f32 v121, v122, v123
  v_cvt_pk_f16_f32 v122, v124, v125
  v_mfma_f32_32x32x16_bf16 v[184:199], v[64:67], v[116:119], v[184:199]
  v_cvt_pk_f16_f32 v123, v126, v127
  ds_write_b128 v244, v[120:123]
  v_xor_b32_e64 v244, 16, v244
  v_mfma_f32_32x32x16_bf16 v[200:215], v[68:71], v[112:115], 0
  v_cvt_pk_f16_f32 v124, v128, v129
  v_cvt_pk_f16_f32 v125, v130, v131
  v_cvt_pk_f16_f32 v126, v132, v133
  v_mfma_f32_32x32x16_bf16 v[200:215], v[72:75], v[116:119], v[200:215]
  v_cvt_pk_f16_f32 v127, v134, v135
  ds_write_b128 v244, v[124:127]
  s_branch L_u3
L_u2:
  v_mfma_f32_32x32x16_bf16 v[184:199], v[216:219], v[92:95], 0
  v_cvt_pk_f16_f32 v120, v120, v121
  v_cvt_pk_f16_f32 v121, v122, v123
  v_cvt_pk_f16_f32 v122, v124, v125
  v_mfma_f32_32x32x16_bf16 v[184:199], v[220:223], v[96:99], v[184:199]
  v_cvt_pk_f16_f32 v123, v126, v127
  ds_write_b128 v244, v[120:123]
  v_xor_b32 v244, 16, v244
  v_mfma_f32_32x32x16_bf16 v[200:215], v[216:219], v[100:103], 0
  v_cvt_pk_f16_f32 v124, v128, v129
  v_cvt_pk_f16_f32 v125, v130, v131
  v_cvt_pk_f16_f32 v126, v132, v133
  v_mfma_f32_32x32x16_bf16 v[200:215], v[220:223], v[104:107], v[200:215]
  v_cvt_pk_f16_f32 v127, v134, v135
  ds_write_b128 v244, v[124:127]
L_u3:
  buffer_load_dwordx4 v[16:19], v6, s[28:31], s94 offen
  s_add_u32 s94, s94, 416
  buffer_load_dwordx4 v[112:115], v6, s[28:31], s94 offen
  s_add_u32 s94, s94, 416
  s_cmp_lg_u32 s84, 0
  s_cbranch_scc1 L_hu1
  v_lshl_add_u32 v12, v12, 7, v8
  v_lshl_add_u32 v13, v13, 7, v8
  v_lshl_add_u32 v14, v14, 7, v8
  v_lshl_add_u32 v15, v15, 7, v8
  s_add_u32 m0, s76, 16256
  s_mov_b32 exec_hi, 0xffffff
  buffer_load_dwordx4 v12, s[32:35], 0 offen lds
  s_add_u32 m0, s76, 17312
  s_nop 0
  buffer_load_dwordx4 v13, s[32:35], 0 offen lds
  s_add_u32 m0, s76, 18368
  s_mov_b32 exec_hi, 0xffff
  buffer_load_dwordx4 v14, s[32:35], 0 offen lds
  s_add_u32 m0, s76, 19424
  s_nop 0
  buffer_load_dwordx4 v15, s[32:35], 0 offen lds
  s_mov_b32 exec_hi, -1
  s_branch L_hu2
L_hu1:
L_hu2:
  v_cvt_pk_f16_f32 v136, v136, v137
  s_waitcnt lgkmcnt(8)
  v_xor_b32 v224, v224, v30
  v_cvt_pk_f16_f32 v137, v138, v139
  v_cvt_pk_f16_f32 v138, v140, v141
  v_xor_b32 v232, 32, v224
  v_cvt_pk_f16_f32 v139, v142, v143
  ds_write_b128 v245, v[136:139]
  v_xor_b32 v245, 16, v245
  v_xor_b32 v225, v225, v30
  v_cvt_pk_f16_f32 v140, v144, v145
  v_cvt_pk_f16_f32 v141, v146, v147
  v_cvt_pk_f16_f32 v142, v148, v149
  v_xor_b32 v233, 32, v225
  v_cvt_pk_f16_f32 v143, v150, v151
  ds_write_b128 v245, v[140:143]
  v_cvt_pk_f16_f32 v184, v184, v185
  s_waitcnt lgkmcnt(9)
  v_xor_b32 v226, v226, v30
  v_cvt_pk_f16_f32 v185, v186, v187
  v_cvt_pk_f16_f32 v186, v188, v189
  v_xor_b32_e64 v234, 32, v226
  v_cvt_pk_f16_f32 v187, v190, v191
  ds_write_b128 v248, v[184:187]
  v_xor_b32 v248, 16, v248
  v_xor_b32 v227, v227, v30
  v_cvt_pk_f16_f32 v188, v192, v193
  v_cvt_pk_f16_f32 v189, v194, v195
  v_cvt_pk_f16_f32 v190, v196, v197
  v_xor_b32_e64 v235, 32, v227
  v_cvt_pk_f16_f32 v191, v198, v199
  ds_write_b128 v248, v[188:191]
  v_cvt_pk_f16_f32 v200, v200, v201
  s_waitcnt lgkmcnt(10)
  v_xor_b32 v228, v228, v30
  v_cvt_pk_f16_f32 v201, v202, v203
  v_cvt_pk_f16_f32 v202, v204, v205
  v_xor_b32 v240, 32, v228
  v_cvt_pk_f16_f32 v203, v206, v207
  ds_write_b128 v249, v[200:203]
  v_xor_b32 v249, 16, v249
  v_xor_b32_e64 v229, v229, v30
  v_cvt_pk_f16_f32 v204, v208, v209
  v_cvt_pk_f16_f32 v205, v210, v211
  v_cvt_pk_f16_f32 v206, v212, v213
  v_xor_b32_e64 v241, 32, v229
  v_cvt_pk_f16_f32 v207, v214, v215
  ds_write_b128 v249, v[204:207]
  v_readlane_b32 s0, v250, 0
  v_readlane_b32 s1, v250, 26
  s_sub_u32 s75, 0x7f000000, s0
  s_sub_u32 s1, 0x7f000000, s1
  s_sub_u32 s74, 254, s74
  s_lshl_b32 s74, s74, 23
  s_mov_b32 s92, 0x88888888
  s_mov_b32 s93, 0x88888888
  s_waitcnt lgkmcnt(0)
  s_barrier
  ds_read_b64_tr_b16 v[60:61], v224 offset:0
  ds_read_b64_tr_b16 v[62:63], v225 offset:0
  ds_read_b64_tr_b16 v[64:65], v232 offset:0
  ds_read_b64_tr_b16 v[66:67], v233 offset:0
  ds_read_b64_tr_b16 v[68:69], v224 offset:43328
  ds_read_b64_tr_b16 v[70:71], v225 offset:43328
  ds_read_b64_tr_b16 v[72:73], v232 offset:43328
  ds_read_b64_tr_b16 v[74:75], v233 offset:43328
  ds_read_b64_tr_b16 v[76:77], v226 offset:0
  ds_read_b64_tr_b16 v[78:79], v227 offset:0
  ds_read_b64_tr_b16 v[80:81], v234 offset:0
  ds_read_b64_tr_b16 v[82:83], v235 offset:0
  ds_read_b64_tr_b16 v[84:85], v226 offset:43328
  ds_read_b64_tr_b16 v[86:87], v227 offset:43328
  ds_read_b64_tr_b16 v[88:89], v234 offset:43328
  ds_read_b64_tr_b16 v[90:91], v235 offset:43328
  s_cmp_ge_u32 s3, 6
  s_cbranch_scc1 L_lin
  ds_read_b64_tr_b16 v[92:93], v228 offset:0
  ds_read_b64_tr_b16 v[94:95], v229 offset:0
  ds_read_b64_tr_b16 v[96:97], v240 offset:0
  ds_read_b64_tr_b16 v[98:99], v241 offset:0
  ds_read_b64_tr_b16 v[100:101], v228 offset:43328
  ds_read_b64_tr_b16 v[102:103], v229 offset:43328
  ds_read_b64_tr_b16 v[104:105], v240 offset:43328
  ds_read_b64_tr_b16 v[106:107], v241 offset:43328
  s_waitcnt lgkmcnt(6)
  v_pk_add_f16 v92, v92, v94
  v_pk_add_f16 v93, v93, v95
  ds_write_b64 v59, v[92:93] offset:30720
  s_waitcnt lgkmcnt(5)
  v_pk_add_f16 v96, v96, v98
  v_pk_add_f16 v97, v97, v99
  s_waitcnt lgkmcnt(3)
  v_pk_add_f16 v100, v100, v102
  v_pk_add_f16 v101, v101, v103
  ds_write_b64 v59, v[100:101] offset:32768
  s_waitcnt lgkmcnt(2)
  v_pk_add_f16 v104, v104, v106
  v_pk_add_f16 v105, v105, v107
  v_cndmask_b32 v96, v96, v104, s[92:93]
  v_cndmask_b32 v97, v97, v105, s[92:93]
  ds_write_b64 v59, v[96:97] offset:31744
  ds_write_b32 v230, v104 offset:3072
  ds_write_b32 v230, v105 offset:3088
  s_branch L_p2
L_lin:
  s_and_b32 s98, s3, 1
  s_cselect_b64 vcc, -1, 0
  s_lshl_b32 s99, s98, 5
  v_mov_b32 v31, 0
  v_xor_b32 v236, s99, v236
  v_xor_b32 v237, s99, v237
  v_cndmask_b32 v238, v238, v239, vcc
  ds_read_b64_tr_b16 v[92:93], v236
  ds_read_b64_tr_b16 v[94:95], v237
  ds_read_u16_d16_hi v31, v238
  s_lshl_b32 s98, s98, 10
  v_add_u32 v29, s98, v1
  s_waitcnt lgkmcnt(2)
  v_cvt_f32_f16 v96, v92
  v_cvt_f32_f16_sdwa v97, v92 dst_sel:DWORD dst_unused:UNUSED_PAD src0_sel:WORD_1
  v_mul_f32 v96, s1, v96
  v_mul_f32 v97, s1, v97
  v_mul_f32 v96, s0, v96
  v_mul_f32 v97, s0, v97
  v_cvt_pk_bf16_f32 v92, v96, v97
  v_cvt_f32_f16 v98, v93
  v_cvt_f32_f16_sdwa v99, v93 dst_sel:DWORD dst_unused:UNUSED_PAD src0_sel:WORD_1
  v_mul_f32 v98, s1, v98
  v_mul_f32 v99, s1, v99
  v_mul_f32 v98, s0, v98
  v_mul_f32 v99, s0, v99
  v_cvt_pk_bf16_f32 v93, v98, v99
  s_waitcnt lgkmcnt(1)
  v_cvt_f32_f16 v100, v94
  v_cvt_f32_f16_sdwa v101, v94 dst_sel:DWORD dst_unused:UNUSED_PAD src0_sel:WORD_1
  v_mul_f32 v100, s1, v100
  v_mul_f32 v101, s1, v101
  v_mul_f32 v100, s0, v100
  v_mul_f32 v101, s0, v101
  v_cvt_pk_bf16_f32 v94, v100, v101
  v_cvt_f32_f16_e64 v102, v95
  v_cvt_f32_f16_sdwa v103, v95 dst_sel:DWORD dst_unused:UNUSED_PAD src0_sel:WORD_1
  v_mul_f32 v102, s1, v102
  v_mul_f32 v103, s1, v103
  s_mov_b32 exec_lo, 0
  s_mov_b32 exec_hi, 0xffff
  s_waitcnt lgkmcnt(0)
  v_mov_b32 v102, v31
  s_mov_b64 exec, -1
  v_mul_f32 v102, s0, v102
  v_mul_f32 v103, s0, v103
  v_cvt_pk_bf16_f32 v95, v102, v103
  ds_write_b128 v29, v[92:95] offset:39936
L_p2:
  v_pk_add_f16 v76, v76, v78
  v_pk_add_f16 v77, v77, v79
  ds_write_b64 v59, v[76:77] offset:18432
  v_pk_add_f16 v80, v80, v82
  v_pk_add_f16 v81, v81, v83
  v_pk_add_f16 v84, v84, v86
  v_pk_add_f16 v85, v85, v87
  ds_write_b64 v59, v[84:85] offset:20480
  v_pk_add_f16 v88, v88, v90
  v_pk_add_f16 v89, v89, v91
  v_cndmask_b32 v80, v80, v88, s[92:93]
  v_cndmask_b32 v81, v81, v89, s[92:93]
  ds_write_b64 v59, v[80:81] offset:19456
  ds_write_b32 v230, v88 offset:1024
  ds_write_b32 v230, v89 offset:1040
  v_pk_add_f16 v60, v60, v62
  v_pk_add_f16 v61, v61, v63
  ds_write_b64 v59, v[60:61] offset:6144
  v_pk_add_f16 v64, v64, v66
  v_pk_add_f16 v65, v65, v67
  v_pk_add_f16 v68, v68, v70
  v_pk_add_f16 v69, v69, v71
  ds_write_b64 v59, v[68:69] offset:8192
  v_pk_add_f16 v72, v72, v74
  v_pk_add_f16 v73, v73, v75
  v_cndmask_b32 v64, v64, v72, s[92:93]
  v_cndmask_b32 v65, v65, v73, s[92:93]
  ds_write_b64 v59, v[64:65] offset:7168
  s_cmp_lt_u32 s3, 2
  s_cbranch_scc1 L_p2d
  v_subrev_u32 v230, 1024, v230
  ds_write_b32 v230, v72 offset:0
  ds_write_b32 v230, v73 offset:16
  s_branch L_built
L_p2d:
  ds_write_b64 v231, v[72:73] offset:5120
L_built:
  s_mov_b32 s0, s74
  s_mov_b32 s1, s75
  s_mov_b32 s96, 0x3e000000
  s_mov_b32 s97, 0x43000000
  s_mov_b32 s51, 1
  s_mul_i32 s98, s3, 1536
  s_add_u32 s98, s98, 116736
  s_cmp_lg_u32 s84, 0
  s_cbranch_scc1 L_g1c
  s_sub_u32 s94, s94, 416
  s_waitcnt vmcnt(4)
  ds_read_u16_d16_hi v32, v10 offset:0
  ds_read_u16_d16_hi v33, v10 offset:2
  ds_read_u16_d16_hi v34, v10 offset:2112
  ds_read_u16_d16_hi v35, v10 offset:2114
  ds_read_u16_d16_hi v36, v10 offset:128
  ds_read_u16_d16_hi v37, v10 offset:130
  ds_read_u16_d16_hi v38, v10 offset:2240
  ds_read_u16_d16_hi v39, v10 offset:2242
  ds_read_u16_d16_hi v40, v10 offset:256
  ds_read_u16_d16_hi v41, v10 offset:258
  ds_read_u16_d16_hi v42, v10 offset:2368
  ds_read_u16_d16_hi v43, v10 offset:2370
  ds_read_u16_d16_hi v44, v10 offset:384
  ds_read_u16_d16_hi v45, v10 offset:386
  ds_read_u16_d16_hi v46, v10 offset:2496
  ds_read_u16_d16_hi v47, v10 offset:2498
  ds_read_u16_d16_hi v48, v10 offset:512
  ds_read_u16_d16_hi v49, v10 offset:514
  ds_read_u16_d16_hi v50, v10 offset:2624
  ds_read_u16_d16_hi v51, v10 offset:2626
  ds_read_u16_d16_hi v52, v10 offset:640
  ds_read_u16_d16_hi v53, v10 offset:642
  ds_read_u16_d16_hi v54, v10 offset:2752
  ds_read_u16_d16_hi v55, v10 offset:2754
  ds_read_u16_d16_hi v56, v10 offset:768
  ds_read_u16_d16_hi v57, v10 offset:770
  s_waitcnt lgkmcnt(14)
  v_max3_f32 v58, |v32|, |v33|, 0
  v_cvt_pk_f16_f32 v184, v32, v33
  v_max3_f32 v58, |v34|, |v35|, v58
  v_cvt_pk_f16_f32 v185, v34, v35
  v_max3_f32 v58, |v36|, |v37|, v58
  v_cvt_pk_f16_f32 v186, v36, v37
  v_max3_f32 v58, |v38|, |v39|, v58
  v_cvt_pk_f16_f32 v187, v38, v39
  v_max3_f32 v58, |v40|, |v41|, v58
  v_cvt_pk_f16_f32 v188, v40, v41
  v_max3_f32 v58, |v42|, |v43|, v58
  v_cvt_pk_f16_f32 v189, v42, v43
  s_waitcnt lgkmcnt(12)
  v_max3_f32 v58, |v44|, |v45|, v58
  v_cvt_pk_f16_f32 v190, v44, v45
  s_waitcnt lgkmcnt(10)
  v_max3_f32 v58, |v46|, |v47|, v58
  v_cvt_pk_f16_f32 v191, v46, v47
  s_waitcnt lgkmcnt(8)
  v_max3_f32 v58, |v48|, |v49|, v58
  v_cvt_pk_f16_f32 v192, v48, v49
  s_waitcnt lgkmcnt(6)
  v_max3_f32 v58, |v50|, |v51|, v58
  v_cvt_pk_f16_f32 v193, v50, v51
  s_waitcnt lgkmcnt(4)
  v_max3_f32 v58, |v52|, |v53|, v58
  v_cvt_pk_f16_f32 v194, v52, v53
  s_waitcnt lgkmcnt(2)
  v_max3_f32 v58, |v54|, |v55|, v58
  v_cvt_pk_f16_f32 v195, v54, v55
  s_waitcnt lgkmcnt(0)
  v_max3_f32 v58, |v56|, |v57|, v58
  v_cvt_pk_f16_f32 v196, v56, v57
  s_waitcnt lgkmcnt(0)
  s_barrier
  s_branch L_cin_go
L_g1c:
  s_waitcnt lgkmcnt(0)
  s_barrier
  s_add_u32 s76, s76, -63168
  s_waitcnt vmcnt(1)
  v_lshl_add_u32 v16, v16, 7, v8
  v_lshl_add_u32 v17, v17, 7, v8
  v_lshl_add_u32 v18, v18, 7, v8
  v_lshl_add_u32 v19, v19, 7, v8
  s_add_u32 m0, s76, 0
  s_mov_b32 exec_hi, 0xffffff
  buffer_load_dwordx4 v16, s[32:35], 0 offen lds
  s_add_u32 m0, s76, 1056
  s_nop 0
  buffer_load_dwordx4 v17, s[32:35], 0 offen lds
  s_add_u32 m0, s76, 2112
  s_mov_b32 exec_hi, 0xffff
  buffer_load_dwordx4 v18, s[32:35], 0 offen lds
  s_add_u32 m0, s76, 3168
  s_nop 0
  buffer_load_dwordx4 v19, s[32:35], 0 offen lds
  s_mov_b32 exec_hi, -1
  s_waitcnt vmcnt(4)
  v_lshl_add_u32 v112, v112, 7, v8
  v_lshl_add_u32 v113, v113, 7, v8
  v_lshl_add_u32 v114, v114, 7, v8
  v_lshl_add_u32 v115, v115, 7, v8
  s_add_u32 m0, s76, 16256
  s_mov_b32 exec_hi, 0xffffff
  buffer_load_dwordx4 v112, s[32:35], 0 offen lds
  s_add_u32 m0, s76, 17312
  s_nop 0
  buffer_load_dwordx4 v113, s[32:35], 0 offen lds
  s_add_u32 m0, s76, 18368
  s_mov_b32 exec_hi, 0xffff
  buffer_load_dwordx4 v114, s[32:35], 0 offen lds
  s_add_u32 m0, s76, 19424
  s_nop 0
  buffer_load_dwordx4 v115, s[32:35], 0 offen lds
  s_mov_b32 exec_hi, -1
  buffer_load_dwordx4 v[16:19], v6, s[28:31], s94 offen
  s_add_u32 s94, s94, 416
  v_add_u32 v10, -63168, v10
  v_add_u32 v4, -63168, v4
  v_add_u32 v5, -63168, v5
  ds_write_b32 v10, v7 offset:2880
  ds_write_b32 v10, v7 offset:19136
L_g1d:
  s_waitcnt vmcnt(5)
  ds_read_u16_d16_hi v32, v10 offset:0
  ds_read_u16_d16_hi v33, v10 offset:2
  ds_read_u16_d16_hi v34, v10 offset:2112
  ds_read_u16_d16_hi v35, v10 offset:2114
  ds_read_u16_d16_hi v36, v10 offset:128
  ds_read_u16_d16_hi v37, v10 offset:130
  ds_read_u16_d16_hi v38, v10 offset:2240
  ds_read_u16_d16_hi v39, v10 offset:2242
  ds_read_u16_d16_hi v40, v10 offset:256
  ds_read_u16_d16_hi v41, v10 offset:258
  ds_read_u16_d16_hi v42, v10 offset:2368
  ds_read_u16_d16_hi v43, v10 offset:2370
  ds_read_u16_d16_hi v44, v10 offset:384
  ds_read_u16_d16_hi v45, v10 offset:386
  ds_read_u16_d16_hi v46, v10 offset:2496
  ds_read_u16_d16_hi v47, v10 offset:2498
  ds_read_u16_d16_hi v48, v10 offset:512
  ds_read_u16_d16_hi v49, v10 offset:514
  ds_read_u16_d16_hi v50, v10 offset:2624
  ds_read_u16_d16_hi v51, v10 offset:2626
  ds_read_u16_d16_hi v52, v10 offset:640
  ds_read_u16_d16_hi v53, v10 offset:642
  ds_read_u16_d16_hi v54, v10 offset:2752
  ds_read_u16_d16_hi v55, v10 offset:2754
  ds_read_u16_d16_hi v56, v10 offset:768
  ds_read_u16_d16_hi v57, v10 offset:770
  s_waitcnt lgkmcnt(14)
  v_max3_f32 v58, |v32|, |v33|, 0
  v_cvt_pk_f16_f32 v184, v32, v33
  v_max3_f32 v58, |v34|, |v35|, v58
  v_cvt_pk_f16_f32 v185, v34, v35
  v_max3_f32 v58, |v36|, |v37|, v58
  v_cvt_pk_f16_f32 v186, v36, v37
  v_max3_f32 v58, |v38|, |v39|, v58
  v_cvt_pk_f16_f32 v187, v38, v39
  v_max3_f32 v58, |v40|, |v41|, v58
  v_cvt_pk_f16_f32 v188, v40, v41
  v_max3_f32 v58, |v42|, |v43|, v58
  v_cvt_pk_f16_f32 v189, v42, v43
  s_waitcnt lgkmcnt(12)
  v_max3_f32 v58, |v44|, |v45|, v58
  v_cvt_pk_f16_f32 v190, v44, v45
  s_waitcnt lgkmcnt(10)
  v_max3_f32 v58, |v46|, |v47|, v58
  v_cvt_pk_f16_f32 v191, v46, v47
  s_waitcnt lgkmcnt(8)
  v_max3_f32 v58, |v48|, |v49|, v58
  v_cvt_pk_f16_f32 v192, v48, v49
  s_waitcnt lgkmcnt(6)
  v_max3_f32 v58, |v50|, |v51|, v58
  v_cvt_pk_f16_f32 v193, v50, v51
  s_waitcnt lgkmcnt(4)
  v_max3_f32 v58, |v52|, |v53|, v58
  v_cvt_pk_f16_f32 v194, v52, v53
  s_waitcnt lgkmcnt(2)
  v_max3_f32 v58, |v54|, |v55|, v58
  v_cvt_pk_f16_f32 v195, v54, v55
  s_waitcnt lgkmcnt(0)
  v_max3_f32 v58, |v56|, |v57|, v58
  v_cvt_pk_f16_f32 v196, v56, v57
L_cin_go:
  ds_write_b32 v11, v184 offset:0
  ds_write_b32 v11, v185 offset:160
  ds_write_b32 v11, v186 offset:320
  ds_write_b32 v11, v187 offset:480
  ds_write_b32 v11, v188 offset:640
  ds_write_b32 v11, v189 offset:800
  ds_write_b32 v11, v190 offset:960
  ds_write_b32 v11, v191 offset:1120
  ds_write_b32 v11, v192 offset:1280
  ds_write_b32 v11, v193 offset:1440
  ds_write_b32 v11, v194 offset:1600
  ds_write_b32 v11, v195 offset:1760
  ds_write_b32 v11, v196 offset:1920
  s_mov_b32 s81, 16256
  s_add_u32 s76, s76, 16256
  v_lshlrev_b32 v7, 2, v0
  v_add_u32 v7, s98, v7
L_cin_loop:
  v_cmp_le_f32 s[90:91], s97, v58
  v_cmp_le_f32 vcc, s96, v58
  s_mov_b32 s49, s74
  s_mov_b32 s50, s75
  s_cmp_lg_u64 s[90:91], 0
  s_cbranch_scc1 L_cslow
  s_cbranch_vccz L_cslow
L_cconv:
  s_cmp_lg_u32 s51, 0
  s_cbranch_scc1 L_first
  ds_read_b64_tr_b16 v[60:61], v20 offset:0
  v_mul_f32 v116, v184, v192
  v_mul_f32 v117, v185, v193
  ds_read_b64_tr_b16 v[74:75], v20 offset:32
  v_mul_f32 v118, v186, v194
  ds_read_b64_tr_b16 v[88:89], v20 offset:64
  v_mul_f32 v119, v187, v195
  ds_read_b64_tr_b16 v[102:103], v20 offset:96
  v_fmac_f32_e64 v116, v188, v191
  ds_read_b64_tr_b16 v[66:67], v23 offset:0
  v_fmac_f32 v117, v200, v208
  ds_read_b64_tr_b16 v[80:81], v23 offset:32
  v_fmac_f32 v118, v201, v209
  ds_read_b64_tr_b16 v[94:95], v23 offset:64
  v_fmac_f32 v119, v202, v210
  ds_read_b64_tr_b16 v[108:109], v23 offset:96
  v_fmac_f32 v116, v203, v211
  ds_read_b64_tr_b16 v[68:69], v24 offset:0
  v_fmac_f32_e64 v117, v204, v207
  ds_read_b64_tr_b16 v[82:83], v24 offset:32
  v_fmac_f32 v118, v216, v224
  ds_read_b64_tr_b16 v[96:97], v24 offset:64
  v_fmac_f32 v119, v217, v225
  ds_read_b64_tr_b16 v[110:111], v24 offset:96
  v_fmac_f32 v116, v218, v226
  ds_read_b64_tr_b16 v[124:125], v4 offset:0
  v_fmac_f32 v117, v219, v227
  ds_read_b64_tr_b16 v[126:127], v5 offset:0
  v_fmac_f32 v118, v220, v223
  v_fmac_f32 v119, v232, v240
  ds_read_b64_tr_b16 v[136:137], v4 offset:32
  v_fmac_f32 v116, v233, v241
  ds_read_b64_tr_b16 v[138:139], v5 offset:32
  v_fmac_f32 v117, v234, v242
  ds_read_b64_tr_b16 v[148:149], v4 offset:64
  v_fmac_f32 v118, v235, v243
  ds_read_b64_tr_b16 v[150:151], v5 offset:64
  v_fmac_f32 v119, v236, v239
  ds_read_b64_tr_b16 v[160:161], v4 offset:96
  v_fmac_f32_e64 v116, v189, v196
  ds_read_b64_tr_b16 v[162:163], v5 offset:96
  v_fmac_f32 v117, v189, v197
  ds_read_b128 v[164:167], v1 offset:39936
  v_fmac_f32 v118, v190, v198
  ds_read_b128 v[168:171], v1 offset:40960
  v_fmac_f32 v119, v190, v199
  ds_read_b128 v[172:175], v1 offset:8192
  v_fmac_f32 v116, v205, v212
  ds_read_b128 v[176:179], v1 offset:6144
  v_fmac_f32_e64 v117, v205, v213
  ds_read_b64_tr_b16 v[70:71], v25 offset:0
  v_fmac_f32 v118, v206, v214
  ds_read_b64_tr_b16 v[84:85], v25 offset:32
  v_fmac_f32 v119, v206, v215
  ds_read_b64_tr_b16 v[98:99], v25 offset:64
  v_fmac_f32 v116, v221, v228
  v_fmac_f32 v117, v221, v229
  ds_read_b64_tr_b16 v[112:113], v25 offset:96
  v_fmac_f32 v118, v222, v230
  ds_read_b64_tr_b16 v[72:73], v26 offset:0
  v_fmac_f32 v119, v222, v231
  ds_read_b64_tr_b16 v[86:87], v26 offset:32
  v_fmac_f32 v116, v237, v244
  ds_read_b64_tr_b16 v[100:101], v26 offset:64
  v_fmac_f32 v117, v237, v245
  ds_read_b64_tr_b16 v[114:115], v26 offset:96
  v_fmac_f32 v118, v238, v246
  ds_read_b64_tr_b16 v[62:63], v21 offset:0
  v_fmac_f32 v119, v238, v247
  ds_read_b64_tr_b16 v[76:77], v21 offset:32
  v_add_f32_e64 v116, v116, v117
  ds_read_b64_tr_b16 v[90:91], v21 offset:64
  v_add_f32 v118, v118, v119
  ds_read_b64_tr_b16 v[104:105], v21 offset:96
  v_add_f32 v116, v116, v118
  ds_read_b64_tr_b16 v[64:65], v22 offset:0
  v_mul_f32 v116, s49, v116
  ds_read_b64_tr_b16 v[78:79], v22 offset:32
  v_mul_f32 v116, s50, v116
  ds_read_b64_tr_b16 v[92:93], v22 offset:64
  ds_write_b32 v7, v116
  ds_read_b64_tr_b16 v[106:107], v22 offset:96
  v_add_u32 v7, 256, v7
  s_waitcnt lgkmcnt(14)
  v_pk_mul_f16 v120, v60, v67 op_sel:[0,0] op_sel_hi:[0,1]
  v_pk_mul_f16 v121, v60, v67 op_sel:[1,0] op_sel_hi:[1,1]
  v_pk_mul_f16 v122, v60, v68 op_sel:[0,0] op_sel_hi:[0,1]
  v_pk_mul_f16 v123, v60, v68 op_sel:[1,0] op_sel_hi:[1,1]
  v_pk_mul_f16 v132, v74, v81 op_sel:[0,0] op_sel_hi:[0,1]
  v_pk_mul_f16 v133, v74, v81 op_sel:[1,0] op_sel_hi:[1,1]
  v_pk_mul_f16 v134, v74, v82 op_sel:[0,0] op_sel_hi:[0,1]
  v_pk_mul_f16 v135, v74, v82 op_sel:[1,0] op_sel_hi:[1,1]
  v_pk_mul_f16 v144, v88, v95 op_sel:[0,0] op_sel_hi:[0,1]
  v_pk_mul_f16 v145, v88, v95 op_sel:[1,0] op_sel_hi:[1,1]
  v_pk_mul_f16 v146, v88, v96 op_sel:[0,0] op_sel_hi:[0,1]
  v_pk_mul_f16 v147, v88, v96 op_sel:[1,0] op_sel_hi:[1,1]
  v_pk_mul_f16 v156, v102, v109 op_sel:[0,0] op_sel_hi:[0,1]
  v_pk_mul_f16 v157, v102, v109 op_sel:[1,0] op_sel_hi:[1,1]
  v_pk_mul_f16 v158, v102, v110 op_sel:[0,0] op_sel_hi:[0,1]
  v_pk_mul_f16 v159, v102, v110 op_sel:[1,0] op_sel_hi:[1,1]
  s_waitcnt vmcnt(0)
  v_lshl_add_u32 v16, v16, 7, v8
  v_lshl_add_u32 v17, v17, 7, v8
  v_lshl_add_u32 v18, v18, 7, v8
  v_lshl_add_u32 v19, v19, 7, v8
  s_add_u32 m0, s76, 0
  s_mov_b32 exec_hi, 0xffffff
  buffer_load_dwordx4 v16, s[32:35], 0 offen lds
  s_add_u32 m0, s76, 1056
  s_nop 0
  buffer_load_dwordx4 v17, s[32:35], 0 offen lds
  s_add_u32 m0, s76, 2112
  s_mov_b32 exec_hi, 0xffff
  buffer_load_dwordx4 v18, s[32:35], 0 offen lds
  s_add_u32 m0, s76, 3168
  s_nop 0
  buffer_load_dwordx4 v19, s[32:35], 0 offen lds
  s_mov_b32 exec_hi, -1
  buffer_load_dwordx4 v[16:19], v6, s[28:31], s94 offen
  s_add_u32 s94, s94, 416
L_novm:
  v_add_u32 v10, s81, v10
  v_add_u32 v4, s81, v4
  v_add_u32 v5, s81, v5
  s_sub_u32 s76, s76, s81
  s_sub_u32 s81, 0, s81
  s_mov_b32 s51, 0
  s_waitcnt lgkmcnt(14)
  s_cmp_eq_u32 s84, 0
  s_cbranch_scc1 L_np1
  s_setprio 1
L_np1:
  v_mfma_f32_16x16x32_bf16 v[184:187], v[164:167], v[124:127], 0
  ds_read_b128 v[180:183], v1 offset:7168
  v_pk_mul_f16 v116, v60, v69 op_sel:[0,0] op_sel_hi:[0,1]
  v_mfma_f32_16x16x32_bf16 v[200:203], v[164:167], v[136:139], 0
  v_pk_mul_f16 v117, v60, v69 op_sel:[1,0] op_sel_hi:[1,1]
  v_mfma_f32_16x16x32_bf16 v[216:219], v[164:167], v[148:151], 0
  v_pk_mul_f16 v118, v60, v70 op_sel:[0,0] op_sel_hi:[0,1]
  v_mfma_f32_16x16x32_bf16 v[232:235], v[164:167], v[160:163], 0
  v_pk_mul_f16 v119, v60, v70 op_sel:[1,0] op_sel_hi:[1,1]
  v_mfma_f32_16x16x32_bf16 v[236:239], v[168:171], v[160:163], 0
  ds_read_b128 v[164:167], v1 offset:5120
  v_pk_mul_f16 v128, v74, v83 op_sel:[0,0] op_sel_hi:[0,1]
  v_mfma_f32_16x16x32_bf16 v[220:223], v[168:171], v[148:151], 0
  v_pk_mul_f16 v129, v74, v83 op_sel:[1,0] op_sel_hi:[1,1]
  v_mfma_f32_16x16x32_bf16 v[204:207], v[168:171], v[136:139], 0
  v_pk_mul_f16 v130, v74, v84 op_sel:[0,0] op_sel_hi:[0,1]
  v_mfma_f32_16x16x32_bf16 v[188:191], v[168:171], v[124:127], 0
  v_pk_mul_f16 v131, v74, v84 op_sel:[1,0] op_sel_hi:[1,1]
  v_mfma_f32_16x16x32_f16 v[192:195], v[172:175], v[120:123], 0
  ds_read_b128 v[168:171], v1 offset:11264
  v_pk_mul_f16 v140, v88, v97 op_sel:[0,0] op_sel_hi:[0,1]
  v_mfma_f32_16x16x32_f16 v[208:211], v[172:175], v[132:135], 0
  v_pk_mul_f16 v141, v88, v97 op_sel:[1,0] op_sel_hi:[1,1]
  v_mfma_f32_16x16x32_f16 v[224:227], v[172:175], v[144:147], 0
  s_waitcnt lgkmcnt(14)
  v_pk_mul_f16 v142, v88, v98 op_sel:[0,0] op_sel_hi:[0,1]
  v_mfma_f32_16x16x32_f16 v[240:243], v[172:175], v[156:159], 0
  v_pk_mul_f16 v143, v88, v98 op_sel:[1,0] op_sel_hi:[1,1]
  v_mfma_f32_16x16x32_f16 v[232:235], v[176:179], v[156:159], v[232:235]
  ds_read_b128 v[172:175], v1 offset:9216
  v_pk_mul_f16 v152, v102, v111 op_sel:[0,0] op_sel_hi:[0,1]
  v_mfma_f32_16x16x32_f16 v[216:219], v[176:179], v[144:147], v[216:219]
  v_pk_mul_f16 v153, v102, v111 op_sel:[1,0] op_sel_hi:[1,1]
  v_mfma_f32_16x16x32_f16 v[200:203], v[176:179], v[132:135], v[200:203]
  s_waitcnt lgkmcnt(14)
  v_pk_mul_f16 v154, v102, v112 op_sel:[0,0] op_sel_hi:[0,1]
  v_mfma_f32_16x16x32_f16 v[184:187], v[176:179], v[120:123], v[184:187]
  s_waitcnt lgkmcnt(3)
  v_pk_mul_f16 v155, v102, v112 op_sel:[1,0] op_sel_hi:[1,1]
  v_mfma_f32_16x16x32_f16 v[188:191], v[180:183], v[120:123], v[188:191]
  ds_read_b128 v[176:179], v1 offset:10240
  v_pk_mul_f16 v124, v61, v68 op_sel:[0,0] op_sel_hi:[0,1]
  v_mfma_f32_16x16x32_f16 v[204:207], v[180:183], v[132:135], v[204:207]
  v_pk_mul_f16 v125, v61, v68 op_sel:[1,0] op_sel_hi:[1,1]
  v_mfma_f32_16x16x32_f16 v[220:223], v[180:183], v[144:147], v[220:223]
  v_pk_mul_f16 v126, v61, v69 op_sel:[0,0] op_sel_hi:[0,1]
  v_mfma_f32_16x16x32_f16 v[236:239], v[180:183], v[156:159], v[236:239]
  s_waitcnt lgkmcnt(3)
  v_pk_mul_f16 v127, v61, v69 op_sel:[1,0] op_sel_hi:[1,1]
  v_mfma_f32_16x16x32_f16 v[196:199], v[164:167], v[120:123], 0
  ds_read_b128 v[180:183], v1 offset:14336
  v_pk_mul_f16 v136, v75, v82 op_sel:[0,0] op_sel_hi:[0,1]
  v_mfma_f32_16x16x32_f16 v[212:215], v[164:167], v[132:135], 0
  v_pk_mul_f16 v120, v60, v71 op_sel:[0,0] op_sel_hi:[0,1]
  v_mfma_f32_16x16x32_f16 v[228:231], v[164:167], v[144:147], 0
  v_pk_mul_f16 v121, v60, v71 op_sel:[1,0] op_sel_hi:[1,1]
  v_mfma_f32_16x16x32_f16 v[244:247], v[164:167], v[156:159], 0
  s_waitcnt lgkmcnt(3)
  v_pk_mul_f16 v122, v60, v66 op_sel:[0,1] op_sel_hi:[0,0]
  v_mfma_f32_16x16x32_f16 v[192:195], v[168:171], v[116:119], v[192:195]
  ds_read_b128 v[164:167], v1 offset:12288
  v_pk_mul_f16 v123, v60, v72 op_sel:[0,0] op_sel_hi:[1,0]
  v_mfma_f32_16x16x32_f16 v[208:211], v[168:171], v[128:131], v[208:211]
  v_pk_mul_f16 v132, v74, v85 op_sel:[0,0] op_sel_hi:[0,1]
  v_mfma_f32_16x16x32_f16 v[224:227], v[168:171], v[140:143], v[224:227]
  v_pk_mul_f16 v133, v74, v85 op_sel:[1,0] op_sel_hi:[1,1]
  v_mfma_f32_16x16x32_f16 v[240:243], v[168:171], v[152:155], v[240:243]
  s_waitcnt lgkmcnt(3)
  v_pk_mul_f16 v134, v74, v80 op_sel:[0,1] op_sel_hi:[0,0]
  v_mfma_f32_16x16x32_f16 v[232:235], v[172:175], v[152:155], v[232:235]
  ds_read_b128 v[168:171], v1 offset:13312
  v_pk_mul_f16 v135, v74, v86 op_sel:[0,0] op_sel_hi:[1,0]
  v_mfma_f32_16x16x32_f16 v[216:219], v[172:175], v[140:143], v[216:219]
  v_pk_mul_f16 v144, v88, v99 op_sel:[0,0] op_sel_hi:[0,1]
  v_mfma_f32_16x16x32_f16 v[200:203], v[172:175], v[128:131], v[200:203]
  s_setprio 2
  v_pk_mul_f16 v145, v88, v99 op_sel:[1,0] op_sel_hi:[1,1]
  v_mfma_f32_16x16x32_f16 v[184:187], v[172:175], v[116:119], v[184:187]
  s_waitcnt lgkmcnt(3)
  v_pk_mul_f16 v146, v88, v94 op_sel:[0,1] op_sel_hi:[0,0]
  v_mfma_f32_16x16x32_f16 v[188:191], v[176:179], v[116:119], v[188:191]
  ds_read_b128 v[172:175], v1 offset:0
  v_pk_mul_f16 v147, v88, v100 op_sel:[0,0] op_sel_hi:[1,0]
  v_mfma_f32_16x16x32_f16 v[204:207], v[176:179], v[128:131], v[204:207]
  v_pk_mul_f16 v156, v102, v113 op_sel:[0,0] op_sel_hi:[0,1]
  v_mfma_f32_16x16x32_f16 v[220:223], v[176:179], v[140:143], v[220:223]
  v_pk_mul_f16 v157, v102, v113 op_sel:[1,0] op_sel_hi:[1,1]
  v_mfma_f32_16x16x32_f16 v[236:239], v[176:179], v[152:155], v[236:239]
  s_waitcnt lgkmcnt(3)
  v_pk_mul_f16 v158, v102, v108 op_sel:[0,1] op_sel_hi:[0,0]
  v_mfma_f32_16x16x32_f16 v[192:195], v[180:183], v[120:123], v[192:195]
  ds_read_b128 v[176:179], v1 offset:17408
  v_pk_mul_f16 v159, v102, v114 op_sel:[0,0] op_sel_hi:[1,0]
  v_mfma_f32_16x16x32_f16 v[208:211], v[180:183], v[132:135], v[208:211]
  v_pk_mul_f16 v137, v75, v82 op_sel:[1,0] op_sel_hi:[1,1]
  v_mfma_f32_16x16x32_f16 v[224:227], v[180:183], v[144:147], v[224:227]
  v_pk_mul_f16 v138, v75, v83 op_sel:[0,0] op_sel_hi:[0,1]
  v_mfma_f32_16x16x32_f16 v[240:243], v[180:183], v[156:159], v[240:243]
  s_waitcnt lgkmcnt(3)
  v_pk_mul_f16 v139, v75, v83 op_sel:[1,0] op_sel_hi:[1,1]
  v_mfma_f32_16x16x32_f16 v[232:235], v[164:167], v[156:159], v[232:235]
  ds_read_b128 v[180:183], v1 offset:15360
  v_pk_mul_f16 v148, v89, v96 op_sel:[0,0] op_sel_hi:[0,1]
  v_mfma_f32_16x16x32_f16 v[216:219], v[164:167], v[144:147], v[216:219]
  v_pk_mul_f16 v149, v89, v96 op_sel:[1,0] op_sel_hi:[1,1]
  v_mfma_f32_16x16x32_f16 v[200:203], v[164:167], v[132:135], v[200:203]
  v_pk_mul_f16 v150, v89, v97 op_sel:[0,0] op_sel_hi:[0,1]
  v_mfma_f32_16x16x32_f16 v[184:187], v[164:167], v[120:123], v[184:187]
  s_waitcnt lgkmcnt(3)
  v_pk_mul_f16 v151, v89, v97 op_sel:[1,0] op_sel_hi:[1,1]
  v_mfma_f32_16x16x32_f16 v[188:191], v[168:171], v[120:123], v[188:191]
  ds_read_b128 v[164:167], v1 offset:16384
  v_pk_mul_f16 v160, v103, v110 op_sel:[0,0] op_sel_hi:[0,1]
  v_mfma_f32_16x16x32_f16 v[204:207], v[168:171], v[132:135], v[204:207]
  v_pk_mul_f16 v161, v103, v110 op_sel:[1,0] op_sel_hi:[1,1]
  v_mfma_f32_16x16x32_f16 v[220:223], v[168:171], v[144:147], v[220:223]
  v_pk_mul_f16 v162, v103, v111 op_sel:[0,0] op_sel_hi:[0,1]
  v_mfma_f32_16x16x32_f16 v[236:239], v[168:171], v[156:159], v[236:239]
  s_waitcnt lgkmcnt(3)
  v_pk_mul_f16 v163, v103, v111 op_sel:[1,0] op_sel_hi:[1,1]
  v_smfmac_f32_16x16x64_f16 v[196:199], v[172:175], v[116:123], v9
  ds_read_b128 v[168:171], v1 offset:20480
  v_smfmac_f32_16x16x64_f16 v[212:215], v[172:175], v[128:135], v9
  v_pk_mul_f16 v120, v61, v70 op_sel:[0,0] op_sel_hi:[0,1]
  v_smfmac_f32_16x16x64_f16 v[228:231], v[172:175], v[140:147], v9
  v_pk_mul_f16 v121, v61, v70 op_sel:[1,0] op_sel_hi:[1,1]
  v_smfmac_f32_16x16x64_f16 v[244:247], v[172:175], v[152:159], v9
  s_waitcnt lgkmcnt(3)
  v_pk_mul_f16 v122, v61, v71 op_sel:[0,0] op_sel_hi:[0,1]
  v_mfma_f32_16x16x32_f16 v[192:195], v[176:179], v[124:127], v[192:195]
  ds_read_b128 v[172:175], v1 offset:18432
  v_pk_mul_f16 v123, v61, v71 op_sel:[1,0] op_sel_hi:[1,1]
  v_mfma_f32_16x16x32_f16 v[208:211], v[176:179], v[136:139], v[208:211]
  v_pk_mul_f16 v132, v75, v84 op_sel:[0,0] op_sel_hi:[0,1]
  v_mfma_f32_16x16x32_f16 v[224:227], v[176:179], v[148:151], v[224:227]
  v_pk_mul_f16 v133, v75, v84 op_sel:[1,0] op_sel_hi:[1,1]
  v_mfma_f32_16x16x32_f16 v[240:243], v[176:179], v[160:163], v[240:243]
  s_waitcnt lgkmcnt(3)
  v_pk_mul_f16 v134, v75, v85 op_sel:[0,0] op_sel_hi:[0,1]
  v_mfma_f32_16x16x32_f16 v[232:235], v[180:183], v[160:163], v[232:235]
  ds_read_b128 v[176:179], v1 offset:19456
  v_pk_mul_f16 v135, v75, v85 op_sel:[1,0] op_sel_hi:[1,1]
  v_mfma_f32_16x16x32_f16 v[216:219], v[180:183], v[148:151], v[216:219]
  v_pk_mul_f16 v144, v89, v98 op_sel:[0,0] op_sel_hi:[0,1]
  v_mfma_f32_16x16x32_f16 v[200:203], v[180:183], v[136:139], v[200:203]
  v_pk_mul_f16 v145, v89, v98 op_sel:[1,0] op_sel_hi:[1,1]
  v_mfma_f32_16x16x32_f16 v[184:187], v[180:183], v[124:127], v[184:187]
  s_waitcnt lgkmcnt(3)
  v_pk_mul_f16 v146, v89, v99 op_sel:[0,0] op_sel_hi:[0,1]
  v_mfma_f32_16x16x32_f16 v[188:191], v[164:167], v[124:127], v[188:191]
  ds_read_b128 v[180:183], v1 offset:1024
  v_pk_mul_f16 v147, v89, v99 op_sel:[1,0] op_sel_hi:[1,1]
  v_mfma_f32_16x16x32_f16 v[204:207], v[164:167], v[136:139], v[204:207]
  s_waitcnt vmcnt(0)
  ds_read_u16_d16_hi v32, v10 offset:0
  v_pk_mul_f16 v156, v103, v112 op_sel:[0,0] op_sel_hi:[0,1]
  v_mfma_f32_16x16x32_f16 v[220:223], v[164:167], v[148:151], v[220:223]
  ds_read_u16_d16_hi v33, v10 offset:2
  v_pk_mul_f16 v157, v103, v112 op_sel:[1,0] op_sel_hi:[1,1]
  v_mfma_f32_16x16x32_f16 v[236:239], v[164:167], v[160:163], v[236:239]
  s_waitcnt lgkmcnt(5)
  v_pk_mul_f16 v158, v103, v113 op_sel:[0,0] op_sel_hi:[0,1]
  v_mfma_f32_16x16x32_f16 v[192:195], v[168:171], v[120:123], v[192:195]
  ds_read_b128 v[164:167], v1 offset:23552
  v_pk_mul_f16 v159, v103, v113 op_sel:[1,0] op_sel_hi:[1,1]
  v_mfma_f32_16x16x32_f16 v[208:211], v[168:171], v[132:135], v[208:211]
  ds_read_u16_d16_hi v34, v10 offset:2112
  v_pk_mul_f16 v116, v61, v67 op_sel:[0,1] op_sel_hi:[0,0]
  v_mfma_f32_16x16x32_f16 v[224:227], v[168:171], v[144:147], v[224:227]
  ds_read_u16_d16_hi v35, v10 offset:2114
  v_pk_mul_f16 v117, v61, v72 op_sel:[0,0] op_sel_hi:[1,0]
  v_mfma_f32_16x16x32_f16 v[240:243], v[168:171], v[156:159], v[240:243]
  s_waitcnt lgkmcnt(7)
  v_pk_mul_f16 v118, v62, v69 op_sel:[0,0] op_sel_hi:[0,1]
  v_mfma_f32_16x16x32_f16 v[232:235], v[172:175], v[156:159], v[232:235]
  ds_read_b128 v[168:171], v1 offset:21504
  v_pk_mul_f16 v119, v62, v69 op_sel:[1,0] op_sel_hi:[1,1]
  v_mfma_f32_16x16x32_f16 v[216:219], v[172:175], v[144:147], v[216:219]
  ds_read_b64_tr_b16 v[60:61], v27 offset:0
  v_pk_mul_f16 v128, v75, v81 op_sel:[0,1] op_sel_hi:[0,0]
  v_mfma_f32_16x16x32_f16 v[200:203], v[172:175], v[132:135], v[200:203]
  ds_read_u16_d16_hi v36, v10 offset:128
  v_pk_mul_f16 v129, v75, v86 op_sel:[0,0] op_sel_hi:[1,0]
  v_mfma_f32_16x16x32_f16 v[184:187], v[172:175], v[120:123], v[184:187]
  s_waitcnt lgkmcnt(9)
  v_pk_mul_f16 v130, v76, v83 op_sel:[0,0] op_sel_hi:[0,1]
  v_pk_mul_f16 v131, v76, v83 op_sel:[1,0] op_sel_hi:[1,1]
  v_mfma_f32_16x16x32_f16 v[188:191], v[176:179], v[120:123], v[188:191]
  ds_read_b128 v[172:175], v1 offset:22528
  v_pk_mul_f16 v140, v89, v95 op_sel:[0,1] op_sel_hi:[0,0]
  v_mfma_f32_16x16x32_f16 v[204:207], v[176:179], v[132:135], v[204:207]
  ds_read_b64_tr_b16 v[74:75], v27 offset:32
  v_pk_mul_f16 v141, v89, v100 op_sel:[0,0] op_sel_hi:[1,0]
  v_mfma_f32_16x16x32_f16 v[220:223], v[176:179], v[144:147], v[220:223]
  ds_read_b64_tr_b16 v[88:89], v27 offset:64
  v_pk_mul_f16 v142, v90, v97 op_sel:[0,0] op_sel_hi:[0,1]
  v_mfma_f32_16x16x32_f16 v[236:239], v[176:179], v[156:159], v[236:239]
  s_waitcnt lgkmcnt(11)
  v_pk_mul_f16 v143, v90, v97 op_sel:[1,0] op_sel_hi:[1,1]
  v_pk_mul_f16 v152, v103, v109 op_sel:[0,1] op_sel_hi:[0,0]
  v_smfmac_f32_16x16x64_f16 v[196:199], v[180:183], v[120:127], v9
  ds_read_b128 v[176:179], v1 offset:26624
  v_pk_mul_f16 v153, v103, v114 op_sel:[0,0] op_sel_hi:[1,0]
  v_smfmac_f32_16x16x64_f16 v[212:215], v[180:183], v[132:139], v9
  ds_read_b64_tr_b16 v[102:103], v27 offset:96
  v_pk_mul_f16 v154, v104, v111 op_sel:[0,0] op_sel_hi:[0,1]
  v_smfmac_f32_16x16x64_f16 v[228:231], v[180:183], v[144:151], v9
  ds_read_u16_d16_hi v37, v10 offset:130
  v_pk_mul_f16 v155, v104, v111 op_sel:[1,0] op_sel_hi:[1,1]
  v_smfmac_f32_16x16x64_f16 v[244:247], v[180:183], v[156:163], v9
  s_waitcnt lgkmcnt(11)
  v_pk_mul_f16 v120, v62, v70 op_sel:[0,0] op_sel_hi:[0,1]
  v_mfma_f32_16x16x32_f16 v[192:195], v[164:167], v[116:119], v[192:195]
  ds_read_b128 v[180:183], v1 offset:24576
  v_pk_mul_f16 v121, v62, v70 op_sel:[1,0] op_sel_hi:[1,1]
  v_mfma_f32_16x16x32_f16 v[208:211], v[164:167], v[128:131], v[208:211]
  ds_read_u16_d16_hi v38, v10 offset:2240
  v_pk_mul_f16 v122, v62, v71 op_sel:[0,0] op_sel_hi:[0,1]
  v_mfma_f32_16x16x32_f16 v[224:227], v[164:167], v[140:143], v[224:227]
  ds_read_u16_d16_hi v39, v10 offset:2242
  v_pk_mul_f16 v123, v62, v71 op_sel:[1,0] op_sel_hi:[1,1]
  v_mfma_f32_16x16x32_f16 v[240:243], v[164:167], v[152:155], v[240:243]
  s_waitcnt lgkmcnt(11)
  v_pk_mul_f16 v132, v76, v84 op_sel:[0,0] op_sel_hi:[0,1]
  v_max3_f32 v58, |v32|, |v33|, 0
  v_mfma_f32_16x16x32_f16 v[232:235], v[168:171], v[152:155], v[232:235]
  ds_read_b128 v[164:167], v1 offset:25600
  v_pk_mul_f16 v133, v76, v84 op_sel:[1,0] op_sel_hi:[1,1]
  v_mfma_f32_16x16x32_f16 v[216:219], v[168:171], v[140:143], v[216:219]
  ds_read_u16_d16_hi v40, v10 offset:256
  v_pk_mul_f16 v134, v76, v85 op_sel:[0,0] op_sel_hi:[0,1]
  v_mfma_f32_16x16x32_f16 v[200:203], v[168:171], v[128:131], v[200:203]
  ds_read_u16_d16_hi v41, v10 offset:258
  v_pk_mul_f16 v135, v76, v85 op_sel:[1,0] op_sel_hi:[1,1]
  v_mfma_f32_16x16x32_f16 v[184:187], v[168:171], v[116:119], v[184:187]
  s_waitcnt lgkmcnt(11)
  v_pk_mul_f16 v144, v90, v98 op_sel:[0,0] op_sel_hi:[0,1]
  v_max3_f32 v58, |v34|, |v35|, v58
  v_mfma_f32_16x16x32_f16 v[188:191], v[172:175], v[116:119], v[188:191]
  ds_read_b128 v[168:171], v1 offset:2048
  v_pk_mul_f16 v145, v90, v98 op_sel:[1,0] op_sel_hi:[1,1]
  v_mfma_f32_16x16x32_f16 v[204:207], v[172:175], v[128:131], v[204:207]
  ds_read_u16_d16_hi v42, v10 offset:2368
  v_pk_mul_f16 v146, v90, v99 op_sel:[0,0] op_sel_hi:[0,1]
  v_mfma_f32_16x16x32_f16 v[220:223], v[172:175], v[140:143], v[220:223]
  ds_read_u16_d16_hi v43, v10 offset:2370
  v_pk_mul_f16 v147, v90, v99 op_sel:[1,0] op_sel_hi:[1,1]
  v_mfma_f32_16x16x32_f16 v[236:239], v[172:175], v[152:155], v[236:239]
  s_waitcnt lgkmcnt(11)
  v_pk_mul_f16 v156, v104, v112 op_sel:[0,0] op_sel_hi:[0,1]
  v_mfma_f32_16x16x32_f16 v[192:195], v[176:179], v[120:123], v[192:195]
  ds_read_b128 v[172:175], v1 offset:29696
  v_pk_mul_f16 v157, v104, v112 op_sel:[1,0] op_sel_hi:[1,1]
  v_mfma_f32_16x16x32_f16 v[208:211], v[176:179], v[132:135], v[208:211]
  ds_read_u16_d16_hi v44, v10 offset:384
  v_pk_mul_f16 v158, v104, v113 op_sel:[0,0] op_sel_hi:[0,1]
  v_mfma_f32_16x16x32_f16 v[224:227], v[176:179], v[144:147], v[224:227]
  ds_read_u16_d16_hi v45, v10 offset:386
  v_pk_mul_f16 v159, v104, v113 op_sel:[1,0] op_sel_hi:[1,1]
  s_nop 1
  v_mfma_f32_16x16x32_f16 v[240:243], v[176:179], v[156:159], v[240:243]
  s_waitcnt lgkmcnt(11)
  v_pk_mul_f16 v124, v62, v68 op_sel:[0,1] op_sel_hi:[0,0]
  v_mfma_f32_16x16x32_f16 v[232:235], v[180:183], v[156:159], v[232:235]
  ds_read_b128 v[176:179], v1 offset:27648
  v_pk_mul_f16 v125, v62, v72 op_sel:[0,0] op_sel_hi:[1,0]
  v_mfma_f32_16x16x32_f16 v[216:219], v[180:183], v[144:147], v[216:219]
  ds_read_u16_d16_hi v46, v10 offset:2496
  v_pk_mul_f16 v126, v63, v70 op_sel:[0,0] op_sel_hi:[0,1]
  v_mfma_f32_16x16x32_f16 v[200:203], v[180:183], v[132:135], v[200:203]
  ds_read_u16_d16_hi v47, v10 offset:2498
  v_pk_mul_f16 v127, v63, v70 op_sel:[1,0] op_sel_hi:[1,1]
  v_mfma_f32_16x16x32_f16 v[184:187], v[180:183], v[120:123], v[184:187]
  s_waitcnt lgkmcnt(11)
  v_pk_mul_f16 v136, v76, v82 op_sel:[0,1] op_sel_hi:[0,0]
  v_pk_mul_f16 v137, v76, v86 op_sel:[0,0] op_sel_hi:[1,0]
  v_mfma_f32_16x16x32_f16 v[188:191], v[164:167], v[120:123], v[188:191]
  ds_read_b128 v[180:183], v1 offset:28672
  v_pk_mul_f16 v138, v77, v84 op_sel:[0,0] op_sel_hi:[0,1]
  v_mfma_f32_16x16x32_f16 v[204:207], v[164:167], v[132:135], v[204:207]
  ds_read_u16_d16_hi v48, v10 offset:512
  v_pk_mul_f16 v139, v77, v84 op_sel:[1,0] op_sel_hi:[1,1]
  v_mfma_f32_16x16x32_f16 v[220:223], v[164:167], v[144:147], v[220:223]
  ds_read_u16_d16_hi v49, v10 offset:514
  v_pk_mul_f16 v148, v90, v96 op_sel:[0,1] op_sel_hi:[0,0]
  v_mfma_f32_16x16x32_f16 v[236:239], v[164:167], v[156:159], v[236:239]
  s_waitcnt lgkmcnt(11)
  v_pk_mul_f16 v149, v90, v100 op_sel:[0,0] op_sel_hi:[1,0]
  v_pk_mul_f16 v150, v91, v98 op_sel:[0,0] op_sel_hi:[0,1]
  v_smfmac_f32_16x16x64_f16 v[196:199], v[168:171], v[116:123], v9
  ds_read_b128 v[164:167], v1 offset:32768
  v_pk_mul_f16 v151, v91, v98 op_sel:[1,0] op_sel_hi:[1,1]
  v_smfmac_f32_16x16x64_f16 v[212:215], v[168:171], v[128:135], v9
  ds_read_u16_d16_hi v50, v10 offset:2624
  v_pk_mul_f16 v160, v104, v110 op_sel:[0,1] op_sel_hi:[0,0]
  v_smfmac_f32_16x16x64_f16 v[228:231], v[168:171], v[140:147], v9
  ds_read_u16_d16_hi v51, v10 offset:2626
  v_pk_mul_f16 v161, v104, v114 op_sel:[0,0] op_sel_hi:[1,0]
  v_smfmac_f32_16x16x64_f16 v[244:247], v[168:171], v[152:159], v9
  s_waitcnt lgkmcnt(11)
  v_pk_mul_f16 v162, v105, v112 op_sel:[0,0] op_sel_hi:[0,1]
  v_mfma_f32_16x16x32_f16 v[192:195], v[172:175], v[124:127], v[192:195]
  ds_read_b128 v[168:171], v1 offset:30720
  v_pk_mul_f16 v163, v105, v112 op_sel:[1,0] op_sel_hi:[1,1]
  v_mfma_f32_16x16x32_f16 v[208:211], v[172:175], v[136:139], v[208:211]
  ds_read_u16_d16_hi v52, v10 offset:640
  v_pk_mul_f16 v120, v63, v71 op_sel:[0,0] op_sel_hi:[0,1]
  v_mfma_f32_16x16x32_f16 v[224:227], v[172:175], v[148:151], v[224:227]
  ds_read_u16_d16_hi v53, v10 offset:642
  v_pk_mul_f16 v121, v63, v71 op_sel:[1,0] op_sel_hi:[1,1]
  v_mfma_f32_16x16x32_f16 v[240:243], v[172:175], v[160:163], v[240:243]
  s_waitcnt lgkmcnt(11)
  v_pk_mul_f16 v122, v63, v69 op_sel:[0,1] op_sel_hi:[1,1]
  v_pk_mul_f16 v123, v63, v72 op_sel:[0,0] op_sel_hi:[1,0]
  v_mfma_f32_16x16x32_f16 v[232:235], v[176:179], v[160:163], v[232:235]
  ds_read_b128 v[172:175], v1 offset:31744
  v_pk_mul_f16 v132, v77, v85 op_sel:[0,0] op_sel_hi:[0,1]
  v_mfma_f32_16x16x32_f16 v[216:219], v[176:179], v[148:151], v[216:219]
  ds_read_u16_d16_hi v54, v10 offset:2752
  v_pk_mul_f16 v133, v77, v85 op_sel:[1,0] op_sel_hi:[1,1]
  v_mfma_f32_16x16x32_f16 v[200:203], v[176:179], v[136:139], v[200:203]
  ds_read_u16_d16_hi v55, v10 offset:2754
  v_pk_mul_f16 v134, v77, v83 op_sel:[0,1] op_sel_hi:[1,1]
  v_mfma_f32_16x16x32_f16 v[184:187], v[176:179], v[124:127], v[184:187]
  s_waitcnt lgkmcnt(11)
  v_pk_mul_f16 v135, v77, v86 op_sel:[0,0] op_sel_hi:[1,0]
  v_pk_mul_f16 v144, v91, v99 op_sel:[0,0] op_sel_hi:[0,1]
  v_mfma_f32_16x16x32_f16 v[188:191], v[180:183], v[124:127], v[188:191]
  ds_read_b128 v[176:179], v1 offset:3072
  v_pk_mul_f16 v145, v91, v99 op_sel:[1,0] op_sel_hi:[1,1]
  v_mfma_f32_16x16x32_f16 v[204:207], v[180:183], v[136:139], v[204:207]
  ds_read_u16_d16_hi v56, v10 offset:768
  v_pk_mul_f16 v146, v91, v97 op_sel:[0,1] op_sel_hi:[1,1]
  v_mfma_f32_16x16x32_f16 v[220:223], v[180:183], v[148:151], v[220:223]
  ds_read_u16_d16_hi v57, v10 offset:770
  v_pk_mul_f16 v147, v91, v100 op_sel:[0,0] op_sel_hi:[1,0]
  v_mfma_f32_16x16x32_f16 v[236:239], v[180:183], v[160:163], v[236:239]
  s_waitcnt lgkmcnt(11)
  v_pk_mul_f16 v156, v105, v113 op_sel:[0,0] op_sel_hi:[0,1]
  v_max3_f32 v58, |v36|, |v37|, v58
  v_mfma_f32_16x16x32_f16 v[192:195], v[164:167], v[120:123], v[192:195]
  ds_read_b128 v[180:183], v1 offset:35840
  v_pk_mul_f16 v157, v105, v113 op_sel:[1,0] op_sel_hi:[1,1]
  v_mfma_f32_16x16x32_f16 v[208:211], v[164:167], v[132:135], v[208:211]
  v_pk_mul_f16 v158, v105, v111 op_sel:[0,1] op_sel_hi:[1,1]
  v_max3_f32 v58, |v38|, |v39|, v58
  v_mfma_f32_16x16x32_f16 v[224:227], v[164:167], v[144:147], v[224:227]
  v_pk_mul_f16 v159, v105, v114 op_sel:[0,0] op_sel_hi:[1,0]
  v_max3_f32 v58, |v40|, |v41|, v58
  s_nop 0
  v_mfma_f32_16x16x32_f16 v[240:243], v[164:167], v[156:159], v[240:243]
  s_waitcnt lgkmcnt(9)
  v_pk_mul_f16 v116, v64, v71 op_sel:[0,0] op_sel_hi:[0,1]
  v_mfma_f32_16x16x32_f16 v[232:235], v[168:171], v[156:159], v[232:235]
  ds_read_b128 v[164:167], v1 offset:33792
  v_pk_mul_f16 v117, v64, v71 op_sel:[1,0] op_sel_hi:[1,1]
  v_mfma_f32_16x16x32_f16 v[216:219], v[168:171], v[144:147], v[216:219]
  v_pk_mul_f16 v118, v64, v70 op_sel:[0,1] op_sel_hi:[1,1]
  v_max3_f32 v58, |v42|, |v43|, v58
  v_mfma_f32_16x16x32_f16 v[200:203], v[168:171], v[132:135], v[200:203]
  v_pk_mul_f16 v119, v64, v72 op_sel:[0,0] op_sel_hi:[1,0]
  v_pk_mul_f16 v128, v78, v85 op_sel:[0,0] op_sel_hi:[0,1]
  v_mfma_f32_16x16x32_f16 v[184:187], v[168:171], v[120:123], v[184:187]
  s_waitcnt lgkmcnt(7)
  v_pk_mul_f16 v129, v78, v85 op_sel:[1,0] op_sel_hi:[1,1]
  v_pk_mul_f16 v130, v78, v84 op_sel:[0,1] op_sel_hi:[1,1]
  v_mfma_f32_16x16x32_f16 v[188:191], v[172:175], v[120:123], v[188:191]
  ds_read_b128 v[168:171], v1 offset:34816
  v_pk_mul_f16 v131, v78, v86 op_sel:[0,0] op_sel_hi:[1,0]
  v_mfma_f32_16x16x32_f16 v[204:207], v[172:175], v[132:135], v[204:207]
  v_pk_mul_f16 v140, v92, v99 op_sel:[0,0] op_sel_hi:[0,1]
  v_pk_mul_f16 v141, v92, v99 op_sel:[1,0] op_sel_hi:[1,1]
  v_mfma_f32_16x16x32_f16 v[220:223], v[172:175], v[144:147], v[220:223]
  v_pk_mul_f16 v142, v92, v98 op_sel:[0,1] op_sel_hi:[1,1]
  v_pk_mul_f16 v143, v92, v100 op_sel:[0,0] op_sel_hi:[1,0]
  v_mfma_f32_16x16x32_f16 v[236:239], v[172:175], v[156:159], v[236:239]
  s_waitcnt lgkmcnt(5)
  v_pk_mul_f16 v152, v106, v113 op_sel:[0,0] op_sel_hi:[0,1]
  v_smfmac_f32_16x16x64_f16 v[196:199], v[176:179], v[120:127], v9
  ds_read_b128 v[172:175], v1 offset:38912
  v_pk_mul_f16 v153, v106, v113 op_sel:[1,0] op_sel_hi:[1,1]
  v_smfmac_f32_16x16x64_f16 v[212:215], v[176:179], v[132:139], v9
  v_pk_mul_f16 v154, v106, v112 op_sel:[0,1] op_sel_hi:[1,1]
  v_smfmac_f32_16x16x64_f16 v[228:231], v[176:179], v[144:151], v9
  v_pk_mul_f16 v155, v106, v114 op_sel:[0,0] op_sel_hi:[1,0]
  v_smfmac_f32_16x16x64_f16 v[244:247], v[176:179], v[156:163], v9
  s_waitcnt lgkmcnt(3)
  v_pk_mul_f16 v120, v65, v71 op_sel:[0,1] op_sel_hi:[1,1]
  v_mfma_f32_16x16x32_f16 v[192:195], v[180:183], v[116:119], v[192:195]
  ds_read_b128 v[176:179], v1 offset:36864
  v_pk_mul_f16 v121, v65, v72 op_sel:[0,0] op_sel_hi:[1,0]
  v_mfma_f32_16x16x32_f16 v[208:211], v[180:183], v[128:131], v[208:211]
  v_pk_mul_f16 v122, v72, v72 op_sel:[0,0] op_sel_hi:[1,1]
  v_max3_f32 v58, |v44|, |v45|, v58
  v_mfma_f32_16x16x32_f16 v[224:227], v[180:183], v[140:143], v[224:227]
  v_pk_mul_f16 v123, v60, v61 op_sel:[0,0] op_sel_hi:[1,1]
  v_max3_f32 v58, |v46|, |v47|, v58
  v_mfma_f32_16x16x32_f16 v[240:243], v[180:183], v[152:155], v[240:243]
  s_waitcnt lgkmcnt(3)
  v_pk_mul_f16 v132, v79, v85 op_sel:[0,1] op_sel_hi:[1,1]
  v_mfma_f32_16x16x32_f16 v[232:235], v[164:167], v[152:155], v[232:235]
  ds_read_b128 v[180:183], v1 offset:37888
  v_pk_mul_f16 v133, v79, v86 op_sel:[0,0] op_sel_hi:[1,0]
  v_mfma_f32_16x16x32_f16 v[216:219], v[164:167], v[140:143], v[216:219]
  v_pk_mul_f16 v134, v86, v86 op_sel:[0,0] op_sel_hi:[1,1]
  v_max3_f32 v58, |v48|, |v49|, v58
  v_mfma_f32_16x16x32_f16 v[200:203], v[164:167], v[128:131], v[200:203]
  v_pk_mul_f16 v135, v74, v75 op_sel:[0,0] op_sel_hi:[1,1]
  v_max3_f32 v58, |v50|, |v51|, v58
  v_mfma_f32_16x16x32_f16 v[184:187], v[164:167], v[116:119], v[184:187]
  s_waitcnt lgkmcnt(3)
  v_pk_mul_f16 v144, v93, v99 op_sel:[0,1] op_sel_hi:[1,1]
  v_mfma_f32_16x16x32_f16 v[188:191], v[168:171], v[116:119], v[188:191]
  ds_read_b128 v[164:167], v1 offset:4096
  v_pk_mul_f16 v145, v93, v100 op_sel:[0,0] op_sel_hi:[1,0]
  v_mfma_f32_16x16x32_f16 v[204:207], v[168:171], v[128:131], v[204:207]
  v_pk_mul_f16 v146, v100, v100 op_sel:[0,0] op_sel_hi:[1,1]
  v_max3_f32 v58, |v52|, |v53|, v58
  v_mfma_f32_16x16x32_f16 v[220:223], v[168:171], v[140:143], v[220:223]
  v_pk_mul_f16 v147, v88, v89 op_sel:[0,0] op_sel_hi:[1,1]
  v_max3_f32 v58, |v54|, |v55|, v58
  v_mfma_f32_16x16x32_f16 v[236:239], v[168:171], v[152:155], v[236:239]
  s_waitcnt lgkmcnt(3)
  v_pk_mul_f16 v156, v107, v113 op_sel:[0,1] op_sel_hi:[1,1]
  v_mfma_f32_16x16x32_f16 v[192:195], v[172:175], v[120:123], v[192:195]
  v_pk_mul_f16 v157, v107, v114 op_sel:[0,0] op_sel_hi:[1,0]
  v_max3_f32 v58, |v56|, |v57|, v58
  v_mfma_f32_16x16x32_f16 v[208:211], v[172:175], v[132:135], v[208:211]
  v_pk_mul_f16 v158, v114, v114 op_sel:[0,0] op_sel_hi:[1,1]
  v_cvt_pk_f16_f32 v62, v32, v33
  v_mfma_f32_16x16x32_f16 v[224:227], v[172:175], v[144:147], v[224:227]
  v_pk_mul_f16 v159, v102, v103 op_sel:[0,0] op_sel_hi:[1,1]
  s_nop 1
  v_mfma_f32_16x16x32_f16 v[240:243], v[172:175], v[156:159], v[240:243]
  s_waitcnt lgkmcnt(2)
  v_cvt_pk_f16_f32 v76, v34, v35
  v_cvt_pk_f16_f32 v90, v36, v37
  v_mfma_f32_16x16x32_f16 v[232:235], v[176:179], v[156:159], v[232:235]
  ds_write_b32 v11, v62 offset:0
  v_mfma_f32_16x16x32_f16 v[216:219], v[176:179], v[144:147], v[216:219]
  ds_write_b32 v11, v76 offset:160
  v_mfma_f32_16x16x32_f16 v[200:203], v[176:179], v[132:135], v[200:203]
  ds_write_b32 v11, v90 offset:320
  v_mfma_f32_16x16x32_f16 v[184:187], v[176:179], v[120:123], v[184:187]
  s_waitcnt lgkmcnt(4)
  v_cvt_pk_f16_f32 v104, v38, v39
  v_cvt_pk_f16_f32 v63, v40, v41
  v_mfma_f32_16x16x32_f16 v[188:191], v[180:183], v[120:123], v[188:191]
  ds_write_b32 v11, v104 offset:480
  v_mfma_f32_16x16x32_f16 v[204:207], v[180:183], v[132:135], v[204:207]
  ds_write_b32 v11, v63 offset:640
  v_mfma_f32_16x16x32_f16 v[220:223], v[180:183], v[144:147], v[220:223]
  v_cvt_pk_f16_f32 v77, v42, v43
  v_cvt_pk_f16_f32 v91, v44, v45
  v_mfma_f32_16x16x32_f16 v[236:239], v[180:183], v[156:159], v[236:239]
  s_waitcnt lgkmcnt(5)
  v_cvt_pk_f16_f32 v105, v46, v47
  v_cvt_pk_f16_f32 v66, v48, v49
  v_smfmac_f32_16x16x64_f16 v[196:199], v[164:167], v[116:123], v9
  ds_write_b32 v11, v77 offset:800
  v_smfmac_f32_16x16x64_f16 v[212:215], v[164:167], v[128:135], v9
  ds_write_b32 v11, v91 offset:960
  v_smfmac_f32_16x16x64_f16 v[228:231], v[164:167], v[140:147], v9
  ds_write_b32 v11, v105 offset:1120
  v_smfmac_f32_16x16x64_f16 v[244:247], v[164:167], v[152:159], v9
  ds_write_b32 v11, v66 offset:1280
  s_setprio 0
  s_sub_u32 s72, s72, 1
  s_cmp_eq_u32 s72, 0
  s_cbranch_scc1 L_cin_done
  v_cvt_pk_f16_f32 v80, v50, v51
  v_cvt_pk_f16_f32 v94, v52, v53
  v_cvt_pk_f16_f32 v108, v54, v55
  v_cvt_pk_f16_f32 v67, v56, v57
  ds_write_b32 v11, v80 offset:1440
  ds_write_b32 v11, v94 offset:1600
  ds_write_b32 v11, v108 offset:1760
  ds_write_b32 v11, v67 offset:1920
  s_branch L_cin_loop
L_cslow:
  v_max_f32_dpp v58, v58, v58 row_shr:1 row_mask:0xf bank_mask:0xf
  s_nop 1
  v_max_f32_dpp v58, v58, v58 row_shr:2 row_mask:0xf bank_mask:0xf
  s_nop 1
  v_max_f32_dpp v58, v58, v58 row_shr:4 row_mask:0xf bank_mask:0xf
  s_nop 1
  v_max_f32_dpp v58, v58, v58 row_shr:8 row_mask:0xf bank_mask:0xf
  s_nop 1
  v_max_f32_dpp v58, v58, v58 row_bcast:15 row_mask:0xa bank_mask:0xf
  s_nop 1
  v_max_f32_dpp v58, v58, v58 row_bcast:31 row_mask:0xc bank_mask:0xf
  s_nop 0
  v_readlane_b32 s98, v58, 63
  s_mov_b32 s97, 0
  s_lshr_b32 s98, s98, 23
  s_min_u32 s98, s98, 182
  s_lshr_b32 s99, s1, 23
  s_sub_u32 s99, s99, 47
  s_lshr_b32 s99, s99, 1
  s_min_u32 s99, s99, 59
  s_sub_u32 s99, 131, s99
  s_max_u32 s98, s98, s99
  s_sub_u32 s99, 258, s98
  s_lshl_b32 s100, s99, 1
  s_sub_u32 s100, s100, 127
  s_sub_u32 s95, 254, s100
  s_lshl_b32 s95, s95, 23
  v_mov_b32 v60, s95
  v_mul_f32 v61, s0, v60
  v_mul_f32 v60, s1, v60
  v_readfirstlane_b32 s74, v61
  v_readfirstlane_b32 s75, v60
  s_lshl_b32 s99, s99, 23
  s_lshl_b32 s100, s100, 23
  v_mul_f32 v60, s99, v32
  v_mul_f32 v61, s99, v33
  v_mul_f32 v62, s100, v32
  v_mul_f32 v63, s100, v33
  v_cvt_pk_f16_f32 v80, v60, v61
  v_cvt_pk_bf16_f32 v64, v62, v63
  ds_write_b32 v11, v80 offset:0
  ds_write_b32 v10, v64 offset:0
  v_mul_f32 v60, s99, v34
  v_mul_f32 v61, s99, v35
  v_mul_f32 v62, s100, v34
  v_mul_f32_e64 v63, s100, v35
  v_cvt_pk_f16_f32 v81, v60, v61
  v_cvt_pk_bf16_f32 v65, v62, v63
  ds_write_b32 v11, v81 offset:160
  ds_write_b32 v10, v65 offset:2112
  v_mul_f32 v60, s99, v36
  v_mul_f32 v61, s99, v37
  v_mul_f32 v62, s100, v36
  v_mul_f32 v63, s100, v37
  v_cvt_pk_f16_f32 v82, v60, v61
  v_cvt_pk_bf16_f32 v66, v62, v63
  ds_write_b32 v11, v82 offset:320
  ds_write_b32 v10, v66 offset:128
  v_mul_f32 v60, s99, v38
  v_mul_f32 v61, s99, v39
  v_mul_f32 v62, s100, v38
  v_mul_f32 v63, s100, v39
  v_cvt_pk_f16_f32 v83, v60, v61
  v_cvt_pk_bf16_f32 v67, v62, v63
  ds_write_b32 v11, v83 offset:480
  ds_write_b32 v10, v67 offset:2240
  v_mul_f32 v60, s99, v40
  v_mul_f32 v61, s99, v41
  v_mul_f32 v62, s100, v40
  v_mul_f32 v63, s100, v41
  v_cvt_pk_f16_f32 v84, v60, v61
  v_cvt_pk_bf16_f32 v68, v62, v63
  ds_write_b32 v11, v84 offset:640
  ds_write_b32 v10, v68 offset:256
  v_mul_f32 v60, s99, v42
  v_mul_f32 v61, s99, v43
  v_mul_f32 v62, s100, v42
  v_mul_f32 v63, s100, v43
  v_cvt_pk_f16_f32 v85, v60, v61
  v_cvt_pk_bf16_f32 v69, v62, v63
  ds_write_b32 v11, v85 offset:800
  ds_write_b32 v10, v69 offset:2368
  v_mul_f32 v60, s99, v44
  v_mul_f32 v61, s99, v45
  v_mul_f32 v62, s100, v44
  v_mul_f32 v63, s100, v45
  v_cvt_pk_f16_f32 v86, v60, v61
  v_cvt_pk_bf16_f32 v70, v62, v63
  ds_write_b32 v11, v86 offset:960
  ds_write_b32 v10, v70 offset:384
  v_mul_f32 v60, s99, v46
  v_mul_f32 v61, s99, v47
  v_mul_f32 v62, s100, v46
  v_mul_f32 v63, s100, v47
  v_cvt_pk_f16_f32 v87, v60, v61
  v_cvt_pk_bf16_f32 v71, v62, v63
  ds_write_b32 v11, v87 offset:1120
  ds_write_b32 v10, v71 offset:2496
  v_mul_f32 v60, s99, v48
  v_mul_f32 v61, s99, v49
  v_mul_f32 v62, s100, v48
  v_mul_f32 v63, s100, v49
  v_cvt_pk_f16_f32 v88, v60, v61
  v_cvt_pk_bf16_f32 v72, v62, v63
  ds_write_b32 v11, v88 offset:1280
  ds_write_b32 v10, v72 offset:512
  v_mul_f32 v60, s99, v50
  v_mul_f32 v61, s99, v51
  v_mul_f32 v62, s100, v50
  v_mul_f32 v63, s100, v51
  v_cvt_pk_f16_f32 v89, v60, v61
  v_cvt_pk_bf16_f32 v73, v62, v63
  ds_write_b32 v11, v89 offset:1440
  ds_write_b32 v10, v73 offset:2624
  v_mul_f32 v60, s99, v52
  v_mul_f32 v61, s99, v53
  v_mul_f32 v62, s100, v52
  v_mul_f32 v63, s100, v53
  v_cvt_pk_f16_f32 v90, v60, v61
  v_cvt_pk_bf16_f32 v74, v62, v63
  ds_write_b32 v11, v90 offset:1600
  ds_write_b32 v10, v74 offset:640
  v_mul_f32 v60, s99, v54
  v_mul_f32 v61, s99, v55
  v_mul_f32 v62, s100, v54
  v_mul_f32 v63, s100, v55
  v_cvt_pk_f16_f32 v91, v60, v61
  v_cvt_pk_bf16_f32 v75, v62, v63
  ds_write_b32 v11, v91 offset:1760
  ds_write_b32 v10, v75 offset:2752
  v_mul_f32 v60, s99, v56
  v_mul_f32 v61, s99, v57
  v_mul_f32 v62, s100, v56
  v_mul_f32 v63, s100, v57
  v_cvt_pk_f16_f32 v92, v60, v61
  v_cvt_pk_bf16_f32 v76, v62, v63
  ds_write_b32 v11, v92 offset:1920
  ds_write_b32 v10, v76 offset:768
  v_mov_b32 v60, s100
  v_cvt_pk_bf16_f32 v60, v60, v60
  s_mov_b32 exec_hi, 0
  ds_write_b32 v10, v60 offset:2880
  s_mov_b32 exec_hi, -1
  s_waitcnt lgkmcnt(0)
  s_branch L_cconv
L_sdown:
  v_lshlrev_b32 v108, 16, v112
  v_and_b32 v109, 0xffff0000, v112
  v_mul_f32 v108, v108, v250
  v_mul_f32 v109, v109, v250
  v_cvt_pk_bf16_f32 v112, v108, v109
  v_lshlrev_b32 v108, 16, v113
  v_and_b32 v109, 0xffff0000, v113
  v_mul_f32 v108, v108, v250
  v_mul_f32_e64 v109, v109, v250
  v_cvt_pk_bf16_f32 v113, v108, v109
  v_lshlrev_b32 v108, 16, v114
  v_and_b32 v109, 0xffff0000, v114
  v_mul_f32 v108, v108, v250
  v_mul_f32 v109, v109, v250
  v_cvt_pk_bf16_f32 v114, v108, v109
  v_lshlrev_b32 v108, 16, v115
  v_and_b32 v109, 0xffff0000, v115
  v_mul_f32 v108, v108, v250
  v_mul_f32 v109, v109, v250
  v_cvt_pk_bf16_f32 v115, v108, v109
  v_lshlrev_b32 v108, 16, v116
  v_and_b32 v109, 0xffff0000, v116
  v_mul_f32 v108, v108, v250
  v_mul_f32 v109, v109, v250
  v_cvt_pk_bf16_f32 v116, v108, v109
  v_lshlrev_b32 v108, 16, v117
  v_and_b32 v109, 0xffff0000, v117
  v_mul_f32 v108, v108, v250
  v_mul_f32 v109, v109, v250
  v_cvt_pk_bf16_f32 v117, v108, v109
  v_lshlrev_b32_e64 v108, 16, v118
  v_and_b32 v109, 0xffff0000, v118
  v_mul_f32 v108, v108, v250
  v_mul_f32 v109, v109, v250
  v_cvt_pk_bf16_f32 v118, v108, v109
  v_lshlrev_b32 v108, 16, v119
  v_and_b32 v109, 0xffff0000, v119
  v_mul_f32 v108, v108, v250
  v_mul_f32 v109, v109, v250
  v_cvt_pk_bf16_f32 v119, v108, v109
  s_branch L_scaled
L_first:
  ds_read_b64_tr_b16 v[60:61], v20 offset:0
  ds_read_b64_tr_b16 v[74:75], v20 offset:32
  ds_read_b64_tr_b16 v[88:89], v20 offset:64
  ds_read_b64_tr_b16 v[102:103], v20 offset:96
  ds_read_b64_tr_b16 v[66:67], v23 offset:0
  ds_read_b64_tr_b16 v[80:81], v23 offset:32
  ds_read_b64_tr_b16 v[94:95], v23 offset:64
  ds_read_b64_tr_b16 v[108:109], v23 offset:96
  ds_read_b64_tr_b16 v[68:69], v24 offset:0
  ds_read_b64_tr_b16 v[82:83], v24 offset:32
  ds_read_b64_tr_b16 v[96:97], v24 offset:64
  ds_read_b64_tr_b16 v[110:111], v24 offset:96
  ds_read_b64_tr_b16 v[124:125], v4 offset:0
  ds_read_b64_tr_b16 v[126:127], v5 offset:0
  ds_read_b64_tr_b16 v[136:137], v4 offset:32
  ds_read_b64_tr_b16 v[138:139], v5 offset:32
  ds_read_b64_tr_b16 v[148:149], v4 offset:64
  ds_read_b64_tr_b16 v[150:151], v5 offset:64
  ds_read_b64_tr_b16 v[160:161], v4 offset:96
  ds_read_b64_tr_b16 v[162:163], v5 offset:96
  ds_read_b128 v[164:167], v1 offset:39936
  ds_read_b128 v[168:171], v1 offset:40960
  ds_read_b128 v[172:175], v1 offset:8192
  ds_read_b128 v[176:179], v1 offset:6144
  ds_read_b64_tr_b16 v[70:71], v25 offset:0
  ds_read_b64_tr_b16 v[84:85], v25 offset:32
  ds_read_b64_tr_b16 v[98:99], v25 offset:64
  ds_read_b64_tr_b16 v[112:113], v25 offset:96
  ds_read_b64_tr_b16 v[72:73], v26 offset:0
  s_waitcnt lgkmcnt(14)
  v_pk_mul_f16 v120, v60, v67 op_sel:[0,0] op_sel_hi:[0,1]
  v_pk_mul_f16 v121, v60, v67 op_sel:[1,0] op_sel_hi:[1,1]
  ds_read_b64_tr_b16 v[86:87], v26 offset:32
  v_pk_mul_f16 v122, v60, v68 op_sel:[0,0] op_sel_hi:[0,1]
  ds_read_b64_tr_b16 v[100:101], v26 offset:64
  v_pk_mul_f16 v123, v60, v68 op_sel:[1,0] op_sel_hi:[1,1]
  ds_read_b64_tr_b16 v[114:115], v26 offset:96
  v_pk_mul_f16 v132, v74, v81 op_sel:[0,0] op_sel_hi:[0,1]
  v_pk_mul_f16 v133, v74, v81 op_sel:[1,0] op_sel_hi:[1,1]
  ds_read_b64_tr_b16 v[62:63], v21 offset:0
  v_pk_mul_f16 v134, v74, v82 op_sel:[0,0] op_sel_hi:[0,1]
  ds_read_b64_tr_b16 v[76:77], v21 offset:32
  v_pk_mul_f16 v135, v74, v82 op_sel:[1,0] op_sel_hi:[1,1]
  ds_read_b64_tr_b16 v[90:91], v21 offset:64
  v_pk_mul_f16 v144, v88, v95 op_sel:[0,0] op_sel_hi:[0,1]
  v_pk_mul_f16 v145, v88, v95 op_sel:[1,0] op_sel_hi:[1,1]
  ds_read_b64_tr_b16 v[104:105], v21 offset:96
  v_pk_mul_f16 v146, v88, v96 op_sel:[0,0] op_sel_hi:[0,1]
  ds_read_b64_tr_b16 v[64:65], v22 offset:0
  v_pk_mul_f16 v147, v88, v96 op_sel:[1,0] op_sel_hi:[1,1]
  ds_read_b64_tr_b16 v[78:79], v22 offset:32
  v_pk_mul_f16 v156, v102, v109 op_sel:[0,0] op_sel_hi:[0,1]
  v_pk_mul_f16 v157, v102, v109 op_sel:[1,0] op_sel_hi:[1,1]
  ds_read_b64_tr_b16 v[92:93], v22 offset:64
  v_pk_mul_f16 v158, v102, v110 op_sel:[0,0] op_sel_hi:[0,1]
  ds_read_b64_tr_b16 v[106:107], v22 offset:96
  v_pk_mul_f16 v159, v102, v110 op_sel:[1,0] op_sel_hi:[1,1]
  s_branch L_novm
L_cid:
  s_mov_b64 exec, 0x1fff
  v_mov_b32 v20, 1
  v_mov_b32 v21, 0
  v_lshlrev_b32_e64 v22, 8, v0
  s_mov_b64 exec, 1
  buffer_atomic_add v20, v21, s[64:67], 0 offen sc0
  s_mov_b32 s81, 0x60000
  s_waitcnt vmcnt(0)
  v_cmp_ne_u32 vcc, 0, v20
  s_cbranch_vccnz L_cpd
  s_mov_b64 exec, 0x1fff
  buffer_store_dword v21, v22, s[60:63], s81 offen sc1
  s_mov_b64 exec, 1
  v_mov_b32 v20, 1
  s_waitcnt vmcnt(0)
  buffer_store_dword v20, v21, s[64:67], 0 offen offset:128 sc1
L_cpd:
  buffer_load_dword v20, v21, s[64:67], 0 offen offset:128 sc1
  s_waitcnt vmcnt(0)
  v_cmp_eq_u32 vcc, 0, v20
  s_cbranch_vccnz L_cpd
  s_mov_b64 exec, -1
  s_branch L_crd
L_cic:
  s_mov_b64 exec, 0x1fff
  v_mov_b32 v20, 1
  v_mov_b32 v21, 0
  v_lshlrev_b32 v22, 8, v0
  s_mov_b64 exec, 1
  buffer_atomic_add v20, v21, s[64:67], 0 offen sc0
  s_mov_b32 s81, 0x60000
  s_waitcnt vmcnt(0)
  v_cmp_ne_u32 vcc, 0, v20
  s_cbranch_vccnz L_cpc
  s_mov_b64 exec, 0x1fff
  buffer_store_dword v21, v22, s[60:63], s81 offen sc1
  s_mov_b64 exec, 1
  v_mov_b32_e64 v20, 1
  s_waitcnt vmcnt(0)
  buffer_store_dword v20, v21, s[64:67], 0 offen offset:128 sc1
L_cpc:
  buffer_load_dword v20, v21, s[64:67], 0 offen offset:128 sc1
  s_waitcnt vmcnt(0)
  v_cmp_eq_u32 vcc, 0, v20
  s_cbranch_vccnz L_cpc
  s_mov_b64 exec, -1
  s_branch L_crc
L_spare:
  s_cmp_lg_u32 s3, 0
  s_cbranch_scc1 L_end
  s_waitcnt lgkmcnt(0)
  s_mov_b32 s60, s24
  s_and_b32 s61, s25, 0xffff
  s_mov_b32 s62, 268435456
  s_mov_b32 s63, 0x20000
  s_mov_b32 s56, s20
  s_and_b32 s57, s21, 0xffff
  s_mov_b32 s58, 8192
  s_mov_b32 s59, 0x20000
  s_mov_b32 s64, s22
  s_and_b32 s65, s23, 0xffff
  s_mov_b32 s66, 256
  s_mov_b32 s67, 0x20000
  s_mov_b64 exec, 0x1fff
  v_mov_b32 v20, 1
  v_mov_b32 v21, 0
  v_lshlrev_b32 v22, 8, v0
  s_mov_b64 exec, 1
  buffer_atomic_add v20, v21, s[64:67], 0 offen sc0
  s_mov_b32 s81, 0x60000
  s_waitcnt vmcnt(0)
  v_cmp_ne_u32 vcc, 0, v20
  s_cbranch_vccnz L_end
  s_mov_b64 exec, 0x1fff
  buffer_store_dword v21, v22, s[60:63], s81 offen sc1
  s_mov_b64 exec, 1
  v_mov_b32 v20, 1
  s_waitcnt vmcnt(0)
  buffer_store_dword v20, v21, s[64:67], 0 offen offset:128 sc1
L_end:
  s_endpgm
.p2align 8
L_tables:
.long 0x0, 0x1800, 0x6c80, 0x81a0, 0x8, 0x1808, 0x6c88, 0x81a8
.long 0x10, 0x1810, 0x6c90, 0x81b0, 0x18, 0x1818, 0x6c98, 0x81b8
.long 0x40, 0x1d48, 0x71c8, 0x86e8, 0x48, 0x1d50, 0x71d0, 0x86f0
.long 0x50, 0x1d58, 0x71d8, 0x86f8, 0x58, 0x1d60, 0x71e0, 0x8700
.long 0x80, 0x2290, 0x7710, 0x8c30, 0x88, 0x2298, 0x7718, 0x8c38
.long 0x90, 0x22a0, 0x7720, 0x8c40, 0x98, 0x22a8, 0x7728, 0x8c48
.long 0xc0, 0x27d8, 0x7c58, 0x9178, 0xc8, 0x27e0, 0x7c60, 0x9180
.long 0xd0, 0x27e8, 0x7c68, 0x9188, 0xd8, 0x27f0, 0x7c70, 0x9190
.long 0x20, 0x1820, 0x6ca0, 0x81c0, 0x28, 0x1828, 0x6ca8, 0x81c8
.long 0x30, 0x1830, 0x6cb0, 0x81d0, 0x38, 0x1838, 0x6cb8, 0x81d8
.long 0x60, 0x1d68, 0x71e8, 0x8708, 0x68, 0x1d70, 0x71f0, 0x8710
.long 0x70, 0x1d78, 0x71f8, 0x8718, 0x78, 0x1d80, 0x7200, 0x8720
.long 0xa0, 0x22b0, 0x7730, 0x8c50, 0xa8, 0x22b8, 0x7738, 0x8c58
.long 0xb0, 0x22c0, 0x7740, 0x8c60, 0xb8, 0x22c8, 0x7748, 0x8c68
.long 0xe0, 0x27f8, 0x7c78, 0x9198, 0xe8, 0x2800, 0x7c80, 0x91a0
.long 0xf0, 0x2808, 0x7c88, 0x91a8, 0xf8, 0x2810, 0x7c90, 0x91b0
.long 0x200, 0x4240, 0x96c0, 0x9c08, 0x208, 0x4248, 0x96c8, 0x9c10
.long 0x210, 0x4250, 0x96d0, 0x9c18, 0x218, 0x4258, 0x96d8, 0x9c20
.long 0x240, 0x4788, 0x9c08, 0x9c08, 0x248, 0x4790, 0x9c10, 0x9c10
.long 0x250, 0x4798, 0x9c18, 0x9c18, 0x258, 0x47a0, 0x9c20, 0x9c20
.long 0x280, 0x4cd0, 0x9c08, 0x9c08, 0x288, 0x4cd8, 0x9c10, 0x9c10
.long 0x290, 0x4ce0, 0x9c18, 0x9c18, 0x298, 0x4ce8, 0x9c20, 0x9c20
.long 0x2c0, 0x5218, 0x9c08, 0x9c08, 0x2c8, 0x5220, 0x9c10, 0x9c10
.long 0x2d0, 0x5228, 0x9c18, 0x9c18, 0x2d8, 0x5230, 0x9c20, 0x9c20
.long 0x220, 0x4260, 0x96e0, 0x9c28, 0x228, 0x4268, 0x96e8, 0x9c30
.long 0x230, 0x4270, 0x96f0, 0x9c38, 0x238, 0x4278, 0x96f8, 0x9c40
.long 0x260, 0x47a8, 0x9c28, 0x9c28, 0x268, 0x47b0, 0x9c30, 0x9c30
.long 0x270, 0x47b8, 0x9c38, 0x9c38, 0x278, 0x47c0, 0x9c40, 0x9c40
.long 0x2a0, 0x4cf0, 0x9c28, 0x9c28, 0x2a8, 0x4cf8, 0x9c30, 0x9c30
.long 0x2b0, 0x4d00, 0x9c38, 0x9c38, 0x2b8, 0x4d08, 0x9c40, 0x9c40
.long 0x2e0, 0x5238, 0x9c28, 0x9c28, 0x2e8, 0x5240, 0x9c30, 0x9c30
.long 0x2f0, 0x5248, 0x9c38, 0x9c38, 0x2f8, 0x5250, 0x9c40, 0x9c40
.long 0xaae0, 0xa680, 0xa900, 0xaae0, 0xaae8, 0xa688, 0xa908, 0xaae8
.long 0xaaf0, 0xa690, 0xa910, 0xaaf0, 0xaaf8, 0xa698, 0xa918, 0xaaf8
.long 0xaa40, 0xa860, 0xa9a0, 0xaa40, 0xaa48, 0xa868, 0xa9a8, 0xaa48
.long 0xaa50, 0xa870, 0xa9b0, 0xaa50, 0xaa58, 0xa878, 0xa9b8, 0xaa58
.long 0xa400, 0xa7c0, 0xa540, 0xa400, 0xa408, 0xa7c8, 0xa548, 0xa408
.long 0xa410, 0xa7d0, 0xa550, 0xa410, 0xa418, 0xa7d8, 0xa558, 0xa418
.long 0xa4a0, 0xa720, 0xa5e0, 0xa4a0, 0xa4a8, 0xa728, 0xa5e8, 0xa4a8
.long 0xa4b0, 0xa730, 0xa5f0, 0xa4b0, 0xa4b8, 0xa738, 0xa5f8, 0xa4b8
.long 0xb260, 0xb4e0, 0xb6c0, 0xb260, 0xb268, 0xb4e8, 0xb6c8, 0xb268
.long 0xb270, 0xb4f0, 0xb6d0, 0xb270, 0xb278, 0xb4f8, 0xb6d8, 0xb278
.long 0xb1c0, 0xb300, 0xb760, 0xb1c0, 0xb1c8, 0xb308, 0xb768, 0xb1c8
.long 0xb1d0, 0xb310, 0xb770, 0xb1d0, 0xb1d8, 0xb318, 0xb778, 0xb1d8
.long 0xb580, 0xb440, 0xb080, 0xb580, 0xb588, 0xb448, 0xb088, 0xb588
.long 0xb590, 0xb450, 0xb090, 0xb590, 0xb598, 0xb458, 0xb098, 0xb598
.long 0xb620, 0xb3a0, 0xb120, 0xb620, 0xb628, 0xb3a8, 0xb128, 0xb628
.long 0xb630, 0xb3b0, 0xb130, 0xb630, 0xb638, 0xb3b8, 0xb138, 0xb638
.long 0xa900, 0xa400, 0xaae0, 0xb620, 0xa908, 0xa408, 0xaae8, 0xb628
.long 0xa910, 0xa410, 0xaaf0, 0xb630, 0xa918, 0xa418, 0xaaf8, 0xb638
.long 0xa9a0, 0xa4a0, 0xab80, 0xb800, 0xa9a8, 0xa4a8, 0xab88, 0xb808
.long 0xa9b0, 0xa4b0, 0xab90, 0xb810, 0xa9b8, 0xa4b8, 0xab98, 0xb818
.long 0xaa40, 0xa680, 0xa860, 0xb3a0, 0xaa48, 0xa688, 0xa868, 0xb3a8
.long 0xaa50, 0xa690, 0xa870, 0xb3b0, 0xaa58, 0xa698, 0xa878, 0xb3b8
.long 0xa720, 0xa540, 0xa7c0, 0xb1c0, 0xa728, 0xa548, 0xa7c8, 0xb1c8
.long 0xa730, 0xa550, 0xa7d0, 0xb1d0, 0xa738, 0xa558, 0xa7d8, 0xb1d8
.long 0xa5e0, 0xaae0, 0xa400, 0xb080, 0xa5e8, 0xaae8, 0xa408, 0xb088
.long 0xa5f0, 0xaaf0, 0xa410, 0xb090, 0xa5f8, 0xaaf8, 0xa418, 0xb098
.long 0xa7c0, 0xa540, 0xa720, 0xb760, 0xa7c8, 0xa548, 0xa728, 0xb768
.long 0xa7d0, 0xa550, 0xa730, 0xb770, 0xa7d8, 0xa558, 0xa738, 0xb778
.long 0xa860, 0xa680, 0xaa40, 0xb440, 0xa868, 0xa688, 0xaa48, 0xb448
.long 0xa870, 0xa690, 0xaa50, 0xb450, 0xa878, 0xa698, 0xaa58, 0xb458
.long 0xab80, 0xa4a0, 0xa9a0, 0xb4e0, 0xab88, 0xa4a8, 0xa9a8, 0xb4e8
.long 0xab90, 0xa4b0, 0xa9b0, 0xb4f0, 0xab98, 0xa4b8, 0xa9b8, 0xb4f8
.long 0xa680, 0xa900, 0xab80, 0xa4a0, 0xa688, 0xa908, 0xab88, 0xa4a8
.long 0xa690, 0xa910, 0xab90, 0xa4b0, 0xa698, 0xa918, 0xab98, 0xa4b8
.long 0xa860, 0xa9a0, 0xb1c0, 0xb440, 0xa868, 0xa9a8, 0xb1c8, 0xb448
.long 0xa870, 0xa9b0, 0xb1d0, 0xb450, 0xa878, 0xa9b8, 0xb1d8, 0xb458
.long 0xa7c0, 0xa540, 0xab80, 0xa4a0, 0xa7c8, 0xa548, 0xab88, 0xa4a8
.long 0xa7d0, 0xa550, 0xab90, 0xa4b0, 0xa7d8, 0xa558, 0xab98, 0xa4b8
.long 0xa720, 0xa5e0, 0xb1c0, 0xb440, 0xa728, 0xa5e8, 0xb1c8, 0xb448
.long 0xa730, 0xa5f0, 0xb1d0, 0xb450, 0xa738, 0xa5f8, 0xb1d8, 0xb458
.long 0xb4e0, 0xb6c0, 0xb800, 0xa860, 0xb4e8, 0xb6c8, 0xb808, 0xa868
.long 0xb4f0, 0xb6d0, 0xb810, 0xa870, 0xb4f8, 0xb6d8, 0xb818, 0xa878
.long 0xb300, 0xb760, 0xa540, 0xa900, 0xb308, 0xb768, 0xa548, 0xa908
.long 0xb310, 0xb770, 0xa550, 0xa910, 0xb318, 0xb778, 0xa558, 0xa918
.long 0xb440, 0xb080, 0xb800, 0xa860, 0xb448, 0xb088, 0xb808, 0xa868
.long 0xb450, 0xb090, 0xb810, 0xa870, 0xb458, 0xb098, 0xb818, 0xa878
.long 0xb3a0, 0xb120, 0xa540, 0xa900, 0xb3a8, 0xb128, 0xa548, 0xa908
.long 0xb3b0, 0xb130, 0xa550, 0xa910, 0xb3b8, 0xb138, 0xa558, 0xa918
.long 0xb120, 0xb580, 0xb080, 0xb300, 0xb128, 0xb588, 0xb088, 0xb308
.long 0xb130, 0xb590, 0xb090, 0xb310, 0xb138, 0xb598, 0xb098, 0xb318
.long 0xb6c0, 0xb4e0, 0xaa40, 0xb6c0, 0xb6c8, 0xb4e8, 0xaa48, 0xb6c8
.long 0xb6d0, 0xb4f0, 0xaa50, 0xb6d0, 0xb6d8, 0xb4f8, 0xaa58, 0xb6d8
.long 0xb300, 0xb440, 0xb080, 0xb300, 0xb308, 0xb448, 0xb088, 0xb308
.long 0xb310, 0xb450, 0xb090, 0xb310, 0xb318, 0xb458, 0xb098, 0xb318
.long 0xb260, 0xb760, 0xaa40, 0xb6c0, 0xb268, 0xb768, 0xaa48, 0xb6c8
.long 0xb270, 0xb770, 0xaa50, 0xb6d0, 0xb278, 0xb778, 0xaa58, 0xb6d8
.long 0xb580, 0xb120, 0xb620, 0xa680, 0xb588, 0xb128, 0xb628, 0xa688
.long 0xb590, 0xb130, 0xb630, 0xa690, 0xb598, 0xb138, 0xb638, 0xa698
.long 0xb260, 0xb1c0, 0xa7c0, 0xa680, 0xb268, 0xb1c8, 0xa7c8, 0xa688
.long 0xb270, 0xb1d0, 0xa7d0, 0xa690, 0xb278, 0xb1d8, 0xa7d8, 0xa698
.long 0xb300, 0xb3a0, 0xb620, 0xb300, 0xb308, 0xb3a8, 0xb628, 0xb308
.long 0xb310, 0xb3b0, 0xb630, 0xb310, 0xb318, 0xb3b8, 0xb638, 0xb318
.long 0xb6c0, 0xb800, 0xa7c0, 0xb300, 0xb6c8, 0xb808, 0xa7c8, 0xb308
.long 0xb6d0, 0xb810, 0xa7d0, 0xb310, 0xb6d8, 0xb818, 0xa7d8, 0xb318
.long 0x0, 0x200, 0x0, 0x3f803f80, 0x8, 0x208, 0x0, 0x3f803f80
.long 0x10, 0x210, 0x0, 0x3f803f80, 0x18, 0x218, 0x0, 0x3f803f80
.long 0x420, 0x620, 0x0, 0x3f803f80, 0x428, 0x628, 0x0, 0x3f803f80
.long 0x430, 0x630, 0x0, 0x3f803f80, 0x438, 0x638, 0x0, 0x3f803f80
.long 0x840, 0xa40, 0x10, 0x3f803f80, 0x848, 0xa48, 0x10, 0x3f803f80
.long 0x850, 0xa50, 0x10, 0x3f803f80, 0x858, 0xa58, 0x10, 0x3f803f80
.long 0xc60, 0xe60, 0x10, 0x3f803f80, 0xc68, 0xe68, 0x10, 0x3f803f80
.long 0xc70, 0xe70, 0x10, 0x3f803f80, 0xc78, 0xe78, 0x10, 0x3f803f80
.long 0x80, 0x280, 0x20, 0x3f803f80, 0x88, 0x288, 0x20, 0x3f803f80
.long 0x90, 0x290, 0x20, 0x3f803f80, 0x98, 0x298, 0x20, 0x3f803f80
.long 0x4a0, 0x6a0, 0x20, 0x3f803f80, 0x4a8, 0x6a8, 0x20, 0x3f803f80
.long 0x4b0, 0x6b0, 0x20, 0x3f803f80, 0x4b8, 0x6b8, 0x20, 0x3f803f80
.long 0x8c0, 0xac0, 0x30, 0x3f803f80, 0x8c8, 0xac8, 0x30, 0x3f803f80
.long 0x8d0, 0xad0, 0x30, 0x3f803f80, 0x8d8, 0xad8, 0x30, 0x3f803f80
.long 0xce0, 0xee0, 0x30, 0x3f803f80, 0xce8, 0xee8, 0x30, 0x3f803f80
.long 0xcf0, 0xef0, 0x30, 0x3f803f80, 0xcf8, 0xef8, 0x30, 0x3f803f80
.long 0x100, 0x300, 0x40, 0x0, 0x108, 0x308, 0x40, 0x0
.long 0x110, 0x310, 0x40, 0x0, 0x118, 0x318, 0x40, 0x0
.long 0x520, 0x720, 0x40, 0x0, 0x528, 0x728, 0x40, 0x0
.long 0x530, 0x730, 0x40, 0x0, 0x538, 0x738, 0x40, 0x0
.long 0x940, 0xb40, 0x50, 0x0, 0x948, 0xb48, 0x50, 0x0
.long 0x950, 0xb50, 0x50, 0x0, 0x958, 0xb58, 0x50, 0x0
.long 0xd60, 0xf60, 0x50, 0x0, 0xd68, 0xf68, 0x50, 0x0
.long 0xd70, 0xf70, 0x50, 0x0, 0xd78, 0xf78, 0x50, 0x0
.long 0x180, 0xf60, 0x60, 0x0, 0x188, 0xf68, 0x60, 0x0
.long 0x190, 0xf70, 0x60, 0x0, 0x198, 0xf78, 0x60, 0x0
.long 0x5a0, 0xf60, 0x60, 0x0, 0x5a8, 0xf68, 0x60, 0x0
.long 0x5b0, 0xf70, 0x60, 0x0, 0x5b8, 0xf78, 0x60, 0x0
.long 0x9c0, 0xf60, 0x70, 0x0, 0x9c8, 0xf68, 0x70, 0x0
.long 0x9d0, 0xf70, 0x70, 0x0, 0x9d8, 0xf78, 0x70, 0x0
.long 0xde0, 0xf60, 0x70, 0x0, 0xde8, 0xf68, 0x70, 0x0
.long 0xdf0, 0xf70, 0x70, 0x0, 0xdf8, 0xf78, 0x70, 0x0
.long 0xffff, 0x0, 0x0, 0x0, 0x0, 0x0, 0xffff, 0x0
.long 0x0, 0x0, 0x0, 0x0, 0x0, 0x0, 0x0, 0x0
.long 0x0, 0x0, 0x0, 0x0, 0x0, 0x0, 0x0, 0x0
.long 0x0, 0x0, 0x0, 0x0, 0x0, 0x0, 0x0, 0x0
.long 0xffff0000, 0x0, 0x0, 0x0, 0x0, 0x0, 0xffff0000, 0x0
.long 0x0, 0x0, 0x0, 0x0, 0x0, 0x0, 0x0, 0x0
.long 0x0, 0x0, 0x0, 0x0, 0x0, 0x0, 0x0, 0x0
.long 0x0, 0x0, 0x0, 0x0, 0x0, 0x0, 0x0, 0x0
.long 0x0, 0xffff, 0x0, 0x0, 0x0, 0x0, 0x0, 0xffff
.long 0x0, 0x0, 0x0, 0x0, 0x0, 0x0, 0x0, 0x0
.long 0x0, 0x0, 0x0, 0x0, 0x0, 0x0, 0x0, 0x0
.long 0x0, 0x0, 0x0, 0x0, 0x0, 0x0, 0x0, 0x0
.long 0x0, 0xffff0000, 0x0, 0x0, 0x0, 0x0, 0x0, 0xffff0000
.long 0x0, 0x0, 0x0, 0x0, 0x0, 0x0, 0x0, 0x0
.long 0x0, 0x0, 0x0, 0x0, 0x0, 0x0, 0x0, 0x0
.long 0x0, 0x0, 0x0, 0x0, 0x0, 0x0, 0x0, 0x0
.long 0x0, 0x0, 0x0, 0x0, 0x0, 0x0, 0x0, 0x0
.long 0xffff, 0x0, 0x0, 0x0, 0x0, 0x0, 0xffff, 0x0
.long 0x0, 0x0, 0x0, 0x0, 0x0, 0x0, 0x0, 0x0
.long 0x0, 0x0, 0x0, 0x0, 0x0, 0x0, 0x0, 0x0
.long 0x0, 0x0, 0x0, 0x0, 0x0, 0x0, 0x0, 0x0
.long 0xffff0000, 0x0, 0x0, 0x0, 0x0, 0x0, 0xffff0000, 0x0
.long 0x0, 0x0, 0x0, 0x0, 0x0, 0x0, 0x0, 0x0
.long 0x0, 0x0, 0x0, 0x0, 0x0, 0x0, 0x0, 0x0
.long 0x0, 0x0, 0x0, 0x0, 0x0, 0x0, 0x0, 0x0
.long 0x0, 0xffff, 0x0, 0x0, 0x0, 0x0, 0x0, 0xffff
.long 0x0, 0x0, 0x0, 0x0, 0x0, 0x0, 0x0, 0x0
.long 0x0, 0x0, 0x0, 0x0, 0x0, 0x0, 0x0, 0x0
.long 0x0, 0x0, 0x0, 0x0, 0x0, 0x0, 0x0, 0x0
.long 0x0, 0xffff0000, 0x0, 0x0, 0x0, 0x0, 0x0, 0xffff0000
.long 0x0, 0x0, 0x0, 0x0, 0x0, 0x0, 0x0, 0x0
.long 0x0, 0x0, 0x0, 0x0, 0x0, 0x0, 0x0, 0x0
.long 0x0, 0x0, 0x0, 0x0, 0x0, 0x0, 0x0, 0x0
.long 0x0, 0x0, 0x0, 0x0, 0x0, 0x0, 0x0, 0x0
.long 0x0, 0x0, 0xffff, 0x0, 0x0, 0x0, 0x0, 0x0
.long 0x0, 0x0, 0x0, 0x0, 0xffff, 0x0, 0x0, 0x0
.long 0x0, 0x0, 0x0, 0x0, 0x0, 0x0, 0x0, 0x0
.long 0x0, 0x0, 0x0, 0x0, 0x0, 0x0, 0x0, 0x0
.long 0x0, 0x0, 0xffff0000, 0x0, 0x0, 0x0, 0x0, 0x0
.long 0x0, 0x0, 0x0, 0x0, 0xffff0000, 0x0, 0x0, 0x0
.long 0x0, 0x0, 0x0, 0x0, 0x0, 0x0, 0x0, 0x0
.long 0x0, 0x0, 0x0, 0x0, 0x0, 0x0, 0x0, 0x0
.long 0x0, 0x0, 0x0, 0xffff, 0x0, 0x0, 0x0, 0x0
.long 0x0, 0x0, 0x0, 0x0, 0x0, 0xffff, 0x0, 0x0
.long 0x0, 0x0, 0x0, 0x0, 0x0, 0x0, 0x0, 0x0
.long 0x0, 0x0, 0x0, 0x0, 0x0, 0x0, 0x0, 0x0
.long 0x0, 0x0, 0x0, 0xffff0000, 0x0, 0x0, 0x0, 0x0
.long 0x0, 0x0, 0x0, 0x0, 0x0, 0xffff0000, 0x0, 0x0
.long 0x0, 0x0, 0x0, 0x0, 0x0, 0x0, 0x0, 0x0
.long 0x0, 0x0, 0x0, 0x0, 0x0, 0x0, 0x0, 0x0
.long 0x0, 0x0, 0x0, 0x0, 0xffff, 0x0, 0x0, 0x0
.long 0x0, 0x0, 0x0, 0x0, 0x0, 0x0, 0x0, 0x0
.long 0x0, 0x0, 0x0, 0x0, 0x0, 0x0, 0x0, 0x0
.long 0x0, 0x0, 0x0, 0x0, 0x0, 0x0, 0x0, 0x0
.long 0x0, 0x0, 0x0, 0x0, 0xffff0000, 0x0, 0x0, 0x0
.long 0x0, 0x0, 0x0, 0x0, 0x0, 0x0, 0x0, 0x0
.long 0x0, 0x0, 0x0, 0x0, 0x0, 0x0, 0x0, 0x0
.long 0x0, 0x0, 0x0, 0x0, 0x0, 0x0, 0x0, 0x0
.long 0x0, 0x0, 0x0, 0x0, 0x0, 0x0, 0x0, 0x0
.long 0x0, 0x0, 0x0, 0x0, 0x0, 0x0, 0x0, 0x0
.long 0x0, 0x0, 0x0, 0x0, 0x0, 0x0, 0x0, 0x0
.long 0x0, 0x0, 0x0, 0x0, 0x0, 0x0, 0x0, 0x0
.long 0x0, 0x0, 0x0, 0x0, 0x0, 0x0, 0x0, 0x0
.long 0x0, 0x0, 0x0, 0x0, 0x0, 0x0, 0x0, 0x0
.long 0x14d40, 0x14d40, 0x0, 0x0, 0x14e10, 0x14e10, 0x20, 0x20
.long 0x14ee0, 0x14ee0, 0x100000, 0x100000, 0x14fb0, 0x14fb0, 0x100020, 0x100020
.long 0x15080, 0x15080, 0x40, 0x40, 0x15150, 0x15150, 0x60, 0x60
.long 0x15220, 0x15220, 0x100040, 0x100040, 0x100000, 0x100000, 0x100060, 0x100060
.long 0x14d74, 0x14d74, 0x80, 0x80, 0x14e44, 0x14e44, 0xa0, 0xa0
.long 0x14f14, 0x14f14, 0x100080, 0x100080, 0x14fe4, 0x14fe4, 0x1000a0, 0x1000a0
.long 0x150b4, 0x150b4, 0xc0, 0xc0, 0x15184, 0x15184, 0xe0, 0xe0
.long 0x15254, 0x15254, 0x1000c0, 0x1000c0, 0x100000, 0x100000, 0x1000e0, 0x1000e0
.long 0x14da8, 0x14da8, 0x8, 0x100, 0x14e78, 0x14e78, 0x28, 0x120
.long 0x14f48, 0x14f48, 0x100008, 0x100100, 0x15018, 0x15018, 0x100028, 0x100120
.long 0x150e8, 0x150e8, 0x48, 0x140, 0x151b8, 0x151b8, 0x68, 0x160
.long 0x100000, 0x100000, 0x100048, 0x100140, 0x100000, 0x100000, 0x100068, 0x100160
.long 0x14ddc, 0x14ddc, 0x88, 0x180, 0x14eac, 0x14eac, 0xa8, 0x1a0
.long 0x14f7c, 0x14f7c, 0x100088, 0x100180, 0x1504c, 0x1504c, 0x1000a8, 0x1001a0
.long 0x1511c, 0x1511c, 0xc8, 0x1c0, 0x151ec, 0x151ec, 0xe8, 0x1e0
.long 0x100000, 0x100000, 0x1000c8, 0x1001c0, 0x100000, 0x100000, 0x1000e8, 0x1001e0
.long 0x17d40, 0x114d40, 0x100, 0x200, 0x17e10, 0x114e10, 0x120, 0x220
.long 0x17ee0, 0x114ee0, 0x100100, 0x100200, 0x17fb0, 0x114fb0, 0x100120, 0x100220
.long 0x18080, 0x115080, 0x140, 0x240, 0x18150, 0x115150, 0x160, 0x260
.long 0x18220, 0x115220, 0x100140, 0x100240, 0x103000, 0x200000, 0x100160, 0x100260
.long 0x17d74, 0x114d74, 0x180, 0x280, 0x17e44, 0x114e44, 0x1a0, 0x2a0
.long 0x17f14, 0x114f14, 0x100180, 0x100280, 0x17fe4, 0x114fe4, 0x1001a0, 0x1002a0
.long 0x180b4, 0x1150b4, 0x1c0, 0x2c0, 0x18184, 0x115184, 0x1e0, 0x2e0
.long 0x18254, 0x115254, 0x1001c0, 0x1002c0, 0x103000, 0x200000, 0x1001e0, 0x1002e0
.long 0x17da8, 0x114da8, 0x108, 0x300, 0x17e78, 0x114e78, 0x128, 0x320
.long 0x17f48, 0x114f48, 0x100108, 0x100300, 0x18018, 0x115018, 0x100128, 0x100320
.long 0x180e8, 0x1150e8, 0x148, 0x340, 0x181b8, 0x1151b8, 0x168, 0x360
.long 0x103000, 0x200000, 0x100148, 0x100340, 0x103000, 0x200000, 0x100168, 0x100360
.long 0x17ddc, 0x114ddc, 0x188, 0x380, 0x17eac, 0x114eac, 0x1a8, 0x3a0
.long 0x17f7c, 0x114f7c, 0x100188, 0x100380, 0x1804c, 0x11504c, 0x1001a8, 0x1003a0
.long 0x1811c, 0x11511c, 0x1c8, 0x3c0, 0x181ec, 0x1151ec, 0x1e8, 0x3e0
.long 0x103000, 0x200000, 0x1001c8, 0x1003c0, 0x103000, 0x200000, 0x1001e8, 0x1003e0
.long 0xa400, 0xd00, 0x0, 0x14d40, 0xa440, 0xd00, 0x0, 0x14d80
.long 0xa480, 0xd00, 0x1, 0x14dd0, 0xa4c0, 0xd00, 0x1, 0x14e10
.long 0xa500, 0xd00, 0x2, 0x14e60, 0xa540, 0xd00, 0x2, 0x14ea0
.long 0xa580, 0xd00, 0x3, 0x14ef0, 0xa5c0, 0xd00, 0x3, 0x14f30
.long 0xa600, 0xd00, 0x4, 0x14f40, 0xa640, 0xd00, 0x4, 0x14f80
.long 0xa680, 0xd00, 0x5, 0x14fd0, 0xa6c0, 0xd00, 0x5, 0x15010
.long 0xa700, 0xd00, 0x6, 0x15060, 0xa740, 0xd00, 0x6, 0x150a0
.long 0xa780, 0xd00, 0x7, 0x150f0, 0xa7c0, 0xd00, 0x7, 0x15130
.long 0xa800, 0xd00, 0x8, 0x15140, 0xa840, 0xd00, 0x8, 0x15180
.long 0xa880, 0xd00, 0x9, 0x151d0, 0xa8c0, 0xd00, 0x9, 0x15210
.long 0xa900, 0xd00, 0xa, 0x15260, 0xa940, 0xd00, 0xa, 0x152a0
.long 0xa980, 0xd00, 0xb, 0x152f0, 0xa9c0, 0xd00, 0xb, 0x15330
.long 0xaa00, 0xd00, 0xc, 0x15340, 0xaa40, 0xd00, 0xc, 0x15380
.long 0x1f680, 0x40, 0xd, 0x153d0, 0x100000, 0xd00, 0xd, 0x15410
.long 0x100000, 0xd00, 0xe, 0x15460, 0x100000, 0xd00, 0xe, 0x154a0
.long 0x100000, 0xd00, 0xf, 0x154f0, 0x100000, 0xd00, 0xf, 0x15530
.long 0xa400, 0xd00, 0x2, 0x14d60, 0xa440, 0xd00, 0x2, 0x14da0
.long 0xa480, 0xd00, 0x3, 0x14df0, 0xa4c0, 0xd00, 0x3, 0x14e30
.long 0xa500, 0xd00, 0x4, 0x14e40, 0xa540, 0xd00, 0x4, 0x14e80
.long 0xa580, 0xd00, 0x5, 0x14ed0, 0xa5c0, 0xd00, 0x5, 0x14f10
.long 0xa600, 0xd00, 0x6, 0x14f60, 0xa640, 0xd00, 0x6, 0x14fa0
.long 0xa680, 0xd00, 0x7, 0x14ff0, 0xa6c0, 0xd00, 0x7, 0x15030
.long 0xa700, 0xd00, 0x8, 0x15040, 0xa740, 0xd00, 0x8, 0x15080
.long 0xa780, 0xd00, 0x9, 0x150d0, 0xa7c0, 0xd00, 0x9, 0x15110
.long 0xa800, 0xd00, 0xa, 0x15160, 0xa840, 0xd00, 0xa, 0x151a0
.long 0xa880, 0xd00, 0xb, 0x151f0, 0xa8c0, 0xd00, 0xb, 0x15230
.long 0xa900, 0xd00, 0xc, 0x15240, 0xa940, 0xd00, 0xc, 0x15280
.long 0xa980, 0xd00, 0xd, 0x152d0, 0xa9c0, 0xd00, 0xd, 0x15310
.long 0xaa00, 0xd00, 0xe, 0x15360, 0xaa40, 0xd00, 0xe, 0x153a0
.long 0x1f680, 0x40, 0xf, 0x153f0, 0x100000, 0xd00, 0xf, 0x15430
.long 0x100000, 0xd00, 0x10, 0x15440, 0x100000, 0xd00, 0x10, 0x15480
.long 0x100000, 0xd00, 0x11, 0x154d0, 0x100000, 0xd00, 0x11, 0x15510
.long 0x1f690, 0x1f890, 0x1f9c0, 0x1f9e0, 0x1f698, 0x1f898, 0x1f9c8, 0x1f9e8
.long 0x1f680, 0x1f880, 0x1f9d0, 0x1f9f0, 0x1f688, 0x1f888, 0x1f9d8, 0x100000
.long 0x1fd20, 0x1ff20, 0x1f9c2, 0x1f9e2, 0x1fd28, 0x1ff28, 0x1f9ca, 0x1f9ea
.long 0x1fd30, 0x1ff30, 0x1f9d2, 0x1f9f2, 0x1fd38, 0x1ff38, 0x1f9da, 0x100000
.long 0x1f6f0, 0x1f8f0, 0x1f9c4, 0x1f9e4, 0x1f6f8, 0x1f8f8, 0x1f9cc, 0x1f9ec
.long 0x1f6e0, 0x1f8e0, 0x1f9d4, 0x100000, 0x1f6e8, 0x1f8e8, 0x1f9dc, 0x100000
.long 0x1fd40, 0x1ff40, 0x1f9c6, 0x1f9e6, 0x1fd48, 0x1ff48, 0x1f9ce, 0x1f9ee
.long 0x1fd50, 0x1ff50, 0x1f9d6, 0x100000, 0x1fd58, 0x1ff58, 0x1f9de, 0x100000
.long 0x1f710, 0x1f910, 0x1f9c0, 0x1f9e0, 0x1f718, 0x1f918, 0x1f9c8, 0x1f9e8
.long 0x1f700, 0x1f900, 0x1f9d0, 0x1f9f0, 0x1f708, 0x1f908, 0x1f9d8, 0x100000
.long 0x1fda0, 0x1ffa0, 0x1f9c2, 0x1f9e2, 0x1fda8, 0x1ffa8, 0x1f9ca, 0x1f9ea
.long 0x1fdb0, 0x1ffb0, 0x1f9d2, 0x1f9f2, 0x1fdb8, 0x1ffb8, 0x1f9da, 0x100000
.long 0x1f770, 0x1f970, 0x1f9c4, 0x1f9e4, 0x1f778, 0x1f978, 0x1f9cc, 0x1f9ec
.long 0x1f760, 0x1f960, 0x1f9d4, 0x100000, 0x1f768, 0x1f968, 0x1f9dc, 0x100000
.long 0x1fdc0, 0x1ffc0, 0x1f9c6, 0x1f9e6, 0x1fdc8, 0x1ffc8, 0x1f9ce, 0x1f9ee
.long 0x1fdd0, 0x1ffd0, 0x1f9d6, 0x100000, 0x1fdd8, 0x1ffd8, 0x1f9de, 0x100000
.long 0x1f790, 0x1f990, 0x1f9c0, 0x1f9e0, 0x1f798, 0x1f998, 0x1f9c8, 0x1f9e8
.long 0x1f780, 0x1f980, 0x1f9d0, 0x1f9f0, 0x1f788, 0x1f988, 0x1f9d8, 0x100000
.long 0x1fe20, 0x20020, 0x1f9c2, 0x1f9e2, 0x1fe28, 0x20028, 0x1f9ca, 0x1f9ea
.long 0x1fe30, 0x20030, 0x1f9d2, 0x1f9f2, 0x1fe38, 0x20038, 0x1f9da, 0x100000
.long 0x1f7f0, 0x14d00, 0x1f9c4, 0x1f9e4, 0x1f7f8, 0x14d08, 0x1f9cc, 0x1f9ec
.long 0x1f7e0, 0x14d10, 0x1f9d4, 0x100000, 0x1f7e8, 0x14d18, 0x1f9dc, 0x100000
.long 0x1fe40, 0x14d00, 0x1f9c6, 0x1f9e6, 0x1fe48, 0x14d08, 0x1f9ce, 0x1f9ee
.long 0x1fe50, 0x14d10, 0x1f9d6, 0x100000, 0x1fe58, 0x14d18, 0x1f9de, 0x100000
.long 0x1f810, 0x14d00, 0x1f9c0, 0x1f9e0, 0x1f818, 0x14d08, 0x1f9c8, 0x1f9e8
.long 0x1f800, 0x14d10, 0x1f9d0, 0x1f9f0, 0x1f808, 0x14d18, 0x1f9d8, 0x100000
.long 0x1fea0, 0x14d00, 0x1f9c2, 0x1f9e2, 0x1fea8, 0x14d08, 0x1f9ca, 0x1f9ea
.long 0x1feb0, 0x14d10, 0x1f9d2, 0x1f9f2, 0x1feb8, 0x14d18, 0x1f9da, 0x100000
.long 0x1f870, 0x14d00, 0x1f9c4, 0x1f9e4, 0x1f878, 0x14d08, 0x1f9cc, 0x1f9ec
.long 0x1f860, 0x14d10, 0x1f9d4, 0x100000, 0x1f868, 0x14d18, 0x1f9dc, 0x100000
.long 0x1fec0, 0x14d00, 0x1f9c6, 0x1f9e6, 0x1fec8, 0x14d08, 0x1f9ce, 0x1f9ee
.long 0x1fed0, 0x14d10, 0x1f9d6, 0x100000, 0x1fed8, 0x14d18, 0x1f9de, 0x100000
.long 0x0, 0x4444, 0x0, 0xa400, 0x10, 0xeeee, 0x4, 0xa404
.long 0x20, 0x4444, 0x8, 0xa408, 0x30, 0xeeee, 0xc, 0xa40c
.long 0x40, 0x4444, 0x10, 0xa410, 0x50, 0xeeee, 0x14, 0xa414
.long 0x60, 0x4444, 0x18, 0xa418, 0x70, 0xeeee, 0x1c, 0xa41c
.long 0x0, 0x4444, 0x20, 0xa420, 0x10, 0xeeee, 0x24, 0xa424
.long 0x20, 0x4444, 0x28, 0xa428, 0x30, 0xeeee, 0x2c, 0xa42c
.long 0x40, 0x4444, 0x30, 0xa430, 0x50, 0xeeee, 0x34, 0xa434
.long 0x60, 0x4444, 0x38, 0xa438, 0x70, 0xeeee, 0x3c, 0xa43c
.long 0x0, 0x4444, 0x40, 0xa440, 0x10, 0xeeee, 0x44, 0xa444
.long 0x20, 0x4444, 0x48, 0xa448, 0x30, 0xeeee, 0x4c, 0xa44c
.long 0x40, 0x4444, 0x50, 0xa450, 0x50, 0xeeee, 0x54, 0xa454
.long 0x60, 0x4444, 0x58, 0xa458, 0x70, 0xeeee, 0x5c, 0xa45c
.long 0x0, 0x4444, 0x60, 0xa460, 0x10, 0xeeee, 0x64, 0xa464
.long 0x20, 0x4444, 0x68, 0xa468, 0x30, 0xeeee, 0x6c, 0xa46c
.long 0x40, 0x4444, 0x70, 0xa470, 0x50, 0xeeee, 0x74, 0xa474
.long 0x60, 0x4444, 0x78, 0xa478, 0x70, 0xeeee, 0x7c, 0xa47c
.long 0x0, 0x4444, 0x420, 0xb080, 0x10, 0xeeee, 0x424, 0xb084
.long 0x20, 0x4444, 0x428, 0xb088, 0x30, 0xeeee, 0x42c, 0xb08c
.long 0x40, 0x4444, 0x430, 0xb090, 0x50, 0xeeee, 0x434, 0xb094
.long 0x60, 0x4444, 0x438, 0xb098, 0x70, 0xeeee, 0x43c, 0xb09c
.long 0x0, 0x4444, 0x440, 0xb0a0, 0x10, 0xeeee, 0x444, 0xb0a4
.long 0x20, 0x4444, 0x448, 0xb0a8, 0x30, 0xeeee, 0x44c, 0xb0ac
.long 0x40, 0x4444, 0x450, 0xb0b0, 0x50, 0xeeee, 0x454, 0xb0b4
.long 0x60, 0x4444, 0x458, 0xb0b8, 0x70, 0xeeee, 0x45c, 0xb0bc
.long 0x0, 0x4444, 0x460, 0xb0c0, 0x10, 0xeeee, 0x464, 0xb0c4
.long 0x20, 0x4444, 0x468, 0xb0c8, 0x30, 0xeeee, 0x46c, 0xb0cc
.long 0x40, 0x4444, 0x470, 0xb0d0, 0x50, 0xeeee, 0x474, 0xb0d4
.long 0x60, 0x4444, 0x478, 0xb0d8, 0x70, 0xeeee, 0x47c, 0xb0dc
.long 0x0, 0x4444, 0x480, 0xb0e0, 0x10, 0xeeee, 0x484, 0xb0e4
.long 0x20, 0x4444, 0x488, 0xb0e8, 0x30, 0xeeee, 0x48c, 0xb0ec
.long 0x40, 0x4444, 0x490, 0xb0f0, 0x50, 0xeeee, 0x494, 0xb0f4
.long 0x60, 0x4444, 0x498, 0xb0f8, 0x70, 0xeeee, 0x49c, 0xb0fc
.long 0x1fa28, 0x1f9f4, 0x34, 0x14d00, 0x1fa28, 0x1f9f6, 0x74, 0x14d04
.long 0x1fa28, 0x1f9f8, 0xb4, 0x14d08, 0x1fa28, 0x1f9fa, 0xf4, 0x14d0c
.long 0x1fa28, 0x1f9fc, 0x134, 0x14d10, 0x1fa28, 0x1f9fe, 0x174, 0x14d14
.long 0x1fa28, 0x1fa00, 0x1b4, 0x14d18, 0x1fa28, 0x1fa02, 0x1f4, 0x14d1c
.long 0x1fa28, 0x1fa04, 0x234, 0x14d20, 0x1fa28, 0x1fa06, 0x274, 0x14d24
.long 0x1fa28, 0x1fa08, 0x2b4, 0x14d28, 0x1fa28, 0x1fa0a, 0x2f4, 0x14d2c
.long 0x1fa28, 0x1fa0c, 0x334, 0x14d30, 0x1fa28, 0x1fa0e, 0x374, 0x14d34
.long 0x1fa28, 0x1fa10, 0x3b4, 0x14d38, 0x1fa28, 0x1fa12, 0x3f4, 0x14d3c
.long 0x1fa28, 0x1fa14, 0x434, 0x14d00, 0x1fa28, 0x1fa16, 0x474, 0x14d04
.long 0x1fa28, 0x1fa18, 0x4b4, 0x14d08, 0x1fa28, 0x1fa1a, 0x4f4, 0x14d0c
.long 0x1fa28, 0x1fa1c, 0x534, 0x14d10, 0x1fa28, 0x1fa1e, 0x574, 0x14d14
.long 0x1fa28, 0x1fa20, 0x5b4, 0x14d18, 0x1fa28, 0x1fa22, 0x5f4, 0x14d1c
.long 0x1fa28, 0x1fa24, 0x634, 0x14d20, 0x1fa28, 0x1fa26, 0x674, 0x14d24
.long 0x1fa28, 0x1fa28, 0x6b4, 0x14d28, 0x1fa28, 0x1fa2a, 0x6f4, 0x14d2c
.long 0x1fa28, 0x1fa2c, 0x734, 0x14d30, 0x1fa28, 0x1fa2e, 0x774, 0x14d34
.long 0x1fa28, 0x1fa30, 0x7b4, 0x14d38, 0x1fa28, 0x1fa32, 0x7f4, 0x14d3c
.long 0x1fa38, 0x1fa34, 0x834, 0x14d00, 0x1fa38, 0x1fa36, 0x874, 0x14d04
.long 0x1fa38, 0x1fa38, 0x8b4, 0x14d08, 0x1fa38, 0x1fa3a, 0x8f4, 0x14d0c
.long 0x1fa38, 0x1fa3c, 0x934, 0x14d10, 0x1fa38, 0x1fa3e, 0x974, 0x14d14
.long 0x1fa38, 0x1fa40, 0x9b4, 0x14d18, 0x1fa38, 0x1fa42, 0x9f4, 0x14d1c
.long 0x1fa38, 0x1fa44, 0xa34, 0x14d20, 0x1fa38, 0x1fa46, 0xa74, 0x14d24
.long 0x1fa38, 0x1fa48, 0xab4, 0x14d28, 0x1fa38, 0x1fa4a, 0xaf4, 0x14d2c
.long 0x1fa38, 0x1fa4c, 0xb34, 0x14d30, 0x1fa38, 0x1fa4e, 0xb74, 0x14d34
.long 0x1fa38, 0x1fa50, 0xbb4, 0x14d38, 0x1fa38, 0x1fa52, 0xbf4, 0x14d3c
.long 0x1fa38, 0x1fa54, 0xc34, 0x14d00, 0x1fa38, 0x1fa56, 0xc74, 0x14d04
.long 0x1fa38, 0x1fa58, 0xcb4, 0x14d08, 0x1fa38, 0x1fa5a, 0xcf4, 0x14d0c
.long 0x1fa38, 0x1fa5c, 0xd34, 0x14d10, 0x1fa38, 0x1fa5e, 0xd74, 0x14d14
.long 0x1fa38, 0x1fa60, 0xdb4, 0x14d18, 0x1fa38, 0x1fa62, 0xdf4, 0x14d1c
.long 0x1fa38, 0x1fa64, 0xe34, 0x14d20, 0x1fa38, 0x1fa66, 0xe74, 0x14d24
.long 0x1fa38, 0x1fa68, 0xeb4, 0x14d28, 0x1fa38, 0x1fa6a, 0xef4, 0x14d2c
.long 0x1fa38, 0x1fa6c, 0xf34, 0x14d30, 0x1fa38, 0x1fa6e, 0xf74, 0x14d34
.long 0x1fa38, 0x1fa70, 0xfb4, 0x14d38, 0x1fa38, 0x1fa72, 0xff4, 0x14d3c
.long 0x0, 0x0, 0x0, 0x0, 0x0, 0x0, 0x0, 0x0
.long 0x0, 0x0, 0x0, 0x0, 0x0, 0x0, 0x0, 0x0
.long 0x0, 0x0, 0x0, 0x0, 0x0, 0x0, 0x0, 0x0
.long 0x0, 0x0, 0x0, 0x0, 0x0, 0x0, 0x0, 0x0
.long 0x0, 0x0, 0x0, 0x0, 0x0, 0x0, 0x0, 0x0
.long 0x0, 0x0, 0x0, 0x0, 0x0, 0x0, 0x0, 0x0
.long 0x0, 0x0, 0x0, 0x0, 0x0, 0x0, 0x0, 0x0
.long 0x0, 0x0, 0x0, 0x0, 0x0, 0x0, 0x0, 0x0
.long 0x0, 0x0, 0x0, 0x0, 0x0, 0x0, 0x0, 0x0
.long 0x0, 0x0, 0x0, 0x0, 0x0, 0x0, 0x0, 0x0
.long 0x0, 0x0, 0x0, 0x0, 0x0, 0x0, 0x0, 0x0
.long 0x0, 0x0, 0x0, 0x0, 0x0, 0x0, 0x0, 0x0
.long 0x0, 0x0, 0x0, 0x0, 0x0, 0x0, 0x0, 0x0
.long 0x0, 0x0, 0x0, 0x0, 0x0, 0x0, 0x0, 0x0
.long 0x0, 0x0, 0x0, 0x0, 0x0, 0x0, 0x0, 0x0
.long 0x0, 0x0, 0x0, 0x0, 0x0, 0x0, 0x0, 0x0
.long 0x0, 0x0, 0x0, 0x0, 0x0, 0x0, 0x0, 0x0
.long 0x0, 0x0, 0x0, 0x0, 0x0, 0x0, 0x0, 0x0
.long 0x0, 0x0, 0x0, 0x0, 0x0, 0x0, 0x0, 0x0
.long 0x0, 0x0, 0x0, 0x0, 0x0, 0x0, 0x0, 0x0
.long 0x0, 0x0, 0x0, 0x0, 0x0, 0x0, 0x0, 0x0
.long 0x0, 0x0, 0x0, 0x0, 0x0, 0x0, 0x0, 0x0
.long 0x0, 0x0, 0x0, 0x0, 0x0, 0x0, 0x0, 0x0
.long 0x0, 0x0, 0x0, 0x0, 0x0, 0x0, 0x0, 0x0
.long 0x0, 0x0, 0x0, 0x0, 0x0, 0x0, 0x0, 0x0
.long 0x0, 0x0, 0x0, 0x0, 0x0, 0x0, 0x0, 0x0
.long 0x0, 0x0, 0x0, 0x0, 0x0, 0x0, 0x0, 0x0
.long 0x0, 0x0, 0x0, 0x0, 0x0, 0x0, 0x0, 0x0
.long 0x0, 0x0, 0x0, 0x0, 0x0, 0x0, 0x0, 0x0
.long 0x0, 0x0, 0x0, 0x0, 0x0, 0x0, 0x0, 0x0
.long 0x0, 0x0, 0x0, 0x0, 0x0, 0x0, 0x0, 0x0
.long 0x0, 0x0, 0x0, 0x0, 0x0, 0x0, 0x0, 0x0
.long 0x13320, 0xa9b0, 0xa800, 0x10c00, 0xf320, 0xc120, 0x133b0, 0xb690
.long 0xa890, 0x11920, 0xf3b0, 0xce00, 0x12600, 0xa920, 0xb520, 0x10c90
.long 0xe600, 0xc090, 0x12690, 0xb600, 0xb5b0, 0x119b0, 0xe690, 0xcdb0
.long 0xd5f0, 0x11440, 0x117f0, 0x130d0, 0xf8d0, 0xadf0, 0xd640, 0x12160
.long 0x11840, 0x13df0, 0xf960, 0xbad0, 0xc8d0, 0x113f0, 0x124d0, 0x13160
.long 0xebf0, 0xad60, 0xc960, 0x120d0, 0x12560, 0x13e40, 0xec40, 0xba40
.long 0xefb0, 0x10ed0, 0x117b0, 0x12a40, 0xfa90, 0xdb60, 0xc890, 0x10d60
.long 0x10a90, 0x129f0, 0x13bb0, 0xddf0, 0xf000, 0x11bf0, 0x11520, 0xe960
.long 0xc160, 0xf9b0, 0xc920, 0x11a40, 0x10800, 0xe8d0, 0xc3f0, 0x13a90
.long 0xce40, 0xfa00, 0xfff0, 0xbb20, 0xedb0, 0xdad0, 0xced0, 0x10720
.long 0x10040, 0xc800, 0x14890, 0xde40, 0xf560, 0xfbb0, 0x140d0, 0xbdb0
.long 0xb3f0, 0xec00, 0xf5f0, 0x10890, 0x14160, 0xca90, 0xb760, 0x14720
.long 0x13520, 0xddb0, 0xa520, 0xbe00, 0xf490, 0xe800, 0x13690, 0x10490
.long 0xa5b0, 0xcb20, 0xe7b0, 0x14d00, 0x12800, 0xdd20, 0xb200, 0xbe90
.long 0xf800, 0x14320, 0x129b0, 0x10400, 0xb290, 0xcbb0, 0xeb20, 0x14290
.long 0xd560, 0x10760, 0x112d0, 0xaed0, 0xfb60, 0xeed0, 0xd3f0, 0xe040
.long 0x11360, 0xbbf0, 0xee40, 0x14d00, 0xc840, 0x106d0, 0x11ff0, 0xaf60
.long 0xfed0, 0x149f0, 0xc6d0, 0xdff0, 0x12040, 0xbc40, 0xf1f0, 0x14960
.long 0xbbb0, 0x10cd0, 0xfdb0, 0x12960, 0xd3b0, 0xd9f0, 0x13090, 0x11160
.long 0x13e90, 0x12bf0, 0xbff0, 0xd290, 0xbc00, 0x119f0, 0xfb20, 0xe840
.long 0xac90, 0xd840, 0x13120, 0x11e40, 0x13c00, 0xead0, 0xbe40, 0xabb0
.long 0xcf60, 0x11400, 0x101f0, 0xef20, 0x12e90, 0xdd60, 0xccd0, 0xd320
.long 0x10560, 0x14a00, 0xb640, 0x12d20, 0xf640, 0x115b0, 0x142d0, 0xf1b0
.long 0x121b0, 0xdcd0, 0xf3f0, 0xd490, 0x14640, 0x14c90, 0xb5f0, 0x12000
.long 0x13600, 0xf7b0, 0xa490, 0xb120, 0x10d20, 0xc200, 0x135b0, 0xea90
.long 0xa400, 0x14d00, 0x10db0, 0xcf20, 0x12920, 0xf720, 0xaa00, 0x14000
.long 0x11a00, 0xc290, 0x12890, 0xea00, 0xb720, 0x14090, 0x11a90, 0xcfb0
.long 0xd4d0, 0xfa40, 0x11760, 0x123f0, 0x12cd0, 0xaff0, 0xd440, 0xed60
.long 0x116d0, 0x14d00, 0x12d60, 0xbcd0, 0xc7f0, 0xf9f0, 0x118d0, 0x14ad0
.long 0x139f0, 0xb040, 0xc760, 0xecd0, 0x125f0, 0x14b60, 0x13a40, 0xbd60
.long 0xe290, 0x10e40, 0xc9b0, 0x12760, 0xfe00, 0x13640, 0x10df0, 0xd5b0
.long 0xf090, 0x128d0, 0x13f20, 0x138d0, 0xe320, 0x11b60, 0x12640, 0xafb0
.long 0xfe90, 0x14360, 0x11ad0, 0xd600, 0xe560, 0xad20, 0x13fb0, 0x145f0
.long 0xe000, 0xcd60, 0x10920, 0x102d0, 0xa6d0, 0xebb0, 0xd040, 0x12e00
.long 0xfc00, 0x10240, 0xaa40, 0x14690, 0xe1b0, 0xf440, 0x103f0, 0x12320
.long 0xe7f0, 0xee00, 0xf760, 0x12fb0, 0x144d0, 0x125b0, 0xeb60, 0x14920
.long 0x13720, 0x111b0, 0xdb20, 0xf400, 0x11090, 0x11d20, 0x137b0, 0x11e90
.long 0xda90, 0xe720, 0x11db0, 0x14d00, 0x12a00, 0x11120, 0x10200, 0xf5b0
.long 0x11200, 0x14400, 0x12a90, 0x11e00, 0x101b0, 0xe890, 0x11f20, 0x14490
.long 0xd6d0, 0x12e40, 0x108d0, 0xfc40, 0x13240, 0x13ed0, 0xd760, 0x13b60
.long 0x10840, 0xef60, 0x13f60, 0x14d00, 0xc9f0, 0x12df0, 0xe1f0, 0xfad0
.long 0x132d0, 0x14bf0, 0xca40, 0x13ad0, 0xe160, 0xedf0, 0x13ff0, 0x14c40
.long 0x11690, 0x11040, 0xde90, 0xa640, 0x10b20, 0x136d0, 0x109b0, 0x10ff0
.long 0xa5f0, 0xd1b0, 0x10bb0, 0x143f0, 0x11720, 0x11d60, 0xdf20, 0xb360
.long 0xb000, 0x13360, 0x10a00, 0x11cd0, 0xb2d0, 0xd200, 0xb090, 0x14040
.long 0xcbf0, 0xb920, 0xe400, 0x13560, 0xa560, 0xc490, 0xcc40, 0xc600
.long 0x13840, 0x13200, 0xe640, 0xc720, 0xf2d0, 0xba90, 0xdfb0, 0xc040
.long 0xa8d0, 0x11fb0, 0xf360, 0xc7b0, 0xc360, 0x12db0, 0xe9f0, 0x12200
.long 0x13400, 0xc3b0, 0xdc00, 0x10e00, 0xbfb0, 0xcc00, 0x13490, 0xd090
.long 0xdc90, 0x11b20, 0xcc90, 0x14d00, 0x12720, 0xc320, 0x10320, 0x10fb0
.long 0xc400, 0x14120, 0x127b0, 0xd000, 0x103b0, 0x11c90, 0xd120, 0x141b0
.long 0xd1f0, 0xac40, 0x10ad0, 0x13040, 0xab60, 0xb7f0, 0xd240, 0xb960
.long 0x10b60, 0x13d60, 0xb840, 0x14d00, 0xc4d0, 0xabf0, 0xe3f0, 0x12ed0
.long 0xb0d0, 0x146d0, 0xc560, 0xb8d0, 0xe440, 0x13bf0, 0xbdf0, 0x14760
.long 0xfc90, 0x10f60, 0x11290, 0xa840, 0x13d20, 0x104d0, 0x13db0, 0x111f0
.long 0x105b0, 0xa7f0, 0x13c90, 0xf7f0, 0xfd20, 0x11c40, 0x11320, 0xb560
.long 0xae00, 0xff60, 0x13e00, 0x11ed0, 0x10600, 0xb4d0, 0xadb0, 0xf240
.long 0xcdf0, 0xed20, 0x133f0, 0xbd20, 0x12c40, 0x14bb0, 0xd160, 0x14800
.long 0x13440, 0xca00, 0x11f60, 0x14b20, 0xf4d0, 0xee90, 0xbed0, 0xb890
.long 0x12ad0, 0x12490, 0xf840, 0x149b0, 0xbf60, 0xc5b0, 0x11df0, 0x12400
.long 0x12bb0, 0x13800, 0xd920, 0xc000, 0x14600, 0x14d00, 0x13890, 0x14d00
.long 0xd9b0, 0xcd20, 0xc5f0, 0x14d00, 0x13920, 0x145b0, 0x10000, 0xc1b0
.long 0xb1b0, 0x14d00, 0x12c00, 0x14520, 0x10090, 0xce90, 0xfbf0, 0x14d00
.long 0xc640, 0xd2d0, 0x105f0, 0xae40, 0x14cd0, 0x14d00, 0xd360, 0x14d00
.long 0x10640, 0xbb60, 0xbf20, 0x14d00, 0xd7f0, 0x14840, 0xded0, 0xacd0
.long 0x10290, 0x14d00, 0xcad0, 0x147f0, 0xdf60, 0xb9f0, 0x11000, 0x14d00
.long 0x14a90, 0x11240, 0xf890, 0xa760, 0x14d00, 0xaad0, 0x123b0, 0x110d0
.long 0x139b0, 0xa9f0, 0x14d00, 0x12b20, 0x10c40, 0xae90, 0xf920, 0xb440
.long 0xe0d0, 0x14d00, 0x11960, 0xaf20, 0x13a00, 0xb6d0, 0x131f0, 0x14d00
.long 0x13b20, 0xd0d0, 0x135f0, 0xf120, 0x14d00, 0x12440, 0xac00, 0xcb60
.long 0x13960, 0x14c00, 0xf520, 0x14d00, 0xcff0, 0x12120, 0xc0d0, 0xec90
.long 0xda40, 0xe090, 0xf6d0, 0x12290, 0xc440, 0x147b0, 0x14d00, 0x14d00
.long 0xa600, 0xd800, 0xdbb0, 0x10120, 0x0, 0x0, 0xa7b0, 0xff20
.long 0xda00, 0x14d00, 0x0, 0x0, 0xb320, 0xd890, 0xde00, 0x14200
.long 0x0, 0x0, 0xb490, 0xffb0, 0x10520, 0x143b0, 0x0, 0x0
.long 0x11640, 0x109f0, 0x107f0, 0xe240, 0x0, 0x0, 0x114d0, 0xe2d0
.long 0x10960, 0x14d00, 0x0, 0x0, 0x12360, 0x10a40, 0x10bf0, 0x14a40
.long 0x0, 0x0, 0x121f0, 0xe360, 0xe4d0, 0x148d0, 0x0, 0x0
.long 0xbc90, 0x126d0, 0x12c90, 0xa960, 0x0, 0x0, 0x131b0, 0x12b60
.long 0xb7b0, 0xa4d0, 0x0, 0x0, 0xba00, 0xe5f0, 0xa440, 0xaa90
.long 0x0, 0x0, 0x12f20, 0xea40, 0xb160, 0xab20, 0x0, 0x0
.long 0x10360, 0x11600, 0xd720, 0x134d0, 0x0, 0x0, 0x100d0, 0xd520
.long 0x11800, 0x13760, 0x0, 0x0, 0x14440, 0x11890, 0x137f0, 0x12520
.long 0x0, 0x0, 0x141f0, 0xd7b0, 0xc2d0, 0x12090, 0x0, 0x0
.long 0xa720, 0xf200, 0xf600, 0x10f20, 0x0, 0x0, 0xa690, 0xe520
.long 0xf690, 0x11c00, 0x0, 0x0, 0xb400, 0xf290, 0xe920, 0x10e90
.long 0x0, 0x0, 0xb3b0, 0xe5b0, 0xe9b0, 0x11bb0, 0x0, 0x0
.long 0x115f0, 0xfcd0, 0xfdf0, 0x12ff0, 0x0, 0x0, 0x11560, 0xeff0
.long 0xfe40, 0x13cd0, 0x0, 0x0, 0x122d0, 0xfd60, 0xf0d0, 0x12f60
.long 0x0, 0x0, 0x12240, 0xf040, 0xf160, 0x13c40, 0x0, 0x0
.long 0xe3b0, 0x12840, 0x11490, 0xdc40, 0x0, 0x0, 0x127f0, 0xd690
.long 0x107b0, 0xdbf0, 0x0, 0x0, 0xe120, 0xe760, 0xc240, 0x113b0
.long 0x0, 0x0, 0xe6d0, 0xd400, 0xc1f0, 0x10690, 0x0, 0x0
.long 0xe200, 0x10160, 0xb9b0, 0xd8d0, 0x0, 0x0, 0x10440, 0x13000
.long 0xc690, 0xd960, 0x0, 0x0, 0xe490, 0x14240, 0xb1f0, 0xb800
.long 0x0, 0x0, 0x14560, 0x13290, 0xb240, 0xc520, 0x0, 0x0
.long 0x0, 0x0, 0x0, 0x0, 0x0, 0x0, 0x0, 0x0
.long 0x0, 0x0, 0x0, 0x0, 0x0, 0x0, 0x0, 0x0
.long 0x0, 0x0, 0x0, 0x0, 0x0, 0x0, 0x0, 0x0
.long 0x0, 0x0, 0x0, 0x0, 0x0, 0x0, 0x0, 0x0
.long 0x0, 0x0, 0x0, 0x0, 0x0, 0x0, 0x0, 0x0
.long 0x0, 0x0, 0x0, 0x0, 0x0, 0x0, 0x0, 0x0
.long 0x0, 0x0, 0x0, 0x0, 0x0, 0x0, 0x0, 0x0
.long 0x0, 0x0, 0x0, 0x0, 0x0, 0x0, 0x0, 0x0
.long 0x0, 0x0, 0x0, 0x0, 0x0, 0x0, 0x0, 0x0
.long 0x0, 0x0, 0x0, 0x0, 0x0, 0x0, 0x0, 0x0
.long 0x0, 0x0, 0x0, 0x0, 0x0, 0x0, 0x0, 0x0
.long 0x0, 0x0, 0x0, 0x0, 0x0, 0x0, 0x0, 0x0
.long 0x0, 0x0, 0x0, 0x0, 0x0, 0x0, 0x0, 0x0
.long 0x0, 0x0, 0x0, 0x0, 0x0, 0x0, 0x0, 0x0
.long 0x0, 0x0, 0x0, 0x0, 0x0, 0x0, 0x0, 0x0
.long 0x0, 0x0, 0x0, 0x0, 0x0, 0x0, 0x0, 0x0
.long 0x0, 0x0, 0x0, 0x0, 0x0, 0x0, 0x0, 0x0
.long 0x0, 0x0, 0x0, 0x0, 0x0, 0x0, 0x0, 0x0
.long 0x0, 0x0, 0x0, 0x0, 0x0, 0x0, 0x0, 0x0
.long 0x0, 0x0, 0x0, 0x0, 0x0, 0x0, 0x0, 0x0
.long 0x0, 0x0, 0x0, 0x0, 0x0, 0x0, 0x0, 0x0
.long 0x0, 0x0, 0x0, 0x0, 0x0, 0x0, 0x0, 0x0
.long 0x0, 0x0, 0x0, 0x0, 0x0, 0x0, 0x0, 0x0
.long 0x0, 0x0, 0x0, 0x0, 0x0, 0x0, 0x0, 0x0
.long 0x0, 0x0, 0x0, 0x0, 0x0, 0x0, 0x0, 0x0
.long 0x0, 0x0, 0x0, 0x0, 0x0, 0x0, 0x0, 0x0
.long 0x0, 0x0, 0x0, 0x0, 0x0, 0x0, 0x0, 0x0
.long 0x0, 0x0, 0x0, 0x0, 0x0, 0x0, 0x0, 0x0
.long 0x0, 0x0, 0x0, 0x0, 0x0, 0x0, 0x0, 0x0
.long 0x0, 0x0, 0x0, 0x0, 0x0, 0x0, 0x0, 0x0
.long 0x0, 0x0, 0x0, 0x0, 0x0, 0x0, 0x0, 0x0
.long 0x0, 0x0, 0x0, 0x0, 0x0, 0x0, 0x0, 0x0
.section .rodata,"a"
.p2align 6
.amdhsa_kernel standalone__deep_cross_xdeepfm__recsys_kernel
  .amdhsa_next_free_vgpr 256
  .amdhsa_next_free_sgpr 102
  .amdhsa_accum_offset 256
  .amdhsa_group_segment_fixed_size 0
  .amdhsa_kernarg_size 88
  .amdhsa_user_sgpr_count 2
  .amdhsa_user_sgpr_kernarg_segment_ptr 1
  .amdhsa_system_sgpr_workgroup_id_x 1
  .amdhsa_float_denorm_mode_32 3
.end_amdhsa_kernel
```

```asm
; @launch grid=(256,1,1) block=(512,1,1) lds=163840
.amdgcn_target "amdgcn-amd-amdhsa--gfx950"
.text
.globl standalone__deep_cross_xdeepfm__recsys_kernel
.p2align 8
.type standalone__deep_cross_xdeepfm__recsys_kernel,@function
standalone__deep_cross_xdeepfm__recsys_kernel:
  s_cmp_ge_u32 s2, 256
  s_cbranch_scc1 L_end
  s_load_dwordx16 s[4:19], s[0:1], 0
  s_load_dwordx4 s[20:23], s[0:1], 64
  s_load_dwordx2 s[24:25], s[0:1], 80
  v_lshrrev_b32 v1, 6, v0
  s_getpc_b64 s[92:93]
L_pc:
  s_and_b32 s68, s2, 0xf8
  v_add_u32 v2, s68, v1
  v_and_b32_e64 v3, 32, v0
  v_lshl_add_u32 v2, v3, 3, v2
  v_lshlrev_b32 v2, 7, v2
  v_min_u32 v2, L_end-L_pc, v2
  v_mov_b32 v3, s93
  v_add_co_u32 v2, vcc, s92, v2
  s_nop 1
  v_addc_co_u32 v3, vcc, 0, v3, vcc
  global_load_dword v251, v[2:3], off
  v_and_b32 v0, 63, v0
  v_readfirstlane_b32 s3, v1
  s_and_b32 s68, s2, 7
  s_lshr_b32 s69, s2, 3
  s_xor_b32 s69, s69, 31
  s_and_b32 s80, s2, 0xf8
  s_add_u32 s80, s80, s3
  s_lshl_b32 s80, s80, 0
  s_min_u32 s70, s68, 1
  s_add_u32 s71, s69, s70
  s_cmp_ge_u32 s71, 22
  s_cbranch_scc1 L_cin
  s_mul_i32 s68, s68, 21
  s_add_u32 s68, s68, s71
  s_mul_i32 s26, s68, 5042
  s_lshr_b32 s26, s26, 16
  s_mul_i32 s69, s26, 13
  s_sub_u32 s27, s68, s69
  s_lshl_b32 s77, s27, 8
  s_mul_i32 s71, s26, 320
  v_lshrrev_b32 v116, 4, v0
  v_lshlrev_b32 v11, 4, v0
  s_and_b32 s79, s3, 3
  s_cmp_ge_u32 s3, 4
  s_cbranch_scc1 L_ld
  s_mul_i32 s70, s3, 13
  v_min_u32 v118, 12, v0
  v_add_u32 v118, s70, v118
  v_lshrrev_b32 v117, 1, v118
  v_mul_u32_u24 v117, 96, v117
  v_lshl_add_u32 v118, v118, 2, v117
  s_mul_i32 s78, s27, 25
  s_min_u32 s78, s78, 294
  s_add_u32 s78, s78, s71
  s_mul_i32 s78, s78, 104
  s_lshl_b32 s70, s26, 2
  s_add_u32 s70, s70, s3
  s_add_u32 s70, s70, 128
  s_mul_i32 s70, s70, 3328
  s_add_u32 s70, s70, s77
  s_mov_b32 s81, 173056
  v_lshrrev_b32_e64 v112, 1, v0
  v_mul_lo_u32 v112, s81, v112
  v_and_b32 v117, 1, v0
  v_lshl_add_u32 v112, v117, 7, v112
  v_add_u32 v112, s70, v112
  s_waitcnt lgkmcnt(0)
  s_mov_b32 s28, s4
  s_and_b32 s29, s5, 0xffff
  s_mov_b32 s30, 425984
  s_mov_b32 s31, 0x20000
  buffer_load_dwordx4 v[100:103], v118, s[28:31], s78 offen
  s_mov_b32 s32, s6
  s_and_b32 s33, s7, 0xffff
  s_mov_b32 s34, 12800000
  s_mov_b32 s35, 0x20000
  s_mov_b32 s48, s14
  s_and_b32 s49, s15, 0xffff
  s_mov_b32 s50, 3328
  s_mov_b32 s51, 0x20000
  s_mov_b32 m0, 122880
  s_mov_b64 exec, 0xffff
  buffer_load_dwordx4 v11, s[48:51], s77 offen lds
  s_mov_b64 exec, -1
  s_mov_b32 s44, s12
  s_and_b32 s45, s13, 0xffff
  s_mov_b32 s46, 5537792
  s_mov_b32 s47, 0x20000
  s_mov_b64 exec, 15
  buffer_load_dword v209, v112, s[44:47], 0 offen
  s_mov_b64 exec, -1
  s_barrier
  s_branch L_cmp
L_ld:
  s_lshr_b32 s68, s79, 1
  s_mul_i32 s68, s68, 20
  s_and_b32 s69, s79, 1
  s_add_u32 s68, s68, s69
  s_lshl_b32 s76, s68, 10
  s_mul_i32 s78, s71, 104
  s_mul_i32 s68, s68, 832
  s_add_u32 s94, s78, s68
  v_mul_u32_u24 v118, 48, v116
  v_sub_u32 v12, v11, v118
  s_add_u32 s95, s94, 3328
  s_add_u32 s96, s94, 6656
  s_add_u32 s97, s94, 9984
  s_add_u32 s98, s94, 13312
  s_and_b32 s70, s79, 1
  s_lshl_b32 s70, s70, 3
  v_lshlrev_b32 v117, 1, v116
  v_or_b32 v117, s70, v117
  v_xor_b32 v117, v117, v0
  v_and_b32 v117, 15, v117
  v_mul_u32_u24 v4, 3328, v116
  v_lshl_add_u32 v4, v117, 4, v4
  v_add_u32 v5, 13312, v4
  s_mul_i32 s74, s79, 26624
  s_add_u32 s74, s74, s77
  s_lshl_b32 s75, s79, 11
  s_waitcnt lgkmcnt(0)
  s_mov_b32 s28, s4
  s_and_b32 s29, s5, 0xffff
  s_mov_b32 s30, 425984
  s_mov_b32 s31, 0x20000
  buffer_load_dwordx4 v[16:19], v12, s[28:31], s94 offen offset:0
  s_mov_b32 s32, s6
  s_and_b32 s33, s7, 0xffff
  s_mov_b32 s34, 12800000
  s_mov_b32 s35, 0x20000
  s_mov_b32 s44, s12
  s_and_b32 s45, s13, 0xffff
  s_mov_b32 s46, 5537792
  s_mov_b32 s47, 0x20000
  s_add_u32 m0, s75, 131072
  s_nop 0
  buffer_load_dwordx4 v4, s[44:47], s74 offen lds
  s_add_u32 m0, s75, 132096
  s_nop 0
  buffer_load_dwordx4 v5, s[44:47], s74 offen lds
  s_add_u32 s74, s74, 106496
  s_add_u32 m0, s75, 139264
  s_nop 0
  buffer_load_dwordx4 v4, s[44:47], s74 offen lds
  s_add_u32 m0, s75, 140288
  s_nop 0
  buffer_load_dwordx4 v5, s[44:47], s74 offen lds
  s_add_u32 s74, s74, 106496
  s_barrier
  buffer_load_dwordx4 v[20:23], v12, s[28:31], s94 offen offset:1664
  buffer_load_dwordx4 v[24:27], v12, s[28:31], s95 offen offset:0
  buffer_load_dwordx4 v[28:31], v12, s[28:31], s95 offen offset:1664
  buffer_load_dwordx4 v[32:35], v12, s[28:31], s96 offen offset:0
  buffer_load_dwordx4 v[36:39], v12, s[28:31], s96 offen offset:1664
  buffer_load_dwordx4 v[40:43], v12, s[28:31], s97 offen offset:0
  buffer_load_dwordx4 v[44:47], v12, s[28:31], s97 offen offset:1664
  buffer_load_dwordx4 v[48:51], v12, s[28:31], s98 offen offset:0
  buffer_load_dwordx4 v[52:55], v12, s[28:31], s98 offen offset:1664
  s_lshl_b32 s70, s69, 6
  v_and_b32 v118, 7, v0
  v_xor_b32 v118, v118, v116
  v_lshlrev_b32 v118, 4, v118
  v_xor_b32 v2, s70, v118
  v_xor_b32 v3, 64, v2
  s_mov_b32 s72, 0
  s_mul_i32 s70, s79, 13
  s_add_u32 s70, s70, s27
  s_min_u32 s70, s70, 39
  s_lshl_b32 s70, s70, 3
  s_add_u32 s70, s70, s71
  s_mul_i32 s84, s70, 104
  v_lshrrev_b32 v118, 2, v0
  v_min_u32 v118, 7, v118
  v_mul_u32_u24 v118, 104, v118
  v_and_b32 v117, 3, v0
  v_lshl_add_u32 v7, v117, 2, v118
  s_lshl_b32 s70, s26, 2
  s_add_u32 s70, s70, s79
  s_add_u32 s70, s70, 224
  s_mul_i32 s85, s70, 3328
  s_add_u32 s85, s85, s77
  s_mov_b32 s70, 173056
  v_lshrrev_b32 v118, 1, v0
  v_mul_lo_u32 v118, s70, v118
  v_and_b32 v117, 1, v0
  v_lshl_add_u32 v84, v117, 7, v118
  s_mov_b32 s52, s16
  s_and_b32 s53, s17, 0xffff
  s_mov_b32 s54, 3328
  s_mov_b32 s55, 0x20000
  s_mul_i32 s70, s79, 2560
  s_add_u32 s70, s70, L_tail-L_pc
  v_lshlrev_b32 v8, 7, v0
  v_add_u32 v8, s70, v8
  v_mov_b32 v9, s93
  v_add_co_u32 v8, vcc, s92, v8
  s_nop 1
  v_addc_co_u32 v9, vcc, 0, v9, vcc
  s_waitcnt vmcnt(13)
  v_lshlrev_b32 v16, 7, v16
  v_lshlrev_b32 v18, 7, v18
  v_lshlrev_b32 v17, 7, v17
  v_lshlrev_b32 v19, 7, v19
  v_add_u32_dpp v56, v16, v2 row_newbcast:0 row_mask:0xf bank_mask:0x3
  s_nop 1
  v_add_u32_dpp v56, v18, v2 row_newbcast:6 row_mask:0xf bank_mask:0xc
  s_add_u32 m0, s76, 0
  s_nop 0
  buffer_load_dwordx4 v56, s[32:35], 0 offen lds
  s_waitcnt vmcnt(10)
  s_barrier
  s_waitcnt vmcnt(9)
  v_lshlrev_b32 v20, 7, v20
  v_lshlrev_b32 v22, 7, v22
  v_lshlrev_b32 v21, 7, v21
  v_lshlrev_b32 v23, 7, v23
  v_add_u32_dpp v57, v20, v2 row_newbcast:0 row_mask:0xf bank_mask:0x3
  s_nop 1
  v_add_u32_dpp v57, v22, v2 row_newbcast:6 row_mask:0xf bank_mask:0xc
  s_add_u32 m0, s76, 2048
  s_nop 0
  buffer_load_dwordx4 v57, s[32:35], 0 offen lds
  s_waitcnt vmcnt(9)
  v_lshlrev_b32 v24, 7, v24
  v_lshlrev_b32 v26, 7, v26
  v_lshlrev_b32 v25, 7, v25
  v_lshlrev_b32 v27, 7, v27
  v_add_u32_dpp v58, v24, v2 row_newbcast:0 row_mask:0xf bank_mask:0x3
  s_nop 1
  v_add_u32_dpp v58, v26, v2 row_newbcast:6 row_mask:0xf bank_mask:0xc
  s_add_u32 m0, s76, 4096
  s_nop 0
  buffer_load_dwordx4 v58, s[32:35], 0 offen lds
  s_waitcnt vmcnt(9)
  v_lshlrev_b32 v28, 7, v28
  v_lshlrev_b32 v30, 7, v30
  v_lshlrev_b32 v29, 7, v29
  v_lshlrev_b32 v31, 7, v31
  v_add_u32_dpp v59, v28, v2 row_newbcast:0 row_mask:0xf bank_mask:0x3
  s_nop 1
  v_add_u32_dpp v59, v30, v2 row_newbcast:6 row_mask:0xf bank_mask:0xc
  s_add_u32 m0, s76, 6144
  s_nop 0
  buffer_load_dwordx4 v59, s[32:35], 0 offen lds
  s_waitcnt vmcnt(9)
  v_lshlrev_b32 v32, 7, v32
  v_lshlrev_b32 v34, 7, v34
  v_lshlrev_b32 v33, 7, v33
  v_lshlrev_b32 v35, 7, v35
  v_add_u32_dpp v60, v32, v2 row_newbcast:0 row_mask:0xf bank_mask:0x3
  s_nop 1
  v_add_u32_dpp v60, v34, v2 row_newbcast:6 row_mask:0xf bank_mask:0xc
  s_add_u32 m0, s76, 8192
  s_nop 0
  buffer_load_dwordx4 v60, s[32:35], 0 offen lds
  s_waitcnt vmcnt(9)
  v_lshlrev_b32 v36, 7, v36
  v_lshlrev_b32 v38, 7, v38
  v_lshlrev_b32 v37, 7, v37
  v_lshlrev_b32_e64 v39, 7, v39
  v_add_u32_dpp v61, v36, v2 row_newbcast:0 row_mask:0xf bank_mask:0x3
  s_nop 1
  v_add_u32_dpp v61, v38, v2 row_newbcast:6 row_mask:0xf bank_mask:0xc
  s_add_u32 m0, s76, 10240
  s_nop 0
  buffer_load_dwordx4 v61, s[32:35], 0 offen lds
  s_waitcnt vmcnt(9)
  v_lshlrev_b32 v40, 7, v40
  v_lshlrev_b32 v42, 7, v42
  v_lshlrev_b32 v41, 7, v41
  v_lshlrev_b32_e64 v43, 7, v43
  v_add_u32_dpp v62, v40, v2 row_newbcast:0 row_mask:0xf bank_mask:0x3
  s_nop 1
  v_add_u32_dpp v62, v42, v2 row_newbcast:6 row_mask:0xf bank_mask:0xc
  s_add_u32 m0, s76, 12288
  s_nop 0
  buffer_load_dwordx4 v62, s[32:35], 0 offen lds
  s_waitcnt vmcnt(9)
  v_lshlrev_b32 v44, 7, v44
  v_lshlrev_b32 v46, 7, v46
  v_lshlrev_b32 v45, 7, v45
  v_lshlrev_b32_e64 v47, 7, v47
  v_add_u32_dpp v63, v44, v2 row_newbcast:0 row_mask:0xf bank_mask:0x3
  s_nop 1
  v_add_u32_dpp v63, v46, v2 row_newbcast:6 row_mask:0xf bank_mask:0xc
  s_add_u32 m0, s76, 14336
  s_nop 0
  buffer_load_dwordx4 v63, s[32:35], 0 offen lds
  s_waitcnt vmcnt(9)
  v_lshlrev_b32 v48, 7, v48
  v_lshlrev_b32 v50, 7, v50
  v_lshlrev_b32 v49, 7, v49
  v_lshlrev_b32_e64 v51, 7, v51
  v_add_u32_dpp v64, v48, v2 row_newbcast:0 row_mask:0xf bank_mask:0x3
  s_nop 1
  v_add_u32_dpp v64, v50, v2 row_newbcast:6 row_mask:0xf bank_mask:0xc
  s_add_u32 m0, s76, 16384
  s_nop 0
  buffer_load_dwordx4 v64, s[32:35], 0 offen lds
  s_waitcnt vmcnt(9)
  v_lshlrev_b32 v52, 7, v52
  v_lshlrev_b32 v54, 7, v54
  v_lshlrev_b32 v53, 7, v53
  v_lshlrev_b32_e64 v55, 7, v55
  v_add_u32_dpp v65, v52, v2 row_newbcast:0 row_mask:0xf bank_mask:0x3
  s_nop 1
  v_add_u32_dpp v65, v54, v2 row_newbcast:6 row_mask:0xf bank_mask:0xc
  s_add_u32 m0, s76, 18432
  s_nop 0
  buffer_load_dwordx4 v65, s[32:35], 0 offen lds
  v_add_u32_dpp v56, v17, v2 row_newbcast:0 row_mask:0xf bank_mask:0x3
  s_nop 1
  v_add_u32_dpp v56, v19, v2 row_newbcast:6 row_mask:0xf bank_mask:0xc
  s_add_u32 m0, s76, 40960
  s_nop 0
  buffer_load_dwordx4 v56, s[32:35], 0 offen lds
  v_add_u32_dpp v57, v21, v2 row_newbcast:0 row_mask:0xf bank_mask:0x3
  s_nop 1
  v_add_u32_dpp v57, v23, v2 row_newbcast:6 row_mask:0xf bank_mask:0xc
  s_add_u32 m0, s76, 43008
  s_nop 0
  buffer_load_dwordx4 v57, s[32:35], 0 offen lds
  v_add_u32_dpp v58, v25, v2 row_newbcast:0 row_mask:0xf bank_mask:0x3
  s_nop 1
  v_add_u32_dpp v58, v27, v2 row_newbcast:6 row_mask:0xf bank_mask:0xc
  s_add_u32 m0, s76, 45056
  s_nop 0
  buffer_load_dwordx4 v58, s[32:35], 0 offen lds
  v_add_u32_dpp v59, v29, v2 row_newbcast:0 row_mask:0xf bank_mask:0x3
  s_nop 1
  v_add_u32_dpp v59, v31, v2 row_newbcast:6 row_mask:0xf bank_mask:0xc
  s_add_u32 m0, s76, 47104
  s_nop 0
  buffer_load_dwordx4 v59, s[32:35], 0 offen lds
  v_add_u32_dpp v60, v33, v2 row_newbcast:0 row_mask:0xf bank_mask:0x3
  s_nop 1
  v_add_u32_dpp v60, v35, v2 row_newbcast:6 row_mask:0xf bank_mask:0xc
  s_add_u32 m0, s76, 49152
  s_nop 0
  buffer_load_dwordx4 v60, s[32:35], 0 offen lds
  s_waitcnt vmcnt(11)
  s_barrier
  v_add_u32_dpp v61, v37, v2 row_newbcast:0 row_mask:0xf bank_mask:0x3
  s_nop 1
  v_add_u32_dpp v61, v39, v2 row_newbcast:6 row_mask:0xf bank_mask:0xc
  s_add_u32 m0, s76, 51200
  s_nop 0
  buffer_load_dwordx4 v61, s[32:35], 0 offen lds
  v_add_u32_dpp v62, v41, v2 row_newbcast:0 row_mask:0xf bank_mask:0x3
  s_nop 1
  v_add_u32_dpp v62, v43, v2 row_newbcast:6 row_mask:0xf bank_mask:0xc
  s_add_u32 m0, s76, 53248
  s_nop 0
  buffer_load_dwordx4 v62, s[32:35], 0 offen lds
  v_add_u32_dpp v63, v45, v2 row_newbcast:0 row_mask:0xf bank_mask:0x3
  s_nop 1
  v_add_u32_dpp v63, v47, v2 row_newbcast:6 row_mask:0xf bank_mask:0xc
  s_add_u32 m0, s76, 55296
  s_nop 0
  buffer_load_dwordx4 v63, s[32:35], 0 offen lds
  v_add_u32_dpp v64, v49, v2 row_newbcast:0 row_mask:0xf bank_mask:0x3
  s_nop 1
  v_add_u32_dpp v64, v51, v2 row_newbcast:6 row_mask:0xf bank_mask:0xc
  s_add_u32 m0, s76, 57344
  s_nop 0
  buffer_load_dwordx4 v64, s[32:35], 0 offen lds
  v_add_u32_dpp v65, v53, v2 row_newbcast:0 row_mask:0xf bank_mask:0x3
  s_nop 1
  v_add_u32_dpp v65, v55, v2 row_newbcast:6 row_mask:0xf bank_mask:0xc
  s_add_u32 m0, s76, 59392
  s_nop 0
  buffer_load_dwordx4 v65, s[32:35], 0 offen lds
  s_waitcnt vmcnt(10)
  s_barrier
  s_add_u32 m0, s75, 147456
  s_nop 0
  buffer_load_dwordx4 v4, s[44:47], s74 offen lds
  s_add_u32 m0, s75, 148480
  s_nop 0
  buffer_load_dwordx4 v5, s[44:47], s74 offen lds
  s_add_u32 s74, s74, 106496
  s_add_u32 m0, s75, 155648
  s_nop 0
  buffer_load_dwordx4 v4, s[44:47], s74 offen lds
  s_add_u32 m0, s75, 156672
  s_nop 0
  buffer_load_dwordx4 v5, s[44:47], s74 offen lds
  s_add_u32 s74, s74, 106496
  v_add_u32_dpp v56, v18, v2 row_newbcast:0 row_mask:0xf bank_mask:0x3
  v_add_u32_dpp v57, v22, v2 row_newbcast:0 row_mask:0xf bank_mask:0x3
  v_add_u32_dpp v58, v26, v2 row_newbcast:0 row_mask:0xf bank_mask:0x3
  v_add_u32_dpp v59, v30, v2 row_newbcast:0 row_mask:0xf bank_mask:0x3
  v_add_u32_dpp v60, v34, v2 row_newbcast:0 row_mask:0xf bank_mask:0x3
  v_add_u32_dpp v61, v38, v2 row_newbcast:0 row_mask:0xf bank_mask:0x3
  v_add_u32_dpp v62, v42, v2 row_newbcast:0 row_mask:0xf bank_mask:0x3
  v_add_u32_dpp v63, v46, v2 row_newbcast:0 row_mask:0xf bank_mask:0x3
  v_add_u32_dpp v64, v50, v2 row_newbcast:0 row_mask:0xf bank_mask:0x3
  v_add_u32_dpp v65, v54, v2 row_newbcast:0 row_mask:0xf bank_mask:0x3
  v_add_u32_dpp v56, v16, v2 row_newbcast:7 row_mask:0xf bank_mask:0xc
  v_add_u32_dpp v57, v20, v2 row_newbcast:7 row_mask:0xf bank_mask:0xc
  v_add_u32_dpp v58, v24, v2 row_newbcast:7 row_mask:0xf bank_mask:0xc
  v_add_u32_dpp v59, v28, v2 row_newbcast:7 row_mask:0xf bank_mask:0xc
  v_add_u32_dpp v60, v32, v2 row_newbcast:7 row_mask:0xf bank_mask:0xc
  v_add_u32_dpp v61, v36, v2 row_newbcast:7 row_mask:0xf bank_mask:0xc
  v_add_u32_dpp v62, v40, v2 row_newbcast:7 row_mask:0xf bank_mask:0xc
  v_add_u32_dpp v63, v44, v2 row_newbcast:7 row_mask:0xf bank_mask:0xc
  v_add_u32_dpp v64, v48, v2 row_newbcast:7 row_mask:0xf bank_mask:0xc
  v_add_u32_dpp v65, v52, v2 row_newbcast:7 row_mask:0xf bank_mask:0xc
  buffer_load_dword v70, v7, s[28:31], s84 offen offset:32
  buffer_load_dword v71, v7, s[28:31], s84 offen offset:48
  buffer_load_dword v72, v7, s[28:31], s84 offen offset:64
  buffer_load_dword v73, v7, s[28:31], s84 offen offset:80
  buffer_load_dword v74, v7, s[28:31], s84 offen offset:88
  s_add_u32 m0, s76, 81920
  s_nop 0
  buffer_load_dwordx4 v56, s[32:35], 0 offen lds
  s_add_u32 m0, s76, 83968
  s_nop 0
  buffer_load_dwordx4 v57, s[32:35], 0 offen lds
  s_add_u32 m0, s76, 86016
  s_nop 0
  buffer_load_dwordx4 v58, s[32:35], 0 offen lds
  s_add_u32 m0, s76, 88064
  s_nop 0
  buffer_load_dwordx4 v59, s[32:35], 0 offen lds
  s_add_u32 m0, s76, 90112
  s_nop 0
  buffer_load_dwordx4 v60, s[32:35], 0 offen lds
  s_add_u32 m0, s76, 92160
  s_nop 0
  buffer_load_dwordx4 v61, s[32:35], 0 offen lds
  s_add_u32 m0, s76, 94208
  s_nop 0
  buffer_load_dwordx4 v62, s[32:35], 0 offen lds
  s_add_u32 m0, s76, 96256
  s_nop 0
  buffer_load_dwordx4 v63, s[32:35], 0 offen lds
  s_waitcnt vmcnt(13)
  s_barrier
  s_add_u32 m0, s76, 98304
  s_nop 0
  buffer_load_dwordx4 v64, s[32:35], 0 offen lds
  s_add_u32 m0, s76, 100352
  s_nop 0
  buffer_load_dwordx4 v65, s[32:35], 0 offen lds
  v_add_u32_dpp v56, v19, v2 row_newbcast:0 row_mask:0xf bank_mask:0x3
  v_add_u32_dpp v57, v23, v2 row_newbcast:0 row_mask:0xf bank_mask:0x3
  v_add_u32_dpp v58, v27, v2 row_newbcast:0 row_mask:0xf bank_mask:0x3
  v_add_u32_dpp v59, v31, v2 row_newbcast:0 row_mask:0xf bank_mask:0x3
  v_add_u32_dpp v60, v35, v2 row_newbcast:0 row_mask:0xf bank_mask:0x3
  v_add_u32_dpp v61, v39, v2 row_newbcast:0 row_mask:0xf bank_mask:0x3
  v_add_u32_dpp v62, v43, v2 row_newbcast:0 row_mask:0xf bank_mask:0x3
  v_add_u32_dpp v63, v47, v2 row_newbcast:0 row_mask:0xf bank_mask:0x3
  v_add_u32_dpp v64, v51, v2 row_newbcast:0 row_mask:0xf bank_mask:0x3
  v_add_u32_dpp v65, v55, v2 row_newbcast:0 row_mask:0xf bank_mask:0x3
  v_add_u32_dpp v56, v17, v2 row_newbcast:7 row_mask:0xf bank_mask:0xc
  v_add_u32_dpp v57, v21, v2 row_newbcast:7 row_mask:0xf bank_mask:0xc
  v_add_u32_dpp v58, v25, v2 row_newbcast:7 row_mask:0xf bank_mask:0xc
  v_add_u32_dpp v59, v29, v2 row_newbcast:7 row_mask:0xf bank_mask:0xc
  v_add_u32_dpp v60, v33, v2 row_newbcast:7 row_mask:0xf bank_mask:0xc
  v_add_u32_dpp v61, v37, v2 row_newbcast:7 row_mask:0xf bank_mask:0xc
  v_add_u32_dpp v62, v41, v2 row_newbcast:7 row_mask:0xf bank_mask:0xc
  v_add_u32_dpp v63, v45, v2 row_newbcast:7 row_mask:0xf bank_mask:0xc
  v_add_u32_dpp v64, v49, v2 row_newbcast:7 row_mask:0xf bank_mask:0xc
  v_add_u32_dpp v65, v53, v2 row_newbcast:7 row_mask:0xf bank_mask:0xc
  s_setprio 0
  s_branch L_ld_in
L_cmp:
  s_and_b32 s68, s3, 1
  s_lshr_b32 s69, s3, 1
  v_bfe_u32 v117, v0, 2, 2
  v_lshl_add_u32 v118, v116, 3, v117
  v_lshlrev_b32 v118, 8, v118
  v_bfe_u32 v117, v0, 2, 3
  s_lshl_b32 s70, s69, 2
  v_xor_b32 v117, s70, v117
  v_lshl_add_u32 v118, v117, 5, v118
  v_and_b32 v117, 3, v0
  v_lshl_add_u32 v118, v117, 3, v118
  v_add_u32 v1, 131072, v118
  v_xor_b32 v2, 32, v1
  v_xor_b32 v3, 64, v1
  v_xor_b32 v4, 96, v1
  s_lshl_b32 s70, s69, 7
  s_add_u32 s70, s70, 122880
  v_lshlrev_b32 v118, 3, v116
  v_add_u32 v9, s70, v118
  v_and_b32 v118, 15, v0
  v_lshlrev_b32 v118, 7, v118
  v_bfe_u32 v117, v0, 1, 3
  v_xor_b32 v117, v117, v116
  v_lshl_add_u32 v118, v117, 4, v118
  s_mul_i32 s70, s68, 20480
  v_add_u32 v5, s70, v118
  v_xor_b32 v7, 64, v5
  v_add_u32 v6, 81920, v5
  v_add_u32 v8, 81920, v7
  s_mul_i32 s70, s3, 640
  s_add_u32 s70, s70, 123392
  v_and_b32 v118, 15, v0
  v_lshlrev_b32 v118, 2, v118
  v_add_u32 v118, s70, v118
  v_lshrrev_b32 v117, 5, v0
  v_lshl_add_u32 v118, v117, 6, v118
  v_bfe_u32 v117, v0, 4, 1
  v_lshl_add_u32 v10, v117, 7, v118
  s_mov_b32 s72, 0
  v_mov_b32 v12, 0xc0135761
  v_mov_b32 v13, 0xc0135761
  v_mov_b32 v14, 0xbdd2d3e8
  v_mov_b32 v15, 0xbdd2d3e8
  s_waitcnt vmcnt(2)
  v_lshlrev_b32 v100, 7, v100
  buffer_load_dword v200, v100, s[32:35], 0 offen
  v_lshlrev_b32 v102, 7, v102
  buffer_load_dword v202, v102, s[32:35], 0 offen
  s_barrier
  ds_read_b64_tr_b16 v[16:17], v1 offset:0
  ds_read_b64_tr_b16 v[18:19], v1 offset:1024
  ds_read_b64_tr_b16 v[32:33], v1 offset:8192
  ds_read_b64_tr_b16 v[34:35], v1 offset:9216
  ds_read_b64_tr_b16 v[20:21], v2 offset:0
  ds_read_b64_tr_b16 v[22:23], v2 offset:1024
  ds_read_b64_tr_b16 v[36:37], v2 offset:8192
  ds_read_b64_tr_b16 v[38:39], v2 offset:9216
  ds_read_b64_tr_b16 v[24:25], v3 offset:0
  ds_read_b64_tr_b16 v[26:27], v3 offset:1024
  ds_read_b64_tr_b16 v[40:41], v3 offset:8192
  ds_read_b64_tr_b16 v[42:43], v3 offset:9216
  ds_read_b64_tr_b16 v[28:29], v4 offset:0
  ds_read_b64_tr_b16 v[30:31], v4 offset:1024
  ds_read_b64_tr_b16 v[44:45], v4 offset:8192
  ds_read_b64_tr_b16 v[46:47], v4 offset:9216
  s_waitcnt vmcnt(3)
  ds_read_b64 v[234:235], v9 offset:0
  ds_read_b64 v[238:239], v9 offset:32
  ds_read_b64 v[242:243], v9 offset:64
  ds_read_b64 v[246:247], v9 offset:96
  s_waitcnt lgkmcnt(3)
  v_lshlrev_b32 v232, 16, v234
  v_and_b32 v233, 0xffff0000, v234
  v_lshlrev_b32 v234, 16, v235
  v_and_b32 v235, 0xffff0000, v235
  s_waitcnt lgkmcnt(2)
  v_lshlrev_b32 v236, 16, v238
  v_and_b32 v237, 0xffff0000, v238
  v_lshlrev_b32 v238, 16, v239
  v_and_b32 v239, 0xffff0000, v239
  s_waitcnt lgkmcnt(1)
  v_lshlrev_b32 v240, 16, v242
  v_and_b32 v241, 0xffff0000, v242
  v_lshlrev_b32_e64 v242, 16, v243
  v_and_b32 v243, 0xffff0000, v243
  s_waitcnt lgkmcnt(0)
  v_lshlrev_b32 v244, 16, v246
  v_and_b32 v245, 0xffff0000, v246
  v_lshlrev_b32 v246, 16, v247
  v_and_b32 v247, 0xffff0000, v247
  v_mov_b64 v[216:217], v[232:233]
  v_mov_b64 v[218:219], v[234:235]
  v_mov_b64 v[220:221], v[236:237]
  v_mov_b64 v[222:223], v[238:239]
  v_mov_b64 v[224:225], v[240:241]
  v_mov_b64 v[226:227], v[242:243]
  v_mov_b64 v[228:229], v[244:245]
  v_mov_b64 v[230:231], v[246:247]
  s_waitcnt lgkmcnt(0)
  s_setprio 1
  s_barrier
  ds_read_b128 v[48:51], v5 offset:0
  ds_read_b128 v[52:55], v7 offset:0
  ds_read_b128 v[56:59], v5 offset:2048
  ds_read_b128 v[60:63], v7 offset:2048
  ds_read_b128 v[64:67], v5 offset:4096
  ds_read_b128 v[68:71], v7 offset:4096
  ds_read_b128 v[72:75], v5 offset:6144
  ds_read_b128 v[76:79], v7 offset:6144
  s_waitcnt lgkmcnt(7)
  v_mfma_f32_16x16x32_bf16 v[88:91], v[16:19], v[48:51], v[232:235]
  s_waitcnt lgkmcnt(4)
  v_mfma_f32_16x16x32_bf16 v[88:91], v[32:35], v[52:55], v[88:91]
  v_mfma_f32_16x16x32_bf16 v[104:107], v[32:35], v[60:63], v[232:235]
  v_mfma_f32_16x16x32_bf16 v[104:107], v[16:19], v[56:59], v[104:107]
  v_mfma_f32_16x16x32_bf16 v[108:111], v[20:23], v[56:59], v[236:239]
  v_mfma_f32_16x16x32_bf16 v[108:111], v[36:39], v[60:63], v[108:111]
  v_mfma_f32_16x16x32_bf16 v[92:95], v[36:39], v[52:55], v[236:239]
  v_mfma_f32_16x16x32_bf16 v[92:95], v[20:23], v[48:51], v[92:95]
  v_mfma_f32_16x16x32_bf16 v[96:99], v[24:27], v[48:51], v[240:243]
  v_xor_b32 v1, 16384, v1
  v_mfma_f32_16x16x32_bf16 v[96:99], v[40:43], v[52:55], v[96:99]
  v_xor_b32 v2, 16384, v2
  v_mfma_f32_16x16x32_bf16 v[112:115], v[40:43], v[60:63], v[240:243]
  v_xor_b32 v3, 16384, v3
  v_mfma_f32_16x16x32_bf16 v[112:115], v[24:27], v[56:59], v[112:115]
  v_xor_b32 v4, 16384, v4
  v_mfma_f32_16x16x32_bf16 v[116:119], v[28:31], v[56:59], v[244:247]
  v_mfma_f32_16x16x32_bf16 v[116:119], v[44:47], v[60:63], v[116:119]
  v_mfma_f32_16x16x32_bf16 v[100:103], v[44:47], v[52:55], v[244:247]
  s_waitcnt lgkmcnt(2)
  v_mfma_f32_16x16x32_bf16 v[100:103], v[28:31], v[48:51], v[100:103]
  v_mfma_f32_16x16x32_bf16 v[120:123], v[16:19], v[64:67], v[232:235]
  s_barrier
  s_waitcnt lgkmcnt(0)
  v_mfma_f32_16x16x32_bf16 v[120:123], v[32:35], v[68:71], v[120:123]
  ds_read_b128 v[80:83], v5 offset:8192
  v_mfma_f32_16x16x32_bf16 v[136:139], v[32:35], v[76:79], v[232:235]
  ds_read_b128 v[84:87], v7 offset:8192
  v_mfma_f32_16x16x32_bf16 v[136:139], v[16:19], v[72:75], v[136:139]
  ds_read_b128 v[48:51], v5 offset:10240
  v_mfma_f32_16x16x32_bf16 v[140:143], v[20:23], v[72:75], v[236:239]
  ds_read_b128 v[52:55], v7 offset:10240
  v_mfma_f32_16x16x32_bf16 v[140:143], v[36:39], v[76:79], v[140:143]
  ds_read_b128 v[56:59], v5 offset:12288
  v_mfma_f32_16x16x32_bf16 v[124:127], v[36:39], v[68:71], v[236:239]
  ds_read_b128 v[60:63], v7 offset:12288
  v_mfma_f32_16x16x32_bf16 v[124:127], v[20:23], v[64:67], v[124:127]
  v_mfma_f32_16x16x32_bf16 v[128:131], v[24:27], v[64:67], v[240:243]
  v_mfma_f32_16x16x32_bf16 v[128:131], v[40:43], v[68:71], v[128:131]
  v_mfma_f32_16x16x32_bf16 v[144:147], v[40:43], v[76:79], v[240:243]
  v_mfma_f32_16x16x32_bf16 v[144:147], v[24:27], v[72:75], v[144:147]
  v_mfma_f32_16x16x32_bf16 v[148:151], v[28:31], v[72:75], v[244:247]
  ds_read_b128 v[72:75], v5 offset:16384
  v_mfma_f32_16x16x32_bf16 v[148:151], v[44:47], v[76:79], v[148:151]
  ds_read_b128 v[76:79], v7 offset:16384
  v_mfma_f32_16x16x32_bf16 v[132:135], v[44:47], v[68:71], v[244:247]
  ds_read_b128 v[68:71], v7 offset:14336
  s_waitcnt lgkmcnt(7)
  v_mfma_f32_16x16x32_bf16 v[132:135], v[28:31], v[64:67], v[132:135]
  ds_read_b128 v[64:67], v5 offset:14336
  v_mfma_f32_16x16x32_bf16 v[152:155], v[16:19], v[80:83], v[232:235]
  s_waitcnt lgkmcnt(6)
  v_mfma_f32_16x16x32_bf16 v[152:155], v[32:35], v[84:87], v[152:155]
  v_mfma_f32_16x16x32_bf16 v[168:171], v[32:35], v[52:55], v[232:235]
  v_mfma_f32_16x16x32_bf16 v[168:171], v[16:19], v[48:51], v[168:171]
  v_mfma_f32_16x16x32_bf16 v[172:175], v[20:23], v[48:51], v[236:239]
  v_mfma_f32_16x16x32_bf16 v[172:175], v[36:39], v[52:55], v[172:175]
  v_mfma_f32_16x16x32_bf16 v[156:159], v[36:39], v[84:87], v[236:239]
  v_mfma_f32_16x16x32_bf16 v[156:159], v[20:23], v[80:83], v[156:159]
  v_mfma_f32_16x16x32_bf16 v[160:163], v[24:27], v[80:83], v[240:243]
  v_mfma_f32_16x16x32_bf16 v[160:163], v[40:43], v[84:87], v[160:163]
  v_mfma_f32_16x16x32_bf16 v[176:179], v[40:43], v[52:55], v[240:243]
  v_mfma_f32_16x16x32_bf16 v[176:179], v[24:27], v[48:51], v[176:179]
  v_mfma_f32_16x16x32_bf16 v[180:183], v[28:31], v[48:51], v[244:247]
  v_mfma_f32_16x16x32_bf16 v[180:183], v[44:47], v[52:55], v[180:183]
  v_mfma_f32_16x16x32_bf16 v[164:167], v[44:47], v[84:87], v[244:247]
  ds_read_b128 v[84:87], v7 offset:18432
  s_waitcnt lgkmcnt(5)
  v_mfma_f32_16x16x32_bf16 v[164:167], v[28:31], v[80:83], v[164:167]
  ds_read_b128 v[80:83], v5 offset:18432
  v_mfma_f32_16x16x32_bf16 v[184:187], v[16:19], v[56:59], v[232:235]
  s_waitcnt lgkmcnt(2)
  v_mfma_f32_16x16x32_bf16 v[184:187], v[32:35], v[60:63], v[184:187]
  s_waitcnt vmcnt(0)
  v_mfma_f32_16x16x32_bf16 v[200:203], v[32:35], v[68:71], v[232:235]
  v_mfma_f32_16x16x32_bf16 v[200:203], v[16:19], v[64:67], v[200:203]
  v_mfma_f32_16x16x32_bf16 v[204:207], v[20:23], v[64:67], v[236:239]
  v_mfma_f32_16x16x32_bf16 v[204:207], v[36:39], v[68:71], v[204:207]
  s_waitcnt lgkmcnt(0)
  s_barrier
  v_mfma_f32_16x16x32_bf16 v[188:191], v[36:39], v[60:63], v[236:239]
  ds_read_b128 v[48:51], v5 offset:40960
  v_mfma_f32_16x16x32_bf16 v[188:191], v[20:23], v[56:59], v[188:191]
  ds_read_b128 v[52:55], v7 offset:40960
  v_mfma_f32_16x16x32_bf16 v[192:195], v[24:27], v[56:59], v[240:243]
  v_mfma_f32_16x16x32_bf16 v[192:195], v[40:43], v[60:63], v[192:195]
  v_mfma_f32_16x16x32_bf16 v[208:211], v[40:43], v[68:71], v[240:243]
  v_mfma_f32_16x16x32_bf16 v[208:211], v[24:27], v[64:67], v[208:211]
  v_mfma_f32_16x16x32_bf16 v[212:215], v[28:31], v[64:67], v[244:247]
  ds_read_b128 v[64:67], v5 offset:45056
  v_mfma_f32_16x16x32_bf16 v[212:215], v[44:47], v[68:71], v[212:215]
  ds_read_b128 v[68:71], v7 offset:45056
  v_mfma_f32_16x16x32_bf16 v[196:199], v[44:47], v[60:63], v[244:247]
  ds_read_b128 v[60:63], v7 offset:43008
  v_mfma_f32_16x16x32_bf16 v[196:199], v[28:31], v[56:59], v[196:199]
  ds_read_b128 v[56:59], v5 offset:43008
  v_mfma_f32_16x16x32_bf16 v[216:219], v[32:35], v[76:79], v[216:219]
  v_mfma_f32_16x16x32_bf16 v[216:219], v[16:19], v[72:75], v[216:219]
  v_mfma_f32_16x16x32_bf16 v[232:235], v[16:19], v[80:83], v[232:235]
  ds_read_b64_tr_b16 v[16:17], v1 offset:0
  v_mfma_f32_16x16x32_bf16 v[232:235], v[32:35], v[84:87], v[232:235]
  ds_read_b64_tr_b16 v[18:19], v1 offset:1024
  v_mfma_f32_16x16x32_bf16 v[236:239], v[36:39], v[84:87], v[236:239]
  ds_read_b64_tr_b16 v[32:33], v1 offset:8192
  v_mfma_f32_16x16x32_bf16 v[236:239], v[20:23], v[80:83], v[236:239]
  ds_read_b64_tr_b16 v[34:35], v1 offset:9216
  v_mfma_f32_16x16x32_bf16 v[220:223], v[20:23], v[72:75], v[220:223]
  ds_read_b64_tr_b16 v[20:21], v2 offset:0
  v_mfma_f32_16x16x32_bf16 v[220:223], v[36:39], v[76:79], v[220:223]
  ds_read_b64_tr_b16 v[22:23], v2 offset:1024
  v_mfma_f32_16x16x32_bf16 v[224:227], v[40:43], v[76:79], v[224:227]
  ds_read_b64_tr_b16 v[36:37], v2 offset:8192
  v_mfma_f32_16x16x32_bf16 v[224:227], v[24:27], v[72:75], v[224:227]
  ds_read_b64_tr_b16 v[38:39], v2 offset:9216
  v_mfma_f32_16x16x32_bf16 v[240:243], v[24:27], v[80:83], v[240:243]
  ds_read_b64_tr_b16 v[24:25], v3 offset:0
  v_mfma_f32_16x16x32_bf16 v[240:243], v[40:43], v[84:87], v[240:243]
  ds_read_b64_tr_b16 v[26:27], v3 offset:1024
  v_mfma_f32_16x16x32_bf16 v[244:247], v[44:47], v[84:87], v[244:247]
  ds_read_b64_tr_b16 v[40:41], v3 offset:8192
  v_mfma_f32_16x16x32_bf16 v[244:247], v[28:31], v[80:83], v[244:247]
  ds_read_b64_tr_b16 v[42:43], v3 offset:9216
  v_mfma_f32_16x16x32_bf16 v[228:231], v[28:31], v[72:75], v[228:231]
  ds_read_b64_tr_b16 v[28:29], v4 offset:0
  s_waitcnt lgkmcnt(9)
  v_mfma_f32_16x16x32_bf16 v[228:231], v[44:47], v[76:79], v[228:231]
  ds_read_b64_tr_b16 v[30:31], v4 offset:1024
L_dnn_loop0:
  v_mfma_f32_16x16x32_bf16 v[88:91], v[16:19], v[48:51], v[88:91]
  ds_read_b64_tr_b16 v[44:45], v4 offset:8192
  v_mfma_f32_16x16x32_bf16 v[88:91], v[32:35], v[52:55], v[88:91]
  ds_read_b64_tr_b16 v[46:47], v4 offset:9216
  v_mfma_f32_16x16x32_bf16 v[104:107], v[32:35], v[60:63], v[104:107]
  ds_read_b128 v[72:75], v5 offset:47104
  s_waitcnt lgkmcnt(9)
  v_mfma_f32_16x16x32_bf16 v[104:107], v[16:19], v[56:59], v[104:107]
  ds_read_b128 v[76:79], v7 offset:47104
  v_mfma_f32_16x16x32_bf16 v[108:111], v[20:23], v[56:59], v[108:111]
  ds_read_b128 v[80:83], v5 offset:49152
  v_mfma_f32_16x16x32_bf16 v[108:111], v[36:39], v[60:63], v[108:111]
  ds_read_b128 v[84:87], v7 offset:49152
  v_mfma_f32_16x16x32_bf16 v[92:95], v[36:39], v[52:55], v[92:95]
  s_waitcnt lgkmcnt(8)
  v_mfma_f32_16x16x32_bf16 v[92:95], v[20:23], v[48:51], v[92:95]
  v_mfma_f32_16x16x32_bf16 v[96:99], v[24:27], v[48:51], v[96:99]
  v_xor_b32 v1, 16384, v1
  v_mfma_f32_16x16x32_bf16 v[96:99], v[40:43], v[52:55], v[96:99]
  v_xor_b32 v2, 16384, v2
  v_mfma_f32_16x16x32_bf16 v[112:115], v[40:43], v[60:63], v[112:115]
  v_xor_b32 v3, 16384, v3
  s_waitcnt lgkmcnt(4)
  v_mfma_f32_16x16x32_bf16 v[112:115], v[24:27], v[56:59], v[112:115]
  v_xor_b32 v4, 16384, v4
  v_mfma_f32_16x16x32_bf16 v[116:119], v[28:31], v[56:59], v[116:119]
  ds_read_b128 v[56:59], v5 offset:53248
  v_mfma_f32_16x16x32_bf16 v[116:119], v[44:47], v[60:63], v[116:119]
  ds_read_b128 v[60:63], v7 offset:53248
  v_mfma_f32_16x16x32_bf16 v[100:103], v[44:47], v[52:55], v[100:103]
  ds_read_b128 v[52:55], v7 offset:51200
  v_mfma_f32_16x16x32_bf16 v[100:103], v[28:31], v[48:51], v[100:103]
  ds_read_b128 v[48:51], v5 offset:51200
  v_mfma_f32_16x16x32_bf16 v[120:123], v[16:19], v[64:67], v[120:123]
  s_waitcnt lgkmcnt(6)
  v_mfma_f32_16x16x32_bf16 v[120:123], v[32:35], v[68:71], v[120:123]
  v_mfma_f32_16x16x32_bf16 v[136:139], v[32:35], v[76:79], v[136:139]
  v_mfma_f32_16x16x32_bf16 v[136:139], v[16:19], v[72:75], v[136:139]
  v_mfma_f32_16x16x32_bf16 v[140:143], v[20:23], v[72:75], v[140:143]
  v_mfma_f32_16x16x32_bf16 v[140:143], v[36:39], v[76:79], v[140:143]
  v_mfma_f32_16x16x32_bf16 v[124:127], v[36:39], v[68:71], v[124:127]
  v_mfma_f32_16x16x32_bf16 v[124:127], v[20:23], v[64:67], v[124:127]
  v_mfma_f32_16x16x32_bf16 v[128:131], v[24:27], v[64:67], v[128:131]
  v_mfma_f32_16x16x32_bf16 v[128:131], v[40:43], v[68:71], v[128:131]
  v_mfma_f32_16x16x32_bf16 v[144:147], v[40:43], v[76:79], v[144:147]
  v_mfma_f32_16x16x32_bf16 v[144:147], v[24:27], v[72:75], v[144:147]
  v_mfma_f32_16x16x32_bf16 v[148:151], v[28:31], v[72:75], v[148:151]
  ds_read_b128 v[72:75], v5 offset:57344
  v_mfma_f32_16x16x32_bf16 v[148:151], v[44:47], v[76:79], v[148:151]
  ds_read_b128 v[76:79], v7 offset:57344
  v_mfma_f32_16x16x32_bf16 v[132:135], v[44:47], v[68:71], v[132:135]
  ds_read_b128 v[68:71], v7 offset:55296
  s_waitcnt lgkmcnt(7)
  v_mfma_f32_16x16x32_bf16 v[132:135], v[28:31], v[64:67], v[132:135]
  ds_read_b128 v[64:67], v5 offset:55296
  v_mfma_f32_16x16x32_bf16 v[152:155], v[16:19], v[80:83], v[152:155]
  s_waitcnt lgkmcnt(4)
  v_mfma_f32_16x16x32_bf16 v[152:155], v[32:35], v[84:87], v[152:155]
  v_mfma_f32_16x16x32_bf16 v[168:171], v[32:35], v[52:55], v[168:171]
  v_mfma_f32_16x16x32_bf16 v[168:171], v[16:19], v[48:51], v[168:171]
  v_mfma_f32_16x16x32_bf16 v[172:175], v[20:23], v[48:51], v[172:175]
  v_mfma_f32_16x16x32_bf16 v[172:175], v[36:39], v[52:55], v[172:175]
  v_mfma_f32_16x16x32_bf16 v[156:159], v[36:39], v[84:87], v[156:159]
  v_mfma_f32_16x16x32_bf16 v[156:159], v[20:23], v[80:83], v[156:159]
  v_mfma_f32_16x16x32_bf16 v[160:163], v[24:27], v[80:83], v[160:163]
  v_mfma_f32_16x16x32_bf16 v[160:163], v[40:43], v[84:87], v[160:163]
  v_mfma_f32_16x16x32_bf16 v[176:179], v[40:43], v[52:55], v[176:179]
  v_mfma_f32_16x16x32_bf16 v[176:179], v[24:27], v[48:51], v[176:179]
  v_mfma_f32_16x16x32_bf16 v[180:183], v[28:31], v[48:51], v[180:183]
  v_mfma_f32_16x16x32_bf16 v[180:183], v[44:47], v[52:55], v[180:183]
  v_mfma_f32_16x16x32_bf16 v[164:167], v[44:47], v[84:87], v[164:167]
  ds_read_b128 v[84:87], v7 offset:59392
  v_mfma_f32_16x16x32_bf16 v[164:167], v[28:31], v[80:83], v[164:167]
  ds_read_b128 v[80:83], v5 offset:59392
  v_mfma_f32_16x16x32_bf16 v[184:187], v[16:19], v[56:59], v[184:187]
  s_waitcnt lgkmcnt(2)
  v_mfma_f32_16x16x32_bf16 v[184:187], v[32:35], v[60:63], v[184:187]
  v_mfma_f32_16x16x32_bf16 v[200:203], v[32:35], v[68:71], v[200:203]
  v_mfma_f32_16x16x32_bf16 v[200:203], v[16:19], v[64:67], v[200:203]
  v_mfma_f32_16x16x32_bf16 v[204:207], v[20:23], v[64:67], v[204:207]
  v_mfma_f32_16x16x32_bf16 v[204:207], v[36:39], v[68:71], v[204:207]
  s_waitcnt lgkmcnt(0)
  s_barrier
  v_mfma_f32_16x16x32_bf16 v[188:191], v[36:39], v[60:63], v[188:191]
  ds_read_b128 v[48:51], v6 offset:0
  v_mfma_f32_16x16x32_bf16 v[188:191], v[20:23], v[56:59], v[188:191]
  ds_read_b128 v[52:55], v8 offset:0
  v_mfma_f32_16x16x32_bf16 v[192:195], v[24:27], v[56:59], v[192:195]
  v_mfma_f32_16x16x32_bf16 v[192:195], v[40:43], v[60:63], v[192:195]
  v_mfma_f32_16x16x32_bf16 v[208:211], v[40:43], v[68:71], v[208:211]
  v_mfma_f32_16x16x32_bf16 v[208:211], v[24:27], v[64:67], v[208:211]
  v_mfma_f32_16x16x32_bf16 v[212:215], v[28:31], v[64:67], v[212:215]
  ds_read_b128 v[64:67], v6 offset:4096
  v_mfma_f32_16x16x32_bf16 v[212:215], v[44:47], v[68:71], v[212:215]
  ds_read_b128 v[68:71], v8 offset:4096
  v_mfma_f32_16x16x32_bf16 v[196:199], v[44:47], v[60:63], v[196:199]
  ds_read_b128 v[60:63], v8 offset:2048
  v_mfma_f32_16x16x32_bf16 v[196:199], v[28:31], v[56:59], v[196:199]
  ds_read_b128 v[56:59], v6 offset:2048
  v_mfma_f32_16x16x32_bf16 v[216:219], v[32:35], v[76:79], v[216:219]
  v_mfma_f32_16x16x32_bf16 v[216:219], v[16:19], v[72:75], v[216:219]
  v_mfma_f32_16x16x32_bf16 v[232:235], v[16:19], v[80:83], v[232:235]
  ds_read_b64_tr_b16 v[16:17], v1 offset:0
  v_mfma_f32_16x16x32_bf16 v[232:235], v[32:35], v[84:87], v[232:235]
  ds_read_b64_tr_b16 v[18:19], v1 offset:1024
  v_mfma_f32_16x16x32_bf16 v[236:239], v[36:39], v[84:87], v[236:239]
  ds_read_b64_tr_b16 v[32:33], v1 offset:8192
  v_mfma_f32_16x16x32_bf16 v[236:239], v[20:23], v[80:83], v[236:239]
  ds_read_b64_tr_b16 v[34:35], v1 offset:9216
  v_mfma_f32_16x16x32_bf16 v[220:223], v[20:23], v[72:75], v[220:223]
  ds_read_b64_tr_b16 v[20:21], v2 offset:0
  v_mfma_f32_16x16x32_bf16 v[220:223], v[36:39], v[76:79], v[220:223]
  ds_read_b64_tr_b16 v[22:23], v2 offset:1024
  v_mfma_f32_16x16x32_bf16 v[224:227], v[40:43], v[76:79], v[224:227]
  ds_read_b64_tr_b16 v[36:37], v2 offset:8192
  v_mfma_f32_16x16x32_bf16 v[224:227], v[24:27], v[72:75], v[224:227]
  ds_read_b64_tr_b16 v[38:39], v2 offset:9216
  v_mfma_f32_16x16x32_bf16 v[240:243], v[24:27], v[80:83], v[240:243]
  ds_read_b64_tr_b16 v[24:25], v3 offset:0
  v_mfma_f32_16x16x32_bf16 v[240:243], v[40:43], v[84:87], v[240:243]
  ds_read_b64_tr_b16 v[26:27], v3 offset:1024
  v_mfma_f32_16x16x32_bf16 v[244:247], v[44:47], v[84:87], v[244:247]
  ds_read_b64_tr_b16 v[40:41], v3 offset:8192
  v_mfma_f32_16x16x32_bf16 v[244:247], v[28:31], v[80:83], v[244:247]
  ds_read_b64_tr_b16 v[42:43], v3 offset:9216
  v_mfma_f32_16x16x32_bf16 v[228:231], v[28:31], v[72:75], v[228:231]
  ds_read_b64_tr_b16 v[28:29], v4 offset:0
  s_waitcnt lgkmcnt(9)
  v_mfma_f32_16x16x32_bf16 v[228:231], v[44:47], v[76:79], v[228:231]
  ds_read_b64_tr_b16 v[30:31], v4 offset:1024
  v_mfma_f32_16x16x32_bf16 v[88:91], v[16:19], v[48:51], v[88:91]
  ds_read_b64_tr_b16 v[44:45], v4 offset:8192
  v_mfma_f32_16x16x32_bf16 v[88:91], v[32:35], v[52:55], v[88:91]
  ds_read_b64_tr_b16 v[46:47], v4 offset:9216
  v_mfma_f32_16x16x32_bf16 v[104:107], v[32:35], v[60:63], v[104:107]
  ds_read_b128 v[72:75], v6 offset:6144
  s_waitcnt lgkmcnt(9)
  v_mfma_f32_16x16x32_bf16 v[104:107], v[16:19], v[56:59], v[104:107]
  ds_read_b128 v[76:79], v8 offset:6144
  v_mfma_f32_16x16x32_bf16 v[108:111], v[20:23], v[56:59], v[108:111]
  ds_read_b128 v[80:83], v6 offset:8192
  v_mfma_f32_16x16x32_bf16 v[108:111], v[36:39], v[60:63], v[108:111]
  ds_read_b128 v[84:87], v8 offset:8192
  v_mfma_f32_16x16x32_bf16 v[92:95], v[36:39], v[52:55], v[92:95]
  s_waitcnt lgkmcnt(8)
  v_mfma_f32_16x16x32_bf16 v[92:95], v[20:23], v[48:51], v[92:95]
  v_mfma_f32_16x16x32_bf16 v[96:99], v[24:27], v[48:51], v[96:99]
  v_xor_b32 v1, 16384, v1
  v_mfma_f32_16x16x32_bf16 v[96:99], v[40:43], v[52:55], v[96:99]
  v_xor_b32 v2, 16384, v2
  v_mfma_f32_16x16x32_bf16 v[112:115], v[40:43], v[60:63], v[112:115]
  v_xor_b32 v3, 16384, v3
  s_waitcnt lgkmcnt(4)
  v_mfma_f32_16x16x32_bf16 v[112:115], v[24:27], v[56:59], v[112:115]
  v_xor_b32 v4, 16384, v4
  v_mfma_f32_16x16x32_bf16 v[116:119], v[28:31], v[56:59], v[116:119]
  ds_read_b128 v[56:59], v6 offset:12288
  v_mfma_f32_16x16x32_bf16 v[116:119], v[44:47], v[60:63], v[116:119]
  ds_read_b128 v[60:63], v8 offset:12288
  v_mfma_f32_16x16x32_bf16 v[100:103], v[44:47], v[52:55], v[100:103]
  ds_read_b128 v[52:55], v8 offset:10240
  v_mfma_f32_16x16x32_bf16 v[100:103], v[28:31], v[48:51], v[100:103]
  ds_read_b128 v[48:51], v6 offset:10240
  v_mfma_f32_16x16x32_bf16 v[120:123], v[16:19], v[64:67], v[120:123]
  s_waitcnt lgkmcnt(6)
  v_mfma_f32_16x16x32_bf16 v[120:123], v[32:35], v[68:71], v[120:123]
  v_mfma_f32_16x16x32_bf16 v[136:139], v[32:35], v[76:79], v[136:139]
  v_mfma_f32_16x16x32_bf16 v[136:139], v[16:19], v[72:75], v[136:139]
  v_mfma_f32_16x16x32_bf16 v[140:143], v[20:23], v[72:75], v[140:143]
  v_mfma_f32_16x16x32_bf16 v[140:143], v[36:39], v[76:79], v[140:143]
  v_mfma_f32_16x16x32_bf16 v[124:127], v[36:39], v[68:71], v[124:127]
  v_mfma_f32_16x16x32_bf16 v[124:127], v[20:23], v[64:67], v[124:127]
  v_mfma_f32_16x16x32_bf16 v[128:131], v[24:27], v[64:67], v[128:131]
  v_mfma_f32_16x16x32_bf16 v[128:131], v[40:43], v[68:71], v[128:131]
  v_mfma_f32_16x16x32_bf16 v[144:147], v[40:43], v[76:79], v[144:147]
  v_mfma_f32_16x16x32_bf16 v[144:147], v[24:27], v[72:75], v[144:147]
  v_mfma_f32_16x16x32_bf16 v[148:151], v[28:31], v[72:75], v[148:151]
  ds_read_b128 v[72:75], v6 offset:16384
  v_mfma_f32_16x16x32_bf16 v[148:151], v[44:47], v[76:79], v[148:151]
  ds_read_b128 v[76:79], v8 offset:16384
  v_mfma_f32_16x16x32_bf16 v[132:135], v[44:47], v[68:71], v[132:135]
  ds_read_b128 v[68:71], v8 offset:14336
  s_waitcnt lgkmcnt(7)
  v_mfma_f32_16x16x32_bf16 v[132:135], v[28:31], v[64:67], v[132:135]
  ds_read_b128 v[64:67], v6 offset:14336
  v_mfma_f32_16x16x32_bf16 v[152:155], v[16:19], v[80:83], v[152:155]
  s_waitcnt lgkmcnt(4)
  v_mfma_f32_16x16x32_bf16 v[152:155], v[32:35], v[84:87], v[152:155]
  v_mfma_f32_16x16x32_bf16 v[168:171], v[32:35], v[52:55], v[168:171]
  v_mfma_f32_16x16x32_bf16 v[168:171], v[16:19], v[48:51], v[168:171]
  v_mfma_f32_16x16x32_bf16 v[172:175], v[20:23], v[48:51], v[172:175]
  v_mfma_f32_16x16x32_bf16 v[172:175], v[36:39], v[52:55], v[172:175]
  v_mfma_f32_16x16x32_bf16 v[156:159], v[36:39], v[84:87], v[156:159]
  v_mfma_f32_16x16x32_bf16 v[156:159], v[20:23], v[80:83], v[156:159]
  v_mfma_f32_16x16x32_bf16 v[160:163], v[24:27], v[80:83], v[160:163]
  v_mfma_f32_16x16x32_bf16 v[160:163], v[40:43], v[84:87], v[160:163]
  v_mfma_f32_16x16x32_bf16 v[176:179], v[40:43], v[52:55], v[176:179]
  v_mfma_f32_16x16x32_bf16 v[176:179], v[24:27], v[48:51], v[176:179]
  v_mfma_f32_16x16x32_bf16 v[180:183], v[28:31], v[48:51], v[180:183]
  v_mfma_f32_16x16x32_bf16 v[180:183], v[44:47], v[52:55], v[180:183]
  v_mfma_f32_16x16x32_bf16 v[164:167], v[44:47], v[84:87], v[164:167]
  ds_read_b128 v[84:87], v8 offset:18432
  v_mfma_f32_16x16x32_bf16 v[164:167], v[28:31], v[80:83], v[164:167]
  ds_read_b128 v[80:83], v6 offset:18432
  v_mfma_f32_16x16x32_bf16 v[184:187], v[16:19], v[56:59], v[184:187]
  s_waitcnt lgkmcnt(2)
  v_mfma_f32_16x16x32_bf16 v[184:187], v[32:35], v[60:63], v[184:187]
  v_mfma_f32_16x16x32_bf16 v[200:203], v[32:35], v[68:71], v[200:203]
  v_mfma_f32_16x16x32_bf16 v[200:203], v[16:19], v[64:67], v[200:203]
  v_mfma_f32_16x16x32_bf16 v[204:207], v[20:23], v[64:67], v[204:207]
  v_mfma_f32_16x16x32_bf16 v[204:207], v[36:39], v[68:71], v[204:207]
  s_waitcnt lgkmcnt(0)
  s_barrier
  v_mfma_f32_16x16x32_bf16 v[188:191], v[36:39], v[60:63], v[188:191]
  ds_read_b128 v[48:51], v5 offset:0
  v_mfma_f32_16x16x32_bf16 v[188:191], v[20:23], v[56:59], v[188:191]
  ds_read_b128 v[52:55], v7 offset:0
  v_mfma_f32_16x16x32_bf16 v[192:195], v[24:27], v[56:59], v[192:195]
  v_mfma_f32_16x16x32_bf16 v[192:195], v[40:43], v[60:63], v[192:195]
  v_mfma_f32_16x16x32_bf16 v[208:211], v[40:43], v[68:71], v[208:211]
  v_mfma_f32_16x16x32_bf16 v[208:211], v[24:27], v[64:67], v[208:211]
  v_mfma_f32_16x16x32_bf16 v[212:215], v[28:31], v[64:67], v[212:215]
  ds_read_b128 v[64:67], v5 offset:4096
  v_mfma_f32_16x16x32_bf16 v[212:215], v[44:47], v[68:71], v[212:215]
  ds_read_b128 v[68:71], v7 offset:4096
  v_mfma_f32_16x16x32_bf16 v[196:199], v[44:47], v[60:63], v[196:199]
  ds_read_b128 v[60:63], v7 offset:2048
  v_mfma_f32_16x16x32_bf16 v[196:199], v[28:31], v[56:59], v[196:199]
  ds_read_b128 v[56:59], v5 offset:2048
  v_mfma_f32_16x16x32_bf16 v[216:219], v[32:35], v[76:79], v[216:219]
  v_mfma_f32_16x16x32_bf16 v[216:219], v[16:19], v[72:75], v[216:219]
  v_mfma_f32_16x16x32_bf16 v[232:235], v[16:19], v[80:83], v[232:235]
  ds_read_b64_tr_b16 v[16:17], v1 offset:0
  v_mfma_f32_16x16x32_bf16 v[232:235], v[32:35], v[84:87], v[232:235]
  ds_read_b64_tr_b16 v[18:19], v1 offset:1024
  v_mfma_f32_16x16x32_bf16 v[236:239], v[36:39], v[84:87], v[236:239]
  ds_read_b64_tr_b16 v[32:33], v1 offset:8192
  v_mfma_f32_16x16x32_bf16 v[236:239], v[20:23], v[80:83], v[236:239]
  ds_read_b64_tr_b16 v[34:35], v1 offset:9216
  v_mfma_f32_16x16x32_bf16 v[220:223], v[20:23], v[72:75], v[220:223]
  ds_read_b64_tr_b16 v[20:21], v2 offset:0
  v_mfma_f32_16x16x32_bf16 v[220:223], v[36:39], v[76:79], v[220:223]
  ds_read_b64_tr_b16 v[22:23], v2 offset:1024
  v_mfma_f32_16x16x32_bf16 v[224:227], v[40:43], v[76:79], v[224:227]
  ds_read_b64_tr_b16 v[36:37], v2 offset:8192
  v_mfma_f32_16x16x32_bf16 v[224:227], v[24:27], v[72:75], v[224:227]
  ds_read_b64_tr_b16 v[38:39], v2 offset:9216
  v_mfma_f32_16x16x32_bf16 v[240:243], v[24:27], v[80:83], v[240:243]
  ds_read_b64_tr_b16 v[24:25], v3 offset:0
  v_mfma_f32_16x16x32_bf16 v[240:243], v[40:43], v[84:87], v[240:243]
  ds_read_b64_tr_b16 v[26:27], v3 offset:1024
  v_mfma_f32_16x16x32_bf16 v[244:247], v[44:47], v[84:87], v[244:247]
  ds_read_b64_tr_b16 v[40:41], v3 offset:8192
  v_mfma_f32_16x16x32_bf16 v[244:247], v[28:31], v[80:83], v[244:247]
  ds_read_b64_tr_b16 v[42:43], v3 offset:9216
  v_mfma_f32_16x16x32_bf16 v[228:231], v[28:31], v[72:75], v[228:231]
  ds_read_b64_tr_b16 v[28:29], v4 offset:0
  s_waitcnt lgkmcnt(9)
  v_mfma_f32_16x16x32_bf16 v[228:231], v[44:47], v[76:79], v[228:231]
  ds_read_b64_tr_b16 v[30:31], v4 offset:1024
  v_mfma_f32_16x16x32_bf16 v[88:91], v[16:19], v[48:51], v[88:91]
  ds_read_b64_tr_b16 v[44:45], v4 offset:8192
  v_mfma_f32_16x16x32_bf16 v[88:91], v[32:35], v[52:55], v[88:91]
  ds_read_b64_tr_b16 v[46:47], v4 offset:9216
  v_mfma_f32_16x16x32_bf16 v[104:107], v[32:35], v[60:63], v[104:107]
  ds_read_b128 v[72:75], v5 offset:6144
  s_waitcnt lgkmcnt(9)
  v_mfma_f32_16x16x32_bf16 v[104:107], v[16:19], v[56:59], v[104:107]
  ds_read_b128 v[76:79], v7 offset:6144
  v_mfma_f32_16x16x32_bf16 v[108:111], v[20:23], v[56:59], v[108:111]
  ds_read_b128 v[80:83], v5 offset:8192
  v_mfma_f32_16x16x32_bf16 v[108:111], v[36:39], v[60:63], v[108:111]
  ds_read_b128 v[84:87], v7 offset:8192
  v_mfma_f32_16x16x32_bf16 v[92:95], v[36:39], v[52:55], v[92:95]
  s_waitcnt lgkmcnt(8)
  v_mfma_f32_16x16x32_bf16 v[92:95], v[20:23], v[48:51], v[92:95]
  v_mfma_f32_16x16x32_bf16 v[96:99], v[24:27], v[48:51], v[96:99]
  v_xor_b32 v1, 16384, v1
  v_mfma_f32_16x16x32_bf16 v[96:99], v[40:43], v[52:55], v[96:99]
  v_xor_b32 v2, 16384, v2
  v_mfma_f32_16x16x32_bf16 v[112:115], v[40:43], v[60:63], v[112:115]
  v_xor_b32 v3, 16384, v3
  s_waitcnt lgkmcnt(4)
  v_mfma_f32_16x16x32_bf16 v[112:115], v[24:27], v[56:59], v[112:115]
  v_xor_b32 v4, 16384, v4
  v_mfma_f32_16x16x32_bf16 v[116:119], v[28:31], v[56:59], v[116:119]
  ds_read_b128 v[56:59], v5 offset:12288
  v_mfma_f32_16x16x32_bf16 v[116:119], v[44:47], v[60:63], v[116:119]
  ds_read_b128 v[60:63], v7 offset:12288
  v_mfma_f32_16x16x32_bf16 v[100:103], v[44:47], v[52:55], v[100:103]
  ds_read_b128 v[52:55], v7 offset:10240
  v_mfma_f32_16x16x32_bf16 v[100:103], v[28:31], v[48:51], v[100:103]
  ds_read_b128 v[48:51], v5 offset:10240
  v_mfma_f32_16x16x32_bf16 v[120:123], v[16:19], v[64:67], v[120:123]
  s_waitcnt lgkmcnt(6)
  v_mfma_f32_16x16x32_bf16 v[120:123], v[32:35], v[68:71], v[120:123]
  v_mfma_f32_16x16x32_bf16 v[136:139], v[32:35], v[76:79], v[136:139]
  v_mfma_f32_16x16x32_bf16 v[136:139], v[16:19], v[72:75], v[136:139]
  v_mfma_f32_16x16x32_bf16 v[140:143], v[20:23], v[72:75], v[140:143]
  v_mfma_f32_16x16x32_bf16 v[140:143], v[36:39], v[76:79], v[140:143]
  v_mfma_f32_16x16x32_bf16 v[124:127], v[36:39], v[68:71], v[124:127]
  v_mfma_f32_16x16x32_bf16 v[124:127], v[20:23], v[64:67], v[124:127]
  v_mfma_f32_16x16x32_bf16 v[128:131], v[24:27], v[64:67], v[128:131]
  v_mfma_f32_16x16x32_bf16 v[128:131], v[40:43], v[68:71], v[128:131]
  v_mfma_f32_16x16x32_bf16 v[144:147], v[40:43], v[76:79], v[144:147]
  v_mfma_f32_16x16x32_bf16 v[144:147], v[24:27], v[72:75], v[144:147]
  v_mfma_f32_16x16x32_bf16 v[148:151], v[28:31], v[72:75], v[148:151]
  ds_read_b128 v[72:75], v5 offset:16384
  v_mfma_f32_16x16x32_bf16 v[148:151], v[44:47], v[76:79], v[148:151]
  ds_read_b128 v[76:79], v7 offset:16384
  v_mfma_f32_16x16x32_bf16 v[132:135], v[44:47], v[68:71], v[132:135]
  ds_read_b128 v[68:71], v7 offset:14336
  s_waitcnt lgkmcnt(7)
  v_mfma_f32_16x16x32_bf16 v[132:135], v[28:31], v[64:67], v[132:135]
  ds_read_b128 v[64:67], v5 offset:14336
  v_mfma_f32_16x16x32_bf16 v[152:155], v[16:19], v[80:83], v[152:155]
  s_waitcnt lgkmcnt(4)
  v_mfma_f32_16x16x32_bf16 v[152:155], v[32:35], v[84:87], v[152:155]
  v_mfma_f32_16x16x32_bf16 v[168:171], v[32:35], v[52:55], v[168:171]
  v_mfma_f32_16x16x32_bf16 v[168:171], v[16:19], v[48:51], v[168:171]
  v_mfma_f32_16x16x32_bf16 v[172:175], v[20:23], v[48:51], v[172:175]
  v_mfma_f32_16x16x32_bf16 v[172:175], v[36:39], v[52:55], v[172:175]
  v_mfma_f32_16x16x32_bf16 v[156:159], v[36:39], v[84:87], v[156:159]
  v_mfma_f32_16x16x32_bf16 v[156:159], v[20:23], v[80:83], v[156:159]
  v_mfma_f32_16x16x32_bf16 v[160:163], v[24:27], v[80:83], v[160:163]
  v_mfma_f32_16x16x32_bf16 v[160:163], v[40:43], v[84:87], v[160:163]
  v_mfma_f32_16x16x32_bf16 v[176:179], v[40:43], v[52:55], v[176:179]
  v_mfma_f32_16x16x32_bf16 v[176:179], v[24:27], v[48:51], v[176:179]
  v_mfma_f32_16x16x32_bf16 v[180:183], v[28:31], v[48:51], v[180:183]
  v_mfma_f32_16x16x32_bf16 v[180:183], v[44:47], v[52:55], v[180:183]
  v_mfma_f32_16x16x32_bf16 v[164:167], v[44:47], v[84:87], v[164:167]
  ds_read_b128 v[84:87], v7 offset:18432
  v_mfma_f32_16x16x32_bf16 v[164:167], v[28:31], v[80:83], v[164:167]
  ds_read_b128 v[80:83], v5 offset:18432
  v_mfma_f32_16x16x32_bf16 v[184:187], v[16:19], v[56:59], v[184:187]
  s_waitcnt lgkmcnt(2)
  s_add_u32 s72, s72, 1
  s_cmp_lt_u32 s72, 8
  v_mfma_f32_16x16x32_bf16 v[184:187], v[32:35], v[60:63], v[184:187]
  v_mfma_f32_16x16x32_bf16 v[200:203], v[32:35], v[68:71], v[200:203]
  v_mfma_f32_16x16x32_bf16 v[200:203], v[16:19], v[64:67], v[200:203]
  v_mfma_f32_16x16x32_bf16 v[204:207], v[20:23], v[64:67], v[204:207]
  v_mfma_f32_16x16x32_bf16 v[204:207], v[36:39], v[68:71], v[204:207]
  s_waitcnt lgkmcnt(0)
  s_barrier
  v_mfma_f32_16x16x32_bf16 v[188:191], v[36:39], v[60:63], v[188:191]
  ds_read_b128 v[48:51], v5 offset:40960
  v_mfma_f32_16x16x32_bf16 v[188:191], v[20:23], v[56:59], v[188:191]
  ds_read_b128 v[52:55], v7 offset:40960
  v_mfma_f32_16x16x32_bf16 v[192:195], v[24:27], v[56:59], v[192:195]
  v_mfma_f32_16x16x32_bf16 v[192:195], v[40:43], v[60:63], v[192:195]
  v_mfma_f32_16x16x32_bf16 v[208:211], v[40:43], v[68:71], v[208:211]
  v_mfma_f32_16x16x32_bf16 v[208:211], v[24:27], v[64:67], v[208:211]
  v_mfma_f32_16x16x32_bf16 v[212:215], v[28:31], v[64:67], v[212:215]
  ds_read_b128 v[64:67], v5 offset:45056
  v_mfma_f32_16x16x32_bf16 v[212:215], v[44:47], v[68:71], v[212:215]
  ds_read_b128 v[68:71], v7 offset:45056
  v_mfma_f32_16x16x32_bf16 v[196:199], v[44:47], v[60:63], v[196:199]
  ds_read_b128 v[60:63], v7 offset:43008
  v_mfma_f32_16x16x32_bf16 v[196:199], v[28:31], v[56:59], v[196:199]
  ds_read_b128 v[56:59], v5 offset:43008
  v_mfma_f32_16x16x32_bf16 v[216:219], v[32:35], v[76:79], v[216:219]
  v_mfma_f32_16x16x32_bf16 v[216:219], v[16:19], v[72:75], v[216:219]
  v_mfma_f32_16x16x32_bf16 v[232:235], v[16:19], v[80:83], v[232:235]
  ds_read_b64_tr_b16 v[16:17], v1 offset:0
  v_mfma_f32_16x16x32_bf16 v[232:235], v[32:35], v[84:87], v[232:235]
  ds_read_b64_tr_b16 v[18:19], v1 offset:1024
  v_mfma_f32_16x16x32_bf16 v[236:239], v[36:39], v[84:87], v[236:239]
  ds_read_b64_tr_b16 v[32:33], v1 offset:8192
  v_mfma_f32_16x16x32_bf16 v[236:239], v[20:23], v[80:83], v[236:239]
  ds_read_b64_tr_b16 v[34:35], v1 offset:9216
  v_mfma_f32_16x16x32_bf16 v[220:223], v[20:23], v[72:75], v[220:223]
  ds_read_b64_tr_b16 v[20:21], v2 offset:0
  v_mfma_f32_16x16x32_bf16 v[220:223], v[36:39], v[76:79], v[220:223]
  ds_read_b64_tr_b16 v[22:23], v2 offset:1024
  v_mfma_f32_16x16x32_bf16 v[224:227], v[40:43], v[76:79], v[224:227]
  ds_read_b64_tr_b16 v[36:37], v2 offset:8192
  v_mfma_f32_16x16x32_bf16 v[224:227], v[24:27], v[72:75], v[224:227]
  ds_read_b64_tr_b16 v[38:39], v2 offset:9216
  v_mfma_f32_16x16x32_bf16 v[240:243], v[24:27], v[80:83], v[240:243]
  ds_read_b64_tr_b16 v[24:25], v3 offset:0
  v_mfma_f32_16x16x32_bf16 v[240:243], v[40:43], v[84:87], v[240:243]
  ds_read_b64_tr_b16 v[26:27], v3 offset:1024
  v_mfma_f32_16x16x32_bf16 v[244:247], v[44:47], v[84:87], v[244:247]
  ds_read_b64_tr_b16 v[40:41], v3 offset:8192
  v_mfma_f32_16x16x32_bf16 v[244:247], v[28:31], v[80:83], v[244:247]
  ds_read_b64_tr_b16 v[42:43], v3 offset:9216
  v_mfma_f32_16x16x32_bf16 v[228:231], v[28:31], v[72:75], v[228:231]
  ds_read_b64_tr_b16 v[28:29], v4 offset:0
  s_waitcnt lgkmcnt(9)
  v_mfma_f32_16x16x32_bf16 v[228:231], v[44:47], v[76:79], v[228:231]
  ds_read_b64_tr_b16 v[30:31], v4 offset:1024
  s_cbranch_scc1 L_dnn_loop0
L_tail:
  v_mfma_f32_16x16x32_bf16 v[88:91], v[16:19], v[48:51], v[88:91]
  ds_read_b64_tr_b16 v[44:45], v4 offset:8192
  v_mfma_f32_16x16x32_bf16 v[88:91], v[32:35], v[52:55], v[88:91]
  ds_read_b64_tr_b16 v[46:47], v4 offset:9216
  v_mfma_f32_16x16x32_bf16 v[104:107], v[32:35], v[60:63], v[104:107]
  ds_read_b128 v[72:75], v5 offset:47104
  s_waitcnt lgkmcnt(9)
  v_mfma_f32_16x16x32_bf16 v[104:107], v[16:19], v[56:59], v[104:107]
  ds_read_b128 v[76:79], v7 offset:47104
  v_mfma_f32_16x16x32_bf16 v[108:111], v[20:23], v[56:59], v[108:111]
  ds_read_b128 v[80:83], v5 offset:49152
  v_mfma_f32_16x16x32_bf16 v[108:111], v[36:39], v[60:63], v[108:111]
  ds_read_b128 v[84:87], v7 offset:49152
  v_mul_f32 v11, v88, v88
  v_mfma_f32_16x16x32_bf16 v[92:95], v[36:39], v[52:55], v[92:95]
  s_waitcnt lgkmcnt(8)
  v_mul_f32 v248, v89, v89
  v_mul_f32 v249, v90, v90
  v_mfma_f32_16x16x32_bf16 v[92:95], v[20:23], v[48:51], v[92:95]
  v_mul_f32 v250, v91, v91
  v_fma_f32 v11, v11, v14, v12
  v_mfma_f32_16x16x32_bf16 v[96:99], v[24:27], v[48:51], v[96:99]
  v_fma_f32 v248, v248, v14, v12
  v_fma_f32 v249, v249, v14, v12
  v_mfma_f32_16x16x32_bf16 v[96:99], v[40:43], v[52:55], v[96:99]
  v_fma_f32 v250, v250, v14, v12
  v_mul_f32 v11, v11, v88
  v_mfma_f32_16x16x32_bf16 v[112:115], v[40:43], v[60:63], v[112:115]
  s_waitcnt lgkmcnt(4)
  v_mul_f32 v248, v248, v89
  v_mul_f32 v249, v249, v90
  v_mfma_f32_16x16x32_bf16 v[112:115], v[24:27], v[56:59], v[112:115]
  v_mul_f32_e64 v250, v250, v91
  v_mfma_f32_16x16x32_bf16 v[116:119], v[28:31], v[56:59], v[116:119]
  ds_read_b128 v[56:59], v5 offset:53248
  v_mfma_f32_16x16x32_bf16 v[116:119], v[44:47], v[60:63], v[116:119]
  ds_read_b128 v[60:63], v7 offset:53248
  v_mfma_f32_16x16x32_bf16 v[100:103], v[44:47], v[52:55], v[100:103]
  ds_read_b128 v[52:55], v7 offset:51200
  v_mfma_f32_16x16x32_bf16 v[100:103], v[28:31], v[48:51], v[100:103]
  ds_read_b128 v[48:51], v5 offset:51200
  v_mfma_f32_16x16x32_bf16 v[120:123], v[16:19], v[64:67], v[120:123]
  s_waitcnt lgkmcnt(6)
  v_exp_f32 v11, v11
  v_mfma_f32_16x16x32_bf16 v[120:123], v[32:35], v[68:71], v[120:123]
  v_exp_f32 v248, v248
  v_mfma_f32_16x16x32_bf16 v[136:139], v[32:35], v[76:79], v[136:139]
  v_exp_f32 v249, v249
  v_mfma_f32_16x16x32_bf16 v[136:139], v[16:19], v[72:75], v[136:139]
  v_exp_f32_e64 v250, v250
  v_mfma_f32_16x16x32_bf16 v[140:143], v[20:23], v[72:75], v[140:143]
  v_add_f32 v11, 1.0, v11
  v_add_f32 v248, 1.0, v248
  v_mfma_f32_16x16x32_bf16 v[140:143], v[36:39], v[76:79], v[140:143]
  v_add_f32 v249, 1.0, v249
  v_add_f32 v250, 1.0, v250
  v_mfma_f32_16x16x32_bf16 v[124:127], v[36:39], v[68:71], v[124:127]
  v_rcp_f32 v11, v11
  v_mfma_f32_16x16x32_bf16 v[124:127], v[20:23], v[64:67], v[124:127]
  v_rcp_f32 v248, v248
  v_mfma_f32_16x16x32_bf16 v[128:131], v[24:27], v[64:67], v[128:131]
  v_rcp_f32 v249, v249
  v_mfma_f32_16x16x32_bf16 v[128:131], v[40:43], v[68:71], v[128:131]
  v_rcp_f32 v250, v250
  v_mfma_f32_16x16x32_bf16 v[144:147], v[40:43], v[76:79], v[144:147]
  v_mul_f32 v88, v88, v11
  v_mul_f32 v89, v89, v248
  v_mfma_f32_16x16x32_bf16 v[144:147], v[24:27], v[72:75], v[144:147]
  v_mul_f32 v90, v90, v249
  v_mul_f32 v91, v91, v250
  v_mfma_f32_16x16x32_bf16 v[148:151], v[28:31], v[72:75], v[148:151]
  ds_read_b128 v[72:75], v5 offset:57344
  v_mul_f32 v11, v92, v92
  v_mfma_f32_16x16x32_bf16 v[148:151], v[44:47], v[76:79], v[148:151]
  ds_read_b128 v[76:79], v7 offset:57344
  v_mul_f32 v248, v93, v93
  v_mfma_f32_16x16x32_bf16 v[132:135], v[44:47], v[68:71], v[132:135]
  ds_read_b128 v[68:71], v7 offset:55296
  s_waitcnt lgkmcnt(7)
  v_mul_f32 v249, v94, v94
  v_mfma_f32_16x16x32_bf16 v[132:135], v[28:31], v[64:67], v[132:135]
  ds_read_b128 v[64:67], v5 offset:55296
  v_mul_f32 v250, v95, v95
  v_mfma_f32_16x16x32_bf16 v[152:155], v[16:19], v[80:83], v[152:155]
  s_waitcnt lgkmcnt(4)
  v_fma_f32 v11, v11, v14, v12
  v_fma_f32 v248, v248, v14, v12
  v_mfma_f32_16x16x32_bf16 v[152:155], v[32:35], v[84:87], v[152:155]
  v_fma_f32 v249, v249, v14, v12
  v_fma_f32 v250, v250, v14, v12
  v_mfma_f32_16x16x32_bf16 v[168:171], v[32:35], v[52:55], v[168:171]
  v_mul_f32 v11, v11, v92
  v_mul_f32 v248, v248, v93
  v_mfma_f32_16x16x32_bf16 v[168:171], v[16:19], v[48:51], v[168:171]
  v_mul_f32 v249, v249, v94
  v_mul_f32 v250, v250, v95
  v_mfma_f32_16x16x32_bf16 v[172:175], v[20:23], v[48:51], v[172:175]
  v_exp_f32 v11, v11
  v_mfma_f32_16x16x32_bf16 v[172:175], v[36:39], v[52:55], v[172:175]
  v_exp_f32 v248, v248
  v_mfma_f32_16x16x32_bf16 v[156:159], v[36:39], v[84:87], v[156:159]
  v_exp_f32_e64 v249, v249
  v_mfma_f32_16x16x32_bf16 v[156:159], v[20:23], v[80:83], v[156:159]
  v_exp_f32 v250, v250
  v_mfma_f32_16x16x32_bf16 v[160:163], v[24:27], v[80:83], v[160:163]
  v_add_f32 v11, 1.0, v11
  v_add_f32 v248, 1.0, v248
  v_mfma_f32_16x16x32_bf16 v[160:163], v[40:43], v[84:87], v[160:163]
  v_add_f32 v249, 1.0, v249
  v_add_f32 v250, 1.0, v250
  v_mfma_f32_16x16x32_bf16 v[176:179], v[40:43], v[52:55], v[176:179]
  v_rcp_f32 v11, v11
  v_mfma_f32_16x16x32_bf16 v[176:179], v[24:27], v[48:51], v[176:179]
  v_rcp_f32 v248, v248
  v_mfma_f32_16x16x32_bf16 v[180:183], v[28:31], v[48:51], v[180:183]
  v_rcp_f32 v249, v249
  v_mfma_f32_16x16x32_bf16 v[180:183], v[44:47], v[52:55], v[180:183]
  v_rcp_f32 v250, v250
  v_mfma_f32_16x16x32_bf16 v[164:167], v[44:47], v[84:87], v[164:167]
  ds_read_b128 v[84:87], v7 offset:59392
  v_mul_f32 v92, v92, v11
  v_mfma_f32_16x16x32_bf16 v[164:167], v[28:31], v[80:83], v[164:167]
  ds_read_b128 v[80:83], v5 offset:59392
  v_mul_f32 v93, v93, v248
  v_mfma_f32_16x16x32_bf16 v[184:187], v[16:19], v[56:59], v[184:187]
  s_waitcnt lgkmcnt(2)
  v_mul_f32 v94, v94, v249
  v_mul_f32 v95, v95, v250
  v_mfma_f32_16x16x32_bf16 v[184:187], v[32:35], v[60:63], v[184:187]
  v_mul_f32 v11, v96, v96
  v_mul_f32 v248, v97, v97
  v_mfma_f32_16x16x32_bf16 v[200:203], v[32:35], v[68:71], v[200:203]
  v_mul_f32 v249, v98, v98
  v_mul_f32 v250, v99, v99
  v_mfma_f32_16x16x32_bf16 v[200:203], v[16:19], v[64:67], v[200:203]
  v_fma_f32 v11, v11, v14, v12
  v_fma_f32 v248, v248, v14, v12
  v_mfma_f32_16x16x32_bf16 v[204:207], v[20:23], v[64:67], v[204:207]
  v_fma_f32 v249, v249, v14, v12
  v_fma_f32 v250, v250, v14, v12
  v_mfma_f32_16x16x32_bf16 v[204:207], v[36:39], v[68:71], v[204:207]
  v_mul_f32 v11, v11, v96
  v_mul_f32 v248, v248, v97
  v_mfma_f32_16x16x32_bf16 v[188:191], v[36:39], v[60:63], v[188:191]
  v_mul_f32 v249, v249, v98
  v_mul_f32 v250, v250, v99
  v_mfma_f32_16x16x32_bf16 v[188:191], v[20:23], v[56:59], v[188:191]
  v_exp_f32 v11, v11
  v_mfma_f32_16x16x32_bf16 v[192:195], v[24:27], v[56:59], v[192:195]
  v_exp_f32 v248, v248
  v_mfma_f32_16x16x32_bf16 v[192:195], v[40:43], v[60:63], v[192:195]
  v_exp_f32 v249, v249
  v_mfma_f32_16x16x32_bf16 v[208:211], v[40:43], v[68:71], v[208:211]
  v_exp_f32 v250, v250
  v_mfma_f32_16x16x32_bf16 v[208:211], v[24:27], v[64:67], v[208:211]
  v_add_f32 v11, 1.0, v11
  v_add_f32 v248, 1.0, v248
  v_mfma_f32_16x16x32_bf16 v[212:215], v[28:31], v[64:67], v[212:215]
  v_add_f32 v249, 1.0, v249
  v_add_f32 v250, 1.0, v250
  v_mfma_f32_16x16x32_bf16 v[212:215], v[44:47], v[68:71], v[212:215]
  v_rcp_f32 v11, v11
  v_mfma_f32_16x16x32_bf16 v[196:199], v[44:47], v[60:63], v[196:199]
  v_rcp_f32 v248, v248
  v_mfma_f32_16x16x32_bf16 v[196:199], v[28:31], v[56:59], v[196:199]
  v_rcp_f32_e64 v249, v249
  v_mfma_f32_16x16x32_bf16 v[216:219], v[32:35], v[76:79], v[216:219]
  s_waitcnt lgkmcnt(0)
  v_rcp_f32 v250, v250
  v_mfma_f32_16x16x32_bf16 v[216:219], v[16:19], v[72:75], v[216:219]
  v_mul_f32 v96, v96, v11
  v_mul_f32 v97, v97, v248
  v_mfma_f32_16x16x32_bf16 v[232:235], v[16:19], v[80:83], v[232:235]
  v_mul_f32 v98, v98, v249
  v_mul_f32 v99, v99, v250
  v_mfma_f32_16x16x32_bf16 v[232:235], v[32:35], v[84:87], v[232:235]
  v_mul_f32 v11, v100, v100
  v_mul_f32 v248, v101, v101
  v_mfma_f32_16x16x32_bf16 v[236:239], v[36:39], v[84:87], v[236:239]
  v_mul_f32 v249, v102, v102
  v_mul_f32 v250, v103, v103
  v_mfma_f32_16x16x32_bf16 v[236:239], v[20:23], v[80:83], v[236:239]
  v_fma_f32 v11, v11, v14, v12
  v_fma_f32 v248, v248, v14, v12
  v_mfma_f32_16x16x32_bf16 v[220:223], v[20:23], v[72:75], v[220:223]
  v_fma_f32 v249, v249, v14, v12
  v_fma_f32 v250, v250, v14, v12
  v_mfma_f32_16x16x32_bf16 v[220:223], v[36:39], v[76:79], v[220:223]
  v_mul_f32 v11, v11, v100
  v_mul_f32 v248, v248, v101
  v_mfma_f32_16x16x32_bf16 v[224:227], v[40:43], v[76:79], v[224:227]
  v_mul_f32 v249, v249, v102
  v_mul_f32 v250, v250, v103
  v_mfma_f32_16x16x32_bf16 v[224:227], v[24:27], v[72:75], v[224:227]
  v_exp_f32 v11, v11
  v_mfma_f32_16x16x32_bf16 v[240:243], v[24:27], v[80:83], v[240:243]
  v_exp_f32 v248, v248
  v_mfma_f32_16x16x32_bf16 v[240:243], v[40:43], v[84:87], v[240:243]
  v_exp_f32 v249, v249
  v_mfma_f32_16x16x32_bf16 v[244:247], v[44:47], v[84:87], v[244:247]
  v_exp_f32 v250, v250
  v_mfma_f32_16x16x32_bf16 v[244:247], v[28:31], v[80:83], v[244:247]
  v_add_f32 v11, 1.0, v11
  v_add_f32 v248, 1.0, v248
  v_mfma_f32_16x16x32_bf16 v[228:231], v[28:31], v[72:75], v[228:231]
  v_add_f32 v249, 1.0, v249
  v_add_f32 v250, 1.0, v250
  v_mfma_f32_16x16x32_bf16 v[228:231], v[44:47], v[76:79], v[228:231]
  v_rcp_f32 v11, v11
  v_rcp_f32 v248, v248
  v_rcp_f32 v249, v249
  v_rcp_f32 v250, v250
  v_mul_f32 v100, v100, v11
  v_mul_f32 v101, v101, v248
  v_mul_f32 v102, v102, v249
  v_mul_f32 v103, v103, v250
  ds_read_b64 v[18:19], v9 offset:256
  ds_read_b64 v[22:23], v9 offset:288
  ds_read_b64 v[26:27], v9 offset:320
  ds_read_b64 v[30:31], v9 offset:352
  v_mov_b32 v248, 1.0
  v_mov_b32 v249, 1.0
L_epi:
  v_mov_b32 v84, 0xc1c00000
  v_mov_b32 v85, 0xc1c00000
  v_mov_b32 v86, 0x4b800000
  v_mov_b32 v87, 0x4b800000
  v_pk_mul_f32 v[52:53], v[104:105], v[104:105]
  v_pk_mul_f32 v[56:57], v[106:107], v[106:107]
  v_pk_mul_f32 v[60:61], v[108:109], v[108:109]
  v_pk_mul_f32 v[64:65], v[110:111], v[110:111]
  v_pk_mul_f32 v[68:69], v[120:121], v[120:121]
  v_pk_mul_f32 v[72:73], v[122:123], v[122:123]
  v_pk_mul_f32 v[76:77], v[124:125], v[124:125]
  v_pk_mul_f32 v[80:81], v[126:127], v[126:127]
  v_pk_fma_f32 v[52:53], v[52:53], v[14:15], v[12:13]
  v_pk_fma_f32 v[56:57], v[56:57], v[14:15], v[12:13]
  v_pk_fma_f32 v[60:61], v[60:61], v[14:15], v[12:13]
  v_pk_fma_f32 v[64:65], v[64:65], v[14:15], v[12:13]
  v_pk_fma_f32 v[68:69], v[68:69], v[14:15], v[12:13]
  v_pk_fma_f32 v[72:73], v[72:73], v[14:15], v[12:13]
  v_pk_fma_f32 v[76:77], v[76:77], v[14:15], v[12:13]
  v_pk_fma_f32 v[80:81], v[80:81], v[14:15], v[12:13]
  v_pk_fma_f32 v[52:53], v[52:53], v[104:105], v[84:85]
  v_pk_fma_f32 v[56:57], v[56:57], v[106:107], v[84:85]
  v_pk_fma_f32 v[60:61], v[60:61], v[108:109], v[84:85]
  v_pk_fma_f32 v[64:65], v[64:65], v[110:111], v[84:85]
  v_pk_fma_f32 v[68:69], v[68:69], v[120:121], v[84:85]
  v_pk_fma_f32 v[72:73], v[72:73], v[122:123], v[84:85]
  v_pk_fma_f32 v[76:77], v[76:77], v[124:125], v[84:85]
  v_pk_fma_f32 v[80:81], v[80:81], v[126:127], v[84:85]
  v_exp_f32 v52, v52 clamp
  v_exp_f32 v53, v53 clamp
  v_exp_f32 v56, v56 clamp
  v_exp_f32 v57, v57 clamp
  v_exp_f32 v60, v60 clamp
  v_exp_f32 v61, v61 clamp
  v_exp_f32 v64, v64 clamp
  v_exp_f32 v65, v65 clamp
  v_exp_f32 v68, v68 clamp
  v_exp_f32 v69, v69 clamp
  v_exp_f32 v72, v72 clamp
  v_exp_f32 v73, v73 clamp
  v_exp_f32 v76, v76 clamp
  v_exp_f32 v77, v77 clamp
  v_exp_f32 v80, v80 clamp
  v_exp_f32 v81, v81 clamp
  s_waitcnt lgkmcnt(3)
  v_lshlrev_b32 v16, 16, v18
  v_and_b32 v17, 0xffff0000, v18
  v_lshlrev_b32 v18, 16, v19
  v_and_b32 v19, 0xffff0000, v19
  s_waitcnt lgkmcnt(2)
  v_lshlrev_b32 v20, 16, v22
  v_and_b32 v21, 0xffff0000, v22
  v_lshlrev_b32 v22, 16, v23
  v_and_b32 v23, 0xffff0000, v23
  s_waitcnt lgkmcnt(1)
  v_lshlrev_b32 v24, 16, v26
  v_and_b32 v25, 0xffff0000, v26
  v_lshlrev_b32 v26, 16, v27
  v_and_b32 v27, 0xffff0000, v27
  s_waitcnt lgkmcnt(0)
  v_lshlrev_b32_e64 v28, 16, v30
  v_and_b32 v29, 0xffff0000, v30
  v_lshlrev_b32_e64 v30, 16, v31
  v_and_b32 v31, 0xffff0000, v31
  v_pk_mul_f32 v[54:55], v[104:105], v[16:17]
  v_pk_mul_f32 v[58:59], v[106:107], v[18:19]
  v_pk_mul_f32 v[62:63], v[108:109], v[20:21]
  v_pk_mul_f32 v[66:67], v[110:111], v[22:23]
  v_pk_mul_f32 v[70:71], v[120:121], v[16:17]
  v_pk_mul_f32 v[74:75], v[122:123], v[18:19]
  v_pk_mul_f32 v[78:79], v[124:125], v[20:21]
  v_pk_mul_f32 v[82:83], v[126:127], v[22:23]
  v_pk_fma_f32 v[52:53], v[52:53], v[86:87], v[248:249]
  v_pk_fma_f32 v[56:57], v[56:57], v[86:87], v[248:249]
  v_pk_fma_f32 v[60:61], v[60:61], v[86:87], v[248:249]
  v_pk_fma_f32 v[64:65], v[64:65], v[86:87], v[248:249]
  v_pk_fma_f32 v[68:69], v[68:69], v[86:87], v[248:249]
  v_pk_fma_f32 v[72:73], v[72:73], v[86:87], v[248:249]
  v_pk_fma_f32 v[76:77], v[76:77], v[86:87], v[248:249]
  v_pk_fma_f32 v[80:81], v[80:81], v[86:87], v[248:249]
  v_pk_mul_f32 v[54:55], v[54:55], v[56:57]
  v_pk_mul_f32 v[62:63], v[62:63], v[64:65]
  v_pk_mul_f32 v[70:71], v[70:71], v[72:73]
  v_pk_mul_f32 v[78:79], v[78:79], v[80:81]
  v_pk_fma_f32 v[54:55], v[58:59], v[52:53], v[54:55]
  v_pk_fma_f32 v[62:63], v[66:67], v[60:61], v[62:63]
  v_pk_fma_f32 v[70:71], v[74:75], v[68:69], v[70:71]
  v_pk_fma_f32 v[78:79], v[82:83], v[76:77], v[78:79]
  v_pk_mul_f32 v[52:53], v[52:53], v[56:57]
  v_pk_mul_f32 v[60:61], v[60:61], v[64:65]
  v_pk_mul_f32 v[68:69], v[68:69], v[72:73]
  v_pk_mul_f32 v[76:77], v[76:77], v[80:81]
  v_pk_mul_f32 v[54:55], v[54:55], v[60:61]
  v_pk_mul_f32 v[70:71], v[70:71], v[76:77]
  v_pk_fma_f32 v[54:55], v[62:63], v[52:53], v[54:55]
  v_pk_fma_f32 v[70:71], v[78:79], v[68:69], v[70:71]
  v_pk_mul_f32 v[52:53], v[52:53], v[60:61]
  v_pk_mul_f32 v[68:69], v[68:69], v[76:77]
  v_rcp_f32 v52, v52
  v_rcp_f32 v53, v53
  v_rcp_f32 v68, v68
  v_rcp_f32 v69, v69
  v_pk_mul_f32 v[34:35], v[52:53], v[54:55]
  v_pk_mul_f32 v[36:37], v[68:69], v[70:71]
  v_pk_mul_f32 v[52:53], v[112:113], v[112:113]
  v_pk_mul_f32 v[56:57], v[114:115], v[114:115]
  v_pk_mul_f32 v[60:61], v[116:117], v[116:117]
  v_pk_mul_f32 v[64:65], v[118:119], v[118:119]
  v_pk_mul_f32 v[68:69], v[128:129], v[128:129]
  v_pk_mul_f32 v[72:73], v[130:131], v[130:131]
  v_pk_mul_f32 v[76:77], v[132:133], v[132:133]
  v_pk_mul_f32 v[80:81], v[134:135], v[134:135]
  v_pk_fma_f32 v[52:53], v[52:53], v[14:15], v[12:13]
  v_pk_fma_f32 v[56:57], v[56:57], v[14:15], v[12:13]
  v_pk_fma_f32 v[60:61], v[60:61], v[14:15], v[12:13]
  v_pk_fma_f32 v[64:65], v[64:65], v[14:15], v[12:13]
  v_pk_fma_f32 v[68:69], v[68:69], v[14:15], v[12:13]
  v_pk_fma_f32 v[72:73], v[72:73], v[14:15], v[12:13]
  v_pk_fma_f32 v[76:77], v[76:77], v[14:15], v[12:13]
  v_pk_fma_f32 v[80:81], v[80:81], v[14:15], v[12:13]
  v_pk_fma_f32 v[52:53], v[52:53], v[112:113], v[84:85]
  v_pk_fma_f32 v[56:57], v[56:57], v[114:115], v[84:85]
  v_pk_fma_f32 v[60:61], v[60:61], v[116:117], v[84:85]
  v_pk_fma_f32 v[64:65], v[64:65], v[118:119], v[84:85]
  v_pk_fma_f32 v[68:69], v[68:69], v[128:129], v[84:85]
  v_pk_fma_f32 v[72:73], v[72:73], v[130:131], v[84:85]
  v_pk_fma_f32 v[76:77], v[76:77], v[132:133], v[84:85]
  v_pk_fma_f32 v[80:81], v[80:81], v[134:135], v[84:85]
  v_exp_f32 v52, v52 clamp
  v_exp_f32 v53, v53 clamp
  v_exp_f32 v56, v56 clamp
  v_exp_f32 v57, v57 clamp
  v_exp_f32 v60, v60 clamp
  v_exp_f32 v61, v61 clamp
  v_exp_f32 v64, v64 clamp
  v_exp_f32 v65, v65 clamp
  v_exp_f32 v68, v68 clamp
  v_exp_f32 v69, v69 clamp
  v_exp_f32 v72, v72 clamp
  v_exp_f32 v73, v73 clamp
  v_exp_f32 v76, v76 clamp
  v_exp_f32 v77, v77 clamp
  v_exp_f32 v80, v80 clamp
  v_exp_f32 v81, v81 clamp
  v_pk_mul_f32 v[54:55], v[112:113], v[24:25]
  v_pk_mul_f32 v[58:59], v[114:115], v[26:27]
  v_pk_mul_f32 v[62:63], v[116:117], v[28:29]
  v_pk_mul_f32 v[66:67], v[118:119], v[30:31]
  v_pk_mul_f32 v[70:71], v[128:129], v[24:25]
  v_pk_mul_f32 v[74:75], v[130:131], v[26:27]
  v_pk_mul_f32 v[78:79], v[132:133], v[28:29]
  v_pk_mul_f32 v[82:83], v[134:135], v[30:31]
  v_pk_fma_f32 v[52:53], v[52:53], v[86:87], v[248:249]
  v_pk_fma_f32 v[56:57], v[56:57], v[86:87], v[248:249]
  v_pk_fma_f32 v[60:61], v[60:61], v[86:87], v[248:249]
  v_pk_fma_f32 v[64:65], v[64:65], v[86:87], v[248:249]
  v_pk_fma_f32 v[68:69], v[68:69], v[86:87], v[248:249]
  v_pk_fma_f32 v[72:73], v[72:73], v[86:87], v[248:249]
  v_pk_fma_f32 v[76:77], v[76:77], v[86:87], v[248:249]
  v_pk_fma_f32 v[80:81], v[80:81], v[86:87], v[248:249]
  v_pk_mul_f32 v[54:55], v[54:55], v[56:57]
  v_pk_mul_f32 v[62:63], v[62:63], v[64:65]
  v_pk_mul_f32 v[70:71], v[70:71], v[72:73]
  v_pk_mul_f32 v[78:79], v[78:79], v[80:81]
  v_pk_fma_f32 v[54:55], v[58:59], v[52:53], v[54:55]
  v_pk_fma_f32 v[62:63], v[66:67], v[60:61], v[62:63]
  v_pk_fma_f32 v[70:71], v[74:75], v[68:69], v[70:71]
  v_pk_fma_f32 v[78:79], v[82:83], v[76:77], v[78:79]
  v_pk_mul_f32 v[52:53], v[52:53], v[56:57]
  v_pk_mul_f32 v[60:61], v[60:61], v[64:65]
  v_pk_mul_f32 v[68:69], v[68:69], v[72:73]
  v_pk_mul_f32 v[76:77], v[76:77], v[80:81]
  v_pk_mul_f32 v[54:55], v[54:55], v[60:61]
  v_pk_mul_f32 v[70:71], v[70:71], v[76:77]
  v_pk_fma_f32 v[54:55], v[62:63], v[52:53], v[54:55]
  v_pk_fma_f32 v[70:71], v[78:79], v[68:69], v[70:71]
  v_pk_mul_f32 v[52:53], v[52:53], v[60:61]
  v_pk_mul_f32 v[68:69], v[68:69], v[76:77]
  v_rcp_f32 v52, v52
  v_rcp_f32 v53, v53
  v_rcp_f32 v68, v68
  v_rcp_f32 v69, v69
  v_pk_fma_f32 v[34:35], v[52:53], v[54:55], v[34:35]
  v_pk_fma_f32 v[36:37], v[68:69], v[70:71], v[36:37]
  v_pk_mul_f32 v[52:53], v[136:137], v[136:137]
  v_pk_mul_f32 v[56:57], v[138:139], v[138:139]
  v_pk_mul_f32 v[60:61], v[140:141], v[140:141]
  v_pk_mul_f32 v[64:65], v[142:143], v[142:143]
  v_pk_mul_f32 v[68:69], v[152:153], v[152:153]
  v_pk_mul_f32 v[72:73], v[154:155], v[154:155]
  v_pk_mul_f32 v[76:77], v[156:157], v[156:157]
  v_pk_mul_f32 v[80:81], v[158:159], v[158:159]
  v_pk_fma_f32 v[52:53], v[52:53], v[14:15], v[12:13]
  v_pk_fma_f32 v[56:57], v[56:57], v[14:15], v[12:13]
  v_pk_fma_f32 v[60:61], v[60:61], v[14:15], v[12:13]
  v_pk_fma_f32 v[64:65], v[64:65], v[14:15], v[12:13]
  v_pk_fma_f32 v[68:69], v[68:69], v[14:15], v[12:13]
  v_pk_fma_f32 v[72:73], v[72:73], v[14:15], v[12:13]
  v_pk_fma_f32 v[76:77], v[76:77], v[14:15], v[12:13]
  v_pk_fma_f32 v[80:81], v[80:81], v[14:15], v[12:13]
  v_pk_fma_f32 v[52:53], v[52:53], v[136:137], v[84:85]
  v_pk_fma_f32 v[56:57], v[56:57], v[138:139], v[84:85]
  v_pk_fma_f32 v[60:61], v[60:61], v[140:141], v[84:85]
  v_pk_fma_f32 v[64:65], v[64:65], v[142:143], v[84:85]
  v_pk_fma_f32 v[68:69], v[68:69], v[152:153], v[84:85]
  v_pk_fma_f32 v[72:73], v[72:73], v[154:155], v[84:85]
  v_pk_fma_f32 v[76:77], v[76:77], v[156:157], v[84:85]
  v_pk_fma_f32 v[80:81], v[80:81], v[158:159], v[84:85]
  v_exp_f32 v52, v52 clamp
  v_exp_f32 v53, v53 clamp
  v_exp_f32 v56, v56 clamp
  v_exp_f32 v57, v57 clamp
  v_exp_f32 v60, v60 clamp
  v_exp_f32 v61, v61 clamp
  v_exp_f32 v64, v64 clamp
  v_exp_f32 v65, v65 clamp
  v_exp_f32 v68, v68 clamp
  v_exp_f32 v69, v69 clamp
  v_exp_f32 v72, v72 clamp
  v_exp_f32 v73, v73 clamp
  v_exp_f32 v76, v76 clamp
  v_exp_f32 v77, v77 clamp
  v_exp_f32 v80, v80 clamp
  v_exp_f32 v81, v81 clamp
  v_pk_mul_f32 v[54:55], v[136:137], v[16:17]
  v_pk_mul_f32 v[58:59], v[138:139], v[18:19]
  v_pk_mul_f32 v[62:63], v[140:141], v[20:21]
  v_pk_mul_f32 v[66:67], v[142:143], v[22:23]
  v_pk_mul_f32 v[70:71], v[152:153], v[16:17]
  v_pk_mul_f32 v[74:75], v[154:155], v[18:19]
  v_pk_mul_f32 v[78:79], v[156:157], v[20:21]
  v_pk_mul_f32 v[82:83], v[158:159], v[22:23]
  v_pk_fma_f32 v[52:53], v[52:53], v[86:87], v[248:249]
  v_pk_fma_f32 v[56:57], v[56:57], v[86:87], v[248:249]
  v_pk_fma_f32 v[60:61], v[60:61], v[86:87], v[248:249]
  v_pk_fma_f32 v[64:65], v[64:65], v[86:87], v[248:249]
  v_pk_fma_f32 v[68:69], v[68:69], v[86:87], v[248:249]
  v_pk_fma_f32 v[72:73], v[72:73], v[86:87], v[248:249]
  v_pk_fma_f32 v[76:77], v[76:77], v[86:87], v[248:249]
  v_pk_fma_f32 v[80:81], v[80:81], v[86:87], v[248:249]
  v_pk_mul_f32 v[54:55], v[54:55], v[56:57]
  v_pk_mul_f32 v[62:63], v[62:63], v[64:65]
  v_pk_mul_f32 v[70:71], v[70:71], v[72:73]
  v_pk_mul_f32 v[78:79], v[78:79], v[80:81]
  v_pk_fma_f32 v[54:55], v[58:59], v[52:53], v[54:55]
  v_pk_fma_f32 v[62:63], v[66:67], v[60:61], v[62:63]
  v_pk_fma_f32 v[70:71], v[74:75], v[68:69], v[70:71]
  v_pk_fma_f32 v[78:79], v[82:83], v[76:77], v[78:79]
  v_pk_mul_f32 v[52:53], v[52:53], v[56:57]
  v_pk_mul_f32 v[60:61], v[60:61], v[64:65]
  v_pk_mul_f32 v[68:69], v[68:69], v[72:73]
  v_pk_mul_f32 v[76:77], v[76:77], v[80:81]
  v_pk_mul_f32 v[54:55], v[54:55], v[60:61]
  v_pk_mul_f32 v[70:71], v[70:71], v[76:77]
  v_pk_fma_f32 v[54:55], v[62:63], v[52:53], v[54:55]
  v_pk_fma_f32 v[70:71], v[78:79], v[68:69], v[70:71]
  v_pk_mul_f32 v[52:53], v[52:53], v[60:61]
  v_pk_mul_f32 v[68:69], v[68:69], v[76:77]
  v_rcp_f32 v52, v52
  v_rcp_f32 v53, v53
  v_rcp_f32 v68, v68
  v_rcp_f32 v69, v69
  v_pk_mul_f32 v[38:39], v[52:53], v[54:55]
  v_pk_mul_f32 v[40:41], v[68:69], v[70:71]
  v_pk_mul_f32 v[52:53], v[144:145], v[144:145]
  v_pk_mul_f32 v[56:57], v[146:147], v[146:147]
  v_pk_mul_f32 v[60:61], v[148:149], v[148:149]
  v_pk_mul_f32 v[64:65], v[150:151], v[150:151]
  v_pk_mul_f32 v[68:69], v[160:161], v[160:161]
  v_pk_mul_f32 v[72:73], v[162:163], v[162:163]
  v_pk_mul_f32 v[76:77], v[164:165], v[164:165]
  v_pk_mul_f32 v[80:81], v[166:167], v[166:167]
  v_pk_fma_f32 v[52:53], v[52:53], v[14:15], v[12:13]
  v_pk_fma_f32 v[56:57], v[56:57], v[14:15], v[12:13]
  v_pk_fma_f32 v[60:61], v[60:61], v[14:15], v[12:13]
  v_pk_fma_f32 v[64:65], v[64:65], v[14:15], v[12:13]
  v_pk_fma_f32 v[68:69], v[68:69], v[14:15], v[12:13]
  v_pk_fma_f32 v[72:73], v[72:73], v[14:15], v[12:13]
  v_pk_fma_f32 v[76:77], v[76:77], v[14:15], v[12:13]
  v_pk_fma_f32 v[80:81], v[80:81], v[14:15], v[12:13]
  v_pk_fma_f32 v[52:53], v[52:53], v[144:145], v[84:85]
  v_pk_fma_f32 v[56:57], v[56:57], v[146:147], v[84:85]
  v_pk_fma_f32 v[60:61], v[60:61], v[148:149], v[84:85]
  v_pk_fma_f32 v[64:65], v[64:65], v[150:151], v[84:85]
  v_pk_fma_f32 v[68:69], v[68:69], v[160:161], v[84:85]
  v_pk_fma_f32 v[72:73], v[72:73], v[162:163], v[84:85]
  v_pk_fma_f32 v[76:77], v[76:77], v[164:165], v[84:85]
  v_pk_fma_f32 v[80:81], v[80:81], v[166:167], v[84:85]
  v_exp_f32 v52, v52 clamp
  v_exp_f32 v53, v53 clamp
  v_exp_f32 v56, v56 clamp
  v_exp_f32 v57, v57 clamp
  v_exp_f32 v60, v60 clamp
  v_exp_f32 v61, v61 clamp
  v_exp_f32 v64, v64 clamp
  v_exp_f32 v65, v65 clamp
  v_exp_f32 v68, v68 clamp
  v_exp_f32 v69, v69 clamp
  v_exp_f32 v72, v72 clamp
  v_exp_f32 v73, v73 clamp
  v_exp_f32 v76, v76 clamp
  v_exp_f32 v77, v77 clamp
  v_exp_f32 v80, v80 clamp
  v_exp_f32 v81, v81 clamp
  v_pk_mul_f32 v[54:55], v[144:145], v[24:25]
  v_pk_mul_f32 v[58:59], v[146:147], v[26:27]
  v_pk_mul_f32 v[62:63], v[148:149], v[28:29]
  v_pk_mul_f32 v[66:67], v[150:151], v[30:31]
  v_pk_mul_f32 v[70:71], v[160:161], v[24:25]
  v_pk_mul_f32 v[74:75], v[162:163], v[26:27]
  v_pk_mul_f32 v[78:79], v[164:165], v[28:29]
  v_pk_mul_f32 v[82:83], v[166:167], v[30:31]
  v_pk_fma_f32 v[52:53], v[52:53], v[86:87], v[248:249]
  v_pk_fma_f32 v[56:57], v[56:57], v[86:87], v[248:249]
  v_pk_fma_f32 v[60:61], v[60:61], v[86:87], v[248:249]
  v_pk_fma_f32 v[64:65], v[64:65], v[86:87], v[248:249]
  v_pk_fma_f32 v[68:69], v[68:69], v[86:87], v[248:249]
  v_pk_fma_f32 v[72:73], v[72:73], v[86:87], v[248:249]
  v_pk_fma_f32 v[76:77], v[76:77], v[86:87], v[248:249]
  v_pk_fma_f32 v[80:81], v[80:81], v[86:87], v[248:249]
  v_pk_mul_f32 v[54:55], v[54:55], v[56:57]
  v_pk_mul_f32 v[62:63], v[62:63], v[64:65]
  v_pk_mul_f32 v[70:71], v[70:71], v[72:73]
  v_pk_mul_f32 v[78:79], v[78:79], v[80:81]
  v_pk_fma_f32 v[54:55], v[58:59], v[52:53], v[54:55]
  v_pk_fma_f32 v[62:63], v[66:67], v[60:61], v[62:63]
  v_pk_fma_f32 v[70:71], v[74:75], v[68:69], v[70:71]
  v_pk_fma_f32 v[78:79], v[82:83], v[76:77], v[78:79]
  v_pk_mul_f32 v[52:53], v[52:53], v[56:57]
  v_pk_mul_f32 v[60:61], v[60:61], v[64:65]
  v_pk_mul_f32 v[68:69], v[68:69], v[72:73]
  v_pk_mul_f32 v[76:77], v[76:77], v[80:81]
  v_pk_mul_f32 v[54:55], v[54:55], v[60:61]
  v_pk_mul_f32 v[70:71], v[70:71], v[76:77]
  v_pk_fma_f32 v[54:55], v[62:63], v[52:53], v[54:55]
  v_pk_fma_f32 v[70:71], v[78:79], v[68:69], v[70:71]
  v_pk_mul_f32 v[52:53], v[52:53], v[60:61]
  v_pk_mul_f32 v[68:69], v[68:69], v[76:77]
  v_rcp_f32 v52, v52
  v_rcp_f32 v53, v53
  v_rcp_f32 v68, v68
  v_rcp_f32 v69, v69
  v_pk_fma_f32 v[38:39], v[52:53], v[54:55], v[38:39]
  v_pk_fma_f32 v[40:41], v[68:69], v[70:71], v[40:41]
  v_pk_mul_f32 v[52:53], v[168:169], v[168:169]
  v_pk_mul_f32 v[56:57], v[170:171], v[170:171]
  v_pk_mul_f32 v[60:61], v[172:173], v[172:173]
  v_pk_mul_f32 v[64:65], v[174:175], v[174:175]
  v_pk_mul_f32 v[68:69], v[184:185], v[184:185]
  v_pk_mul_f32 v[72:73], v[186:187], v[186:187]
  v_pk_mul_f32 v[76:77], v[188:189], v[188:189]
  v_pk_mul_f32 v[80:81], v[190:191], v[190:191]
  v_pk_fma_f32 v[52:53], v[52:53], v[14:15], v[12:13]
  v_pk_fma_f32 v[56:57], v[56:57], v[14:15], v[12:13]
  v_pk_fma_f32 v[60:61], v[60:61], v[14:15], v[12:13]
  v_pk_fma_f32 v[64:65], v[64:65], v[14:15], v[12:13]
  v_pk_fma_f32 v[68:69], v[68:69], v[14:15], v[12:13]
  v_pk_fma_f32 v[72:73], v[72:73], v[14:15], v[12:13]
  v_pk_fma_f32 v[76:77], v[76:77], v[14:15], v[12:13]
  v_pk_fma_f32 v[80:81], v[80:81], v[14:15], v[12:13]
  v_pk_fma_f32 v[52:53], v[52:53], v[168:169], v[84:85]
  v_pk_fma_f32 v[56:57], v[56:57], v[170:171], v[84:85]
  v_pk_fma_f32 v[60:61], v[60:61], v[172:173], v[84:85]
  v_pk_fma_f32 v[64:65], v[64:65], v[174:175], v[84:85]
  v_pk_fma_f32 v[68:69], v[68:69], v[184:185], v[84:85]
  v_pk_fma_f32 v[72:73], v[72:73], v[186:187], v[84:85]
  v_pk_fma_f32 v[76:77], v[76:77], v[188:189], v[84:85]
  v_pk_fma_f32 v[80:81], v[80:81], v[190:191], v[84:85]
  v_exp_f32 v52, v52 clamp
  v_exp_f32 v53, v53 clamp
  v_exp_f32 v56, v56 clamp
  v_exp_f32 v57, v57 clamp
  v_exp_f32 v60, v60 clamp
  v_exp_f32 v61, v61 clamp
  v_exp_f32 v64, v64 clamp
  v_exp_f32 v65, v65 clamp
  v_exp_f32 v68, v68 clamp
  v_exp_f32 v69, v69 clamp
  v_exp_f32 v72, v72 clamp
  v_exp_f32 v73, v73 clamp
  v_exp_f32 v76, v76 clamp
  v_exp_f32 v77, v77 clamp
  v_exp_f32 v80, v80 clamp
  v_exp_f32 v81, v81 clamp
  v_pk_mul_f32 v[54:55], v[168:169], v[16:17]
  v_pk_mul_f32 v[58:59], v[170:171], v[18:19]
  v_pk_mul_f32 v[62:63], v[172:173], v[20:21]
  v_pk_mul_f32 v[66:67], v[174:175], v[22:23]
  v_pk_mul_f32 v[70:71], v[184:185], v[16:17]
  v_pk_mul_f32 v[74:75], v[186:187], v[18:19]
  v_pk_mul_f32 v[78:79], v[188:189], v[20:21]
  v_pk_mul_f32 v[82:83], v[190:191], v[22:23]
  v_pk_fma_f32 v[52:53], v[52:53], v[86:87], v[248:249]
  v_pk_fma_f32 v[56:57], v[56:57], v[86:87], v[248:249]
  v_pk_fma_f32 v[60:61], v[60:61], v[86:87], v[248:249]
  v_pk_fma_f32 v[64:65], v[64:65], v[86:87], v[248:249]
  v_pk_fma_f32 v[68:69], v[68:69], v[86:87], v[248:249]
  v_pk_fma_f32 v[72:73], v[72:73], v[86:87], v[248:249]
  v_pk_fma_f32 v[76:77], v[76:77], v[86:87], v[248:249]
  v_pk_fma_f32 v[80:81], v[80:81], v[86:87], v[248:249]
  v_pk_mul_f32 v[54:55], v[54:55], v[56:57]
  v_pk_mul_f32 v[62:63], v[62:63], v[64:65]
  v_pk_mul_f32 v[70:71], v[70:71], v[72:73]
  v_pk_mul_f32 v[78:79], v[78:79], v[80:81]
  v_pk_fma_f32 v[54:55], v[58:59], v[52:53], v[54:55]
  v_pk_fma_f32 v[62:63], v[66:67], v[60:61], v[62:63]
  v_pk_fma_f32 v[70:71], v[74:75], v[68:69], v[70:71]
  v_pk_fma_f32 v[78:79], v[82:83], v[76:77], v[78:79]
  v_pk_mul_f32 v[52:53], v[52:53], v[56:57]
  v_pk_mul_f32 v[60:61], v[60:61], v[64:65]
  v_pk_mul_f32 v[68:69], v[68:69], v[72:73]
  v_pk_mul_f32 v[76:77], v[76:77], v[80:81]
  v_pk_mul_f32 v[54:55], v[54:55], v[60:61]
  v_pk_mul_f32 v[70:71], v[70:71], v[76:77]
  v_pk_fma_f32 v[54:55], v[62:63], v[52:53], v[54:55]
  v_pk_fma_f32 v[70:71], v[78:79], v[68:69], v[70:71]
  v_pk_mul_f32 v[52:53], v[52:53], v[60:61]
  v_pk_mul_f32 v[68:69], v[68:69], v[76:77]
  v_rcp_f32 v52, v52
  v_rcp_f32 v53, v53
  v_rcp_f32 v68, v68
  v_rcp_f32 v69, v69
  v_pk_mul_f32 v[42:43], v[52:53], v[54:55]
  v_pk_mul_f32 v[44:45], v[68:69], v[70:71]
  v_pk_mul_f32 v[52:53], v[176:177], v[176:177]
  v_pk_mul_f32 v[56:57], v[178:179], v[178:179]
  v_pk_mul_f32 v[60:61], v[180:181], v[180:181]
  v_pk_mul_f32 v[64:65], v[182:183], v[182:183]
  v_pk_mul_f32 v[68:69], v[192:193], v[192:193]
  v_pk_mul_f32 v[72:73], v[194:195], v[194:195]
  v_pk_mul_f32 v[76:77], v[196:197], v[196:197]
  v_pk_mul_f32 v[80:81], v[198:199], v[198:199]
  v_pk_fma_f32 v[52:53], v[52:53], v[14:15], v[12:13]
  v_pk_fma_f32 v[56:57], v[56:57], v[14:15], v[12:13]
  v_pk_fma_f32 v[60:61], v[60:61], v[14:15], v[12:13]
  v_pk_fma_f32 v[64:65], v[64:65], v[14:15], v[12:13]
  v_pk_fma_f32 v[68:69], v[68:69], v[14:15], v[12:13]
  v_pk_fma_f32 v[72:73], v[72:73], v[14:15], v[12:13]
  v_pk_fma_f32 v[76:77], v[76:77], v[14:15], v[12:13]
  v_pk_fma_f32 v[80:81], v[80:81], v[14:15], v[12:13]
  v_pk_fma_f32 v[52:53], v[52:53], v[176:177], v[84:85]
  v_pk_fma_f32 v[56:57], v[56:57], v[178:179], v[84:85]
  v_pk_fma_f32 v[60:61], v[60:61], v[180:181], v[84:85]
  v_pk_fma_f32 v[64:65], v[64:65], v[182:183], v[84:85]
  v_pk_fma_f32 v[68:69], v[68:69], v[192:193], v[84:85]
  v_pk_fma_f32 v[72:73], v[72:73], v[194:195], v[84:85]
  v_pk_fma_f32 v[76:77], v[76:77], v[196:197], v[84:85]
  v_pk_fma_f32 v[80:81], v[80:81], v[198:199], v[84:85]
  v_exp_f32 v52, v52 clamp
  v_exp_f32 v53, v53 clamp
  v_exp_f32 v56, v56 clamp
  v_exp_f32 v57, v57 clamp
  v_exp_f32 v60, v60 clamp
  v_exp_f32 v61, v61 clamp
  v_exp_f32 v64, v64 clamp
  v_exp_f32 v65, v65 clamp
  v_exp_f32 v68, v68 clamp
  v_exp_f32 v69, v69 clamp
  v_exp_f32 v72, v72 clamp
  v_exp_f32 v73, v73 clamp
  v_exp_f32 v76, v76 clamp
  v_exp_f32 v77, v77 clamp
  v_exp_f32 v80, v80 clamp
  v_exp_f32 v81, v81 clamp
  v_pk_mul_f32 v[54:55], v[176:177], v[24:25]
  v_pk_mul_f32 v[58:59], v[178:179], v[26:27]
  v_pk_mul_f32 v[62:63], v[180:181], v[28:29]
  v_pk_mul_f32 v[66:67], v[182:183], v[30:31]
  v_pk_mul_f32 v[70:71], v[192:193], v[24:25]
  v_pk_mul_f32 v[74:75], v[194:195], v[26:27]
  v_pk_mul_f32 v[78:79], v[196:197], v[28:29]
  v_pk_mul_f32 v[82:83], v[198:199], v[30:31]
  v_pk_fma_f32 v[52:53], v[52:53], v[86:87], v[248:249]
  v_pk_fma_f32 v[56:57], v[56:57], v[86:87], v[248:249]
  v_pk_fma_f32 v[60:61], v[60:61], v[86:87], v[248:249]
  v_pk_fma_f32 v[64:65], v[64:65], v[86:87], v[248:249]
  v_pk_fma_f32 v[68:69], v[68:69], v[86:87], v[248:249]
  v_pk_fma_f32 v[72:73], v[72:73], v[86:87], v[248:249]
  v_pk_fma_f32 v[76:77], v[76:77], v[86:87], v[248:249]
  v_pk_fma_f32 v[80:81], v[80:81], v[86:87], v[248:249]
  v_pk_mul_f32 v[54:55], v[54:55], v[56:57]
  v_pk_mul_f32 v[62:63], v[62:63], v[64:65]
  v_pk_mul_f32 v[70:71], v[70:71], v[72:73]
  v_pk_mul_f32 v[78:79], v[78:79], v[80:81]
  v_pk_fma_f32 v[54:55], v[58:59], v[52:53], v[54:55]
  v_pk_fma_f32 v[62:63], v[66:67], v[60:61], v[62:63]
  v_pk_fma_f32 v[70:71], v[74:75], v[68:69], v[70:71]
  v_pk_fma_f32 v[78:79], v[82:83], v[76:77], v[78:79]
  v_pk_mul_f32 v[52:53], v[52:53], v[56:57]
  v_pk_mul_f32 v[60:61], v[60:61], v[64:65]
  v_pk_mul_f32 v[68:69], v[68:69], v[72:73]
  v_pk_mul_f32 v[76:77], v[76:77], v[80:81]
  v_pk_mul_f32 v[54:55], v[54:55], v[60:61]
  v_pk_mul_f32 v[70:71], v[70:71], v[76:77]
  v_pk_fma_f32 v[54:55], v[62:63], v[52:53], v[54:55]
  v_pk_fma_f32 v[70:71], v[78:79], v[68:69], v[70:71]
  v_pk_mul_f32 v[52:53], v[52:53], v[60:61]
  v_pk_mul_f32 v[68:69], v[68:69], v[76:77]
  v_rcp_f32 v52, v52
  v_rcp_f32 v53, v53
  v_rcp_f32 v68, v68
  v_rcp_f32 v69, v69
  v_pk_fma_f32 v[42:43], v[52:53], v[54:55], v[42:43]
  v_pk_fma_f32 v[44:45], v[68:69], v[70:71], v[44:45]
  v_pk_mul_f32 v[52:53], v[200:201], v[200:201]
  v_pk_mul_f32 v[56:57], v[202:203], v[202:203]
  v_pk_mul_f32 v[60:61], v[204:205], v[204:205]
  v_pk_mul_f32 v[64:65], v[206:207], v[206:207]
  v_pk_mul_f32 v[68:69], v[216:217], v[216:217]
  v_pk_mul_f32 v[72:73], v[218:219], v[218:219]
  v_pk_mul_f32 v[76:77], v[220:221], v[220:221]
  v_pk_mul_f32 v[80:81], v[222:223], v[222:223]
  v_pk_fma_f32 v[52:53], v[52:53], v[14:15], v[12:13]
  v_pk_fma_f32 v[56:57], v[56:57], v[14:15], v[12:13]
  v_pk_fma_f32 v[60:61], v[60:61], v[14:15], v[12:13]
  v_pk_fma_f32 v[64:65], v[64:65], v[14:15], v[12:13]
  v_pk_fma_f32 v[68:69], v[68:69], v[14:15], v[12:13]
  v_pk_fma_f32 v[72:73], v[72:73], v[14:15], v[12:13]
  v_pk_fma_f32 v[76:77], v[76:77], v[14:15], v[12:13]
  v_pk_fma_f32 v[80:81], v[80:81], v[14:15], v[12:13]
  v_pk_fma_f32 v[52:53], v[52:53], v[200:201], v[84:85]
  v_pk_fma_f32 v[56:57], v[56:57], v[202:203], v[84:85]
  v_pk_fma_f32 v[60:61], v[60:61], v[204:205], v[84:85]
  v_pk_fma_f32 v[64:65], v[64:65], v[206:207], v[84:85]
  v_pk_fma_f32 v[68:69], v[68:69], v[216:217], v[84:85]
  v_pk_fma_f32 v[72:73], v[72:73], v[218:219], v[84:85]
  v_pk_fma_f32 v[76:77], v[76:77], v[220:221], v[84:85]
  v_pk_fma_f32 v[80:81], v[80:81], v[222:223], v[84:85]
  v_exp_f32 v52, v52 clamp
  v_exp_f32 v53, v53 clamp
  v_exp_f32 v56, v56 clamp
  v_exp_f32 v57, v57 clamp
  v_exp_f32 v60, v60 clamp
  v_exp_f32 v61, v61 clamp
  v_exp_f32 v64, v64 clamp
  v_exp_f32 v65, v65 clamp
  v_exp_f32 v68, v68 clamp
  v_exp_f32 v69, v69 clamp
  v_exp_f32 v72, v72 clamp
  v_exp_f32 v73, v73 clamp
  v_exp_f32 v76, v76 clamp
  v_exp_f32 v77, v77 clamp
  v_exp_f32 v80, v80 clamp
  v_exp_f32 v81, v81 clamp
  v_pk_mul_f32 v[54:55], v[200:201], v[16:17]
  v_pk_mul_f32 v[58:59], v[202:203], v[18:19]
  v_pk_mul_f32 v[62:63], v[204:205], v[20:21]
  v_pk_mul_f32 v[66:67], v[206:207], v[22:23]
  v_pk_mul_f32 v[70:71], v[216:217], v[16:17]
  v_pk_mul_f32 v[74:75], v[218:219], v[18:19]
  v_pk_mul_f32 v[78:79], v[220:221], v[20:21]
  v_pk_mul_f32 v[82:83], v[222:223], v[22:23]
  v_pk_fma_f32 v[52:53], v[52:53], v[86:87], v[248:249]
  v_pk_fma_f32 v[56:57], v[56:57], v[86:87], v[248:249]
  v_pk_fma_f32 v[60:61], v[60:61], v[86:87], v[248:249]
  v_pk_fma_f32 v[64:65], v[64:65], v[86:87], v[248:249]
  v_pk_fma_f32 v[68:69], v[68:69], v[86:87], v[248:249]
  v_pk_fma_f32 v[72:73], v[72:73], v[86:87], v[248:249]
  v_pk_fma_f32 v[76:77], v[76:77], v[86:87], v[248:249]
  v_pk_fma_f32 v[80:81], v[80:81], v[86:87], v[248:249]
  v_pk_mul_f32 v[54:55], v[54:55], v[56:57]
  v_pk_mul_f32 v[62:63], v[62:63], v[64:65]
  v_pk_mul_f32 v[70:71], v[70:71], v[72:73]
  v_pk_mul_f32 v[78:79], v[78:79], v[80:81]
  v_pk_fma_f32 v[54:55], v[58:59], v[52:53], v[54:55]
  v_pk_fma_f32 v[62:63], v[66:67], v[60:61], v[62:63]
  v_pk_fma_f32 v[70:71], v[74:75], v[68:69], v[70:71]
  v_pk_fma_f32 v[78:79], v[82:83], v[76:77], v[78:79]
  v_pk_mul_f32 v[52:53], v[52:53], v[56:57]
  v_pk_mul_f32 v[60:61], v[60:61], v[64:65]
  v_pk_mul_f32 v[68:69], v[68:69], v[72:73]
  v_pk_mul_f32 v[76:77], v[76:77], v[80:81]
  v_pk_mul_f32 v[54:55], v[54:55], v[60:61]
  v_pk_mul_f32 v[70:71], v[70:71], v[76:77]
  v_pk_fma_f32 v[54:55], v[62:63], v[52:53], v[54:55]
  v_pk_fma_f32 v[70:71], v[78:79], v[68:69], v[70:71]
  v_pk_mul_f32 v[52:53], v[52:53], v[60:61]
  v_pk_mul_f32 v[68:69], v[68:69], v[76:77]
  v_rcp_f32 v52, v52
  v_rcp_f32 v53, v53
  v_rcp_f32 v68, v68
  v_rcp_f32 v69, v69
  v_pk_mul_f32 v[46:47], v[52:53], v[54:55]
  v_pk_mul_f32 v[48:49], v[68:69], v[70:71]
  v_pk_mul_f32 v[52:53], v[208:209], v[208:209]
  v_pk_mul_f32 v[56:57], v[210:211], v[210:211]
  v_pk_mul_f32 v[60:61], v[212:213], v[212:213]
  v_pk_mul_f32 v[64:65], v[214:215], v[214:215]
  v_pk_mul_f32 v[68:69], v[224:225], v[224:225]
  v_pk_mul_f32 v[72:73], v[226:227], v[226:227]
  v_pk_mul_f32 v[76:77], v[228:229], v[228:229]
  v_pk_mul_f32 v[80:81], v[230:231], v[230:231]
  v_pk_fma_f32 v[52:53], v[52:53], v[14:15], v[12:13]
  v_pk_fma_f32 v[56:57], v[56:57], v[14:15], v[12:13]
  v_pk_fma_f32 v[60:61], v[60:61], v[14:15], v[12:13]
  v_pk_fma_f32 v[64:65], v[64:65], v[14:15], v[12:13]
  v_pk_fma_f32 v[68:69], v[68:69], v[14:15], v[12:13]
  v_pk_fma_f32 v[72:73], v[72:73], v[14:15], v[12:13]
  v_pk_fma_f32 v[76:77], v[76:77], v[14:15], v[12:13]
  v_pk_fma_f32 v[80:81], v[80:81], v[14:15], v[12:13]
  v_pk_fma_f32 v[52:53], v[52:53], v[208:209], v[84:85]
  v_pk_fma_f32 v[56:57], v[56:57], v[210:211], v[84:85]
  v_pk_fma_f32 v[60:61], v[60:61], v[212:213], v[84:85]
  v_pk_fma_f32 v[64:65], v[64:65], v[214:215], v[84:85]
  v_pk_fma_f32 v[68:69], v[68:69], v[224:225], v[84:85]
  v_pk_fma_f32 v[72:73], v[72:73], v[226:227], v[84:85]
  v_pk_fma_f32 v[76:77], v[76:77], v[228:229], v[84:85]
  v_pk_fma_f32 v[80:81], v[80:81], v[230:231], v[84:85]
  v_exp_f32 v52, v52 clamp
  v_exp_f32 v53, v53 clamp
  v_exp_f32 v56, v56 clamp
  v_exp_f32 v57, v57 clamp
  v_exp_f32 v60, v60 clamp
  v_exp_f32 v61, v61 clamp
  v_exp_f32 v64, v64 clamp
  v_exp_f32 v65, v65 clamp
  v_exp_f32 v68, v68 clamp
  v_exp_f32 v69, v69 clamp
  v_exp_f32 v72, v72 clamp
  v_exp_f32 v73, v73 clamp
  v_exp_f32 v76, v76 clamp
  v_exp_f32 v77, v77 clamp
  v_exp_f32 v80, v80 clamp
  v_exp_f32 v81, v81 clamp
  v_pk_mul_f32 v[54:55], v[208:209], v[24:25]
  v_pk_mul_f32 v[58:59], v[210:211], v[26:27]
  v_pk_mul_f32 v[62:63], v[212:213], v[28:29]
  v_pk_mul_f32 v[66:67], v[214:215], v[30:31]
  v_pk_mul_f32 v[70:71], v[224:225], v[24:25]
  v_pk_mul_f32 v[74:75], v[226:227], v[26:27]
  v_pk_mul_f32 v[78:79], v[228:229], v[28:29]
  v_pk_mul_f32 v[82:83], v[230:231], v[30:31]
  v_pk_fma_f32 v[52:53], v[52:53], v[86:87], v[248:249]
  v_pk_fma_f32 v[56:57], v[56:57], v[86:87], v[248:249]
  v_pk_fma_f32 v[60:61], v[60:61], v[86:87], v[248:249]
  v_pk_fma_f32 v[64:65], v[64:65], v[86:87], v[248:249]
  v_pk_fma_f32 v[68:69], v[68:69], v[86:87], v[248:249]
  v_pk_fma_f32 v[72:73], v[72:73], v[86:87], v[248:249]
  v_pk_fma_f32 v[76:77], v[76:77], v[86:87], v[248:249]
  v_pk_fma_f32 v[80:81], v[80:81], v[86:87], v[248:249]
  v_pk_mul_f32 v[54:55], v[54:55], v[56:57]
  v_pk_mul_f32 v[62:63], v[62:63], v[64:65]
  v_pk_mul_f32 v[70:71], v[70:71], v[72:73]
  v_pk_mul_f32 v[78:79], v[78:79], v[80:81]
  v_pk_fma_f32 v[54:55], v[58:59], v[52:53], v[54:55]
  v_pk_fma_f32 v[62:63], v[66:67], v[60:61], v[62:63]
  v_pk_fma_f32 v[70:71], v[74:75], v[68:69], v[70:71]
  v_pk_fma_f32 v[78:79], v[82:83], v[76:77], v[78:79]
  v_pk_mul_f32 v[52:53], v[52:53], v[56:57]
  v_pk_mul_f32 v[60:61], v[60:61], v[64:65]
  v_pk_mul_f32 v[68:69], v[68:69], v[72:73]
  v_pk_mul_f32 v[76:77], v[76:77], v[80:81]
  v_pk_mul_f32 v[54:55], v[54:55], v[60:61]
  v_pk_mul_f32 v[70:71], v[70:71], v[76:77]
  v_pk_fma_f32 v[54:55], v[62:63], v[52:53], v[54:55]
  v_pk_fma_f32 v[70:71], v[78:79], v[68:69], v[70:71]
  v_pk_mul_f32 v[52:53], v[52:53], v[60:61]
  v_pk_mul_f32 v[68:69], v[68:69], v[76:77]
  v_rcp_f32 v52, v52
  v_rcp_f32 v53, v53
  v_rcp_f32 v68, v68
  v_rcp_f32 v69, v69
  v_pk_fma_f32 v[46:47], v[52:53], v[54:55], v[46:47]
  v_pk_fma_f32 v[48:49], v[68:69], v[70:71], v[48:49]
  v_pk_mul_f32 v[52:53], v[232:233], v[232:233]
  v_pk_mul_f32 v[56:57], v[234:235], v[234:235]
  v_pk_mul_f32 v[60:61], v[236:237], v[236:237]
  v_pk_mul_f32 v[64:65], v[238:239], v[238:239]
  v_pk_mul_f32 v[68:69], v[240:241], v[240:241]
  v_pk_mul_f32 v[72:73], v[242:243], v[242:243]
  v_pk_mul_f32 v[76:77], v[244:245], v[244:245]
  v_pk_mul_f32 v[80:81], v[246:247], v[246:247]
  v_pk_fma_f32 v[52:53], v[52:53], v[14:15], v[12:13]
  v_pk_fma_f32 v[56:57], v[56:57], v[14:15], v[12:13]
  v_pk_fma_f32 v[60:61], v[60:61], v[14:15], v[12:13]
  v_pk_fma_f32 v[64:65], v[64:65], v[14:15], v[12:13]
  v_pk_fma_f32 v[68:69], v[68:69], v[14:15], v[12:13]
  v_pk_fma_f32 v[72:73], v[72:73], v[14:15], v[12:13]
  v_pk_fma_f32 v[76:77], v[76:77], v[14:15], v[12:13]
  v_pk_fma_f32 v[80:81], v[80:81], v[14:15], v[12:13]
  v_pk_fma_f32 v[52:53], v[52:53], v[232:233], v[84:85]
  v_pk_fma_f32 v[56:57], v[56:57], v[234:235], v[84:85]
  v_pk_fma_f32 v[60:61], v[60:61], v[236:237], v[84:85]
  v_pk_fma_f32 v[64:65], v[64:65], v[238:239], v[84:85]
  v_pk_fma_f32 v[68:69], v[68:69], v[240:241], v[84:85]
  v_pk_fma_f32 v[72:73], v[72:73], v[242:243], v[84:85]
  v_pk_fma_f32 v[76:77], v[76:77], v[244:245], v[84:85]
  v_pk_fma_f32 v[80:81], v[80:81], v[246:247], v[84:85]
  v_exp_f32 v52, v52 clamp
  v_exp_f32 v53, v53 clamp
  v_exp_f32 v56, v56 clamp
  v_exp_f32 v57, v57 clamp
  v_exp_f32 v60, v60 clamp
  v_exp_f32 v61, v61 clamp
  v_exp_f32 v64, v64 clamp
  v_exp_f32 v65, v65 clamp
  v_exp_f32 v68, v68 clamp
  v_exp_f32 v69, v69 clamp
  v_exp_f32 v72, v72 clamp
  v_exp_f32 v73, v73 clamp
  v_exp_f32 v76, v76 clamp
  v_exp_f32 v77, v77 clamp
  v_exp_f32 v80, v80 clamp
  v_exp_f32 v81, v81 clamp
  v_pk_mul_f32 v[54:55], v[232:233], v[16:17]
  v_pk_mul_f32 v[58:59], v[234:235], v[18:19]
  v_pk_mul_f32 v[62:63], v[236:237], v[20:21]
  v_pk_mul_f32 v[66:67], v[238:239], v[22:23]
  v_pk_mul_f32 v[70:71], v[240:241], v[24:25]
  v_pk_mul_f32 v[74:75], v[242:243], v[26:27]
  v_pk_mul_f32 v[78:79], v[244:245], v[28:29]
  v_pk_mul_f32 v[82:83], v[246:247], v[30:31]
  v_pk_fma_f32 v[52:53], v[52:53], v[86:87], v[248:249]
  v_pk_fma_f32 v[56:57], v[56:57], v[86:87], v[248:249]
  v_pk_fma_f32 v[60:61], v[60:61], v[86:87], v[248:249]
  v_pk_fma_f32 v[64:65], v[64:65], v[86:87], v[248:249]
  v_pk_fma_f32 v[68:69], v[68:69], v[86:87], v[248:249]
  v_pk_fma_f32 v[72:73], v[72:73], v[86:87], v[248:249]
  v_pk_fma_f32 v[76:77], v[76:77], v[86:87], v[248:249]
  v_pk_fma_f32 v[80:81], v[80:81], v[86:87], v[248:249]
  v_pk_mul_f32 v[54:55], v[54:55], v[56:57]
  v_pk_mul_f32 v[62:63], v[62:63], v[64:65]
  v_pk_mul_f32 v[70:71], v[70:71], v[72:73]
  v_pk_mul_f32 v[78:79], v[78:79], v[80:81]
  v_pk_fma_f32 v[54:55], v[58:59], v[52:53], v[54:55]
  v_pk_fma_f32 v[62:63], v[66:67], v[60:61], v[62:63]
  v_pk_fma_f32 v[70:71], v[74:75], v[68:69], v[70:71]
  v_pk_fma_f32 v[78:79], v[82:83], v[76:77], v[78:79]
  v_pk_mul_f32 v[52:53], v[52:53], v[56:57]
  v_pk_mul_f32 v[60:61], v[60:61], v[64:65]
  v_pk_mul_f32 v[68:69], v[68:69], v[72:73]
  v_pk_mul_f32 v[76:77], v[76:77], v[80:81]
  v_pk_mul_f32 v[54:55], v[54:55], v[60:61]
  v_pk_mul_f32 v[70:71], v[70:71], v[76:77]
  v_pk_fma_f32 v[54:55], v[62:63], v[52:53], v[54:55]
  v_pk_fma_f32 v[70:71], v[78:79], v[68:69], v[70:71]
  v_pk_mul_f32 v[52:53], v[52:53], v[60:61]
  v_pk_mul_f32 v[68:69], v[68:69], v[76:77]
  v_rcp_f32 v52, v52
  v_rcp_f32 v53, v53
  v_rcp_f32 v68, v68
  v_rcp_f32 v69, v69
  v_pk_mul_f32 v[50:51], v[52:53], v[54:55]
  v_pk_fma_f32 v[50:51], v[68:69], v[70:71], v[50:51]
  v_pk_mul_f32 v[32:33], v[88:89], v[16:17]
  v_pk_fma_f32 v[32:33], v[90:91], v[18:19], v[32:33]
  v_pk_fma_f32 v[32:33], v[92:93], v[20:21], v[32:33]
  v_pk_fma_f32 v[32:33], v[94:95], v[22:23], v[32:33]
  v_pk_fma_f32 v[32:33], v[96:97], v[24:25], v[32:33]
  v_pk_fma_f32 v[32:33], v[98:99], v[26:27], v[32:33]
  v_pk_fma_f32 v[32:33], v[100:101], v[28:29], v[32:33]
  v_pk_fma_f32 v[32:33], v[102:103], v[30:31], v[32:33]
  v_add_f32 v32, v32, v33
  v_add_f32 v34, v34, v35
  v_add_f32 v36, v36, v37
  v_add_f32 v38, v38, v39
  v_add_f32 v40, v40, v41
  v_add_f32 v42, v42, v43
  v_add_f32 v44, v44, v45
  v_add_f32 v46, v46, v47
  v_add_f32 v48, v48, v49
  v_add_f32 v50, v50, v51
  v_permlane32_swap_b32 v32, v34
  v_permlane32_swap_b32 v36, v38
  v_permlane32_swap_b32 v40, v42
  v_permlane32_swap_b32 v44, v46
  v_permlane32_swap_b32 v48, v50
  v_add_f32 v48, v48, v50
  v_add_f32 v32, v32, v34
  v_add_f32 v36, v36, v38
  v_add_f32 v40, v40, v42
  v_add_f32 v44, v44, v46
  v_mov_b32 v50, v48
  v_permlane16_swap_b32 v32, v36
  v_permlane16_swap_b32 v40, v44
  v_permlane16_swap_b32 v48, v50
  v_add_f32 v32, v32, v36
  v_add_f32 v40, v40, v44
  v_add_f32_e64 v48, v48, v50
  ds_write_b32 v10, v32
  ds_write_b32 v10, v40 offset:256
  s_mov_b32 exec_lo, 0xffff
  s_mov_b32 exec_hi, 0xffff
  ds_write_b32 v10, v48 offset:512
  s_mov_b64 exec, -1
  s_waitcnt lgkmcnt(0)
  s_barrier
  s_endpgm
L_ld_tail0:
  s_waitcnt vmcnt(0)
L_ld_tail:
  s_barrier
  s_mov_b32 s60, s24
  s_and_b32 s61, s25, 0xffff
  s_mov_b32 s62, 268435456
  s_mov_b32 s63, 0x20000
  s_mov_b32 s56, s20
  s_and_b32 s57, s21, 0xffff
  s_mov_b32 s58, 8192
  s_mov_b32 s59, 0x20000
  s_mov_b32 s64, s22
  s_and_b32 s65, s23, 0xffff
  s_mov_b32 s66, 256
  s_mov_b32 s67, 0x20000
  s_load_dword s80, s[18:19], 0
  v_mov_b32_e64 v100, 0
  s_mov_b64 exec, 1
  s_mov_b32 s81, 0x80000
  buffer_load_dword v101, v100, s[60:63], s81 offen
  buffer_load_dword v102, v100, s[56:59], 0 offen
  s_mov_b64 exec, -1
  s_mov_b64 exec, 1
  buffer_load_dword v250, v100, s[64:67], 0 offen offset:128 sc1
  s_mov_b64 exec, -1
  s_cmp_lg_u32 s3, 4
  s_cbranch_scc1 L_end
  v_lshlrev_b32 v3, 4, v0
  v_lshlrev_b32 v4, 2, v0
  v_add_u32 v1, 123392, v3
  v_add_u32 v2, 124416, v4
  v_add_u32 v4, 1024, v4
  v_mov_b32 v5, 32
  v_mov_b32_e64 v7, s26
  s_mul_i32 s68, s26, 1280
  s_mul_i32 s69, s27, 16640
  s_add_u32 s69, s69, s68
  s_setprio 3
  v_mov_b32 v64, -1
  v_mov_b32 v65, -1
  v_mov_b32 v66, -1
  v_mov_b32 v67, -1
  buffer_store_dwordx4 v[64:67], v3, s[60:63], s69 offen sc1
  buffer_store_dword v64, v4, s[60:63], s69 offen sc1
  s_waitcnt vmcnt(0)
  v_readfirstlane_b32 s81, v250
  s_nop 0
  s_cmp_eq_u32 s81, 0
  s_cbranch_scc1 L_cid
L_crd:
  s_barrier
  ds_read_b128 v[64:67], v1
  ds_read_b128 v[72:75], v1 offset:1280
  ds_read2st64_b32 v[68:69], v2 offset0:0 offset1:5
  s_waitcnt lgkmcnt(0)
  v_pk_add_f32 v[64:65], v[64:65], v[72:73]
  v_pk_add_f32 v[66:67], v[66:67], v[74:75]
  v_add_f32 v68, v68, v69
  v_min_u32 v64, -2, v64
  v_min_u32 v65, -2, v65
  v_min_u32 v66, -2, v66
  v_min_u32 v67, -2, v67
  v_min_u32 v68, -2, v68
  buffer_store_dwordx4 v[64:67], v3, s[60:63], s69 offen sc1
  buffer_store_dword v68, v4, s[60:63], s69 offen sc1
  s_mov_b64 exec, 1
L_pub:
  v_lshlrev_b32 v6, 8, v7
  s_mov_b32 s70, 0x60000
  v_mov_b32 v13, v5
  buffer_atomic_add v5, v6, s[60:63], s70 offen sc0
  v_cmp_eq_u32 vcc, 12, v7
  v_mov_b32 v8, 0x1b4
  v_mov_b32 v9, 0x1b2
  v_cndmask_b32 v8, v8, v9, vcc
  v_sub_u32 v8, v8, v13
  s_waitcnt vmcnt(0) lgkmcnt(0)
  v_cmp_eq_u32 s[82:83], v5, v8
  s_mov_b64 exec, -1
  s_lshl_b32 s80, s80, 16
  v_lshrrev_b32 v1, 1, v3
  v_lshrrev_b32 v2, 1, v4
L_fin:
  s_cmp_eq_u32 s82, 0
  s_cbranch_scc1 L_done
  s_ff1_i32_b32 s70, s82
  s_bitset0_b32 s82, s70
  v_readlane_b32 s71, v7, s70
  s_waitcnt vmcnt(0)
L_again:
  s_mul_i32 s68, s71, 1280
  buffer_load_dwordx4 v[64:67], v3, s[60:63], s68 offen sc1
  buffer_load_dword v68, v4, s[60:63], s68 offen sc1
  s_add_u32 s68, s68, 16640
  buffer_load_dwordx4 v[72:75], v3, s[60:63], s68 offen sc1
  buffer_load_dword v76, v4, s[60:63], s68 offen sc1
  s_add_u32 s68, s68, 16640
  buffer_load_dwordx4 v[80:83], v3, s[60:63], s68 offen sc1
  buffer_load_dword v84, v4, s[60:63], s68 offen sc1
  s_add_u32 s68, s68, 16640
  buffer_load_dwordx4 v[88:91], v3, s[60:63], s68 offen sc1
  buffer_load_dword v92, v4, s[60:63], s68 offen sc1
  s_add_u32 s68, s68, 16640
  buffer_load_dwordx4 v[96:99], v3, s[60:63], s68 offen sc1
  buffer_load_dword v100, v4, s[60:63], s68 offen sc1
  s_add_u32 s68, s68, 16640
  buffer_load_dwordx4 v[104:107], v3, s[60:63], s68 offen sc1
  buffer_load_dword v108, v4, s[60:63], s68 offen sc1
  s_add_u32 s68, s68, 16640
  buffer_load_dwordx4 v[112:115], v3, s[60:63], s68 offen sc1
  buffer_load_dword v116, v4, s[60:63], s68 offen sc1
  s_add_u32 s68, s68, 16640
  buffer_load_dwordx4 v[120:123], v3, s[60:63], s68 offen sc1
  buffer_load_dword v124, v4, s[60:63], s68 offen sc1
  s_add_u32 s68, s68, 16640
  buffer_load_dwordx4 v[128:131], v3, s[60:63], s68 offen sc1
  buffer_load_dword v132, v4, s[60:63], s68 offen sc1
  s_add_u32 s68, s68, 16640
  buffer_load_dwordx4 v[136:139], v3, s[60:63], s68 offen sc1
  buffer_load_dword v140, v4, s[60:63], s68 offen sc1
  s_add_u32 s68, s68, 16640
  buffer_load_dwordx4 v[144:147], v3, s[60:63], s68 offen sc1
  buffer_load_dword v148, v4, s[60:63], s68 offen sc1
  s_add_u32 s68, s68, 16640
  buffer_load_dwordx4 v[152:155], v3, s[60:63], s68 offen sc1
  buffer_load_dword v156, v4, s[60:63], s68 offen sc1
  s_add_u32 s68, s68, 16640
  buffer_load_dwordx4 v[160:163], v3, s[60:63], s68 offen sc1
  buffer_load_dword v164, v4, s[60:63], s68 offen sc1
  s_add_u32 s68, s68, 16640
  buffer_load_dwordx4 v[168:171], v3, s[60:63], s68 offen sc1
  buffer_load_dword v172, v4, s[60:63], s68 offen sc1
  s_add_u32 s68, s68, 16640
L_sum:
  s_waitcnt vmcnt(25)
  v_pk_add_f32 v[56:57], v[64:65], v[72:73]
  v_pk_add_f32 v[58:59], v[66:67], v[74:75]
  s_waitcnt vmcnt(24)
  v_add_f32 v60, v68, v76
  s_waitcnt vmcnt(23)
  v_pk_add_f32 v[56:57], v[56:57], v[80:81]
  v_pk_add_f32 v[58:59], v[58:59], v[82:83]
  s_waitcnt vmcnt(22)
  v_add_f32 v60, v60, v84
  s_waitcnt vmcnt(21)
  v_pk_add_f32 v[56:57], v[56:57], v[88:89]
  v_pk_add_f32 v[58:59], v[58:59], v[90:91]
  s_waitcnt vmcnt(20)
  v_add_f32 v60, v60, v92
  s_waitcnt vmcnt(19)
  v_pk_add_f32 v[56:57], v[56:57], v[96:97]
  v_pk_add_f32 v[58:59], v[58:59], v[98:99]
  s_waitcnt vmcnt(18)
  v_add_f32 v60, v60, v100
  s_waitcnt vmcnt(17)
  v_pk_add_f32 v[56:57], v[56:57], v[104:105]
  v_pk_add_f32 v[58:59], v[58:59], v[106:107]
  s_waitcnt vmcnt(16)
  v_add_f32_e64 v60, v60, v108
  s_waitcnt vmcnt(15)
  v_pk_add_f32 v[56:57], v[56:57], v[112:113]
  v_pk_add_f32 v[58:59], v[58:59], v[114:115]
  s_waitcnt vmcnt(14)
  v_add_f32 v60, v60, v116
  s_waitcnt vmcnt(13)
  v_pk_add_f32 v[56:57], v[56:57], v[120:121]
  v_pk_add_f32 v[58:59], v[58:59], v[122:123]
  s_waitcnt vmcnt(12)
  v_add_f32 v60, v60, v124
  s_waitcnt vmcnt(11)
  v_pk_add_f32 v[56:57], v[56:57], v[128:129]
  v_pk_add_f32 v[58:59], v[58:59], v[130:131]
  s_waitcnt vmcnt(10)
  v_add_f32 v60, v60, v132
  s_waitcnt vmcnt(9)
  v_pk_add_f32 v[56:57], v[56:57], v[136:137]
  v_pk_add_f32 v[58:59], v[58:59], v[138:139]
  s_waitcnt vmcnt(8)
  v_add_f32 v60, v60, v140
  s_waitcnt vmcnt(7)
  v_pk_add_f32 v[56:57], v[56:57], v[144:145]
  v_pk_add_f32 v[58:59], v[58:59], v[146:147]
  s_waitcnt vmcnt(6)
  v_add_f32 v60, v60, v148
  s_waitcnt vmcnt(5)
  v_pk_add_f32 v[56:57], v[56:57], v[152:153]
  v_pk_add_f32 v[58:59], v[58:59], v[154:155]
  s_waitcnt vmcnt(4)
  v_add_f32 v60, v60, v156
  s_waitcnt vmcnt(3)
  v_pk_add_f32 v[56:57], v[56:57], v[160:161]
  v_pk_add_f32 v[58:59], v[58:59], v[162:163]
  s_waitcnt vmcnt(2)
  v_add_f32 v60, v60, v164
  s_waitcnt vmcnt(1)
  v_pk_add_f32 v[56:57], v[56:57], v[168:169]
  v_pk_add_f32 v[58:59], v[58:59], v[170:171]
  s_waitcnt vmcnt(0)
  v_add_f32 v60, v60, v172
  v_cmp_u_f32 vcc, v56, v57
  v_cmp_u_f32 s[92:93], v58, v59
  s_nop 0
  s_or_b64 s[92:93], s[92:93], vcc
  v_cmp_u_f32 vcc, v60, v60
  s_nop 0
  s_or_b64 vcc, s[92:93], vcc
  s_cbranch_vccnz L_chk
L_ok:
  s_mul_i32 s71, s71, 640
  v_add_f32 v56, s80, v56
  v_add_f32 v57, s80, v57
  v_add_f32 v58, s80, v58
  v_add_f32 v59, s80, v59
  v_add_f32_e64 v60, s80, v60
  v_cvt_pk_bf16_f32 v10, v56, v57
  v_cvt_pk_bf16_f32 v11, v58, v59
  v_cvt_pk_bf16_f32 v12, v60, v60
  buffer_store_dwordx2 v[10:11], v1, s[56:59], s71 offen
  buffer_store_short v12, v2, s[56:59], s71 offen
  s_branch L_fin
L_chk:
  v_mov_b32 v14, 0
  v_mov_b32 v15, 0
  v_max3_u32 v14, v14, v64, v65
  v_max3_u32 v14, v14, v66, v67
  v_max_u32 v15, v15, v68
  v_max3_u32 v14, v14, v72, v73
  v_max3_u32 v14, v14, v74, v75
  v_max_u32_e64 v15, v15, v76
  v_max3_u32 v14, v14, v80, v81
  v_max3_u32 v14, v14, v82, v83
  v_max_u32 v15, v15, v84
  v_max3_u32 v14, v14, v88, v89
  v_max3_u32 v14, v14, v90, v91
  v_max_u32 v15, v15, v92
  v_max3_u32 v14, v14, v96, v97
  v_max3_u32 v14, v14, v98, v99
  v_max_u32_e64 v15, v15, v100
  v_max3_u32 v14, v14, v104, v105
  v_max3_u32 v14, v14, v106, v107
  v_max_u32 v15, v15, v108
  v_max3_u32 v14, v14, v112, v113
  v_max3_u32 v14, v14, v114, v115
  v_max_u32 v15, v15, v116
  v_max3_u32 v14, v14, v120, v121
  v_max3_u32 v14, v14, v122, v123
  v_max_u32_e64 v15, v15, v124
  v_max3_u32 v14, v14, v128, v129
  v_max3_u32 v14, v14, v130, v131
  v_max_u32 v15, v15, v132
  v_max3_u32 v14, v14, v136, v137
  v_max3_u32 v14, v14, v138, v139
  v_max_u32 v15, v15, v140
  v_max3_u32 v14, v14, v144, v145
  v_max3_u32 v14, v14, v146, v147
  v_max_u32_e64 v15, v15, v148
  v_max3_u32 v14, v14, v152, v153
  v_max3_u32 v14, v14, v154, v155
  v_max_u32 v15, v15, v156
  v_max3_u32 v14, v14, v160, v161
  v_max3_u32 v14, v14, v162, v163
  v_max_u32 v15, v15, v164
  v_max3_u32 v14, v14, v168, v169
  v_max3_u32 v14, v14, v170, v171
  v_max_u32 v15, v15, v172
  s_cmp_eq_u32 s71, 12
  s_cselect_b32 s68, 0, -1
  v_and_b32 v15, s68, v15
  v_max_u32 v14, v14, v15
  v_cmp_eq_u32 vcc, -1, v14
  s_cbranch_vccnz L_again
  s_branch L_ok
L_done:
  s_endpgm
L_cin_done:
  s_mul_i32 s98, s3, 1536
  s_add_u32 s98, s98, 116736
  v_lshlrev_b32 v120, 5, v0
  v_add_u32_e64 v120, s98, v120
  ds_read_b128 v[60:63], v120
  ds_read_b128 v[64:67], v120 offset:16
  v_mul_f32 v116, v184, v192
  v_mul_f32 v117, v185, v193
  v_mul_f32 v118, v186, v194
  v_mul_f32 v119, v187, v195
  v_fmac_f32 v116, v188, v191
  v_fmac_f32 v117, v200, v208
  v_fmac_f32 v118, v201, v209
  v_fmac_f32 v119, v202, v210
  v_fmac_f32 v116, v203, v211
  v_fmac_f32 v117, v204, v207
  v_fmac_f32 v118, v216, v224
  v_fmac_f32 v119, v217, v225
  v_fmac_f32 v116, v218, v226
  v_fmac_f32 v117, v219, v227
  v_fmac_f32 v118, v220, v223
  v_fmac_f32 v119, v232, v240
  v_fmac_f32 v116, v233, v241
  v_fmac_f32 v117, v234, v242
  v_fmac_f32 v118, v235, v243
  v_fmac_f32 v119, v236, v239
  v_fmac_f32 v116, v189, v196
  v_fmac_f32 v117, v189, v197
  v_fmac_f32 v118, v190, v198
  v_fmac_f32 v119, v190, v199
  v_fmac_f32 v116, v205, v212
  v_fmac_f32 v117, v205, v213
  v_fmac_f32 v118, v206, v214
  v_fmac_f32 v119, v206, v215
  v_fmac_f32 v116, v221, v228
  v_fmac_f32 v117, v221, v229
  v_fmac_f32 v118, v222, v230
  v_fmac_f32 v119, v222, v231
  v_fmac_f32 v116, v237, v244
  v_fmac_f32 v117, v237, v245
  v_fmac_f32 v118, v238, v246
  v_fmac_f32 v119, v238, v247
  v_add_f32 v116, v116, v117
  v_add_f32 v118, v118, v119
  v_add_f32 v116, v116, v118
  v_mul_f32 v116, s74, v116
  v_mul_f32 v116, s75, v116
  s_nop 1
  v_add_f32_dpp v116, v116, v116 row_shr:1 row_mask:0xf bank_mask:0xf
  v_subrev_u32 v122, s98, v7
  v_lshrrev_b32 v122, 8, v122
  v_lshrrev_b32 v121, 3, v0
  v_add_f32_dpp v116, v116, v116 row_shr:2 row_mask:0xf bank_mask:0xf
  v_cmp_gt_u32 vcc, v122, v121
  v_min_u32 v121, v121, v122
  v_lshlrev_b32 v121, 4, v121
  v_add_f32_dpp v116, v116, v116 row_shr:4 row_mask:0xf bank_mask:0xf
  v_add_u32 v121, s85, v121
  s_waitcnt lgkmcnt(1)
  v_add_f32 v60, v60, v61
  v_add_f32 v62, v62, v63
  v_add_f32_dpp v116, v116, v116 row_shr:8 row_mask:0xf bank_mask:0xf
  s_waitcnt lgkmcnt(0)
  v_add_f32 v64, v64, v65
  v_add_f32 v66, v66, v67
  v_add_f32 v60, v60, v62
  v_add_f32_dpp v116, v116, v116 row_bcast:15 row_mask:0xa bank_mask:0xf
  v_add_f32 v64, v64, v66
  v_add_f32_e64 v60, v60, v64
  s_nop 1
  v_add_f32_dpp v60, v60, v60 quad_perm:[1,0,3,2] row_mask:0xf bank_mask:0xf
  v_add_f32_dpp v116, v116, v116 row_bcast:31 row_mask:0xc bank_mask:0xf
  s_nop 0
  v_add_f32_dpp v60, v60, v60 quad_perm:[2,3,0,1] row_mask:0xf bank_mask:0xf
  s_nop 1
  v_add_f32_dpp v60, v60, v60 row_half_mirror row_mask:0xf bank_mask:0xf
  v_cndmask_b32 v60, v116, v60, vcc
  s_bitset1_b32 vcc_hi, 31
  s_mov_b64 exec, vcc
  ds_write_b32 v121, v60
  s_mov_b64 exec, -1
  s_cmp_eq_u32 s3, 0
  s_cbranch_scc1 L_cpub
  s_waitcnt lgkmcnt(0)
  s_barrier
  s_endpgm
L_cpub:
  s_load_dword s80, s[18:19], 0
  s_mov_b32 s60, s24
  s_and_b32 s61, s25, 0xffff
  s_mov_b32 s62, 268435456
  s_mov_b32 s63, 0x20000
  s_mov_b32 s56, s20
  s_and_b32 s57, s21, 0xffff
  s_mov_b32 s58, 8192
  s_mov_b32 s59, 0x20000
  s_mov_b32 s64, s22
  s_and_b32 s65, s23, 0xffff
  s_mov_b32 s66, 256
  s_mov_b32 s67, 0x20000
  v_lshlrev_b32 v6, 2, v0
  v_add_u32 v2, 129728, v6
  v_add_u32 v4, 1024, v6
  s_mul_i32 s69, s26, 192
  s_add_u32 s69, s69, 216320
  v_mov_b32 v13, -1
  s_mov_b32 exec_hi, 0xffff
  buffer_store_dword v13, v6, s[60:63], s69 offen sc1
  s_mov_b64 exec, 1
  buffer_load_dword v250, v6, s[56:59], 0 offen
  buffer_load_dword v251, v6, s[64:67], 0 offen offset:128 sc1
  s_mov_b64 exec, -1
  s_mul_i32 s68, s26, 3
  s_mul_i32 s70, s68, 3277
  s_lshr_b32 s70, s70, 16
  v_add_u32 v7, s70, v0
  s_mul_i32 s70, s70, 20
  s_add_u32 s70, s70, 20
  s_sub_u32 s70, s70, s68
  s_min_u32 s70, s70, 3
  s_sub_u32 s68, 3, s70
  v_mov_b32 v5, s68
  v_writelane_b32 v5, s70, 0
  s_cmp_eq_u32 s68, 0
  s_cselect_b32 s68, 1, 3
  v_lshlrev_b32 v3, 4, v0
  s_waitcnt vmcnt(0) lgkmcnt(0)
  v_readfirstlane_b32 s81, v251
  s_nop 0
  s_cmp_eq_u32 s81, 0
  s_cbranch_scc1 L_cic
L_crc:
  s_mov_b32 exec_hi, 0xffff
  s_barrier
  ds_read_b32 v64, v2
  s_waitcnt lgkmcnt(0)
  v_min_u32_e64 v64, -2, v64
  buffer_store_dword v64, v6, s[60:63], s69 offen sc1
  s_mov_b32 exec_lo, s68
  s_mov_b32 exec_hi, 0
  s_branch L_pub
L_dnn_loop1:
  s_barrier
L_ld_in:
  s_add_u32 m0, s75, 131072
  s_nop 0
  buffer_load_dwordx4 v4, s[44:47], s74 offen lds
  s_add_u32 m0, s75, 132096
  s_nop 0
  buffer_load_dwordx4 v5, s[44:47], s74 offen lds
  s_add_u32 s74, s74, 106496
  s_add_u32 m0, s75, 139264
  s_nop 0
  buffer_load_dwordx4 v4, s[44:47], s74 offen lds
  s_add_u32 m0, s75, 140288
  s_nop 0
  buffer_load_dwordx4 v5, s[44:47], s74 offen lds
  s_add_u32 s74, s74, 106496
  s_add_u32 m0, s76, 0
  s_nop 0
  buffer_load_dwordx4 v56, s[32:35], 0 offen lds
  s_add_u32 m0, s76, 2048
  v_add_u32_dpp v56, v16, v2 row_newbcast:1 row_mask:0xf bank_mask:0x3
  buffer_load_dwordx4 v57, s[32:35], 0 offen lds
  s_nop 0
  v_add_u32_dpp v56, v18, v2 row_newbcast:7 row_mask:0xf bank_mask:0xc
  s_add_u32 m0, s76, 4096
  v_add_u32_dpp v57, v20, v2 row_newbcast:1 row_mask:0xf bank_mask:0x3
  buffer_load_dwordx4 v58, s[32:35], 0 offen lds
  s_nop 0
  v_add_u32_dpp v57, v22, v2 row_newbcast:7 row_mask:0xf bank_mask:0xc
  s_add_u32 m0, s76, 6144
  v_add_u32_dpp v58, v24, v2 row_newbcast:1 row_mask:0xf bank_mask:0x3
  buffer_load_dwordx4 v59, s[32:35], 0 offen lds
  s_nop 0
  v_add_u32_dpp v58, v26, v2 row_newbcast:7 row_mask:0xf bank_mask:0xc
  s_add_u32 m0, s76, 8192
  v_add_u32_dpp v59, v28, v2 row_newbcast:1 row_mask:0xf bank_mask:0x3
  buffer_load_dwordx4 v60, s[32:35], 0 offen lds
  s_nop 0
  v_add_u32_dpp v59, v30, v2 row_newbcast:7 row_mask:0xf bank_mask:0xc
  s_add_u32 m0, s76, 10240
  v_add_u32_dpp v60, v32, v2 row_newbcast:1 row_mask:0xf bank_mask:0x3
  buffer_load_dwordx4 v61, s[32:35], 0 offen lds
  s_nop 0
  v_add_u32_dpp v60, v34, v2 row_newbcast:7 row_mask:0xf bank_mask:0xc
  s_add_u32 m0, s76, 12288
  v_add_u32_dpp v61, v36, v2 row_newbcast:1 row_mask:0xf bank_mask:0x3
  buffer_load_dwordx4 v62, s[32:35], 0 offen lds
  s_nop 0
  v_add_u32_dpp v61, v38, v2 row_newbcast:7 row_mask:0xf bank_mask:0xc
  s_add_u32 m0, s76, 14336
  v_add_u32_dpp v62, v40, v2 row_newbcast:1 row_mask:0xf bank_mask:0x3
  buffer_load_dwordx4 v63, s[32:35], 0 offen lds
  s_nop 0
  v_add_u32_dpp v62, v42, v2 row_newbcast:7 row_mask:0xf bank_mask:0xc
  s_add_u32 m0, s76, 16384
  v_add_u32_dpp v63, v44, v2 row_newbcast:1 row_mask:0xf bank_mask:0x3
  buffer_load_dwordx4 v64, s[32:35], 0 offen lds
  s_nop 0
  v_add_u32_dpp v63, v46, v2 row_newbcast:7 row_mask:0xf bank_mask:0xc
  s_add_u32 m0, s76, 18432
  v_add_u32_dpp v64, v48, v2 row_newbcast:1 row_mask:0xf bank_mask:0x3
  buffer_load_dwordx4 v65, s[32:35], 0 offen lds
  s_nop 0
  v_add_u32_dpp v64, v50, v2 row_newbcast:7 row_mask:0xf bank_mask:0xc
  v_add_u32_dpp v65, v52, v2 row_newbcast:1 row_mask:0xf bank_mask:0x3
  s_nop 1
  v_add_u32_dpp v65, v54, v2 row_newbcast:7 row_mask:0xf bank_mask:0xc
  s_mov_b64 exec, 0x3ff
  buffer_load_dword v103, v84, s[44:47], s85 offen
  s_mov_b64 exec, -1
  s_add_u32 s85, s85, 865280
  s_waitcnt vmcnt(11)
  s_barrier
  s_add_u32 m0, s75, 147456
  s_nop 0
  buffer_load_dwordx4 v4, s[44:47], s74 offen lds
  s_add_u32 m0, s75, 148480
  s_nop 0
  buffer_load_dwordx4 v5, s[44:47], s74 offen lds
  s_add_u32 s74, s74, 106496
  s_add_u32 m0, s75, 155648
  s_nop 0
  buffer_load_dwordx4 v4, s[44:47], s74 offen lds
  s_add_u32 m0, s75, 156672
  s_nop 0
  buffer_load_dwordx4 v5, s[44:47], s74 offen lds
  s_add_u32 s74, s74, 106496
  s_add_u32 m0, s76, 40960
  s_nop 0
  buffer_load_dwordx4 v56, s[32:35], 0 offen lds
  s_add_u32 m0, s76, 43008
  v_add_u32_dpp v56, v17, v2 row_newbcast:1 row_mask:0xf bank_mask:0x3
  buffer_load_dwordx4 v57, s[32:35], 0 offen lds
  s_nop 0
  v_add_u32_dpp v56, v19, v2 row_newbcast:7 row_mask:0xf bank_mask:0xc
  s_add_u32 m0, s76, 45056
  v_add_u32_dpp v57, v21, v2 row_newbcast:1 row_mask:0xf bank_mask:0x3
  buffer_load_dwordx4 v58, s[32:35], 0 offen lds
  s_nop 0
  v_add_u32_dpp v57, v23, v2 row_newbcast:7 row_mask:0xf bank_mask:0xc
  s_add_u32 m0, s76, 47104
  v_add_u32_dpp v58, v25, v2 row_newbcast:1 row_mask:0xf bank_mask:0x3
  buffer_load_dwordx4 v59, s[32:35], 0 offen lds
  s_nop 0
  v_add_u32_dpp v58, v27, v2 row_newbcast:7 row_mask:0xf bank_mask:0xc
  s_add_u32 m0, s76, 49152
  v_add_u32_dpp v59, v29, v2 row_newbcast:1 row_mask:0xf bank_mask:0x3
  buffer_load_dwordx4 v60, s[32:35], 0 offen lds
  s_nop 0
  v_add_u32_dpp v59, v31, v2 row_newbcast:7 row_mask:0xf bank_mask:0xc
  s_add_u32 m0, s76, 51200
  v_add_u32_dpp v60, v33, v2 row_newbcast:1 row_mask:0xf bank_mask:0x3
  buffer_load_dwordx4 v61, s[32:35], 0 offen lds
  s_nop 0
  v_add_u32_dpp v60, v35, v2 row_newbcast:7 row_mask:0xf bank_mask:0xc
  s_add_u32 m0, s76, 53248
  v_add_u32_dpp v61, v37, v2 row_newbcast:1 row_mask:0xf bank_mask:0x3
  buffer_load_dwordx4 v62, s[32:35], 0 offen lds
  s_nop 0
  v_add_u32_dpp v61, v39, v2 row_newbcast:7 row_mask:0xf bank_mask:0xc
  s_add_u32 m0, s76, 55296
  v_add_u32_dpp v62, v41, v2 row_newbcast:1 row_mask:0xf bank_mask:0x3
  buffer_load_dwordx4 v63, s[32:35], 0 offen lds
  s_nop 0
  v_add_u32_dpp v62, v43, v2 row_newbcast:7 row_mask:0xf bank_mask:0xc
  s_add_u32 m0, s76, 57344
  v_add_u32_dpp v63, v45, v2 row_newbcast:1 row_mask:0xf bank_mask:0x3
  buffer_load_dwordx4 v64, s[32:35], 0 offen lds
  s_nop 0
  v_add_u32_dpp v63, v47, v2 row_newbcast:7 row_mask:0xf bank_mask:0xc
  s_add_u32 m0, s76, 59392
  v_add_u32_dpp v64, v49, v2 row_newbcast:1 row_mask:0xf bank_mask:0x3
  buffer_load_dwordx4 v65, s[32:35], 0 offen lds
  s_nop 0
  v_add_u32_dpp v64, v51, v2 row_newbcast:7 row_mask:0xf bank_mask:0xc
  v_add_u32_dpp v65, v53, v2 row_newbcast:1 row_mask:0xf bank_mask:0x3
  s_nop 1
  v_add_u32_dpp v65, v55, v2 row_newbcast:7 row_mask:0xf bank_mask:0xc
  s_waitcnt vmcnt(10)
  s_barrier
  s_add_u32 m0, s75, 131072
  s_nop 0
  buffer_load_dwordx4 v4, s[44:47], s74 offen lds
  s_add_u32 m0, s75, 132096
  s_nop 0
  buffer_load_dwordx4 v5, s[44:47], s74 offen lds
  s_add_u32 s74, s74, 106496
  s_add_u32 m0, s75, 139264
  s_nop 0
  buffer_load_dwordx4 v4, s[44:47], s74 offen lds
  s_add_u32 m0, s75, 140288
  s_nop 0
  buffer_load_dwordx4 v5, s[44:47], s74 offen lds
  s_add_u32 s74, s74, 106496
  s_add_u32 m0, s76, 81920
  s_nop 0
  buffer_load_dwordx4 v56, s[32:35], 0 offen lds
  s_add_u32 m0, s76, 83968
  v_add_u32_dpp v56, v18, v2 row_newbcast:1 row_mask:0xf bank_mask:0x3
  buffer_load_dwordx4 v57, s[32:35], 0 offen lds
  s_nop 0
  v_add_u32_dpp v56, v16, v2 row_newbcast:8 row_mask:0xf bank_mask:0xc
  s_add_u32 m0, s76, 86016
  v_add_u32_dpp v57, v22, v2 row_newbcast:1 row_mask:0xf bank_mask:0x3
  buffer_load_dwordx4 v58, s[32:35], 0 offen lds
  s_nop 0
  v_add_u32_dpp v57, v20, v2 row_newbcast:8 row_mask:0xf bank_mask:0xc
  s_add_u32 m0, s76, 88064
  v_add_u32_dpp v58, v26, v2 row_newbcast:1 row_mask:0xf bank_mask:0x3
  buffer_load_dwordx4 v59, s[32:35], 0 offen lds
  s_nop 0
  v_add_u32_dpp v58, v24, v2 row_newbcast:8 row_mask:0xf bank_mask:0xc
  s_add_u32 m0, s76, 90112
  v_add_u32_dpp v59, v30, v2 row_newbcast:1 row_mask:0xf bank_mask:0x3
  buffer_load_dwordx4 v60, s[32:35], 0 offen lds
  s_nop 0
  v_add_u32_dpp v59, v28, v2 row_newbcast:8 row_mask:0xf bank_mask:0xc
  s_add_u32 m0, s76, 92160
  v_add_u32_dpp v60, v34, v2 row_newbcast:1 row_mask:0xf bank_mask:0x3
  buffer_load_dwordx4 v61, s[32:35], 0 offen lds
  s_nop 0
  v_add_u32_dpp v60, v32, v2 row_newbcast:8 row_mask:0xf bank_mask:0xc
  s_add_u32 m0, s76, 94208
  v_add_u32_dpp v61, v38, v2 row_newbcast:1 row_mask:0xf bank_mask:0x3
  buffer_load_dwordx4 v62, s[32:35], 0 offen lds
  s_nop 0
  v_add_u32_dpp v61, v36, v2 row_newbcast:8 row_mask:0xf bank_mask:0xc
  s_add_u32 m0, s76, 96256
  v_add_u32_dpp v62, v42, v2 row_newbcast:1 row_mask:0xf bank_mask:0x3
  buffer_load_dwordx4 v63, s[32:35], 0 offen lds
  s_nop 0
  v_add_u32_dpp v62, v40, v2 row_newbcast:8 row_mask:0xf bank_mask:0xc
  s_add_u32 m0, s76, 98304
  v_add_u32_dpp v63, v46, v2 row_newbcast:1 row_mask:0xf bank_mask:0x3
  buffer_load_dwordx4 v64, s[32:35], 0 offen lds
  s_nop 0
  v_add_u32_dpp v63, v44, v2 row_newbcast:8 row_mask:0xf bank_mask:0xc
  s_add_u32 m0, s76, 100352
  v_add_u32_dpp v64, v50, v2 row_newbcast:1 row_mask:0xf bank_mask:0x3
  buffer_load_dwordx4 v65, s[32:35], 0 offen lds
  s_nop 0
  v_add_u32_dpp v64, v48, v2 row_newbcast:8 row_mask:0xf bank_mask:0xc
  v_add_u32_dpp v65, v54, v2 row_newbcast:1 row_mask:0xf bank_mask:0x3
  s_nop 1
  v_add_u32_dpp v65, v52, v2 row_newbcast:8 row_mask:0xf bank_mask:0xc
  v_lshlrev_b32 v101, 7, v70
  s_mov_b32 exec_lo, 0xffffffff
  s_mov_b32 exec_hi, 0x0
  buffer_load_dword v102, v101, s[32:35], 0 offen
  s_mov_b64 exec, -1
  v_mov_b32 v70, v71
  v_mov_b32 v71, v72
  v_mov_b32 v72, v73
  v_mov_b32_e64 v73, v74
  v_mov_b32 v74, 0xffffff
  s_waitcnt vmcnt(11)
  s_barrier
  s_add_u32 m0, s75, 147456
  s_nop 0
  buffer_load_dwordx4 v4, s[44:47], s74 offen lds
  s_add_u32 m0, s75, 148480
  s_nop 0
  buffer_load_dwordx4 v5, s[44:47], s74 offen lds
  s_add_u32 s74, s74, 106496
  s_add_u32 m0, s75, 155648
  s_nop 0
  buffer_load_dwordx4 v4, s[44:47], s74 offen lds
  s_add_u32 m0, s75, 156672
  s_nop 0
  buffer_load_dwordx4 v5, s[44:47], s74 offen lds
  s_add_u32 s74, s74, 106496
  s_add_u32 m0, s76, 0
  s_nop 0
  buffer_load_dwordx4 v56, s[32:35], 0 offen lds
  s_add_u32 m0, s76, 2048
  v_add_u32_dpp v56, v19, v2 row_newbcast:1 row_mask:0xf bank_mask:0x3
  buffer_load_dwordx4 v57, s[32:35], 0 offen lds
  s_nop 0
  v_add_u32_dpp v56, v17, v2 row_newbcast:8 row_mask:0xf bank_mask:0xc
  s_add_u32 m0, s76, 4096
  v_add_u32_dpp v57, v23, v2 row_newbcast:1 row_mask:0xf bank_mask:0x3
  buffer_load_dwordx4 v58, s[32:35], 0 offen lds
  s_nop 0
  v_add_u32_dpp v57, v21, v2 row_newbcast:8 row_mask:0xf bank_mask:0xc
  s_add_u32 m0, s76, 6144
  v_add_u32_dpp v58, v27, v2 row_newbcast:1 row_mask:0xf bank_mask:0x3
  buffer_load_dwordx4 v59, s[32:35], 0 offen lds
  s_nop 0
  v_add_u32_dpp v58, v25, v2 row_newbcast:8 row_mask:0xf bank_mask:0xc
  s_add_u32 m0, s76, 8192
  v_add_u32_dpp v59, v31, v2 row_newbcast:1 row_mask:0xf bank_mask:0x3
  buffer_load_dwordx4 v60, s[32:35], 0 offen lds
  s_nop 0
  v_add_u32_dpp v59, v29, v2 row_newbcast:8 row_mask:0xf bank_mask:0xc
  s_add_u32 m0, s76, 10240
  v_add_u32_dpp v60, v35, v2 row_newbcast:1 row_mask:0xf bank_mask:0x3
  buffer_load_dwordx4 v61, s[32:35], 0 offen lds
  s_nop 0
  v_add_u32_dpp v60, v33, v2 row_newbcast:8 row_mask:0xf bank_mask:0xc
  s_add_u32 m0, s76, 12288
  v_add_u32_dpp v61, v39, v2 row_newbcast:1 row_mask:0xf bank_mask:0x3
  buffer_load_dwordx4 v62, s[32:35], 0 offen lds
  s_nop 0
  v_add_u32_dpp v61, v37, v2 row_newbcast:8 row_mask:0xf bank_mask:0xc
  s_add_u32 m0, s76, 14336
  v_add_u32_dpp v62, v43, v2 row_newbcast:1 row_mask:0xf bank_mask:0x3
  buffer_load_dwordx4 v63, s[32:35], 0 offen lds
  s_nop 0
  v_add_u32_dpp v62, v41, v2 row_newbcast:8 row_mask:0xf bank_mask:0xc
  s_add_u32 m0, s76, 16384
  v_add_u32_dpp v63, v47, v2 row_newbcast:1 row_mask:0xf bank_mask:0x3
  buffer_load_dwordx4 v64, s[32:35], 0 offen lds
  s_nop 0
  v_add_u32_dpp v63, v45, v2 row_newbcast:8 row_mask:0xf bank_mask:0xc
  s_add_u32 m0, s76, 18432
  v_add_u32_dpp v64, v51, v2 row_newbcast:1 row_mask:0xf bank_mask:0x3
  buffer_load_dwordx4 v65, s[32:35], 0 offen lds
  s_nop 0
  v_add_u32_dpp v64, v49, v2 row_newbcast:8 row_mask:0xf bank_mask:0xc
  v_add_u32_dpp v65, v55, v2 row_newbcast:1 row_mask:0xf bank_mask:0x3
  s_nop 1
  v_add_u32_dpp v65, v53, v2 row_newbcast:8 row_mask:0xf bank_mask:0xc
  s_waitcnt vmcnt(10)
  s_barrier
  s_add_u32 m0, s75, 131072
  s_nop 0
  buffer_load_dwordx4 v4, s[44:47], s74 offen lds
  s_add_u32 m0, s75, 132096
  s_nop 0
  buffer_load_dwordx4 v5, s[44:47], s74 offen lds
  s_add_u32 s74, s74, 106496
  s_add_u32 m0, s75, 139264
  s_nop 0
  buffer_load_dwordx4 v4, s[44:47], s74 offen lds
  s_add_u32 m0, s75, 140288
  s_nop 0
  buffer_load_dwordx4 v5, s[44:47], s74 offen lds
  s_add_u32 s74, s74, 106496
  s_add_u32 m0, s76, 40960
  s_nop 0
  buffer_load_dwordx4 v56, s[32:35], 0 offen lds
  s_add_u32 m0, s76, 43008
  v_add_u32_dpp v56, v16, v2 row_newbcast:2 row_mask:0xf bank_mask:0x3
  buffer_load_dwordx4 v57, s[32:35], 0 offen lds
  s_nop 0
  v_add_u32_dpp v56, v18, v2 row_newbcast:8 row_mask:0xf bank_mask:0xc
  s_add_u32 m0, s76, 45056
  v_add_u32_dpp v57, v20, v2 row_newbcast:2 row_mask:0xf bank_mask:0x3
  buffer_load_dwordx4 v58, s[32:35], 0 offen lds
  s_nop 0
  v_add_u32_dpp v57, v22, v2 row_newbcast:8 row_mask:0xf bank_mask:0xc
  s_add_u32 m0, s76, 47104
  v_add_u32_dpp v58, v24, v2 row_newbcast:2 row_mask:0xf bank_mask:0x3
  buffer_load_dwordx4 v59, s[32:35], 0 offen lds
  s_nop 0
  v_add_u32_dpp v58, v26, v2 row_newbcast:8 row_mask:0xf bank_mask:0xc
  s_add_u32 m0, s76, 49152
  v_add_u32_dpp v59, v28, v2 row_newbcast:2 row_mask:0xf bank_mask:0x3
  buffer_load_dwordx4 v60, s[32:35], 0 offen lds
  s_nop 0
  v_add_u32_dpp v59, v30, v2 row_newbcast:8 row_mask:0xf bank_mask:0xc
  s_add_u32 m0, s76, 51200
  v_add_u32_dpp v60, v32, v2 row_newbcast:2 row_mask:0xf bank_mask:0x3
  buffer_load_dwordx4 v61, s[32:35], 0 offen lds
  s_nop 0
  v_add_u32_dpp v60, v34, v2 row_newbcast:8 row_mask:0xf bank_mask:0xc
  s_add_u32 m0, s76, 53248
  v_add_u32_dpp v61, v36, v2 row_newbcast:2 row_mask:0xf bank_mask:0x3
  buffer_load_dwordx4 v62, s[32:35], 0 offen lds
  s_nop 0
  v_add_u32_dpp v61, v38, v2 row_newbcast:8 row_mask:0xf bank_mask:0xc
  s_add_u32 m0, s76, 55296
  v_add_u32_dpp v62, v40, v2 row_newbcast:2 row_mask:0xf bank_mask:0x3
  buffer_load_dwordx4 v63, s[32:35], 0 offen lds
  s_nop 0
  v_add_u32_dpp v62, v42, v2 row_newbcast:8 row_mask:0xf bank_mask:0xc
  s_add_u32 m0, s76, 57344
  v_add_u32_dpp v63, v44, v2 row_newbcast:2 row_mask:0xf bank_mask:0x3
  buffer_load_dwordx4 v64, s[32:35], 0 offen lds
  s_nop 0
  v_add_u32_dpp v63, v46, v2 row_newbcast:8 row_mask:0xf bank_mask:0xc
  s_add_u32 m0, s76, 59392
  v_add_u32_dpp v64, v48, v2 row_newbcast:2 row_mask:0xf bank_mask:0x3
  buffer_load_dwordx4 v65, s[32:35], 0 offen lds
  s_nop 0
  v_add_u32_dpp v64, v50, v2 row_newbcast:8 row_mask:0xf bank_mask:0xc
  v_add_u32_dpp v65, v52, v2 row_newbcast:2 row_mask:0xf bank_mask:0x3
  s_nop 1
  v_add_u32_dpp v65, v54, v2 row_newbcast:8 row_mask:0xf bank_mask:0xc
  s_mov_b64 exec, 0x3ff
  buffer_load_dword v103, v84, s[44:47], s85 offen
  s_mov_b64 exec, -1
  s_add_u32 s85, s85, 865280
  s_waitcnt vmcnt(11)
  s_barrier
  s_add_u32 m0, s75, 147456
  s_nop 0
  buffer_load_dwordx4 v4, s[44:47], s74 offen lds
  s_add_u32 m0, s75, 148480
  s_nop 0
  buffer_load_dwordx4 v5, s[44:47], s74 offen lds
  s_add_u32 s74, s74, 106496
  s_add_u32 m0, s75, 155648
  s_nop 0
  buffer_load_dwordx4 v4, s[44:47], s74 offen lds
  s_add_u32 m0, s75, 156672
  s_nop 0
  buffer_load_dwordx4 v5, s[44:47], s74 offen lds
  s_add_u32 s74, s74, 106496
  s_add_u32 m0, s76, 81920
  s_nop 0
  buffer_load_dwordx4 v56, s[32:35], 0 offen lds
  s_add_u32 m0, s76, 83968
  v_add_u32_dpp v56, v17, v2 row_newbcast:2 row_mask:0xf bank_mask:0x3
  buffer_load_dwordx4 v57, s[32:35], 0 offen lds
  s_nop 0
  v_add_u32_dpp v56, v19, v2 row_newbcast:8 row_mask:0xf bank_mask:0xc
  s_add_u32 m0, s76, 86016
  v_add_u32_dpp v57, v21, v2 row_newbcast:2 row_mask:0xf bank_mask:0x3
  buffer_load_dwordx4 v58, s[32:35], 0 offen lds
  s_nop 0
  v_add_u32_dpp v57, v23, v2 row_newbcast:8 row_mask:0xf bank_mask:0xc
  s_add_u32 m0, s76, 88064
  v_add_u32_dpp v58, v25, v2 row_newbcast:2 row_mask:0xf bank_mask:0x3
  buffer_load_dwordx4 v59, s[32:35], 0 offen lds
  s_nop 0
  v_add_u32_dpp v58, v27, v2 row_newbcast:8 row_mask:0xf bank_mask:0xc
  s_add_u32 m0, s76, 90112
  v_add_u32_dpp v59, v29, v2 row_newbcast:2 row_mask:0xf bank_mask:0x3
  buffer_load_dwordx4 v60, s[32:35], 0 offen lds
  s_nop 0
  v_add_u32_dpp v59, v31, v2 row_newbcast:8 row_mask:0xf bank_mask:0xc
  s_add_u32 m0, s76, 92160
  v_add_u32_dpp v60, v33, v2 row_newbcast:2 row_mask:0xf bank_mask:0x3
  buffer_load_dwordx4 v61, s[32:35], 0 offen lds
  s_nop 0
  v_add_u32_dpp v60, v35, v2 row_newbcast:8 row_mask:0xf bank_mask:0xc
  s_add_u32 m0, s76, 94208
  v_add_u32_dpp v61, v37, v2 row_newbcast:2 row_mask:0xf bank_mask:0x3
  buffer_load_dwordx4 v62, s[32:35], 0 offen lds
  s_nop 0
  v_add_u32_dpp v61, v39, v2 row_newbcast:8 row_mask:0xf bank_mask:0xc
  s_add_u32 m0, s76, 96256
  v_add_u32_dpp v62, v41, v2 row_newbcast:2 row_mask:0xf bank_mask:0x3
  buffer_load_dwordx4 v63, s[32:35], 0 offen lds
  s_nop 0
  v_add_u32_dpp v62, v43, v2 row_newbcast:8 row_mask:0xf bank_mask:0xc
  s_add_u32 m0, s76, 98304
  v_add_u32_dpp v63, v45, v2 row_newbcast:2 row_mask:0xf bank_mask:0x3
  buffer_load_dwordx4 v64, s[32:35], 0 offen lds
  s_nop 0
  v_add_u32_dpp v63, v47, v2 row_newbcast:8 row_mask:0xf bank_mask:0xc
  s_add_u32 m0, s76, 100352
  v_add_u32_dpp v64, v49, v2 row_newbcast:2 row_mask:0xf bank_mask:0x3
  buffer_load_dwordx4 v65, s[32:35], 0 offen lds
  s_nop 0
  v_add_u32_dpp v64, v51, v2 row_newbcast:8 row_mask:0xf bank_mask:0xc
  v_add_u32_dpp v65, v53, v2 row_newbcast:2 row_mask:0xf bank_mask:0x3
  s_nop 1
  v_add_u32_dpp v65, v55, v2 row_newbcast:8 row_mask:0xf bank_mask:0xc
  s_waitcnt vmcnt(10)
  s_barrier
  s_add_u32 m0, s75, 131072
  s_nop 0
  buffer_load_dwordx4 v4, s[44:47], s74 offen lds
  s_add_u32 m0, s75, 132096
  s_nop 0
  buffer_load_dwordx4 v5, s[44:47], s74 offen lds
  s_add_u32 s74, s74, 106496
  s_add_u32 m0, s75, 139264
  s_nop 0
  buffer_load_dwordx4 v4, s[44:47], s74 offen lds
  s_add_u32 m0, s75, 140288
  s_nop 0
  buffer_load_dwordx4 v5, s[44:47], s74 offen lds
  s_add_u32 s74, s74, 106496
  s_add_u32 m0, s76, 0
  s_nop 0
  buffer_load_dwordx4 v56, s[32:35], 0 offen lds
  s_add_u32 m0, s76, 2048
  v_add_u32_dpp v56, v18, v2 row_newbcast:2 row_mask:0xf bank_mask:0x3
  buffer_load_dwordx4 v57, s[32:35], 0 offen lds
  s_nop 0
  v_add_u32_dpp v56, v16, v2 row_newbcast:9 row_mask:0xf bank_mask:0xc
  s_add_u32 m0, s76, 4096
  v_add_u32_dpp v57, v22, v2 row_newbcast:2 row_mask:0xf bank_mask:0x3
  buffer_load_dwordx4 v58, s[32:35], 0 offen lds
  s_nop 0
  v_add_u32_dpp v57, v20, v2 row_newbcast:9 row_mask:0xf bank_mask:0xc
  s_add_u32 m0, s76, 6144
  v_add_u32_dpp v58, v26, v2 row_newbcast:2 row_mask:0xf bank_mask:0x3
  buffer_load_dwordx4 v59, s[32:35], 0 offen lds
  s_nop 0
  v_add_u32_dpp v58, v24, v2 row_newbcast:9 row_mask:0xf bank_mask:0xc
  s_add_u32 m0, s76, 8192
  v_add_u32_dpp v59, v30, v2 row_newbcast:2 row_mask:0xf bank_mask:0x3
  buffer_load_dwordx4 v60, s[32:35], 0 offen lds
  s_nop 0
  v_add_u32_dpp v59, v28, v2 row_newbcast:9 row_mask:0xf bank_mask:0xc
  s_add_u32 m0, s76, 10240
  v_add_u32_dpp v60, v34, v2 row_newbcast:2 row_mask:0xf bank_mask:0x3
  buffer_load_dwordx4 v61, s[32:35], 0 offen lds
  s_nop 0
  v_add_u32_dpp v60, v32, v2 row_newbcast:9 row_mask:0xf bank_mask:0xc
  s_add_u32 m0, s76, 12288
  v_add_u32_dpp v61, v38, v2 row_newbcast:2 row_mask:0xf bank_mask:0x3
  buffer_load_dwordx4 v62, s[32:35], 0 offen lds
  s_nop 0
  v_add_u32_dpp v61, v36, v2 row_newbcast:9 row_mask:0xf bank_mask:0xc
  s_add_u32 m0, s76, 14336
  v_add_u32_dpp v62, v42, v2 row_newbcast:2 row_mask:0xf bank_mask:0x3
  buffer_load_dwordx4 v63, s[32:35], 0 offen lds
  s_nop 0
  v_add_u32_dpp v62, v40, v2 row_newbcast:9 row_mask:0xf bank_mask:0xc
  s_add_u32 m0, s76, 16384
  v_add_u32_dpp v63, v46, v2 row_newbcast:2 row_mask:0xf bank_mask:0x3
  buffer_load_dwordx4 v64, s[32:35], 0 offen lds
  s_nop 0
  v_add_u32_dpp v63, v44, v2 row_newbcast:9 row_mask:0xf bank_mask:0xc
  s_add_u32 m0, s76, 18432
  v_add_u32_dpp v64, v50, v2 row_newbcast:2 row_mask:0xf bank_mask:0x3
  buffer_load_dwordx4 v65, s[32:35], 0 offen lds
  s_nop 0
  v_add_u32_dpp v64, v48, v2 row_newbcast:9 row_mask:0xf bank_mask:0xc
  v_add_u32_dpp v65, v54, v2 row_newbcast:2 row_mask:0xf bank_mask:0x3
  s_nop 1
  v_add_u32_dpp v65, v52, v2 row_newbcast:9 row_mask:0xf bank_mask:0xc
  v_lshlrev_b32 v101, 7, v70
  s_mov_b32 exec_lo, 0xffffffff
  s_mov_b32 exec_hi, 0x0
  buffer_load_dword v102, v101, s[32:35], 0 offen
  s_mov_b64 exec, -1
  v_mov_b32 v70, v71
  v_mov_b32 v71, v72
  v_mov_b32 v72, v73
  v_mov_b32 v73, v74
  v_mov_b32 v74, 0xffffff
  s_waitcnt vmcnt(11)
  s_barrier
  s_add_u32 m0, s75, 147456
  s_nop 0
  buffer_load_dwordx4 v4, s[44:47], s74 offen lds
  s_add_u32 m0, s75, 148480
  s_nop 0
  buffer_load_dwordx4 v5, s[44:47], s74 offen lds
  s_add_u32 s74, s74, 106496
  s_add_u32 m0, s75, 155648
  s_nop 0
  buffer_load_dwordx4 v4, s[44:47], s74 offen lds
  s_add_u32 m0, s75, 156672
  s_nop 0
  buffer_load_dwordx4 v5, s[44:47], s74 offen lds
  s_add_u32 s74, s74, 106496
  s_add_u32 m0, s76, 40960
  s_nop 0
  buffer_load_dwordx4 v56, s[32:35], 0 offen lds
  s_add_u32 m0, s76, 43008
  v_add_u32_dpp v56, v19, v2 row_newbcast:2 row_mask:0xf bank_mask:0x3
  buffer_load_dwordx4 v57, s[32:35], 0 offen lds
  s_nop 0
  v_add_u32_dpp v56, v17, v2 row_newbcast:9 row_mask:0xf bank_mask:0xc
  s_add_u32 m0, s76, 45056
  v_add_u32_dpp v57, v23, v2 row_newbcast:2 row_mask:0xf bank_mask:0x3
  buffer_load_dwordx4 v58, s[32:35], 0 offen lds
  s_nop 0
  v_add_u32_dpp v57, v21, v2 row_newbcast:9 row_mask:0xf bank_mask:0xc
  s_add_u32 m0, s76, 47104
  v_add_u32_dpp v58, v27, v2 row_newbcast:2 row_mask:0xf bank_mask:0x3
  buffer_load_dwordx4 v59, s[32:35], 0 offen lds
  s_nop 0
  v_add_u32_dpp v58, v25, v2 row_newbcast:9 row_mask:0xf bank_mask:0xc
  s_add_u32 m0, s76, 49152
  v_add_u32_dpp v59, v31, v2 row_newbcast:2 row_mask:0xf bank_mask:0x3
  buffer_load_dwordx4 v60, s[32:35], 0 offen lds
  s_nop 0
  v_add_u32_dpp v59, v29, v2 row_newbcast:9 row_mask:0xf bank_mask:0xc
  s_add_u32 m0, s76, 51200
  v_add_u32_dpp v60, v35, v2 row_newbcast:2 row_mask:0xf bank_mask:0x3
  buffer_load_dwordx4 v61, s[32:35], 0 offen lds
  s_nop 0
  v_add_u32_dpp v60, v33, v2 row_newbcast:9 row_mask:0xf bank_mask:0xc
  s_add_u32 m0, s76, 53248
  v_add_u32_dpp v61, v39, v2 row_newbcast:2 row_mask:0xf bank_mask:0x3
  buffer_load_dwordx4 v62, s[32:35], 0 offen lds
  s_nop 0
  v_add_u32_dpp v61, v37, v2 row_newbcast:9 row_mask:0xf bank_mask:0xc
  s_add_u32 m0, s76, 55296
  v_add_u32_dpp v62, v43, v2 row_newbcast:2 row_mask:0xf bank_mask:0x3
  buffer_load_dwordx4 v63, s[32:35], 0 offen lds
  s_nop 0
  v_add_u32_dpp v62, v41, v2 row_newbcast:9 row_mask:0xf bank_mask:0xc
  s_add_u32 m0, s76, 57344
  v_add_u32_dpp v63, v47, v2 row_newbcast:2 row_mask:0xf bank_mask:0x3
  buffer_load_dwordx4 v64, s[32:35], 0 offen lds
  s_nop 0
  v_add_u32_dpp v63, v45, v2 row_newbcast:9 row_mask:0xf bank_mask:0xc
  s_add_u32 m0, s76, 59392
  v_add_u32_dpp v64, v51, v2 row_newbcast:2 row_mask:0xf bank_mask:0x3
  buffer_load_dwordx4 v65, s[32:35], 0 offen lds
  s_nop 0
  v_add_u32_dpp v64, v49, v2 row_newbcast:9 row_mask:0xf bank_mask:0xc
  v_add_u32_dpp v65, v55, v2 row_newbcast:2 row_mask:0xf bank_mask:0x3
  s_nop 1
  v_add_u32_dpp v65, v53, v2 row_newbcast:9 row_mask:0xf bank_mask:0xc
  s_waitcnt vmcnt(10)
  s_cmp_lg_u32 s72, 1
  s_cbranch_scc1 L_nolpf
  s_mov_b64 exec, 1048575
  global_load_dword v10, v[8:9], off
  s_mov_b64 exec, -1
  s_mov_b32 m0, 123136
  s_mov_b64 exec, 0xffff
  buffer_load_dwordx4 v11, s[52:55], s77 offen lds
  s_mov_b64 exec, -1
L_nolpf:
  s_barrier
  s_add_u32 m0, s75, 131072
  s_nop 0
  buffer_load_dwordx4 v4, s[44:47], s74 offen lds
  s_add_u32 m0, s75, 132096
  s_nop 0
  buffer_load_dwordx4 v5, s[44:47], s74 offen lds
  s_add_u32 s74, s74, 106496
  s_add_u32 m0, s75, 139264
  s_nop 0
  buffer_load_dwordx4 v4, s[44:47], s74 offen lds
  s_add_u32 m0, s75, 140288
  s_nop 0
  buffer_load_dwordx4 v5, s[44:47], s74 offen lds
  s_add_u32 s74, s74, 106496
  s_add_u32 m0, s76, 81920
  s_nop 0
  buffer_load_dwordx4 v56, s[32:35], 0 offen lds
  s_add_u32 m0, s76, 83968
  v_add_u32_dpp v56, v16, v2 row_newbcast:3 row_mask:0xf bank_mask:0x3
  buffer_load_dwordx4 v57, s[32:35], 0 offen lds
  s_nop 0
  v_add_u32_dpp v56, v18, v2 row_newbcast:9 row_mask:0xf bank_mask:0xc
  s_add_u32 m0, s76, 86016
  v_add_u32_dpp v57, v20, v2 row_newbcast:3 row_mask:0xf bank_mask:0x3
  buffer_load_dwordx4 v58, s[32:35], 0 offen lds
  s_nop 0
  v_add_u32_dpp v57, v22, v2 row_newbcast:9 row_mask:0xf bank_mask:0xc
  s_add_u32 m0, s76, 88064
  v_add_u32_dpp v58, v24, v2 row_newbcast:3 row_mask:0xf bank_mask:0x3
  buffer_load_dwordx4 v59, s[32:35], 0 offen lds
  s_nop 0
  v_add_u32_dpp v58, v26, v2 row_newbcast:9 row_mask:0xf bank_mask:0xc
  s_add_u32 m0, s76, 90112
  v_add_u32_dpp v59, v28, v2 row_newbcast:3 row_mask:0xf bank_mask:0x3
  buffer_load_dwordx4 v60, s[32:35], 0 offen lds
  s_nop 0
  v_add_u32_dpp v59, v30, v2 row_newbcast:9 row_mask:0xf bank_mask:0xc
  s_add_u32 m0, s76, 92160
  v_add_u32_dpp v60, v32, v2 row_newbcast:3 row_mask:0xf bank_mask:0x3
  buffer_load_dwordx4 v61, s[32:35], 0 offen lds
  s_nop 0
  v_add_u32_dpp v60, v34, v2 row_newbcast:9 row_mask:0xf bank_mask:0xc
  s_add_u32 m0, s76, 94208
  v_add_u32_dpp v61, v36, v2 row_newbcast:3 row_mask:0xf bank_mask:0x3
  buffer_load_dwordx4 v62, s[32:35], 0 offen lds
  s_nop 0
  v_add_u32_dpp v61, v38, v2 row_newbcast:9 row_mask:0xf bank_mask:0xc
  s_add_u32 m0, s76, 96256
  v_add_u32_dpp v62, v40, v2 row_newbcast:3 row_mask:0xf bank_mask:0x3
  buffer_load_dwordx4 v63, s[32:35], 0 offen lds
  s_nop 0
  v_add_u32_dpp v62, v42, v2 row_newbcast:9 row_mask:0xf bank_mask:0xc
  s_add_u32 m0, s76, 98304
  v_add_u32_dpp v63, v44, v2 row_newbcast:3 row_mask:0xf bank_mask:0x3
  buffer_load_dwordx4 v64, s[32:35], 0 offen lds
  s_nop 0
  v_add_u32_dpp v63, v46, v2 row_newbcast:9 row_mask:0xf bank_mask:0xc
  s_add_u32 m0, s76, 100352
  v_add_u32_dpp v64, v48, v2 row_newbcast:3 row_mask:0xf bank_mask:0x3
  buffer_load_dwordx4 v65, s[32:35], 0 offen lds
  s_nop 0
  v_add_u32_dpp v64, v50, v2 row_newbcast:9 row_mask:0xf bank_mask:0xc
  v_add_u32_dpp v65, v52, v2 row_newbcast:3 row_mask:0xf bank_mask:0x3
  s_nop 1
  v_add_u32_dpp v65, v54, v2 row_newbcast:9 row_mask:0xf bank_mask:0xc
  s_mov_b64 exec, 0x3ff
  buffer_load_dword v103, v84, s[44:47], s85 offen
  s_mov_b64 exec, -1
  s_add_u32 s85, s85, 865280
  s_waitcnt vmcnt(11)
  s_barrier
  s_add_u32 m0, s75, 147456
  s_nop 0
  buffer_load_dwordx4 v4, s[44:47], s74 offen lds
  s_add_u32 m0, s75, 148480
  s_nop 0
  buffer_load_dwordx4 v5, s[44:47], s74 offen lds
  s_add_u32 s74, s74, 106496
  s_add_u32 m0, s75, 155648
  s_nop 0
  buffer_load_dwordx4 v4, s[44:47], s74 offen lds
  s_add_u32 m0, s75, 156672
  s_nop 0
  buffer_load_dwordx4 v5, s[44:47], s74 offen lds
  s_add_u32 s74, s74, 106496
  s_add_u32 m0, s76, 0
  s_nop 0
  buffer_load_dwordx4 v56, s[32:35], 0 offen lds
  s_add_u32 m0, s76, 2048
  v_add_u32_dpp v56, v17, v2 row_newbcast:3 row_mask:0xf bank_mask:0x3
  buffer_load_dwordx4 v57, s[32:35], 0 offen lds
  s_nop 0
  v_add_u32_dpp v56, v19, v2 row_newbcast:9 row_mask:0xf bank_mask:0xc
  s_add_u32 m0, s76, 4096
  v_add_u32_dpp v57, v21, v2 row_newbcast:3 row_mask:0xf bank_mask:0x3
  buffer_load_dwordx4 v58, s[32:35], 0 offen lds
  s_nop 0
  v_add_u32_dpp v57, v23, v2 row_newbcast:9 row_mask:0xf bank_mask:0xc
  s_add_u32 m0, s76, 6144
  v_add_u32_dpp v58, v25, v2 row_newbcast:3 row_mask:0xf bank_mask:0x3
  buffer_load_dwordx4 v59, s[32:35], 0 offen lds
  s_nop 0
  v_add_u32_dpp v58, v27, v2 row_newbcast:9 row_mask:0xf bank_mask:0xc
  s_add_u32 m0, s76, 8192
  v_add_u32_dpp v59, v29, v2 row_newbcast:3 row_mask:0xf bank_mask:0x3
  buffer_load_dwordx4 v60, s[32:35], 0 offen lds
  s_nop 0
  v_add_u32_dpp v59, v31, v2 row_newbcast:9 row_mask:0xf bank_mask:0xc
  s_add_u32 m0, s76, 10240
  v_add_u32_dpp v60, v33, v2 row_newbcast:3 row_mask:0xf bank_mask:0x3
  buffer_load_dwordx4 v61, s[32:35], 0 offen lds
  s_nop 0
  v_add_u32_dpp v60, v35, v2 row_newbcast:9 row_mask:0xf bank_mask:0xc
  s_add_u32 m0, s76, 12288
  v_add_u32_dpp v61, v37, v2 row_newbcast:3 row_mask:0xf bank_mask:0x3
  buffer_load_dwordx4 v62, s[32:35], 0 offen lds
  s_nop 0
  v_add_u32_dpp v61, v39, v2 row_newbcast:9 row_mask:0xf bank_mask:0xc
  s_add_u32 m0, s76, 14336
  v_add_u32_dpp v62, v41, v2 row_newbcast:3 row_mask:0xf bank_mask:0x3
  buffer_load_dwordx4 v63, s[32:35], 0 offen lds
  s_nop 0
  v_add_u32_dpp v62, v43, v2 row_newbcast:9 row_mask:0xf bank_mask:0xc
  s_add_u32 m0, s76, 16384
  v_add_u32_dpp v63, v45, v2 row_newbcast:3 row_mask:0xf bank_mask:0x3
  buffer_load_dwordx4 v64, s[32:35], 0 offen lds
  s_nop 0
  v_add_u32_dpp v63, v47, v2 row_newbcast:9 row_mask:0xf bank_mask:0xc
  s_add_u32 m0, s76, 18432
  v_add_u32_dpp v64, v49, v2 row_newbcast:3 row_mask:0xf bank_mask:0x3
  buffer_load_dwordx4 v65, s[32:35], 0 offen lds
  s_nop 0
  v_add_u32_dpp v64, v51, v2 row_newbcast:9 row_mask:0xf bank_mask:0xc
  v_add_u32_dpp v65, v53, v2 row_newbcast:3 row_mask:0xf bank_mask:0x3
  s_nop 1
  v_add_u32_dpp v65, v55, v2 row_newbcast:9 row_mask:0xf bank_mask:0xc
  s_waitcnt vmcnt(10)
  s_barrier
  s_add_u32 m0, s75, 131072
  s_nop 0
  buffer_load_dwordx4 v4, s[44:47], s74 offen lds
  s_add_u32 m0, s75, 132096
  s_nop 0
  buffer_load_dwordx4 v5, s[44:47], s74 offen lds
  s_add_u32 s74, s74, 106496
  s_add_u32 m0, s75, 139264
  s_nop 0
  buffer_load_dwordx4 v4, s[44:47], s74 offen lds
  s_add_u32 m0, s75, 140288
  s_nop 0
  buffer_load_dwordx4 v5, s[44:47], s74 offen lds
  s_add_u32 s74, s74, 106496
  s_add_u32 m0, s76, 40960
  s_nop 0
  buffer_load_dwordx4 v56, s[32:35], 0 offen lds
  s_add_u32 m0, s76, 43008
  v_add_u32_dpp v56, v18, v2 row_newbcast:3 row_mask:0xf bank_mask:0x3
  buffer_load_dwordx4 v57, s[32:35], 0 offen lds
  s_nop 0
  v_add_u32_dpp v56, v16, v2 row_newbcast:10 row_mask:0xf bank_mask:0xc
  s_add_u32 m0, s76, 45056
  v_add_u32_dpp v57, v22, v2 row_newbcast:3 row_mask:0xf bank_mask:0x3
  buffer_load_dwordx4 v58, s[32:35], 0 offen lds
  s_nop 0
  v_add_u32_dpp v57, v20, v2 row_newbcast:10 row_mask:0xf bank_mask:0xc
  s_add_u32 m0, s76, 47104
  v_add_u32_dpp v58, v26, v2 row_newbcast:3 row_mask:0xf bank_mask:0x3
  buffer_load_dwordx4 v59, s[32:35], 0 offen lds
  s_nop 0
  v_add_u32_dpp v58, v24, v2 row_newbcast:10 row_mask:0xf bank_mask:0xc
  s_add_u32 m0, s76, 49152
  v_add_u32_dpp v59, v30, v2 row_newbcast:3 row_mask:0xf bank_mask:0x3
  buffer_load_dwordx4 v60, s[32:35], 0 offen lds
  s_nop 0
  v_add_u32_dpp v59, v28, v2 row_newbcast:10 row_mask:0xf bank_mask:0xc
  s_add_u32 m0, s76, 51200
  v_add_u32_dpp v60, v34, v2 row_newbcast:3 row_mask:0xf bank_mask:0x3
  buffer_load_dwordx4 v61, s[32:35], 0 offen lds
  s_nop 0
  v_add_u32_dpp v60, v32, v2 row_newbcast:10 row_mask:0xf bank_mask:0xc
  s_add_u32 m0, s76, 53248
  v_add_u32_dpp v61, v38, v2 row_newbcast:3 row_mask:0xf bank_mask:0x3
  buffer_load_dwordx4 v62, s[32:35], 0 offen lds
  s_nop 0
  v_add_u32_dpp v61, v36, v2 row_newbcast:10 row_mask:0xf bank_mask:0xc
  s_add_u32 m0, s76, 55296
  v_add_u32_dpp v62, v42, v2 row_newbcast:3 row_mask:0xf bank_mask:0x3
  buffer_load_dwordx4 v63, s[32:35], 0 offen lds
  s_nop 0
  v_add_u32_dpp v62, v40, v2 row_newbcast:10 row_mask:0xf bank_mask:0xc
  s_add_u32 m0, s76, 57344
  v_add_u32_dpp v63, v46, v2 row_newbcast:3 row_mask:0xf bank_mask:0x3
  buffer_load_dwordx4 v64, s[32:35], 0 offen lds
  s_nop 0
  v_add_u32_dpp v63, v44, v2 row_newbcast:10 row_mask:0xf bank_mask:0xc
  s_add_u32 m0, s76, 59392
  v_add_u32_dpp v64, v50, v2 row_newbcast:3 row_mask:0xf bank_mask:0x3
  buffer_load_dwordx4 v65, s[32:35], 0 offen lds
  s_nop 0
  v_add_u32_dpp v64, v48, v2 row_newbcast:10 row_mask:0xf bank_mask:0xc
  v_add_u32_dpp v65, v54, v2 row_newbcast:3 row_mask:0xf bank_mask:0x3
  s_nop 1
  v_add_u32_dpp v65, v52, v2 row_newbcast:10 row_mask:0xf bank_mask:0xc
  v_mov_b32_dpp v16, v16 row_shl:3 row_mask:0xf bank_mask:0xf
  v_mov_b32_dpp v18, v18 row_shl:3 row_mask:0xf bank_mask:0xf
  v_mov_b32_dpp v20, v20 row_shl:3 row_mask:0xf bank_mask:0xf
  v_mov_b32_dpp v22, v22 row_shl:3 row_mask:0xf bank_mask:0xf
  v_mov_b32_dpp v24, v24 row_shl:3 row_mask:0xf bank_mask:0xf
  v_mov_b32_dpp v26, v26 row_shl:3 row_mask:0xf bank_mask:0xf
  v_mov_b32_dpp v28, v28 row_shl:3 row_mask:0xf bank_mask:0xf
  v_mov_b32_dpp v30, v30 row_shl:3 row_mask:0xf bank_mask:0xf
  v_mov_b32_dpp v32, v32 row_shl:3 row_mask:0xf bank_mask:0xf
  v_mov_b32_dpp v34, v34 row_shl:3 row_mask:0xf bank_mask:0xf
  v_mov_b32_dpp v36, v36 row_shl:3 row_mask:0xf bank_mask:0xf
  v_mov_b32_dpp v38, v38 row_shl:3 row_mask:0xf bank_mask:0xf
  v_mov_b32_dpp v40, v40 row_shl:3 row_mask:0xf bank_mask:0xf
  v_mov_b32_dpp v42, v42 row_shl:3 row_mask:0xf bank_mask:0xf
  v_mov_b32_dpp v44, v44 row_shl:3 row_mask:0xf bank_mask:0xf
  v_mov_b32_dpp v46, v46 row_shl:3 row_mask:0xf bank_mask:0xf
  v_mov_b32_dpp v48, v48 row_shl:3 row_mask:0xf bank_mask:0xf
  v_mov_b32_dpp v50, v50 row_shl:3 row_mask:0xf bank_mask:0xf
  v_mov_b32_dpp v52, v52 row_shl:3 row_mask:0xf bank_mask:0xf
  v_mov_b32_dpp v54, v54 row_shl:3 row_mask:0xf bank_mask:0xf
  v_lshlrev_b32 v101, 7, v70
  s_mov_b32 exec_lo, 0xffffffff
  s_mov_b32 exec_hi, 0x0
  buffer_load_dword v102, v101, s[32:35], 0 offen
  s_mov_b64 exec, -1
  v_mov_b32 v70, v71
  v_mov_b32 v71, v72
  v_mov_b32 v72, v73
  v_mov_b32 v73, v74
  v_mov_b32 v74, 0xffffff
  s_waitcnt vmcnt(11)
  s_barrier
  s_add_u32 m0, s75, 147456
  s_nop 0
  buffer_load_dwordx4 v4, s[44:47], s74 offen lds
  s_add_u32 m0, s75, 148480
  s_nop 0
  buffer_load_dwordx4 v5, s[44:47], s74 offen lds
  s_add_u32 s74, s74, 106496
  s_add_u32 m0, s75, 155648
  s_nop 0
  buffer_load_dwordx4 v4, s[44:47], s74 offen lds
  s_add_u32 m0, s75, 156672
  s_nop 0
  buffer_load_dwordx4 v5, s[44:47], s74 offen lds
  s_add_u32 s74, s74, 106496
  s_cmp_eq_u32 s72, 1
  s_cbranch_scc1 L_ld_tail0
  s_add_u32 m0, s76, 81920
  s_nop 0
  buffer_load_dwordx4 v56, s[32:35], 0 offen lds
  s_add_u32 m0, s76, 83968
  v_add_u32_dpp v56, v19, v2 row_newbcast:3 row_mask:0xf bank_mask:0x3
  buffer_load_dwordx4 v57, s[32:35], 0 offen lds
  s_nop 0
  v_add_u32_dpp v56, v17, v2 row_newbcast:10 row_mask:0xf bank_mask:0xc
  s_add_u32 m0, s76, 86016
  v_add_u32_dpp v57, v23, v2 row_newbcast:3 row_mask:0xf bank_mask:0x3
  buffer_load_dwordx4 v58, s[32:35], 0 offen lds
  s_nop 0
  v_add_u32_dpp v57, v21, v2 row_newbcast:10 row_mask:0xf bank_mask:0xc
  s_add_u32 m0, s76, 88064
  v_add_u32_dpp v58, v27, v2 row_newbcast:3 row_mask:0xf bank_mask:0x3
  buffer_load_dwordx4 v59, s[32:35], 0 offen lds
  s_nop 0
  v_add_u32_dpp v58, v25, v2 row_newbcast:10 row_mask:0xf bank_mask:0xc
  s_add_u32 m0, s76, 90112
  v_add_u32_dpp v59, v31, v2 row_newbcast:3 row_mask:0xf bank_mask:0x3
  buffer_load_dwordx4 v60, s[32:35], 0 offen lds
  s_nop 0
  v_add_u32_dpp v59, v29, v2 row_newbcast:10 row_mask:0xf bank_mask:0xc
  s_add_u32 m0, s76, 92160
  v_add_u32_dpp v60, v35, v2 row_newbcast:3 row_mask:0xf bank_mask:0x3
  buffer_load_dwordx4 v61, s[32:35], 0 offen lds
  s_nop 0
  v_add_u32_dpp v60, v33, v2 row_newbcast:10 row_mask:0xf bank_mask:0xc
  s_add_u32 m0, s76, 94208
  v_add_u32_dpp v61, v39, v2 row_newbcast:3 row_mask:0xf bank_mask:0x3
  buffer_load_dwordx4 v62, s[32:35], 0 offen lds
  s_nop 0
  v_add_u32_dpp v61, v37, v2 row_newbcast:10 row_mask:0xf bank_mask:0xc
  s_add_u32 m0, s76, 96256
  v_add_u32_dpp v62, v43, v2 row_newbcast:3 row_mask:0xf bank_mask:0x3
  buffer_load_dwordx4 v63, s[32:35], 0 offen lds
  s_nop 0
  v_add_u32_dpp v62, v41, v2 row_newbcast:10 row_mask:0xf bank_mask:0xc
  s_add_u32 m0, s76, 98304
  v_add_u32_dpp v63, v47, v2 row_newbcast:3 row_mask:0xf bank_mask:0x3
  buffer_load_dwordx4 v64, s[32:35], 0 offen lds
  s_nop 0
  v_add_u32_dpp v63, v45, v2 row_newbcast:10 row_mask:0xf bank_mask:0xc
  s_add_u32 m0, s76, 100352
  v_add_u32_dpp v64, v51, v2 row_newbcast:3 row_mask:0xf bank_mask:0x3
  buffer_load_dwordx4 v65, s[32:35], 0 offen lds
  s_nop 0
  v_add_u32_dpp v64, v49, v2 row_newbcast:10 row_mask:0xf bank_mask:0xc
  v_add_u32_dpp v65, v55, v2 row_newbcast:3 row_mask:0xf bank_mask:0x3
  s_nop 1
  v_add_u32_dpp v65, v53, v2 row_newbcast:10 row_mask:0xf bank_mask:0xc
  v_mov_b32_dpp v17, v17 row_shl:3 row_mask:0xf bank_mask:0xf
  v_mov_b32_dpp v19, v19 row_shl:3 row_mask:0xf bank_mask:0xf
  v_mov_b32_dpp v21, v21 row_shl:3 row_mask:0xf bank_mask:0xf
  v_mov_b32_dpp v23, v23 row_shl:3 row_mask:0xf bank_mask:0xf
  v_mov_b32_dpp v25, v25 row_shl:3 row_mask:0xf bank_mask:0xf
  v_mov_b32_dpp v27, v27 row_shl:3 row_mask:0xf bank_mask:0xf
  v_mov_b32_dpp v29, v29 row_shl:3 row_mask:0xf bank_mask:0xf
  v_mov_b32_dpp v31, v31 row_shl:3 row_mask:0xf bank_mask:0xf
  v_mov_b32_dpp v33, v33 row_shl:3 row_mask:0xf bank_mask:0xf
  v_mov_b32_dpp v35, v35 row_shl:3 row_mask:0xf bank_mask:0xf
  v_mov_b32_dpp v37, v37 row_shl:3 row_mask:0xf bank_mask:0xf
  v_mov_b32_dpp v39, v39 row_shl:3 row_mask:0xf bank_mask:0xf
  v_mov_b32_dpp v41, v41 row_shl:3 row_mask:0xf bank_mask:0xf
  v_mov_b32_dpp v43, v43 row_shl:3 row_mask:0xf bank_mask:0xf
  v_mov_b32_dpp v45, v45 row_shl:3 row_mask:0xf bank_mask:0xf
  v_mov_b32_dpp v47, v47 row_shl:3 row_mask:0xf bank_mask:0xf
  v_mov_b32_dpp v49, v49 row_shl:3 row_mask:0xf bank_mask:0xf
  v_mov_b32_dpp v51, v51 row_shl:3 row_mask:0xf bank_mask:0xf
  v_mov_b32_dpp v53, v53 row_shl:3 row_mask:0xf bank_mask:0xf
  v_mov_b32_dpp v55, v55 row_shl:3 row_mask:0xf bank_mask:0xf
  s_add_u32 s72, s72, 1
  s_cmp_lt_u32 s72, 2
  s_waitcnt vmcnt(10)
  s_cbranch_scc1 L_dnn_loop1
  s_branch L_ld_tail
L_cin:
  v_lshlrev_b32 v1, 4, v0
  s_and_b32 s79, s3, 3
  s_lshr_b32 s84, s3, 2
  s_lshl_b32 s95, s79, 10
  s_mul_i32 s26, s68, 11
  s_add_u32 s26, s26, s69
  s_sub_u32 s26, s26, 22
  s_cmp_eq_u32 s26, 86
  s_cbranch_scc1 L_spare
  s_cmp_eq_u32 s84, 0
  s_cbranch_scc1 L_sc
  s_setprio 2
  v_add_u32 v2, L_tables-L_pc+4096, v1
  v_mov_b32 v3, s93
  v_add_co_u32 v2, vcc, s92, v2
  s_nop 1
  v_addc_co_u32 v3, vcc, 0, v3, vcc
  v_add_co_u32 v32, vcc, s95, v2
  s_nop 1
  v_addc_co_u32 v33, vcc, 0, v3, vcc
  global_load_dwordx4 v[224:227], v[2:3], off offset:-4096
  v_add_co_u32 v2, vcc, 0x1800, v2
  s_nop 1
  v_addc_co_u32 v3, vcc, 0, v3, vcc
  global_load_dwordx4 v[240:243], v[2:3], off
  s_cmp_lt_u32 s79, 3
  s_mov_b32 s70, 122176
  s_cselect_b32 s70, 81920, s70
  s_add_u32 m0, s95, 81920
  s_nop 0
  global_load_lds_dwordx4 v[32:33], off offset:-4096
  s_add_u32 m0, s95, s70
  s_nop 0
  global_load_lds_dwordx4 v[32:33], off offset:0
  v_add_co_u32 v32, vcc, 0x2000, v32
  s_nop 1
  v_addc_co_u32 v33, vcc, 0, v33, vcc
  s_add_u32 m0, s95, 2048
  s_nop 0
  global_load_lds_dwordx4 v[32:33], off offset:0
  s_add_u32 m0, s95, 130368
  s_cmp_ge_u32 s79, 2
  s_cbranch_scc1 L_sc
  global_load_lds_dwordx4 v[32:33], off offset:-4096
L_sc:
  s_mul_i32 s85, s84, 20
  s_add_u32 s85, s85, s3
  s_mul_i32 s94, s26, 48
  s_add_u32 s94, s94, s85
  s_mul_i32 s94, s94, 104
  v_lshrrev_b32 v30, 3, v0
  v_lshlrev_b32 v30, 4, v30
  v_and_b32 v29, 0x70, v1
  s_mul_i32 s76, s3, 4064
  s_add_u32 s76, s76, 131136
  s_cmp_eq_u32 s84, 0
  s_cbranch_scc1 L_g0
  s_sub_u32 s68, s71, 22
  s_min_u32 s68, s68, 9
  s_lshl_b32 s68, s68, 2
  s_add_u32 s68, s68, s79
  s_lshl_b32 s68, s68, 7
  v_mul_u32_u24 v31, 5120, v0
  s_waitcnt lgkmcnt(0)
  s_mov_b32 s36, s8
  s_and_b32 s37, s9, 0xffff
  s_mov_b32 s38, 105456
  s_mov_b32 s39, 0x20000
  buffer_load_dword v107, v31, s[36:39], s68 offen
  s_waitcnt lgkmcnt(0)
  s_mov_b32 s40, s10
  s_and_b32 s41, s11, 0xffff
  s_mov_b32 s42, 156
  s_mov_b32 s43, 0x20000
  s_mov_b32 m0, 129472
  s_mov_b64 exec, 0x7ff
  buffer_load_dwordx4 v1, s[40:43], 0 offen lds
  s_mov_b64 exec, -1
  s_barrier
  s_lshl_b32 s85, s85, 2
  s_add_u32 s85, s85, 129728
  s_mul_i32 s72, s84, 3
  s_sub_u32 s72, 4, s72
  s_cmp_eq_u32 s26, 85
  s_cselect_b32 s72, s72, 6
  s_lshl_b32 s52, s3, 7
  s_mul_i32 s53, s3, 5280
  s_lshl_b32 s54, s3, 2
  s_lshl_b32 s55, s3, 1
  s_lshl_b32 s82, s3, 12
  s_and_b32 s98, s3, 1
  s_lshr_b32 s99, s3, 1
  s_mul_i32 s68, s99, 3072
  s_lshl_b32 s83, s98, 3
  s_add_u32 s68, s68, s83
  v_add_u32 v59, s68, v1
  s_lshl_b32 s69, s99, 3
  s_lshr_b32 s69, 0x05030200, s69
  s_and_b32 s69, s69, 0xff
  s_lshl_b32 s69, s69, 9
  s_lshl_b32 s70, s98, 2
  s_add_u32 s91, s69, s70
  s_mov_b32 s99, 0x05040100
  s_mov_b32 s100, 0x07060302
  v_mov_b32 v2, 129664
  v_mov_b32 v109, 0
  v_mov_b32 v108, 0
  v_mov_b64 v[32:33], 0
  v_mov_b64 v[34:35], 0
  v_mov_b64 v[36:37], 0
  v_mov_b64 v[38:39], 0
  v_mov_b64 v[40:41], 0
  v_mov_b64 v[42:43], 0
  v_mov_b64 v[44:45], 0
  v_mov_b64 v[46:47], 0
  v_mov_b64 v[48:49], 0
  v_mov_b64 v[50:51], 0
  v_mov_b64 v[52:53], 0
  v_mov_b64 v[54:55], 0
  v_mov_b64 v[56:57], 0
  v_add_u32 v250, 77824, v1
  s_waitcnt vmcnt(7)
  v_add_u32 v251, 125248, v1
  v_lshrrev_b32 v3, 5, v0
  v_lshl_add_u32 v3, v3, 2, v2
  s_mov_b32 s28, s4
  s_and_b32 s29, s5, 0xffff
  s_mov_b32 s30, 425984
  s_mov_b32 s31, 0x20000
  s_mov_b32 s32, s6
  s_and_b32 s33, s7, 0xffff
  s_mov_b32 s34, 12800000
  s_mov_b32 s35, 0x20000
  v_and_b32 v13, 31, v0
  v_min_u32 v13, 25, v13
  v_lshrrev_b32 v14, 5, v0
  v_mul_u32_u24 v14, 416, v14
  v_lshl_add_u32 v13, v13, 2, v14
  buffer_load_dword v14, v13, s[28:31], s94 offen
  v_min_u32 v12, 47, v0
  v_mul_u32_u24 v15, 16384, v12
  v_lshrrev_b32 v15, 16, v15
  v_mul_u32_u24 v15, 88, v15
  v_lshl_add_u32 v12, v12, 2, v15
  s_lshl_b32 s68, s26, 2
  s_add_u32 s68, s68, s79
  s_mul_i32 s68, s68, 1248
  buffer_load_dword v15, v12, s[28:31], s68 offen offset:16
  ds_write_b128 v2, v[32:35] offset:16
  s_lshl_b32 s68, s79, 6
  v_add_u32_e64 v29, s68, v0
  v_mul_u32_u24 v30, 2521, v29
  v_lshrrev_b32 v30, 16, v30
  v_mul_u32_u24 v30, 12, v30
  v_lshl_add_u32 v28, v29, 1, v30
  v_add_u32 v29, 256, v29
  v_mul_u32_u24 v30, 2521, v29
  v_lshrrev_b32 v30, 16, v30
  v_mul_u32_u24 v30, 12, v30
  v_lshl_add_u32 v58, v29, 1, v30
  v_add_u32 v29, 256, v29
  v_mul_u32_u24 v30, 2521, v29
  v_lshrrev_b32 v30, 16, v30
  v_mul_u32_u24 v30, 12, v30
  v_lshl_add_u32 v111, v29, 1, v30
  v_cmp_gt_u32 vcc, 676, v29
  s_nop 0
  s_mov_b64 s[92:93], vcc
  v_lshlrev_b32 v29, 3, v0
  s_mov_b32 exec_hi, 0xffff
  ds_write_b64 v29, v[32:33] offset:1664
  s_mov_b32 exec_hi, -1
  s_waitcnt vmcnt(7)
  ds_write_b32 v243, v32
  ds_write_b32 v243, v32 offset:43328
  s_waitcnt vmcnt(2)
  ds_read_b64 v[112:113], v240 offset:0
  ds_read_b64 v[114:115], v240 offset:8
  ds_read_b64 v[116:117], v240 offset:32
  ds_read_b64 v[118:119], v240 offset:40
  ds_read_u16 v110, v241
  s_mov_b64 exec, 0x3ffffff
  s_waitcnt lgkmcnt(0)
  ds_write_b16 v242, v110
  v_lshlrev_b32 v109, 17, v110
  v_lshrrev_b32 v109, 1, v109
  s_mov_b64 exec, -1
  v_add_u32 v225, s52, v225
  v_add_u32 v226, s52, v226
  v_add_u32_e64 v227, s52, v227
  s_waitcnt lgkmcnt(0)
  s_barrier
  ds_read_b64_tr_b16 v[60:61], v225 offset:35328
  ds_read_b64_tr_b16 v[62:63], v225 offset:40736
  ds_read_b64_tr_b16 v[64:65], v226 offset:35328
  ds_read_b64_tr_b16 v[66:67], v227 offset:35328
  ds_read_b64_tr_b16 v[68:69], v225 offset:35392
  ds_read_b64_tr_b16 v[70:71], v225 offset:40800
  ds_read_b64_tr_b16 v[72:73], v226 offset:35392
  ds_read_b64_tr_b16 v[74:75], v227 offset:35392
  ds_read_b64_tr_b16 v[76:77], v225 offset:35840
  ds_read_b64_tr_b16 v[78:79], v225 offset:41248
  ds_read_b64_tr_b16 v[80:81], v226 offset:35840
  ds_read_b64_tr_b16 v[82:83], v227 offset:35840
  ds_read_b64_tr_b16 v[84:85], v225 offset:35904
  ds_read_b64_tr_b16 v[86:87], v225 offset:41312
  ds_read_b64_tr_b16 v[88:89], v226 offset:35904
  ds_read_b64_tr_b16 v[90:91], v227 offset:35904
  s_waitcnt lgkmcnt(14)
  v_mfma_f32_32x32x16_bf16 v[120:135], v[112:115], v[60:63], 0
  s_waitcnt lgkmcnt(12)
  v_mfma_f32_32x32x16_bf16 v[120:135], v[116:119], v[64:67], v[120:135]
  ds_read_b64_tr_b16 v[92:93], v225 offset:36352
  ds_read_b64_tr_b16 v[94:95], v225 offset:41760
  ds_read_b64_tr_b16 v[96:97], v226 offset:36352
  ds_read_b64_tr_b16 v[98:99], v227 offset:36352
  s_waitcnt lgkmcnt(14)
  v_mfma_f32_32x32x16_bf16 v[136:151], v[112:115], v[68:71], 0
  s_waitcnt lgkmcnt(12)
  v_mfma_f32_32x32x16_bf16 v[136:151], v[116:119], v[72:75], v[136:151]
  ds_read_b64_tr_b16 v[100:101], v225 offset:36416
  ds_read_b64_tr_b16 v[102:103], v225 offset:41824
  ds_read_b64_tr_b16 v[104:105], v226 offset:36416
  ds_read_b64_tr_b16 v[106:107], v227 offset:36416
  s_waitcnt lgkmcnt(14)
  v_mfma_f32_32x32x16_bf16 v[152:167], v[112:115], v[76:79], 0
  s_waitcnt lgkmcnt(12)
  v_mfma_f32_32x32x16_bf16 v[152:167], v[116:119], v[80:83], v[152:167]
  s_waitcnt lgkmcnt(10)
  v_mfma_f32_32x32x16_bf16 v[168:183], v[112:115], v[84:87], 0
  s_waitcnt lgkmcnt(8)
  v_mfma_f32_32x32x16_bf16 v[168:183], v[116:119], v[88:91], v[168:183]
  ds_read_b128 v[228:231], v250 offset:6144
  ds_read_b128 v[232:235], v251 offset:0
  ds_read_b128 v[4:7], v250 offset:3072
  ds_read_b128 v[8:11], v251 offset:2048
  ds_read_b128 v[20:23], v250 offset:1024
  ds_read_b128 v[24:27], v250 offset:2048
  ds_read_b128 v[216:219], v250 offset:4096
  ds_read_b128 v[220:223], v250 offset:5120
  ds_read_b128 v[236:239], v251 offset:1024
  s_waitcnt lgkmcnt(14)
  v_mfma_f32_32x32x16_bf16 v[184:199], v[112:115], v[92:95], 0
  s_waitcnt lgkmcnt(13)
  v_mfma_f32_32x32x16_bf16 v[184:199], v[116:119], v[96:99], v[184:199]
  s_waitcnt lgkmcnt(11)
  v_mfma_f32_32x32x16_bf16 v[200:215], v[112:115], v[100:103], 0
  s_waitcnt lgkmcnt(9)
  v_mfma_f32_32x32x16_bf16 v[200:215], v[116:119], v[104:107], v[200:215]
  s_waitcnt lgkmcnt(8)
  v_add_u32 v228, s54, v228
  v_add_u32 v229, s54, v229
  v_add_u32 v231, s83, v231
  v_add_u32 v230, s91, v230
  s_waitcnt lgkmcnt(7)
  v_mad_u32_u24 v232, v233, s3, v232
  v_add_u32 v234, s55, v234
  v_mad_u32_u24 v233, v233, 8, v232
  v_add_u32 v246, s82, v235
  v_add_u32 v247, 2048, v246
  v_add_u32 v31, 0, v234
  v_and_b32 v31, 3, v31
  v_lshl_add_u32 v244, v31, 4, v232
  v_add_u32 v31, 1, v234
  v_and_b32 v31, 3, v31
  v_lshl_add_u32 v245, v31, 4, v232
  v_add_u32 v245, 1664, v245
  v_add_u32 v31, 0, v234
  v_and_b32 v31, 3, v31
  v_lshl_add_u32 v248, v31, 4, v233
  v_add_u32 v31, 1, v234
  v_and_b32 v31, 3, v31
  v_lshl_add_u32 v249, v31, 4, v233
  v_add_u32 v249, 1664, v249
  s_waitcnt lgkmcnt(5)
  v_add_u32 v10, s76, v10
  v_add_u32 v4, s76, v4
  v_add_u32 v5, s76, v5
  ds_write_b32 v10, v7 offset:2880
  v_add_u32 v11, s53, v11
  s_waitcnt lgkmcnt(5)
  v_add_u32 v20, s53, v20
  v_add_u32 v21, s53, v21
  v_add_u32 v22, s53, v22
  v_add_u32 v23, s53, v23
  s_waitcnt lgkmcnt(4)
  v_add_u32 v24, s53, v24
  v_add_u32 v25, s53, v25
  v_add_u32 v26, s53, v26
  v_add_u32 v27, s53, v27
  s_mov_b32 exec_lo, 0
  v_mov_b32 v120, v136
  s_mov_b32 exec_lo, -1
  v_cvt_pk_bf16_f32 v60, 0, v120
  ds_write_b16_d16_hi v28, v60
  v_max_f32 v108, |v60|, v108
  s_mov_b32 exec_lo, 0
  v_mov_b32 v152, v168
  s_mov_b32 exec_lo, -1
  v_cvt_pk_bf16_f32 v61, 0, v152
  ds_write_b16_d16_hi v58, v61
  v_max_f32 v108, |v61|, v108
  s_mov_b32 exec_lo, 0
  v_mov_b32_e64 v184, v200
  s_mov_b32 exec_lo, -1
  v_cvt_pk_bf16_f32 v62, 0, v184
  s_mov_b64 exec, s[92:93]
  ds_write_b16_d16_hi v111, v62
  v_max_f32 v108, |v62|, v108
  s_mov_b64 exec, -1
  s_nop 0
  v_permlane32_swap_b32 v108, v109
  v_max_u32_e64 v108, v108, v109
  s_nop 1
  v_max_u32_dpp v108, v108, v108 row_shr:1 row_mask:0xf bank_mask:0xf
  s_nop 1
  v_max_u32_dpp v108, v108, v108 row_shr:2 row_mask:0xf bank_mask:0xf
  s_nop 1
  v_max_u32_dpp v108, v108, v108 row_shr:4 row_mask:0xf bank_mask:0xf
  s_nop 1
  v_max_u32_dpp v108, v108, v108 row_shr:8 row_mask:0xf bank_mask:0xf
  s_nop 1
  v_max_u32_dpp v108, v108, v108 row_bcast:15 row_mask:0xa bank_mask:0xf
  s_mov_b32 exec_lo, 0x80000000
  s_mov_b32 exec_hi, 0x80000000
  ds_max_u32 v3, v108 offset:24
  s_mov_b64 exec, -1
  s_setprio 0
  s_waitcnt vmcnt(0)
  v_lshlrev_b32 v15, 7, v15
  buffer_load_dword v12, v15, s[32:35], 0 offen
  s_waitcnt lgkmcnt(0)
  s_barrier
  s_branch L_w2
L_g0:
  s_waitcnt lgkmcnt(0)
  s_mov_b32 s36, s8
  s_and_b32 s37, s9, 0xffff
  s_mov_b32 s38, 105456
  s_mov_b32 s39, 0x20000
  s_barrier
  s_add_u32 m0, s95, 41984
  s_add_u32 s81, s95, 70304
  buffer_load_dwordx4 v1, s[36:39], s81 offen lds
  s_add_u32 m0, s95, 46080
  s_add_u32 s81, s95, 74400
  buffer_load_dwordx4 v1, s[36:39], s81 offen lds
  s_add_u32 m0, s95, 50176
  s_add_u32 s81, s95, 78496
  buffer_load_dwordx4 v1, s[36:39], s81 offen lds
  s_add_u32 m0, s95, 54272
  s_add_u32 s81, s95, 82592
  buffer_load_dwordx4 v1, s[36:39], s81 offen lds
  s_add_u32 m0, s95, 58368
  s_add_u32 s81, s95, 86688
  buffer_load_dwordx4 v1, s[36:39], s81 offen lds
  s_add_u32 m0, s95, 62464
  s_add_u32 s81, s95, 90784
  buffer_load_dwordx4 v1, s[36:39], s81 offen lds
  s_add_u32 m0, s95, 66560
  s_add_u32 s81, s95, 94880
  buffer_load_dwordx4 v1, s[36:39], s81 offen lds
  s_add_u32 m0, s95, 70656
  s_add_u32 s81, s95, 98976
  buffer_load_dwordx4 v1, s[36:39], s81 offen lds
  s_cmp_eq_u32 s79, 3
  s_cbranch_scc1 L_st3
  s_add_u32 m0, s95, 74752
  s_add_u32 s81, s95, 103072
  buffer_load_dwordx4 v1, s[36:39], s81 offen lds
L_st3:
  s_mov_b32 s28, s4
  s_and_b32 s29, s5, 0xffff
  s_mov_b32 s30, 425984
  s_mov_b32 s31, 0x20000
  buffer_load_dwordx4 v[16:19], v30, s[28:31], s94 offen
  s_add_u32 s94, s94, 416
  buffer_load_dwordx4 v[12:15], v30, s[28:31], s94 offen
  s_add_u32 s94, s94, 416
  s_mov_b32 s32, s6
  s_and_b32 s33, s7, 0xffff
  s_mov_b32 s34, 12800000
  s_mov_b32 s35, 0x20000
  s_mul_i32 s96, s79, 3072
  s_mul_i32 s97, s79, 2704
  v_lshrrev_b32 v31, 5, v0
  v_mul_u32_u24 v31, 184, v31
  v_sub_u32 v31, v1, v31
  s_add_u32 m0, s96, 85312
  s_add_u32 s81, s97, 35152
  buffer_load_dwordx4 v1, s[36:39], s81 offen lds
  s_lshl_b32 s85, s85, 2
  s_add_u32 s85, s85, 129728
  s_mul_i32 s72, s84, 3
  s_sub_u32 s72, 4, s72
  s_cmp_eq_u32 s26, 85
  s_cselect_b32 s72, s72, 6
  s_add_u32 m0, s96, 86336
  s_add_u32 s81, s97, 36176
  buffer_load_dwordx4 v31, s[36:39], s81 offen lds
  s_lshl_b32 s52, s3, 7
  s_mul_i32 s53, s3, 5280
  s_lshl_b32 s54, s3, 2
  s_lshl_b32 s55, s3, 1
  s_lshl_b32 s82, s3, 12
  s_add_u32 m0, s96, 87360
  s_add_u32 s81, s97, 37016
  buffer_load_dwordx4 v1, s[36:39], s81 offen lds
  s_and_b32 s98, s3, 1
  s_lshr_b32 s99, s3, 1
  s_mul_i32 s68, s99, 3072
  s_lshl_b32 s83, s98, 3
  s_add_u32 s68, s68, s83
  s_add_u32 m0, s96, 97600
  s_add_u32 s81, s97, 45968
  buffer_load_dwordx4 v1, s[36:39], s81 offen lds
  v_add_u32 v59, s68, v1
  s_lshl_b32 s69, s99, 3
  s_lshr_b32 s69, 0x05030200, s69
  s_and_b32 s69, s69, 0xff
  s_lshl_b32 s69, s69, 9
  s_add_u32 m0, s96, 98624
  s_add_u32 s81, s97, 46992
  buffer_load_dwordx4 v31, s[36:39], s81 offen lds
  s_lshl_b32 s70, s98, 2
  s_add_u32 s91, s69, s70
  s_mov_b32 s99, 0x05040100
  s_mov_b32 s100, 0x07060302
  v_mov_b32 v2, 129664
  s_add_u32 m0, s96, 99648
  s_add_u32 s81, s97, 47832
  buffer_load_dwordx4 v1, s[36:39], s81 offen lds
  v_mov_b32 v109, 0
  v_mov_b32 v108, 0
  v_mov_b64 v[32:33], 0
  v_mov_b64 v[34:35], 0
  v_mov_b64 v[36:37], 0
  s_add_u32 m0, s96, 109888
  s_add_u32 s81, s97, 56784
  buffer_load_dwordx4 v1, s[36:39], s81 offen lds
  v_mov_b64 v[38:39], 0
  v_mov_b64 v[40:41], 0
  v_mov_b64 v[42:43], 0
  v_mov_b64 v[44:45], 0
  v_mov_b64 v[46:47], 0
  s_add_u32 m0, s96, 110912
  s_add_u32 s81, s97, 57808
  buffer_load_dwordx4 v31, s[36:39], s81 offen lds
  v_mov_b64 v[48:49], 0
  v_mov_b64 v[50:51], 0
  v_mov_b64 v[52:53], 0
  v_mov_b64 v[54:55], 0
  v_mov_b64 v[56:57], 0
  s_add_u32 m0, s96, 111936
  s_add_u32 s81, s97, 58648
  buffer_load_dwordx4 v1, s[36:39], s81 offen lds
  v_add_u32 v250, 77824, v1
  s_waitcnt vmcnt(19)
  v_add_u32 v251, 125248, v1
  v_lshrrev_b32 v3, 5, v0
  v_lshl_add_u32 v3, v3, 2, v2
  s_cmp_lg_u32 s79, 0
  s_cbranch_scc1 L_st2
  s_add_u32 m0, s96, 122176
  s_add_u32 s81, s97, 67600
  buffer_load_dwordx4 v1, s[36:39], s81 offen lds
  s_add_u32 m0, s96, 123200
  s_add_u32 s81, s97, 68624
  buffer_load_dwordx4 v31, s[36:39], s81 offen lds
  s_add_u32 m0, s96, 124224
  s_add_u32 s81, s97, 69464
  buffer_load_dwordx4 v1, s[36:39], s81 offen lds
L_st2:
  s_add_u32 m0, s95, 6144
  s_add_u32 s81, s95, 0
  buffer_load_dwordx4 v1, s[36:39], s81 offen lds
  s_add_u32 m0, s95, 10240
  s_add_u32 s81, s95, 4096
  buffer_load_dwordx4 v1, s[36:39], s81 offen lds
  s_add_u32 m0, s95, 14336
  s_add_u32 s81, s95, 8192
  buffer_load_dwordx4 v1, s[36:39], s81 offen lds
  s_add_u32 m0, s95, 18432
  s_add_u32 s81, s95, 12288
  buffer_load_dwordx4 v1, s[36:39], s81 offen lds
  s_waitcnt vmcnt(15)
  s_barrier
  ds_read_b128 v[224:227], v250 offset:0
  ds_read_b128 v[228:231], v250 offset:6144
  ds_read_b128 v[232:235], v251 offset:0
  ds_read_b128 v[4:7], v250 offset:3072
  ds_read_b128 v[8:11], v251 offset:2048
  ds_read_b128 v[20:23], v250 offset:1024
  ds_read_b128 v[24:27], v250 offset:2048
  ds_read_b128 v[216:219], v250 offset:4096
  ds_read_b128 v[220:223], v250 offset:5120
  ds_read_b128 v[236:239], v251 offset:1024
  s_add_u32 m0, s95, 22528
  s_add_u32 s81, s95, 16384
  buffer_load_dwordx4 v1, s[36:39], s81 offen lds
  s_add_u32 m0, s95, 26624
  s_add_u32 s81, s95, 20480
  buffer_load_dwordx4 v1, s[36:39], s81 offen lds
  s_add_u32 m0, s95, 30720
  s_add_u32 s81, s95, 24576
  buffer_load_dwordx4 v1, s[36:39], s81 offen lds
  s_add_u32 m0, s95, 34816
  s_add_u32 s81, s95, 28672
  buffer_load_dwordx4 v1, s[36:39], s81 offen lds
  s_cmp_eq_u32 s79, 3
  s_cbranch_scc1 L_st1
  s_add_u32 m0, s95, 38912
  s_add_u32 s81, s95, 32768
  buffer_load_dwordx4 v1, s[36:39], s81 offen lds
L_st1:
  s_waitcnt lgkmcnt(9)
  v_add_u32 v225, s52, v225
  v_add_u32 v226, s52, v226
  v_add_u32 v227, s52, v227
  s_waitcnt lgkmcnt(8)
  v_add_u32 v228, s54, v228
  v_add_u32 v229, s54, v229
  v_add_u32 v231, s83, v231
  v_add_u32 v230, s91, v230
  s_waitcnt lgkmcnt(7)
  v_mad_u32_u24 v232, v233, s3, v232
  v_add_u32 v234, s55, v234
  v_mad_u32_u24 v233, v233, 8, v232
  v_add_u32 v246, s82, v235
  v_add_u32 v247, 2048, v246
  v_add_u32 v31, 0, v234
  v_and_b32 v31, 3, v31
  v_lshl_add_u32 v244, v31, 4, v232
  v_add_u32 v31, 1, v234
  v_and_b32_e64 v31, 3, v31
  v_lshl_add_u32 v245, v31, 4, v232
  v_add_u32 v245, 1664, v245
  v_add_u32 v31, 0, v234
  v_and_b32 v31, 3, v31
  v_lshl_add_u32 v248, v31, 4, v233
  v_add_u32 v31, 1, v234
  v_and_b32 v31, 3, v31
  v_lshl_add_u32 v249, v31, 4, v233
  v_add_u32 v249, 1664, v249
  s_waitcnt lgkmcnt(5)
  v_add_u32 v10, s76, v10
  v_add_u32 v4, s76, v4
  v_add_u32 v5, s76, v5
  ds_write_b32 v10, v7 offset:2880
  v_add_u32 v11, s53, v11
  s_waitcnt lgkmcnt(5)
  v_add_u32 v20, s53, v20
  v_add_u32 v21, s53, v21
  v_add_u32 v22, s53, v22
  v_add_u32 v23, s53, v23
  s_waitcnt lgkmcnt(4)
  v_add_u32 v24, s53, v24
  v_add_u32 v25, s53, v25
  v_add_u32 v26, s53, v26
  v_add_u32 v27, s53, v27
  s_waitcnt vmcnt(18)
  v_lshl_add_u32 v16, v16, 7, v29
  v_lshl_add_u32 v17, v17, 7, v29
  v_lshl_add_u32 v18, v18, 7, v29
  v_lshl_add_u32 v19, v19, 7, v29
  s_add_u32 m0, s76, 0
  s_mov_b32 exec_hi, 0xffffff
  buffer_load_dwordx4 v16, s[32:35], 0 offen lds
  s_add_u32 m0, s76, 1056
  s_nop 0
  buffer_load_dwordx4 v17, s[32:35], 0 offen lds
  s_add_u32 m0, s76, 2112
  s_mov_b32 exec_hi, 0xffff
  buffer_load_dwordx4 v18, s[32:35], 0 offen lds
  s_add_u32 m0, s76, 3168
  s_nop 0
  buffer_load_dwordx4 v19, s[32:35], 0 offen lds
  s_mov_b32 exec_hi, -1
  s_waitcnt vmcnt(4)
  s_barrier
L_w2:
  ds_read2st64_b32 v[60:61], v228 offset0:0 offset1:6
  ds_read2st64_b32 v[62:63], v228 offset0:12 offset1:18
  ds_read2st64_b32 v[64:65], v228 offset0:24 offset1:30
  ds_read2st64_b32 v[66:67], v228 offset0:36 offset1:42
  ds_read2st64_b32 v[68:69], v228 offset0:96 offset1:102
  ds_read2st64_b32 v[70:71], v229 offset0:108 offset1:114
  ds_read2st64_b32 v[72:73], v229 offset0:120 offset1:126
  ds_read2st64_b32 v[74:75], v229 offset0:132 offset1:138
  s_cmp_ge_u32 s3, 5
  s_cbranch_scc1 L_u0
  v_add_u32 v228, 32, v228
  v_add_u32 v229, 32, v229
  ds_read2st64_b32 v[92:93], v228 offset0:0 offset1:6
  ds_read2st64_b32 v[94:95], v228 offset0:12 offset1:18
  ds_read2st64_b32 v[96:97], v228 offset0:24 offset1:30
  ds_read2st64_b32 v[98:99], v228 offset0:36 offset1:42
  ds_read2st64_b32 v[100:101], v228 offset0:96 offset1:102
  ds_read2st64_b32 v[102:103], v229 offset0:108 offset1:114
  ds_read2st64_b32 v[104:105], v229 offset0:120 offset1:126
  ds_read2st64_b32 v[106:107], v229 offset0:132 offset1:138
  ds_read_b64_tr_b16 v[76:77], v225 offset:0
  ds_read_b64_tr_b16 v[78:79], v225 offset:5408
  ds_read_b64_tr_b16 v[80:81], v226 offset:0
  ds_read_b64_tr_b16 v[82:83], v227 offset:0
  ds_read_b64_tr_b16 v[84:85], v225 offset:64
  ds_read_b64_tr_b16 v[86:87], v225 offset:5472
  ds_read_b64_tr_b16 v[88:89], v226 offset:64
  ds_read_b64_tr_b16 v[90:91], v227 offset:64
  ds_read_b64_tr_b16 v[112:113], v224 offset:0
  ds_read_b64_tr_b16 v[114:115], v224 offset:256
  ds_read_b64_tr_b16 v[116:117], v224 offset:1024
  ds_read_b64_tr_b16 v[118:119], v224 offset:1280
  s_waitcnt lgkmcnt(14)
  v_mfma_f32_16x16x32_bf16 v[108:111], v[60:63], v[60:63], 0
  v_mfma_f32_16x16x32_bf16 v[108:111], v[64:67], v[64:67], v[108:111]
  v_mfma_f32_16x16x32_bf16 v[108:111], v[68:71], v[68:71], v[108:111]
  v_mfma_f32_16x16x32_bf16 v[108:111], v[72:75], v[72:75], v[108:111]
  v_perm_b32 v184, v61, v60, s99
  v_perm_b32 v185, v63, v62, s99
  v_perm_b32 v186, v65, v64, s99
  v_perm_b32 v187, v67, v66, s99
  v_perm_b32 v188, v69, v68, s99
  v_perm_b32 v189, v71, v70, s99
  v_perm_b32 v190, v73, v72, s99
  v_perm_b32 v191, v75, v74, s99
  v_mfma_f32_16x16x32_bf16 v[108:111], v[92:95], v[92:95], v[108:111]
  v_mfma_f32_16x16x32_bf16 v[108:111], v[96:99], v[96:99], v[108:111]
  v_mfma_f32_16x16x32_bf16 v[108:111], v[100:103], v[100:103], v[108:111]
  s_waitcnt lgkmcnt(12)
  v_mfma_f32_16x16x32_bf16 v[108:111], v[104:107], v[104:107], v[108:111]
  s_waitcnt lgkmcnt(10)
  v_mfma_f32_16x16x32_bf16 v[28:31], v[76:79], v[76:79], 0
  s_waitcnt lgkmcnt(8)
  v_mfma_f32_16x16x32_bf16 v[28:31], v[80:83], v[80:83], v[28:31]
  s_waitcnt lgkmcnt(6)
  v_mfma_f32_16x16x32_bf16 v[28:31], v[84:87], v[84:87], v[28:31]
  s_waitcnt lgkmcnt(4)
  v_mfma_f32_16x16x32_bf16 v[28:31], v[88:91], v[88:91], v[28:31]
  v_perm_b32 v192, v61, v60, s100
  v_perm_b32 v193, v63, v62, s100
  v_perm_b32 v194, v65, v64, s100
  v_perm_b32 v195, v67, v66, s100
  v_perm_b32 v196, v69, v68, s100
  v_perm_b32 v197, v71, v70, s100
  v_perm_b32 v198, v73, v72, s100
  v_perm_b32 v199, v75, v74, s100
  v_max3_f32 v28, v28, v29, 0
  v_perm_b32 v60, v93, v92, s99
  v_perm_b32 v61, v95, v94, s99
  v_max3_f32 v108, v108, v109, 0
  v_perm_b32 v62, v97, v96, s99
  v_max3_f32 v28, v28, v30, v31
  v_perm_b32 v63, v99, v98, s99
  v_max3_f32 v108, v108, v110, v111
  v_perm_b32 v64, v101, v100, s99
  v_perm_b32 v65, v103, v102, s99
  v_permlane32_swap_b32 v28, v108
  v_perm_b32 v66, v105, v104, s99
  v_max_u32 v28, v28, v108
  v_perm_b32 v67, v107, v106, s99
  s_nop 0
  v_max_u32_dpp v28, v28, v28 row_shr:1 row_mask:0xf bank_mask:0xf
  v_perm_b32 v68, v93, v92, s100
  v_perm_b32 v69, v95, v94, s100
  v_max_u32_dpp v28, v28, v28 row_shr:2 row_mask:0xf bank_mask:0xf
  v_perm_b32 v70, v97, v96, s100
  s_nop 0
  v_max_u32_dpp v28, v28, v28 row_shr:4 row_mask:0xf bank_mask:0xf
  v_perm_b32 v71, v99, v98, s100
  s_nop 0
  v_max_u32_dpp v28, v28, v28 row_shr:8 row_mask:0xf bank_mask:0xf
  v_perm_b32 v72, v101, v100, s100
  v_perm_b32 v73, v103, v102, s100
  v_max_u32_dpp v28, v28, v28 row_bcast:15 row_mask:0xa bank_mask:0xf
  v_perm_b32 v74, v105, v104, s100
  s_mov_b32 exec_lo, 0x80000000
  s_mov_b32 exec_hi, 0x80000000
  ds_max_u32 v3, v28 offset:16
  s_mov_b64 exec, -1
  v_perm_b32 v75, v107, v106, s100
  s_branch L_u1
L_u0:
  ds_read_b64_tr_b16 v[76:77], v225 offset:0
  ds_read_b64_tr_b16 v[78:79], v225 offset:5408
  ds_read_b64_tr_b16 v[80:81], v226 offset:0
  ds_read_b64_tr_b16 v[82:83], v227 offset:0
  ds_read_b64_tr_b16 v[84:85], v225 offset:64
  ds_read_b64_tr_b16 v[86:87], v225 offset:5472
  ds_read_b64_tr_b16 v[88:89], v226 offset:64
  ds_read_b64_tr_b16 v[90:91], v227 offset:64
  ds_read_b64_tr_b16 v[92:93], v225 offset:384
  ds_read_b64_tr_b16 v[94:95], v225 offset:5792
  ds_read_b64_tr_b16 v[96:97], v226 offset:384
  ds_read_b64_tr_b16 v[98:99], v227 offset:384
  ds_read_b64_tr_b16 v[100:101], v225 offset:448
  ds_read_b64_tr_b16 v[102:103], v225 offset:5856
  ds_read_b64_tr_b16 v[104:105], v226 offset:448
  ds_read_b64_tr_b16 v[106:107], v227 offset:448
  ds_read_b64_tr_b16 v[112:113], v224 offset:0
  ds_read_b64_tr_b16 v[114:115], v224 offset:256
  ds_read_b64_tr_b16 v[116:117], v224 offset:1024
  ds_read_b64_tr_b16 v[118:119], v224 offset:1280
  s_waitcnt lgkmcnt(14)
  v_mfma_f32_16x16x32_bf16 v[108:111], v[60:63], v[60:63], 0
  v_mfma_f32_16x16x32_bf16 v[108:111], v[64:67], v[64:67], v[108:111]
  v_mfma_f32_16x16x32_bf16 v[108:111], v[68:71], v[68:71], v[108:111]
  v_mfma_f32_16x16x32_bf16 v[108:111], v[72:75], v[72:75], v[108:111]
  v_mfma_f32_16x16x32_bf16 v[28:31], v[76:79], v[76:79], 0
  v_mfma_f32_16x16x32_bf16 v[28:31], v[80:83], v[80:83], v[28:31]
  v_mfma_f32_16x16x32_bf16 v[28:31], v[84:87], v[84:87], v[28:31]
  s_waitcnt lgkmcnt(12)
  v_mfma_f32_16x16x32_bf16 v[28:31], v[88:91], v[88:91], v[28:31]
  s_waitcnt lgkmcnt(10)
  v_mfma_f32_16x16x32_bf16 v[28:31], v[92:95], v[92:95], v[28:31]
  s_waitcnt lgkmcnt(8)
  v_mfma_f32_16x16x32_bf16 v[28:31], v[96:99], v[96:99], v[28:31]
  s_waitcnt lgkmcnt(6)
  v_mfma_f32_16x16x32_bf16 v[28:31], v[100:103], v[100:103], v[28:31]
  s_waitcnt lgkmcnt(4)
  v_mfma_f32_16x16x32_bf16 v[28:31], v[104:107], v[104:107], v[28:31]
  v_perm_b32 v184, v61, v60, s99
  v_perm_b32 v185, v63, v62, s99
  v_perm_b32 v186, v65, v64, s99
  v_perm_b32 v187, v67, v66, s99
  s_nop 3
  v_max3_f32 v28, v28, v29, 0
  v_perm_b32 v188, v69, v68, s99
  v_max3_f32 v108, v108, v109, 0
  v_perm_b32 v189, v71, v70, s99
  v_max3_f32 v28, v28, v30, v31
  v_perm_b32 v190, v73, v72, s99
  v_max3_f32 v108, v108, v110, v111
  v_perm_b32 v191, v75, v74, s99
  s_nop 0
  v_permlane32_swap_b32 v28, v108
  v_perm_b32 v192, v61, v60, s100
  v_max_u32 v28, v28, v108
  v_perm_b32 v193, v63, v62, s100
  s_nop 0
  v_max_u32_dpp v28, v28, v28 row_shr:1 row_mask:0xf bank_mask:0xf
  v_perm_b32 v194, v65, v64, s100
  s_nop 0
  v_max_u32_dpp v28, v28, v28 row_shr:2 row_mask:0xf bank_mask:0xf
  v_perm_b32 v195, v67, v66, s100
  s_nop 0
  v_max_u32_dpp v28, v28, v28 row_shr:4 row_mask:0xf bank_mask:0xf
  v_perm_b32 v196, v69, v68, s100
  s_nop 0
  v_max_u32_dpp v28, v28, v28 row_shr:8 row_mask:0xf bank_mask:0xf
  v_perm_b32 v197, v71, v70, s100
  s_nop 0
  v_max_u32_dpp v28, v28, v28 row_bcast:15 row_mask:0xa bank_mask:0xf
  v_perm_b32 v198, v73, v72, s100
  s_mov_b32 exec_lo, 0x80000000
  s_mov_b32 exec_hi, 0x80000000
  ds_max_u32 v3, v28 offset:16
  s_mov_b64 exec, -1
  v_perm_b32 v199, v75, v74, s100
  v_add_u32 v248, 12288, v246
  v_add_u32 v249, 12288, v247
  s_cmp_lg_u32 s3, 7
  s_cbranch_scc1 L_u1
  s_mov_b32 exec_lo, 0xfffffff0
  s_mov_b32 exec_hi, 0xfffffff0
  v_mov_b32 v249, 1048576
  s_mov_b64 exec, -1
L_u1:
  s_waitcnt lgkmcnt(0)
  s_barrier
  ds_read_b128 v[108:111], v2 offset:16
  s_cmp_lg_u32 s84, 0
  s_cbranch_scc1 L_hb1
  s_branch L_hb2
L_hb1:
  v_lshlrev_b32 v14, 7, v14
  buffer_load_dword v13, v14, s[32:35], 0 offen
L_hb2:
  s_mul_i32 s68, s3, 384
  v_lshrrev_b32 v29, 2, v0
  v_mul_u32_u24 v29, 24, v29
  v_add_u32 v29, s68, v29
  v_and_b32 v30, 3, v0
  v_lshlrev_b32_e64 v30, 3, v30
  ds_read_b64 v[224:225], v29 offset:2048
  ds_read_b64 v[226:227], v29 offset:2056
  ds_read_b64 v[228:229], v29 offset:2064
  s_waitcnt lgkmcnt(3)
  v_add_u32 v108, 0x3f800000, v108
  v_add_u32 v109, 0x3f800000, v109
  v_lshrrev_b32 v108, 24, v108
  v_lshrrev_b32_e64 v109, 24, v109
  v_sub_u32 v108, 267, v108
  s_mov_b32 vcc_lo, 0x4000000
  v_min_u32 v108, 167, v108
  s_mov_b32 vcc_hi, 0x4000000
  v_readfirstlane_b32 s74, v108
  v_cndmask_b32 v250, v110, v111, vcc
  v_mul_u32_u24 v108, 0x800080, v108
  v_lshrrev_b32 v250, 23, v250
  v_and_b32 v216, v216, v108
  v_and_b32 v217, v217, v108
  v_and_b32 v218, v218, v108
  v_and_b32 v219, v219, v108
  v_and_b32 v220, v220, v108
  v_and_b32 v221, v221, v108
  v_and_b32 v222, v222, v108
  v_and_b32_e64 v223, v223, v108
  v_mfma_f32_32x32x16_bf16 v[152:167], v[216:219], v[76:79], 0
  v_add_u32 v250, v250, v109
  v_sub_u32 v250, 388, v250
  v_mfma_f32_32x32x16_bf16 v[168:183], v[216:219], v[84:87], 0
  s_movk_i32 s98, 167
  v_med3_i32 v250, v250, 1, s98
  v_mfma_f32_32x32x16_bf16 v[152:167], v[220:223], v[80:83], v[152:167]
  v_subrev_u32 v110, 127, v250
  v_lshlrev_b32_e64 v250, 23, v250
  v_mfma_f32_32x32x16_bf16 v[168:183], v[220:223], v[88:91], v[168:183]
  v_cmp_gt_i32 vcc, 0, v110
  v_mul_u32_u24 v110, 0x800080, v110
  s_cbranch_vccnz L_sdown
  v_add_u32 v112, v112, v110
  v_add_u32 v113, v113, v110
  v_add_u32 v114, v114, v110
  v_add_u32 v115, v115, v110
  v_add_u32 v116, v116, v110
  v_add_u32 v117, v117, v110
  v_add_u32 v118, v118, v110
  v_add_u32 v119, v119, v110
L_scaled:
  v_mfma_f32_32x32x16_bf16 v[120:135], v[184:187], v[112:115], 0
  v_cvt_pk_f16_f32 v152, v152, v153
  v_cvt_pk_f16_f32 v153, v154, v155
  v_cvt_pk_f16_f32 v154, v156, v157
  v_cvt_pk_f16_f32 v155, v158, v159
  ds_write_b128 v246, v[152:155]
  v_xor_b32_e64 v246, 16, v246
  v_mfma_f32_32x32x16_bf16 v[120:135], v[188:191], v[116:119], v[120:135]
  v_cvt_pk_f16_f32 v156, v160, v161
  v_cvt_pk_f16_f32 v157, v162, v163
  v_cvt_pk_f16_f32 v158, v164, v165
  v_cvt_pk_f16_f32 v159, v166, v167
  ds_write_b128 v246, v[156:159]
  v_mfma_f32_32x32x16_bf16 v[136:151], v[192:195], v[112:115], 0
  v_cvt_pk_f16_f32 v168, v168, v169
  v_cvt_pk_f16_f32 v169, v170, v171
  v_cvt_pk_f16_f32 v170, v172, v173
  v_cvt_pk_f16_f32 v171, v174, v175
  ds_write_b128 v247, v[168:171]
  v_xor_b32_e64 v247, 16, v247
  v_mfma_f32_32x32x16_bf16 v[136:151], v[196:199], v[116:119], v[136:151]
  v_cvt_pk_f16_f32 v172, v176, v177
  v_cvt_pk_f16_f32 v173, v178, v179
  v_cvt_pk_f16_f32 v174, v180, v181
  v_cvt_pk_f16_f32 v175, v182, v183
  ds_write_b128 v247, v[172:175]
  s_cmp_ge_u32 s3, 5
  s_cbranch_scc1 L_u2
  v_mfma_f32_32x32x16_bf16 v[184:199], v[60:63], v[112:115], 0
  v_cvt_pk_f16_f32 v120, v120, v121
  v_cvt_pk_f16_f32 v121, v122, v123
  v_cvt_pk_f16_f32 v122, v124, v125
  v_mfma_f32_32x32x16_bf16 v[184:199], v[64:67], v[116:119], v[184:199]
  v_cvt_pk_f16_f32 v123, v126, v127
  ds_write_b128 v244, v[120:123]
  v_xor_b32_e64 v244, 16, v244
  v_mfma_f32_32x32x16_bf16 v[200:215], v[68:71], v[112:115], 0
  v_cvt_pk_f16_f32 v124, v128, v129
  v_cvt_pk_f16_f32 v125, v130, v131
  v_cvt_pk_f16_f32 v126, v132, v133
  v_mfma_f32_32x32x16_bf16 v[200:215], v[72:75], v[116:119], v[200:215]
  v_cvt_pk_f16_f32 v127, v134, v135
  ds_write_b128 v244, v[124:127]
  s_branch L_u3
L_u2:
  v_mfma_f32_32x32x16_bf16 v[184:199], v[216:219], v[92:95], 0
  v_cvt_pk_f16_f32 v120, v120, v121
  v_cvt_pk_f16_f32 v121, v122, v123
  v_cvt_pk_f16_f32 v122, v124, v125
  v_mfma_f32_32x32x16_bf16 v[184:199], v[220:223], v[96:99], v[184:199]
  v_cvt_pk_f16_f32 v123, v126, v127
  ds_write_b128 v244, v[120:123]
  v_xor_b32 v244, 16, v244
  v_mfma_f32_32x32x16_bf16 v[200:215], v[216:219], v[100:103], 0
  v_cvt_pk_f16_f32 v124, v128, v129
  v_cvt_pk_f16_f32 v125, v130, v131
  v_cvt_pk_f16_f32 v126, v132, v133
  v_mfma_f32_32x32x16_bf16 v[200:215], v[220:223], v[104:107], v[200:215]
  v_cvt_pk_f16_f32 v127, v134, v135
  ds_write_b128 v244, v[124:127]
L_u3:
  buffer_load_dwordx4 v[16:19], v6, s[28:31], s94 offen
  s_add_u32 s94, s94, 416
  buffer_load_dwordx4 v[112:115], v6, s[28:31], s94 offen
  s_add_u32 s94, s94, 416
  s_cmp_lg_u32 s84, 0
  s_cbranch_scc1 L_hu1
  v_lshl_add_u32 v12, v12, 7, v8
  v_lshl_add_u32 v13, v13, 7, v8
  v_lshl_add_u32 v14, v14, 7, v8
  v_lshl_add_u32 v15, v15, 7, v8
  s_add_u32 m0, s76, 16256
  s_mov_b32 exec_hi, 0xffffff
  buffer_load_dwordx4 v12, s[32:35], 0 offen lds
  s_add_u32 m0, s76, 17312
  s_nop 0
  buffer_load_dwordx4 v13, s[32:35], 0 offen lds
  s_add_u32 m0, s76, 18368
  s_mov_b32 exec_hi, 0xffff
  buffer_load_dwordx4 v14, s[32:35], 0 offen lds
  s_add_u32 m0, s76, 19424
  s_nop 0
  buffer_load_dwordx4 v15, s[32:35], 0 offen lds
  s_mov_b32 exec_hi, -1
  s_branch L_hu2
L_hu1:
L_hu2:
  v_cvt_pk_f16_f32 v136, v136, v137
  s_waitcnt lgkmcnt(8)
  v_xor_b32 v224, v224, v30
  v_cvt_pk_f16_f32 v137, v138, v139
  v_cvt_pk_f16_f32 v138, v140, v141
  v_xor_b32 v232, 32, v224
  v_cvt_pk_f16_f32 v139, v142, v143
  ds_write_b128 v245, v[136:139]
  v_xor_b32 v245, 16, v245
  v_xor_b32 v225, v225, v30
  v_cvt_pk_f16_f32 v140, v144, v145
  v_cvt_pk_f16_f32 v141, v146, v147
  v_cvt_pk_f16_f32 v142, v148, v149
  v_xor_b32 v233, 32, v225
  v_cvt_pk_f16_f32 v143, v150, v151
  ds_write_b128 v245, v[140:143]
  v_cvt_pk_f16_f32 v184, v184, v185
  s_waitcnt lgkmcnt(9)
  v_xor_b32 v226, v226, v30
  v_cvt_pk_f16_f32 v185, v186, v187
  v_cvt_pk_f16_f32 v186, v188, v189
  v_xor_b32_e64 v234, 32, v226
  v_cvt_pk_f16_f32 v187, v190, v191
  ds_write_b128 v248, v[184:187]
  v_xor_b32 v248, 16, v248
  v_xor_b32 v227, v227, v30
  v_cvt_pk_f16_f32 v188, v192, v193
  v_cvt_pk_f16_f32 v189, v194, v195
  v_cvt_pk_f16_f32 v190, v196, v197
  v_xor_b32_e64 v235, 32, v227
  v_cvt_pk_f16_f32 v191, v198, v199
  ds_write_b128 v248, v[188:191]
  v_cvt_pk_f16_f32 v200, v200, v201
  s_waitcnt lgkmcnt(10)
  v_xor_b32 v228, v228, v30
  v_cvt_pk_f16_f32 v201, v202, v203
  v_cvt_pk_f16_f32 v202, v204, v205
  v_xor_b32 v240, 32, v228
  v_cvt_pk_f16_f32 v203, v206, v207
  ds_write_b128 v249, v[200:203]
  v_xor_b32 v249, 16, v249
  v_xor_b32_e64 v229, v229, v30
  v_cvt_pk_f16_f32 v204, v208, v209
  v_cvt_pk_f16_f32 v205, v210, v211
  v_cvt_pk_f16_f32 v206, v212, v213
  v_xor_b32_e64 v241, 32, v229
  v_cvt_pk_f16_f32 v207, v214, v215
  ds_write_b128 v249, v[204:207]
  v_readlane_b32 s0, v250, 0
  v_readlane_b32 s1, v250, 26
  s_sub_u32 s75, 0x7f000000, s0
  s_sub_u32 s1, 0x7f000000, s1
  s_sub_u32 s74, 254, s74
  s_lshl_b32 s74, s74, 23
  s_mov_b32 s92, 0x88888888
  s_mov_b32 s93, 0x88888888
  s_waitcnt lgkmcnt(0)
  s_barrier
  ds_read_b64_tr_b16 v[60:61], v224 offset:0
  ds_read_b64_tr_b16 v[62:63], v225 offset:0
  ds_read_b64_tr_b16 v[64:65], v232 offset:0
  ds_read_b64_tr_b16 v[66:67], v233 offset:0
  ds_read_b64_tr_b16 v[68:69], v224 offset:43328
  ds_read_b64_tr_b16 v[70:71], v225 offset:43328
  ds_read_b64_tr_b16 v[72:73], v232 offset:43328
  ds_read_b64_tr_b16 v[74:75], v233 offset:43328
  ds_read_b64_tr_b16 v[76:77], v226 offset:0
  ds_read_b64_tr_b16 v[78:79], v227 offset:0
  ds_read_b64_tr_b16 v[80:81], v234 offset:0
  ds_read_b64_tr_b16 v[82:83], v235 offset:0
  ds_read_b64_tr_b16 v[84:85], v226 offset:43328
  ds_read_b64_tr_b16 v[86:87], v227 offset:43328
  ds_read_b64_tr_b16 v[88:89], v234 offset:43328
  ds_read_b64_tr_b16 v[90:91], v235 offset:43328
  s_cmp_ge_u32 s3, 6
  s_cbranch_scc1 L_lin
  ds_read_b64_tr_b16 v[92:93], v228 offset:0
  ds_read_b64_tr_b16 v[94:95], v229 offset:0
  ds_read_b64_tr_b16 v[96:97], v240 offset:0
  ds_read_b64_tr_b16 v[98:99], v241 offset:0
  ds_read_b64_tr_b16 v[100:101], v228 offset:43328
  ds_read_b64_tr_b16 v[102:103], v229 offset:43328
  ds_read_b64_tr_b16 v[104:105], v240 offset:43328
  ds_read_b64_tr_b16 v[106:107], v241 offset:43328
  s_waitcnt lgkmcnt(6)
  v_pk_add_f16 v92, v92, v94
  v_pk_add_f16 v93, v93, v95
  ds_write_b64 v59, v[92:93] offset:30720
  s_waitcnt lgkmcnt(5)
  v_pk_add_f16 v96, v96, v98
  v_pk_add_f16 v97, v97, v99
  s_waitcnt lgkmcnt(3)
  v_pk_add_f16 v100, v100, v102
  v_pk_add_f16 v101, v101, v103
  ds_write_b64 v59, v[100:101] offset:32768
  s_waitcnt lgkmcnt(2)
  v_pk_add_f16 v104, v104, v106
  v_pk_add_f16 v105, v105, v107
  v_cndmask_b32 v96, v96, v104, s[92:93]
  v_cndmask_b32 v97, v97, v105, s[92:93]
  ds_write_b64 v59, v[96:97] offset:31744
  ds_write_b32 v230, v104 offset:3072
  ds_write_b32 v230, v105 offset:3088
  s_branch L_p2
L_lin:
  s_and_b32 s98, s3, 1
  s_cselect_b64 vcc, -1, 0
  s_lshl_b32 s99, s98, 5
  v_mov_b32 v31, 0
  v_xor_b32 v236, s99, v236
  v_xor_b32 v237, s99, v237
  v_cndmask_b32 v238, v238, v239, vcc
  ds_read_b64_tr_b16 v[92:93], v236
  ds_read_b64_tr_b16 v[94:95], v237
  ds_read_u16_d16_hi v31, v238
  s_lshl_b32 s98, s98, 10
  v_add_u32 v29, s98, v1
  s_waitcnt lgkmcnt(2)
  v_cvt_f32_f16 v96, v92
  v_cvt_f32_f16_sdwa v97, v92 dst_sel:DWORD dst_unused:UNUSED_PAD src0_sel:WORD_1
  v_mul_f32 v96, s1, v96
  v_mul_f32 v97, s1, v97
  v_mul_f32 v96, s0, v96
  v_mul_f32 v97, s0, v97
  v_cvt_pk_bf16_f32 v92, v96, v97
  v_cvt_f32_f16 v98, v93
  v_cvt_f32_f16_sdwa v99, v93 dst_sel:DWORD dst_unused:UNUSED_PAD src0_sel:WORD_1
  v_mul_f32 v98, s1, v98
  v_mul_f32 v99, s1, v99
  v_mul_f32 v98, s0, v98
  v_mul_f32 v99, s0, v99
  v_cvt_pk_bf16_f32 v93, v98, v99
  s_waitcnt lgkmcnt(1)
  v_cvt_f32_f16 v100, v94
  v_cvt_f32_f16_sdwa v101, v94 dst_sel:DWORD dst_unused:UNUSED_PAD src0_sel:WORD_1
  v_mul_f32 v100, s1, v100
  v_mul_f32 v101, s1, v101
  v_mul_f32 v100, s0, v100
  v_mul_f32 v101, s0, v101
  v_cvt_pk_bf16_f32 v94, v100, v101
  v_cvt_f32_f16_e64 v102, v95
  v_cvt_f32_f16_sdwa v103, v95 dst_sel:DWORD dst_unused:UNUSED_PAD src0_sel:WORD_1
  v_mul_f32 v102, s1, v102
  v_mul_f32 v103, s1, v103
  s_mov_b32 exec_lo, 0
  s_mov_b32 exec_hi, 0xffff
  s_waitcnt lgkmcnt(0)
  v_mov_b32 v102, v31
  s_mov_b64 exec, -1
  v_mul_f32 v102, s0, v102
  v_mul_f32 v103, s0, v103
  v_cvt_pk_bf16_f32 v95, v102, v103
  ds_write_b128 v29, v[92:95] offset:39936
L_p2:
  v_pk_add_f16 v76, v76, v78
  v_pk_add_f16 v77, v77, v79
  ds_write_b64 v59, v[76:77] offset:18432
  v_pk_add_f16 v80, v80, v82
  v_pk_add_f16 v81, v81, v83
  v_pk_add_f16 v84, v84, v86
  v_pk_add_f16 v85, v85, v87
  ds_write_b64 v59, v[84:85] offset:20480
  v_pk_add_f16 v88, v88, v90
  v_pk_add_f16 v89, v89, v91
  v_cndmask_b32 v80, v80, v88, s[92:93]
  v_cndmask_b32 v81, v81, v89, s[92:93]
  ds_write_b64 v59, v[80:81] offset:19456
  ds_write_b32 v230, v88 offset:1024
  ds_write_b32 v230, v89 offset:1040
  v_pk_add_f16 v60, v60, v62
  v_pk_add_f16 v61, v61, v63
  ds_write_b64 v59, v[60:61] offset:6144
  v_pk_add_f16 v64, v64, v66
  v_pk_add_f16 v65, v65, v67
  v_pk_add_f16 v68, v68, v70
  v_pk_add_f16 v69, v69, v71
  ds_write_b64 v59, v[68:69] offset:8192
  v_pk_add_f16 v72, v72, v74
  v_pk_add_f16 v73, v73, v75
  v_cndmask_b32 v64, v64, v72, s[92:93]
  v_cndmask_b32 v65, v65, v73, s[92:93]
  ds_write_b64 v59, v[64:65] offset:7168
  s_cmp_lt_u32 s3, 2
  s_cbranch_scc1 L_p2d
  v_subrev_u32 v230, 1024, v230
  ds_write_b32 v230, v72 offset:0
  ds_write_b32 v230, v73 offset:16
  s_branch L_built
L_p2d:
  ds_write_b64 v231, v[72:73] offset:5120
L_built:
  s_mov_b32 s0, s74
  s_mov_b32 s1, s75
  s_mov_b32 s96, 0x3e000000
  s_mov_b32 s97, 0x43000000
  s_mov_b32 s51, 1
  s_mul_i32 s98, s3, 1536
  s_add_u32 s98, s98, 116736
  s_cmp_lg_u32 s84, 0
  s_cbranch_scc1 L_g1c
  s_sub_u32 s94, s94, 416
  s_waitcnt vmcnt(4)
  ds_read_u16_d16_hi v32, v10 offset:0
  ds_read_u16_d16_hi v33, v10 offset:2
  ds_read_u16_d16_hi v34, v10 offset:2112
  ds_read_u16_d16_hi v35, v10 offset:2114
  ds_read_u16_d16_hi v36, v10 offset:128
  ds_read_u16_d16_hi v37, v10 offset:130
  ds_read_u16_d16_hi v38, v10 offset:2240
  ds_read_u16_d16_hi v39, v10 offset:2242
  ds_read_u16_d16_hi v40, v10 offset:256
  ds_read_u16_d16_hi v41, v10 offset:258
  ds_read_u16_d16_hi v42, v10 offset:2368
  ds_read_u16_d16_hi v43, v10 offset:2370
  ds_read_u16_d16_hi v44, v10 offset:384
  ds_read_u16_d16_hi v45, v10 offset:386
  ds_read_u16_d16_hi v46, v10 offset:2496
  ds_read_u16_d16_hi v47, v10 offset:2498
  ds_read_u16_d16_hi v48, v10 offset:512
  ds_read_u16_d16_hi v49, v10 offset:514
  ds_read_u16_d16_hi v50, v10 offset:2624
  ds_read_u16_d16_hi v51, v10 offset:2626
  ds_read_u16_d16_hi v52, v10 offset:640
  ds_read_u16_d16_hi v53, v10 offset:642
  ds_read_u16_d16_hi v54, v10 offset:2752
  ds_read_u16_d16_hi v55, v10 offset:2754
  ds_read_u16_d16_hi v56, v10 offset:768
  ds_read_u16_d16_hi v57, v10 offset:770
  s_waitcnt lgkmcnt(14)
  v_max3_f32 v58, |v32|, |v33|, 0
  v_cvt_pk_f16_f32 v184, v32, v33
  v_max3_f32 v58, |v34|, |v35|, v58
  v_cvt_pk_f16_f32 v185, v34, v35
  v_max3_f32 v58, |v36|, |v37|, v58
  v_cvt_pk_f16_f32 v186, v36, v37
  v_max3_f32 v58, |v38|, |v39|, v58
  v_cvt_pk_f16_f32 v187, v38, v39
  v_max3_f32 v58, |v40|, |v41|, v58
  v_cvt_pk_f16_f32 v188, v40, v41
  v_max3_f32 v58, |v42|, |v43|, v58
  v_cvt_pk_f16_f32 v189, v42, v43
  s_waitcnt lgkmcnt(12)
  v_max3_f32 v58, |v44|, |v45|, v58
  v_cvt_pk_f16_f32 v190, v44, v45
  s_waitcnt lgkmcnt(10)
  v_max3_f32 v58, |v46|, |v47|, v58
  v_cvt_pk_f16_f32 v191, v46, v47
  s_waitcnt lgkmcnt(8)
  v_max3_f32 v58, |v48|, |v49|, v58
  v_cvt_pk_f16_f32 v192, v48, v49
  s_waitcnt lgkmcnt(6)
  v_max3_f32 v58, |v50|, |v51|, v58
  v_cvt_pk_f16_f32 v193, v50, v51
  s_waitcnt lgkmcnt(4)
  v_max3_f32 v58, |v52|, |v53|, v58
  v_cvt_pk_f16_f32 v194, v52, v53
  s_waitcnt lgkmcnt(2)
  v_max3_f32 v58, |v54|, |v55|, v58
  v_cvt_pk_f16_f32 v195, v54, v55
  s_waitcnt lgkmcnt(0)
  v_max3_f32 v58, |v56|, |v57|, v58
  v_cvt_pk_f16_f32 v196, v56, v57
  s_waitcnt lgkmcnt(0)
  s_barrier
  s_branch L_cin_go
L_g1c:
  s_waitcnt lgkmcnt(0)
  s_barrier
  s_add_u32 s76, s76, -63168
  s_waitcnt vmcnt(1)
  v_lshl_add_u32 v16, v16, 7, v8
  v_lshl_add_u32 v17, v17, 7, v8
  v_lshl_add_u32 v18, v18, 7, v8
  v_lshl_add_u32 v19, v19, 7, v8
  s_add_u32 m0, s76, 0
  s_mov_b32 exec_hi, 0xffffff
  buffer_load_dwordx4 v16, s[32:35], 0 offen lds
  s_add_u32 m0, s76, 1056
  s_nop 0
  buffer_load_dwordx4 v17, s[32:35], 0 offen lds
  s_add_u32 m0, s76, 2112
  s_mov_b32 exec_hi, 0xffff
  buffer_load_dwordx4 v18, s[32:35], 0 offen lds
  s_add_u32 m0, s76, 3168
  s_nop 0
  buffer_load_dwordx4 v19, s[32:35], 0 offen lds
  s_mov_b32 exec_hi, -1
  s_waitcnt vmcnt(4)
  v_lshl_add_u32 v112, v112, 7, v8
  v_lshl_add_u32 v113, v113, 7, v8
  v_lshl_add_u32 v114, v114, 7, v8
  v_lshl_add_u32 v115, v115, 7, v8
  s_add_u32 m0, s76, 16256
  s_mov_b32 exec_hi, 0xffffff
  buffer_load_dwordx4 v112, s[32:35], 0 offen lds
  s_add_u32 m0, s76, 17312
  s_nop 0
  buffer_load_dwordx4 v113, s[32:35], 0 offen lds
  s_add_u32 m0, s76, 18368
  s_mov_b32 exec_hi, 0xffff
  buffer_load_dwordx4 v114, s[32:35], 0 offen lds
  s_add_u32 m0, s76, 19424
  s_nop 0
  buffer_load_dwordx4 v115, s[32:35], 0 offen lds
  s_mov_b32 exec_hi, -1
  buffer_load_dwordx4 v[16:19], v6, s[28:31], s94 offen
  s_add_u32 s94, s94, 416
  v_add_u32 v10, -63168, v10
  v_add_u32 v4, -63168, v4
  v_add_u32 v5, -63168, v5
  ds_write_b32 v10, v7 offset:2880
  ds_write_b32 v10, v7 offset:19136
L_g1d:
  s_waitcnt vmcnt(5)
  ds_read_u16_d16_hi v32, v10 offset:0
  ds_read_u16_d16_hi v33, v10 offset:2
  ds_read_u16_d16_hi v34, v10 offset:2112
  ds_read_u16_d16_hi v35, v10 offset:2114
  ds_read_u16_d16_hi v36, v10 offset:128
  ds_read_u16_d16_hi v37, v10 offset:130
  ds_read_u16_d16_hi v38, v10 offset:2240
  ds_read_u16_d16_hi v39, v10 offset:2242
  ds_read_u16_d16_hi v40, v10 offset:256
  ds_read_u16_d16_hi v41, v10 offset:258
  ds_read_u16_d16_hi v42, v10 offset:2368
  ds_read_u16_d16_hi v43, v10 offset:2370
  ds_read_u16_d16_hi v44, v10 offset:384
  ds_read_u16_d16_hi v45, v10 offset:386
  ds_read_u16_d16_hi v46, v10 offset:2496
  ds_read_u16_d16_hi v47, v10 offset:2498
  ds_read_u16_d16_hi v48, v10 offset:512
  ds_read_u16_d16_hi v49, v10 offset:514
  ds_read_u16_d16_hi v50, v10 offset:2624
  ds_read_u16_d16_hi v51, v10 offset:2626
  ds_read_u16_d16_hi v52, v10 offset:640
  ds_read_u16_d16_hi v53, v10 offset:642
  ds_read_u16_d16_hi v54, v10 offset:2752
  ds_read_u16_d16_hi v55, v10 offset:2754
  ds_read_u16_d16_hi v56, v10 offset:768
  ds_read_u16_d16_hi v57, v10 offset:770
  s_waitcnt lgkmcnt(14)
  v_max3_f32 v58, |v32|, |v33|, 0
  v_cvt_pk_f16_f32 v184, v32, v33
  v_max3_f32 v58, |v34|, |v35|, v58
  v_cvt_pk_f16_f32 v185, v34, v35
  v_max3_f32 v58, |v36|, |v37|, v58
  v_cvt_pk_f16_f32 v186, v36, v37
  v_max3_f32 v58, |v38|, |v39|, v58
  v_cvt_pk_f16_f32 v187, v38, v39
  v_max3_f32 v58, |v40|, |v41|, v58
  v_cvt_pk_f16_f32 v188, v40, v41
  v_max3_f32 v58, |v42|, |v43|, v58
  v_cvt_pk_f16_f32 v189, v42, v43
  s_waitcnt lgkmcnt(12)
  v_max3_f32 v58, |v44|, |v45|, v58
  v_cvt_pk_f16_f32 v190, v44, v45
  s_waitcnt lgkmcnt(10)
  v_max3_f32 v58, |v46|, |v47|, v58
  v_cvt_pk_f16_f32 v191, v46, v47
  s_waitcnt lgkmcnt(8)
  v_max3_f32 v58, |v48|, |v49|, v58
  v_cvt_pk_f16_f32 v192, v48, v49
  s_waitcnt lgkmcnt(6)
  v_max3_f32 v58, |v50|, |v51|, v58
  v_cvt_pk_f16_f32 v193, v50, v51
  s_waitcnt lgkmcnt(4)
  v_max3_f32 v58, |v52|, |v53|, v58
  v_cvt_pk_f16_f32 v194, v52, v53
  s_waitcnt lgkmcnt(2)
  v_max3_f32 v58, |v54|, |v55|, v58
  v_cvt_pk_f16_f32 v195, v54, v55
  s_waitcnt lgkmcnt(0)
  v_max3_f32 v58, |v56|, |v57|, v58
  v_cvt_pk_f16_f32 v196, v56, v57
L_cin_go:
  ds_write_b32 v11, v184 offset:0
  ds_write_b32 v11, v185 offset:160
  ds_write_b32 v11, v186 offset:320
  ds_write_b32 v11, v187 offset:480
  ds_write_b32 v11, v188 offset:640
  ds_write_b32 v11, v189 offset:800
  ds_write_b32 v11, v190 offset:960
  ds_write_b32 v11, v191 offset:1120
  ds_write_b32 v11, v192 offset:1280
  ds_write_b32 v11, v193 offset:1440
  ds_write_b32 v11, v194 offset:1600
  ds_write_b32 v11, v195 offset:1760
  ds_write_b32 v11, v196 offset:1920
  s_mov_b32 s81, 16256
  s_add_u32 s76, s76, 16256
  v_lshlrev_b32 v7, 2, v0
  v_add_u32 v7, s98, v7
L_cin_loop:
  v_cmp_le_f32 s[90:91], s97, v58
  v_cmp_le_f32 vcc, s96, v58
  s_mov_b32 s49, s74
  s_mov_b32 s50, s75
  s_cmp_lg_u64 s[90:91], 0
  s_cbranch_scc1 L_cslow
  s_cbranch_vccz L_cslow
L_cconv:
  s_cmp_lg_u32 s51, 0
  s_cbranch_scc1 L_first
  ds_read_b64_tr_b16 v[60:61], v20 offset:0
  v_mul_f32 v116, v184, v192
  v_mul_f32 v117, v185, v193
  ds_read_b64_tr_b16 v[74:75], v20 offset:32
  v_mul_f32 v118, v186, v194
  ds_read_b64_tr_b16 v[88:89], v20 offset:64
  v_mul_f32 v119, v187, v195
  ds_read_b64_tr_b16 v[102:103], v20 offset:96
  v_fmac_f32_e64 v116, v188, v191
  ds_read_b64_tr_b16 v[66:67], v23 offset:0
  v_fmac_f32 v117, v200, v208
  ds_read_b64_tr_b16 v[80:81], v23 offset:32
  v_fmac_f32 v118, v201, v209
  ds_read_b64_tr_b16 v[94:95], v23 offset:64
  v_fmac_f32 v119, v202, v210
  ds_read_b64_tr_b16 v[108:109], v23 offset:96
  v_fmac_f32 v116, v203, v211
  ds_read_b64_tr_b16 v[68:69], v24 offset:0
  v_fmac_f32_e64 v117, v204, v207
  ds_read_b64_tr_b16 v[82:83], v24 offset:32
  v_fmac_f32 v118, v216, v224
  ds_read_b64_tr_b16 v[96:97], v24 offset:64
  v_fmac_f32 v119, v217, v225
  ds_read_b64_tr_b16 v[110:111], v24 offset:96
  v_fmac_f32 v116, v218, v226
  ds_read_b64_tr_b16 v[124:125], v4 offset:0
  v_fmac_f32 v117, v219, v227
  ds_read_b64_tr_b16 v[126:127], v5 offset:0
  v_fmac_f32 v118, v220, v223
  v_fmac_f32 v119, v232, v240
  ds_read_b64_tr_b16 v[136:137], v4 offset:32
  v_fmac_f32 v116, v233, v241
  ds_read_b64_tr_b16 v[138:139], v5 offset:32
  v_fmac_f32 v117, v234, v242
  ds_read_b64_tr_b16 v[148:149], v4 offset:64
  v_fmac_f32 v118, v235, v243
  ds_read_b64_tr_b16 v[150:151], v5 offset:64
  v_fmac_f32 v119, v236, v239
  ds_read_b64_tr_b16 v[160:161], v4 offset:96
  v_fmac_f32_e64 v116, v189, v196
  ds_read_b64_tr_b16 v[162:163], v5 offset:96
  v_fmac_f32 v117, v189, v197
  ds_read_b128 v[164:167], v1 offset:39936
  v_fmac_f32 v118, v190, v198
  ds_read_b128 v[168:171], v1 offset:40960
  v_fmac_f32 v119, v190, v199
  ds_read_b128 v[172:175], v1 offset:8192
  v_fmac_f32 v116, v205, v212
  ds_read_b128 v[176:179], v1 offset:6144
  v_fmac_f32_e64 v117, v205, v213
  ds_read_b64_tr_b16 v[70:71], v25 offset:0
  v_fmac_f32 v118, v206, v214
  ds_read_b64_tr_b16 v[84:85], v25 offset:32
  v_fmac_f32 v119, v206, v215
  ds_read_b64_tr_b16 v[98:99], v25 offset:64
  v_fmac_f32 v116, v221, v228
  v_fmac_f32 v117, v221, v229
  ds_read_b64_tr_b16 v[112:113], v25 offset:96
  v_fmac_f32 v118, v222, v230
  ds_read_b64_tr_b16 v[72:73], v26 offset:0
  v_fmac_f32 v119, v222, v231
  ds_read_b64_tr_b16 v[86:87], v26 offset:32
  v_fmac_f32 v116, v237, v244
  ds_read_b64_tr_b16 v[100:101], v26 offset:64
  v_fmac_f32 v117, v237, v245
  ds_read_b64_tr_b16 v[114:115], v26 offset:96
  v_fmac_f32 v118, v238, v246
  ds_read_b64_tr_b16 v[62:63], v21 offset:0
  v_fmac_f32 v119, v238, v247
  ds_read_b64_tr_b16 v[76:77], v21 offset:32
  v_add_f32_e64 v116, v116, v117
  ds_read_b64_tr_b16 v[90:91], v21 offset:64
  v_add_f32 v118, v118, v119
  ds_read_b64_tr_b16 v[104:105], v21 offset:96
  v_add_f32 v116, v116, v118
  ds_read_b64_tr_b16 v[64:65], v22 offset:0
  v_mul_f32 v116, s49, v116
  ds_read_b64_tr_b16 v[78:79], v22 offset:32
  v_mul_f32 v116, s50, v116
  ds_read_b64_tr_b16 v[92:93], v22 offset:64
  ds_write_b32 v7, v116
  ds_read_b64_tr_b16 v[106:107], v22 offset:96
  v_add_u32 v7, 256, v7
  s_waitcnt lgkmcnt(14)
  v_pk_mul_f16 v120, v60, v67 op_sel:[0,0] op_sel_hi:[0,1]
  v_pk_mul_f16 v121, v60, v67 op_sel:[1,0] op_sel_hi:[1,1]
  v_pk_mul_f16 v122, v60, v68 op_sel:[0,0] op_sel_hi:[0,1]
  v_pk_mul_f16 v123, v60, v68 op_sel:[1,0] op_sel_hi:[1,1]
  v_pk_mul_f16 v132, v74, v81 op_sel:[0,0] op_sel_hi:[0,1]
  v_pk_mul_f16 v133, v74, v81 op_sel:[1,0] op_sel_hi:[1,1]
  v_pk_mul_f16 v134, v74, v82 op_sel:[0,0] op_sel_hi:[0,1]
  v_pk_mul_f16 v135, v74, v82 op_sel:[1,0] op_sel_hi:[1,1]
  v_pk_mul_f16 v144, v88, v95 op_sel:[0,0] op_sel_hi:[0,1]
  v_pk_mul_f16 v145, v88, v95 op_sel:[1,0] op_sel_hi:[1,1]
  v_pk_mul_f16 v146, v88, v96 op_sel:[0,0] op_sel_hi:[0,1]
  v_pk_mul_f16 v147, v88, v96 op_sel:[1,0] op_sel_hi:[1,1]
  v_pk_mul_f16 v156, v102, v109 op_sel:[0,0] op_sel_hi:[0,1]
  v_pk_mul_f16 v157, v102, v109 op_sel:[1,0] op_sel_hi:[1,1]
  v_pk_mul_f16 v158, v102, v110 op_sel:[0,0] op_sel_hi:[0,1]
  v_pk_mul_f16 v159, v102, v110 op_sel:[1,0] op_sel_hi:[1,1]
  s_waitcnt vmcnt(0)
  v_lshl_add_u32 v16, v16, 7, v8
  v_lshl_add_u32 v17, v17, 7, v8
  v_lshl_add_u32 v18, v18, 7, v8
  v_lshl_add_u32 v19, v19, 7, v8
  s_add_u32 m0, s76, 0
  s_mov_b32 exec_hi, 0xffffff
  buffer_load_dwordx4 v16, s[32:35], 0 offen lds
  s_add_u32 m0, s76, 1056
  s_nop 0
  buffer_load_dwordx4 v17, s[32:35], 0 offen lds
  s_add_u32 m0, s76, 2112
  s_mov_b32 exec_hi, 0xffff
  buffer_load_dwordx4 v18, s[32:35], 0 offen lds
  s_add_u32 m0, s76, 3168
  s_nop 0
  buffer_load_dwordx4 v19, s[32:35], 0 offen lds
  s_mov_b32 exec_hi, -1
  buffer_load_dwordx4 v[16:19], v6, s[28:31], s94 offen
  s_add_u32 s94, s94, 416
L_novm:
  v_add_u32 v10, s81, v10
  v_add_u32 v4, s81, v4
  v_add_u32 v5, s81, v5
  s_sub_u32 s76, s76, s81
  s_sub_u32 s81, 0, s81
  s_mov_b32 s51, 0
  s_waitcnt lgkmcnt(14)
  s_cmp_eq_u32 s84, 0
  s_cbranch_scc1 L_np1
  s_setprio 1
L_np1:
  v_mfma_f32_16x16x32_bf16 v[184:187], v[164:167], v[124:127], 0
  ds_read_b128 v[180:183], v1 offset:7168
  v_pk_mul_f16 v116, v60, v69 op_sel:[0,0] op_sel_hi:[0,1]
  v_mfma_f32_16x16x32_bf16 v[200:203], v[164:167], v[136:139], 0
  v_pk_mul_f16 v117, v60, v69 op_sel:[1,0] op_sel_hi:[1,1]
  v_mfma_f32_16x16x32_bf16 v[216:219], v[164:167], v[148:151], 0
  v_pk_mul_f16 v118, v60, v70 op_sel:[0,0] op_sel_hi:[0,1]
  v_mfma_f32_16x16x32_bf16 v[232:235], v[164:167], v[160:163], 0
  v_pk_mul_f16 v119, v60, v70 op_sel:[1,0] op_sel_hi:[1,1]
  v_mfma_f32_16x16x32_bf16 v[236:239], v[168:171], v[160:163], 0
  ds_read_b128 v[164:167], v1 offset:5120
  v_pk_mul_f16 v128, v74, v83 op_sel:[0,0] op_sel_hi:[0,1]
  v_mfma_f32_16x16x32_bf16 v[220:223], v[168:171], v[148:151], 0
  v_pk_mul_f16 v129, v74, v83 op_sel:[1,0] op_sel_hi:[1,1]
  v_mfma_f32_16x16x32_bf16 v[204:207], v[168:171], v[136:139], 0
  v_pk_mul_f16 v130, v74, v84 op_sel:[0,0] op_sel_hi:[0,1]
  v_mfma_f32_16x16x32_bf16 v[188:191], v[168:171], v[124:127], 0
  v_pk_mul_f16 v131, v74, v84 op_sel:[1,0] op_sel_hi:[1,1]
  v_mfma_f32_16x16x32_f16 v[192:195], v[172:175], v[120:123], 0
  ds_read_b128 v[168:171], v1 offset:11264
  v_pk_mul_f16 v140, v88, v97 op_sel:[0,0] op_sel_hi:[0,1]
  v_mfma_f32_16x16x32_f16 v[208:211], v[172:175], v[132:135], 0
  v_pk_mul_f16 v141, v88, v97 op_sel:[1,0] op_sel_hi:[1,1]
  v_mfma_f32_16x16x32_f16 v[224:227], v[172:175], v[144:147], 0
  s_waitcnt lgkmcnt(14)
  v_pk_mul_f16 v142, v88, v98 op_sel:[0,0] op_sel_hi:[0,1]
  v_mfma_f32_16x16x32_f16 v[240:243], v[172:175], v[156:159], 0
  v_pk_mul_f16 v143, v88, v98 op_sel:[1,0] op_sel_hi:[1,1]
  v_mfma_f32_16x16x32_f16 v[232:235], v[176:179], v[156:159], v[232:235]
  ds_read_b128 v[172:175], v1 offset:9216
  v_pk_mul_f16 v152, v102, v111 op_sel:[0,0] op_sel_hi:[0,1]
  v_mfma_f32_16x16x32_f16 v[216:219], v[176:179], v[144:147], v[216:219]
  v_pk_mul_f16 v153, v102, v111 op_sel:[1,0] op_sel_hi:[1,1]
  v_mfma_f32_16x16x32_f16 v[200:203], v[176:179], v[132:135], v[200:203]
  s_waitcnt lgkmcnt(14)
  v_pk_mul_f16 v154, v102, v112 op_sel:[0,0] op_sel_hi:[0,1]
  v_mfma_f32_16x16x32_f16 v[184:187], v[176:179], v[120:123], v[184:187]
  s_waitcnt lgkmcnt(3)
  v_pk_mul_f16 v155, v102, v112 op_sel:[1,0] op_sel_hi:[1,1]
  v_mfma_f32_16x16x32_f16 v[188:191], v[180:183], v[120:123], v[188:191]
  ds_read_b128 v[176:179], v1 offset:10240
  v_pk_mul_f16 v124, v61, v68 op_sel:[0,0] op_sel_hi:[0,1]
  v_mfma_f32_16x16x32_f16 v[204:207], v[180:183], v[132:135], v[204:207]
  v_pk_mul_f16 v125, v61, v68 op_sel:[1,0] op_sel_hi:[1,1]
  v_mfma_f32_16x16x32_f16 v[220:223], v[180:183], v[144:147], v[220:223]
  v_pk_mul_f16 v126, v61, v69 op_sel:[0,0] op_sel_hi:[0,1]
  v_mfma_f32_16x16x32_f16 v[236:239], v[180:183], v[156:159], v[236:239]
  s_waitcnt lgkmcnt(3)
  v_pk_mul_f16 v127, v61, v69 op_sel:[1,0] op_sel_hi:[1,1]
  v_mfma_f32_16x16x32_f16 v[196:199], v[164:167], v[120:123], 0
  ds_read_b128 v[180:183], v1 offset:14336
  v_pk_mul_f16 v136, v75, v82 op_sel:[0,0] op_sel_hi:[0,1]
  v_mfma_f32_16x16x32_f16 v[212:215], v[164:167], v[132:135], 0
  v_pk_mul_f16 v120, v60, v71 op_sel:[0,0] op_sel_hi:[0,1]
  v_mfma_f32_16x16x32_f16 v[228:231], v[164:167], v[144:147], 0
  v_pk_mul_f16 v121, v60, v71 op_sel:[1,0] op_sel_hi:[1,1]
  v_mfma_f32_16x16x32_f16 v[244:247], v[164:167], v[156:159], 0
  s_waitcnt lgkmcnt(3)
  v_pk_mul_f16 v122, v60, v66 op_sel:[0,1] op_sel_hi:[0,0]
  v_mfma_f32_16x16x32_f16 v[192:195], v[168:171], v[116:119], v[192:195]
  ds_read_b128 v[164:167], v1 offset:12288
  v_pk_mul_f16 v123, v60, v72 op_sel:[0,0] op_sel_hi:[1,0]
  v_mfma_f32_16x16x32_f16 v[208:211], v[168:171], v[128:131], v[208:211]
  v_pk_mul_f16 v132, v74, v85 op_sel:[0,0] op_sel_hi:[0,1]
  v_mfma_f32_16x16x32_f16 v[224:227], v[168:171], v[140:143], v[224:227]
  v_pk_mul_f16 v133, v74, v85 op_sel:[1,0] op_sel_hi:[1,1]
  v_mfma_f32_16x16x32_f16 v[240:243], v[168:171], v[152:155], v[240:243]
  s_waitcnt lgkmcnt(3)
  v_pk_mul_f16 v134, v74, v80 op_sel:[0,1] op_sel_hi:[0,0]
  v_mfma_f32_16x16x32_f16 v[232:235], v[172:175], v[152:155], v[232:235]
  ds_read_b128 v[168:171], v1 offset:13312
  v_pk_mul_f16 v135, v74, v86 op_sel:[0,0] op_sel_hi:[1,0]
  v_mfma_f32_16x16x32_f16 v[216:219], v[172:175], v[140:143], v[216:219]
  v_pk_mul_f16 v144, v88, v99 op_sel:[0,0] op_sel_hi:[0,1]
  v_mfma_f32_16x16x32_f16 v[200:203], v[172:175], v[128:131], v[200:203]
  s_setprio 2
  v_pk_mul_f16 v145, v88, v99 op_sel:[1,0] op_sel_hi:[1,1]
  v_mfma_f32_16x16x32_f16 v[184:187], v[172:175], v[116:119], v[184:187]
  s_waitcnt lgkmcnt(3)
  v_pk_mul_f16 v146, v88, v94 op_sel:[0,1] op_sel_hi:[0,0]
  v_mfma_f32_16x16x32_f16 v[188:191], v[176:179], v[116:119], v[188:191]
  ds_read_b128 v[172:175], v1 offset:0
  v_pk_mul_f16 v147, v88, v100 op_sel:[0,0] op_sel_hi:[1,0]
  v_mfma_f32_16x16x32_f16 v[204:207], v[176:179], v[128:131], v[204:207]
  v_pk_mul_f16 v156, v102, v113 op_sel:[0,0] op_sel_hi:[0,1]
  v_mfma_f32_16x16x32_f16 v[220:223], v[176:179], v[140:143], v[220:223]
  v_pk_mul_f16 v157, v102, v113 op_sel:[1,0] op_sel_hi:[1,1]
  v_mfma_f32_16x16x32_f16 v[236:239], v[176:179], v[152:155], v[236:239]
  s_waitcnt lgkmcnt(3)
  v_pk_mul_f16 v158, v102, v108 op_sel:[0,1] op_sel_hi:[0,0]
  v_mfma_f32_16x16x32_f16 v[192:195], v[180:183], v[120:123], v[192:195]
  ds_read_b128 v[176:179], v1 offset:17408
  v_pk_mul_f16 v159, v102, v114 op_sel:[0,0] op_sel_hi:[1,0]
  v_mfma_f32_16x16x32_f16 v[208:211], v[180:183], v[132:135], v[208:211]
  v_pk_mul_f16 v137, v75, v82 op_sel:[1,0] op_sel_hi:[1,1]
  v_mfma_f32_16x16x32_f16 v[224:227], v[180:183], v[144:147], v[224:227]
  v_pk_mul_f16 v138, v75, v83 op_sel:[0,0] op_sel_hi:[0,1]
  v_mfma_f32_16x16x32_f16 v[240:243], v[180:183], v[156:159], v[240:243]
  s_waitcnt lgkmcnt(3)
  v_pk_mul_f16 v139, v75, v83 op_sel:[1,0] op_sel_hi:[1,1]
  v_mfma_f32_16x16x32_f16 v[232:235], v[164:167], v[156:159], v[232:235]
  ds_read_b128 v[180:183], v1 offset:15360
  v_pk_mul_f16 v148, v89, v96 op_sel:[0,0] op_sel_hi:[0,1]
  v_mfma_f32_16x16x32_f16 v[216:219], v[164:167], v[144:147], v[216:219]
  v_pk_mul_f16 v149, v89, v96 op_sel:[1,0] op_sel_hi:[1,1]
  v_mfma_f32_16x16x32_f16 v[200:203], v[164:167], v[132:135], v[200:203]
  v_pk_mul_f16 v150, v89, v97 op_sel:[0,0] op_sel_hi:[0,1]
  v_mfma_f32_16x16x32_f16 v[184:187], v[164:167], v[120:123], v[184:187]
  s_waitcnt lgkmcnt(3)
  v_pk_mul_f16 v151, v89, v97 op_sel:[1,0] op_sel_hi:[1,1]
  v_mfma_f32_16x16x32_f16 v[188:191], v[168:171], v[120:123], v[188:191]
  ds_read_b128 v[164:167], v1 offset:16384
  v_pk_mul_f16 v160, v103, v110 op_sel:[0,0] op_sel_hi:[0,1]
  v_mfma_f32_16x16x32_f16 v[204:207], v[168:171], v[132:135], v[204:207]
  v_pk_mul_f16 v161, v103, v110 op_sel:[1,0] op_sel_hi:[1,1]
  v_mfma_f32_16x16x32_f16 v[220:223], v[168:171], v[144:147], v[220:223]
  v_pk_mul_f16 v162, v103, v111 op_sel:[0,0] op_sel_hi:[0,1]
  v_mfma_f32_16x16x32_f16 v[236:239], v[168:171], v[156:159], v[236:239]
  s_waitcnt lgkmcnt(3)
  v_pk_mul_f16 v163, v103, v111 op_sel:[1,0] op_sel_hi:[1,1]
  v_smfmac_f32_16x16x64_f16 v[196:199], v[172:175], v[116:123], v9
  ds_read_b128 v[168:171], v1 offset:20480
  v_smfmac_f32_16x16x64_f16 v[212:215], v[172:175], v[128:135], v9
  v_pk_mul_f16 v120, v61, v70 op_sel:[0,0] op_sel_hi:[0,1]
  v_smfmac_f32_16x16x64_f16 v[228:231], v[172:175], v[140:147], v9
  v_pk_mul_f16 v121, v61, v70 op_sel:[1,0] op_sel_hi:[1,1]
  v_smfmac_f32_16x16x64_f16 v[244:247], v[172:175], v[152:159], v9
  s_waitcnt lgkmcnt(3)
  v_pk_mul_f16 v122, v61, v71 op_sel:[0,0] op_sel_hi:[0,1]
  v_mfma_f32_16x16x32_f16 v[192:195], v[176:179], v[124:127], v[192:195]
  ds_read_b128 v[172:175], v1 offset:18432
  v_pk_mul_f16 v123, v61, v71 op_sel:[1,0] op_sel_hi:[1,1]
  v_mfma_f32_16x16x32_f16 v[208:211], v[176:179], v[136:139], v[208:211]
  v_pk_mul_f16 v132, v75, v84 op_sel:[0,0] op_sel_hi:[0,1]
  v_mfma_f32_16x16x32_f16 v[224:227], v[176:179], v[148:151], v[224:227]
  v_pk_mul_f16 v133, v75, v84 op_sel:[1,0] op_sel_hi:[1,1]
  v_mfma_f32_16x16x32_f16 v[240:243], v[176:179], v[160:163], v[240:243]
  s_waitcnt lgkmcnt(3)
  v_pk_mul_f16 v134, v75, v85 op_sel:[0,0] op_sel_hi:[0,1]
  v_mfma_f32_16x16x32_f16 v[232:235], v[180:183], v[160:163], v[232:235]
  ds_read_b128 v[176:179], v1 offset:19456
  v_pk_mul_f16 v135, v75, v85 op_sel:[1,0] op_sel_hi:[1,1]
  v_mfma_f32_16x16x32_f16 v[216:219], v[180:183], v[148:151], v[216:219]
  v_pk_mul_f16 v144, v89, v98 op_sel:[0,0] op_sel_hi:[0,1]
  v_mfma_f32_16x16x32_f16 v[200:203], v[180:183], v[136:139], v[200:203]
  v_pk_mul_f16 v145, v89, v98 op_sel:[1,0] op_sel_hi:[1,1]
  v_mfma_f32_16x16x32_f16 v[184:187], v[180:183], v[124:127], v[184:187]
  s_waitcnt lgkmcnt(3)
  v_pk_mul_f16 v146, v89, v99 op_sel:[0,0] op_sel_hi:[0,1]
  v_mfma_f32_16x16x32_f16 v[188:191], v[164:167], v[124:127], v[188:191]
  ds_read_b128 v[180:183], v1 offset:1024
  v_pk_mul_f16 v147, v89, v99 op_sel:[1,0] op_sel_hi:[1,1]
  v_mfma_f32_16x16x32_f16 v[204:207], v[164:167], v[136:139], v[204:207]
  s_waitcnt vmcnt(0)
  ds_read_u16_d16_hi v32, v10 offset:0
  v_pk_mul_f16 v156, v103, v112 op_sel:[0,0] op_sel_hi:[0,1]
  v_mfma_f32_16x16x32_f16 v[220:223], v[164:167], v[148:151], v[220:223]
  ds_read_u16_d16_hi v33, v10 offset:2
  v_pk_mul_f16 v157, v103, v112 op_sel:[1,0] op_sel_hi:[1,1]
  v_mfma_f32_16x16x32_f16 v[236:239], v[164:167], v[160:163], v[236:239]
  s_waitcnt lgkmcnt(5)
  v_pk_mul_f16 v158, v103, v113 op_sel:[0,0] op_sel_hi:[0,1]
  v_mfma_f32_16x16x32_f16 v[192:195], v[168:171], v[120:123], v[192:195]
  ds_read_b128 v[164:167], v1 offset:23552
  v_pk_mul_f16 v159, v103, v113 op_sel:[1,0] op_sel_hi:[1,1]
  v_mfma_f32_16x16x32_f16 v[208:211], v[168:171], v[132:135], v[208:211]
  ds_read_u16_d16_hi v34, v10 offset:2112
  v_pk_mul_f16 v116, v61, v67 op_sel:[0,1] op_sel_hi:[0,0]
  v_mfma_f32_16x16x32_f16 v[224:227], v[168:171], v[144:147], v[224:227]
  ds_read_u16_d16_hi v35, v10 offset:2114
  v_pk_mul_f16 v117, v61, v72 op_sel:[0,0] op_sel_hi:[1,0]
  v_mfma_f32_16x16x32_f16 v[240:243], v[168:171], v[156:159], v[240:243]
  s_waitcnt lgkmcnt(7)
  v_pk_mul_f16 v118, v62, v69 op_sel:[0,0] op_sel_hi:[0,1]
  v_mfma_f32_16x16x32_f16 v[232:235], v[172:175], v[156:159], v[232:235]
  ds_read_b128 v[168:171], v1 offset:21504
  v_pk_mul_f16 v119, v62, v69 op_sel:[1,0] op_sel_hi:[1,1]
  v_mfma_f32_16x16x32_f16 v[216:219], v[172:175], v[144:147], v[216:219]
  ds_read_b64_tr_b16 v[60:61], v27 offset:0
  v_pk_mul_f16 v128, v75, v81 op_sel:[0,1] op_sel_hi:[0,0]
  v_mfma_f32_16x16x32_f16 v[200:203], v[172:175], v[132:135], v[200:203]
  ds_read_u16_d16_hi v36, v10 offset:128
  v_pk_mul_f16 v129, v75, v86 op_sel:[0,0] op_sel_hi:[1,0]
  v_mfma_f32_16x16x32_f16 v[184:187], v[172:175], v[120:123], v[184:187]
  s_waitcnt lgkmcnt(9)
  v_pk_mul_f16 v130, v76, v83 op_sel:[0,0] op_sel_hi:[0,1]
  v_pk_mul_f16 v131, v76, v83 op_sel:[1,0] op_sel_hi:[1,1]
  v_mfma_f32_16x16x32_f16 v[188:191], v[176:179], v[120:123], v[188:191]
  ds_read_b128 v[172:175], v1 offset:22528
  v_pk_mul_f16 v140, v89, v95 op_sel:[0,1] op_sel_hi:[0,0]
  v_mfma_f32_16x16x32_f16 v[204:207], v[176:179], v[132:135], v[204:207]
  ds_read_b64_tr_b16 v[74:75], v27 offset:32
  v_pk_mul_f16 v141, v89, v100 op_sel:[0,0] op_sel_hi:[1,0]
  v_mfma_f32_16x16x32_f16 v[220:223], v[176:179], v[144:147], v[220:223]
  ds_read_b64_tr_b16 v[88:89], v27 offset:64
  v_pk_mul_f16 v142, v90, v97 op_sel:[0,0] op_sel_hi:[0,1]
  v_mfma_f32_16x16x32_f16 v[236:239], v[176:179], v[156:159], v[236:239]
  s_waitcnt lgkmcnt(11)
  v_pk_mul_f16 v143, v90, v97 op_sel:[1,0] op_sel_hi:[1,1]
  v_pk_mul_f16 v152, v103, v109 op_sel:[0,1] op_sel_hi:[0,0]
  v_smfmac_f32_16x16x64_f16 v[196:199], v[180:183], v[120:127], v9
  ds_read_b128 v[176:179], v1 offset:26624
  v_pk_mul_f16 v153, v103, v114 op_sel:[0,0] op_sel_hi:[1,0]
  v_smfmac_f32_16x16x64_f16 v[212:215], v[180:183], v[132:139], v9
  ds_read_b64_tr_b16 v[102:103], v27 offset:96
  v_pk_mul_f16 v154, v104, v111 op_sel:[0,0] op_sel_hi:[0,1]
  v_smfmac_f32_16x16x64_f16 v[228:231], v[180:183], v[144:151], v9
  ds_read_u16_d16_hi v37, v10 offset:130
  v_pk_mul_f16 v155, v104, v111 op_sel:[1,0] op_sel_hi:[1,1]
  v_smfmac_f32_16x16x64_f16 v[244:247], v[180:183], v[156:163], v9
  s_waitcnt lgkmcnt(11)
  v_pk_mul_f16 v120, v62, v70 op_sel:[0,0] op_sel_hi:[0,1]
  v_mfma_f32_16x16x32_f16 v[192:195], v[164:167], v[116:119], v[192:195]
  ds_read_b128 v[180:183], v1 offset:24576
  v_pk_mul_f16 v121, v62, v70 op_sel:[1,0] op_sel_hi:[1,1]
  v_mfma_f32_16x16x32_f16 v[208:211], v[164:167], v[128:131], v[208:211]
  ds_read_u16_d16_hi v38, v10 offset:2240
  v_pk_mul_f16 v122, v62, v71 op_sel:[0,0] op_sel_hi:[0,1]
  v_mfma_f32_16x16x32_f16 v[224:227], v[164:167], v[140:143], v[224:227]
  ds_read_u16_d16_hi v39, v10 offset:2242
  v_pk_mul_f16 v123, v62, v71 op_sel:[1,0] op_sel_hi:[1,1]
  v_mfma_f32_16x16x32_f16 v[240:243], v[164:167], v[152:155], v[240:243]
  s_waitcnt lgkmcnt(11)
  v_pk_mul_f16 v132, v76, v84 op_sel:[0,0] op_sel_hi:[0,1]
  v_max3_f32 v58, |v32|, |v33|, 0
  v_mfma_f32_16x16x32_f16 v[232:235], v[168:171], v[152:155], v[232:235]
  ds_read_b128 v[164:167], v1 offset:25600
  v_pk_mul_f16 v133, v76, v84 op_sel:[1,0] op_sel_hi:[1,1]
  v_mfma_f32_16x16x32_f16 v[216:219], v[168:171], v[140:143], v[216:219]
  ds_read_u16_d16_hi v40, v10 offset:256
  v_pk_mul_f16 v134, v76, v85 op_sel:[0,0] op_sel_hi:[0,1]
  v_mfma_f32_16x16x32_f16 v[200:203], v[168:171], v[128:131], v[200:203]
  ds_read_u16_d16_hi v41, v10 offset:258
  v_pk_mul_f16 v135, v76, v85 op_sel:[1,0] op_sel_hi:[1,1]
  v_mfma_f32_16x16x32_f16 v[184:187], v[168:171], v[116:119], v[184:187]
  s_waitcnt lgkmcnt(11)
  v_pk_mul_f16 v144, v90, v98 op_sel:[0,0] op_sel_hi:[0,1]
  v_max3_f32 v58, |v34|, |v35|, v58
  v_mfma_f32_16x16x32_f16 v[188:191], v[172:175], v[116:119], v[188:191]
  ds_read_b128 v[168:171], v1 offset:2048
  v_pk_mul_f16 v145, v90, v98 op_sel:[1,0] op_sel_hi:[1,1]
  v_mfma_f32_16x16x32_f16 v[204:207], v[172:175], v[128:131], v[204:207]
  ds_read_u16_d16_hi v42, v10 offset:2368
  v_pk_mul_f16 v146, v90, v99 op_sel:[0,0] op_sel_hi:[0,1]
  v_mfma_f32_16x16x32_f16 v[220:223], v[172:175], v[140:143], v[220:223]
  ds_read_u16_d16_hi v43, v10 offset:2370
  v_pk_mul_f16 v147, v90, v99 op_sel:[1,0] op_sel_hi:[1,1]
  v_mfma_f32_16x16x32_f16 v[236:239], v[172:175], v[152:155], v[236:239]
  s_waitcnt lgkmcnt(11)
  v_pk_mul_f16 v156, v104, v112 op_sel:[0,0] op_sel_hi:[0,1]
  v_mfma_f32_16x16x32_f16 v[192:195], v[176:179], v[120:123], v[192:195]
  ds_read_b128 v[172:175], v1 offset:29696
  v_pk_mul_f16 v157, v104, v112 op_sel:[1,0] op_sel_hi:[1,1]
  v_mfma_f32_16x16x32_f16 v[208:211], v[176:179], v[132:135], v[208:211]
  ds_read_u16_d16_hi v44, v10 offset:384
  v_pk_mul_f16 v158, v104, v113 op_sel:[0,0] op_sel_hi:[0,1]
  v_mfma_f32_16x16x32_f16 v[224:227], v[176:179], v[144:147], v[224:227]
  ds_read_u16_d16_hi v45, v10 offset:386
  v_pk_mul_f16 v159, v104, v113 op_sel:[1,0] op_sel_hi:[1,1]
  s_nop 1
  v_mfma_f32_16x16x32_f16 v[240:243], v[176:179], v[156:159], v[240:243]
  s_waitcnt lgkmcnt(11)
  v_pk_mul_f16 v124, v62, v68 op_sel:[0,1] op_sel_hi:[0,0]
  v_mfma_f32_16x16x32_f16 v[232:235], v[180:183], v[156:159], v[232:235]
  ds_read_b128 v[176:179], v1 offset:27648
  v_pk_mul_f16 v125, v62, v72 op_sel:[0,0] op_sel_hi:[1,0]
  v_mfma_f32_16x16x32_f16 v[216:219], v[180:183], v[144:147], v[216:219]
  ds_read_u16_d16_hi v46, v10 offset:2496
  v_pk_mul_f16 v126, v63, v70 op_sel:[0,0] op_sel_hi:[0,1]
  v_mfma_f32_16x16x32_f16 v[200:203], v[180:183], v[132:135], v[200:203]
  ds_read_u16_d16_hi v47, v10 offset:2498
  v_pk_mul_f16 v127, v63, v70 op_sel:[1,0] op_sel_hi:[1,1]
  v_mfma_f32_16x16x32_f16 v[184:187], v[180:183], v[120:123], v[184:187]
  s_waitcnt lgkmcnt(11)
  v_pk_mul_f16 v136, v76, v82 op_sel:[0,1] op_sel_hi:[0,0]
  v_pk_mul_f16 v137, v76, v86 op_sel:[0,0] op_sel_hi:[1,0]
  v_mfma_f32_16x16x32_f16 v[188:191], v[164:167], v[120:123], v[188:191]
  ds_read_b128 v[180:183], v1 offset:28672
  v_pk_mul_f16 v138, v77, v84 op_sel:[0,0] op_sel_hi:[0,1]
  v_mfma_f32_16x16x32_f16 v[204:207], v[164:167], v[132:135], v[204:207]
  ds_read_u16_d16_hi v48, v10 offset:512
  v_pk_mul_f16 v139, v77, v84 op_sel:[1,0] op_sel_hi:[1,1]
  v_mfma_f32_16x16x32_f16 v[220:223], v[164:167], v[144:147], v[220:223]
  ds_read_u16_d16_hi v49, v10 offset:514
  v_pk_mul_f16 v148, v90, v96 op_sel:[0,1] op_sel_hi:[0,0]
  v_mfma_f32_16x16x32_f16 v[236:239], v[164:167], v[156:159], v[236:239]
  s_waitcnt lgkmcnt(11)
  v_pk_mul_f16 v149, v90, v100 op_sel:[0,0] op_sel_hi:[1,0]
  v_pk_mul_f16 v150, v91, v98 op_sel:[0,0] op_sel_hi:[0,1]
  v_smfmac_f32_16x16x64_f16 v[196:199], v[168:171], v[116:123], v9
  ds_read_b128 v[164:167], v1 offset:32768
  v_pk_mul_f16 v151, v91, v98 op_sel:[1,0] op_sel_hi:[1,1]
  v_smfmac_f32_16x16x64_f16 v[212:215], v[168:171], v[128:135], v9
  ds_read_u16_d16_hi v50, v10 offset:2624
  v_pk_mul_f16 v160, v104, v110 op_sel:[0,1] op_sel_hi:[0,0]
  v_smfmac_f32_16x16x64_f16 v[228:231], v[168:171], v[140:147], v9
  ds_read_u16_d16_hi v51, v10 offset:2626
  v_pk_mul_f16 v161, v104, v114 op_sel:[0,0] op_sel_hi:[1,0]
  v_smfmac_f32_16x16x64_f16 v[244:247], v[168:171], v[152:159], v9
  s_waitcnt lgkmcnt(11)
  v_pk_mul_f16 v162, v105, v112 op_sel:[0,0] op_sel_hi:[0,1]
  v_mfma_f32_16x16x32_f16 v[192:195], v[172:175], v[124:127], v[192:195]
  ds_read_b128 v[168:171], v1 offset:30720
  v_pk_mul_f16 v163, v105, v112 op_sel:[1,0] op_sel_hi:[1,1]
  v_mfma_f32_16x16x32_f16 v[208:211], v[172:175], v[136:139], v[208:211]
  ds_read_u16_d16_hi v52, v10 offset:640
  v_pk_mul_f16 v120, v63, v71 op_sel:[0,0] op_sel_hi:[0,1]
  v_mfma_f32_16x16x32_f16 v[224:227], v[172:175], v[148:151], v[224:227]
  ds_read_u16_d16_hi v53, v10 offset:642
  v_pk_mul_f16 v121, v63, v71 op_sel:[1,0] op_sel_hi:[1,1]
  v_mfma_f32_16x16x32_f16 v[240:243], v[172:175], v[160:163], v[240:243]
  s_waitcnt lgkmcnt(11)
  v_pk_mul_f16 v122, v63, v69 op_sel:[0,1] op_sel_hi:[1,1]
  v_pk_mul_f16 v123, v63, v72 op_sel:[0,0] op_sel_hi:[1,0]
  v_mfma_f32_16x16x32_f16 v[232:235], v[176:179], v[160:163], v[232:235]
  ds_read_b128 v[172:175], v1 offset:31744
  v_pk_mul_f16 v132, v77, v85 op_sel:[0,0] op_sel_hi:[0,1]
  v_mfma_f32_16x16x32_f16 v[216:219], v[176:179], v[148:151], v[216:219]
  ds_read_u16_d16_hi v54, v10 offset:2752
  v_pk_mul_f16 v133, v77, v85 op_sel:[1,0] op_sel_hi:[1,1]
  v_mfma_f32_16x16x32_f16 v[200:203], v[176:179], v[136:139], v[200:203]
  ds_read_u16_d16_hi v55, v10 offset:2754
  v_pk_mul_f16 v134, v77, v83 op_sel:[0,1] op_sel_hi:[1,1]
  v_mfma_f32_16x16x32_f16 v[184:187], v[176:179], v[124:127], v[184:187]
  s_waitcnt lgkmcnt(11)
  v_pk_mul_f16 v135, v77, v86 op_sel:[0,0] op_sel_hi:[1,0]
  v_pk_mul_f16 v144, v91, v99 op_sel:[0,0] op_sel_hi:[0,1]
  v_mfma_f32_16x16x32_f16 v[188:191], v[180:183], v[124:127], v[188:191]
  ds_read_b128 v[176:179], v1 offset:3072
  v_pk_mul_f16 v145, v91, v99 op_sel:[1,0] op_sel_hi:[1,1]
  v_mfma_f32_16x16x32_f16 v[204:207], v[180:183], v[136:139], v[204:207]
  ds_read_u16_d16_hi v56, v10 offset:768
  v_pk_mul_f16 v146, v91, v97 op_sel:[0,1] op_sel_hi:[1,1]
  v_mfma_f32_16x16x32_f16 v[220:223], v[180:183], v[148:151], v[220:223]
  ds_read_u16_d16_hi v57, v10 offset:770
  v_pk_mul_f16 v147, v91, v100 op_sel:[0,0] op_sel_hi:[1,0]
  v_mfma_f32_16x16x32_f16 v[236:239], v[180:183], v[160:163], v[236:239]
  s_waitcnt lgkmcnt(11)
  v_pk_mul_f16 v156, v105, v113 op_sel:[0,0] op_sel_hi:[0,1]
  v_max3_f32 v58, |v36|, |v37|, v58
  v_mfma_f32_16x16x32_f16 v[192:195], v[164:167], v[120:123], v[192:195]
  ds_read_b128 v[180:183], v1 offset:35840
  v_pk_mul_f16 v157, v105, v113 op_sel:[1,0] op_sel_hi:[1,1]
  v_mfma_f32_16x16x32_f16 v[208:211], v[164:167], v[132:135], v[208:211]
  v_pk_mul_f16 v158, v105, v111 op_sel:[0,1] op_sel_hi:[1,1]
  v_max3_f32 v58, |v38|, |v39|, v58
  v_mfma_f32_16x16x32_f16 v[224:227], v[164:167], v[144:147], v[224:227]
  v_pk_mul_f16 v159, v105, v114 op_sel:[0,0] op_sel_hi:[1,0]
  v_max3_f32 v58, |v40|, |v41|, v58
  s_nop 0
  v_mfma_f32_16x16x32_f16 v[240:243], v[164:167], v[156:159], v[240:243]
  s_waitcnt lgkmcnt(9)
  v_pk_mul_f16 v116, v64, v71 op_sel:[0,0] op_sel_hi:[0,1]
  v_mfma_f32_16x16x32_f16 v[232:235], v[168:171], v[156:159], v[232:235]
  ds_read_b128 v[164:167], v1 offset:33792
  v_pk_mul_f16 v117, v64, v71 op_sel:[1,0] op_sel_hi:[1,1]
  v_mfma_f32_16x16x32_f16 v[216:219], v[168:171], v[144:147], v[216:219]
  v_pk_mul_f16 v118, v64, v70 op_sel:[0,1] op_sel_hi:[1,1]
  v_max3_f32 v58, |v42|, |v43|, v58
  v_mfma_f32_16x16x32_f16 v[200:203], v[168:171], v[132:135], v[200:203]
  v_pk_mul_f16 v119, v64, v72 op_sel:[0,0] op_sel_hi:[1,0]
  v_pk_mul_f16 v128, v78, v85 op_sel:[0,0] op_sel_hi:[0,1]
  v_mfma_f32_16x16x32_f16 v[184:187], v[168:171], v[120:123], v[184:187]
  s_waitcnt lgkmcnt(7)
  v_pk_mul_f16 v129, v78, v85 op_sel:[1,0] op_sel_hi:[1,1]
  v_pk_mul_f16 v130, v78, v84 op_sel:[0,1] op_sel_hi:[1,1]
  v_mfma_f32_16x16x32_f16 v[188:191], v[172:175], v[120:123], v[188:191]
  ds_read_b128 v[168:171], v1 offset:34816
  v_pk_mul_f16 v131, v78, v86 op_sel:[0,0] op_sel_hi:[1,0]
  v_mfma_f32_16x16x32_f16 v[204:207], v[172:175], v[132:135], v[204:207]
  v_pk_mul_f16 v140, v92, v99 op_sel:[0,0] op_sel_hi:[0,1]
  v_pk_mul_f16 v141, v92, v99 op_sel:[1,0] op_sel_hi:[1,1]
  v_mfma_f32_16x16x32_f16 v[220:223], v[172:175], v[144:147], v[220:223]
  v_pk_mul_f16 v142, v92, v98 op_sel:[0,1] op_sel_hi:[1,1]
  v_pk_mul_f16 v143, v92, v100 op_sel:[0,0] op_sel_hi:[1,0]
  v_mfma_f32_16x16x32_f16 v[236:239], v[172:175], v[156:159], v[236:239]
  s_waitcnt lgkmcnt(5)
  v_pk_mul_f16 v152, v106, v113 op_sel:[0,0] op_sel_hi:[0,1]
  v_smfmac_f32_16x16x64_f16 v[196:199], v[176:179], v[120:127], v9
  ds_read_b128 v[172:175], v1 offset:38912
  v_pk_mul_f16 v153, v106, v113 op_sel:[1,0] op_sel_hi:[1,1]
  v_smfmac_f32_16x16x64_f16 v[212:215], v[176:179], v[132:139], v9
  v_pk_mul_f16 v154, v106, v112 op_sel:[0,1] op_sel_hi:[1,1]
  v_smfmac_f32_16x16x64_f16 v[228:231], v[176:179], v[144:151], v9
  v_pk_mul_f16 v155, v106, v114 op_sel:[0,0] op_sel_hi:[1,0]
  v_smfmac_f32_16x16x64_f16 v[244:247], v[176:179], v[156:163], v9
  s_waitcnt lgkmcnt(3)
  v_pk_mul_f16 v120, v65, v71 op_sel:[0,1] op_sel_hi:[1,1]
  v_mfma_f32_16x16x32_f16 v[192:195], v[180:183], v[116:119], v[192:195]
  ds_read_b128 v[176:179], v1 offset:36864
  v_pk_mul_f16 v121, v65, v72 op_sel:[0,0] op_sel_hi:[1,0]
  v_mfma_f32_16x16x32_f16 v[208:211], v[180:183], v[128:131], v[208:211]
  v_pk_mul_f16 v122, v72, v72 op_sel:[0,0] op_sel_hi:[1,1]
  v_max3_f32 v58, |v44|, |v45|, v58
  v_mfma_f32_16x16x32_f16 v[224:227], v[180:183], v[140:143], v[224:227]
  v_pk_mul_f16 v123, v60, v61 op_sel:[0,0] op_sel_hi:[1,1]
  v_max3_f32 v58, |v46|, |v47|, v58
  v_mfma_f32_16x16x32_f16 v[240:243], v[180:183], v[152:155], v[240:243]
  s_waitcnt lgkmcnt(3)
  v_pk_mul_f16 v132, v79, v85 op_sel:[0,1] op_sel_hi:[1,1]
  v_mfma_f32_16x16x32_f16 v[232:235], v[164:167], v[152:155], v[232:235]
  ds_read_b128 v[180:183], v1 offset:37888
  v_pk_mul_f16 v133, v79, v86 op_sel:[0,0] op_sel_hi:[1,0]
  v_mfma_f32_16x16x32_f16 v[216:219], v[164:167], v[140:143], v[216:219]
  v_pk_mul_f16 v134, v86, v86 op_sel:[0,0] op_sel_hi:[1,1]
  v_max3_f32 v58, |v48|, |v49|, v58
  v_mfma_f32_16x16x32_f16 v[200:203], v[164:167], v[128:131], v[200:203]
  v_pk_mul_f16 v135, v74, v75 op_sel:[0,0] op_sel_hi:[1,1]
  v_max3_f32 v58, |v50|, |v51|, v58
  v_mfma_f32_16x16x32_f16 v[184:187], v[164:167], v[116:119], v[184:187]
  s_waitcnt lgkmcnt(3)
  v_pk_mul_f16 v144, v93, v99 op_sel:[0,1] op_sel_hi:[1,1]
  v_mfma_f32_16x16x32_f16 v[188:191], v[168:171], v[116:119], v[188:191]
  ds_read_b128 v[164:167], v1 offset:4096
  v_pk_mul_f16 v145, v93, v100 op_sel:[0,0] op_sel_hi:[1,0]
  v_mfma_f32_16x16x32_f16 v[204:207], v[168:171], v[128:131], v[204:207]
  v_pk_mul_f16 v146, v100, v100 op_sel:[0,0] op_sel_hi:[1,1]
  v_max3_f32 v58, |v52|, |v53|, v58
  v_mfma_f32_16x16x32_f16 v[220:223], v[168:171], v[140:143], v[220:223]
  v_pk_mul_f16 v147, v88, v89 op_sel:[0,0] op_sel_hi:[1,1]
  v_max3_f32 v58, |v54|, |v55|, v58
  v_mfma_f32_16x16x32_f16 v[236:239], v[168:171], v[152:155], v[236:239]
  s_waitcnt lgkmcnt(3)
  v_pk_mul_f16 v156, v107, v113 op_sel:[0,1] op_sel_hi:[1,1]
  v_mfma_f32_16x16x32_f16 v[192:195], v[172:175], v[120:123], v[192:195]
  v_pk_mul_f16 v157, v107, v114 op_sel:[0,0] op_sel_hi:[1,0]
  v_max3_f32 v58, |v56|, |v57|, v58
  v_mfma_f32_16x16x32_f16 v[208:211], v[172:175], v[132:135], v[208:211]
  v_pk_mul_f16 v158, v114, v114 op_sel:[0,0] op_sel_hi:[1,1]
  v_cvt_pk_f16_f32 v62, v32, v33
  v_mfma_f32_16x16x32_f16 v[224:227], v[172:175], v[144:147], v[224:227]
  v_pk_mul_f16 v159, v102, v103 op_sel:[0,0] op_sel_hi:[1,1]
  s_nop 1
  v_mfma_f32_16x16x32_f16 v[240:243], v[172:175], v[156:159], v[240:243]
  s_waitcnt lgkmcnt(2)
  v_cvt_pk_f16_f32 v76, v34, v35
  v_cvt_pk_f16_f32 v90, v36, v37
  v_mfma_f32_16x16x32_f16 v[232:235], v[176:179], v[156:159], v[232:235]
  ds_write_b32 v11, v62 offset:0
  v_mfma_f32_16x16x32_f16 v[216:219], v[176:179], v[144:147], v[216:219]
  ds_write_b32 v11, v76 offset:160
  v_mfma_f32_16x16x32_f16 v[200:203], v[176:179], v[132:135], v[200:203]
  ds_write_b32 v11, v90 offset:320
  v_mfma_f32_16x16x32_f16 v[184:187], v[176:179], v[120:123], v[184:187]
  s_waitcnt lgkmcnt(4)
  v_cvt_pk_f16_f32 v104, v38, v39
  v_cvt_pk_f16_f32 v63, v40, v41
  v_mfma_f32_16x16x32_f16 v[188:191], v[180:183], v[120:123], v[188:191]
  ds_write_b32 v11, v104 offset:480
  v_mfma_f32_16x16x32_f16 v[204:207], v[180:183], v[132:135], v[204:207]
  ds_write_b32 v11, v63 offset:640
  v_mfma_f32_16x16x32_f16 v[220:223], v[180:183], v[144:147], v[220:223]
  v_cvt_pk_f16_f32 v77, v42, v43
  v_cvt_pk_f16_f32 v91, v44, v45
  v_mfma_f32_16x16x32_f16 v[236:239], v[180:183], v[156:159], v[236:239]
  s_waitcnt lgkmcnt(5)
  v_cvt_pk_f16_f32 v105, v46, v47
  v_cvt_pk_f16_f32 v66, v48, v49
  v_smfmac_f32_16x16x64_f16 v[196:199], v[164:167], v[116:123], v9
  ds_write_b32 v11, v77 offset:800
  v_smfmac_f32_16x16x64_f16 v[212:215], v[164:167], v[128:135], v9
  ds_write_b32 v11, v91 offset:960
  v_smfmac_f32_16x16x64_f16 v[228:231], v[164:167], v[140:147], v9
  ds_write_b32 v11, v105 offset:1120
  v_smfmac_f32_16x16x64_f16 v[244:247], v[164:167], v[152:159], v9
  ds_write_b32 v11, v66 offset:1280
  s_setprio 0
  s_sub_u32 s72, s72, 1
  s_cmp_eq_u32 s72, 0
  s_cbranch_scc1 L_cin_done
  v_cvt_pk_f16_f32 v80, v50, v51
  v_cvt_pk_f16_f32 v94, v52, v53
  v_cvt_pk_f16_f32 v108, v54, v55
  v_cvt_pk_f16_f32 v67, v56, v57
  ds_write_b32 v11, v80 offset:1440
  ds_write_b32 v11, v94 offset:1600
  ds_write_b32 v11, v108 offset:1760
  ds_write_b32 v11, v67 offset:1920
  s_branch L_cin_loop
L_cslow:
  v_max_f32_dpp v58, v58, v58 row_shr:1 row_mask:0xf bank_mask:0xf
  s_nop 1
  v_max_f32_dpp v58, v58, v58 row_shr:2 row_mask:0xf bank_mask:0xf
  s_nop 1
  v_max_f32_dpp v58, v58, v58 row_shr:4 row_mask:0xf bank_mask:0xf
  s_nop 1
  v_max_f32_dpp v58, v58, v58 row_shr:8 row_mask:0xf bank_mask:0xf
  s_nop 1
  v_max_f32_dpp v58, v58, v58 row_bcast:15 row_mask:0xa bank_mask:0xf
  s_nop 1
  v_max_f32_dpp v58, v58, v58 row_bcast:31 row_mask:0xc bank_mask:0xf
  s_nop 0
  v_readlane_b32 s98, v58, 63
  s_mov_b32 s97, 0
  s_lshr_b32 s98, s98, 23
  s_min_u32 s98, s98, 182
  s_lshr_b32 s99, s1, 23
  s_sub_u32 s99, s99, 47
  s_lshr_b32 s99, s99, 1
  s_min_u32 s99, s99, 59
  s_sub_u32 s99, 131, s99
  s_max_u32 s98, s98, s99
  s_sub_u32 s99, 258, s98
  s_lshl_b32 s100, s99, 1
  s_sub_u32 s100, s100, 127
  s_sub_u32 s95, 254, s100
  s_lshl_b32 s95, s95, 23
  v_mov_b32 v60, s95
  v_mul_f32 v61, s0, v60
  v_mul_f32 v60, s1, v60
  v_readfirstlane_b32 s74, v61
  v_readfirstlane_b32 s75, v60
  s_lshl_b32 s99, s99, 23
  s_lshl_b32 s100, s100, 23
  v_mul_f32 v60, s99, v32
  v_mul_f32 v61, s99, v33
  v_mul_f32 v62, s100, v32
  v_mul_f32 v63, s100, v33
  v_cvt_pk_f16_f32 v80, v60, v61
  v_cvt_pk_bf16_f32 v64, v62, v63
  ds_write_b32 v11, v80 offset:0
  ds_write_b32 v10, v64 offset:0
  v_mul_f32 v60, s99, v34
  v_mul_f32 v61, s99, v35
  v_mul_f32 v62, s100, v34
  v_mul_f32_e64 v63, s100, v35
  v_cvt_pk_f16_f32 v81, v60, v61
  v_cvt_pk_bf16_f32 v65, v62, v63
  ds_write_b32 v11, v81 offset:160
  ds_write_b32 v10, v65 offset:2112
  v_mul_f32 v60, s99, v36
  v_mul_f32 v61, s99, v37
  v_mul_f32 v62, s100, v36
  v_mul_f32 v63, s100, v37
  v_cvt_pk_f16_f32 v82, v60, v61
  v_cvt_pk_bf16_f32 v66, v62, v63
  ds_write_b32 v11, v82 offset:320
  ds_write_b32 v10, v66 offset:128
  v_mul_f32 v60, s99, v38
  v_mul_f32 v61, s99, v39
  v_mul_f32 v62, s100, v38
  v_mul_f32 v63, s100, v39
  v_cvt_pk_f16_f32 v83, v60, v61
  v_cvt_pk_bf16_f32 v67, v62, v63
  ds_write_b32 v11, v83 offset:480
  ds_write_b32 v10, v67 offset:2240
  v_mul_f32 v60, s99, v40
  v_mul_f32 v61, s99, v41
  v_mul_f32 v62, s100, v40
  v_mul_f32 v63, s100, v41
  v_cvt_pk_f16_f32 v84, v60, v61
  v_cvt_pk_bf16_f32 v68, v62, v63
  ds_write_b32 v11, v84 offset:640
  ds_write_b32 v10, v68 offset:256
  v_mul_f32 v60, s99, v42
  v_mul_f32 v61, s99, v43
  v_mul_f32 v62, s100, v42
  v_mul_f32 v63, s100, v43
  v_cvt_pk_f16_f32 v85, v60, v61
  v_cvt_pk_bf16_f32 v69, v62, v63
  ds_write_b32 v11, v85 offset:800
  ds_write_b32 v10, v69 offset:2368
  v_mul_f32 v60, s99, v44
  v_mul_f32 v61, s99, v45
  v_mul_f32 v62, s100, v44
  v_mul_f32 v63, s100, v45
  v_cvt_pk_f16_f32 v86, v60, v61
  v_cvt_pk_bf16_f32 v70, v62, v63
  ds_write_b32 v11, v86 offset:960
  ds_write_b32 v10, v70 offset:384
  v_mul_f32 v60, s99, v46
  v_mul_f32 v61, s99, v47
  v_mul_f32 v62, s100, v46
  v_mul_f32 v63, s100, v47
  v_cvt_pk_f16_f32 v87, v60, v61
  v_cvt_pk_bf16_f32 v71, v62, v63
  ds_write_b32 v11, v87 offset:1120
  ds_write_b32 v10, v71 offset:2496
  v_mul_f32 v60, s99, v48
  v_mul_f32 v61, s99, v49
  v_mul_f32 v62, s100, v48
  v_mul_f32 v63, s100, v49
  v_cvt_pk_f16_f32 v88, v60, v61
  v_cvt_pk_bf16_f32 v72, v62, v63
  ds_write_b32 v11, v88 offset:1280
  ds_write_b32 v10, v72 offset:512
  v_mul_f32 v60, s99, v50
  v_mul_f32 v61, s99, v51
  v_mul_f32 v62, s100, v50
  v_mul_f32 v63, s100, v51
  v_cvt_pk_f16_f32 v89, v60, v61
  v_cvt_pk_bf16_f32 v73, v62, v63
  ds_write_b32 v11, v89 offset:1440
  ds_write_b32 v10, v73 offset:2624
  v_mul_f32 v60, s99, v52
  v_mul_f32 v61, s99, v53
  v_mul_f32 v62, s100, v52
  v_mul_f32 v63, s100, v53
  v_cvt_pk_f16_f32 v90, v60, v61
  v_cvt_pk_bf16_f32 v74, v62, v63
  ds_write_b32 v11, v90 offset:1600
  ds_write_b32 v10, v74 offset:640
  v_mul_f32 v60, s99, v54
  v_mul_f32 v61, s99, v55
  v_mul_f32 v62, s100, v54
  v_mul_f32 v63, s100, v55
  v_cvt_pk_f16_f32 v91, v60, v61
  v_cvt_pk_bf16_f32 v75, v62, v63
  ds_write_b32 v11, v91 offset:1760
  ds_write_b32 v10, v75 offset:2752
  v_mul_f32 v60, s99, v56
  v_mul_f32 v61, s99, v57
  v_mul_f32 v62, s100, v56
  v_mul_f32 v63, s100, v57
  v_cvt_pk_f16_f32 v92, v60, v61
  v_cvt_pk_bf16_f32 v76, v62, v63
  ds_write_b32 v11, v92 offset:1920
  ds_write_b32 v10, v76 offset:768
  v_mov_b32 v60, s100
  v_cvt_pk_bf16_f32 v60, v60, v60
  s_mov_b32 exec_hi, 0
  ds_write_b32 v10, v60 offset:2880
  s_mov_b32 exec_hi, -1
  s_waitcnt lgkmcnt(0)
  s_branch L_cconv
L_sdown:
  v_lshlrev_b32 v108, 16, v112
  v_and_b32 v109, 0xffff0000, v112
  v_mul_f32 v108, v108, v250
  v_mul_f32 v109, v109, v250
  v_cvt_pk_bf16_f32 v112, v108, v109
  v_lshlrev_b32 v108, 16, v113
  v_and_b32 v109, 0xffff0000, v113
  v_mul_f32 v108, v108, v250
  v_mul_f32_e64 v109, v109, v250
  v_cvt_pk_bf16_f32 v113, v108, v109
  v_lshlrev_b32 v108, 16, v114
  v_and_b32 v109, 0xffff0000, v114
  v_mul_f32 v108, v108, v250
  v_mul_f32 v109, v109, v250
  v_cvt_pk_bf16_f32 v114, v108, v109
  v_lshlrev_b32 v108, 16, v115
  v_and_b32 v109, 0xffff0000, v115
  v_mul_f32 v108, v108, v250
  v_mul_f32 v109, v109, v250
  v_cvt_pk_bf16_f32 v115, v108, v109
  v_lshlrev_b32 v108, 16, v116
  v_and_b32 v109, 0xffff0000, v116
  v_mul_f32 v108, v108, v250
  v_mul_f32 v109, v109, v250
  v_cvt_pk_bf16_f32 v116, v108, v109
  v_lshlrev_b32 v108, 16, v117
  v_and_b32 v109, 0xffff0000, v117
  v_mul_f32 v108, v108, v250
  v_mul_f32 v109, v109, v250
  v_cvt_pk_bf16_f32 v117, v108, v109
  v_lshlrev_b32_e64 v108, 16, v118
  v_and_b32 v109, 0xffff0000, v118
  v_mul_f32 v108, v108, v250
  v_mul_f32 v109, v109, v250
  v_cvt_pk_bf16_f32 v118, v108, v109
  v_lshlrev_b32 v108, 16, v119
  v_and_b32 v109, 0xffff0000, v119
  v_mul_f32 v108, v108, v250
  v_mul_f32 v109, v109, v250
  v_cvt_pk_bf16_f32 v119, v108, v109
  s_branch L_scaled
L_first:
  ds_read_b64_tr_b16 v[60:61], v20 offset:0
  ds_read_b64_tr_b16 v[74:75], v20 offset:32
  ds_read_b64_tr_b16 v[88:89], v20 offset:64
  ds_read_b64_tr_b16 v[102:103], v20 offset:96
  ds_read_b64_tr_b16 v[66:67], v23 offset:0
  ds_read_b64_tr_b16 v[80:81], v23 offset:32
  ds_read_b64_tr_b16 v[94:95], v23 offset:64
  ds_read_b64_tr_b16 v[108:109], v23 offset:96
  ds_read_b64_tr_b16 v[68:69], v24 offset:0
  ds_read_b64_tr_b16 v[82:83], v24 offset:32
  ds_read_b64_tr_b16 v[96:97], v24 offset:64
  ds_read_b64_tr_b16 v[110:111], v24 offset:96
  ds_read_b64_tr_b16 v[124:125], v4 offset:0
  ds_read_b64_tr_b16 v[126:127], v5 offset:0
  ds_read_b64_tr_b16 v[136:137], v4 offset:32
  ds_read_b64_tr_b16 v[138:139], v5 offset:32
  ds_read_b64_tr_b16 v[148:149], v4 offset:64
  ds_read_b64_tr_b16 v[150:151], v5 offset:64
  ds_read_b64_tr_b16 v[160:161], v4 offset:96
  ds_read_b64_tr_b16 v[162:163], v5 offset:96
  ds_read_b128 v[164:167], v1 offset:39936
  ds_read_b128 v[168:171], v1 offset:40960
  ds_read_b128 v[172:175], v1 offset:8192
  ds_read_b128 v[176:179], v1 offset:6144
  ds_read_b64_tr_b16 v[70:71], v25 offset:0
  ds_read_b64_tr_b16 v[84:85], v25 offset:32
  ds_read_b64_tr_b16 v[98:99], v25 offset:64
  ds_read_b64_tr_b16 v[112:113], v25 offset:96
  ds_read_b64_tr_b16 v[72:73], v26 offset:0
  s_waitcnt lgkmcnt(14)
  v_pk_mul_f16 v120, v60, v67 op_sel:[0,0] op_sel_hi:[0,1]
  v_pk_mul_f16 v121, v60, v67 op_sel:[1,0] op_sel_hi:[1,1]
  ds_read_b64_tr_b16 v[86:87], v26 offset:32
  v_pk_mul_f16 v122, v60, v68 op_sel:[0,0] op_sel_hi:[0,1]
  ds_read_b64_tr_b16 v[100:101], v26 offset:64
  v_pk_mul_f16 v123, v60, v68 op_sel:[1,0] op_sel_hi:[1,1]
  ds_read_b64_tr_b16 v[114:115], v26 offset:96
  v_pk_mul_f16 v132, v74, v81 op_sel:[0,0] op_sel_hi:[0,1]
  v_pk_mul_f16 v133, v74, v81 op_sel:[1,0] op_sel_hi:[1,1]
  ds_read_b64_tr_b16 v[62:63], v21 offset:0
  v_pk_mul_f16 v134, v74, v82 op_sel:[0,0] op_sel_hi:[0,1]
  ds_read_b64_tr_b16 v[76:77], v21 offset:32
  v_pk_mul_f16 v135, v74, v82 op_sel:[1,0] op_sel_hi:[1,1]
  ds_read_b64_tr_b16 v[90:91], v21 offset:64
  v_pk_mul_f16 v144, v88, v95 op_sel:[0,0] op_sel_hi:[0,1]
  v_pk_mul_f16 v145, v88, v95 op_sel:[1,0] op_sel_hi:[1,1]
  ds_read_b64_tr_b16 v[104:105], v21 offset:96
  v_pk_mul_f16 v146, v88, v96 op_sel:[0,0] op_sel_hi:[0,1]
  ds_read_b64_tr_b16 v[64:65], v22 offset:0
  v_pk_mul_f16 v147, v88, v96 op_sel:[1,0] op_sel_hi:[1,1]
  ds_read_b64_tr_b16 v[78:79], v22 offset:32
  v_pk_mul_f16 v156, v102, v109 op_sel:[0,0] op_sel_hi:[0,1]
  v_pk_mul_f16 v157, v102, v109 op_sel:[1,0] op_sel_hi:[1,1]
  ds_read_b64_tr_b16 v[92:93], v22 offset:64
  v_pk_mul_f16 v158, v102, v110 op_sel:[0,0] op_sel_hi:[0,1]
  ds_read_b64_tr_b16 v[106:107], v22 offset:96
  v_pk_mul_f16 v159, v102, v110 op_sel:[1,0] op_sel_hi:[1,1]
  s_branch L_novm
L_cid:
  s_mov_b64 exec, 0x1fff
  v_mov_b32 v20, 1
  v_mov_b32 v21, 0
  v_lshlrev_b32_e64 v22, 8, v0
  s_mov_b64 exec, 1
  buffer_atomic_add v20, v21, s[64:67], 0 offen sc0
  s_mov_b32 s81, 0x60000
  s_waitcnt vmcnt(0)
  v_cmp_ne_u32 vcc, 0, v20
  s_cbranch_vccnz L_cpd
  s_mov_b64 exec, 0x1fff
  buffer_store_dword v21, v22, s[60:63], s81 offen sc1
  s_mov_b64 exec, 1
  v_mov_b32 v20, 1
  s_waitcnt vmcnt(0)
  buffer_store_dword v20, v21, s[64:67], 0 offen offset:128 sc1
L_cpd:
  buffer_load_dword v20, v21, s[64:67], 0 offen offset:128 sc1
  s_waitcnt vmcnt(0)
  v_cmp_eq_u32 vcc, 0, v20
  s_cbranch_vccnz L_cpd
  s_mov_b64 exec, -1
  s_branch L_crd
L_cic:
  s_mov_b64 exec, 0x1fff
  v_mov_b32 v20, 1
  v_mov_b32 v21, 0
  v_lshlrev_b32 v22, 8, v0
  s_mov_b64 exec, 1
  buffer_atomic_add v20, v21, s[64:67], 0 offen sc0
  s_mov_b32 s81, 0x60000
  s_waitcnt vmcnt(0)
  v_cmp_ne_u32 vcc, 0, v20
  s_cbranch_vccnz L_cpc
  s_mov_b64 exec, 0x1fff
  buffer_store_dword v21, v22, s[60:63], s81 offen sc1
  s_mov_b64 exec, 1
  v_mov_b32_e64 v20, 1
  s_waitcnt vmcnt(0)
  buffer_store_dword v20, v21, s[64:67], 0 offen offset:128 sc1
L_cpc:
  buffer_load_dword v20, v21, s[64:67], 0 offen offset:128 sc1
  s_waitcnt vmcnt(0)
  v_cmp_eq_u32 vcc, 0, v20
  s_cbranch_vccnz L_cpc
  s_mov_b64 exec, -1
  s_branch L_crc
L_spare:
  s_cmp_lg_u32 s3, 0
  s_cbranch_scc1 L_end
  s_waitcnt lgkmcnt(0)
  s_mov_b32 s60, s24
  s_and_b32 s61, s25, 0xffff
  s_mov_b32 s62, 268435456
  s_mov_b32 s63, 0x20000
  s_mov_b32 s56, s20
  s_and_b32 s57, s21, 0xffff
  s_mov_b32 s58, 8192
  s_mov_b32 s59, 0x20000
  s_mov_b32 s64, s22
  s_and_b32 s65, s23, 0xffff
  s_mov_b32 s66, 256
  s_mov_b32 s67, 0x20000
  s_mov_b64 exec, 0x1fff
  v_mov_b32 v20, 1
  v_mov_b32 v21, 0
  v_lshlrev_b32 v22, 8, v0
  s_mov_b64 exec, 1
  buffer_atomic_add v20, v21, s[64:67], 0 offen sc0
  s_mov_b32 s81, 0x60000
  s_waitcnt vmcnt(0)
  v_cmp_ne_u32 vcc, 0, v20
  s_cbranch_vccnz L_end
  s_mov_b64 exec, 0x1fff
  buffer_store_dword v21, v22, s[60:63], s81 offen sc1
  s_mov_b64 exec, 1
  v_mov_b32 v20, 1
  s_waitcnt vmcnt(0)
  buffer_store_dword v20, v21, s[64:67], 0 offen offset:128 sc1
L_end:
  s_endpgm
.p2align 8
L_tables:
.long 0x0, 0x1800, 0x6c80, 0x81a0, 0x8, 0x1808, 0x6c88, 0x81a8
.long 0x10, 0x1810, 0x6c90, 0x81b0, 0x18, 0x1818, 0x6c98, 0x81b8
.long 0x40, 0x1d48, 0x71c8, 0x86e8, 0x48, 0x1d50, 0x71d0, 0x86f0
.long 0x50, 0x1d58, 0x71d8, 0x86f8, 0x58, 0x1d60, 0x71e0, 0x8700
.long 0x80, 0x2290, 0x7710, 0x8c30, 0x88, 0x2298, 0x7718, 0x8c38
.long 0x90, 0x22a0, 0x7720, 0x8c40, 0x98, 0x22a8, 0x7728, 0x8c48
.long 0xc0, 0x27d8, 0x7c58, 0x9178, 0xc8, 0x27e0, 0x7c60, 0x9180
.long 0xd0, 0x27e8, 0x7c68, 0x9188, 0xd8, 0x27f0, 0x7c70, 0x9190
.long 0x20, 0x1820, 0x6ca0, 0x81c0, 0x28, 0x1828, 0x6ca8, 0x81c8
.long 0x30, 0x1830, 0x6cb0, 0x81d0, 0x38, 0x1838, 0x6cb8, 0x81d8
.long 0x60, 0x1d68, 0x71e8, 0x8708, 0x68, 0x1d70, 0x71f0, 0x8710
.long 0x70, 0x1d78, 0x71f8, 0x8718, 0x78, 0x1d80, 0x7200, 0x8720
.long 0xa0, 0x22b0, 0x7730, 0x8c50, 0xa8, 0x22b8, 0x7738, 0x8c58
.long 0xb0, 0x22c0, 0x7740, 0x8c60, 0xb8, 0x22c8, 0x7748, 0x8c68
.long 0xe0, 0x27f8, 0x7c78, 0x9198, 0xe8, 0x2800, 0x7c80, 0x91a0
.long 0xf0, 0x2808, 0x7c88, 0x91a8, 0xf8, 0x2810, 0x7c90, 0x91b0
.long 0x200, 0x4240, 0x96c0, 0x9c08, 0x208, 0x4248, 0x96c8, 0x9c10
.long 0x210, 0x4250, 0x96d0, 0x9c18, 0x218, 0x4258, 0x96d8, 0x9c20
.long 0x240, 0x4788, 0x9c08, 0x9c08, 0x248, 0x4790, 0x9c10, 0x9c10
.long 0x250, 0x4798, 0x9c18, 0x9c18, 0x258, 0x47a0, 0x9c20, 0x9c20
.long 0x280, 0x4cd0, 0x9c08, 0x9c08, 0x288, 0x4cd8, 0x9c10, 0x9c10
.long 0x290, 0x4ce0, 0x9c18, 0x9c18, 0x298, 0x4ce8, 0x9c20, 0x9c20
.long 0x2c0, 0x5218, 0x9c08, 0x9c08, 0x2c8, 0x5220, 0x9c10, 0x9c10
.long 0x2d0, 0x5228, 0x9c18, 0x9c18, 0x2d8, 0x5230, 0x9c20, 0x9c20
.long 0x220, 0x4260, 0x96e0, 0x9c28, 0x228, 0x4268, 0x96e8, 0x9c30
.long 0x230, 0x4270, 0x96f0, 0x9c38, 0x238, 0x4278, 0x96f8, 0x9c40
.long 0x260, 0x47a8, 0x9c28, 0x9c28, 0x268, 0x47b0, 0x9c30, 0x9c30
.long 0x270, 0x47b8, 0x9c38, 0x9c38, 0x278, 0x47c0, 0x9c40, 0x9c40
.long 0x2a0, 0x4cf0, 0x9c28, 0x9c28, 0x2a8, 0x4cf8, 0x9c30, 0x9c30
.long 0x2b0, 0x4d00, 0x9c38, 0x9c38, 0x2b8, 0x4d08, 0x9c40, 0x9c40
.long 0x2e0, 0x5238, 0x9c28, 0x9c28, 0x2e8, 0x5240, 0x9c30, 0x9c30
.long 0x2f0, 0x5248, 0x9c38, 0x9c38, 0x2f8, 0x5250, 0x9c40, 0x9c40
.long 0xaae0, 0xa680, 0xa900, 0xaae0, 0xaae8, 0xa688, 0xa908, 0xaae8
.long 0xaaf0, 0xa690, 0xa910, 0xaaf0, 0xaaf8, 0xa698, 0xa918, 0xaaf8
.long 0xaa40, 0xa860, 0xa9a0, 0xaa40, 0xaa48, 0xa868, 0xa9a8, 0xaa48
.long 0xaa50, 0xa870, 0xa9b0, 0xaa50, 0xaa58, 0xa878, 0xa9b8, 0xaa58
.long 0xa400, 0xa7c0, 0xa540, 0xa400, 0xa408, 0xa7c8, 0xa548, 0xa408
.long 0xa410, 0xa7d0, 0xa550, 0xa410, 0xa418, 0xa7d8, 0xa558, 0xa418
.long 0xa4a0, 0xa720, 0xa5e0, 0xa4a0, 0xa4a8, 0xa728, 0xa5e8, 0xa4a8
.long 0xa4b0, 0xa730, 0xa5f0, 0xa4b0, 0xa4b8, 0xa738, 0xa5f8, 0xa4b8
.long 0xb260, 0xb4e0, 0xb6c0, 0xb260, 0xb268, 0xb4e8, 0xb6c8, 0xb268
.long 0xb270, 0xb4f0, 0xb6d0, 0xb270, 0xb278, 0xb4f8, 0xb6d8, 0xb278
.long 0xb1c0, 0xb300, 0xb760, 0xb1c0, 0xb1c8, 0xb308, 0xb768, 0xb1c8
.long 0xb1d0, 0xb310, 0xb770, 0xb1d0, 0xb1d8, 0xb318, 0xb778, 0xb1d8
.long 0xb580, 0xb440, 0xb080, 0xb580, 0xb588, 0xb448, 0xb088, 0xb588
.long 0xb590, 0xb450, 0xb090, 0xb590, 0xb598, 0xb458, 0xb098, 0xb598
.long 0xb620, 0xb3a0, 0xb120, 0xb620, 0xb628, 0xb3a8, 0xb128, 0xb628
.long 0xb630, 0xb3b0, 0xb130, 0xb630, 0xb638, 0xb3b8, 0xb138, 0xb638
.long 0xa900, 0xa400, 0xaae0, 0xb620, 0xa908, 0xa408, 0xaae8, 0xb628
.long 0xa910, 0xa410, 0xaaf0, 0xb630, 0xa918, 0xa418, 0xaaf8, 0xb638
.long 0xa9a0, 0xa4a0, 0xab80, 0xb800, 0xa9a8, 0xa4a8, 0xab88, 0xb808
.long 0xa9b0, 0xa4b0, 0xab90, 0xb810, 0xa9b8, 0xa4b8, 0xab98, 0xb818
.long 0xaa40, 0xa680, 0xa860, 0xb3a0, 0xaa48, 0xa688, 0xa868, 0xb3a8
.long 0xaa50, 0xa690, 0xa870, 0xb3b0, 0xaa58, 0xa698, 0xa878, 0xb3b8
.long 0xa720, 0xa540, 0xa7c0, 0xb1c0, 0xa728, 0xa548, 0xa7c8, 0xb1c8
.long 0xa730, 0xa550, 0xa7d0, 0xb1d0, 0xa738, 0xa558, 0xa7d8, 0xb1d8
.long 0xa5e0, 0xaae0, 0xa400, 0xb080, 0xa5e8, 0xaae8, 0xa408, 0xb088
.long 0xa5f0, 0xaaf0, 0xa410, 0xb090, 0xa5f8, 0xaaf8, 0xa418, 0xb098
.long 0xa7c0, 0xa540, 0xa720, 0xb760, 0xa7c8, 0xa548, 0xa728, 0xb768
.long 0xa7d0, 0xa550, 0xa730, 0xb770, 0xa7d8, 0xa558, 0xa738, 0xb778
.long 0xa860, 0xa680, 0xaa40, 0xb440, 0xa868, 0xa688, 0xaa48, 0xb448
.long 0xa870, 0xa690, 0xaa50, 0xb450, 0xa878, 0xa698, 0xaa58, 0xb458
.long 0xab80, 0xa4a0, 0xa9a0, 0xb4e0, 0xab88, 0xa4a8, 0xa9a8, 0xb4e8
.long 0xab90, 0xa4b0, 0xa9b0, 0xb4f0, 0xab98, 0xa4b8, 0xa9b8, 0xb4f8
.long 0xa680, 0xa900, 0xab80, 0xa4a0, 0xa688, 0xa908, 0xab88, 0xa4a8
.long 0xa690, 0xa910, 0xab90, 0xa4b0, 0xa698, 0xa918, 0xab98, 0xa4b8
.long 0xa860, 0xa9a0, 0xb1c0, 0xb440, 0xa868, 0xa9a8, 0xb1c8, 0xb448
.long 0xa870, 0xa9b0, 0xb1d0, 0xb450, 0xa878, 0xa9b8, 0xb1d8, 0xb458
.long 0xa7c0, 0xa540, 0xab80, 0xa4a0, 0xa7c8, 0xa548, 0xab88, 0xa4a8
.long 0xa7d0, 0xa550, 0xab90, 0xa4b0, 0xa7d8, 0xa558, 0xab98, 0xa4b8
.long 0xa720, 0xa5e0, 0xb1c0, 0xb440, 0xa728, 0xa5e8, 0xb1c8, 0xb448
.long 0xa730, 0xa5f0, 0xb1d0, 0xb450, 0xa738, 0xa5f8, 0xb1d8, 0xb458
.long 0xb4e0, 0xb6c0, 0xb800, 0xa860, 0xb4e8, 0xb6c8, 0xb808, 0xa868
.long 0xb4f0, 0xb6d0, 0xb810, 0xa870, 0xb4f8, 0xb6d8, 0xb818, 0xa878
.long 0xb300, 0xb760, 0xa540, 0xa900, 0xb308, 0xb768, 0xa548, 0xa908
.long 0xb310, 0xb770, 0xa550, 0xa910, 0xb318, 0xb778, 0xa558, 0xa918
.long 0xb440, 0xb080, 0xb800, 0xa860, 0xb448, 0xb088, 0xb808, 0xa868
.long 0xb450, 0xb090, 0xb810, 0xa870, 0xb458, 0xb098, 0xb818, 0xa878
.long 0xb3a0, 0xb120, 0xa540, 0xa900, 0xb3a8, 0xb128, 0xa548, 0xa908
.long 0xb3b0, 0xb130, 0xa550, 0xa910, 0xb3b8, 0xb138, 0xa558, 0xa918
.long 0xb120, 0xb580, 0xb080, 0xb300, 0xb128, 0xb588, 0xb088, 0xb308
.long 0xb130, 0xb590, 0xb090, 0xb310, 0xb138, 0xb598, 0xb098, 0xb318
.long 0xb6c0, 0xb4e0, 0xaa40, 0xb6c0, 0xb6c8, 0xb4e8, 0xaa48, 0xb6c8
.long 0xb6d0, 0xb4f0, 0xaa50, 0xb6d0, 0xb6d8, 0xb4f8, 0xaa58, 0xb6d8
.long 0xb300, 0xb440, 0xb080, 0xb300, 0xb308, 0xb448, 0xb088, 0xb308
.long 0xb310, 0xb450, 0xb090, 0xb310, 0xb318, 0xb458, 0xb098, 0xb318
.long 0xb260, 0xb760, 0xaa40, 0xb6c0, 0xb268, 0xb768, 0xaa48, 0xb6c8
.long 0xb270, 0xb770, 0xaa50, 0xb6d0, 0xb278, 0xb778, 0xaa58, 0xb6d8
.long 0xb580, 0xb120, 0xb620, 0xa680, 0xb588, 0xb128, 0xb628, 0xa688
.long 0xb590, 0xb130, 0xb630, 0xa690, 0xb598, 0xb138, 0xb638, 0xa698
.long 0xb260, 0xb1c0, 0xa7c0, 0xa680, 0xb268, 0xb1c8, 0xa7c8, 0xa688
.long 0xb270, 0xb1d0, 0xa7d0, 0xa690, 0xb278, 0xb1d8, 0xa7d8, 0xa698
.long 0xb300, 0xb3a0, 0xb620, 0xb300, 0xb308, 0xb3a8, 0xb628, 0xb308
.long 0xb310, 0xb3b0, 0xb630, 0xb310, 0xb318, 0xb3b8, 0xb638, 0xb318
.long 0xb6c0, 0xb800, 0xa7c0, 0xb300, 0xb6c8, 0xb808, 0xa7c8, 0xb308
.long 0xb6d0, 0xb810, 0xa7d0, 0xb310, 0xb6d8, 0xb818, 0xa7d8, 0xb318
.long 0x0, 0x200, 0x0, 0x3f803f80, 0x8, 0x208, 0x0, 0x3f803f80
.long 0x10, 0x210, 0x0, 0x3f803f80, 0x18, 0x218, 0x0, 0x3f803f80
.long 0x420, 0x620, 0x0, 0x3f803f80, 0x428, 0x628, 0x0, 0x3f803f80
.long 0x430, 0x630, 0x0, 0x3f803f80, 0x438, 0x638, 0x0, 0x3f803f80
.long 0x840, 0xa40, 0x10, 0x3f803f80, 0x848, 0xa48, 0x10, 0x3f803f80
.long 0x850, 0xa50, 0x10, 0x3f803f80, 0x858, 0xa58, 0x10, 0x3f803f80
.long 0xc60, 0xe60, 0x10, 0x3f803f80, 0xc68, 0xe68, 0x10, 0x3f803f80
.long 0xc70, 0xe70, 0x10, 0x3f803f80, 0xc78, 0xe78, 0x10, 0x3f803f80
.long 0x80, 0x280, 0x20, 0x3f803f80, 0x88, 0x288, 0x20, 0x3f803f80
.long 0x90, 0x290, 0x20, 0x3f803f80, 0x98, 0x298, 0x20, 0x3f803f80
.long 0x4a0, 0x6a0, 0x20, 0x3f803f80, 0x4a8, 0x6a8, 0x20, 0x3f803f80
.long 0x4b0, 0x6b0, 0x20, 0x3f803f80, 0x4b8, 0x6b8, 0x20, 0x3f803f80
.long 0x8c0, 0xac0, 0x30, 0x3f803f80, 0x8c8, 0xac8, 0x30, 0x3f803f80
.long 0x8d0, 0xad0, 0x30, 0x3f803f80, 0x8d8, 0xad8, 0x30, 0x3f803f80
.long 0xce0, 0xee0, 0x30, 0x3f803f80, 0xce8, 0xee8, 0x30, 0x3f803f80
.long 0xcf0, 0xef0, 0x30, 0x3f803f80, 0xcf8, 0xef8, 0x30, 0x3f803f80
.long 0x100, 0x300, 0x40, 0x0, 0x108, 0x308, 0x40, 0x0
.long 0x110, 0x310, 0x40, 0x0, 0x118, 0x318, 0x40, 0x0
.long 0x520, 0x720, 0x40, 0x0, 0x528, 0x728, 0x40, 0x0
.long 0x530, 0x730, 0x40, 0x0, 0x538, 0x738, 0x40, 0x0
.long 0x940, 0xb40, 0x50, 0x0, 0x948, 0xb48, 0x50, 0x0
.long 0x950, 0xb50, 0x50, 0x0, 0x958, 0xb58, 0x50, 0x0
.long 0xd60, 0xf60, 0x50, 0x0, 0xd68, 0xf68, 0x50, 0x0
.long 0xd70, 0xf70, 0x50, 0x0, 0xd78, 0xf78, 0x50, 0x0
.long 0x180, 0xf60, 0x60, 0x0, 0x188, 0xf68, 0x60, 0x0
.long 0x190, 0xf70, 0x60, 0x0, 0x198, 0xf78, 0x60, 0x0
.long 0x5a0, 0xf60, 0x60, 0x0, 0x5a8, 0xf68, 0x60, 0x0
.long 0x5b0, 0xf70, 0x60, 0x0, 0x5b8, 0xf78, 0x60, 0x0
.long 0x9c0, 0xf60, 0x70, 0x0, 0x9c8, 0xf68, 0x70, 0x0
.long 0x9d0, 0xf70, 0x70, 0x0, 0x9d8, 0xf78, 0x70, 0x0
.long 0xde0, 0xf60, 0x70, 0x0, 0xde8, 0xf68, 0x70, 0x0
.long 0xdf0, 0xf70, 0x70, 0x0, 0xdf8, 0xf78, 0x70, 0x0
.long 0xffff, 0x0, 0x0, 0x0, 0x0, 0x0, 0xffff, 0x0
.long 0x0, 0x0, 0x0, 0x0, 0x0, 0x0, 0x0, 0x0
.long 0x0, 0x0, 0x0, 0x0, 0x0, 0x0, 0x0, 0x0
.long 0x0, 0x0, 0x0, 0x0, 0x0, 0x0, 0x0, 0x0
.long 0xffff0000, 0x0, 0x0, 0x0, 0x0, 0x0, 0xffff0000, 0x0
.long 0x0, 0x0, 0x0, 0x0, 0x0, 0x0, 0x0, 0x0
.long 0x0, 0x0, 0x0, 0x0, 0x0, 0x0, 0x0, 0x0
.long 0x0, 0x0, 0x0, 0x0, 0x0, 0x0, 0x0, 0x0
.long 0x0, 0xffff, 0x0, 0x0, 0x0, 0x0, 0x0, 0xffff
.long 0x0, 0x0, 0x0, 0x0, 0x0, 0x0, 0x0, 0x0
.long 0x0, 0x0, 0x0, 0x0, 0x0, 0x0, 0x0, 0x0
.long 0x0, 0x0, 0x0, 0x0, 0x0, 0x0, 0x0, 0x0
.long 0x0, 0xffff0000, 0x0, 0x0, 0x0, 0x0, 0x0, 0xffff0000
.long 0x0, 0x0, 0x0, 0x0, 0x0, 0x0, 0x0, 0x0
.long 0x0, 0x0, 0x0, 0x0, 0x0, 0x0, 0x0, 0x0
.long 0x0, 0x0, 0x0, 0x0, 0x0, 0x0, 0x0, 0x0
.long 0x0, 0x0, 0x0, 0x0, 0x0, 0x0, 0x0, 0x0
.long 0xffff, 0x0, 0x0, 0x0, 0x0, 0x0, 0xffff, 0x0
.long 0x0, 0x0, 0x0, 0x0, 0x0, 0x0, 0x0, 0x0
.long 0x0, 0x0, 0x0, 0x0, 0x0, 0x0, 0x0, 0x0
.long 0x0, 0x0, 0x0, 0x0, 0x0, 0x0, 0x0, 0x0
.long 0xffff0000, 0x0, 0x0, 0x0, 0x0, 0x0, 0xffff0000, 0x0
.long 0x0, 0x0, 0x0, 0x0, 0x0, 0x0, 0x0, 0x0
.long 0x0, 0x0, 0x0, 0x0, 0x0, 0x0, 0x0, 0x0
.long 0x0, 0x0, 0x0, 0x0, 0x0, 0x0, 0x0, 0x0
.long 0x0, 0xffff, 0x0, 0x0, 0x0, 0x0, 0x0, 0xffff
.long 0x0, 0x0, 0x0, 0x0, 0x0, 0x0, 0x0, 0x0
.long 0x0, 0x0, 0x0, 0x0, 0x0, 0x0, 0x0, 0x0
.long 0x0, 0x0, 0x0, 0x0, 0x0, 0x0, 0x0, 0x0
.long 0x0, 0xffff0000, 0x0, 0x0, 0x0, 0x0, 0x0, 0xffff0000
.long 0x0, 0x0, 0x0, 0x0, 0x0, 0x0, 0x0, 0x0
.long 0x0, 0x0, 0x0, 0x0, 0x0, 0x0, 0x0, 0x0
.long 0x0, 0x0, 0x0, 0x0, 0x0, 0x0, 0x0, 0x0
.long 0x0, 0x0, 0x0, 0x0, 0x0, 0x0, 0x0, 0x0
.long 0x0, 0x0, 0xffff, 0x0, 0x0, 0x0, 0x0, 0x0
.long 0x0, 0x0, 0x0, 0x0, 0xffff, 0x0, 0x0, 0x0
.long 0x0, 0x0, 0x0, 0x0, 0x0, 0x0, 0x0, 0x0
.long 0x0, 0x0, 0x0, 0x0, 0x0, 0x0, 0x0, 0x0
.long 0x0, 0x0, 0xffff0000, 0x0, 0x0, 0x0, 0x0, 0x0
.long 0x0, 0x0, 0x0, 0x0, 0xffff0000, 0x0, 0x0, 0x0
.long 0x0, 0x0, 0x0, 0x0, 0x0, 0x0, 0x0, 0x0
.long 0x0, 0x0, 0x0, 0x0, 0x0, 0x0, 0x0, 0x0
.long 0x0, 0x0, 0x0, 0xffff, 0x0, 0x0, 0x0, 0x0
.long 0x0, 0x0, 0x0, 0x0, 0x0, 0xffff, 0x0, 0x0
.long 0x0, 0x0, 0x0, 0x0, 0x0, 0x0, 0x0, 0x0
.long 0x0, 0x0, 0x0, 0x0, 0x0, 0x0, 0x0, 0x0
.long 0x0, 0x0, 0x0, 0xffff0000, 0x0, 0x0, 0x0, 0x0
.long 0x0, 0x0, 0x0, 0x0, 0x0, 0xffff0000, 0x0, 0x0
.long 0x0, 0x0, 0x0, 0x0, 0x0, 0x0, 0x0, 0x0
.long 0x0, 0x0, 0x0, 0x0, 0x0, 0x0, 0x0, 0x0
.long 0x0, 0x0, 0x0, 0x0, 0xffff, 0x0, 0x0, 0x0
.long 0x0, 0x0, 0x0, 0x0, 0x0, 0x0, 0x0, 0x0
.long 0x0, 0x0, 0x0, 0x0, 0x0, 0x0, 0x0, 0x0
.long 0x0, 0x0, 0x0, 0x0, 0x0, 0x0, 0x0, 0x0
.long 0x0, 0x0, 0x0, 0x0, 0xffff0000, 0x0, 0x0, 0x0
.long 0x0, 0x0, 0x0, 0x0, 0x0, 0x0, 0x0, 0x0
.long 0x0, 0x0, 0x0, 0x0, 0x0, 0x0, 0x0, 0x0
.long 0x0, 0x0, 0x0, 0x0, 0x0, 0x0, 0x0, 0x0
.long 0x0, 0x0, 0x0, 0x0, 0x0, 0x0, 0x0, 0x0
.long 0x0, 0x0, 0x0, 0x0, 0x0, 0x0, 0x0, 0x0
.long 0x0, 0x0, 0x0, 0x0, 0x0, 0x0, 0x0, 0x0
.long 0x0, 0x0, 0x0, 0x0, 0x0, 0x0, 0x0, 0x0
.long 0x0, 0x0, 0x0, 0x0, 0x0, 0x0, 0x0, 0x0
.long 0x0, 0x0, 0x0, 0x0, 0x0, 0x0, 0x0, 0x0
.long 0x14d40, 0x14d40, 0x0, 0x0, 0x14e10, 0x14e10, 0x20, 0x20
.long 0x14ee0, 0x14ee0, 0x100000, 0x100000, 0x14fb0, 0x14fb0, 0x100020, 0x100020
.long 0x15080, 0x15080, 0x40, 0x40, 0x15150, 0x15150, 0x60, 0x60
.long 0x15220, 0x15220, 0x100040, 0x100040, 0x100000, 0x100000, 0x100060, 0x100060
.long 0x14d74, 0x14d74, 0x80, 0x80, 0x14e44, 0x14e44, 0xa0, 0xa0
.long 0x14f14, 0x14f14, 0x100080, 0x100080, 0x14fe4, 0x14fe4, 0x1000a0, 0x1000a0
.long 0x150b4, 0x150b4, 0xc0, 0xc0, 0x15184, 0x15184, 0xe0, 0xe0
.long 0x15254, 0x15254, 0x1000c0, 0x1000c0, 0x100000, 0x100000, 0x1000e0, 0x1000e0
.long 0x14da8, 0x14da8, 0x8, 0x100, 0x14e78, 0x14e78, 0x28, 0x120
.long 0x14f48, 0x14f48, 0x100008, 0x100100, 0x15018, 0x15018, 0x100028, 0x100120
.long 0x150e8, 0x150e8, 0x48, 0x140, 0x151b8, 0x151b8, 0x68, 0x160
.long 0x100000, 0x100000, 0x100048, 0x100140, 0x100000, 0x100000, 0x100068, 0x100160
.long 0x14ddc, 0x14ddc, 0x88, 0x180, 0x14eac, 0x14eac, 0xa8, 0x1a0
.long 0x14f7c, 0x14f7c, 0x100088, 0x100180, 0x1504c, 0x1504c, 0x1000a8, 0x1001a0
.long 0x1511c, 0x1511c, 0xc8, 0x1c0, 0x151ec, 0x151ec, 0xe8, 0x1e0
.long 0x100000, 0x100000, 0x1000c8, 0x1001c0, 0x100000, 0x100000, 0x1000e8, 0x1001e0
.long 0x17d40, 0x114d40, 0x100, 0x200, 0x17e10, 0x114e10, 0x120, 0x220
.long 0x17ee0, 0x114ee0, 0x100100, 0x100200, 0x17fb0, 0x114fb0, 0x100120, 0x100220
.long 0x18080, 0x115080, 0x140, 0x240, 0x18150, 0x115150, 0x160, 0x260
.long 0x18220, 0x115220, 0x100140, 0x100240, 0x103000, 0x200000, 0x100160, 0x100260
.long 0x17d74, 0x114d74, 0x180, 0x280, 0x17e44, 0x114e44, 0x1a0, 0x2a0
.long 0x17f14, 0x114f14, 0x100180, 0x100280, 0x17fe4, 0x114fe4, 0x1001a0, 0x1002a0
.long 0x180b4, 0x1150b4, 0x1c0, 0x2c0, 0x18184, 0x115184, 0x1e0, 0x2e0
.long 0x18254, 0x115254, 0x1001c0, 0x1002c0, 0x103000, 0x200000, 0x1001e0, 0x1002e0
.long 0x17da8, 0x114da8, 0x108, 0x300, 0x17e78, 0x114e78, 0x128, 0x320
.long 0x17f48, 0x114f48, 0x100108, 0x100300, 0x18018, 0x115018, 0x100128, 0x100320
.long 0x180e8, 0x1150e8, 0x148, 0x340, 0x181b8, 0x1151b8, 0x168, 0x360
.long 0x103000, 0x200000, 0x100148, 0x100340, 0x103000, 0x200000, 0x100168, 0x100360
.long 0x17ddc, 0x114ddc, 0x188, 0x380, 0x17eac, 0x114eac, 0x1a8, 0x3a0
.long 0x17f7c, 0x114f7c, 0x100188, 0x100380, 0x1804c, 0x11504c, 0x1001a8, 0x1003a0
.long 0x1811c, 0x11511c, 0x1c8, 0x3c0, 0x181ec, 0x1151ec, 0x1e8, 0x3e0
.long 0x103000, 0x200000, 0x1001c8, 0x1003c0, 0x103000, 0x200000, 0x1001e8, 0x1003e0
.long 0xa400, 0xd00, 0x0, 0x14d40, 0xa440, 0xd00, 0x0, 0x14d80
.long 0xa480, 0xd00, 0x1, 0x14dd0, 0xa4c0, 0xd00, 0x1, 0x14e10
.long 0xa500, 0xd00, 0x2, 0x14e60, 0xa540, 0xd00, 0x2, 0x14ea0
.long 0xa580, 0xd00, 0x3, 0x14ef0, 0xa5c0, 0xd00, 0x3, 0x14f30
.long 0xa600, 0xd00, 0x4, 0x14f40, 0xa640, 0xd00, 0x4, 0x14f80
.long 0xa680, 0xd00, 0x5, 0x14fd0, 0xa6c0, 0xd00, 0x5, 0x15010
.long 0xa700, 0xd00, 0x6, 0x15060, 0xa740, 0xd00, 0x6, 0x150a0
.long 0xa780, 0xd00, 0x7, 0x150f0, 0xa7c0, 0xd00, 0x7, 0x15130
.long 0xa800, 0xd00, 0x8, 0x15140, 0xa840, 0xd00, 0x8, 0x15180
.long 0xa880, 0xd00, 0x9, 0x151d0, 0xa8c0, 0xd00, 0x9, 0x15210
.long 0xa900, 0xd00, 0xa, 0x15260, 0xa940, 0xd00, 0xa, 0x152a0
.long 0xa980, 0xd00, 0xb, 0x152f0, 0xa9c0, 0xd00, 0xb, 0x15330
.long 0xaa00, 0xd00, 0xc, 0x15340, 0xaa40, 0xd00, 0xc, 0x15380
.long 0x1f680, 0x40, 0xd, 0x153d0, 0x100000, 0xd00, 0xd, 0x15410
.long 0x100000, 0xd00, 0xe, 0x15460, 0x100000, 0xd00, 0xe, 0x154a0
.long 0x100000, 0xd00, 0xf, 0x154f0, 0x100000, 0xd00, 0xf, 0x15530
.long 0xa400, 0xd00, 0x2, 0x14d60, 0xa440, 0xd00, 0x2, 0x14da0
.long 0xa480, 0xd00, 0x3, 0x14df0, 0xa4c0, 0xd00, 0x3, 0x14e30
.long 0xa500, 0xd00, 0x4, 0x14e40, 0xa540, 0xd00, 0x4, 0x14e80
.long 0xa580, 0xd00, 0x5, 0x14ed0, 0xa5c0, 0xd00, 0x5, 0x14f10
.long 0xa600, 0xd00, 0x6, 0x14f60, 0xa640, 0xd00, 0x6, 0x14fa0
.long 0xa680, 0xd00, 0x7, 0x14ff0, 0xa6c0, 0xd00, 0x7, 0x15030
.long 0xa700, 0xd00, 0x8, 0x15040, 0xa740, 0xd00, 0x8, 0x15080
.long 0xa780, 0xd00, 0x9, 0x150d0, 0xa7c0, 0xd00, 0x9, 0x15110
.long 0xa800, 0xd00, 0xa, 0x15160, 0xa840, 0xd00, 0xa, 0x151a0
.long 0xa880, 0xd00, 0xb, 0x151f0, 0xa8c0, 0xd00, 0xb, 0x15230
.long 0xa900, 0xd00, 0xc, 0x15240, 0xa940, 0xd00, 0xc, 0x15280
.long 0xa980, 0xd00, 0xd, 0x152d0, 0xa9c0, 0xd00, 0xd, 0x15310
.long 0xaa00, 0xd00, 0xe, 0x15360, 0xaa40, 0xd00, 0xe, 0x153a0
.long 0x1f680, 0x40, 0xf, 0x153f0, 0x100000, 0xd00, 0xf, 0x15430
.long 0x100000, 0xd00, 0x10, 0x15440, 0x100000, 0xd00, 0x10, 0x15480
.long 0x100000, 0xd00, 0x11, 0x154d0, 0x100000, 0xd00, 0x11, 0x15510
.long 0x1f690, 0x1f890, 0x1f9c0, 0x1f9e0, 0x1f698, 0x1f898, 0x1f9c8, 0x1f9e8
.long 0x1f680, 0x1f880, 0x1f9d0, 0x1f9f0, 0x1f688, 0x1f888, 0x1f9d8, 0x100000
.long 0x1fd20, 0x1ff20, 0x1f9c2, 0x1f9e2, 0x1fd28, 0x1ff28, 0x1f9ca, 0x1f9ea
.long 0x1fd30, 0x1ff30, 0x1f9d2, 0x1f9f2, 0x1fd38, 0x1ff38, 0x1f9da, 0x100000
.long 0x1f6f0, 0x1f8f0, 0x1f9c4, 0x1f9e4, 0x1f6f8, 0x1f8f8, 0x1f9cc, 0x1f9ec
.long 0x1f6e0, 0x1f8e0, 0x1f9d4, 0x100000, 0x1f6e8, 0x1f8e8, 0x1f9dc, 0x100000
.long 0x1fd40, 0x1ff40, 0x1f9c6, 0x1f9e6, 0x1fd48, 0x1ff48, 0x1f9ce, 0x1f9ee
.long 0x1fd50, 0x1ff50, 0x1f9d6, 0x100000, 0x1fd58, 0x1ff58, 0x1f9de, 0x100000
.long 0x1f710, 0x1f910, 0x1f9c0, 0x1f9e0, 0x1f718, 0x1f918, 0x1f9c8, 0x1f9e8
.long 0x1f700, 0x1f900, 0x1f9d0, 0x1f9f0, 0x1f708, 0x1f908, 0x1f9d8, 0x100000
.long 0x1fda0, 0x1ffa0, 0x1f9c2, 0x1f9e2, 0x1fda8, 0x1ffa8, 0x1f9ca, 0x1f9ea
.long 0x1fdb0, 0x1ffb0, 0x1f9d2, 0x1f9f2, 0x1fdb8, 0x1ffb8, 0x1f9da, 0x100000
.long 0x1f770, 0x1f970, 0x1f9c4, 0x1f9e4, 0x1f778, 0x1f978, 0x1f9cc, 0x1f9ec
.long 0x1f760, 0x1f960, 0x1f9d4, 0x100000, 0x1f768, 0x1f968, 0x1f9dc, 0x100000
.long 0x1fdc0, 0x1ffc0, 0x1f9c6, 0x1f9e6, 0x1fdc8, 0x1ffc8, 0x1f9ce, 0x1f9ee
.long 0x1fdd0, 0x1ffd0, 0x1f9d6, 0x100000, 0x1fdd8, 0x1ffd8, 0x1f9de, 0x100000
.long 0x1f790, 0x1f990, 0x1f9c0, 0x1f9e0, 0x1f798, 0x1f998, 0x1f9c8, 0x1f9e8
.long 0x1f780, 0x1f980, 0x1f9d0, 0x1f9f0, 0x1f788, 0x1f988, 0x1f9d8, 0x100000
.long 0x1fe20, 0x20020, 0x1f9c2, 0x1f9e2, 0x1fe28, 0x20028, 0x1f9ca, 0x1f9ea
.long 0x1fe30, 0x20030, 0x1f9d2, 0x1f9f2, 0x1fe38, 0x20038, 0x1f9da, 0x100000
.long 0x1f7f0, 0x14d00, 0x1f9c4, 0x1f9e4, 0x1f7f8, 0x14d08, 0x1f9cc, 0x1f9ec
.long 0x1f7e0, 0x14d10, 0x1f9d4, 0x100000, 0x1f7e8, 0x14d18, 0x1f9dc, 0x100000
.long 0x1fe40, 0x14d00, 0x1f9c6, 0x1f9e6, 0x1fe48, 0x14d08, 0x1f9ce, 0x1f9ee
.long 0x1fe50, 0x14d10, 0x1f9d6, 0x100000, 0x1fe58, 0x14d18, 0x1f9de, 0x100000
.long 0x1f810, 0x14d00, 0x1f9c0, 0x1f9e0, 0x1f818, 0x14d08, 0x1f9c8, 0x1f9e8
.long 0x1f800, 0x14d10, 0x1f9d0, 0x1f9f0, 0x1f808, 0x14d18, 0x1f9d8, 0x100000
.long 0x1fea0, 0x14d00, 0x1f9c2, 0x1f9e2, 0x1fea8, 0x14d08, 0x1f9ca, 0x1f9ea
.long 0x1feb0, 0x14d10, 0x1f9d2, 0x1f9f2, 0x1feb8, 0x14d18, 0x1f9da, 0x100000
.long 0x1f870, 0x14d00, 0x1f9c4, 0x1f9e4, 0x1f878, 0x14d08, 0x1f9cc, 0x1f9ec
.long 0x1f860, 0x14d10, 0x1f9d4, 0x100000, 0x1f868, 0x14d18, 0x1f9dc, 0x100000
.long 0x1fec0, 0x14d00, 0x1f9c6, 0x1f9e6, 0x1fec8, 0x14d08, 0x1f9ce, 0x1f9ee
.long 0x1fed0, 0x14d10, 0x1f9d6, 0x100000, 0x1fed8, 0x14d18, 0x1f9de, 0x100000
.long 0x0, 0x4444, 0x0, 0xa400, 0x10, 0xeeee, 0x4, 0xa404
.long 0x20, 0x4444, 0x8, 0xa408, 0x30, 0xeeee, 0xc, 0xa40c
.long 0x40, 0x4444, 0x10, 0xa410, 0x50, 0xeeee, 0x14, 0xa414
.long 0x60, 0x4444, 0x18, 0xa418, 0x70, 0xeeee, 0x1c, 0xa41c
.long 0x0, 0x4444, 0x20, 0xa420, 0x10, 0xeeee, 0x24, 0xa424
.long 0x20, 0x4444, 0x28, 0xa428, 0x30, 0xeeee, 0x2c, 0xa42c
.long 0x40, 0x4444, 0x30, 0xa430, 0x50, 0xeeee, 0x34, 0xa434
.long 0x60, 0x4444, 0x38, 0xa438, 0x70, 0xeeee, 0x3c, 0xa43c
.long 0x0, 0x4444, 0x40, 0xa440, 0x10, 0xeeee, 0x44, 0xa444
.long 0x20, 0x4444, 0x48, 0xa448, 0x30, 0xeeee, 0x4c, 0xa44c
.long 0x40, 0x4444, 0x50, 0xa450, 0x50, 0xeeee, 0x54, 0xa454
.long 0x60, 0x4444, 0x58, 0xa458, 0x70, 0xeeee, 0x5c, 0xa45c
.long 0x0, 0x4444, 0x60, 0xa460, 0x10, 0xeeee, 0x64, 0xa464
.long 0x20, 0x4444, 0x68, 0xa468, 0x30, 0xeeee, 0x6c, 0xa46c
.long 0x40, 0x4444, 0x70, 0xa470, 0x50, 0xeeee, 0x74, 0xa474
.long 0x60, 0x4444, 0x78, 0xa478, 0x70, 0xeeee, 0x7c, 0xa47c
.long 0x0, 0x4444, 0x420, 0xb080, 0x10, 0xeeee, 0x424, 0xb084
.long 0x20, 0x4444, 0x428, 0xb088, 0x30, 0xeeee, 0x42c, 0xb08c
.long 0x40, 0x4444, 0x430, 0xb090, 0x50, 0xeeee, 0x434, 0xb094
.long 0x60, 0x4444, 0x438, 0xb098, 0x70, 0xeeee, 0x43c, 0xb09c
.long 0x0, 0x4444, 0x440, 0xb0a0, 0x10, 0xeeee, 0x444, 0xb0a4
.long 0x20, 0x4444, 0x448, 0xb0a8, 0x30, 0xeeee, 0x44c, 0xb0ac
.long 0x40, 0x4444, 0x450, 0xb0b0, 0x50, 0xeeee, 0x454, 0xb0b4
.long 0x60, 0x4444, 0x458, 0xb0b8, 0x70, 0xeeee, 0x45c, 0xb0bc
.long 0x0, 0x4444, 0x460, 0xb0c0, 0x10, 0xeeee, 0x464, 0xb0c4
.long 0x20, 0x4444, 0x468, 0xb0c8, 0x30, 0xeeee, 0x46c, 0xb0cc
.long 0x40, 0x4444, 0x470, 0xb0d0, 0x50, 0xeeee, 0x474, 0xb0d4
.long 0x60, 0x4444, 0x478, 0xb0d8, 0x70, 0xeeee, 0x47c, 0xb0dc
.long 0x0, 0x4444, 0x480, 0xb0e0, 0x10, 0xeeee, 0x484, 0xb0e4
.long 0x20, 0x4444, 0x488, 0xb0e8, 0x30, 0xeeee, 0x48c, 0xb0ec
.long 0x40, 0x4444, 0x490, 0xb0f0, 0x50, 0xeeee, 0x494, 0xb0f4
.long 0x60, 0x4444, 0x498, 0xb0f8, 0x70, 0xeeee, 0x49c, 0xb0fc
.long 0x1fa28, 0x1f9f4, 0x34, 0x14d00, 0x1fa28, 0x1f9f6, 0x74, 0x14d04
.long 0x1fa28, 0x1f9f8, 0xb4, 0x14d08, 0x1fa28, 0x1f9fa, 0xf4, 0x14d0c
.long 0x1fa28, 0x1f9fc, 0x134, 0x14d10, 0x1fa28, 0x1f9fe, 0x174, 0x14d14
.long 0x1fa28, 0x1fa00, 0x1b4, 0x14d18, 0x1fa28, 0x1fa02, 0x1f4, 0x14d1c
.long 0x1fa28, 0x1fa04, 0x234, 0x14d20, 0x1fa28, 0x1fa06, 0x274, 0x14d24
.long 0x1fa28, 0x1fa08, 0x2b4, 0x14d28, 0x1fa28, 0x1fa0a, 0x2f4, 0x14d2c
.long 0x1fa28, 0x1fa0c, 0x334, 0x14d30, 0x1fa28, 0x1fa0e, 0x374, 0x14d34
.long 0x1fa28, 0x1fa10, 0x3b4, 0x14d38, 0x1fa28, 0x1fa12, 0x3f4, 0x14d3c
.long 0x1fa28, 0x1fa14, 0x434, 0x14d00, 0x1fa28, 0x1fa16, 0x474, 0x14d04
.long 0x1fa28, 0x1fa18, 0x4b4, 0x14d08, 0x1fa28, 0x1fa1a, 0x4f4, 0x14d0c
.long 0x1fa28, 0x1fa1c, 0x534, 0x14d10, 0x1fa28, 0x1fa1e, 0x574, 0x14d14
.long 0x1fa28, 0x1fa20, 0x5b4, 0x14d18, 0x1fa28, 0x1fa22, 0x5f4, 0x14d1c
.long 0x1fa28, 0x1fa24, 0x634, 0x14d20, 0x1fa28, 0x1fa26, 0x674, 0x14d24
.long 0x1fa28, 0x1fa28, 0x6b4, 0x14d28, 0x1fa28, 0x1fa2a, 0x6f4, 0x14d2c
.long 0x1fa28, 0x1fa2c, 0x734, 0x14d30, 0x1fa28, 0x1fa2e, 0x774, 0x14d34
.long 0x1fa28, 0x1fa30, 0x7b4, 0x14d38, 0x1fa28, 0x1fa32, 0x7f4, 0x14d3c
.long 0x1fa38, 0x1fa34, 0x834, 0x14d00, 0x1fa38, 0x1fa36, 0x874, 0x14d04
.long 0x1fa38, 0x1fa38, 0x8b4, 0x14d08, 0x1fa38, 0x1fa3a, 0x8f4, 0x14d0c
.long 0x1fa38, 0x1fa3c, 0x934, 0x14d10, 0x1fa38, 0x1fa3e, 0x974, 0x14d14
.long 0x1fa38, 0x1fa40, 0x9b4, 0x14d18, 0x1fa38, 0x1fa42, 0x9f4, 0x14d1c
.long 0x1fa38, 0x1fa44, 0xa34, 0x14d20, 0x1fa38, 0x1fa46, 0xa74, 0x14d24
.long 0x1fa38, 0x1fa48, 0xab4, 0x14d28, 0x1fa38, 0x1fa4a, 0xaf4, 0x14d2c
.long 0x1fa38, 0x1fa4c, 0xb34, 0x14d30, 0x1fa38, 0x1fa4e, 0xb74, 0x14d34
.long 0x1fa38, 0x1fa50, 0xbb4, 0x14d38, 0x1fa38, 0x1fa52, 0xbf4, 0x14d3c
.long 0x1fa38, 0x1fa54, 0xc34, 0x14d00, 0x1fa38, 0x1fa56, 0xc74, 0x14d04
.long 0x1fa38, 0x1fa58, 0xcb4, 0x14d08, 0x1fa38, 0x1fa5a, 0xcf4, 0x14d0c
.long 0x1fa38, 0x1fa5c, 0xd34, 0x14d10, 0x1fa38, 0x1fa5e, 0xd74, 0x14d14
.long 0x1fa38, 0x1fa60, 0xdb4, 0x14d18, 0x1fa38, 0x1fa62, 0xdf4, 0x14d1c
.long 0x1fa38, 0x1fa64, 0xe34, 0x14d20, 0x1fa38, 0x1fa66, 0xe74, 0x14d24
.long 0x1fa38, 0x1fa68, 0xeb4, 0x14d28, 0x1fa38, 0x1fa6a, 0xef4, 0x14d2c
.long 0x1fa38, 0x1fa6c, 0xf34, 0x14d30, 0x1fa38, 0x1fa6e, 0xf74, 0x14d34
.long 0x1fa38, 0x1fa70, 0xfb4, 0x14d38, 0x1fa38, 0x1fa72, 0xff4, 0x14d3c
.long 0x0, 0x0, 0x0, 0x0, 0x0, 0x0, 0x0, 0x0
.long 0x0, 0x0, 0x0, 0x0, 0x0, 0x0, 0x0, 0x0
.long 0x0, 0x0, 0x0, 0x0, 0x0, 0x0, 0x0, 0x0
.long 0x0, 0x0, 0x0, 0x0, 0x0, 0x0, 0x0, 0x0
.long 0x0, 0x0, 0x0, 0x0, 0x0, 0x0, 0x0, 0x0
.long 0x0, 0x0, 0x0, 0x0, 0x0, 0x0, 0x0, 0x0
.long 0x0, 0x0, 0x0, 0x0, 0x0, 0x0, 0x0, 0x0
.long 0x0, 0x0, 0x0, 0x0, 0x0, 0x0, 0x0, 0x0
.long 0x0, 0x0, 0x0, 0x0, 0x0, 0x0, 0x0, 0x0
.long 0x0, 0x0, 0x0, 0x0, 0x0, 0x0, 0x0, 0x0
.long 0x0, 0x0, 0x0, 0x0, 0x0, 0x0, 0x0, 0x0
.long 0x0, 0x0, 0x0, 0x0, 0x0, 0x0, 0x0, 0x0
.long 0x0, 0x0, 0x0, 0x0, 0x0, 0x0, 0x0, 0x0
.long 0x0, 0x0, 0x0, 0x0, 0x0, 0x0, 0x0, 0x0
.long 0x0, 0x0, 0x0, 0x0, 0x0, 0x0, 0x0, 0x0
.long 0x0, 0x0, 0x0, 0x0, 0x0, 0x0, 0x0, 0x0
.long 0x0, 0x0, 0x0, 0x0, 0x0, 0x0, 0x0, 0x0
.long 0x0, 0x0, 0x0, 0x0, 0x0, 0x0, 0x0, 0x0
.long 0x0, 0x0, 0x0, 0x0, 0x0, 0x0, 0x0, 0x0
.long 0x0, 0x0, 0x0, 0x0, 0x0, 0x0, 0x0, 0x0
.long 0x0, 0x0, 0x0, 0x0, 0x0, 0x0, 0x0, 0x0
.long 0x0, 0x0, 0x0, 0x0, 0x0, 0x0, 0x0, 0x0
.long 0x0, 0x0, 0x0, 0x0, 0x0, 0x0, 0x0, 0x0
.long 0x0, 0x0, 0x0, 0x0, 0x0, 0x0, 0x0, 0x0
.long 0x0, 0x0, 0x0, 0x0, 0x0, 0x0, 0x0, 0x0
.long 0x0, 0x0, 0x0, 0x0, 0x0, 0x0, 0x0, 0x0
.long 0x0, 0x0, 0x0, 0x0, 0x0, 0x0, 0x0, 0x0
.long 0x0, 0x0, 0x0, 0x0, 0x0, 0x0, 0x0, 0x0
.long 0x0, 0x0, 0x0, 0x0, 0x0, 0x0, 0x0, 0x0
.long 0x0, 0x0, 0x0, 0x0, 0x0, 0x0, 0x0, 0x0
.long 0x0, 0x0, 0x0, 0x0, 0x0, 0x0, 0x0, 0x0
.long 0x0, 0x0, 0x0, 0x0, 0x0, 0x0, 0x0, 0x0
.long 0x13320, 0xa9b0, 0xa800, 0x10c00, 0xf320, 0xc120, 0x133b0, 0xb690
.long 0xa890, 0x11920, 0xf3b0, 0xce00, 0x12600, 0xa920, 0xb520, 0x10c90
.long 0xe600, 0xc090, 0x12690, 0xb600, 0xb5b0, 0x119b0, 0xe690, 0xcdb0
.long 0xd5f0, 0x11440, 0x117f0, 0x130d0, 0xf8d0, 0xadf0, 0xd640, 0x12160
.long 0x11840, 0x13df0, 0xf960, 0xbad0, 0xc8d0, 0x113f0, 0x124d0, 0x13160
.long 0xebf0, 0xad60, 0xc960, 0x120d0, 0x12560, 0x13e40, 0xec40, 0xba40
.long 0xefb0, 0x10ed0, 0x117b0, 0x12a40, 0xfa90, 0xdb60, 0xc890, 0x10d60
.long 0x10a90, 0x129f0, 0x13bb0, 0xddf0, 0xf000, 0x11bf0, 0x11520, 0xe960
.long 0xc160, 0xf9b0, 0xc920, 0x11a40, 0x10800, 0xe8d0, 0xc3f0, 0x13a90
.long 0xce40, 0xfa00, 0xfff0, 0xbb20, 0xedb0, 0xdad0, 0xced0, 0x10720
.long 0x10040, 0xc800, 0x14890, 0xde40, 0xf560, 0xfbb0, 0x140d0, 0xbdb0
.long 0xb3f0, 0xec00, 0xf5f0, 0x10890, 0x14160, 0xca90, 0xb760, 0x14720
.long 0x13520, 0xddb0, 0xa520, 0xbe00, 0xf490, 0xe800, 0x13690, 0x10490
.long 0xa5b0, 0xcb20, 0xe7b0, 0x14d00, 0x12800, 0xdd20, 0xb200, 0xbe90
.long 0xf800, 0x14320, 0x129b0, 0x10400, 0xb290, 0xcbb0, 0xeb20, 0x14290
.long 0xd560, 0x10760, 0x112d0, 0xaed0, 0xfb60, 0xeed0, 0xd3f0, 0xe040
.long 0x11360, 0xbbf0, 0xee40, 0x14d00, 0xc840, 0x106d0, 0x11ff0, 0xaf60
.long 0xfed0, 0x149f0, 0xc6d0, 0xdff0, 0x12040, 0xbc40, 0xf1f0, 0x14960
.long 0xbbb0, 0x10cd0, 0xfdb0, 0x12960, 0xd3b0, 0xd9f0, 0x13090, 0x11160
.long 0x13e90, 0x12bf0, 0xbff0, 0xd290, 0xbc00, 0x119f0, 0xfb20, 0xe840
.long 0xac90, 0xd840, 0x13120, 0x11e40, 0x13c00, 0xead0, 0xbe40, 0xabb0
.long 0xcf60, 0x11400, 0x101f0, 0xef20, 0x12e90, 0xdd60, 0xccd0, 0xd320
.long 0x10560, 0x14a00, 0xb640, 0x12d20, 0xf640, 0x115b0, 0x142d0, 0xf1b0
.long 0x121b0, 0xdcd0, 0xf3f0, 0xd490, 0x14640, 0x14c90, 0xb5f0, 0x12000
.long 0x13600, 0xf7b0, 0xa490, 0xb120, 0x10d20, 0xc200, 0x135b0, 0xea90
.long 0xa400, 0x14d00, 0x10db0, 0xcf20, 0x12920, 0xf720, 0xaa00, 0x14000
.long 0x11a00, 0xc290, 0x12890, 0xea00, 0xb720, 0x14090, 0x11a90, 0xcfb0
.long 0xd4d0, 0xfa40, 0x11760, 0x123f0, 0x12cd0, 0xaff0, 0xd440, 0xed60
.long 0x116d0, 0x14d00, 0x12d60, 0xbcd0, 0xc7f0, 0xf9f0, 0x118d0, 0x14ad0
.long 0x139f0, 0xb040, 0xc760, 0xecd0, 0x125f0, 0x14b60, 0x13a40, 0xbd60
.long 0xe290, 0x10e40, 0xc9b0, 0x12760, 0xfe00, 0x13640, 0x10df0, 0xd5b0
.long 0xf090, 0x128d0, 0x13f20, 0x138d0, 0xe320, 0x11b60, 0x12640, 0xafb0
.long 0xfe90, 0x14360, 0x11ad0, 0xd600, 0xe560, 0xad20, 0x13fb0, 0x145f0
.long 0xe000, 0xcd60, 0x10920, 0x102d0, 0xa6d0, 0xebb0, 0xd040, 0x12e00
.long 0xfc00, 0x10240, 0xaa40, 0x14690, 0xe1b0, 0xf440, 0x103f0, 0x12320
.long 0xe7f0, 0xee00, 0xf760, 0x12fb0, 0x144d0, 0x125b0, 0xeb60, 0x14920
.long 0x13720, 0x111b0, 0xdb20, 0xf400, 0x11090, 0x11d20, 0x137b0, 0x11e90
.long 0xda90, 0xe720, 0x11db0, 0x14d00, 0x12a00, 0x11120, 0x10200, 0xf5b0
.long 0x11200, 0x14400, 0x12a90, 0x11e00, 0x101b0, 0xe890, 0x11f20, 0x14490
.long 0xd6d0, 0x12e40, 0x108d0, 0xfc40, 0x13240, 0x13ed0, 0xd760, 0x13b60
.long 0x10840, 0xef60, 0x13f60, 0x14d00, 0xc9f0, 0x12df0, 0xe1f0, 0xfad0
.long 0x132d0, 0x14bf0, 0xca40, 0x13ad0, 0xe160, 0xedf0, 0x13ff0, 0x14c40
.long 0x11690, 0x11040, 0xde90, 0xa640, 0x10b20, 0x136d0, 0x109b0, 0x10ff0
.long 0xa5f0, 0xd1b0, 0x10bb0, 0x143f0, 0x11720, 0x11d60, 0xdf20, 0xb360
.long 0xb000, 0x13360, 0x10a00, 0x11cd0, 0xb2d0, 0xd200, 0xb090, 0x14040
.long 0xcbf0, 0xb920, 0xe400, 0x13560, 0xa560, 0xc490, 0xcc40, 0xc600
.long 0x13840, 0x13200, 0xe640, 0xc720, 0xf2d0, 0xba90, 0xdfb0, 0xc040
.long 0xa8d0, 0x11fb0, 0xf360, 0xc7b0, 0xc360, 0x12db0, 0xe9f0, 0x12200
.long 0x13400, 0xc3b0, 0xdc00, 0x10e00, 0xbfb0, 0xcc00, 0x13490, 0xd090
.long 0xdc90, 0x11b20, 0xcc90, 0x14d00, 0x12720, 0xc320, 0x10320, 0x10fb0
.long 0xc400, 0x14120, 0x127b0, 0xd000, 0x103b0, 0x11c90, 0xd120, 0x141b0
.long 0xd1f0, 0xac40, 0x10ad0, 0x13040, 0xab60, 0xb7f0, 0xd240, 0xb960
.long 0x10b60, 0x13d60, 0xb840, 0x14d00, 0xc4d0, 0xabf0, 0xe3f0, 0x12ed0
.long 0xb0d0, 0x146d0, 0xc560, 0xb8d0, 0xe440, 0x13bf0, 0xbdf0, 0x14760
.long 0xfc90, 0x10f60, 0x11290, 0xa840, 0x13d20, 0x104d0, 0x13db0, 0x111f0
.long 0x105b0, 0xa7f0, 0x13c90, 0xf7f0, 0xfd20, 0x11c40, 0x11320, 0xb560
.long 0xae00, 0xff60, 0x13e00, 0x11ed0, 0x10600, 0xb4d0, 0xadb0, 0xf240
.long 0xcdf0, 0xed20, 0x133f0, 0xbd20, 0x12c40, 0x14bb0, 0xd160, 0x14800
.long 0x13440, 0xca00, 0x11f60, 0x14b20, 0xf4d0, 0xee90, 0xbed0, 0xb890
.long 0x12ad0, 0x12490, 0xf840, 0x149b0, 0xbf60, 0xc5b0, 0x11df0, 0x12400
.long 0x12bb0, 0x13800, 0xd920, 0xc000, 0x14600, 0x14d00, 0x13890, 0x14d00
.long 0xd9b0, 0xcd20, 0xc5f0, 0x14d00, 0x13920, 0x145b0, 0x10000, 0xc1b0
.long 0xb1b0, 0x14d00, 0x12c00, 0x14520, 0x10090, 0xce90, 0xfbf0, 0x14d00
.long 0xc640, 0xd2d0, 0x105f0, 0xae40, 0x14cd0, 0x14d00, 0xd360, 0x14d00
.long 0x10640, 0xbb60, 0xbf20, 0x14d00, 0xd7f0, 0x14840, 0xded0, 0xacd0
.long 0x10290, 0x14d00, 0xcad0, 0x147f0, 0xdf60, 0xb9f0, 0x11000, 0x14d00
.long 0x14a90, 0x11240, 0xf890, 0xa760, 0x14d00, 0xaad0, 0x123b0, 0x110d0
.long 0x139b0, 0xa9f0, 0x14d00, 0x12b20, 0x10c40, 0xae90, 0xf920, 0xb440
.long 0xe0d0, 0x14d00, 0x11960, 0xaf20, 0x13a00, 0xb6d0, 0x131f0, 0x14d00
.long 0x13b20, 0xd0d0, 0x135f0, 0xf120, 0x14d00, 0x12440, 0xac00, 0xcb60
.long 0x13960, 0x14c00, 0xf520, 0x14d00, 0xcff0, 0x12120, 0xc0d0, 0xec90
.long 0xda40, 0xe090, 0xf6d0, 0x12290, 0xc440, 0x147b0, 0x14d00, 0x14d00
.long 0xa600, 0xd800, 0xdbb0, 0x10120, 0x0, 0x0, 0xa7b0, 0xff20
.long 0xda00, 0x14d00, 0x0, 0x0, 0xb320, 0xd890, 0xde00, 0x14200
.long 0x0, 0x0, 0xb490, 0xffb0, 0x10520, 0x143b0, 0x0, 0x0
.long 0x11640, 0x109f0, 0x107f0, 0xe240, 0x0, 0x0, 0x114d0, 0xe2d0
.long 0x10960, 0x14d00, 0x0, 0x0, 0x12360, 0x10a40, 0x10bf0, 0x14a40
.long 0x0, 0x0, 0x121f0, 0xe360, 0xe4d0, 0x148d0, 0x0, 0x0
.long 0xbc90, 0x126d0, 0x12c90, 0xa960, 0x0, 0x0, 0x131b0, 0x12b60
.long 0xb7b0, 0xa4d0, 0x0, 0x0, 0xba00, 0xe5f0, 0xa440, 0xaa90
.long 0x0, 0x0, 0x12f20, 0xea40, 0xb160, 0xab20, 0x0, 0x0
.long 0x10360, 0x11600, 0xd720, 0x134d0, 0x0, 0x0, 0x100d0, 0xd520
.long 0x11800, 0x13760, 0x0, 0x0, 0x14440, 0x11890, 0x137f0, 0x12520
.long 0x0, 0x0, 0x141f0, 0xd7b0, 0xc2d0, 0x12090, 0x0, 0x0
.long 0xa720, 0xf200, 0xf600, 0x10f20, 0x0, 0x0, 0xa690, 0xe520
.long 0xf690, 0x11c00, 0x0, 0x0, 0xb400, 0xf290, 0xe920, 0x10e90
.long 0x0, 0x0, 0xb3b0, 0xe5b0, 0xe9b0, 0x11bb0, 0x0, 0x0
.long 0x115f0, 0xfcd0, 0xfdf0, 0x12ff0, 0x0, 0x0, 0x11560, 0xeff0
.long 0xfe40, 0x13cd0, 0x0, 0x0, 0x122d0, 0xfd60, 0xf0d0, 0x12f60
.long 0x0, 0x0, 0x12240, 0xf040, 0xf160, 0x13c40, 0x0, 0x0
.long 0xe3b0, 0x12840, 0x11490, 0xdc40, 0x0, 0x0, 0x127f0, 0xd690
.long 0x107b0, 0xdbf0, 0x0, 0x0, 0xe120, 0xe760, 0xc240, 0x113b0
.long 0x0, 0x0, 0xe6d0, 0xd400, 0xc1f0, 0x10690, 0x0, 0x0
.long 0xe200, 0x10160, 0xb9b0, 0xd8d0, 0x0, 0x0, 0x10440, 0x13000
.long 0xc690, 0xd960, 0x0, 0x0, 0xe490, 0x14240, 0xb1f0, 0xb800
.long 0x0, 0x0, 0x14560, 0x13290, 0xb240, 0xc520, 0x0, 0x0
.long 0x0, 0x0, 0x0, 0x0, 0x0, 0x0, 0x0, 0x0
.long 0x0, 0x0, 0x0, 0x0, 0x0, 0x0, 0x0, 0x0
.long 0x0, 0x0, 0x0, 0x0, 0x0, 0x0, 0x0, 0x0
.long 0x0, 0x0, 0x0, 0x0, 0x0, 0x0, 0x0, 0x0
.long 0x0, 0x0, 0x0, 0x0, 0x0, 0x0, 0x0, 0x0
.long 0x0, 0x0, 0x0, 0x0, 0x0, 0x0, 0x0, 0x0
.long 0x0, 0x0, 0x0, 0x0, 0x0, 0x0, 0x0, 0x0
.long 0x0, 0x0, 0x0, 0x0, 0x0, 0x0, 0x0, 0x0
.long 0x0, 0x0, 0x0, 0x0, 0x0, 0x0, 0x0, 0x0
.long 0x0, 0x0, 0x0, 0x0, 0x0, 0x0, 0x0, 0x0
.long 0x0, 0x0, 0x0, 0x0, 0x0, 0x0, 0x0, 0x0
.long 0x0, 0x0, 0x0, 0x0, 0x0, 0x0, 0x0, 0x0
.long 0x0, 0x0, 0x0, 0x0, 0x0, 0x0, 0x0, 0x0
.long 0x0, 0x0, 0x0, 0x0, 0x0, 0x0, 0x0, 0x0
.long 0x0, 0x0, 0x0, 0x0, 0x0, 0x0, 0x0, 0x0
.long 0x0, 0x0, 0x0, 0x0, 0x0, 0x0, 0x0, 0x0
.long 0x0, 0x0, 0x0, 0x0, 0x0, 0x0, 0x0, 0x0
.long 0x0, 0x0, 0x0, 0x0, 0x0, 0x0, 0x0, 0x0
.long 0x0, 0x0, 0x0, 0x0, 0x0, 0x0, 0x0, 0x0
.long 0x0, 0x0, 0x0, 0x0, 0x0, 0x0, 0x0, 0x0
.long 0x0, 0x0, 0x0, 0x0, 0x0, 0x0, 0x0, 0x0
.long 0x0, 0x0, 0x0, 0x0, 0x0, 0x0, 0x0, 0x0
.long 0x0, 0x0, 0x0, 0x0, 0x0, 0x0, 0x0, 0x0
.long 0x0, 0x0, 0x0, 0x0, 0x0, 0x0, 0x0, 0x0
.long 0x0, 0x0, 0x0, 0x0, 0x0, 0x0, 0x0, 0x0
.long 0x0, 0x0, 0x0, 0x0, 0x0, 0x0, 0x0, 0x0
.long 0x0, 0x0, 0x0, 0x0, 0x0, 0x0, 0x0, 0x0
.long 0x0, 0x0, 0x0, 0x0, 0x0, 0x0, 0x0, 0x0
.long 0x0, 0x0, 0x0, 0x0, 0x0, 0x0, 0x0, 0x0
.long 0x0, 0x0, 0x0, 0x0, 0x0, 0x0, 0x0, 0x0
.long 0x0, 0x0, 0x0, 0x0, 0x0, 0x0, 0x0, 0x0
.long 0x0, 0x0, 0x0, 0x0, 0x0, 0x0, 0x0, 0x0
.section .rodata,"a"
.p2align 6
.amdhsa_kernel standalone__deep_cross_xdeepfm__recsys_kernel
  .amdhsa_next_free_vgpr 256
  .amdhsa_next_free_sgpr 102
  .amdhsa_accum_offset 256
  .amdhsa_group_segment_fixed_size 0
  .amdhsa_kernarg_size 88
  .amdhsa_user_sgpr_count 2
  .amdhsa_user_sgpr_kernarg_segment_ptr 1
  .amdhsa_system_sgpr_workgroup_id_x 1
  .amdhsa_float_denorm_mode_32 3
.end_amdhsa_kernel
```

```asm
; @launch grid=(256,1,1) block=(512,1,1) lds=163840
.amdgcn_target "amdgcn-amd-amdhsa--gfx950"
.text
.globl standalone__deep_cross_xdeepfm__recsys_kernel
.p2align 8
.type standalone__deep_cross_xdeepfm__recsys_kernel,@function
standalone__deep_cross_xdeepfm__recsys_kernel:
  s_cmp_ge_u32 s2, 256
  s_cbranch_scc1 L_end
  s_load_dwordx16 s[4:19], s[0:1], 0
  s_load_dwordx4 s[20:23], s[0:1], 64
  s_load_dwordx2 s[24:25], s[0:1], 80
  v_lshrrev_b32 v1, 6, v0
  s_getpc_b64 s[92:93]
L_pc:
  s_and_b32 s68, s2, 0xf8
  v_add_u32 v2, s68, v1
  v_and_b32_e64 v3, 32, v0
  v_lshl_add_u32 v2, v3, 3, v2
  v_lshlrev_b32 v2, 7, v2
  v_min_u32 v2, L_tables+16256-L_pc, v2
  v_mov_b32 v3, s93
  v_add_co_u32 v2, vcc, s92, v2
  s_nop 1
  v_addc_co_u32 v3, vcc, 0, v3, vcc
  global_load_dword v251, v[2:3], off
  v_and_b32 v0, 63, v0
  v_readfirstlane_b32 s3, v1
  s_and_b32 s68, s2, 7
  s_lshr_b32 s69, s2, 3
  s_xor_b32 s69, s69, 31
  s_and_b32 s80, s2, 0xf8
  s_add_u32 s80, s80, s3
  s_lshl_b32 s80, s80, 0
  s_min_u32 s70, s68, 1
  s_add_u32 s71, s69, s70
  s_cmp_ge_u32 s71, 22
  s_cbranch_scc1 L_cin
L_dnn:
  s_mul_i32 s68, s68, 21
  s_add_u32 s68, s68, s71
  s_mul_i32 s26, s68, 5042
  s_lshr_b32 s26, s26, 16
  s_mul_i32 s69, s26, 13
  s_sub_u32 s27, s68, s69
  s_lshl_b32 s77, s27, 8
  s_mul_i32 s71, s26, 320
  v_lshrrev_b32 v116, 4, v0
  v_lshlrev_b32 v11, 4, v0
  s_and_b32 s79, s3, 3
  s_cmp_ge_u32 s3, 4
  s_cbranch_scc1 L_ld
  s_mul_i32 s70, s3, 13
  v_min_u32 v118, 12, v0
  v_add_u32 v118, s70, v118
  v_lshrrev_b32 v117, 1, v118
  v_mul_u32_u24 v117, 96, v117
  v_lshl_add_u32 v118, v118, 2, v117
  s_mul_i32 s78, s27, 25
  s_min_u32 s78, s78, 294
  s_add_u32 s78, s78, s71
  s_mul_i32 s78, s78, 104
  s_lshl_b32 s70, s26, 2
  s_add_u32 s70, s70, s3
  s_add_u32 s70, s70, 64
  s_mul_i32 s70, s70, 3328
  s_add_u32 s70, s70, s77
  s_mov_b32 s81, 173056
  v_lshrrev_b32 v112, 1, v0
  v_mul_lo_u32 v112, s81, v112
  v_and_b32 v117, 1, v0
  v_lshl_add_u32 v112, v117, 7, v112
  v_add_u32_e64 v112, s70, v112
  s_waitcnt lgkmcnt(0)
  s_mov_b32 s28, s4
  s_and_b32 s29, s5, 0xffff
  s_mov_b32 s30, 425984
  s_mov_b32 s31, 0x20000
  buffer_load_dwordx4 v[100:103], v118, s[28:31], s78 offen
  s_mov_b32 s32, s6
  s_and_b32 s33, s7, 0xffff
  s_mov_b32 s34, 12800000
  s_mov_b32 s35, 0x20000
  s_mov_b32 s48, s14
  s_and_b32 s49, s15, 0xffff
  s_mov_b32 s50, 3328
  s_mov_b32 s51, 0x20000
  s_mov_b32 m0, 122880
  s_mov_b64 exec, 0xffff
  buffer_load_dwordx4 v11, s[48:51], s77 offen lds
  s_mov_b64 exec, -1
  s_mov_b32 s44, s12
  s_and_b32 s45, s13, 0xffff
  s_mov_b32 s46, 5537792
  s_mov_b32 s47, 0x20000
  s_mov_b64 exec, 63
  buffer_load_dword v209, v112, s[44:47], 0 offen
  s_mov_b64 exec, -1
  s_barrier
  s_branch L_cmp
L_ld:
  s_lshr_b32 s68, s79, 1
  s_mul_i32 s68, s68, 20
  s_and_b32 s69, s79, 1
  s_add_u32 s68, s68, s69
  s_lshl_b32 s76, s68, 10
  s_mul_i32 s78, s71, 104
  s_mul_i32 s68, s68, 832
  s_add_u32 s94, s78, s68
  v_mul_u32_u24 v118, 48, v116
  v_sub_u32_e64 v12, v11, v118
  s_add_u32 s95, s94, 3328
  s_add_u32 s96, s94, 6656
  s_add_u32 s97, s94, 9984
  s_add_u32 s98, s94, 13312
  s_and_b32 s70, s79, 1
  s_lshl_b32 s70, s70, 3
  v_lshlrev_b32 v117, 1, v116
  v_or_b32 v117, s70, v117
  v_xor_b32 v117, v117, v0
  v_and_b32 v117, 15, v117
  v_mul_u32_u24 v4, 3328, v116
  v_lshl_add_u32 v4, v117, 4, v4
  v_add_u32 v5, 13312, v4
  s_mul_i32 s74, s79, 26624
  s_add_u32 s74, s74, s77
  s_lshl_b32 s75, s79, 11
  s_waitcnt lgkmcnt(0)
  s_mov_b32 s28, s4
  s_and_b32 s29, s5, 0xffff
  s_mov_b32 s30, 425984
  s_mov_b32 s31, 0x20000
  buffer_load_dwordx4 v[16:19], v12, s[28:31], s94 offen offset:0
  s_mov_b32 s32, s6
  s_and_b32 s33, s7, 0xffff
  s_mov_b32 s34, 12800000
  s_mov_b32 s35, 0x20000
  s_mov_b32 s44, s12
  s_and_b32 s45, s13, 0xffff
  s_mov_b32 s46, 5537792
  s_mov_b32 s47, 0x20000
  s_add_u32 m0, s75, 131072
  s_nop 0
  buffer_load_dwordx4 v4, s[44:47], s74 offen lds
  s_add_u32 m0, s75, 132096
  s_nop 0
  buffer_load_dwordx4 v5, s[44:47], s74 offen lds
  s_add_u32 s74, s74, 106496
  s_add_u32 m0, s75, 139264
  s_nop 0
  buffer_load_dwordx4 v4, s[44:47], s74 offen lds
  s_add_u32 m0, s75, 140288
  s_nop 0
  buffer_load_dwordx4 v5, s[44:47], s74 offen lds
  s_add_u32 s74, s74, 106496
  s_barrier
  buffer_load_dwordx4 v[20:23], v12, s[28:31], s94 offen offset:1664
  buffer_load_dwordx4 v[24:27], v12, s[28:31], s95 offen offset:0
  buffer_load_dwordx4 v[28:31], v12, s[28:31], s95 offen offset:1664
  buffer_load_dwordx4 v[32:35], v12, s[28:31], s96 offen offset:0
  buffer_load_dwordx4 v[36:39], v12, s[28:31], s96 offen offset:1664
  buffer_load_dwordx4 v[40:43], v12, s[28:31], s97 offen offset:0
  buffer_load_dwordx4 v[44:47], v12, s[28:31], s97 offen offset:1664
  buffer_load_dwordx4 v[48:51], v12, s[28:31], s98 offen offset:0
  buffer_load_dwordx4 v[52:55], v12, s[28:31], s98 offen offset:1664
  s_lshl_b32 s70, s69, 6
  v_and_b32 v118, 7, v0
  v_xor_b32 v118, v118, v116
  v_lshlrev_b32 v118, 4, v118
  v_xor_b32 v2, s70, v118
  v_xor_b32 v3, 64, v2
  s_mov_b32 s72, 0
  s_mul_i32 s70, s79, 13
  s_add_u32 s70, s70, s27
  s_min_u32 s70, s70, 39
  s_lshl_b32 s70, s70, 3
  s_add_u32 s70, s70, s71
  s_mul_i32 s84, s70, 104
  v_lshrrev_b32 v118, 2, v0
  v_min_u32 v118, 7, v118
  v_mul_u32_u24 v118, 104, v118
  v_and_b32 v117, 3, v0
  v_lshl_add_u32 v7, v117, 2, v118
  s_lshl_b32 s70, s26, 2
  s_add_u32 s70, s70, s79
  s_add_u32 s70, s70, 192
  s_mul_i32 s85, s70, 3328
  s_add_u32 s85, s85, s77
  s_mov_b32 s70, 173056
  v_lshrrev_b32 v118, 1, v0
  v_mul_lo_u32 v118, s70, v118
  v_and_b32 v117, 1, v0
  v_lshl_add_u32 v84, v117, 7, v118
  s_mov_b32 s52, s16
  s_and_b32 s53, s17, 0xffff
  s_mov_b32 s54, 3328
  s_mov_b32 s55, 0x20000
  s_mul_i32 s70, s79, 2560
  s_add_u32 s70, s70, L_tail-L_pc
  v_lshlrev_b32 v8, 7, v0
  v_add_u32 v8, s70, v8
  v_mov_b32 v9, s93
  v_add_co_u32 v8, vcc, s92, v8
  s_nop 1
  v_addc_co_u32 v9, vcc, 0, v9, vcc
  s_waitcnt vmcnt(13)
  v_lshlrev_b32 v16, 7, v16
  v_lshlrev_b32 v18, 7, v18
  v_lshlrev_b32 v17, 7, v17
  v_lshlrev_b32 v19, 7, v19
  v_add_u32_dpp v56, v16, v2 row_newbcast:0 row_mask:0xf bank_mask:0x3
  s_nop 1
  v_add_u32_dpp v56, v18, v2 row_newbcast:6 row_mask:0xf bank_mask:0xc
  s_add_u32 m0, s76, 0
  s_nop 0
  buffer_load_dwordx4 v56, s[32:35], 0 offen lds
  s_waitcnt vmcnt(10)
  s_barrier
  s_waitcnt vmcnt(9)
  v_lshlrev_b32 v20, 7, v20
  v_lshlrev_b32 v22, 7, v22
  v_lshlrev_b32 v21, 7, v21
  v_lshlrev_b32 v23, 7, v23
  v_add_u32_dpp v57, v20, v2 row_newbcast:0 row_mask:0xf bank_mask:0x3
  s_nop 1
  v_add_u32_dpp v57, v22, v2 row_newbcast:6 row_mask:0xf bank_mask:0xc
  s_add_u32 m0, s76, 2048
  s_nop 0
  buffer_load_dwordx4 v57, s[32:35], 0 offen lds
  s_waitcnt vmcnt(9)
  v_lshlrev_b32 v24, 7, v24
  v_lshlrev_b32 v26, 7, v26
  v_lshlrev_b32 v25, 7, v25
  v_lshlrev_b32 v27, 7, v27
  v_add_u32_dpp v58, v24, v2 row_newbcast:0 row_mask:0xf bank_mask:0x3
  s_nop 1
  v_add_u32_dpp v58, v26, v2 row_newbcast:6 row_mask:0xf bank_mask:0xc
  s_add_u32 m0, s76, 4096
  s_nop 0
  buffer_load_dwordx4 v58, s[32:35], 0 offen lds
  s_waitcnt vmcnt(9)
  v_lshlrev_b32 v28, 7, v28
  v_lshlrev_b32 v30, 7, v30
  v_lshlrev_b32 v29, 7, v29
  v_lshlrev_b32 v31, 7, v31
  v_add_u32_dpp v59, v28, v2 row_newbcast:0 row_mask:0xf bank_mask:0x3
  s_nop 1
  v_add_u32_dpp v59, v30, v2 row_newbcast:6 row_mask:0xf bank_mask:0xc
  s_add_u32 m0, s76, 6144
  s_nop 0
  buffer_load_dwordx4 v59, s[32:35], 0 offen lds
  s_waitcnt vmcnt(9)
  v_lshlrev_b32 v32, 7, v32
  v_lshlrev_b32 v34, 7, v34
  v_lshlrev_b32 v33, 7, v33
  v_lshlrev_b32 v35, 7, v35
  v_add_u32_dpp v60, v32, v2 row_newbcast:0 row_mask:0xf bank_mask:0x3
  s_nop 1
  v_add_u32_dpp v60, v34, v2 row_newbcast:6 row_mask:0xf bank_mask:0xc
  s_add_u32 m0, s76, 8192
  s_nop 0
  buffer_load_dwordx4 v60, s[32:35], 0 offen lds
  s_waitcnt vmcnt(9)
  v_lshlrev_b32 v36, 7, v36
  v_lshlrev_b32 v38, 7, v38
  v_lshlrev_b32 v37, 7, v37
  v_lshlrev_b32_e64 v39, 7, v39
  v_add_u32_dpp v61, v36, v2 row_newbcast:0 row_mask:0xf bank_mask:0x3
  s_nop 1
  v_add_u32_dpp v61, v38, v2 row_newbcast:6 row_mask:0xf bank_mask:0xc
  s_add_u32 m0, s76, 10240
  s_nop 0
  buffer_load_dwordx4 v61, s[32:35], 0 offen lds
  s_waitcnt vmcnt(9)
  v_lshlrev_b32 v40, 7, v40
  v_lshlrev_b32 v42, 7, v42
  v_lshlrev_b32 v41, 7, v41
  v_lshlrev_b32_e64 v43, 7, v43
  v_add_u32_dpp v62, v40, v2 row_newbcast:0 row_mask:0xf bank_mask:0x3
  s_nop 1
  v_add_u32_dpp v62, v42, v2 row_newbcast:6 row_mask:0xf bank_mask:0xc
  s_add_u32 m0, s76, 12288
  s_nop 0
  buffer_load_dwordx4 v62, s[32:35], 0 offen lds
  s_waitcnt vmcnt(9)
  v_lshlrev_b32 v44, 7, v44
  v_lshlrev_b32 v46, 7, v46
  v_lshlrev_b32 v45, 7, v45
  v_lshlrev_b32_e64 v47, 7, v47
  v_add_u32_dpp v63, v44, v2 row_newbcast:0 row_mask:0xf bank_mask:0x3
  s_nop 1
  v_add_u32_dpp v63, v46, v2 row_newbcast:6 row_mask:0xf bank_mask:0xc
  s_add_u32 m0, s76, 14336
  s_nop 0
  buffer_load_dwordx4 v63, s[32:35], 0 offen lds
  s_waitcnt vmcnt(9)
  v_lshlrev_b32 v48, 7, v48
  v_lshlrev_b32 v50, 7, v50
  v_lshlrev_b32 v49, 7, v49
  v_lshlrev_b32_e64 v51, 7, v51
  v_add_u32_dpp v64, v48, v2 row_newbcast:0 row_mask:0xf bank_mask:0x3
  s_nop 1
  v_add_u32_dpp v64, v50, v2 row_newbcast:6 row_mask:0xf bank_mask:0xc
  s_add_u32 m0, s76, 16384
  s_nop 0
  buffer_load_dwordx4 v64, s[32:35], 0 offen lds
  s_waitcnt vmcnt(9)
  v_lshlrev_b32 v52, 7, v52
  v_lshlrev_b32 v54, 7, v54
  v_lshlrev_b32 v53, 7, v53
  v_lshlrev_b32_e64 v55, 7, v55
  v_add_u32_dpp v65, v52, v2 row_newbcast:0 row_mask:0xf bank_mask:0x3
  s_nop 1
  v_add_u32_dpp v65, v54, v2 row_newbcast:6 row_mask:0xf bank_mask:0xc
  s_add_u32 m0, s76, 18432
  s_nop 0
  buffer_load_dwordx4 v65, s[32:35], 0 offen lds
  v_add_u32_dpp v56, v17, v2 row_newbcast:0 row_mask:0xf bank_mask:0x3
  s_nop 1
  v_add_u32_dpp v56, v19, v2 row_newbcast:6 row_mask:0xf bank_mask:0xc
  s_add_u32 m0, s76, 40960
  s_nop 0
  buffer_load_dwordx4 v56, s[32:35], 0 offen lds
  v_add_u32_dpp v57, v21, v2 row_newbcast:0 row_mask:0xf bank_mask:0x3
  s_nop 1
  v_add_u32_dpp v57, v23, v2 row_newbcast:6 row_mask:0xf bank_mask:0xc
  s_add_u32 m0, s76, 43008
  s_nop 0
  buffer_load_dwordx4 v57, s[32:35], 0 offen lds
  v_add_u32_dpp v58, v25, v2 row_newbcast:0 row_mask:0xf bank_mask:0x3
  s_nop 1
  v_add_u32_dpp v58, v27, v2 row_newbcast:6 row_mask:0xf bank_mask:0xc
  s_add_u32 m0, s76, 45056
  s_nop 0
  buffer_load_dwordx4 v58, s[32:35], 0 offen lds
  v_add_u32_dpp v59, v29, v2 row_newbcast:0 row_mask:0xf bank_mask:0x3
  s_nop 1
  v_add_u32_dpp v59, v31, v2 row_newbcast:6 row_mask:0xf bank_mask:0xc
  s_add_u32 m0, s76, 47104
  s_nop 0
  buffer_load_dwordx4 v59, s[32:35], 0 offen lds
  v_add_u32_dpp v60, v33, v2 row_newbcast:0 row_mask:0xf bank_mask:0x3
  s_nop 1
  v_add_u32_dpp v60, v35, v2 row_newbcast:6 row_mask:0xf bank_mask:0xc
  s_add_u32 m0, s76, 49152
  s_nop 0
  buffer_load_dwordx4 v60, s[32:35], 0 offen lds
  s_waitcnt vmcnt(11)
  s_barrier
  v_add_u32_dpp v61, v37, v2 row_newbcast:0 row_mask:0xf bank_mask:0x3
  s_nop 1
  v_add_u32_dpp v61, v39, v2 row_newbcast:6 row_mask:0xf bank_mask:0xc
  s_add_u32 m0, s76, 51200
  s_nop 0
  buffer_load_dwordx4 v61, s[32:35], 0 offen lds
  v_add_u32_dpp v62, v41, v2 row_newbcast:0 row_mask:0xf bank_mask:0x3
  s_nop 1
  v_add_u32_dpp v62, v43, v2 row_newbcast:6 row_mask:0xf bank_mask:0xc
  s_add_u32 m0, s76, 53248
  s_nop 0
  buffer_load_dwordx4 v62, s[32:35], 0 offen lds
  v_add_u32_dpp v63, v45, v2 row_newbcast:0 row_mask:0xf bank_mask:0x3
  s_nop 1
  v_add_u32_dpp v63, v47, v2 row_newbcast:6 row_mask:0xf bank_mask:0xc
  s_add_u32 m0, s76, 55296
  s_nop 0
  buffer_load_dwordx4 v63, s[32:35], 0 offen lds
  v_add_u32_dpp v64, v49, v2 row_newbcast:0 row_mask:0xf bank_mask:0x3
  s_nop 1
  v_add_u32_dpp v64, v51, v2 row_newbcast:6 row_mask:0xf bank_mask:0xc
  s_add_u32 m0, s76, 57344
  s_nop 0
  buffer_load_dwordx4 v64, s[32:35], 0 offen lds
  v_add_u32_dpp v65, v53, v2 row_newbcast:0 row_mask:0xf bank_mask:0x3
  s_nop 1
  v_add_u32_dpp v65, v55, v2 row_newbcast:6 row_mask:0xf bank_mask:0xc
  s_add_u32 m0, s76, 59392
  s_nop 0
  buffer_load_dwordx4 v65, s[32:35], 0 offen lds
  s_waitcnt vmcnt(10)
  s_barrier
  s_add_u32 m0, s75, 147456
  s_nop 0
  buffer_load_dwordx4 v4, s[44:47], s74 offen lds
  s_add_u32 m0, s75, 148480
  s_nop 0
  buffer_load_dwordx4 v5, s[44:47], s74 offen lds
  s_add_u32 s74, s74, 106496
  s_add_u32 m0, s75, 155648
  s_nop 0
  buffer_load_dwordx4 v4, s[44:47], s74 offen lds
  s_add_u32 m0, s75, 156672
  s_nop 0
  buffer_load_dwordx4 v5, s[44:47], s74 offen lds
  s_add_u32 s74, s74, 106496
  v_add_u32_dpp v56, v18, v2 row_newbcast:0 row_mask:0xf bank_mask:0x3
  v_add_u32_dpp v57, v22, v2 row_newbcast:0 row_mask:0xf bank_mask:0x3
  v_add_u32_dpp v58, v26, v2 row_newbcast:0 row_mask:0xf bank_mask:0x3
  v_add_u32_dpp v59, v30, v2 row_newbcast:0 row_mask:0xf bank_mask:0x3
  v_add_u32_dpp v60, v34, v2 row_newbcast:0 row_mask:0xf bank_mask:0x3
  v_add_u32_dpp v61, v38, v2 row_newbcast:0 row_mask:0xf bank_mask:0x3
  v_add_u32_dpp v62, v42, v2 row_newbcast:0 row_mask:0xf bank_mask:0x3
  v_add_u32_dpp v63, v46, v2 row_newbcast:0 row_mask:0xf bank_mask:0x3
  v_add_u32_dpp v64, v50, v2 row_newbcast:0 row_mask:0xf bank_mask:0x3
  v_add_u32_dpp v65, v54, v2 row_newbcast:0 row_mask:0xf bank_mask:0x3
  v_add_u32_dpp v56, v16, v2 row_newbcast:7 row_mask:0xf bank_mask:0xc
  v_add_u32_dpp v57, v20, v2 row_newbcast:7 row_mask:0xf bank_mask:0xc
  v_add_u32_dpp v58, v24, v2 row_newbcast:7 row_mask:0xf bank_mask:0xc
  v_add_u32_dpp v59, v28, v2 row_newbcast:7 row_mask:0xf bank_mask:0xc
  v_add_u32_dpp v60, v32, v2 row_newbcast:7 row_mask:0xf bank_mask:0xc
  v_add_u32_dpp v61, v36, v2 row_newbcast:7 row_mask:0xf bank_mask:0xc
  v_add_u32_dpp v62, v40, v2 row_newbcast:7 row_mask:0xf bank_mask:0xc
  v_add_u32_dpp v63, v44, v2 row_newbcast:7 row_mask:0xf bank_mask:0xc
  v_add_u32_dpp v64, v48, v2 row_newbcast:7 row_mask:0xf bank_mask:0xc
  v_add_u32_dpp v65, v52, v2 row_newbcast:7 row_mask:0xf bank_mask:0xc
  buffer_load_dword v70, v7, s[28:31], s84 offen offset:32
  buffer_load_dword v71, v7, s[28:31], s84 offen offset:48
  buffer_load_dword v72, v7, s[28:31], s84 offen offset:64
  buffer_load_dword v73, v7, s[28:31], s84 offen offset:80
  buffer_load_dword v74, v7, s[28:31], s84 offen offset:88
  s_add_u32 m0, s76, 81920
  s_nop 0
  buffer_load_dwordx4 v56, s[32:35], 0 offen lds
  s_add_u32 m0, s76, 83968
  s_nop 0
  buffer_load_dwordx4 v57, s[32:35], 0 offen lds
  s_add_u32 m0, s76, 86016
  s_nop 0
  buffer_load_dwordx4 v58, s[32:35], 0 offen lds
  s_add_u32 m0, s76, 88064
  s_nop 0
  buffer_load_dwordx4 v59, s[32:35], 0 offen lds
  s_add_u32 m0, s76, 90112
  s_nop 0
  buffer_load_dwordx4 v60, s[32:35], 0 offen lds
  s_add_u32 m0, s76, 92160
  s_nop 0
  buffer_load_dwordx4 v61, s[32:35], 0 offen lds
  s_add_u32 m0, s76, 94208
  s_nop 0
  buffer_load_dwordx4 v62, s[32:35], 0 offen lds
  s_add_u32 m0, s76, 96256
  s_nop 0
  buffer_load_dwordx4 v63, s[32:35], 0 offen lds
  s_waitcnt vmcnt(13)
  s_barrier
  s_add_u32 m0, s76, 98304
  s_nop 0
  buffer_load_dwordx4 v64, s[32:35], 0 offen lds
  s_add_u32 m0, s76, 100352
  s_nop 0
  buffer_load_dwordx4 v65, s[32:35], 0 offen lds
  v_add_u32_dpp v56, v19, v2 row_newbcast:0 row_mask:0xf bank_mask:0x3
  v_add_u32_dpp v57, v23, v2 row_newbcast:0 row_mask:0xf bank_mask:0x3
  v_add_u32_dpp v58, v27, v2 row_newbcast:0 row_mask:0xf bank_mask:0x3
  v_add_u32_dpp v59, v31, v2 row_newbcast:0 row_mask:0xf bank_mask:0x3
  v_add_u32_dpp v60, v35, v2 row_newbcast:0 row_mask:0xf bank_mask:0x3
  v_add_u32_dpp v61, v39, v2 row_newbcast:0 row_mask:0xf bank_mask:0x3
  v_add_u32_dpp v62, v43, v2 row_newbcast:0 row_mask:0xf bank_mask:0x3
  v_add_u32_dpp v63, v47, v2 row_newbcast:0 row_mask:0xf bank_mask:0x3
  v_add_u32_dpp v64, v51, v2 row_newbcast:0 row_mask:0xf bank_mask:0x3
  v_add_u32_dpp v65, v55, v2 row_newbcast:0 row_mask:0xf bank_mask:0x3
  v_add_u32_dpp v56, v17, v2 row_newbcast:7 row_mask:0xf bank_mask:0xc
  v_add_u32_dpp v57, v21, v2 row_newbcast:7 row_mask:0xf bank_mask:0xc
  v_add_u32_dpp v58, v25, v2 row_newbcast:7 row_mask:0xf bank_mask:0xc
  v_add_u32_dpp v59, v29, v2 row_newbcast:7 row_mask:0xf bank_mask:0xc
  v_add_u32_dpp v60, v33, v2 row_newbcast:7 row_mask:0xf bank_mask:0xc
  v_add_u32_dpp v61, v37, v2 row_newbcast:7 row_mask:0xf bank_mask:0xc
  v_add_u32_dpp v62, v41, v2 row_newbcast:7 row_mask:0xf bank_mask:0xc
  v_add_u32_dpp v63, v45, v2 row_newbcast:7 row_mask:0xf bank_mask:0xc
  v_add_u32_dpp v64, v49, v2 row_newbcast:7 row_mask:0xf bank_mask:0xc
  v_add_u32_dpp v65, v53, v2 row_newbcast:7 row_mask:0xf bank_mask:0xc
  s_setprio 0
  s_branch L_ld_in
L_cmp:
  s_and_b32 s68, s3, 1
  s_lshr_b32 s69, s3, 1
  v_bfe_u32 v117, v0, 2, 2
  v_lshl_add_u32 v118, v116, 3, v117
  v_lshlrev_b32 v118, 8, v118
  v_bfe_u32 v117, v0, 2, 3
  s_lshl_b32 s70, s69, 2
  v_xor_b32 v117, s70, v117
  v_lshl_add_u32 v118, v117, 5, v118
  v_and_b32 v117, 3, v0
  v_lshl_add_u32 v118, v117, 3, v118
  v_add_u32 v1, 131072, v118
  v_xor_b32 v2, 32, v1
  v_xor_b32 v3, 64, v1
  v_xor_b32 v4, 96, v1
  s_lshl_b32 s70, s69, 7
  s_add_u32 s70, s70, 122880
  v_lshlrev_b32 v118, 3, v116
  v_add_u32 v9, s70, v118
  v_and_b32 v118, 15, v0
  v_lshlrev_b32 v118, 7, v118
  v_bfe_u32 v117, v0, 1, 3
  v_xor_b32 v117, v117, v116
  v_lshl_add_u32 v118, v117, 4, v118
  s_mul_i32 s70, s68, 20480
  v_add_u32 v5, s70, v118
  v_xor_b32 v7, 64, v5
  v_add_u32 v6, 81920, v5
  v_add_u32 v8, 81920, v7
  s_mul_i32 s70, s3, 640
  s_add_u32 s70, s70, 123392
  v_and_b32 v118, 15, v0
  v_lshlrev_b32 v118, 2, v118
  v_add_u32 v118, s70, v118
  v_lshrrev_b32 v117, 5, v0
  v_lshl_add_u32 v118, v117, 6, v118
  v_bfe_u32 v117, v0, 4, 1
  v_lshl_add_u32 v10, v117, 7, v118
  s_mov_b32 s72, 0
  v_mov_b32 v12, 0xc0135761
  v_mov_b32 v13, 0xc0135761
  v_mov_b32 v14, 0xbdd2d3e8
  v_mov_b32 v15, 0xbdd2d3e8
  s_waitcnt vmcnt(2)
  v_lshlrev_b32 v100, 7, v100
  buffer_load_dword v200, v100, s[32:35], 0 offen
  v_lshlrev_b32 v102, 7, v102
  buffer_load_dword v202, v102, s[32:35], 0 offen
  s_barrier
  ds_read_b64_tr_b16 v[16:17], v1 offset:0
  ds_read_b64_tr_b16 v[18:19], v1 offset:1024
  ds_read_b64_tr_b16 v[32:33], v1 offset:8192
  ds_read_b64_tr_b16 v[34:35], v1 offset:9216
  ds_read_b64_tr_b16 v[20:21], v2 offset:0
  ds_read_b64_tr_b16 v[22:23], v2 offset:1024
  ds_read_b64_tr_b16 v[36:37], v2 offset:8192
  ds_read_b64_tr_b16 v[38:39], v2 offset:9216
  ds_read_b64_tr_b16 v[24:25], v3 offset:0
  ds_read_b64_tr_b16 v[26:27], v3 offset:1024
  ds_read_b64_tr_b16 v[40:41], v3 offset:8192
  ds_read_b64_tr_b16 v[42:43], v3 offset:9216
  ds_read_b64_tr_b16 v[28:29], v4 offset:0
  ds_read_b64_tr_b16 v[30:31], v4 offset:1024
  ds_read_b64_tr_b16 v[44:45], v4 offset:8192
  ds_read_b64_tr_b16 v[46:47], v4 offset:9216
  s_waitcnt vmcnt(3)
  ds_read_b64 v[234:235], v9 offset:0
  ds_read_b64 v[238:239], v9 offset:32
  ds_read_b64 v[242:243], v9 offset:64
  ds_read_b64 v[246:247], v9 offset:96
  s_waitcnt lgkmcnt(3)
  v_lshlrev_b32 v232, 16, v234
  v_and_b32 v233, 0xffff0000, v234
  v_lshlrev_b32 v234, 16, v235
  v_and_b32 v235, 0xffff0000, v235
  s_waitcnt lgkmcnt(2)
  v_lshlrev_b32 v236, 16, v238
  v_and_b32 v237, 0xffff0000, v238
  v_lshlrev_b32 v238, 16, v239
  v_and_b32 v239, 0xffff0000, v239
  s_waitcnt lgkmcnt(1)
  v_lshlrev_b32 v240, 16, v242
  v_and_b32 v241, 0xffff0000, v242
  v_lshlrev_b32_e64 v242, 16, v243
  v_and_b32 v243, 0xffff0000, v243
  s_waitcnt lgkmcnt(0)
  v_lshlrev_b32 v244, 16, v246
  v_and_b32 v245, 0xffff0000, v246
  v_lshlrev_b32 v246, 16, v247
  v_and_b32 v247, 0xffff0000, v247
  v_mov_b64 v[216:217], v[232:233]
  v_mov_b64 v[218:219], v[234:235]
  v_mov_b64 v[220:221], v[236:237]
  v_mov_b64 v[222:223], v[238:239]
  v_mov_b64 v[224:225], v[240:241]
  v_mov_b64 v[226:227], v[242:243]
  v_mov_b64 v[228:229], v[244:245]
  v_mov_b64 v[230:231], v[246:247]
  s_waitcnt lgkmcnt(0)
  s_setprio 1
  s_barrier
  ds_read_b128 v[48:51], v5 offset:0
  ds_read_b128 v[52:55], v7 offset:0
  ds_read_b128 v[56:59], v5 offset:2048
  ds_read_b128 v[60:63], v7 offset:2048
  ds_read_b128 v[64:67], v5 offset:4096
  ds_read_b128 v[68:71], v7 offset:4096
  ds_read_b128 v[72:75], v5 offset:6144
  ds_read_b128 v[76:79], v7 offset:6144
  s_waitcnt lgkmcnt(7)
  v_mfma_f32_16x16x32_bf16 v[88:91], v[16:19], v[48:51], v[232:235]
  s_waitcnt lgkmcnt(4)
  v_mfma_f32_16x16x32_bf16 v[88:91], v[32:35], v[52:55], v[88:91]
  v_mfma_f32_16x16x32_bf16 v[104:107], v[32:35], v[60:63], v[232:235]
  v_mfma_f32_16x16x32_bf16 v[104:107], v[16:19], v[56:59], v[104:107]
  v_mfma_f32_16x16x32_bf16 v[108:111], v[20:23], v[56:59], v[236:239]
  v_mfma_f32_16x16x32_bf16 v[108:111], v[36:39], v[60:63], v[108:111]
  v_mfma_f32_16x16x32_bf16 v[92:95], v[36:39], v[52:55], v[236:239]
  v_mfma_f32_16x16x32_bf16 v[92:95], v[20:23], v[48:51], v[92:95]
  v_mfma_f32_16x16x32_bf16 v[96:99], v[24:27], v[48:51], v[240:243]
  v_xor_b32 v1, 16384, v1
  v_mfma_f32_16x16x32_bf16 v[96:99], v[40:43], v[52:55], v[96:99]
  v_xor_b32 v2, 16384, v2
  v_mfma_f32_16x16x32_bf16 v[112:115], v[40:43], v[60:63], v[240:243]
  v_xor_b32 v3, 16384, v3
  v_mfma_f32_16x16x32_bf16 v[112:115], v[24:27], v[56:59], v[112:115]
  v_xor_b32 v4, 16384, v4
  v_mfma_f32_16x16x32_bf16 v[116:119], v[28:31], v[56:59], v[244:247]
  v_mfma_f32_16x16x32_bf16 v[116:119], v[44:47], v[60:63], v[116:119]
  v_mfma_f32_16x16x32_bf16 v[100:103], v[44:47], v[52:55], v[244:247]
  s_waitcnt lgkmcnt(2)
  v_mfma_f32_16x16x32_bf16 v[100:103], v[28:31], v[48:51], v[100:103]
  v_mfma_f32_16x16x32_bf16 v[120:123], v[16:19], v[64:67], v[232:235]
  s_barrier
  s_waitcnt lgkmcnt(0)
  v_mfma_f32_16x16x32_bf16 v[120:123], v[32:35], v[68:71], v[120:123]
  ds_read_b128 v[80:83], v5 offset:8192
  v_mfma_f32_16x16x32_bf16 v[136:139], v[32:35], v[76:79], v[232:235]
  ds_read_b128 v[84:87], v7 offset:8192
  v_mfma_f32_16x16x32_bf16 v[136:139], v[16:19], v[72:75], v[136:139]
  ds_read_b128 v[48:51], v5 offset:10240
  v_mfma_f32_16x16x32_bf16 v[140:143], v[20:23], v[72:75], v[236:239]
  ds_read_b128 v[52:55], v7 offset:10240
  v_mfma_f32_16x16x32_bf16 v[140:143], v[36:39], v[76:79], v[140:143]
  ds_read_b128 v[56:59], v5 offset:12288
  v_mfma_f32_16x16x32_bf16 v[124:127], v[36:39], v[68:71], v[236:239]
  ds_read_b128 v[60:63], v7 offset:12288
  v_mfma_f32_16x16x32_bf16 v[124:127], v[20:23], v[64:67], v[124:127]
  v_mfma_f32_16x16x32_bf16 v[128:131], v[24:27], v[64:67], v[240:243]
  v_mfma_f32_16x16x32_bf16 v[128:131], v[40:43], v[68:71], v[128:131]
  v_mfma_f32_16x16x32_bf16 v[144:147], v[40:43], v[76:79], v[240:243]
  v_mfma_f32_16x16x32_bf16 v[144:147], v[24:27], v[72:75], v[144:147]
  v_mfma_f32_16x16x32_bf16 v[148:151], v[28:31], v[72:75], v[244:247]
  ds_read_b128 v[72:75], v5 offset:16384
  v_mfma_f32_16x16x32_bf16 v[148:151], v[44:47], v[76:79], v[148:151]
  ds_read_b128 v[76:79], v7 offset:16384
  v_mfma_f32_16x16x32_bf16 v[132:135], v[44:47], v[68:71], v[244:247]
  ds_read_b128 v[68:71], v7 offset:14336
  s_waitcnt lgkmcnt(7)
  v_mfma_f32_16x16x32_bf16 v[132:135], v[28:31], v[64:67], v[132:135]
  ds_read_b128 v[64:67], v5 offset:14336
  v_mfma_f32_16x16x32_bf16 v[152:155], v[16:19], v[80:83], v[232:235]
  s_waitcnt lgkmcnt(6)
  v_mfma_f32_16x16x32_bf16 v[152:155], v[32:35], v[84:87], v[152:155]
  v_mfma_f32_16x16x32_bf16 v[168:171], v[32:35], v[52:55], v[232:235]
  v_mfma_f32_16x16x32_bf16 v[168:171], v[16:19], v[48:51], v[168:171]
  v_mfma_f32_16x16x32_bf16 v[172:175], v[20:23], v[48:51], v[236:239]
  v_mfma_f32_16x16x32_bf16 v[172:175], v[36:39], v[52:55], v[172:175]
  v_mfma_f32_16x16x32_bf16 v[156:159], v[36:39], v[84:87], v[236:239]
  v_mfma_f32_16x16x32_bf16 v[156:159], v[20:23], v[80:83], v[156:159]
  v_mfma_f32_16x16x32_bf16 v[160:163], v[24:27], v[80:83], v[240:243]
  v_mfma_f32_16x16x32_bf16 v[160:163], v[40:43], v[84:87], v[160:163]
  v_mfma_f32_16x16x32_bf16 v[176:179], v[40:43], v[52:55], v[240:243]
  v_mfma_f32_16x16x32_bf16 v[176:179], v[24:27], v[48:51], v[176:179]
  v_mfma_f32_16x16x32_bf16 v[180:183], v[28:31], v[48:51], v[244:247]
  v_mfma_f32_16x16x32_bf16 v[180:183], v[44:47], v[52:55], v[180:183]
  v_mfma_f32_16x16x32_bf16 v[164:167], v[44:47], v[84:87], v[244:247]
  ds_read_b128 v[84:87], v7 offset:18432
  s_waitcnt lgkmcnt(5)
  v_mfma_f32_16x16x32_bf16 v[164:167], v[28:31], v[80:83], v[164:167]
  ds_read_b128 v[80:83], v5 offset:18432
  v_mfma_f32_16x16x32_bf16 v[184:187], v[16:19], v[56:59], v[232:235]
  s_waitcnt lgkmcnt(2)
  v_mfma_f32_16x16x32_bf16 v[184:187], v[32:35], v[60:63], v[184:187]
  s_waitcnt vmcnt(0)
  v_mfma_f32_16x16x32_bf16 v[200:203], v[32:35], v[68:71], v[232:235]
  v_mfma_f32_16x16x32_bf16 v[200:203], v[16:19], v[64:67], v[200:203]
  v_mfma_f32_16x16x32_bf16 v[204:207], v[20:23], v[64:67], v[236:239]
  v_mfma_f32_16x16x32_bf16 v[204:207], v[36:39], v[68:71], v[204:207]
  s_waitcnt lgkmcnt(0)
  s_barrier
  v_mfma_f32_16x16x32_bf16 v[188:191], v[36:39], v[60:63], v[236:239]
  ds_read_b128 v[48:51], v5 offset:40960
  v_mfma_f32_16x16x32_bf16 v[188:191], v[20:23], v[56:59], v[188:191]
  ds_read_b128 v[52:55], v7 offset:40960
  v_mfma_f32_16x16x32_bf16 v[192:195], v[24:27], v[56:59], v[240:243]
  v_mfma_f32_16x16x32_bf16 v[192:195], v[40:43], v[60:63], v[192:195]
  v_mfma_f32_16x16x32_bf16 v[208:211], v[40:43], v[68:71], v[240:243]
  v_mfma_f32_16x16x32_bf16 v[208:211], v[24:27], v[64:67], v[208:211]
  v_mfma_f32_16x16x32_bf16 v[212:215], v[28:31], v[64:67], v[244:247]
  ds_read_b128 v[64:67], v5 offset:45056
  v_mfma_f32_16x16x32_bf16 v[212:215], v[44:47], v[68:71], v[212:215]
  ds_read_b128 v[68:71], v7 offset:45056
  v_mfma_f32_16x16x32_bf16 v[196:199], v[44:47], v[60:63], v[244:247]
  ds_read_b128 v[60:63], v7 offset:43008
  v_mfma_f32_16x16x32_bf16 v[196:199], v[28:31], v[56:59], v[196:199]
  ds_read_b128 v[56:59], v5 offset:43008
  v_mfma_f32_16x16x32_bf16 v[216:219], v[32:35], v[76:79], v[216:219]
  v_mfma_f32_16x16x32_bf16 v[216:219], v[16:19], v[72:75], v[216:219]
  v_mfma_f32_16x16x32_bf16 v[232:235], v[16:19], v[80:83], v[232:235]
  ds_read_b64_tr_b16 v[16:17], v1 offset:0
  v_mfma_f32_16x16x32_bf16 v[232:235], v[32:35], v[84:87], v[232:235]
  ds_read_b64_tr_b16 v[18:19], v1 offset:1024
  v_mfma_f32_16x16x32_bf16 v[236:239], v[36:39], v[84:87], v[236:239]
  ds_read_b64_tr_b16 v[32:33], v1 offset:8192
  v_mfma_f32_16x16x32_bf16 v[236:239], v[20:23], v[80:83], v[236:239]
  ds_read_b64_tr_b16 v[34:35], v1 offset:9216
  v_mfma_f32_16x16x32_bf16 v[220:223], v[20:23], v[72:75], v[220:223]
  ds_read_b64_tr_b16 v[20:21], v2 offset:0
  v_mfma_f32_16x16x32_bf16 v[220:223], v[36:39], v[76:79], v[220:223]
  ds_read_b64_tr_b16 v[22:23], v2 offset:1024
  v_mfma_f32_16x16x32_bf16 v[224:227], v[40:43], v[76:79], v[224:227]
  ds_read_b64_tr_b16 v[36:37], v2 offset:8192
  v_mfma_f32_16x16x32_bf16 v[224:227], v[24:27], v[72:75], v[224:227]
  ds_read_b64_tr_b16 v[38:39], v2 offset:9216
  v_mfma_f32_16x16x32_bf16 v[240:243], v[24:27], v[80:83], v[240:243]
  ds_read_b64_tr_b16 v[24:25], v3 offset:0
  v_mfma_f32_16x16x32_bf16 v[240:243], v[40:43], v[84:87], v[240:243]
  ds_read_b64_tr_b16 v[26:27], v3 offset:1024
  v_mfma_f32_16x16x32_bf16 v[244:247], v[44:47], v[84:87], v[244:247]
  ds_read_b64_tr_b16 v[40:41], v3 offset:8192
  v_mfma_f32_16x16x32_bf16 v[244:247], v[28:31], v[80:83], v[244:247]
  ds_read_b64_tr_b16 v[42:43], v3 offset:9216
  v_mfma_f32_16x16x32_bf16 v[228:231], v[28:31], v[72:75], v[228:231]
  ds_read_b64_tr_b16 v[28:29], v4 offset:0
  s_waitcnt lgkmcnt(9)
  v_mfma_f32_16x16x32_bf16 v[228:231], v[44:47], v[76:79], v[228:231]
  ds_read_b64_tr_b16 v[30:31], v4 offset:1024
L_dnn_loop0:
  v_mfma_f32_16x16x32_bf16 v[88:91], v[16:19], v[48:51], v[88:91]
  ds_read_b64_tr_b16 v[44:45], v4 offset:8192
  v_mfma_f32_16x16x32_bf16 v[88:91], v[32:35], v[52:55], v[88:91]
  ds_read_b64_tr_b16 v[46:47], v4 offset:9216
  v_mfma_f32_16x16x32_bf16 v[104:107], v[32:35], v[60:63], v[104:107]
  ds_read_b128 v[72:75], v5 offset:47104
  s_waitcnt lgkmcnt(9)
  v_mfma_f32_16x16x32_bf16 v[104:107], v[16:19], v[56:59], v[104:107]
  ds_read_b128 v[76:79], v7 offset:47104
  v_mfma_f32_16x16x32_bf16 v[108:111], v[20:23], v[56:59], v[108:111]
  ds_read_b128 v[80:83], v5 offset:49152
  v_mfma_f32_16x16x32_bf16 v[108:111], v[36:39], v[60:63], v[108:111]
  ds_read_b128 v[84:87], v7 offset:49152
  v_mfma_f32_16x16x32_bf16 v[92:95], v[36:39], v[52:55], v[92:95]
  s_waitcnt lgkmcnt(8)
  v_mfma_f32_16x16x32_bf16 v[92:95], v[20:23], v[48:51], v[92:95]
  v_mfma_f32_16x16x32_bf16 v[96:99], v[24:27], v[48:51], v[96:99]
  v_xor_b32 v1, 16384, v1
  v_mfma_f32_16x16x32_bf16 v[96:99], v[40:43], v[52:55], v[96:99]
  v_xor_b32 v2, 16384, v2
  v_mfma_f32_16x16x32_bf16 v[112:115], v[40:43], v[60:63], v[112:115]
  v_xor_b32 v3, 16384, v3
  s_waitcnt lgkmcnt(4)
  v_mfma_f32_16x16x32_bf16 v[112:115], v[24:27], v[56:59], v[112:115]
  v_xor_b32 v4, 16384, v4
  v_mfma_f32_16x16x32_bf16 v[116:119], v[28:31], v[56:59], v[116:119]
  ds_read_b128 v[56:59], v5 offset:53248
  v_mfma_f32_16x16x32_bf16 v[116:119], v[44:47], v[60:63], v[116:119]
  ds_read_b128 v[60:63], v7 offset:53248
  v_mfma_f32_16x16x32_bf16 v[100:103], v[44:47], v[52:55], v[100:103]
  ds_read_b128 v[52:55], v7 offset:51200
  v_mfma_f32_16x16x32_bf16 v[100:103], v[28:31], v[48:51], v[100:103]
  ds_read_b128 v[48:51], v5 offset:51200
  v_mfma_f32_16x16x32_bf16 v[120:123], v[16:19], v[64:67], v[120:123]
  s_waitcnt lgkmcnt(6)
  v_mfma_f32_16x16x32_bf16 v[120:123], v[32:35], v[68:71], v[120:123]
  v_mfma_f32_16x16x32_bf16 v[136:139], v[32:35], v[76:79], v[136:139]
  v_mfma_f32_16x16x32_bf16 v[136:139], v[16:19], v[72:75], v[136:139]
  v_mfma_f32_16x16x32_bf16 v[140:143], v[20:23], v[72:75], v[140:143]
  v_mfma_f32_16x16x32_bf16 v[140:143], v[36:39], v[76:79], v[140:143]
  v_mfma_f32_16x16x32_bf16 v[124:127], v[36:39], v[68:71], v[124:127]
  v_mfma_f32_16x16x32_bf16 v[124:127], v[20:23], v[64:67], v[124:127]
  v_mfma_f32_16x16x32_bf16 v[128:131], v[24:27], v[64:67], v[128:131]
  v_mfma_f32_16x16x32_bf16 v[128:131], v[40:43], v[68:71], v[128:131]
  v_mfma_f32_16x16x32_bf16 v[144:147], v[40:43], v[76:79], v[144:147]
  v_mfma_f32_16x16x32_bf16 v[144:147], v[24:27], v[72:75], v[144:147]
  v_mfma_f32_16x16x32_bf16 v[148:151], v[28:31], v[72:75], v[148:151]
  ds_read_b128 v[72:75], v5 offset:57344
  v_mfma_f32_16x16x32_bf16 v[148:151], v[44:47], v[76:79], v[148:151]
  ds_read_b128 v[76:79], v7 offset:57344
  v_mfma_f32_16x16x32_bf16 v[132:135], v[44:47], v[68:71], v[132:135]
  ds_read_b128 v[68:71], v7 offset:55296
  s_waitcnt lgkmcnt(7)
  v_mfma_f32_16x16x32_bf16 v[132:135], v[28:31], v[64:67], v[132:135]
  ds_read_b128 v[64:67], v5 offset:55296
  v_mfma_f32_16x16x32_bf16 v[152:155], v[16:19], v[80:83], v[152:155]
  s_waitcnt lgkmcnt(4)
  v_mfma_f32_16x16x32_bf16 v[152:155], v[32:35], v[84:87], v[152:155]
  v_mfma_f32_16x16x32_bf16 v[168:171], v[32:35], v[52:55], v[168:171]
  v_mfma_f32_16x16x32_bf16 v[168:171], v[16:19], v[48:51], v[168:171]
  v_mfma_f32_16x16x32_bf16 v[172:175], v[20:23], v[48:51], v[172:175]
  v_mfma_f32_16x16x32_bf16 v[172:175], v[36:39], v[52:55], v[172:175]
  v_mfma_f32_16x16x32_bf16 v[156:159], v[36:39], v[84:87], v[156:159]
  v_mfma_f32_16x16x32_bf16 v[156:159], v[20:23], v[80:83], v[156:159]
  v_mfma_f32_16x16x32_bf16 v[160:163], v[24:27], v[80:83], v[160:163]
  v_mfma_f32_16x16x32_bf16 v[160:163], v[40:43], v[84:87], v[160:163]
  v_mfma_f32_16x16x32_bf16 v[176:179], v[40:43], v[52:55], v[176:179]
  v_mfma_f32_16x16x32_bf16 v[176:179], v[24:27], v[48:51], v[176:179]
  v_mfma_f32_16x16x32_bf16 v[180:183], v[28:31], v[48:51], v[180:183]
  v_mfma_f32_16x16x32_bf16 v[180:183], v[44:47], v[52:55], v[180:183]
  v_mfma_f32_16x16x32_bf16 v[164:167], v[44:47], v[84:87], v[164:167]
  ds_read_b128 v[84:87], v7 offset:59392
  v_mfma_f32_16x16x32_bf16 v[164:167], v[28:31], v[80:83], v[164:167]
  ds_read_b128 v[80:83], v5 offset:59392
  v_mfma_f32_16x16x32_bf16 v[184:187], v[16:19], v[56:59], v[184:187]
  s_waitcnt lgkmcnt(2)
  v_mfma_f32_16x16x32_bf16 v[184:187], v[32:35], v[60:63], v[184:187]
  v_mfma_f32_16x16x32_bf16 v[200:203], v[32:35], v[68:71], v[200:203]
  v_mfma_f32_16x16x32_bf16 v[200:203], v[16:19], v[64:67], v[200:203]
  v_mfma_f32_16x16x32_bf16 v[204:207], v[20:23], v[64:67], v[204:207]
  v_mfma_f32_16x16x32_bf16 v[204:207], v[36:39], v[68:71], v[204:207]
  s_waitcnt lgkmcnt(0)
  s_barrier
  v_mfma_f32_16x16x32_bf16 v[188:191], v[36:39], v[60:63], v[188:191]
  ds_read_b128 v[48:51], v6 offset:0
  v_mfma_f32_16x16x32_bf16 v[188:191], v[20:23], v[56:59], v[188:191]
  ds_read_b128 v[52:55], v8 offset:0
  v_mfma_f32_16x16x32_bf16 v[192:195], v[24:27], v[56:59], v[192:195]
  v_mfma_f32_16x16x32_bf16 v[192:195], v[40:43], v[60:63], v[192:195]
  v_mfma_f32_16x16x32_bf16 v[208:211], v[40:43], v[68:71], v[208:211]
  v_mfma_f32_16x16x32_bf16 v[208:211], v[24:27], v[64:67], v[208:211]
  v_mfma_f32_16x16x32_bf16 v[212:215], v[28:31], v[64:67], v[212:215]
  ds_read_b128 v[64:67], v6 offset:4096
  v_mfma_f32_16x16x32_bf16 v[212:215], v[44:47], v[68:71], v[212:215]
  ds_read_b128 v[68:71], v8 offset:4096
  v_mfma_f32_16x16x32_bf16 v[196:199], v[44:47], v[60:63], v[196:199]
  ds_read_b128 v[60:63], v8 offset:2048
  v_mfma_f32_16x16x32_bf16 v[196:199], v[28:31], v[56:59], v[196:199]
  ds_read_b128 v[56:59], v6 offset:2048
  v_mfma_f32_16x16x32_bf16 v[216:219], v[32:35], v[76:79], v[216:219]
  v_mfma_f32_16x16x32_bf16 v[216:219], v[16:19], v[72:75], v[216:219]
  v_mfma_f32_16x16x32_bf16 v[232:235], v[16:19], v[80:83], v[232:235]
  ds_read_b64_tr_b16 v[16:17], v1 offset:0
  v_mfma_f32_16x16x32_bf16 v[232:235], v[32:35], v[84:87], v[232:235]
  ds_read_b64_tr_b16 v[18:19], v1 offset:1024
  v_mfma_f32_16x16x32_bf16 v[236:239], v[36:39], v[84:87], v[236:239]
  ds_read_b64_tr_b16 v[32:33], v1 offset:8192
  v_mfma_f32_16x16x32_bf16 v[236:239], v[20:23], v[80:83], v[236:239]
  ds_read_b64_tr_b16 v[34:35], v1 offset:9216
  v_mfma_f32_16x16x32_bf16 v[220:223], v[20:23], v[72:75], v[220:223]
  ds_read_b64_tr_b16 v[20:21], v2 offset:0
  v_mfma_f32_16x16x32_bf16 v[220:223], v[36:39], v[76:79], v[220:223]
  ds_read_b64_tr_b16 v[22:23], v2 offset:1024
  v_mfma_f32_16x16x32_bf16 v[224:227], v[40:43], v[76:79], v[224:227]
  ds_read_b64_tr_b16 v[36:37], v2 offset:8192
  v_mfma_f32_16x16x32_bf16 v[224:227], v[24:27], v[72:75], v[224:227]
  ds_read_b64_tr_b16 v[38:39], v2 offset:9216
  v_mfma_f32_16x16x32_bf16 v[240:243], v[24:27], v[80:83], v[240:243]
  ds_read_b64_tr_b16 v[24:25], v3 offset:0
  v_mfma_f32_16x16x32_bf16 v[240:243], v[40:43], v[84:87], v[240:243]
  ds_read_b64_tr_b16 v[26:27], v3 offset:1024
  v_mfma_f32_16x16x32_bf16 v[244:247], v[44:47], v[84:87], v[244:247]
  ds_read_b64_tr_b16 v[40:41], v3 offset:8192
  v_mfma_f32_16x16x32_bf16 v[244:247], v[28:31], v[80:83], v[244:247]
  ds_read_b64_tr_b16 v[42:43], v3 offset:9216
  v_mfma_f32_16x16x32_bf16 v[228:231], v[28:31], v[72:75], v[228:231]
  ds_read_b64_tr_b16 v[28:29], v4 offset:0
  s_waitcnt lgkmcnt(9)
  v_mfma_f32_16x16x32_bf16 v[228:231], v[44:47], v[76:79], v[228:231]
  ds_read_b64_tr_b16 v[30:31], v4 offset:1024
  v_mfma_f32_16x16x32_bf16 v[88:91], v[16:19], v[48:51], v[88:91]
  ds_read_b64_tr_b16 v[44:45], v4 offset:8192
  v_mfma_f32_16x16x32_bf16 v[88:91], v[32:35], v[52:55], v[88:91]
  ds_read_b64_tr_b16 v[46:47], v4 offset:9216
  v_mfma_f32_16x16x32_bf16 v[104:107], v[32:35], v[60:63], v[104:107]
  ds_read_b128 v[72:75], v6 offset:6144
  s_waitcnt lgkmcnt(9)
  v_mfma_f32_16x16x32_bf16 v[104:107], v[16:19], v[56:59], v[104:107]
  ds_read_b128 v[76:79], v8 offset:6144
  v_mfma_f32_16x16x32_bf16 v[108:111], v[20:23], v[56:59], v[108:111]
  ds_read_b128 v[80:83], v6 offset:8192
  v_mfma_f32_16x16x32_bf16 v[108:111], v[36:39], v[60:63], v[108:111]
  ds_read_b128 v[84:87], v8 offset:8192
  v_mfma_f32_16x16x32_bf16 v[92:95], v[36:39], v[52:55], v[92:95]
  s_waitcnt lgkmcnt(8)
  v_mfma_f32_16x16x32_bf16 v[92:95], v[20:23], v[48:51], v[92:95]
  v_mfma_f32_16x16x32_bf16 v[96:99], v[24:27], v[48:51], v[96:99]
  v_xor_b32 v1, 16384, v1
  v_mfma_f32_16x16x32_bf16 v[96:99], v[40:43], v[52:55], v[96:99]
  v_xor_b32 v2, 16384, v2
  v_mfma_f32_16x16x32_bf16 v[112:115], v[40:43], v[60:63], v[112:115]
  v_xor_b32 v3, 16384, v3
  s_waitcnt lgkmcnt(4)
  v_mfma_f32_16x16x32_bf16 v[112:115], v[24:27], v[56:59], v[112:115]
  v_xor_b32 v4, 16384, v4
  v_mfma_f32_16x16x32_bf16 v[116:119], v[28:31], v[56:59], v[116:119]
  ds_read_b128 v[56:59], v6 offset:12288
  v_mfma_f32_16x16x32_bf16 v[116:119], v[44:47], v[60:63], v[116:119]
  ds_read_b128 v[60:63], v8 offset:12288
  v_mfma_f32_16x16x32_bf16 v[100:103], v[44:47], v[52:55], v[100:103]
  ds_read_b128 v[52:55], v8 offset:10240
  v_mfma_f32_16x16x32_bf16 v[100:103], v[28:31], v[48:51], v[100:103]
  ds_read_b128 v[48:51], v6 offset:10240
  v_mfma_f32_16x16x32_bf16 v[120:123], v[16:19], v[64:67], v[120:123]
  s_waitcnt lgkmcnt(6)
  v_mfma_f32_16x16x32_bf16 v[120:123], v[32:35], v[68:71], v[120:123]
  v_mfma_f32_16x16x32_bf16 v[136:139], v[32:35], v[76:79], v[136:139]
  v_mfma_f32_16x16x32_bf16 v[136:139], v[16:19], v[72:75], v[136:139]
  v_mfma_f32_16x16x32_bf16 v[140:143], v[20:23], v[72:75], v[140:143]
  v_mfma_f32_16x16x32_bf16 v[140:143], v[36:39], v[76:79], v[140:143]
  v_mfma_f32_16x16x32_bf16 v[124:127], v[36:39], v[68:71], v[124:127]
  v_mfma_f32_16x16x32_bf16 v[124:127], v[20:23], v[64:67], v[124:127]
  v_mfma_f32_16x16x32_bf16 v[128:131], v[24:27], v[64:67], v[128:131]
  v_mfma_f32_16x16x32_bf16 v[128:131], v[40:43], v[68:71], v[128:131]
  v_mfma_f32_16x16x32_bf16 v[144:147], v[40:43], v[76:79], v[144:147]
  v_mfma_f32_16x16x32_bf16 v[144:147], v[24:27], v[72:75], v[144:147]
  v_mfma_f32_16x16x32_bf16 v[148:151], v[28:31], v[72:75], v[148:151]
  ds_read_b128 v[72:75], v6 offset:16384
  v_mfma_f32_16x16x32_bf16 v[148:151], v[44:47], v[76:79], v[148:151]
  ds_read_b128 v[76:79], v8 offset:16384
  v_mfma_f32_16x16x32_bf16 v[132:135], v[44:47], v[68:71], v[132:135]
  ds_read_b128 v[68:71], v8 offset:14336
  s_waitcnt lgkmcnt(7)
  v_mfma_f32_16x16x32_bf16 v[132:135], v[28:31], v[64:67], v[132:135]
  ds_read_b128 v[64:67], v6 offset:14336
  v_mfma_f32_16x16x32_bf16 v[152:155], v[16:19], v[80:83], v[152:155]
  s_waitcnt lgkmcnt(4)
  v_mfma_f32_16x16x32_bf16 v[152:155], v[32:35], v[84:87], v[152:155]
  v_mfma_f32_16x16x32_bf16 v[168:171], v[32:35], v[52:55], v[168:171]
  v_mfma_f32_16x16x32_bf16 v[168:171], v[16:19], v[48:51], v[168:171]
  v_mfma_f32_16x16x32_bf16 v[172:175], v[20:23], v[48:51], v[172:175]
  v_mfma_f32_16x16x32_bf16 v[172:175], v[36:39], v[52:55], v[172:175]
  v_mfma_f32_16x16x32_bf16 v[156:159], v[36:39], v[84:87], v[156:159]
  v_mfma_f32_16x16x32_bf16 v[156:159], v[20:23], v[80:83], v[156:159]
  v_mfma_f32_16x16x32_bf16 v[160:163], v[24:27], v[80:83], v[160:163]
  v_mfma_f32_16x16x32_bf16 v[160:163], v[40:43], v[84:87], v[160:163]
  v_mfma_f32_16x16x32_bf16 v[176:179], v[40:43], v[52:55], v[176:179]
  v_mfma_f32_16x16x32_bf16 v[176:179], v[24:27], v[48:51], v[176:179]
  v_mfma_f32_16x16x32_bf16 v[180:183], v[28:31], v[48:51], v[180:183]
  v_mfma_f32_16x16x32_bf16 v[180:183], v[44:47], v[52:55], v[180:183]
  v_mfma_f32_16x16x32_bf16 v[164:167], v[44:47], v[84:87], v[164:167]
  ds_read_b128 v[84:87], v8 offset:18432
  v_mfma_f32_16x16x32_bf16 v[164:167], v[28:31], v[80:83], v[164:167]
  ds_read_b128 v[80:83], v6 offset:18432
  v_mfma_f32_16x16x32_bf16 v[184:187], v[16:19], v[56:59], v[184:187]
  s_waitcnt lgkmcnt(2)
  v_mfma_f32_16x16x32_bf16 v[184:187], v[32:35], v[60:63], v[184:187]
  v_mfma_f32_16x16x32_bf16 v[200:203], v[32:35], v[68:71], v[200:203]
  v_mfma_f32_16x16x32_bf16 v[200:203], v[16:19], v[64:67], v[200:203]
  v_mfma_f32_16x16x32_bf16 v[204:207], v[20:23], v[64:67], v[204:207]
  v_mfma_f32_16x16x32_bf16 v[204:207], v[36:39], v[68:71], v[204:207]
  s_waitcnt lgkmcnt(0)
  s_barrier
  v_mfma_f32_16x16x32_bf16 v[188:191], v[36:39], v[60:63], v[188:191]
  ds_read_b128 v[48:51], v5 offset:0
  v_mfma_f32_16x16x32_bf16 v[188:191], v[20:23], v[56:59], v[188:191]
  ds_read_b128 v[52:55], v7 offset:0
  v_mfma_f32_16x16x32_bf16 v[192:195], v[24:27], v[56:59], v[192:195]
  v_mfma_f32_16x16x32_bf16 v[192:195], v[40:43], v[60:63], v[192:195]
  v_mfma_f32_16x16x32_bf16 v[208:211], v[40:43], v[68:71], v[208:211]
  v_mfma_f32_16x16x32_bf16 v[208:211], v[24:27], v[64:67], v[208:211]
  v_mfma_f32_16x16x32_bf16 v[212:215], v[28:31], v[64:67], v[212:215]
  ds_read_b128 v[64:67], v5 offset:4096
  v_mfma_f32_16x16x32_bf16 v[212:215], v[44:47], v[68:71], v[212:215]
  ds_read_b128 v[68:71], v7 offset:4096
  v_mfma_f32_16x16x32_bf16 v[196:199], v[44:47], v[60:63], v[196:199]
  ds_read_b128 v[60:63], v7 offset:2048
  v_mfma_f32_16x16x32_bf16 v[196:199], v[28:31], v[56:59], v[196:199]
  ds_read_b128 v[56:59], v5 offset:2048
  v_mfma_f32_16x16x32_bf16 v[216:219], v[32:35], v[76:79], v[216:219]
  v_mfma_f32_16x16x32_bf16 v[216:219], v[16:19], v[72:75], v[216:219]
  v_mfma_f32_16x16x32_bf16 v[232:235], v[16:19], v[80:83], v[232:235]
  ds_read_b64_tr_b16 v[16:17], v1 offset:0
  v_mfma_f32_16x16x32_bf16 v[232:235], v[32:35], v[84:87], v[232:235]
  ds_read_b64_tr_b16 v[18:19], v1 offset:1024
  v_mfma_f32_16x16x32_bf16 v[236:239], v[36:39], v[84:87], v[236:239]
  ds_read_b64_tr_b16 v[32:33], v1 offset:8192
  v_mfma_f32_16x16x32_bf16 v[236:239], v[20:23], v[80:83], v[236:239]
  ds_read_b64_tr_b16 v[34:35], v1 offset:9216
  v_mfma_f32_16x16x32_bf16 v[220:223], v[20:23], v[72:75], v[220:223]
  ds_read_b64_tr_b16 v[20:21], v2 offset:0
  v_mfma_f32_16x16x32_bf16 v[220:223], v[36:39], v[76:79], v[220:223]
  ds_read_b64_tr_b16 v[22:23], v2 offset:1024
  v_mfma_f32_16x16x32_bf16 v[224:227], v[40:43], v[76:79], v[224:227]
  ds_read_b64_tr_b16 v[36:37], v2 offset:8192
  v_mfma_f32_16x16x32_bf16 v[224:227], v[24:27], v[72:75], v[224:227]
  ds_read_b64_tr_b16 v[38:39], v2 offset:9216
  v_mfma_f32_16x16x32_bf16 v[240:243], v[24:27], v[80:83], v[240:243]
  ds_read_b64_tr_b16 v[24:25], v3 offset:0
  v_mfma_f32_16x16x32_bf16 v[240:243], v[40:43], v[84:87], v[240:243]
  ds_read_b64_tr_b16 v[26:27], v3 offset:1024
  v_mfma_f32_16x16x32_bf16 v[244:247], v[44:47], v[84:87], v[244:247]
  ds_read_b64_tr_b16 v[40:41], v3 offset:8192
  v_mfma_f32_16x16x32_bf16 v[244:247], v[28:31], v[80:83], v[244:247]
  ds_read_b64_tr_b16 v[42:43], v3 offset:9216
  v_mfma_f32_16x16x32_bf16 v[228:231], v[28:31], v[72:75], v[228:231]
  ds_read_b64_tr_b16 v[28:29], v4 offset:0
  s_waitcnt lgkmcnt(9)
  v_mfma_f32_16x16x32_bf16 v[228:231], v[44:47], v[76:79], v[228:231]
  ds_read_b64_tr_b16 v[30:31], v4 offset:1024
  v_mfma_f32_16x16x32_bf16 v[88:91], v[16:19], v[48:51], v[88:91]
  ds_read_b64_tr_b16 v[44:45], v4 offset:8192
  v_mfma_f32_16x16x32_bf16 v[88:91], v[32:35], v[52:55], v[88:91]
  ds_read_b64_tr_b16 v[46:47], v4 offset:9216
  v_mfma_f32_16x16x32_bf16 v[104:107], v[32:35], v[60:63], v[104:107]
  ds_read_b128 v[72:75], v5 offset:6144
  s_waitcnt lgkmcnt(9)
  v_mfma_f32_16x16x32_bf16 v[104:107], v[16:19], v[56:59], v[104:107]
  ds_read_b128 v[76:79], v7 offset:6144
  v_mfma_f32_16x16x32_bf16 v[108:111], v[20:23], v[56:59], v[108:111]
  ds_read_b128 v[80:83], v5 offset:8192
  v_mfma_f32_16x16x32_bf16 v[108:111], v[36:39], v[60:63], v[108:111]
  ds_read_b128 v[84:87], v7 offset:8192
  v_mfma_f32_16x16x32_bf16 v[92:95], v[36:39], v[52:55], v[92:95]
  s_waitcnt lgkmcnt(8)
  v_mfma_f32_16x16x32_bf16 v[92:95], v[20:23], v[48:51], v[92:95]
  v_mfma_f32_16x16x32_bf16 v[96:99], v[24:27], v[48:51], v[96:99]
  v_xor_b32 v1, 16384, v1
  v_mfma_f32_16x16x32_bf16 v[96:99], v[40:43], v[52:55], v[96:99]
  v_xor_b32 v2, 16384, v2
  v_mfma_f32_16x16x32_bf16 v[112:115], v[40:43], v[60:63], v[112:115]
  v_xor_b32 v3, 16384, v3
  s_waitcnt lgkmcnt(4)
  v_mfma_f32_16x16x32_bf16 v[112:115], v[24:27], v[56:59], v[112:115]
  v_xor_b32 v4, 16384, v4
  v_mfma_f32_16x16x32_bf16 v[116:119], v[28:31], v[56:59], v[116:119]
  ds_read_b128 v[56:59], v5 offset:12288
  v_mfma_f32_16x16x32_bf16 v[116:119], v[44:47], v[60:63], v[116:119]
  ds_read_b128 v[60:63], v7 offset:12288
  v_mfma_f32_16x16x32_bf16 v[100:103], v[44:47], v[52:55], v[100:103]
  ds_read_b128 v[52:55], v7 offset:10240
  v_mfma_f32_16x16x32_bf16 v[100:103], v[28:31], v[48:51], v[100:103]
  ds_read_b128 v[48:51], v5 offset:10240
  v_mfma_f32_16x16x32_bf16 v[120:123], v[16:19], v[64:67], v[120:123]
  s_waitcnt lgkmcnt(6)
  v_mfma_f32_16x16x32_bf16 v[120:123], v[32:35], v[68:71], v[120:123]
  v_mfma_f32_16x16x32_bf16 v[136:139], v[32:35], v[76:79], v[136:139]
  v_mfma_f32_16x16x32_bf16 v[136:139], v[16:19], v[72:75], v[136:139]
  v_mfma_f32_16x16x32_bf16 v[140:143], v[20:23], v[72:75], v[140:143]
  v_mfma_f32_16x16x32_bf16 v[140:143], v[36:39], v[76:79], v[140:143]
  v_mfma_f32_16x16x32_bf16 v[124:127], v[36:39], v[68:71], v[124:127]
  v_mfma_f32_16x16x32_bf16 v[124:127], v[20:23], v[64:67], v[124:127]
  v_mfma_f32_16x16x32_bf16 v[128:131], v[24:27], v[64:67], v[128:131]
  v_mfma_f32_16x16x32_bf16 v[128:131], v[40:43], v[68:71], v[128:131]
  v_mfma_f32_16x16x32_bf16 v[144:147], v[40:43], v[76:79], v[144:147]
  v_mfma_f32_16x16x32_bf16 v[144:147], v[24:27], v[72:75], v[144:147]
  v_mfma_f32_16x16x32_bf16 v[148:151], v[28:31], v[72:75], v[148:151]
  ds_read_b128 v[72:75], v5 offset:16384
  v_mfma_f32_16x16x32_bf16 v[148:151], v[44:47], v[76:79], v[148:151]
  ds_read_b128 v[76:79], v7 offset:16384
  v_mfma_f32_16x16x32_bf16 v[132:135], v[44:47], v[68:71], v[132:135]
  ds_read_b128 v[68:71], v7 offset:14336
  s_waitcnt lgkmcnt(7)
  v_mfma_f32_16x16x32_bf16 v[132:135], v[28:31], v[64:67], v[132:135]
  ds_read_b128 v[64:67], v5 offset:14336
  v_mfma_f32_16x16x32_bf16 v[152:155], v[16:19], v[80:83], v[152:155]
  s_waitcnt lgkmcnt(4)
  v_mfma_f32_16x16x32_bf16 v[152:155], v[32:35], v[84:87], v[152:155]
  v_mfma_f32_16x16x32_bf16 v[168:171], v[32:35], v[52:55], v[168:171]
  v_mfma_f32_16x16x32_bf16 v[168:171], v[16:19], v[48:51], v[168:171]
  v_mfma_f32_16x16x32_bf16 v[172:175], v[20:23], v[48:51], v[172:175]
  v_mfma_f32_16x16x32_bf16 v[172:175], v[36:39], v[52:55], v[172:175]
  v_mfma_f32_16x16x32_bf16 v[156:159], v[36:39], v[84:87], v[156:159]
  v_mfma_f32_16x16x32_bf16 v[156:159], v[20:23], v[80:83], v[156:159]
  v_mfma_f32_16x16x32_bf16 v[160:163], v[24:27], v[80:83], v[160:163]
  v_mfma_f32_16x16x32_bf16 v[160:163], v[40:43], v[84:87], v[160:163]
  v_mfma_f32_16x16x32_bf16 v[176:179], v[40:43], v[52:55], v[176:179]
  v_mfma_f32_16x16x32_bf16 v[176:179], v[24:27], v[48:51], v[176:179]
  v_mfma_f32_16x16x32_bf16 v[180:183], v[28:31], v[48:51], v[180:183]
  v_mfma_f32_16x16x32_bf16 v[180:183], v[44:47], v[52:55], v[180:183]
  v_mfma_f32_16x16x32_bf16 v[164:167], v[44:47], v[84:87], v[164:167]
  ds_read_b128 v[84:87], v7 offset:18432
  v_mfma_f32_16x16x32_bf16 v[164:167], v[28:31], v[80:83], v[164:167]
  ds_read_b128 v[80:83], v5 offset:18432
  v_mfma_f32_16x16x32_bf16 v[184:187], v[16:19], v[56:59], v[184:187]
  s_waitcnt lgkmcnt(2)
  s_add_u32 s72, s72, 1
  s_cmp_lt_u32 s72, 8
  v_mfma_f32_16x16x32_bf16 v[184:187], v[32:35], v[60:63], v[184:187]
  v_mfma_f32_16x16x32_bf16 v[200:203], v[32:35], v[68:71], v[200:203]
  v_mfma_f32_16x16x32_bf16 v[200:203], v[16:19], v[64:67], v[200:203]
  v_mfma_f32_16x16x32_bf16 v[204:207], v[20:23], v[64:67], v[204:207]
  v_mfma_f32_16x16x32_bf16 v[204:207], v[36:39], v[68:71], v[204:207]
  s_waitcnt lgkmcnt(0)
  s_barrier
  v_mfma_f32_16x16x32_bf16 v[188:191], v[36:39], v[60:63], v[188:191]
  ds_read_b128 v[48:51], v5 offset:40960
  v_mfma_f32_16x16x32_bf16 v[188:191], v[20:23], v[56:59], v[188:191]
  ds_read_b128 v[52:55], v7 offset:40960
  v_mfma_f32_16x16x32_bf16 v[192:195], v[24:27], v[56:59], v[192:195]
  v_mfma_f32_16x16x32_bf16 v[192:195], v[40:43], v[60:63], v[192:195]
  v_mfma_f32_16x16x32_bf16 v[208:211], v[40:43], v[68:71], v[208:211]
  v_mfma_f32_16x16x32_bf16 v[208:211], v[24:27], v[64:67], v[208:211]
  v_mfma_f32_16x16x32_bf16 v[212:215], v[28:31], v[64:67], v[212:215]
  ds_read_b128 v[64:67], v5 offset:45056
  v_mfma_f32_16x16x32_bf16 v[212:215], v[44:47], v[68:71], v[212:215]
  ds_read_b128 v[68:71], v7 offset:45056
  v_mfma_f32_16x16x32_bf16 v[196:199], v[44:47], v[60:63], v[196:199]
  ds_read_b128 v[60:63], v7 offset:43008
  v_mfma_f32_16x16x32_bf16 v[196:199], v[28:31], v[56:59], v[196:199]
  ds_read_b128 v[56:59], v5 offset:43008
  v_mfma_f32_16x16x32_bf16 v[216:219], v[32:35], v[76:79], v[216:219]
  v_mfma_f32_16x16x32_bf16 v[216:219], v[16:19], v[72:75], v[216:219]
  v_mfma_f32_16x16x32_bf16 v[232:235], v[16:19], v[80:83], v[232:235]
  ds_read_b64_tr_b16 v[16:17], v1 offset:0
  v_mfma_f32_16x16x32_bf16 v[232:235], v[32:35], v[84:87], v[232:235]
  ds_read_b64_tr_b16 v[18:19], v1 offset:1024
  v_mfma_f32_16x16x32_bf16 v[236:239], v[36:39], v[84:87], v[236:239]
  ds_read_b64_tr_b16 v[32:33], v1 offset:8192
  v_mfma_f32_16x16x32_bf16 v[236:239], v[20:23], v[80:83], v[236:239]
  ds_read_b64_tr_b16 v[34:35], v1 offset:9216
  v_mfma_f32_16x16x32_bf16 v[220:223], v[20:23], v[72:75], v[220:223]
  ds_read_b64_tr_b16 v[20:21], v2 offset:0
  v_mfma_f32_16x16x32_bf16 v[220:223], v[36:39], v[76:79], v[220:223]
  ds_read_b64_tr_b16 v[22:23], v2 offset:1024
  v_mfma_f32_16x16x32_bf16 v[224:227], v[40:43], v[76:79], v[224:227]
  ds_read_b64_tr_b16 v[36:37], v2 offset:8192
  v_mfma_f32_16x16x32_bf16 v[224:227], v[24:27], v[72:75], v[224:227]
  ds_read_b64_tr_b16 v[38:39], v2 offset:9216
  v_mfma_f32_16x16x32_bf16 v[240:243], v[24:27], v[80:83], v[240:243]
  ds_read_b64_tr_b16 v[24:25], v3 offset:0
  v_mfma_f32_16x16x32_bf16 v[240:243], v[40:43], v[84:87], v[240:243]
  ds_read_b64_tr_b16 v[26:27], v3 offset:1024
  v_mfma_f32_16x16x32_bf16 v[244:247], v[44:47], v[84:87], v[244:247]
  ds_read_b64_tr_b16 v[40:41], v3 offset:8192
  v_mfma_f32_16x16x32_bf16 v[244:247], v[28:31], v[80:83], v[244:247]
  ds_read_b64_tr_b16 v[42:43], v3 offset:9216
  v_mfma_f32_16x16x32_bf16 v[228:231], v[28:31], v[72:75], v[228:231]
  ds_read_b64_tr_b16 v[28:29], v4 offset:0
  s_waitcnt lgkmcnt(9)
  v_mfma_f32_16x16x32_bf16 v[228:231], v[44:47], v[76:79], v[228:231]
  ds_read_b64_tr_b16 v[30:31], v4 offset:1024
  s_cbranch_scc1 L_dnn_loop0
L_tail:
  v_mfma_f32_16x16x32_bf16 v[88:91], v[16:19], v[48:51], v[88:91]
  ds_read_b64_tr_b16 v[44:45], v4 offset:8192
  v_mfma_f32_16x16x32_bf16 v[88:91], v[32:35], v[52:55], v[88:91]
  ds_read_b64_tr_b16 v[46:47], v4 offset:9216
  v_mfma_f32_16x16x32_bf16 v[104:107], v[32:35], v[60:63], v[104:107]
  ds_read_b128 v[72:75], v5 offset:47104
  s_waitcnt lgkmcnt(9)
  v_mfma_f32_16x16x32_bf16 v[104:107], v[16:19], v[56:59], v[104:107]
  ds_read_b128 v[76:79], v7 offset:47104
  v_mfma_f32_16x16x32_bf16 v[108:111], v[20:23], v[56:59], v[108:111]
  ds_read_b128 v[80:83], v5 offset:49152
  v_mfma_f32_16x16x32_bf16 v[108:111], v[36:39], v[60:63], v[108:111]
  ds_read_b128 v[84:87], v7 offset:49152
  v_mul_f32 v11, v88, v88
  v_mfma_f32_16x16x32_bf16 v[92:95], v[36:39], v[52:55], v[92:95]
  s_waitcnt lgkmcnt(8)
  v_mul_f32 v248, v89, v89
  v_mul_f32 v249, v90, v90
  v_mfma_f32_16x16x32_bf16 v[92:95], v[20:23], v[48:51], v[92:95]
  v_mul_f32 v250, v91, v91
  v_fma_f32 v11, v11, v14, v12
  v_mfma_f32_16x16x32_bf16 v[96:99], v[24:27], v[48:51], v[96:99]
  v_fma_f32 v248, v248, v14, v12
  v_fma_f32 v249, v249, v14, v12
  v_mfma_f32_16x16x32_bf16 v[96:99], v[40:43], v[52:55], v[96:99]
  v_fma_f32 v250, v250, v14, v12
  v_mul_f32 v11, v11, v88
  v_mfma_f32_16x16x32_bf16 v[112:115], v[40:43], v[60:63], v[112:115]
  s_waitcnt lgkmcnt(4)
  v_mul_f32 v248, v248, v89
  v_mul_f32 v249, v249, v90
  v_mfma_f32_16x16x32_bf16 v[112:115], v[24:27], v[56:59], v[112:115]
  v_mul_f32_e64 v250, v250, v91
  v_mfma_f32_16x16x32_bf16 v[116:119], v[28:31], v[56:59], v[116:119]
  ds_read_b128 v[56:59], v5 offset:53248
  v_mfma_f32_16x16x32_bf16 v[116:119], v[44:47], v[60:63], v[116:119]
  ds_read_b128 v[60:63], v7 offset:53248
  v_mfma_f32_16x16x32_bf16 v[100:103], v[44:47], v[52:55], v[100:103]
  ds_read_b128 v[52:55], v7 offset:51200
  v_mfma_f32_16x16x32_bf16 v[100:103], v[28:31], v[48:51], v[100:103]
  ds_read_b128 v[48:51], v5 offset:51200
  v_mfma_f32_16x16x32_bf16 v[120:123], v[16:19], v[64:67], v[120:123]
  s_waitcnt lgkmcnt(6)
  v_exp_f32 v11, v11
  v_mfma_f32_16x16x32_bf16 v[120:123], v[32:35], v[68:71], v[120:123]
  v_exp_f32 v248, v248
  v_mfma_f32_16x16x32_bf16 v[136:139], v[32:35], v[76:79], v[136:139]
  v_exp_f32 v249, v249
  v_mfma_f32_16x16x32_bf16 v[136:139], v[16:19], v[72:75], v[136:139]
  v_exp_f32_e64 v250, v250
  v_mfma_f32_16x16x32_bf16 v[140:143], v[20:23], v[72:75], v[140:143]
  v_add_f32 v11, 1.0, v11
  v_add_f32 v248, 1.0, v248
  v_mfma_f32_16x16x32_bf16 v[140:143], v[36:39], v[76:79], v[140:143]
  v_add_f32 v249, 1.0, v249
  v_add_f32 v250, 1.0, v250
  v_mfma_f32_16x16x32_bf16 v[124:127], v[36:39], v[68:71], v[124:127]
  v_rcp_f32 v11, v11
  v_mfma_f32_16x16x32_bf16 v[124:127], v[20:23], v[64:67], v[124:127]
  v_rcp_f32 v248, v248
  v_mfma_f32_16x16x32_bf16 v[128:131], v[24:27], v[64:67], v[128:131]
  v_rcp_f32 v249, v249
  v_mfma_f32_16x16x32_bf16 v[128:131], v[40:43], v[68:71], v[128:131]
  v_rcp_f32 v250, v250
  v_mfma_f32_16x16x32_bf16 v[144:147], v[40:43], v[76:79], v[144:147]
  v_mul_f32 v88, v88, v11
  v_mul_f32 v89, v89, v248
  v_mfma_f32_16x16x32_bf16 v[144:147], v[24:27], v[72:75], v[144:147]
  v_mul_f32 v90, v90, v249
  v_mul_f32 v91, v91, v250
  v_mfma_f32_16x16x32_bf16 v[148:151], v[28:31], v[72:75], v[148:151]
  ds_read_b128 v[72:75], v5 offset:57344
  v_mul_f32 v11, v92, v92
  v_mfma_f32_16x16x32_bf16 v[148:151], v[44:47], v[76:79], v[148:151]
  ds_read_b128 v[76:79], v7 offset:57344
  v_mul_f32 v248, v93, v93
  v_mfma_f32_16x16x32_bf16 v[132:135], v[44:47], v[68:71], v[132:135]
  ds_read_b128 v[68:71], v7 offset:55296
  s_waitcnt lgkmcnt(7)
  v_mul_f32 v249, v94, v94
  v_mfma_f32_16x16x32_bf16 v[132:135], v[28:31], v[64:67], v[132:135]
  ds_read_b128 v[64:67], v5 offset:55296
  v_mul_f32 v250, v95, v95
  v_mfma_f32_16x16x32_bf16 v[152:155], v[16:19], v[80:83], v[152:155]
  s_waitcnt lgkmcnt(4)
  v_fma_f32 v11, v11, v14, v12
  v_fma_f32 v248, v248, v14, v12
  v_mfma_f32_16x16x32_bf16 v[152:155], v[32:35], v[84:87], v[152:155]
  v_fma_f32 v249, v249, v14, v12
  v_fma_f32 v250, v250, v14, v12
  v_mfma_f32_16x16x32_bf16 v[168:171], v[32:35], v[52:55], v[168:171]
  v_mul_f32 v11, v11, v92
  v_mul_f32 v248, v248, v93
  v_mfma_f32_16x16x32_bf16 v[168:171], v[16:19], v[48:51], v[168:171]
  v_mul_f32 v249, v249, v94
  v_mul_f32 v250, v250, v95
  v_mfma_f32_16x16x32_bf16 v[172:175], v[20:23], v[48:51], v[172:175]
  v_exp_f32 v11, v11
  v_mfma_f32_16x16x32_bf16 v[172:175], v[36:39], v[52:55], v[172:175]
  v_exp_f32 v248, v248
  v_mfma_f32_16x16x32_bf16 v[156:159], v[36:39], v[84:87], v[156:159]
  v_exp_f32_e64 v249, v249
  v_mfma_f32_16x16x32_bf16 v[156:159], v[20:23], v[80:83], v[156:159]
  v_exp_f32 v250, v250
  v_mfma_f32_16x16x32_bf16 v[160:163], v[24:27], v[80:83], v[160:163]
  v_add_f32 v11, 1.0, v11
  v_add_f32 v248, 1.0, v248
  v_mfma_f32_16x16x32_bf16 v[160:163], v[40:43], v[84:87], v[160:163]
  v_add_f32 v249, 1.0, v249
  v_add_f32 v250, 1.0, v250
  v_mfma_f32_16x16x32_bf16 v[176:179], v[40:43], v[52:55], v[176:179]
  v_rcp_f32 v11, v11
  v_mfma_f32_16x16x32_bf16 v[176:179], v[24:27], v[48:51], v[176:179]
  v_rcp_f32 v248, v248
  v_mfma_f32_16x16x32_bf16 v[180:183], v[28:31], v[48:51], v[180:183]
  v_rcp_f32 v249, v249
  v_mfma_f32_16x16x32_bf16 v[180:183], v[44:47], v[52:55], v[180:183]
  v_rcp_f32 v250, v250
  v_mfma_f32_16x16x32_bf16 v[164:167], v[44:47], v[84:87], v[164:167]
  ds_read_b128 v[84:87], v7 offset:59392
  v_mul_f32 v92, v92, v11
  v_mfma_f32_16x16x32_bf16 v[164:167], v[28:31], v[80:83], v[164:167]
  ds_read_b128 v[80:83], v5 offset:59392
  v_mul_f32 v93, v93, v248
  v_mfma_f32_16x16x32_bf16 v[184:187], v[16:19], v[56:59], v[184:187]
  s_waitcnt lgkmcnt(2)
  v_mul_f32 v94, v94, v249
  v_mul_f32 v95, v95, v250
  v_mfma_f32_16x16x32_bf16 v[184:187], v[32:35], v[60:63], v[184:187]
  v_mul_f32 v11, v96, v96
  v_mul_f32 v248, v97, v97
  v_mfma_f32_16x16x32_bf16 v[200:203], v[32:35], v[68:71], v[200:203]
  v_mul_f32 v249, v98, v98
  v_mul_f32 v250, v99, v99
  v_mfma_f32_16x16x32_bf16 v[200:203], v[16:19], v[64:67], v[200:203]
  v_fma_f32 v11, v11, v14, v12
  v_fma_f32 v248, v248, v14, v12
  v_mfma_f32_16x16x32_bf16 v[204:207], v[20:23], v[64:67], v[204:207]
  v_fma_f32 v249, v249, v14, v12
  v_fma_f32 v250, v250, v14, v12
  v_mfma_f32_16x16x32_bf16 v[204:207], v[36:39], v[68:71], v[204:207]
  v_mul_f32 v11, v11, v96
  v_mul_f32 v248, v248, v97
  v_mfma_f32_16x16x32_bf16 v[188:191], v[36:39], v[60:63], v[188:191]
  v_mul_f32 v249, v249, v98
  v_mul_f32 v250, v250, v99
  v_mfma_f32_16x16x32_bf16 v[188:191], v[20:23], v[56:59], v[188:191]
  v_exp_f32 v11, v11
  v_mfma_f32_16x16x32_bf16 v[192:195], v[24:27], v[56:59], v[192:195]
  v_exp_f32 v248, v248
  v_mfma_f32_16x16x32_bf16 v[192:195], v[40:43], v[60:63], v[192:195]
  v_exp_f32 v249, v249
  v_mfma_f32_16x16x32_bf16 v[208:211], v[40:43], v[68:71], v[208:211]
  v_exp_f32 v250, v250
  v_mfma_f32_16x16x32_bf16 v[208:211], v[24:27], v[64:67], v[208:211]
  v_add_f32 v11, 1.0, v11
  v_add_f32 v248, 1.0, v248
  v_mfma_f32_16x16x32_bf16 v[212:215], v[28:31], v[64:67], v[212:215]
  v_add_f32 v249, 1.0, v249
  v_add_f32 v250, 1.0, v250
  v_mfma_f32_16x16x32_bf16 v[212:215], v[44:47], v[68:71], v[212:215]
  v_rcp_f32 v11, v11
  v_mfma_f32_16x16x32_bf16 v[196:199], v[44:47], v[60:63], v[196:199]
  v_rcp_f32 v248, v248
  v_mfma_f32_16x16x32_bf16 v[196:199], v[28:31], v[56:59], v[196:199]
  v_rcp_f32_e64 v249, v249
  v_mfma_f32_16x16x32_bf16 v[216:219], v[32:35], v[76:79], v[216:219]
  s_waitcnt lgkmcnt(0)
  v_rcp_f32 v250, v250
  v_mfma_f32_16x16x32_bf16 v[216:219], v[16:19], v[72:75], v[216:219]
  v_mul_f32 v96, v96, v11
  v_mul_f32 v97, v97, v248
  v_mfma_f32_16x16x32_bf16 v[232:235], v[16:19], v[80:83], v[232:235]
  v_mul_f32 v98, v98, v249
  v_mul_f32 v99, v99, v250
  v_mfma_f32_16x16x32_bf16 v[232:235], v[32:35], v[84:87], v[232:235]
  v_mul_f32 v11, v100, v100
  v_mul_f32 v248, v101, v101
  v_mfma_f32_16x16x32_bf16 v[236:239], v[36:39], v[84:87], v[236:239]
  v_mul_f32 v249, v102, v102
  v_mul_f32 v250, v103, v103
  v_mfma_f32_16x16x32_bf16 v[236:239], v[20:23], v[80:83], v[236:239]
  v_fma_f32 v11, v11, v14, v12
  v_fma_f32 v248, v248, v14, v12
  v_mfma_f32_16x16x32_bf16 v[220:223], v[20:23], v[72:75], v[220:223]
  v_fma_f32 v249, v249, v14, v12
  v_fma_f32 v250, v250, v14, v12
  v_mfma_f32_16x16x32_bf16 v[220:223], v[36:39], v[76:79], v[220:223]
  v_mul_f32 v11, v11, v100
  v_mul_f32 v248, v248, v101
  v_mfma_f32_16x16x32_bf16 v[224:227], v[40:43], v[76:79], v[224:227]
  v_mul_f32 v249, v249, v102
  v_mul_f32 v250, v250, v103
  v_mfma_f32_16x16x32_bf16 v[224:227], v[24:27], v[72:75], v[224:227]
  v_exp_f32 v11, v11
  v_mfma_f32_16x16x32_bf16 v[240:243], v[24:27], v[80:83], v[240:243]
  v_exp_f32 v248, v248
  v_mfma_f32_16x16x32_bf16 v[240:243], v[40:43], v[84:87], v[240:243]
  v_exp_f32 v249, v249
  v_mfma_f32_16x16x32_bf16 v[244:247], v[44:47], v[84:87], v[244:247]
  v_exp_f32 v250, v250
  v_mfma_f32_16x16x32_bf16 v[244:247], v[28:31], v[80:83], v[244:247]
  v_add_f32 v11, 1.0, v11
  v_add_f32 v248, 1.0, v248
  v_mfma_f32_16x16x32_bf16 v[228:231], v[28:31], v[72:75], v[228:231]
  v_add_f32 v249, 1.0, v249
  v_add_f32 v250, 1.0, v250
  v_mfma_f32_16x16x32_bf16 v[228:231], v[44:47], v[76:79], v[228:231]
  v_rcp_f32 v11, v11
  v_rcp_f32 v248, v248
  v_rcp_f32 v249, v249
  v_rcp_f32 v250, v250
  v_mul_f32 v100, v100, v11
  v_mul_f32 v101, v101, v248
  v_mul_f32 v102, v102, v249
  v_mul_f32 v103, v103, v250
  ds_read_b64 v[18:19], v9 offset:256
  ds_read_b64 v[22:23], v9 offset:288
  ds_read_b64 v[26:27], v9 offset:320
  ds_read_b64 v[30:31], v9 offset:352
  v_mov_b32 v248, 1.0
  v_mov_b32 v249, 1.0
L_epi:
  v_mov_b32 v84, 0xc1c00000
  v_mov_b32 v85, 0xc1c00000
  v_mov_b32 v86, 0x4b800000
  v_mov_b32 v87, 0x4b800000
  v_pk_mul_f32 v[52:53], v[104:105], v[104:105]
  v_pk_mul_f32 v[56:57], v[106:107], v[106:107]
  v_pk_mul_f32 v[60:61], v[108:109], v[108:109]
  v_pk_mul_f32 v[64:65], v[110:111], v[110:111]
  v_pk_mul_f32 v[68:69], v[120:121], v[120:121]
  v_pk_mul_f32 v[72:73], v[122:123], v[122:123]
  v_pk_mul_f32 v[76:77], v[124:125], v[124:125]
  v_pk_mul_f32 v[80:81], v[126:127], v[126:127]
  v_pk_fma_f32 v[52:53], v[52:53], v[14:15], v[12:13]
  v_pk_fma_f32 v[56:57], v[56:57], v[14:15], v[12:13]
  v_pk_fma_f32 v[60:61], v[60:61], v[14:15], v[12:13]
  v_pk_fma_f32 v[64:65], v[64:65], v[14:15], v[12:13]
  v_pk_fma_f32 v[68:69], v[68:69], v[14:15], v[12:13]
  v_pk_fma_f32 v[72:73], v[72:73], v[14:15], v[12:13]
  v_pk_fma_f32 v[76:77], v[76:77], v[14:15], v[12:13]
  v_pk_fma_f32 v[80:81], v[80:81], v[14:15], v[12:13]
  v_pk_fma_f32 v[52:53], v[52:53], v[104:105], v[84:85]
  v_pk_fma_f32 v[56:57], v[56:57], v[106:107], v[84:85]
  v_pk_fma_f32 v[60:61], v[60:61], v[108:109], v[84:85]
  v_pk_fma_f32 v[64:65], v[64:65], v[110:111], v[84:85]
  v_pk_fma_f32 v[68:69], v[68:69], v[120:121], v[84:85]
  v_pk_fma_f32 v[72:73], v[72:73], v[122:123], v[84:85]
  v_pk_fma_f32 v[76:77], v[76:77], v[124:125], v[84:85]
  v_pk_fma_f32 v[80:81], v[80:81], v[126:127], v[84:85]
  v_exp_f32 v52, v52 clamp
  v_exp_f32 v53, v53 clamp
  v_exp_f32 v56, v56 clamp
  v_exp_f32 v57, v57 clamp
  v_exp_f32 v60, v60 clamp
  v_exp_f32 v61, v61 clamp
  v_exp_f32 v64, v64 clamp
  v_exp_f32 v65, v65 clamp
  v_exp_f32 v68, v68 clamp
  v_exp_f32 v69, v69 clamp
  v_exp_f32 v72, v72 clamp
  v_exp_f32 v73, v73 clamp
  v_exp_f32 v76, v76 clamp
  v_exp_f32 v77, v77 clamp
  v_exp_f32 v80, v80 clamp
  v_exp_f32 v81, v81 clamp
  s_waitcnt lgkmcnt(3)
  v_lshlrev_b32 v16, 16, v18
  v_and_b32 v17, 0xffff0000, v18
  v_lshlrev_b32 v18, 16, v19
  v_and_b32 v19, 0xffff0000, v19
  s_waitcnt lgkmcnt(2)
  v_lshlrev_b32 v20, 16, v22
  v_and_b32 v21, 0xffff0000, v22
  v_lshlrev_b32 v22, 16, v23
  v_and_b32 v23, 0xffff0000, v23
  s_waitcnt lgkmcnt(1)
  v_lshlrev_b32 v24, 16, v26
  v_and_b32 v25, 0xffff0000, v26
  v_lshlrev_b32 v26, 16, v27
  v_and_b32 v27, 0xffff0000, v27
  s_waitcnt lgkmcnt(0)
  v_lshlrev_b32_e64 v28, 16, v30
  v_and_b32 v29, 0xffff0000, v30
  v_lshlrev_b32_e64 v30, 16, v31
  v_and_b32 v31, 0xffff0000, v31
  v_pk_mul_f32 v[54:55], v[104:105], v[16:17]
  v_pk_mul_f32 v[58:59], v[106:107], v[18:19]
  v_pk_mul_f32 v[62:63], v[108:109], v[20:21]
  v_pk_mul_f32 v[66:67], v[110:111], v[22:23]
  v_pk_mul_f32 v[70:71], v[120:121], v[16:17]
  v_pk_mul_f32 v[74:75], v[122:123], v[18:19]
  v_pk_mul_f32 v[78:79], v[124:125], v[20:21]
  v_pk_mul_f32 v[82:83], v[126:127], v[22:23]
  v_pk_fma_f32 v[52:53], v[52:53], v[86:87], v[248:249]
  v_pk_fma_f32 v[56:57], v[56:57], v[86:87], v[248:249]
  v_pk_fma_f32 v[60:61], v[60:61], v[86:87], v[248:249]
  v_pk_fma_f32 v[64:65], v[64:65], v[86:87], v[248:249]
  v_pk_fma_f32 v[68:69], v[68:69], v[86:87], v[248:249]
  v_pk_fma_f32 v[72:73], v[72:73], v[86:87], v[248:249]
  v_pk_fma_f32 v[76:77], v[76:77], v[86:87], v[248:249]
  v_pk_fma_f32 v[80:81], v[80:81], v[86:87], v[248:249]
  v_pk_mul_f32 v[54:55], v[54:55], v[56:57]
  v_pk_mul_f32 v[62:63], v[62:63], v[64:65]
  v_pk_mul_f32 v[70:71], v[70:71], v[72:73]
  v_pk_mul_f32 v[78:79], v[78:79], v[80:81]
  v_pk_fma_f32 v[54:55], v[58:59], v[52:53], v[54:55]
  v_pk_fma_f32 v[62:63], v[66:67], v[60:61], v[62:63]
  v_pk_fma_f32 v[70:71], v[74:75], v[68:69], v[70:71]
  v_pk_fma_f32 v[78:79], v[82:83], v[76:77], v[78:79]
  v_pk_mul_f32 v[52:53], v[52:53], v[56:57]
  v_pk_mul_f32 v[60:61], v[60:61], v[64:65]
  v_pk_mul_f32 v[68:69], v[68:69], v[72:73]
  v_pk_mul_f32 v[76:77], v[76:77], v[80:81]
  v_pk_mul_f32 v[54:55], v[54:55], v[60:61]
  v_pk_mul_f32 v[70:71], v[70:71], v[76:77]
  v_pk_fma_f32 v[54:55], v[62:63], v[52:53], v[54:55]
  v_pk_fma_f32 v[70:71], v[78:79], v[68:69], v[70:71]
  v_pk_mul_f32 v[52:53], v[52:53], v[60:61]
  v_pk_mul_f32 v[68:69], v[68:69], v[76:77]
  v_rcp_f32 v52, v52
  v_rcp_f32 v53, v53
  v_rcp_f32 v68, v68
  v_rcp_f32 v69, v69
  v_pk_mul_f32 v[34:35], v[52:53], v[54:55]
  v_pk_mul_f32 v[36:37], v[68:69], v[70:71]
  v_pk_mul_f32 v[52:53], v[112:113], v[112:113]
  v_pk_mul_f32 v[56:57], v[114:115], v[114:115]
  v_pk_mul_f32 v[60:61], v[116:117], v[116:117]
  v_pk_mul_f32 v[64:65], v[118:119], v[118:119]
  v_pk_mul_f32 v[68:69], v[128:129], v[128:129]
  v_pk_mul_f32 v[72:73], v[130:131], v[130:131]
  v_pk_mul_f32 v[76:77], v[132:133], v[132:133]
  v_pk_mul_f32 v[80:81], v[134:135], v[134:135]
  v_pk_fma_f32 v[52:53], v[52:53], v[14:15], v[12:13]
  v_pk_fma_f32 v[56:57], v[56:57], v[14:15], v[12:13]
  v_pk_fma_f32 v[60:61], v[60:61], v[14:15], v[12:13]
  v_pk_fma_f32 v[64:65], v[64:65], v[14:15], v[12:13]
  v_pk_fma_f32 v[68:69], v[68:69], v[14:15], v[12:13]
  v_pk_fma_f32 v[72:73], v[72:73], v[14:15], v[12:13]
  v_pk_fma_f32 v[76:77], v[76:77], v[14:15], v[12:13]
  v_pk_fma_f32 v[80:81], v[80:81], v[14:15], v[12:13]
  v_pk_fma_f32 v[52:53], v[52:53], v[112:113], v[84:85]
  v_pk_fma_f32 v[56:57], v[56:57], v[114:115], v[84:85]
  v_pk_fma_f32 v[60:61], v[60:61], v[116:117], v[84:85]
  v_pk_fma_f32 v[64:65], v[64:65], v[118:119], v[84:85]
  v_pk_fma_f32 v[68:69], v[68:69], v[128:129], v[84:85]
  v_pk_fma_f32 v[72:73], v[72:73], v[130:131], v[84:85]
  v_pk_fma_f32 v[76:77], v[76:77], v[132:133], v[84:85]
  v_pk_fma_f32 v[80:81], v[80:81], v[134:135], v[84:85]
  v_exp_f32 v52, v52 clamp
  v_exp_f32 v53, v53 clamp
  v_exp_f32 v56, v56 clamp
  v_exp_f32 v57, v57 clamp
  v_exp_f32 v60, v60 clamp
  v_exp_f32 v61, v61 clamp
  v_exp_f32 v64, v64 clamp
  v_exp_f32 v65, v65 clamp
  v_exp_f32 v68, v68 clamp
  v_exp_f32 v69, v69 clamp
  v_exp_f32 v72, v72 clamp
  v_exp_f32 v73, v73 clamp
  v_exp_f32 v76, v76 clamp
  v_exp_f32 v77, v77 clamp
  v_exp_f32 v80, v80 clamp
  v_exp_f32 v81, v81 clamp
  v_pk_mul_f32 v[54:55], v[112:113], v[24:25]
  v_pk_mul_f32 v[58:59], v[114:115], v[26:27]
  v_pk_mul_f32 v[62:63], v[116:117], v[28:29]
  v_pk_mul_f32 v[66:67], v[118:119], v[30:31]
  v_pk_mul_f32 v[70:71], v[128:129], v[24:25]
  v_pk_mul_f32 v[74:75], v[130:131], v[26:27]
  v_pk_mul_f32 v[78:79], v[132:133], v[28:29]
  v_pk_mul_f32 v[82:83], v[134:135], v[30:31]
  v_pk_fma_f32 v[52:53], v[52:53], v[86:87], v[248:249]
  v_pk_fma_f32 v[56:57], v[56:57], v[86:87], v[248:249]
  v_pk_fma_f32 v[60:61], v[60:61], v[86:87], v[248:249]
  v_pk_fma_f32 v[64:65], v[64:65], v[86:87], v[248:249]
  v_pk_fma_f32 v[68:69], v[68:69], v[86:87], v[248:249]
  v_pk_fma_f32 v[72:73], v[72:73], v[86:87], v[248:249]
  v_pk_fma_f32 v[76:77], v[76:77], v[86:87], v[248:249]
  v_pk_fma_f32 v[80:81], v[80:81], v[86:87], v[248:249]
  v_pk_mul_f32 v[54:55], v[54:55], v[56:57]
  v_pk_mul_f32 v[62:63], v[62:63], v[64:65]
  v_pk_mul_f32 v[70:71], v[70:71], v[72:73]
  v_pk_mul_f32 v[78:79], v[78:79], v[80:81]
  v_pk_fma_f32 v[54:55], v[58:59], v[52:53], v[54:55]
  v_pk_fma_f32 v[62:63], v[66:67], v[60:61], v[62:63]
  v_pk_fma_f32 v[70:71], v[74:75], v[68:69], v[70:71]
  v_pk_fma_f32 v[78:79], v[82:83], v[76:77], v[78:79]
  v_pk_mul_f32 v[52:53], v[52:53], v[56:57]
  v_pk_mul_f32 v[60:61], v[60:61], v[64:65]
  v_pk_mul_f32 v[68:69], v[68:69], v[72:73]
  v_pk_mul_f32 v[76:77], v[76:77], v[80:81]
  v_pk_mul_f32 v[54:55], v[54:55], v[60:61]
  v_pk_mul_f32 v[70:71], v[70:71], v[76:77]
  v_pk_fma_f32 v[54:55], v[62:63], v[52:53], v[54:55]
  v_pk_fma_f32 v[70:71], v[78:79], v[68:69], v[70:71]
  v_pk_mul_f32 v[52:53], v[52:53], v[60:61]
  v_pk_mul_f32 v[68:69], v[68:69], v[76:77]
  v_rcp_f32 v52, v52
  v_rcp_f32 v53, v53
  v_rcp_f32 v68, v68
  v_rcp_f32 v69, v69
  v_pk_fma_f32 v[34:35], v[52:53], v[54:55], v[34:35]
  v_pk_fma_f32 v[36:37], v[68:69], v[70:71], v[36:37]
  v_pk_mul_f32 v[52:53], v[136:137], v[136:137]
  v_pk_mul_f32 v[56:57], v[138:139], v[138:139]
  v_pk_mul_f32 v[60:61], v[140:141], v[140:141]
  v_pk_mul_f32 v[64:65], v[142:143], v[142:143]
  v_pk_mul_f32 v[68:69], v[152:153], v[152:153]
  v_pk_mul_f32 v[72:73], v[154:155], v[154:155]
  v_pk_mul_f32 v[76:77], v[156:157], v[156:157]
  v_pk_mul_f32 v[80:81], v[158:159], v[158:159]
  v_pk_fma_f32 v[52:53], v[52:53], v[14:15], v[12:13]
  v_pk_fma_f32 v[56:57], v[56:57], v[14:15], v[12:13]
  v_pk_fma_f32 v[60:61], v[60:61], v[14:15], v[12:13]
  v_pk_fma_f32 v[64:65], v[64:65], v[14:15], v[12:13]
  v_pk_fma_f32 v[68:69], v[68:69], v[14:15], v[12:13]
  v_pk_fma_f32 v[72:73], v[72:73], v[14:15], v[12:13]
  v_pk_fma_f32 v[76:77], v[76:77], v[14:15], v[12:13]
  v_pk_fma_f32 v[80:81], v[80:81], v[14:15], v[12:13]
  v_pk_fma_f32 v[52:53], v[52:53], v[136:137], v[84:85]
  v_pk_fma_f32 v[56:57], v[56:57], v[138:139], v[84:85]
  v_pk_fma_f32 v[60:61], v[60:61], v[140:141], v[84:85]
  v_pk_fma_f32 v[64:65], v[64:65], v[142:143], v[84:85]
  v_pk_fma_f32 v[68:69], v[68:69], v[152:153], v[84:85]
  v_pk_fma_f32 v[72:73], v[72:73], v[154:155], v[84:85]
  v_pk_fma_f32 v[76:77], v[76:77], v[156:157], v[84:85]
  v_pk_fma_f32 v[80:81], v[80:81], v[158:159], v[84:85]
  v_exp_f32 v52, v52 clamp
  v_exp_f32 v53, v53 clamp
  v_exp_f32 v56, v56 clamp
  v_exp_f32 v57, v57 clamp
  v_exp_f32 v60, v60 clamp
  v_exp_f32 v61, v61 clamp
  v_exp_f32 v64, v64 clamp
  v_exp_f32 v65, v65 clamp
  v_exp_f32 v68, v68 clamp
  v_exp_f32 v69, v69 clamp
  v_exp_f32 v72, v72 clamp
  v_exp_f32 v73, v73 clamp
  v_exp_f32 v76, v76 clamp
  v_exp_f32 v77, v77 clamp
  v_exp_f32 v80, v80 clamp
  v_exp_f32 v81, v81 clamp
  v_pk_mul_f32 v[54:55], v[136:137], v[16:17]
  v_pk_mul_f32 v[58:59], v[138:139], v[18:19]
  v_pk_mul_f32 v[62:63], v[140:141], v[20:21]
  v_pk_mul_f32 v[66:67], v[142:143], v[22:23]
  v_pk_mul_f32 v[70:71], v[152:153], v[16:17]
  v_pk_mul_f32 v[74:75], v[154:155], v[18:19]
  v_pk_mul_f32 v[78:79], v[156:157], v[20:21]
  v_pk_mul_f32 v[82:83], v[158:159], v[22:23]
  v_pk_fma_f32 v[52:53], v[52:53], v[86:87], v[248:249]
  v_pk_fma_f32 v[56:57], v[56:57], v[86:87], v[248:249]
  v_pk_fma_f32 v[60:61], v[60:61], v[86:87], v[248:249]
  v_pk_fma_f32 v[64:65], v[64:65], v[86:87], v[248:249]
  v_pk_fma_f32 v[68:69], v[68:69], v[86:87], v[248:249]
  v_pk_fma_f32 v[72:73], v[72:73], v[86:87], v[248:249]
  v_pk_fma_f32 v[76:77], v[76:77], v[86:87], v[248:249]
  v_pk_fma_f32 v[80:81], v[80:81], v[86:87], v[248:249]
  v_pk_mul_f32 v[54:55], v[54:55], v[56:57]
  v_pk_mul_f32 v[62:63], v[62:63], v[64:65]
  v_pk_mul_f32 v[70:71], v[70:71], v[72:73]
  v_pk_mul_f32 v[78:79], v[78:79], v[80:81]
  v_pk_fma_f32 v[54:55], v[58:59], v[52:53], v[54:55]
  v_pk_fma_f32 v[62:63], v[66:67], v[60:61], v[62:63]
  v_pk_fma_f32 v[70:71], v[74:75], v[68:69], v[70:71]
  v_pk_fma_f32 v[78:79], v[82:83], v[76:77], v[78:79]
  v_pk_mul_f32 v[52:53], v[52:53], v[56:57]
  v_pk_mul_f32 v[60:61], v[60:61], v[64:65]
  v_pk_mul_f32 v[68:69], v[68:69], v[72:73]
  v_pk_mul_f32 v[76:77], v[76:77], v[80:81]
  v_pk_mul_f32 v[54:55], v[54:55], v[60:61]
  v_pk_mul_f32 v[70:71], v[70:71], v[76:77]
  v_pk_fma_f32 v[54:55], v[62:63], v[52:53], v[54:55]
  v_pk_fma_f32 v[70:71], v[78:79], v[68:69], v[70:71]
  v_pk_mul_f32 v[52:53], v[52:53], v[60:61]
  v_pk_mul_f32 v[68:69], v[68:69], v[76:77]
  v_rcp_f32 v52, v52
  v_rcp_f32 v53, v53
  v_rcp_f32 v68, v68
  v_rcp_f32 v69, v69
  v_pk_mul_f32 v[38:39], v[52:53], v[54:55]
  v_pk_mul_f32 v[40:41], v[68:69], v[70:71]
  v_pk_mul_f32 v[52:53], v[144:145], v[144:145]
  v_pk_mul_f32 v[56:57], v[146:147], v[146:147]
  v_pk_mul_f32 v[60:61], v[148:149], v[148:149]
  v_pk_mul_f32 v[64:65], v[150:151], v[150:151]
  v_pk_mul_f32 v[68:69], v[160:161], v[160:161]
  v_pk_mul_f32 v[72:73], v[162:163], v[162:163]
  v_pk_mul_f32 v[76:77], v[164:165], v[164:165]
  v_pk_mul_f32 v[80:81], v[166:167], v[166:167]
  v_pk_fma_f32 v[52:53], v[52:53], v[14:15], v[12:13]
  v_pk_fma_f32 v[56:57], v[56:57], v[14:15], v[12:13]
  v_pk_fma_f32 v[60:61], v[60:61], v[14:15], v[12:13]
  v_pk_fma_f32 v[64:65], v[64:65], v[14:15], v[12:13]
  v_pk_fma_f32 v[68:69], v[68:69], v[14:15], v[12:13]
  v_pk_fma_f32 v[72:73], v[72:73], v[14:15], v[12:13]
  v_pk_fma_f32 v[76:77], v[76:77], v[14:15], v[12:13]
  v_pk_fma_f32 v[80:81], v[80:81], v[14:15], v[12:13]
  v_pk_fma_f32 v[52:53], v[52:53], v[144:145], v[84:85]
  v_pk_fma_f32 v[56:57], v[56:57], v[146:147], v[84:85]
  v_pk_fma_f32 v[60:61], v[60:61], v[148:149], v[84:85]
  v_pk_fma_f32 v[64:65], v[64:65], v[150:151], v[84:85]
  v_pk_fma_f32 v[68:69], v[68:69], v[160:161], v[84:85]
  v_pk_fma_f32 v[72:73], v[72:73], v[162:163], v[84:85]
  v_pk_fma_f32 v[76:77], v[76:77], v[164:165], v[84:85]
  v_pk_fma_f32 v[80:81], v[80:81], v[166:167], v[84:85]
  v_exp_f32 v52, v52 clamp
  v_exp_f32 v53, v53 clamp
  v_exp_f32 v56, v56 clamp
  v_exp_f32 v57, v57 clamp
  v_exp_f32 v60, v60 clamp
  v_exp_f32 v61, v61 clamp
  v_exp_f32 v64, v64 clamp
  v_exp_f32 v65, v65 clamp
  v_exp_f32 v68, v68 clamp
  v_exp_f32 v69, v69 clamp
  v_exp_f32 v72, v72 clamp
  v_exp_f32 v73, v73 clamp
  v_exp_f32 v76, v76 clamp
  v_exp_f32 v77, v77 clamp
  v_exp_f32 v80, v80 clamp
  v_exp_f32 v81, v81 clamp
  v_pk_mul_f32 v[54:55], v[144:145], v[24:25]
  v_pk_mul_f32 v[58:59], v[146:147], v[26:27]
  v_pk_mul_f32 v[62:63], v[148:149], v[28:29]
  v_pk_mul_f32 v[66:67], v[150:151], v[30:31]
  v_pk_mul_f32 v[70:71], v[160:161], v[24:25]
  v_pk_mul_f32 v[74:75], v[162:163], v[26:27]
  v_pk_mul_f32 v[78:79], v[164:165], v[28:29]
  v_pk_mul_f32 v[82:83], v[166:167], v[30:31]
  v_pk_fma_f32 v[52:53], v[52:53], v[86:87], v[248:249]
  v_pk_fma_f32 v[56:57], v[56:57], v[86:87], v[248:249]
  v_pk_fma_f32 v[60:61], v[60:61], v[86:87], v[248:249]
  v_pk_fma_f32 v[64:65], v[64:65], v[86:87], v[248:249]
  v_pk_fma_f32 v[68:69], v[68:69], v[86:87], v[248:249]
  v_pk_fma_f32 v[72:73], v[72:73], v[86:87], v[248:249]
  v_pk_fma_f32 v[76:77], v[76:77], v[86:87], v[248:249]
  v_pk_fma_f32 v[80:81], v[80:81], v[86:87], v[248:249]
  v_pk_mul_f32 v[54:55], v[54:55], v[56:57]
  v_pk_mul_f32 v[62:63], v[62:63], v[64:65]
  v_pk_mul_f32 v[70:71], v[70:71], v[72:73]
  v_pk_mul_f32 v[78:79], v[78:79], v[80:81]
  v_pk_fma_f32 v[54:55], v[58:59], v[52:53], v[54:55]
  v_pk_fma_f32 v[62:63], v[66:67], v[60:61], v[62:63]
  v_pk_fma_f32 v[70:71], v[74:75], v[68:69], v[70:71]
  v_pk_fma_f32 v[78:79], v[82:83], v[76:77], v[78:79]
  v_pk_mul_f32 v[52:53], v[52:53], v[56:57]
  v_pk_mul_f32 v[60:61], v[60:61], v[64:65]
  v_pk_mul_f32 v[68:69], v[68:69], v[72:73]
  v_pk_mul_f32 v[76:77], v[76:77], v[80:81]
  v_pk_mul_f32 v[54:55], v[54:55], v[60:61]
  v_pk_mul_f32 v[70:71], v[70:71], v[76:77]
  v_pk_fma_f32 v[54:55], v[62:63], v[52:53], v[54:55]
  v_pk_fma_f32 v[70:71], v[78:79], v[68:69], v[70:71]
  v_pk_mul_f32 v[52:53], v[52:53], v[60:61]
  v_pk_mul_f32 v[68:69], v[68:69], v[76:77]
  v_rcp_f32 v52, v52
  v_rcp_f32 v53, v53
  v_rcp_f32 v68, v68
  v_rcp_f32 v69, v69
  v_pk_fma_f32 v[38:39], v[52:53], v[54:55], v[38:39]
  v_pk_fma_f32 v[40:41], v[68:69], v[70:71], v[40:41]
  v_pk_mul_f32 v[52:53], v[168:169], v[168:169]
  v_pk_mul_f32 v[56:57], v[170:171], v[170:171]
  v_pk_mul_f32 v[60:61], v[172:173], v[172:173]
  v_pk_mul_f32 v[64:65], v[174:175], v[174:175]
  v_pk_mul_f32 v[68:69], v[184:185], v[184:185]
  v_pk_mul_f32 v[72:73], v[186:187], v[186:187]
  v_pk_mul_f32 v[76:77], v[188:189], v[188:189]
  v_pk_mul_f32 v[80:81], v[190:191], v[190:191]
  v_pk_fma_f32 v[52:53], v[52:53], v[14:15], v[12:13]
  v_pk_fma_f32 v[56:57], v[56:57], v[14:15], v[12:13]
  v_pk_fma_f32 v[60:61], v[60:61], v[14:15], v[12:13]
  v_pk_fma_f32 v[64:65], v[64:65], v[14:15], v[12:13]
  v_pk_fma_f32 v[68:69], v[68:69], v[14:15], v[12:13]
  v_pk_fma_f32 v[72:73], v[72:73], v[14:15], v[12:13]
  v_pk_fma_f32 v[76:77], v[76:77], v[14:15], v[12:13]
  v_pk_fma_f32 v[80:81], v[80:81], v[14:15], v[12:13]
  v_pk_fma_f32 v[52:53], v[52:53], v[168:169], v[84:85]
  v_pk_fma_f32 v[56:57], v[56:57], v[170:171], v[84:85]
  v_pk_fma_f32 v[60:61], v[60:61], v[172:173], v[84:85]
  v_pk_fma_f32 v[64:65], v[64:65], v[174:175], v[84:85]
  v_pk_fma_f32 v[68:69], v[68:69], v[184:185], v[84:85]
  v_pk_fma_f32 v[72:73], v[72:73], v[186:187], v[84:85]
  v_pk_fma_f32 v[76:77], v[76:77], v[188:189], v[84:85]
  v_pk_fma_f32 v[80:81], v[80:81], v[190:191], v[84:85]
  v_exp_f32 v52, v52 clamp
  v_exp_f32 v53, v53 clamp
  v_exp_f32 v56, v56 clamp
  v_exp_f32 v57, v57 clamp
  v_exp_f32 v60, v60 clamp
  v_exp_f32 v61, v61 clamp
  v_exp_f32 v64, v64 clamp
  v_exp_f32 v65, v65 clamp
  v_exp_f32 v68, v68 clamp
  v_exp_f32 v69, v69 clamp
  v_exp_f32 v72, v72 clamp
  v_exp_f32 v73, v73 clamp
  v_exp_f32 v76, v76 clamp
  v_exp_f32 v77, v77 clamp
  v_exp_f32 v80, v80 clamp
  v_exp_f32 v81, v81 clamp
  v_pk_mul_f32 v[54:55], v[168:169], v[16:17]
  v_pk_mul_f32 v[58:59], v[170:171], v[18:19]
  v_pk_mul_f32 v[62:63], v[172:173], v[20:21]
  v_pk_mul_f32 v[66:67], v[174:175], v[22:23]
  v_pk_mul_f32 v[70:71], v[184:185], v[16:17]
  v_pk_mul_f32 v[74:75], v[186:187], v[18:19]
  v_pk_mul_f32 v[78:79], v[188:189], v[20:21]
  v_pk_mul_f32 v[82:83], v[190:191], v[22:23]
  v_pk_fma_f32 v[52:53], v[52:53], v[86:87], v[248:249]
  v_pk_fma_f32 v[56:57], v[56:57], v[86:87], v[248:249]
  v_pk_fma_f32 v[60:61], v[60:61], v[86:87], v[248:249]
  v_pk_fma_f32 v[64:65], v[64:65], v[86:87], v[248:249]
  v_pk_fma_f32 v[68:69], v[68:69], v[86:87], v[248:249]
  v_pk_fma_f32 v[72:73], v[72:73], v[86:87], v[248:249]
  v_pk_fma_f32 v[76:77], v[76:77], v[86:87], v[248:249]
  v_pk_fma_f32 v[80:81], v[80:81], v[86:87], v[248:249]
  v_pk_mul_f32 v[54:55], v[54:55], v[56:57]
  v_pk_mul_f32 v[62:63], v[62:63], v[64:65]
  v_pk_mul_f32 v[70:71], v[70:71], v[72:73]
  v_pk_mul_f32 v[78:79], v[78:79], v[80:81]
  v_pk_fma_f32 v[54:55], v[58:59], v[52:53], v[54:55]
  v_pk_fma_f32 v[62:63], v[66:67], v[60:61], v[62:63]
  v_pk_fma_f32 v[70:71], v[74:75], v[68:69], v[70:71]
  v_pk_fma_f32 v[78:79], v[82:83], v[76:77], v[78:79]
  v_pk_mul_f32 v[52:53], v[52:53], v[56:57]
  v_pk_mul_f32 v[60:61], v[60:61], v[64:65]
  v_pk_mul_f32 v[68:69], v[68:69], v[72:73]
  v_pk_mul_f32 v[76:77], v[76:77], v[80:81]
  v_pk_mul_f32 v[54:55], v[54:55], v[60:61]
  v_pk_mul_f32 v[70:71], v[70:71], v[76:77]
  v_pk_fma_f32 v[54:55], v[62:63], v[52:53], v[54:55]
  v_pk_fma_f32 v[70:71], v[78:79], v[68:69], v[70:71]
  v_pk_mul_f32 v[52:53], v[52:53], v[60:61]
  v_pk_mul_f32 v[68:69], v[68:69], v[76:77]
  v_rcp_f32 v52, v52
  v_rcp_f32 v53, v53
  v_rcp_f32 v68, v68
  v_rcp_f32 v69, v69
  v_pk_mul_f32 v[42:43], v[52:53], v[54:55]
  v_pk_mul_f32 v[44:45], v[68:69], v[70:71]
  v_pk_mul_f32 v[52:53], v[176:177], v[176:177]
  v_pk_mul_f32 v[56:57], v[178:179], v[178:179]
  v_pk_mul_f32 v[60:61], v[180:181], v[180:181]
  v_pk_mul_f32 v[64:65], v[182:183], v[182:183]
  v_pk_mul_f32 v[68:69], v[192:193], v[192:193]
  v_pk_mul_f32 v[72:73], v[194:195], v[194:195]
  v_pk_mul_f32 v[76:77], v[196:197], v[196:197]
  v_pk_mul_f32 v[80:81], v[198:199], v[198:199]
  v_pk_fma_f32 v[52:53], v[52:53], v[14:15], v[12:13]
  v_pk_fma_f32 v[56:57], v[56:57], v[14:15], v[12:13]
  v_pk_fma_f32 v[60:61], v[60:61], v[14:15], v[12:13]
  v_pk_fma_f32 v[64:65], v[64:65], v[14:15], v[12:13]
  v_pk_fma_f32 v[68:69], v[68:69], v[14:15], v[12:13]
  v_pk_fma_f32 v[72:73], v[72:73], v[14:15], v[12:13]
  v_pk_fma_f32 v[76:77], v[76:77], v[14:15], v[12:13]
  v_pk_fma_f32 v[80:81], v[80:81], v[14:15], v[12:13]
  v_pk_fma_f32 v[52:53], v[52:53], v[176:177], v[84:85]
  v_pk_fma_f32 v[56:57], v[56:57], v[178:179], v[84:85]
  v_pk_fma_f32 v[60:61], v[60:61], v[180:181], v[84:85]
  v_pk_fma_f32 v[64:65], v[64:65], v[182:183], v[84:85]
  v_pk_fma_f32 v[68:69], v[68:69], v[192:193], v[84:85]
  v_pk_fma_f32 v[72:73], v[72:73], v[194:195], v[84:85]
  v_pk_fma_f32 v[76:77], v[76:77], v[196:197], v[84:85]
  v_pk_fma_f32 v[80:81], v[80:81], v[198:199], v[84:85]
  v_exp_f32 v52, v52 clamp
  v_exp_f32 v53, v53 clamp
  v_exp_f32 v56, v56 clamp
  v_exp_f32 v57, v57 clamp
  v_exp_f32 v60, v60 clamp
  v_exp_f32 v61, v61 clamp
  v_exp_f32 v64, v64 clamp
  v_exp_f32 v65, v65 clamp
  v_exp_f32 v68, v68 clamp
  v_exp_f32 v69, v69 clamp
  v_exp_f32 v72, v72 clamp
  v_exp_f32 v73, v73 clamp
  v_exp_f32 v76, v76 clamp
  v_exp_f32 v77, v77 clamp
  v_exp_f32 v80, v80 clamp
  v_exp_f32 v81, v81 clamp
  v_pk_mul_f32 v[54:55], v[176:177], v[24:25]
  v_pk_mul_f32 v[58:59], v[178:179], v[26:27]
  v_pk_mul_f32 v[62:63], v[180:181], v[28:29]
  v_pk_mul_f32 v[66:67], v[182:183], v[30:31]
  v_pk_mul_f32 v[70:71], v[192:193], v[24:25]
  v_pk_mul_f32 v[74:75], v[194:195], v[26:27]
  v_pk_mul_f32 v[78:79], v[196:197], v[28:29]
  v_pk_mul_f32 v[82:83], v[198:199], v[30:31]
  v_pk_fma_f32 v[52:53], v[52:53], v[86:87], v[248:249]
  v_pk_fma_f32 v[56:57], v[56:57], v[86:87], v[248:249]
  v_pk_fma_f32 v[60:61], v[60:61], v[86:87], v[248:249]
  v_pk_fma_f32 v[64:65], v[64:65], v[86:87], v[248:249]
  v_pk_fma_f32 v[68:69], v[68:69], v[86:87], v[248:249]
  v_pk_fma_f32 v[72:73], v[72:73], v[86:87], v[248:249]
  v_pk_fma_f32 v[76:77], v[76:77], v[86:87], v[248:249]
  v_pk_fma_f32 v[80:81], v[80:81], v[86:87], v[248:249]
  v_pk_mul_f32 v[54:55], v[54:55], v[56:57]
  v_pk_mul_f32 v[62:63], v[62:63], v[64:65]
  v_pk_mul_f32 v[70:71], v[70:71], v[72:73]
  v_pk_mul_f32 v[78:79], v[78:79], v[80:81]
  v_pk_fma_f32 v[54:55], v[58:59], v[52:53], v[54:55]
  v_pk_fma_f32 v[62:63], v[66:67], v[60:61], v[62:63]
  v_pk_fma_f32 v[70:71], v[74:75], v[68:69], v[70:71]
  v_pk_fma_f32 v[78:79], v[82:83], v[76:77], v[78:79]
  v_pk_mul_f32 v[52:53], v[52:53], v[56:57]
  v_pk_mul_f32 v[60:61], v[60:61], v[64:65]
  v_pk_mul_f32 v[68:69], v[68:69], v[72:73]
  v_pk_mul_f32 v[76:77], v[76:77], v[80:81]
  v_pk_mul_f32 v[54:55], v[54:55], v[60:61]
  v_pk_mul_f32 v[70:71], v[70:71], v[76:77]
  v_pk_fma_f32 v[54:55], v[62:63], v[52:53], v[54:55]
  v_pk_fma_f32 v[70:71], v[78:79], v[68:69], v[70:71]
  v_pk_mul_f32 v[52:53], v[52:53], v[60:61]
  v_pk_mul_f32 v[68:69], v[68:69], v[76:77]
  v_rcp_f32 v52, v52
  v_rcp_f32 v53, v53
  v_rcp_f32 v68, v68
  v_rcp_f32 v69, v69
  v_pk_fma_f32 v[42:43], v[52:53], v[54:55], v[42:43]
  v_pk_fma_f32 v[44:45], v[68:69], v[70:71], v[44:45]
  v_pk_mul_f32 v[52:53], v[200:201], v[200:201]
  v_pk_mul_f32 v[56:57], v[202:203], v[202:203]
  v_pk_mul_f32 v[60:61], v[204:205], v[204:205]
  v_pk_mul_f32 v[64:65], v[206:207], v[206:207]
  v_pk_mul_f32 v[68:69], v[216:217], v[216:217]
  v_pk_mul_f32 v[72:73], v[218:219], v[218:219]
  v_pk_mul_f32 v[76:77], v[220:221], v[220:221]
  v_pk_mul_f32 v[80:81], v[222:223], v[222:223]
  v_pk_fma_f32 v[52:53], v[52:53], v[14:15], v[12:13]
  v_pk_fma_f32 v[56:57], v[56:57], v[14:15], v[12:13]
  v_pk_fma_f32 v[60:61], v[60:61], v[14:15], v[12:13]
  v_pk_fma_f32 v[64:65], v[64:65], v[14:15], v[12:13]
  v_pk_fma_f32 v[68:69], v[68:69], v[14:15], v[12:13]
  v_pk_fma_f32 v[72:73], v[72:73], v[14:15], v[12:13]
  v_pk_fma_f32 v[76:77], v[76:77], v[14:15], v[12:13]
  v_pk_fma_f32 v[80:81], v[80:81], v[14:15], v[12:13]
  v_pk_fma_f32 v[52:53], v[52:53], v[200:201], v[84:85]
  v_pk_fma_f32 v[56:57], v[56:57], v[202:203], v[84:85]
  v_pk_fma_f32 v[60:61], v[60:61], v[204:205], v[84:85]
  v_pk_fma_f32 v[64:65], v[64:65], v[206:207], v[84:85]
  v_pk_fma_f32 v[68:69], v[68:69], v[216:217], v[84:85]
  v_pk_fma_f32 v[72:73], v[72:73], v[218:219], v[84:85]
  v_pk_fma_f32 v[76:77], v[76:77], v[220:221], v[84:85]
  v_pk_fma_f32 v[80:81], v[80:81], v[222:223], v[84:85]
  v_exp_f32 v52, v52 clamp
  v_exp_f32 v53, v53 clamp
  v_exp_f32 v56, v56 clamp
  v_exp_f32 v57, v57 clamp
  v_exp_f32 v60, v60 clamp
  v_exp_f32 v61, v61 clamp
  v_exp_f32 v64, v64 clamp
  v_exp_f32 v65, v65 clamp
  v_exp_f32 v68, v68 clamp
  v_exp_f32 v69, v69 clamp
  v_exp_f32 v72, v72 clamp
  v_exp_f32 v73, v73 clamp
  v_exp_f32 v76, v76 clamp
  v_exp_f32 v77, v77 clamp
  v_exp_f32 v80, v80 clamp
  v_exp_f32 v81, v81 clamp
  v_pk_mul_f32 v[54:55], v[200:201], v[16:17]
  v_pk_mul_f32 v[58:59], v[202:203], v[18:19]
  v_pk_mul_f32 v[62:63], v[204:205], v[20:21]
  v_pk_mul_f32 v[66:67], v[206:207], v[22:23]
  v_pk_mul_f32 v[70:71], v[216:217], v[16:17]
  v_pk_mul_f32 v[74:75], v[218:219], v[18:19]
  v_pk_mul_f32 v[78:79], v[220:221], v[20:21]
  v_pk_mul_f32 v[82:83], v[222:223], v[22:23]
  v_pk_fma_f32 v[52:53], v[52:53], v[86:87], v[248:249]
  v_pk_fma_f32 v[56:57], v[56:57], v[86:87], v[248:249]
  v_pk_fma_f32 v[60:61], v[60:61], v[86:87], v[248:249]
  v_pk_fma_f32 v[64:65], v[64:65], v[86:87], v[248:249]
  v_pk_fma_f32 v[68:69], v[68:69], v[86:87], v[248:249]
  v_pk_fma_f32 v[72:73], v[72:73], v[86:87], v[248:249]
  v_pk_fma_f32 v[76:77], v[76:77], v[86:87], v[248:249]
  v_pk_fma_f32 v[80:81], v[80:81], v[86:87], v[248:249]
  v_pk_mul_f32 v[54:55], v[54:55], v[56:57]
  v_pk_mul_f32 v[62:63], v[62:63], v[64:65]
  v_pk_mul_f32 v[70:71], v[70:71], v[72:73]
  v_pk_mul_f32 v[78:79], v[78:79], v[80:81]
  v_pk_fma_f32 v[54:55], v[58:59], v[52:53], v[54:55]
  v_pk_fma_f32 v[62:63], v[66:67], v[60:61], v[62:63]
  v_pk_fma_f32 v[70:71], v[74:75], v[68:69], v[70:71]
  v_pk_fma_f32 v[78:79], v[82:83], v[76:77], v[78:79]
  v_pk_mul_f32 v[52:53], v[52:53], v[56:57]
  v_pk_mul_f32 v[60:61], v[60:61], v[64:65]
  v_pk_mul_f32 v[68:69], v[68:69], v[72:73]
  v_pk_mul_f32 v[76:77], v[76:77], v[80:81]
  v_pk_mul_f32 v[54:55], v[54:55], v[60:61]
  v_pk_mul_f32 v[70:71], v[70:71], v[76:77]
  v_pk_fma_f32 v[54:55], v[62:63], v[52:53], v[54:55]
  v_pk_fma_f32 v[70:71], v[78:79], v[68:69], v[70:71]
  v_pk_mul_f32 v[52:53], v[52:53], v[60:61]
  v_pk_mul_f32 v[68:69], v[68:69], v[76:77]
  v_rcp_f32 v52, v52
  v_rcp_f32 v53, v53
  v_rcp_f32 v68, v68
  v_rcp_f32 v69, v69
  v_pk_mul_f32 v[46:47], v[52:53], v[54:55]
  v_pk_mul_f32 v[48:49], v[68:69], v[70:71]
  v_pk_mul_f32 v[52:53], v[208:209], v[208:209]
  v_pk_mul_f32 v[56:57], v[210:211], v[210:211]
  v_pk_mul_f32 v[60:61], v[212:213], v[212:213]
  v_pk_mul_f32 v[64:65], v[214:215], v[214:215]
  v_pk_mul_f32 v[68:69], v[224:225], v[224:225]
  v_pk_mul_f32 v[72:73], v[226:227], v[226:227]
  v_pk_mul_f32 v[76:77], v[228:229], v[228:229]
  v_pk_mul_f32 v[80:81], v[230:231], v[230:231]
  v_pk_fma_f32 v[52:53], v[52:53], v[14:15], v[12:13]
  v_pk_fma_f32 v[56:57], v[56:57], v[14:15], v[12:13]
  v_pk_fma_f32 v[60:61], v[60:61], v[14:15], v[12:13]
  v_pk_fma_f32 v[64:65], v[64:65], v[14:15], v[12:13]
  v_pk_fma_f32 v[68:69], v[68:69], v[14:15], v[12:13]
  v_pk_fma_f32 v[72:73], v[72:73], v[14:15], v[12:13]
  v_pk_fma_f32 v[76:77], v[76:77], v[14:15], v[12:13]
  v_pk_fma_f32 v[80:81], v[80:81], v[14:15], v[12:13]
  v_pk_fma_f32 v[52:53], v[52:53], v[208:209], v[84:85]
  v_pk_fma_f32 v[56:57], v[56:57], v[210:211], v[84:85]
  v_pk_fma_f32 v[60:61], v[60:61], v[212:213], v[84:85]
  v_pk_fma_f32 v[64:65], v[64:65], v[214:215], v[84:85]
  v_pk_fma_f32 v[68:69], v[68:69], v[224:225], v[84:85]
  v_pk_fma_f32 v[72:73], v[72:73], v[226:227], v[84:85]
  v_pk_fma_f32 v[76:77], v[76:77], v[228:229], v[84:85]
  v_pk_fma_f32 v[80:81], v[80:81], v[230:231], v[84:85]
  v_exp_f32 v52, v52 clamp
  v_exp_f32 v53, v53 clamp
  v_exp_f32 v56, v56 clamp
  v_exp_f32 v57, v57 clamp
  v_exp_f32 v60, v60 clamp
  v_exp_f32 v61, v61 clamp
  v_exp_f32 v64, v64 clamp
  v_exp_f32 v65, v65 clamp
  v_exp_f32 v68, v68 clamp
  v_exp_f32 v69, v69 clamp
  v_exp_f32 v72, v72 clamp
  v_exp_f32 v73, v73 clamp
  v_exp_f32 v76, v76 clamp
  v_exp_f32 v77, v77 clamp
  v_exp_f32 v80, v80 clamp
  v_exp_f32 v81, v81 clamp
  v_pk_mul_f32 v[54:55], v[208:209], v[24:25]
  v_pk_mul_f32 v[58:59], v[210:211], v[26:27]
  v_pk_mul_f32 v[62:63], v[212:213], v[28:29]
  v_pk_mul_f32 v[66:67], v[214:215], v[30:31]
  v_pk_mul_f32 v[70:71], v[224:225], v[24:25]
  v_pk_mul_f32 v[74:75], v[226:227], v[26:27]
  v_pk_mul_f32 v[78:79], v[228:229], v[28:29]
  v_pk_mul_f32 v[82:83], v[230:231], v[30:31]
  v_pk_fma_f32 v[52:53], v[52:53], v[86:87], v[248:249]
  v_pk_fma_f32 v[56:57], v[56:57], v[86:87], v[248:249]
  v_pk_fma_f32 v[60:61], v[60:61], v[86:87], v[248:249]
  v_pk_fma_f32 v[64:65], v[64:65], v[86:87], v[248:249]
  v_pk_fma_f32 v[68:69], v[68:69], v[86:87], v[248:249]
  v_pk_fma_f32 v[72:73], v[72:73], v[86:87], v[248:249]
  v_pk_fma_f32 v[76:77], v[76:77], v[86:87], v[248:249]
  v_pk_fma_f32 v[80:81], v[80:81], v[86:87], v[248:249]
  v_pk_mul_f32 v[54:55], v[54:55], v[56:57]
  v_pk_mul_f32 v[62:63], v[62:63], v[64:65]
  v_pk_mul_f32 v[70:71], v[70:71], v[72:73]
  v_pk_mul_f32 v[78:79], v[78:79], v[80:81]
  v_pk_fma_f32 v[54:55], v[58:59], v[52:53], v[54:55]
  v_pk_fma_f32 v[62:63], v[66:67], v[60:61], v[62:63]
  v_pk_fma_f32 v[70:71], v[74:75], v[68:69], v[70:71]
  v_pk_fma_f32 v[78:79], v[82:83], v[76:77], v[78:79]
  v_pk_mul_f32 v[52:53], v[52:53], v[56:57]
  v_pk_mul_f32 v[60:61], v[60:61], v[64:65]
  v_pk_mul_f32 v[68:69], v[68:69], v[72:73]
  v_pk_mul_f32 v[76:77], v[76:77], v[80:81]
  v_pk_mul_f32 v[54:55], v[54:55], v[60:61]
  v_pk_mul_f32 v[70:71], v[70:71], v[76:77]
  v_pk_fma_f32 v[54:55], v[62:63], v[52:53], v[54:55]
  v_pk_fma_f32 v[70:71], v[78:79], v[68:69], v[70:71]
  v_pk_mul_f32 v[52:53], v[52:53], v[60:61]
  v_pk_mul_f32 v[68:69], v[68:69], v[76:77]
  v_rcp_f32 v52, v52
  v_rcp_f32 v53, v53
  v_rcp_f32 v68, v68
  v_rcp_f32 v69, v69
  v_pk_fma_f32 v[46:47], v[52:53], v[54:55], v[46:47]
  v_pk_fma_f32 v[48:49], v[68:69], v[70:71], v[48:49]
  v_pk_mul_f32 v[52:53], v[232:233], v[232:233]
  v_pk_mul_f32 v[56:57], v[234:235], v[234:235]
  v_pk_mul_f32 v[60:61], v[236:237], v[236:237]
  v_pk_mul_f32 v[64:65], v[238:239], v[238:239]
  v_pk_mul_f32 v[68:69], v[240:241], v[240:241]
  v_pk_mul_f32 v[72:73], v[242:243], v[242:243]
  v_pk_mul_f32 v[76:77], v[244:245], v[244:245]
  v_pk_mul_f32 v[80:81], v[246:247], v[246:247]
  v_pk_fma_f32 v[52:53], v[52:53], v[14:15], v[12:13]
  v_pk_fma_f32 v[56:57], v[56:57], v[14:15], v[12:13]
  v_pk_fma_f32 v[60:61], v[60:61], v[14:15], v[12:13]
  v_pk_fma_f32 v[64:65], v[64:65], v[14:15], v[12:13]
  v_pk_fma_f32 v[68:69], v[68:69], v[14:15], v[12:13]
  v_pk_fma_f32 v[72:73], v[72:73], v[14:15], v[12:13]
  v_pk_fma_f32 v[76:77], v[76:77], v[14:15], v[12:13]
  v_pk_fma_f32 v[80:81], v[80:81], v[14:15], v[12:13]
  v_pk_fma_f32 v[52:53], v[52:53], v[232:233], v[84:85]
  v_pk_fma_f32 v[56:57], v[56:57], v[234:235], v[84:85]
  v_pk_fma_f32 v[60:61], v[60:61], v[236:237], v[84:85]
  v_pk_fma_f32 v[64:65], v[64:65], v[238:239], v[84:85]
  v_pk_fma_f32 v[68:69], v[68:69], v[240:241], v[84:85]
  v_pk_fma_f32 v[72:73], v[72:73], v[242:243], v[84:85]
  v_pk_fma_f32 v[76:77], v[76:77], v[244:245], v[84:85]
  v_pk_fma_f32 v[80:81], v[80:81], v[246:247], v[84:85]
  v_exp_f32 v52, v52 clamp
  v_exp_f32 v53, v53 clamp
  v_exp_f32 v56, v56 clamp
  v_exp_f32 v57, v57 clamp
  v_exp_f32 v60, v60 clamp
  v_exp_f32 v61, v61 clamp
  v_exp_f32 v64, v64 clamp
  v_exp_f32 v65, v65 clamp
  v_exp_f32 v68, v68 clamp
  v_exp_f32 v69, v69 clamp
  v_exp_f32 v72, v72 clamp
  v_exp_f32 v73, v73 clamp
  v_exp_f32 v76, v76 clamp
  v_exp_f32 v77, v77 clamp
  v_exp_f32 v80, v80 clamp
  v_exp_f32 v81, v81 clamp
  v_pk_mul_f32 v[54:55], v[232:233], v[16:17]
  v_pk_mul_f32 v[58:59], v[234:235], v[18:19]
  v_pk_mul_f32 v[62:63], v[236:237], v[20:21]
  v_pk_mul_f32 v[66:67], v[238:239], v[22:23]
  v_pk_mul_f32 v[70:71], v[240:241], v[24:25]
  v_pk_mul_f32 v[74:75], v[242:243], v[26:27]
  v_pk_mul_f32 v[78:79], v[244:245], v[28:29]
  v_pk_mul_f32 v[82:83], v[246:247], v[30:31]
  v_pk_fma_f32 v[52:53], v[52:53], v[86:87], v[248:249]
  v_pk_fma_f32 v[56:57], v[56:57], v[86:87], v[248:249]
  v_pk_fma_f32 v[60:61], v[60:61], v[86:87], v[248:249]
  v_pk_fma_f32 v[64:65], v[64:65], v[86:87], v[248:249]
  v_pk_fma_f32 v[68:69], v[68:69], v[86:87], v[248:249]
  v_pk_fma_f32 v[72:73], v[72:73], v[86:87], v[248:249]
  v_pk_fma_f32 v[76:77], v[76:77], v[86:87], v[248:249]
  v_pk_fma_f32 v[80:81], v[80:81], v[86:87], v[248:249]
  v_pk_mul_f32 v[54:55], v[54:55], v[56:57]
  v_pk_mul_f32 v[62:63], v[62:63], v[64:65]
  v_pk_mul_f32 v[70:71], v[70:71], v[72:73]
  v_pk_mul_f32 v[78:79], v[78:79], v[80:81]
  v_pk_fma_f32 v[54:55], v[58:59], v[52:53], v[54:55]
  v_pk_fma_f32 v[62:63], v[66:67], v[60:61], v[62:63]
  v_pk_fma_f32 v[70:71], v[74:75], v[68:69], v[70:71]
  v_pk_fma_f32 v[78:79], v[82:83], v[76:77], v[78:79]
  v_pk_mul_f32 v[52:53], v[52:53], v[56:57]
  v_pk_mul_f32 v[60:61], v[60:61], v[64:65]
  v_pk_mul_f32 v[68:69], v[68:69], v[72:73]
  v_pk_mul_f32 v[76:77], v[76:77], v[80:81]
  v_pk_mul_f32 v[54:55], v[54:55], v[60:61]
  v_pk_mul_f32 v[70:71], v[70:71], v[76:77]
  v_pk_fma_f32 v[54:55], v[62:63], v[52:53], v[54:55]
  v_pk_fma_f32 v[70:71], v[78:79], v[68:69], v[70:71]
  v_pk_mul_f32 v[52:53], v[52:53], v[60:61]
  v_pk_mul_f32 v[68:69], v[68:69], v[76:77]
  v_rcp_f32 v52, v52
  v_rcp_f32 v53, v53
  v_rcp_f32 v68, v68
  v_rcp_f32 v69, v69
  v_pk_mul_f32 v[50:51], v[52:53], v[54:55]
  v_pk_fma_f32 v[50:51], v[68:69], v[70:71], v[50:51]
  v_pk_mul_f32 v[32:33], v[88:89], v[16:17]
  v_pk_fma_f32 v[32:33], v[90:91], v[18:19], v[32:33]
  v_pk_fma_f32 v[32:33], v[92:93], v[20:21], v[32:33]
  v_pk_fma_f32 v[32:33], v[94:95], v[22:23], v[32:33]
  v_pk_fma_f32 v[32:33], v[96:97], v[24:25], v[32:33]
  v_pk_fma_f32 v[32:33], v[98:99], v[26:27], v[32:33]
  v_pk_fma_f32 v[32:33], v[100:101], v[28:29], v[32:33]
  v_pk_fma_f32 v[32:33], v[102:103], v[30:31], v[32:33]
  v_add_f32 v32, v32, v33
  v_add_f32 v34, v34, v35
  v_add_f32 v36, v36, v37
  v_add_f32 v38, v38, v39
  v_add_f32 v40, v40, v41
  v_add_f32 v42, v42, v43
  v_add_f32 v44, v44, v45
  v_add_f32 v46, v46, v47
  v_add_f32 v48, v48, v49
  v_add_f32 v50, v50, v51
  v_permlane32_swap_b32 v32, v34
  v_permlane32_swap_b32 v36, v38
  v_permlane32_swap_b32 v40, v42
  v_permlane32_swap_b32 v44, v46
  v_permlane32_swap_b32 v48, v50
  v_add_f32 v48, v48, v50
  v_add_f32 v32, v32, v34
  v_add_f32 v36, v36, v38
  v_add_f32 v40, v40, v42
  v_add_f32 v44, v44, v46
  v_mov_b32 v50, v48
  v_permlane16_swap_b32 v32, v36
  v_permlane16_swap_b32 v40, v44
  v_permlane16_swap_b32 v48, v50
  v_add_f32 v32, v32, v36
  v_add_f32 v40, v40, v44
  v_add_f32_e64 v48, v48, v50
  ds_write_b32 v10, v32
  ds_write_b32 v10, v40 offset:256
  s_mov_b32 exec_lo, 0xffff
  s_mov_b32 exec_hi, 0xffff
  ds_write_b32 v10, v48 offset:512
  s_mov_b64 exec, -1
  s_waitcnt lgkmcnt(0)
  s_barrier
  s_endpgm
L_ld_tail0:
  s_waitcnt vmcnt(0)
L_ld_tail:
  s_barrier
  s_mov_b32 s60, s24
  s_and_b32 s61, s25, 0xffff
  s_mov_b32 s62, 268435456
  s_mov_b32 s63, 0x20000
  s_mov_b32 s56, s20
  s_and_b32 s57, s21, 0xffff
  s_mov_b32 s58, 8192
  s_mov_b32 s59, 0x20000
  s_mov_b32 s64, s22
  s_and_b32 s65, s23, 0xffff
  s_mov_b32 s66, 256
  s_mov_b32 s67, 0x20000
  s_load_dword s80, s[18:19], 0
  v_mov_b32_e64 v100, 0
  s_mov_b64 exec, 1
  s_mov_b32 s81, 0x80000
  buffer_load_dword v101, v100, s[60:63], s81 offen
  buffer_load_dword v102, v100, s[56:59], 0 offen
  s_mov_b64 exec, -1
  s_mov_b64 exec, 1
  buffer_load_dword v250, v100, s[64:67], 0 offen offset:128 sc1
  s_mov_b64 exec, -1
  s_cmp_lg_u32 s3, 4
  s_cbranch_scc1 L_end
  v_lshlrev_b32 v3, 4, v0
  v_lshlrev_b32 v4, 2, v0
  v_add_u32 v1, 123392, v3
  v_add_u32 v2, 124416, v4
  v_add_u32 v4, 1024, v4
  v_mov_b32 v5, 32
  v_mov_b32_e64 v7, s26
  s_mul_i32 s68, s26, 1280
  s_mul_i32 s69, s27, 16640
  s_add_u32 s69, s69, s68
  s_setprio 3
  v_mov_b32 v64, -1
  v_mov_b32 v65, -1
  v_mov_b32 v66, -1
  v_mov_b32 v67, -1
  buffer_store_dwordx4 v[64:67], v3, s[60:63], s69 offen sc1
  buffer_store_dword v64, v4, s[60:63], s69 offen sc1
  s_waitcnt vmcnt(0)
  v_readfirstlane_b32 s81, v250
  s_nop 0
  s_cmp_eq_u32 s81, 0
  s_cbranch_scc1 L_cid
L_crd:
  s_barrier
  ds_read_b128 v[64:67], v1
  ds_read_b128 v[72:75], v1 offset:1280
  ds_read2st64_b32 v[68:69], v2 offset0:0 offset1:5
  s_waitcnt lgkmcnt(0)
  v_pk_add_f32 v[64:65], v[64:65], v[72:73]
  v_pk_add_f32 v[66:67], v[66:67], v[74:75]
  v_add_f32 v68, v68, v69
  v_min_u32 v64, -2, v64
  v_min_u32 v65, -2, v65
  v_min_u32 v66, -2, v66
  v_min_u32 v67, -2, v67
  v_min_u32 v68, -2, v68
  buffer_store_dwordx4 v[64:67], v3, s[60:63], s69 offen sc1
  buffer_store_dword v68, v4, s[60:63], s69 offen sc1
  s_mov_b64 exec, 1
L_pub:
  v_lshlrev_b32 v6, 8, v7
  s_mov_b32 s70, 0x60000
  v_mov_b32 v13, v5
  buffer_atomic_add v5, v6, s[60:63], s70 offen sc0
  v_cmp_eq_u32 vcc, 12, v7
  v_mov_b32 v8, 0x1b4
  v_mov_b32 v9, 0x1b2
  v_cndmask_b32 v8, v8, v9, vcc
  v_sub_u32 v8, v8, v13
  s_waitcnt vmcnt(0) lgkmcnt(0)
  v_cmp_eq_u32 s[82:83], v5, v8
  s_mov_b64 exec, -1
  s_lshl_b32 s80, s80, 16
  v_lshrrev_b32 v1, 1, v3
  v_lshrrev_b32 v2, 1, v4
L_fin:
  s_cmp_eq_u32 s82, 0
  s_cbranch_scc1 L_done
  s_ff1_i32_b32 s70, s82
  s_bitset0_b32 s82, s70
  v_readlane_b32 s71, v7, s70
  s_waitcnt vmcnt(0)
L_again:
  s_mul_i32 s68, s71, 1280
  buffer_load_dwordx4 v[64:67], v3, s[60:63], s68 offen sc1
  buffer_load_dword v68, v4, s[60:63], s68 offen sc1
  s_add_u32 s68, s68, 16640
  buffer_load_dwordx4 v[72:75], v3, s[60:63], s68 offen sc1
  buffer_load_dword v76, v4, s[60:63], s68 offen sc1
  s_add_u32 s68, s68, 16640
  buffer_load_dwordx4 v[80:83], v3, s[60:63], s68 offen sc1
  buffer_load_dword v84, v4, s[60:63], s68 offen sc1
  s_add_u32 s68, s68, 16640
  buffer_load_dwordx4 v[88:91], v3, s[60:63], s68 offen sc1
  buffer_load_dword v92, v4, s[60:63], s68 offen sc1
  s_add_u32 s68, s68, 16640
  buffer_load_dwordx4 v[96:99], v3, s[60:63], s68 offen sc1
  buffer_load_dword v100, v4, s[60:63], s68 offen sc1
  s_add_u32 s68, s68, 16640
  buffer_load_dwordx4 v[104:107], v3, s[60:63], s68 offen sc1
  buffer_load_dword v108, v4, s[60:63], s68 offen sc1
  s_add_u32 s68, s68, 16640
  buffer_load_dwordx4 v[112:115], v3, s[60:63], s68 offen sc1
  buffer_load_dword v116, v4, s[60:63], s68 offen sc1
  s_add_u32 s68, s68, 16640
  buffer_load_dwordx4 v[120:123], v3, s[60:63], s68 offen sc1
  buffer_load_dword v124, v4, s[60:63], s68 offen sc1
  s_add_u32 s68, s68, 16640
  buffer_load_dwordx4 v[128:131], v3, s[60:63], s68 offen sc1
  buffer_load_dword v132, v4, s[60:63], s68 offen sc1
  s_add_u32 s68, s68, 16640
  buffer_load_dwordx4 v[136:139], v3, s[60:63], s68 offen sc1
  buffer_load_dword v140, v4, s[60:63], s68 offen sc1
  s_add_u32 s68, s68, 16640
  buffer_load_dwordx4 v[144:147], v3, s[60:63], s68 offen sc1
  buffer_load_dword v148, v4, s[60:63], s68 offen sc1
  s_add_u32 s68, s68, 16640
  buffer_load_dwordx4 v[152:155], v3, s[60:63], s68 offen sc1
  buffer_load_dword v156, v4, s[60:63], s68 offen sc1
  s_add_u32 s68, s68, 16640
  buffer_load_dwordx4 v[160:163], v3, s[60:63], s68 offen sc1
  buffer_load_dword v164, v4, s[60:63], s68 offen sc1
  s_add_u32 s68, s68, 16640
  buffer_load_dwordx4 v[168:171], v3, s[60:63], s68 offen sc1
  buffer_load_dword v172, v4, s[60:63], s68 offen sc1
  s_add_u32 s68, s68, 16640
L_sum:
  s_waitcnt vmcnt(25)
  v_pk_add_f32 v[56:57], v[64:65], v[72:73]
  v_pk_add_f32 v[58:59], v[66:67], v[74:75]
  s_waitcnt vmcnt(24)
  v_add_f32 v60, v68, v76
  s_waitcnt vmcnt(23)
  v_pk_add_f32 v[56:57], v[56:57], v[80:81]
  v_pk_add_f32 v[58:59], v[58:59], v[82:83]
  s_waitcnt vmcnt(22)
  v_add_f32 v60, v60, v84
  s_waitcnt vmcnt(21)
  v_pk_add_f32 v[56:57], v[56:57], v[88:89]
  v_pk_add_f32 v[58:59], v[58:59], v[90:91]
  s_waitcnt vmcnt(20)
  v_add_f32 v60, v60, v92
  s_waitcnt vmcnt(19)
  v_pk_add_f32 v[56:57], v[56:57], v[96:97]
  v_pk_add_f32 v[58:59], v[58:59], v[98:99]
  s_waitcnt vmcnt(18)
  v_add_f32 v60, v60, v100
  s_waitcnt vmcnt(17)
  v_pk_add_f32 v[56:57], v[56:57], v[104:105]
  v_pk_add_f32 v[58:59], v[58:59], v[106:107]
  s_waitcnt vmcnt(16)
  v_add_f32_e64 v60, v60, v108
  s_waitcnt vmcnt(15)
  v_pk_add_f32 v[56:57], v[56:57], v[112:113]
  v_pk_add_f32 v[58:59], v[58:59], v[114:115]
  s_waitcnt vmcnt(14)
  v_add_f32 v60, v60, v116
  s_waitcnt vmcnt(13)
  v_pk_add_f32 v[56:57], v[56:57], v[120:121]
  v_pk_add_f32 v[58:59], v[58:59], v[122:123]
  s_waitcnt vmcnt(12)
  v_add_f32 v60, v60, v124
  s_waitcnt vmcnt(11)
  v_pk_add_f32 v[56:57], v[56:57], v[128:129]
  v_pk_add_f32 v[58:59], v[58:59], v[130:131]
  s_waitcnt vmcnt(10)
  v_add_f32 v60, v60, v132
  s_waitcnt vmcnt(9)
  v_pk_add_f32 v[56:57], v[56:57], v[136:137]
  v_pk_add_f32 v[58:59], v[58:59], v[138:139]
  s_waitcnt vmcnt(8)
  v_add_f32 v60, v60, v140
  s_waitcnt vmcnt(7)
  v_pk_add_f32 v[56:57], v[56:57], v[144:145]
  v_pk_add_f32 v[58:59], v[58:59], v[146:147]
  s_waitcnt vmcnt(6)
  v_add_f32 v60, v60, v148
  s_waitcnt vmcnt(5)
  v_pk_add_f32 v[56:57], v[56:57], v[152:153]
  v_pk_add_f32 v[58:59], v[58:59], v[154:155]
  s_waitcnt vmcnt(4)
  v_add_f32 v60, v60, v156
  s_waitcnt vmcnt(3)
  v_pk_add_f32 v[56:57], v[56:57], v[160:161]
  v_pk_add_f32 v[58:59], v[58:59], v[162:163]
  s_waitcnt vmcnt(2)
  v_add_f32 v60, v60, v164
  s_waitcnt vmcnt(1)
  v_pk_add_f32 v[56:57], v[56:57], v[168:169]
  v_pk_add_f32 v[58:59], v[58:59], v[170:171]
  s_waitcnt vmcnt(0)
  v_add_f32 v60, v60, v172
  v_cmp_u_f32 vcc, v56, v57
  v_cmp_u_f32 s[92:93], v58, v59
  s_nop 0
  s_or_b64 s[92:93], s[92:93], vcc
  v_cmp_u_f32 vcc, v60, v60
  s_nop 0
  s_or_b64 vcc, s[92:93], vcc
  s_cbranch_vccnz L_chk
L_ok:
  s_mul_i32 s71, s71, 640
  v_add_f32 v56, s80, v56
  v_add_f32 v57, s80, v57
  v_add_f32 v58, s80, v58
  v_add_f32 v59, s80, v59
  v_add_f32_e64 v60, s80, v60
  v_cvt_pk_bf16_f32 v10, v56, v57
  v_cvt_pk_bf16_f32 v11, v58, v59
  v_cvt_pk_bf16_f32 v12, v60, v60
  buffer_store_dwordx2 v[10:11], v1, s[56:59], s71 offen
  buffer_store_short v12, v2, s[56:59], s71 offen
  s_branch L_fin
L_chk:
  v_mov_b32 v14, 0
  v_mov_b32 v15, 0
  v_max3_u32 v14, v14, v64, v65
  v_max3_u32 v14, v14, v66, v67
  v_max_u32 v15, v15, v68
  v_max3_u32 v14, v14, v72, v73
  v_max3_u32 v14, v14, v74, v75
  v_max_u32_e64 v15, v15, v76
  v_max3_u32 v14, v14, v80, v81
  v_max3_u32 v14, v14, v82, v83
  v_max_u32 v15, v15, v84
  v_max3_u32 v14, v14, v88, v89
  v_max3_u32 v14, v14, v90, v91
  v_max_u32 v15, v15, v92
  v_max3_u32 v14, v14, v96, v97
  v_max3_u32 v14, v14, v98, v99
  v_max_u32_e64 v15, v15, v100
  v_max3_u32 v14, v14, v104, v105
  v_max3_u32 v14, v14, v106, v107
  v_max_u32 v15, v15, v108
  v_max3_u32 v14, v14, v112, v113
  v_max3_u32 v14, v14, v114, v115
  v_max_u32 v15, v15, v116
  v_max3_u32 v14, v14, v120, v121
  v_max3_u32 v14, v14, v122, v123
  v_max_u32_e64 v15, v15, v124
  v_max3_u32 v14, v14, v128, v129
  v_max3_u32 v14, v14, v130, v131
  v_max_u32 v15, v15, v132
  v_max3_u32 v14, v14, v136, v137
  v_max3_u32 v14, v14, v138, v139
  v_max_u32 v15, v15, v140
  v_max3_u32 v14, v14, v144, v145
  v_max3_u32 v14, v14, v146, v147
  v_max_u32_e64 v15, v15, v148
  v_max3_u32 v14, v14, v152, v153
  v_max3_u32 v14, v14, v154, v155
  v_max_u32 v15, v15, v156
  v_max3_u32 v14, v14, v160, v161
  v_max3_u32 v14, v14, v162, v163
  v_max_u32 v15, v15, v164
  v_max3_u32 v14, v14, v168, v169
  v_max3_u32 v14, v14, v170, v171
  v_max_u32 v15, v15, v172
  s_cmp_eq_u32 s71, 12
  s_cselect_b32 s68, 0, -1
  v_and_b32 v15, s68, v15
  v_max_u32 v14, v14, v15
  v_cmp_eq_u32 vcc, -1, v14
  s_cbranch_vccnz L_again
  s_branch L_ok
L_done:
  s_endpgm
L_cin_done:
  s_mul_i32 s98, s3, 1536
  s_add_u32 s98, s98, 116736
  v_lshlrev_b32 v120, 5, v0
  v_add_u32_e64 v120, s98, v120
  ds_read_b128 v[60:63], v120
  ds_read_b128 v[64:67], v120 offset:16
  v_mul_f32 v116, v184, v192
  v_mul_f32 v117, v185, v193
  v_mul_f32 v118, v186, v194
  v_mul_f32 v119, v187, v195
  v_fmac_f32 v116, v188, v191
  v_fmac_f32 v117, v200, v208
  v_fmac_f32 v118, v201, v209
  v_fmac_f32 v119, v202, v210
  v_fmac_f32 v116, v203, v211
  v_fmac_f32 v117, v204, v207
  v_fmac_f32 v118, v216, v224
  v_fmac_f32 v119, v217, v225
  v_fmac_f32 v116, v218, v226
  v_fmac_f32 v117, v219, v227
  v_fmac_f32 v118, v220, v223
  v_fmac_f32 v119, v232, v240
  v_fmac_f32 v116, v233, v241
  v_fmac_f32 v117, v234, v242
  v_fmac_f32 v118, v235, v243
  v_fmac_f32 v119, v236, v239
  v_fmac_f32 v116, v189, v196
  v_fmac_f32 v117, v189, v197
  v_fmac_f32 v118, v190, v198
  v_fmac_f32 v119, v190, v199
  v_fmac_f32 v116, v205, v212
  v_fmac_f32 v117, v205, v213
  v_fmac_f32 v118, v206, v214
  v_fmac_f32 v119, v206, v215
  v_fmac_f32 v116, v221, v228
  v_fmac_f32 v117, v221, v229
  v_fmac_f32 v118, v222, v230
  v_fmac_f32 v119, v222, v231
  v_fmac_f32 v116, v237, v244
  v_fmac_f32 v117, v237, v245
  v_fmac_f32 v118, v238, v246
  v_fmac_f32 v119, v238, v247
  v_add_f32 v116, v116, v117
  v_add_f32 v118, v118, v119
  v_add_f32 v116, v116, v118
  v_mul_f32 v116, s74, v116
  v_mul_f32 v116, s75, v116
  s_nop 1
  v_add_f32_dpp v116, v116, v116 row_shr:1 row_mask:0xf bank_mask:0xf
  v_subrev_u32 v122, s98, v7
  v_lshrrev_b32 v122, 8, v122
  v_lshrrev_b32 v121, 3, v0
  v_add_f32_dpp v116, v116, v116 row_shr:2 row_mask:0xf bank_mask:0xf
  v_cmp_gt_u32 vcc, v122, v121
  v_min_u32 v121, v121, v122
  v_lshlrev_b32 v121, 4, v121
  v_add_f32_dpp v116, v116, v116 row_shr:4 row_mask:0xf bank_mask:0xf
  v_add_u32 v121, s85, v121
  s_waitcnt lgkmcnt(1)
  v_add_f32 v60, v60, v61
  v_add_f32 v62, v62, v63
  v_add_f32_dpp v116, v116, v116 row_shr:8 row_mask:0xf bank_mask:0xf
  s_waitcnt lgkmcnt(0)
  v_add_f32 v64, v64, v65
  v_add_f32 v66, v66, v67
  v_add_f32 v60, v60, v62
  v_add_f32_dpp v116, v116, v116 row_bcast:15 row_mask:0xa bank_mask:0xf
  v_add_f32 v64, v64, v66
  v_add_f32_e64 v60, v60, v64
  s_nop 1
  v_add_f32_dpp v60, v60, v60 quad_perm:[1,0,3,2] row_mask:0xf bank_mask:0xf
  v_add_f32_dpp v116, v116, v116 row_bcast:31 row_mask:0xc bank_mask:0xf
  s_nop 0
  v_add_f32_dpp v60, v60, v60 quad_perm:[2,3,0,1] row_mask:0xf bank_mask:0xf
  s_nop 1
  v_add_f32_dpp v60, v60, v60 row_half_mirror row_mask:0xf bank_mask:0xf
  v_cndmask_b32 v60, v116, v60, vcc
  s_bitset1_b32 vcc_hi, 31
  s_mov_b64 exec, vcc
  ds_write_b32 v121, v60
  s_mov_b64 exec, -1
  s_cmp_eq_u32 s3, 0
  s_cbranch_scc1 L_cpub
  s_waitcnt lgkmcnt(0)
  s_barrier
  s_endpgm
L_cpub:
  s_load_dword s80, s[18:19], 0
  s_mov_b32 s60, s24
  s_and_b32 s61, s25, 0xffff
  s_mov_b32 s62, 268435456
  s_mov_b32 s63, 0x20000
  s_mov_b32 s56, s20
  s_and_b32 s57, s21, 0xffff
  s_mov_b32 s58, 8192
  s_mov_b32 s59, 0x20000
  s_mov_b32 s64, s22
  s_and_b32 s65, s23, 0xffff
  s_mov_b32 s66, 256
  s_mov_b32 s67, 0x20000
  v_lshlrev_b32 v6, 2, v0
  v_add_u32 v2, 129728, v6
  v_add_u32 v4, 1024, v6
  s_mul_i32 s69, s26, 192
  s_add_u32 s69, s69, 216320
  v_mov_b32 v13, -1
  s_mov_b32 exec_hi, 0xffff
  buffer_store_dword v13, v6, s[60:63], s69 offen sc1
  s_mov_b64 exec, 1
  buffer_load_dword v250, v6, s[56:59], 0 offen
  buffer_load_dword v251, v6, s[64:67], 0 offen offset:128 sc1
  s_mov_b64 exec, -1
  s_mul_i32 s68, s26, 3
  s_mul_i32 s70, s68, 3277
  s_lshr_b32 s70, s70, 16
  v_add_u32 v7, s70, v0
  s_mul_i32 s70, s70, 20
  s_add_u32 s70, s70, 20
  s_sub_u32 s70, s70, s68
  s_min_u32 s70, s70, 3
  s_sub_u32 s68, 3, s70
  v_mov_b32 v5, s68
  v_writelane_b32 v5, s70, 0
  s_cmp_eq_u32 s68, 0
  s_cselect_b32 s68, 1, 3
  v_lshlrev_b32 v3, 4, v0
  s_waitcnt vmcnt(0) lgkmcnt(0)
  v_readfirstlane_b32 s81, v251
  s_nop 0
  s_cmp_eq_u32 s81, 0
  s_cbranch_scc1 L_cic
L_crc:
  s_mov_b32 exec_hi, 0xffff
  s_barrier
  ds_read_b32 v64, v2
  s_waitcnt lgkmcnt(0)
  v_min_u32_e64 v64, -2, v64
  buffer_store_dword v64, v6, s[60:63], s69 offen sc1
  s_mov_b32 exec_lo, s68
  s_mov_b32 exec_hi, 0
  s_branch L_pub
L_dnn_loop1:
  s_barrier
L_ld_in:
  s_add_u32 m0, s75, 131072
  s_nop 0
  buffer_load_dwordx4 v4, s[44:47], s74 offen lds
  s_add_u32 m0, s75, 132096
  s_nop 0
  buffer_load_dwordx4 v5, s[44:47], s74 offen lds
  s_add_u32 s74, s74, 106496
  s_add_u32 m0, s75, 139264
  s_nop 0
  buffer_load_dwordx4 v4, s[44:47], s74 offen lds
  s_add_u32 m0, s75, 140288
  s_nop 0
  buffer_load_dwordx4 v5, s[44:47], s74 offen lds
  s_add_u32 s74, s74, 106496
  s_add_u32 m0, s76, 0
  s_nop 0
  buffer_load_dwordx4 v56, s[32:35], 0 offen lds
  s_add_u32 m0, s76, 2048
  v_add_u32_dpp v56, v16, v2 row_newbcast:1 row_mask:0xf bank_mask:0x3
  buffer_load_dwordx4 v57, s[32:35], 0 offen lds
  s_nop 0
  v_add_u32_dpp v56, v18, v2 row_newbcast:7 row_mask:0xf bank_mask:0xc
  s_add_u32 m0, s76, 4096
  v_add_u32_dpp v57, v20, v2 row_newbcast:1 row_mask:0xf bank_mask:0x3
  buffer_load_dwordx4 v58, s[32:35], 0 offen lds
  s_nop 0
  v_add_u32_dpp v57, v22, v2 row_newbcast:7 row_mask:0xf bank_mask:0xc
  s_add_u32 m0, s76, 6144
  v_add_u32_dpp v58, v24, v2 row_newbcast:1 row_mask:0xf bank_mask:0x3
  buffer_load_dwordx4 v59, s[32:35], 0 offen lds
  s_nop 0
  v_add_u32_dpp v58, v26, v2 row_newbcast:7 row_mask:0xf bank_mask:0xc
  s_add_u32 m0, s76, 8192
  v_add_u32_dpp v59, v28, v2 row_newbcast:1 row_mask:0xf bank_mask:0x3
  buffer_load_dwordx4 v60, s[32:35], 0 offen lds
  s_nop 0
  v_add_u32_dpp v59, v30, v2 row_newbcast:7 row_mask:0xf bank_mask:0xc
  s_add_u32 m0, s76, 10240
  v_add_u32_dpp v60, v32, v2 row_newbcast:1 row_mask:0xf bank_mask:0x3
  buffer_load_dwordx4 v61, s[32:35], 0 offen lds
  s_nop 0
  v_add_u32_dpp v60, v34, v2 row_newbcast:7 row_mask:0xf bank_mask:0xc
  s_add_u32 m0, s76, 12288
  v_add_u32_dpp v61, v36, v2 row_newbcast:1 row_mask:0xf bank_mask:0x3
  buffer_load_dwordx4 v62, s[32:35], 0 offen lds
  s_nop 0
  v_add_u32_dpp v61, v38, v2 row_newbcast:7 row_mask:0xf bank_mask:0xc
  s_add_u32 m0, s76, 14336
  v_add_u32_dpp v62, v40, v2 row_newbcast:1 row_mask:0xf bank_mask:0x3
  buffer_load_dwordx4 v63, s[32:35], 0 offen lds
  s_nop 0
  v_add_u32_dpp v62, v42, v2 row_newbcast:7 row_mask:0xf bank_mask:0xc
  s_add_u32 m0, s76, 16384
  v_add_u32_dpp v63, v44, v2 row_newbcast:1 row_mask:0xf bank_mask:0x3
  buffer_load_dwordx4 v64, s[32:35], 0 offen lds
  s_nop 0
  v_add_u32_dpp v63, v46, v2 row_newbcast:7 row_mask:0xf bank_mask:0xc
  s_add_u32 m0, s76, 18432
  v_add_u32_dpp v64, v48, v2 row_newbcast:1 row_mask:0xf bank_mask:0x3
  buffer_load_dwordx4 v65, s[32:35], 0 offen lds
  s_nop 0
  v_add_u32_dpp v64, v50, v2 row_newbcast:7 row_mask:0xf bank_mask:0xc
  v_add_u32_dpp v65, v52, v2 row_newbcast:1 row_mask:0xf bank_mask:0x3
  s_nop 1
  v_add_u32_dpp v65, v54, v2 row_newbcast:7 row_mask:0xf bank_mask:0xc
  s_mov_b64 exec, 0x3ff
  buffer_load_dword v103, v84, s[44:47], s85 offen
  s_mov_b64 exec, -1
  s_add_u32 s85, s85, 865280
  s_waitcnt vmcnt(11)
  s_barrier
  s_add_u32 m0, s75, 147456
  s_nop 0
  buffer_load_dwordx4 v4, s[44:47], s74 offen lds
  s_add_u32 m0, s75, 148480
  s_nop 0
  buffer_load_dwordx4 v5, s[44:47], s74 offen lds
  s_add_u32 s74, s74, 106496
  s_add_u32 m0, s75, 155648
  s_nop 0
  buffer_load_dwordx4 v4, s[44:47], s74 offen lds
  s_add_u32 m0, s75, 156672
  s_nop 0
  buffer_load_dwordx4 v5, s[44:47], s74 offen lds
  s_add_u32 s74, s74, 106496
  s_add_u32 m0, s76, 40960
  s_nop 0
  buffer_load_dwordx4 v56, s[32:35], 0 offen lds
  s_add_u32 m0, s76, 43008
  v_add_u32_dpp v56, v17, v2 row_newbcast:1 row_mask:0xf bank_mask:0x3
  buffer_load_dwordx4 v57, s[32:35], 0 offen lds
  s_nop 0
  v_add_u32_dpp v56, v19, v2 row_newbcast:7 row_mask:0xf bank_mask:0xc
  s_add_u32 m0, s76, 45056
  v_add_u32_dpp v57, v21, v2 row_newbcast:1 row_mask:0xf bank_mask:0x3
  buffer_load_dwordx4 v58, s[32:35], 0 offen lds
  s_nop 0
  v_add_u32_dpp v57, v23, v2 row_newbcast:7 row_mask:0xf bank_mask:0xc
  s_add_u32 m0, s76, 47104
  v_add_u32_dpp v58, v25, v2 row_newbcast:1 row_mask:0xf bank_mask:0x3
  buffer_load_dwordx4 v59, s[32:35], 0 offen lds
  s_nop 0
  v_add_u32_dpp v58, v27, v2 row_newbcast:7 row_mask:0xf bank_mask:0xc
  s_add_u32 m0, s76, 49152
  v_add_u32_dpp v59, v29, v2 row_newbcast:1 row_mask:0xf bank_mask:0x3
  buffer_load_dwordx4 v60, s[32:35], 0 offen lds
  s_nop 0
  v_add_u32_dpp v59, v31, v2 row_newbcast:7 row_mask:0xf bank_mask:0xc
  s_add_u32 m0, s76, 51200
  v_add_u32_dpp v60, v33, v2 row_newbcast:1 row_mask:0xf bank_mask:0x3
  buffer_load_dwordx4 v61, s[32:35], 0 offen lds
  s_nop 0
  v_add_u32_dpp v60, v35, v2 row_newbcast:7 row_mask:0xf bank_mask:0xc
  s_add_u32 m0, s76, 53248
  v_add_u32_dpp v61, v37, v2 row_newbcast:1 row_mask:0xf bank_mask:0x3
  buffer_load_dwordx4 v62, s[32:35], 0 offen lds
  s_nop 0
  v_add_u32_dpp v61, v39, v2 row_newbcast:7 row_mask:0xf bank_mask:0xc
  s_add_u32 m0, s76, 55296
  v_add_u32_dpp v62, v41, v2 row_newbcast:1 row_mask:0xf bank_mask:0x3
  buffer_load_dwordx4 v63, s[32:35], 0 offen lds
  s_nop 0
  v_add_u32_dpp v62, v43, v2 row_newbcast:7 row_mask:0xf bank_mask:0xc
  s_add_u32 m0, s76, 57344
  v_add_u32_dpp v63, v45, v2 row_newbcast:1 row_mask:0xf bank_mask:0x3
  buffer_load_dwordx4 v64, s[32:35], 0 offen lds
  s_nop 0
  v_add_u32_dpp v63, v47, v2 row_newbcast:7 row_mask:0xf bank_mask:0xc
  s_add_u32 m0, s76, 59392
  v_add_u32_dpp v64, v49, v2 row_newbcast:1 row_mask:0xf bank_mask:0x3
  buffer_load_dwordx4 v65, s[32:35], 0 offen lds
  s_nop 0
  v_add_u32_dpp v64, v51, v2 row_newbcast:7 row_mask:0xf bank_mask:0xc
  v_add_u32_dpp v65, v53, v2 row_newbcast:1 row_mask:0xf bank_mask:0x3
  s_nop 1
  v_add_u32_dpp v65, v55, v2 row_newbcast:7 row_mask:0xf bank_mask:0xc
  s_waitcnt vmcnt(10)
  s_barrier
  s_add_u32 m0, s75, 131072
  s_nop 0
  buffer_load_dwordx4 v4, s[44:47], s74 offen lds
  s_add_u32 m0, s75, 132096
  s_nop 0
  buffer_load_dwordx4 v5, s[44:47], s74 offen lds
  s_add_u32 s74, s74, 106496
  s_add_u32 m0, s75, 139264
  s_nop 0
  buffer_load_dwordx4 v4, s[44:47], s74 offen lds
  s_add_u32 m0, s75, 140288
  s_nop 0
  buffer_load_dwordx4 v5, s[44:47], s74 offen lds
  s_add_u32 s74, s74, 106496
  s_add_u32 m0, s76, 81920
  s_nop 0
  buffer_load_dwordx4 v56, s[32:35], 0 offen lds
  s_add_u32 m0, s76, 83968
  v_add_u32_dpp v56, v18, v2 row_newbcast:1 row_mask:0xf bank_mask:0x3
  buffer_load_dwordx4 v57, s[32:35], 0 offen lds
  s_nop 0
  v_add_u32_dpp v56, v16, v2 row_newbcast:8 row_mask:0xf bank_mask:0xc
  s_add_u32 m0, s76, 86016
  v_add_u32_dpp v57, v22, v2 row_newbcast:1 row_mask:0xf bank_mask:0x3
  buffer_load_dwordx4 v58, s[32:35], 0 offen lds
  s_nop 0
  v_add_u32_dpp v57, v20, v2 row_newbcast:8 row_mask:0xf bank_mask:0xc
  s_add_u32 m0, s76, 88064
  v_add_u32_dpp v58, v26, v2 row_newbcast:1 row_mask:0xf bank_mask:0x3
  buffer_load_dwordx4 v59, s[32:35], 0 offen lds
  s_nop 0
  v_add_u32_dpp v58, v24, v2 row_newbcast:8 row_mask:0xf bank_mask:0xc
  s_add_u32 m0, s76, 90112
  v_add_u32_dpp v59, v30, v2 row_newbcast:1 row_mask:0xf bank_mask:0x3
  buffer_load_dwordx4 v60, s[32:35], 0 offen lds
  s_nop 0
  v_add_u32_dpp v59, v28, v2 row_newbcast:8 row_mask:0xf bank_mask:0xc
  s_add_u32 m0, s76, 92160
  v_add_u32_dpp v60, v34, v2 row_newbcast:1 row_mask:0xf bank_mask:0x3
  buffer_load_dwordx4 v61, s[32:35], 0 offen lds
  s_nop 0
  v_add_u32_dpp v60, v32, v2 row_newbcast:8 row_mask:0xf bank_mask:0xc
  s_add_u32 m0, s76, 94208
  v_add_u32_dpp v61, v38, v2 row_newbcast:1 row_mask:0xf bank_mask:0x3
  buffer_load_dwordx4 v62, s[32:35], 0 offen lds
  s_nop 0
  v_add_u32_dpp v61, v36, v2 row_newbcast:8 row_mask:0xf bank_mask:0xc
  s_add_u32 m0, s76, 96256
  v_add_u32_dpp v62, v42, v2 row_newbcast:1 row_mask:0xf bank_mask:0x3
  buffer_load_dwordx4 v63, s[32:35], 0 offen lds
  s_nop 0
  v_add_u32_dpp v62, v40, v2 row_newbcast:8 row_mask:0xf bank_mask:0xc
  s_add_u32 m0, s76, 98304
  v_add_u32_dpp v63, v46, v2 row_newbcast:1 row_mask:0xf bank_mask:0x3
  buffer_load_dwordx4 v64, s[32:35], 0 offen lds
  s_nop 0
  v_add_u32_dpp v63, v44, v2 row_newbcast:8 row_mask:0xf bank_mask:0xc
  s_add_u32 m0, s76, 100352
  v_add_u32_dpp v64, v50, v2 row_newbcast:1 row_mask:0xf bank_mask:0x3
  buffer_load_dwordx4 v65, s[32:35], 0 offen lds
  s_nop 0
  v_add_u32_dpp v64, v48, v2 row_newbcast:8 row_mask:0xf bank_mask:0xc
  v_add_u32_dpp v65, v54, v2 row_newbcast:1 row_mask:0xf bank_mask:0x3
  s_nop 1
  v_add_u32_dpp v65, v52, v2 row_newbcast:8 row_mask:0xf bank_mask:0xc
  v_lshlrev_b32 v101, 7, v70
  s_mov_b32 exec_lo, 0xffffffff
  s_mov_b32 exec_hi, 0x0
  buffer_load_dword v102, v101, s[32:35], 0 offen
  s_mov_b64 exec, -1
  v_mov_b32 v70, v71
  v_mov_b32 v71, v72
  v_mov_b32 v72, v73
  v_mov_b32_e64 v73, v74
  v_mov_b32 v74, 0xffffff
  s_waitcnt vmcnt(11)
  s_barrier
  s_add_u32 m0, s75, 147456
  s_nop 0
  buffer_load_dwordx4 v4, s[44:47], s74 offen lds
  s_add_u32 m0, s75, 148480
  s_nop 0
  buffer_load_dwordx4 v5, s[44:47], s74 offen lds
  s_add_u32 s74, s74, 106496
  s_add_u32 m0, s75, 155648
  s_nop 0
  buffer_load_dwordx4 v4, s[44:47], s74 offen lds
  s_add_u32 m0, s75, 156672
  s_nop 0
  buffer_load_dwordx4 v5, s[44:47], s74 offen lds
  s_add_u32 s74, s74, 106496
  s_add_u32 m0, s76, 0
  s_nop 0
  buffer_load_dwordx4 v56, s[32:35], 0 offen lds
  s_add_u32 m0, s76, 2048
  v_add_u32_dpp v56, v19, v2 row_newbcast:1 row_mask:0xf bank_mask:0x3
  buffer_load_dwordx4 v57, s[32:35], 0 offen lds
  s_nop 0
  v_add_u32_dpp v56, v17, v2 row_newbcast:8 row_mask:0xf bank_mask:0xc
  s_add_u32 m0, s76, 4096
  v_add_u32_dpp v57, v23, v2 row_newbcast:1 row_mask:0xf bank_mask:0x3
  buffer_load_dwordx4 v58, s[32:35], 0 offen lds
  s_nop 0
  v_add_u32_dpp v57, v21, v2 row_newbcast:8 row_mask:0xf bank_mask:0xc
  s_add_u32 m0, s76, 6144
  v_add_u32_dpp v58, v27, v2 row_newbcast:1 row_mask:0xf bank_mask:0x3
  buffer_load_dwordx4 v59, s[32:35], 0 offen lds
  s_nop 0
  v_add_u32_dpp v58, v25, v2 row_newbcast:8 row_mask:0xf bank_mask:0xc
  s_add_u32 m0, s76, 8192
  v_add_u32_dpp v59, v31, v2 row_newbcast:1 row_mask:0xf bank_mask:0x3
  buffer_load_dwordx4 v60, s[32:35], 0 offen lds
  s_nop 0
  v_add_u32_dpp v59, v29, v2 row_newbcast:8 row_mask:0xf bank_mask:0xc
  s_add_u32 m0, s76, 10240
  v_add_u32_dpp v60, v35, v2 row_newbcast:1 row_mask:0xf bank_mask:0x3
  buffer_load_dwordx4 v61, s[32:35], 0 offen lds
  s_nop 0
  v_add_u32_dpp v60, v33, v2 row_newbcast:8 row_mask:0xf bank_mask:0xc
  s_add_u32 m0, s76, 12288
  v_add_u32_dpp v61, v39, v2 row_newbcast:1 row_mask:0xf bank_mask:0x3
  buffer_load_dwordx4 v62, s[32:35], 0 offen lds
  s_nop 0
  v_add_u32_dpp v61, v37, v2 row_newbcast:8 row_mask:0xf bank_mask:0xc
  s_add_u32 m0, s76, 14336
  v_add_u32_dpp v62, v43, v2 row_newbcast:1 row_mask:0xf bank_mask:0x3
  buffer_load_dwordx4 v63, s[32:35], 0 offen lds
  s_nop 0
  v_add_u32_dpp v62, v41, v2 row_newbcast:8 row_mask:0xf bank_mask:0xc
  s_add_u32 m0, s76, 16384
  v_add_u32_dpp v63, v47, v2 row_newbcast:1 row_mask:0xf bank_mask:0x3
  buffer_load_dwordx4 v64, s[32:35], 0 offen lds
  s_nop 0
  v_add_u32_dpp v63, v45, v2 row_newbcast:8 row_mask:0xf bank_mask:0xc
  s_add_u32 m0, s76, 18432
  v_add_u32_dpp v64, v51, v2 row_newbcast:1 row_mask:0xf bank_mask:0x3
  buffer_load_dwordx4 v65, s[32:35], 0 offen lds
  s_nop 0
  v_add_u32_dpp v64, v49, v2 row_newbcast:8 row_mask:0xf bank_mask:0xc
  v_add_u32_dpp v65, v55, v2 row_newbcast:1 row_mask:0xf bank_mask:0x3
  s_nop 1
  v_add_u32_dpp v65, v53, v2 row_newbcast:8 row_mask:0xf bank_mask:0xc
  s_waitcnt vmcnt(10)
  s_barrier
  s_add_u32 m0, s75, 131072
  s_nop 0
  buffer_load_dwordx4 v4, s[44:47], s74 offen lds
  s_add_u32 m0, s75, 132096
  s_nop 0
  buffer_load_dwordx4 v5, s[44:47], s74 offen lds
  s_add_u32 s74, s74, 106496
  s_add_u32 m0, s75, 139264
  s_nop 0
  buffer_load_dwordx4 v4, s[44:47], s74 offen lds
  s_add_u32 m0, s75, 140288
  s_nop 0
  buffer_load_dwordx4 v5, s[44:47], s74 offen lds
  s_add_u32 s74, s74, 106496
  s_add_u32 m0, s76, 40960
  s_nop 0
  buffer_load_dwordx4 v56, s[32:35], 0 offen lds
  s_add_u32 m0, s76, 43008
  v_add_u32_dpp v56, v16, v2 row_newbcast:2 row_mask:0xf bank_mask:0x3
  buffer_load_dwordx4 v57, s[32:35], 0 offen lds
  s_nop 0
  v_add_u32_dpp v56, v18, v2 row_newbcast:8 row_mask:0xf bank_mask:0xc
  s_add_u32 m0, s76, 45056
  v_add_u32_dpp v57, v20, v2 row_newbcast:2 row_mask:0xf bank_mask:0x3
  buffer_load_dwordx4 v58, s[32:35], 0 offen lds
  s_nop 0
  v_add_u32_dpp v57, v22, v2 row_newbcast:8 row_mask:0xf bank_mask:0xc
  s_add_u32 m0, s76, 47104
  v_add_u32_dpp v58, v24, v2 row_newbcast:2 row_mask:0xf bank_mask:0x3
  buffer_load_dwordx4 v59, s[32:35], 0 offen lds
  s_nop 0
  v_add_u32_dpp v58, v26, v2 row_newbcast:8 row_mask:0xf bank_mask:0xc
  s_add_u32 m0, s76, 49152
  v_add_u32_dpp v59, v28, v2 row_newbcast:2 row_mask:0xf bank_mask:0x3
  buffer_load_dwordx4 v60, s[32:35], 0 offen lds
  s_nop 0
  v_add_u32_dpp v59, v30, v2 row_newbcast:8 row_mask:0xf bank_mask:0xc
  s_add_u32 m0, s76, 51200
  v_add_u32_dpp v60, v32, v2 row_newbcast:2 row_mask:0xf bank_mask:0x3
  buffer_load_dwordx4 v61, s[32:35], 0 offen lds
  s_nop 0
  v_add_u32_dpp v60, v34, v2 row_newbcast:8 row_mask:0xf bank_mask:0xc
  s_add_u32 m0, s76, 53248
  v_add_u32_dpp v61, v36, v2 row_newbcast:2 row_mask:0xf bank_mask:0x3
  buffer_load_dwordx4 v62, s[32:35], 0 offen lds
  s_nop 0
  v_add_u32_dpp v61, v38, v2 row_newbcast:8 row_mask:0xf bank_mask:0xc
  s_add_u32 m0, s76, 55296
  v_add_u32_dpp v62, v40, v2 row_newbcast:2 row_mask:0xf bank_mask:0x3
  buffer_load_dwordx4 v63, s[32:35], 0 offen lds
  s_nop 0
  v_add_u32_dpp v62, v42, v2 row_newbcast:8 row_mask:0xf bank_mask:0xc
  s_add_u32 m0, s76, 57344
  v_add_u32_dpp v63, v44, v2 row_newbcast:2 row_mask:0xf bank_mask:0x3
  buffer_load_dwordx4 v64, s[32:35], 0 offen lds
  s_nop 0
  v_add_u32_dpp v63, v46, v2 row_newbcast:8 row_mask:0xf bank_mask:0xc
  s_add_u32 m0, s76, 59392
  v_add_u32_dpp v64, v48, v2 row_newbcast:2 row_mask:0xf bank_mask:0x3
  buffer_load_dwordx4 v65, s[32:35], 0 offen lds
  s_nop 0
  v_add_u32_dpp v64, v50, v2 row_newbcast:8 row_mask:0xf bank_mask:0xc
  v_add_u32_dpp v65, v52, v2 row_newbcast:2 row_mask:0xf bank_mask:0x3
  s_nop 1
  v_add_u32_dpp v65, v54, v2 row_newbcast:8 row_mask:0xf bank_mask:0xc
  s_mov_b64 exec, 0x3ff
  buffer_load_dword v103, v84, s[44:47], s85 offen
  s_mov_b64 exec, -1
  s_add_u32 s85, s85, 865280
  s_waitcnt vmcnt(11)
  s_barrier
  s_add_u32 m0, s75, 147456
  s_nop 0
  buffer_load_dwordx4 v4, s[44:47], s74 offen lds
  s_add_u32 m0, s75, 148480
  s_nop 0
  buffer_load_dwordx4 v5, s[44:47], s74 offen lds
  s_add_u32 s74, s74, 106496
  s_add_u32 m0, s75, 155648
  s_nop 0
  buffer_load_dwordx4 v4, s[44:47], s74 offen lds
  s_add_u32 m0, s75, 156672
  s_nop 0
  buffer_load_dwordx4 v5, s[44:47], s74 offen lds
  s_add_u32 s74, s74, 106496
  s_add_u32 m0, s76, 81920
  s_nop 0
  buffer_load_dwordx4 v56, s[32:35], 0 offen lds
  s_add_u32 m0, s76, 83968
  v_add_u32_dpp v56, v17, v2 row_newbcast:2 row_mask:0xf bank_mask:0x3
  buffer_load_dwordx4 v57, s[32:35], 0 offen lds
  s_nop 0
  v_add_u32_dpp v56, v19, v2 row_newbcast:8 row_mask:0xf bank_mask:0xc
  s_add_u32 m0, s76, 86016
  v_add_u32_dpp v57, v21, v2 row_newbcast:2 row_mask:0xf bank_mask:0x3
  buffer_load_dwordx4 v58, s[32:35], 0 offen lds
  s_nop 0
  v_add_u32_dpp v57, v23, v2 row_newbcast:8 row_mask:0xf bank_mask:0xc
  s_add_u32 m0, s76, 88064
  v_add_u32_dpp v58, v25, v2 row_newbcast:2 row_mask:0xf bank_mask:0x3
  buffer_load_dwordx4 v59, s[32:35], 0 offen lds
  s_nop 0
  v_add_u32_dpp v58, v27, v2 row_newbcast:8 row_mask:0xf bank_mask:0xc
  s_add_u32 m0, s76, 90112
  v_add_u32_dpp v59, v29, v2 row_newbcast:2 row_mask:0xf bank_mask:0x3
  buffer_load_dwordx4 v60, s[32:35], 0 offen lds
  s_nop 0
  v_add_u32_dpp v59, v31, v2 row_newbcast:8 row_mask:0xf bank_mask:0xc
  s_add_u32 m0, s76, 92160
  v_add_u32_dpp v60, v33, v2 row_newbcast:2 row_mask:0xf bank_mask:0x3
  buffer_load_dwordx4 v61, s[32:35], 0 offen lds
  s_nop 0
  v_add_u32_dpp v60, v35, v2 row_newbcast:8 row_mask:0xf bank_mask:0xc
  s_add_u32 m0, s76, 94208
  v_add_u32_dpp v61, v37, v2 row_newbcast:2 row_mask:0xf bank_mask:0x3
  buffer_load_dwordx4 v62, s[32:35], 0 offen lds
  s_nop 0
  v_add_u32_dpp v61, v39, v2 row_newbcast:8 row_mask:0xf bank_mask:0xc
  s_add_u32 m0, s76, 96256
  v_add_u32_dpp v62, v41, v2 row_newbcast:2 row_mask:0xf bank_mask:0x3
  buffer_load_dwordx4 v63, s[32:35], 0 offen lds
  s_nop 0
  v_add_u32_dpp v62, v43, v2 row_newbcast:8 row_mask:0xf bank_mask:0xc
  s_add_u32 m0, s76, 98304
  v_add_u32_dpp v63, v45, v2 row_newbcast:2 row_mask:0xf bank_mask:0x3
  buffer_load_dwordx4 v64, s[32:35], 0 offen lds
  s_nop 0
  v_add_u32_dpp v63, v47, v2 row_newbcast:8 row_mask:0xf bank_mask:0xc
  s_add_u32 m0, s76, 100352
  v_add_u32_dpp v64, v49, v2 row_newbcast:2 row_mask:0xf bank_mask:0x3
  buffer_load_dwordx4 v65, s[32:35], 0 offen lds
  s_nop 0
  v_add_u32_dpp v64, v51, v2 row_newbcast:8 row_mask:0xf bank_mask:0xc
  v_add_u32_dpp v65, v53, v2 row_newbcast:2 row_mask:0xf bank_mask:0x3
  s_nop 1
  v_add_u32_dpp v65, v55, v2 row_newbcast:8 row_mask:0xf bank_mask:0xc
  s_waitcnt vmcnt(10)
  s_barrier
  s_add_u32 m0, s75, 131072
  s_nop 0
  buffer_load_dwordx4 v4, s[44:47], s74 offen lds
  s_add_u32 m0, s75, 132096
  s_nop 0
  buffer_load_dwordx4 v5, s[44:47], s74 offen lds
  s_add_u32 s74, s74, 106496
  s_add_u32 m0, s75, 139264
  s_nop 0
  buffer_load_dwordx4 v4, s[44:47], s74 offen lds
  s_add_u32 m0, s75, 140288
  s_nop 0
  buffer_load_dwordx4 v5, s[44:47], s74 offen lds
  s_add_u32 s74, s74, 106496
  s_add_u32 m0, s76, 0
  s_nop 0
  buffer_load_dwordx4 v56, s[32:35], 0 offen lds
  s_add_u32 m0, s76, 2048
  v_add_u32_dpp v56, v18, v2 row_newbcast:2 row_mask:0xf bank_mask:0x3
  buffer_load_dwordx4 v57, s[32:35], 0 offen lds
  s_nop 0
  v_add_u32_dpp v56, v16, v2 row_newbcast:9 row_mask:0xf bank_mask:0xc
  s_add_u32 m0, s76, 4096
  v_add_u32_dpp v57, v22, v2 row_newbcast:2 row_mask:0xf bank_mask:0x3
  buffer_load_dwordx4 v58, s[32:35], 0 offen lds
  s_nop 0
  v_add_u32_dpp v57, v20, v2 row_newbcast:9 row_mask:0xf bank_mask:0xc
  s_add_u32 m0, s76, 6144
  v_add_u32_dpp v58, v26, v2 row_newbcast:2 row_mask:0xf bank_mask:0x3
  buffer_load_dwordx4 v59, s[32:35], 0 offen lds
  s_nop 0
  v_add_u32_dpp v58, v24, v2 row_newbcast:9 row_mask:0xf bank_mask:0xc
  s_add_u32 m0, s76, 8192
  v_add_u32_dpp v59, v30, v2 row_newbcast:2 row_mask:0xf bank_mask:0x3
  buffer_load_dwordx4 v60, s[32:35], 0 offen lds
  s_nop 0
  v_add_u32_dpp v59, v28, v2 row_newbcast:9 row_mask:0xf bank_mask:0xc
  s_add_u32 m0, s76, 10240
  v_add_u32_dpp v60, v34, v2 row_newbcast:2 row_mask:0xf bank_mask:0x3
  buffer_load_dwordx4 v61, s[32:35], 0 offen lds
  s_nop 0
  v_add_u32_dpp v60, v32, v2 row_newbcast:9 row_mask:0xf bank_mask:0xc
  s_add_u32 m0, s76, 12288
  v_add_u32_dpp v61, v38, v2 row_newbcast:2 row_mask:0xf bank_mask:0x3
  buffer_load_dwordx4 v62, s[32:35], 0 offen lds
  s_nop 0
  v_add_u32_dpp v61, v36, v2 row_newbcast:9 row_mask:0xf bank_mask:0xc
  s_add_u32 m0, s76, 14336
  v_add_u32_dpp v62, v42, v2 row_newbcast:2 row_mask:0xf bank_mask:0x3
  buffer_load_dwordx4 v63, s[32:35], 0 offen lds
  s_nop 0
  v_add_u32_dpp v62, v40, v2 row_newbcast:9 row_mask:0xf bank_mask:0xc
  s_add_u32 m0, s76, 16384
  v_add_u32_dpp v63, v46, v2 row_newbcast:2 row_mask:0xf bank_mask:0x3
  buffer_load_dwordx4 v64, s[32:35], 0 offen lds
  s_nop 0
  v_add_u32_dpp v63, v44, v2 row_newbcast:9 row_mask:0xf bank_mask:0xc
  s_add_u32 m0, s76, 18432
  v_add_u32_dpp v64, v50, v2 row_newbcast:2 row_mask:0xf bank_mask:0x3
  buffer_load_dwordx4 v65, s[32:35], 0 offen lds
  s_nop 0
  v_add_u32_dpp v64, v48, v2 row_newbcast:9 row_mask:0xf bank_mask:0xc
  v_add_u32_dpp v65, v54, v2 row_newbcast:2 row_mask:0xf bank_mask:0x3
  s_nop 1
  v_add_u32_dpp v65, v52, v2 row_newbcast:9 row_mask:0xf bank_mask:0xc
  v_lshlrev_b32 v101, 7, v70
  s_mov_b32 exec_lo, 0xffffffff
  s_mov_b32 exec_hi, 0x0
  buffer_load_dword v102, v101, s[32:35], 0 offen
  s_mov_b64 exec, -1
  v_mov_b32 v70, v71
  v_mov_b32 v71, v72
  v_mov_b32 v72, v73
  v_mov_b32 v73, v74
  v_mov_b32 v74, 0xffffff
  s_waitcnt vmcnt(11)
  s_barrier
  s_add_u32 m0, s75, 147456
  s_nop 0
  buffer_load_dwordx4 v4, s[44:47], s74 offen lds
  s_add_u32 m0, s75, 148480
  s_nop 0
  buffer_load_dwordx4 v5, s[44:47], s74 offen lds
  s_add_u32 s74, s74, 106496
  s_add_u32 m0, s75, 155648
  s_nop 0
  buffer_load_dwordx4 v4, s[44:47], s74 offen lds
  s_add_u32 m0, s75, 156672
  s_nop 0
  buffer_load_dwordx4 v5, s[44:47], s74 offen lds
  s_add_u32 s74, s74, 106496
  s_add_u32 m0, s76, 40960
  s_nop 0
  buffer_load_dwordx4 v56, s[32:35], 0 offen lds
  s_add_u32 m0, s76, 43008
  v_add_u32_dpp v56, v19, v2 row_newbcast:2 row_mask:0xf bank_mask:0x3
  buffer_load_dwordx4 v57, s[32:35], 0 offen lds
  s_nop 0
  v_add_u32_dpp v56, v17, v2 row_newbcast:9 row_mask:0xf bank_mask:0xc
  s_add_u32 m0, s76, 45056
  v_add_u32_dpp v57, v23, v2 row_newbcast:2 row_mask:0xf bank_mask:0x3
  buffer_load_dwordx4 v58, s[32:35], 0 offen lds
  s_nop 0
  v_add_u32_dpp v57, v21, v2 row_newbcast:9 row_mask:0xf bank_mask:0xc
  s_add_u32 m0, s76, 47104
  v_add_u32_dpp v58, v27, v2 row_newbcast:2 row_mask:0xf bank_mask:0x3
  buffer_load_dwordx4 v59, s[32:35], 0 offen lds
  s_nop 0
  v_add_u32_dpp v58, v25, v2 row_newbcast:9 row_mask:0xf bank_mask:0xc
  s_add_u32 m0, s76, 49152
  v_add_u32_dpp v59, v31, v2 row_newbcast:2 row_mask:0xf bank_mask:0x3
  buffer_load_dwordx4 v60, s[32:35], 0 offen lds
  s_nop 0
  v_add_u32_dpp v59, v29, v2 row_newbcast:9 row_mask:0xf bank_mask:0xc
  s_add_u32 m0, s76, 51200
  v_add_u32_dpp v60, v35, v2 row_newbcast:2 row_mask:0xf bank_mask:0x3
  buffer_load_dwordx4 v61, s[32:35], 0 offen lds
  s_nop 0
  v_add_u32_dpp v60, v33, v2 row_newbcast:9 row_mask:0xf bank_mask:0xc
  s_add_u32 m0, s76, 53248
  v_add_u32_dpp v61, v39, v2 row_newbcast:2 row_mask:0xf bank_mask:0x3
  buffer_load_dwordx4 v62, s[32:35], 0 offen lds
  s_nop 0
  v_add_u32_dpp v61, v37, v2 row_newbcast:9 row_mask:0xf bank_mask:0xc
  s_add_u32 m0, s76, 55296
  v_add_u32_dpp v62, v43, v2 row_newbcast:2 row_mask:0xf bank_mask:0x3
  buffer_load_dwordx4 v63, s[32:35], 0 offen lds
  s_nop 0
  v_add_u32_dpp v62, v41, v2 row_newbcast:9 row_mask:0xf bank_mask:0xc
  s_add_u32 m0, s76, 57344
  v_add_u32_dpp v63, v47, v2 row_newbcast:2 row_mask:0xf bank_mask:0x3
  buffer_load_dwordx4 v64, s[32:35], 0 offen lds
  s_nop 0
  v_add_u32_dpp v63, v45, v2 row_newbcast:9 row_mask:0xf bank_mask:0xc
  s_add_u32 m0, s76, 59392
  v_add_u32_dpp v64, v51, v2 row_newbcast:2 row_mask:0xf bank_mask:0x3
  buffer_load_dwordx4 v65, s[32:35], 0 offen lds
  s_nop 0
  v_add_u32_dpp v64, v49, v2 row_newbcast:9 row_mask:0xf bank_mask:0xc
  v_add_u32_dpp v65, v55, v2 row_newbcast:2 row_mask:0xf bank_mask:0x3
  s_nop 1
  v_add_u32_dpp v65, v53, v2 row_newbcast:9 row_mask:0xf bank_mask:0xc
  s_waitcnt vmcnt(10)
  s_cmp_lg_u32 s72, 1
  s_cbranch_scc1 L_nolpf
  s_mov_b64 exec, 1048575
  global_load_dword v10, v[8:9], off
  s_mov_b64 exec, -1
  s_mov_b32 m0, 123136
  s_mov_b64 exec, 0xffff
  buffer_load_dwordx4 v11, s[52:55], s77 offen lds
  s_mov_b64 exec, -1
L_nolpf:
  s_barrier
  s_add_u32 m0, s75, 131072
  s_nop 0
  buffer_load_dwordx4 v4, s[44:47], s74 offen lds
  s_add_u32 m0, s75, 132096
  s_nop 0
  buffer_load_dwordx4 v5, s[44:47], s74 offen lds
  s_add_u32 s74, s74, 106496
  s_add_u32 m0, s75, 139264
  s_nop 0
  buffer_load_dwordx4 v4, s[44:47], s74 offen lds
  s_add_u32 m0, s75, 140288
  s_nop 0
  buffer_load_dwordx4 v5, s[44:47], s74 offen lds
  s_add_u32 s74, s74, 106496
  s_add_u32 m0, s76, 81920
  s_nop 0
  buffer_load_dwordx4 v56, s[32:35], 0 offen lds
  s_add_u32 m0, s76, 83968
  v_add_u32_dpp v56, v16, v2 row_newbcast:3 row_mask:0xf bank_mask:0x3
  buffer_load_dwordx4 v57, s[32:35], 0 offen lds
  s_nop 0
  v_add_u32_dpp v56, v18, v2 row_newbcast:9 row_mask:0xf bank_mask:0xc
  s_add_u32 m0, s76, 86016
  v_add_u32_dpp v57, v20, v2 row_newbcast:3 row_mask:0xf bank_mask:0x3
  buffer_load_dwordx4 v58, s[32:35], 0 offen lds
  s_nop 0
  v_add_u32_dpp v57, v22, v2 row_newbcast:9 row_mask:0xf bank_mask:0xc
  s_add_u32 m0, s76, 88064
  v_add_u32_dpp v58, v24, v2 row_newbcast:3 row_mask:0xf bank_mask:0x3
  buffer_load_dwordx4 v59, s[32:35], 0 offen lds
  s_nop 0
  v_add_u32_dpp v58, v26, v2 row_newbcast:9 row_mask:0xf bank_mask:0xc
  s_add_u32 m0, s76, 90112
  v_add_u32_dpp v59, v28, v2 row_newbcast:3 row_mask:0xf bank_mask:0x3
  buffer_load_dwordx4 v60, s[32:35], 0 offen lds
  s_nop 0
  v_add_u32_dpp v59, v30, v2 row_newbcast:9 row_mask:0xf bank_mask:0xc
  s_add_u32 m0, s76, 92160
  v_add_u32_dpp v60, v32, v2 row_newbcast:3 row_mask:0xf bank_mask:0x3
  buffer_load_dwordx4 v61, s[32:35], 0 offen lds
  s_nop 0
  v_add_u32_dpp v60, v34, v2 row_newbcast:9 row_mask:0xf bank_mask:0xc
  s_add_u32 m0, s76, 94208
  v_add_u32_dpp v61, v36, v2 row_newbcast:3 row_mask:0xf bank_mask:0x3
  buffer_load_dwordx4 v62, s[32:35], 0 offen lds
  s_nop 0
  v_add_u32_dpp v61, v38, v2 row_newbcast:9 row_mask:0xf bank_mask:0xc
  s_add_u32 m0, s76, 96256
  v_add_u32_dpp v62, v40, v2 row_newbcast:3 row_mask:0xf bank_mask:0x3
  buffer_load_dwordx4 v63, s[32:35], 0 offen lds
  s_nop 0
  v_add_u32_dpp v62, v42, v2 row_newbcast:9 row_mask:0xf bank_mask:0xc
  s_add_u32 m0, s76, 98304
  v_add_u32_dpp v63, v44, v2 row_newbcast:3 row_mask:0xf bank_mask:0x3
  buffer_load_dwordx4 v64, s[32:35], 0 offen lds
  s_nop 0
  v_add_u32_dpp v63, v46, v2 row_newbcast:9 row_mask:0xf bank_mask:0xc
  s_add_u32 m0, s76, 100352
  v_add_u32_dpp v64, v48, v2 row_newbcast:3 row_mask:0xf bank_mask:0x3
  buffer_load_dwordx4 v65, s[32:35], 0 offen lds
  s_nop 0
  v_add_u32_dpp v64, v50, v2 row_newbcast:9 row_mask:0xf bank_mask:0xc
  v_add_u32_dpp v65, v52, v2 row_newbcast:3 row_mask:0xf bank_mask:0x3
  s_nop 1
  v_add_u32_dpp v65, v54, v2 row_newbcast:9 row_mask:0xf bank_mask:0xc
  s_mov_b64 exec, 0x3ff
  buffer_load_dword v103, v84, s[44:47], s85 offen
  s_mov_b64 exec, -1
  s_add_u32 s85, s85, 865280
  s_waitcnt vmcnt(11)
  s_barrier
  s_add_u32 m0, s75, 147456
  s_nop 0
  buffer_load_dwordx4 v4, s[44:47], s74 offen lds
  s_add_u32 m0, s75, 148480
  s_nop 0
  buffer_load_dwordx4 v5, s[44:47], s74 offen lds
  s_add_u32 s74, s74, 106496
  s_add_u32 m0, s75, 155648
  s_nop 0
  buffer_load_dwordx4 v4, s[44:47], s74 offen lds
  s_add_u32 m0, s75, 156672
  s_nop 0
  buffer_load_dwordx4 v5, s[44:47], s74 offen lds
  s_add_u32 s74, s74, 106496
  s_add_u32 m0, s76, 0
  s_nop 0
  buffer_load_dwordx4 v56, s[32:35], 0 offen lds
  s_add_u32 m0, s76, 2048
  v_add_u32_dpp v56, v17, v2 row_newbcast:3 row_mask:0xf bank_mask:0x3
  buffer_load_dwordx4 v57, s[32:35], 0 offen lds
  s_nop 0
  v_add_u32_dpp v56, v19, v2 row_newbcast:9 row_mask:0xf bank_mask:0xc
  s_add_u32 m0, s76, 4096
  v_add_u32_dpp v57, v21, v2 row_newbcast:3 row_mask:0xf bank_mask:0x3
  buffer_load_dwordx4 v58, s[32:35], 0 offen lds
  s_nop 0
  v_add_u32_dpp v57, v23, v2 row_newbcast:9 row_mask:0xf bank_mask:0xc
  s_add_u32 m0, s76, 6144
  v_add_u32_dpp v58, v25, v2 row_newbcast:3 row_mask:0xf bank_mask:0x3
  buffer_load_dwordx4 v59, s[32:35], 0 offen lds
  s_nop 0
  v_add_u32_dpp v58, v27, v2 row_newbcast:9 row_mask:0xf bank_mask:0xc
  s_add_u32 m0, s76, 8192
  v_add_u32_dpp v59, v29, v2 row_newbcast:3 row_mask:0xf bank_mask:0x3
  buffer_load_dwordx4 v60, s[32:35], 0 offen lds
  s_nop 0
  v_add_u32_dpp v59, v31, v2 row_newbcast:9 row_mask:0xf bank_mask:0xc
  s_add_u32 m0, s76, 10240
  v_add_u32_dpp v60, v33, v2 row_newbcast:3 row_mask:0xf bank_mask:0x3
  buffer_load_dwordx4 v61, s[32:35], 0 offen lds
  s_nop 0
  v_add_u32_dpp v60, v35, v2 row_newbcast:9 row_mask:0xf bank_mask:0xc
  s_add_u32 m0, s76, 12288
  v_add_u32_dpp v61, v37, v2 row_newbcast:3 row_mask:0xf bank_mask:0x3
  buffer_load_dwordx4 v62, s[32:35], 0 offen lds
  s_nop 0
  v_add_u32_dpp v61, v39, v2 row_newbcast:9 row_mask:0xf bank_mask:0xc
  s_add_u32 m0, s76, 14336
  v_add_u32_dpp v62, v41, v2 row_newbcast:3 row_mask:0xf bank_mask:0x3
  buffer_load_dwordx4 v63, s[32:35], 0 offen lds
  s_nop 0
  v_add_u32_dpp v62, v43, v2 row_newbcast:9 row_mask:0xf bank_mask:0xc
  s_add_u32 m0, s76, 16384
  v_add_u32_dpp v63, v45, v2 row_newbcast:3 row_mask:0xf bank_mask:0x3
  buffer_load_dwordx4 v64, s[32:35], 0 offen lds
  s_nop 0
  v_add_u32_dpp v63, v47, v2 row_newbcast:9 row_mask:0xf bank_mask:0xc
  s_add_u32 m0, s76, 18432
  v_add_u32_dpp v64, v49, v2 row_newbcast:3 row_mask:0xf bank_mask:0x3
  buffer_load_dwordx4 v65, s[32:35], 0 offen lds
  s_nop 0
  v_add_u32_dpp v64, v51, v2 row_newbcast:9 row_mask:0xf bank_mask:0xc
  v_add_u32_dpp v65, v53, v2 row_newbcast:3 row_mask:0xf bank_mask:0x3
  s_nop 1
  v_add_u32_dpp v65, v55, v2 row_newbcast:9 row_mask:0xf bank_mask:0xc
  s_waitcnt vmcnt(10)
  s_barrier
  s_add_u32 m0, s75, 131072
  s_nop 0
  buffer_load_dwordx4 v4, s[44:47], s74 offen lds
  s_add_u32 m0, s75, 132096
  s_nop 0
  buffer_load_dwordx4 v5, s[44:47], s74 offen lds
  s_add_u32 s74, s74, 106496
  s_add_u32 m0, s75, 139264
  s_nop 0
  buffer_load_dwordx4 v4, s[44:47], s74 offen lds
  s_add_u32 m0, s75, 140288
  s_nop 0
  buffer_load_dwordx4 v5, s[44:47], s74 offen lds
  s_add_u32 s74, s74, 106496
  s_add_u32 m0, s76, 40960
  s_nop 0
  buffer_load_dwordx4 v56, s[32:35], 0 offen lds
  s_add_u32 m0, s76, 43008
  v_add_u32_dpp v56, v18, v2 row_newbcast:3 row_mask:0xf bank_mask:0x3
  buffer_load_dwordx4 v57, s[32:35], 0 offen lds
  s_nop 0
  v_add_u32_dpp v56, v16, v2 row_newbcast:10 row_mask:0xf bank_mask:0xc
  s_add_u32 m0, s76, 45056
  v_add_u32_dpp v57, v22, v2 row_newbcast:3 row_mask:0xf bank_mask:0x3
  buffer_load_dwordx4 v58, s[32:35], 0 offen lds
  s_nop 0
  v_add_u32_dpp v57, v20, v2 row_newbcast:10 row_mask:0xf bank_mask:0xc
  s_add_u32 m0, s76, 47104
  v_add_u32_dpp v58, v26, v2 row_newbcast:3 row_mask:0xf bank_mask:0x3
  buffer_load_dwordx4 v59, s[32:35], 0 offen lds
  s_nop 0
  v_add_u32_dpp v58, v24, v2 row_newbcast:10 row_mask:0xf bank_mask:0xc
  s_add_u32 m0, s76, 49152
  v_add_u32_dpp v59, v30, v2 row_newbcast:3 row_mask:0xf bank_mask:0x3
  buffer_load_dwordx4 v60, s[32:35], 0 offen lds
  s_nop 0
  v_add_u32_dpp v59, v28, v2 row_newbcast:10 row_mask:0xf bank_mask:0xc
  s_add_u32 m0, s76, 51200
  v_add_u32_dpp v60, v34, v2 row_newbcast:3 row_mask:0xf bank_mask:0x3
  buffer_load_dwordx4 v61, s[32:35], 0 offen lds
  s_nop 0
  v_add_u32_dpp v60, v32, v2 row_newbcast:10 row_mask:0xf bank_mask:0xc
  s_add_u32 m0, s76, 53248
  v_add_u32_dpp v61, v38, v2 row_newbcast:3 row_mask:0xf bank_mask:0x3
  buffer_load_dwordx4 v62, s[32:35], 0 offen lds
  s_nop 0
  v_add_u32_dpp v61, v36, v2 row_newbcast:10 row_mask:0xf bank_mask:0xc
  s_add_u32 m0, s76, 55296
  v_add_u32_dpp v62, v42, v2 row_newbcast:3 row_mask:0xf bank_mask:0x3
  buffer_load_dwordx4 v63, s[32:35], 0 offen lds
  s_nop 0
  v_add_u32_dpp v62, v40, v2 row_newbcast:10 row_mask:0xf bank_mask:0xc
  s_add_u32 m0, s76, 57344
  v_add_u32_dpp v63, v46, v2 row_newbcast:3 row_mask:0xf bank_mask:0x3
  buffer_load_dwordx4 v64, s[32:35], 0 offen lds
  s_nop 0
  v_add_u32_dpp v63, v44, v2 row_newbcast:10 row_mask:0xf bank_mask:0xc
  s_add_u32 m0, s76, 59392
  v_add_u32_dpp v64, v50, v2 row_newbcast:3 row_mask:0xf bank_mask:0x3
  buffer_load_dwordx4 v65, s[32:35], 0 offen lds
  s_nop 0
  v_add_u32_dpp v64, v48, v2 row_newbcast:10 row_mask:0xf bank_mask:0xc
  v_add_u32_dpp v65, v54, v2 row_newbcast:3 row_mask:0xf bank_mask:0x3
  s_nop 1
  v_add_u32_dpp v65, v52, v2 row_newbcast:10 row_mask:0xf bank_mask:0xc
  v_mov_b32_dpp v16, v16 row_shl:3 row_mask:0xf bank_mask:0xf
  v_mov_b32_dpp v18, v18 row_shl:3 row_mask:0xf bank_mask:0xf
  v_mov_b32_dpp v20, v20 row_shl:3 row_mask:0xf bank_mask:0xf
  v_mov_b32_dpp v22, v22 row_shl:3 row_mask:0xf bank_mask:0xf
  v_mov_b32_dpp v24, v24 row_shl:3 row_mask:0xf bank_mask:0xf
  v_mov_b32_dpp v26, v26 row_shl:3 row_mask:0xf bank_mask:0xf
  v_mov_b32_dpp v28, v28 row_shl:3 row_mask:0xf bank_mask:0xf
  v_mov_b32_dpp v30, v30 row_shl:3 row_mask:0xf bank_mask:0xf
  v_mov_b32_dpp v32, v32 row_shl:3 row_mask:0xf bank_mask:0xf
  v_mov_b32_dpp v34, v34 row_shl:3 row_mask:0xf bank_mask:0xf
  v_mov_b32_dpp v36, v36 row_shl:3 row_mask:0xf bank_mask:0xf
  v_mov_b32_dpp v38, v38 row_shl:3 row_mask:0xf bank_mask:0xf
  v_mov_b32_dpp v40, v40 row_shl:3 row_mask:0xf bank_mask:0xf
  v_mov_b32_dpp v42, v42 row_shl:3 row_mask:0xf bank_mask:0xf
  v_mov_b32_dpp v44, v44 row_shl:3 row_mask:0xf bank_mask:0xf
  v_mov_b32_dpp v46, v46 row_shl:3 row_mask:0xf bank_mask:0xf
  v_mov_b32_dpp v48, v48 row_shl:3 row_mask:0xf bank_mask:0xf
  v_mov_b32_dpp v50, v50 row_shl:3 row_mask:0xf bank_mask:0xf
  v_mov_b32_dpp v52, v52 row_shl:3 row_mask:0xf bank_mask:0xf
  v_mov_b32_dpp v54, v54 row_shl:3 row_mask:0xf bank_mask:0xf
  v_lshlrev_b32 v101, 7, v70
  s_mov_b32 exec_lo, 0xffffffff
  s_mov_b32 exec_hi, 0x0
  buffer_load_dword v102, v101, s[32:35], 0 offen
  s_mov_b64 exec, -1
  v_mov_b32 v70, v71
  v_mov_b32 v71, v72
  v_mov_b32 v72, v73
  v_mov_b32 v73, v74
  v_mov_b32 v74, 0xffffff
  s_waitcnt vmcnt(11)
  s_barrier
  s_add_u32 m0, s75, 147456
  s_nop 0
  buffer_load_dwordx4 v4, s[44:47], s74 offen lds
  s_add_u32 m0, s75, 148480
  s_nop 0
  buffer_load_dwordx4 v5, s[44:47], s74 offen lds
  s_add_u32 s74, s74, 106496
  s_add_u32 m0, s75, 155648
  s_nop 0
  buffer_load_dwordx4 v4, s[44:47], s74 offen lds
  s_add_u32 m0, s75, 156672
  s_nop 0
  buffer_load_dwordx4 v5, s[44:47], s74 offen lds
  s_add_u32 s74, s74, 106496
  s_cmp_eq_u32 s72, 1
  s_cbranch_scc1 L_ld_tail0
  s_add_u32 m0, s76, 81920
  s_nop 0
  buffer_load_dwordx4 v56, s[32:35], 0 offen lds
  s_add_u32 m0, s76, 83968
  v_add_u32_dpp v56, v19, v2 row_newbcast:3 row_mask:0xf bank_mask:0x3
  buffer_load_dwordx4 v57, s[32:35], 0 offen lds
  s_nop 0
  v_add_u32_dpp v56, v17, v2 row_newbcast:10 row_mask:0xf bank_mask:0xc
  s_add_u32 m0, s76, 86016
  v_add_u32_dpp v57, v23, v2 row_newbcast:3 row_mask:0xf bank_mask:0x3
  buffer_load_dwordx4 v58, s[32:35], 0 offen lds
  s_nop 0
  v_add_u32_dpp v57, v21, v2 row_newbcast:10 row_mask:0xf bank_mask:0xc
  s_add_u32 m0, s76, 88064
  v_add_u32_dpp v58, v27, v2 row_newbcast:3 row_mask:0xf bank_mask:0x3
  buffer_load_dwordx4 v59, s[32:35], 0 offen lds
  s_nop 0
  v_add_u32_dpp v58, v25, v2 row_newbcast:10 row_mask:0xf bank_mask:0xc
  s_add_u32 m0, s76, 90112
  v_add_u32_dpp v59, v31, v2 row_newbcast:3 row_mask:0xf bank_mask:0x3
  buffer_load_dwordx4 v60, s[32:35], 0 offen lds
  s_nop 0
  v_add_u32_dpp v59, v29, v2 row_newbcast:10 row_mask:0xf bank_mask:0xc
  s_add_u32 m0, s76, 92160
  v_add_u32_dpp v60, v35, v2 row_newbcast:3 row_mask:0xf bank_mask:0x3
  buffer_load_dwordx4 v61, s[32:35], 0 offen lds
  s_nop 0
  v_add_u32_dpp v60, v33, v2 row_newbcast:10 row_mask:0xf bank_mask:0xc
  s_add_u32 m0, s76, 94208
  v_add_u32_dpp v61, v39, v2 row_newbcast:3 row_mask:0xf bank_mask:0x3
  buffer_load_dwordx4 v62, s[32:35], 0 offen lds
  s_nop 0
  v_add_u32_dpp v61, v37, v2 row_newbcast:10 row_mask:0xf bank_mask:0xc
  s_add_u32 m0, s76, 96256
  v_add_u32_dpp v62, v43, v2 row_newbcast:3 row_mask:0xf bank_mask:0x3
  buffer_load_dwordx4 v63, s[32:35], 0 offen lds
  s_nop 0
  v_add_u32_dpp v62, v41, v2 row_newbcast:10 row_mask:0xf bank_mask:0xc
  s_add_u32 m0, s76, 98304
  v_add_u32_dpp v63, v47, v2 row_newbcast:3 row_mask:0xf bank_mask:0x3
  buffer_load_dwordx4 v64, s[32:35], 0 offen lds
  s_nop 0
  v_add_u32_dpp v63, v45, v2 row_newbcast:10 row_mask:0xf bank_mask:0xc
  s_add_u32 m0, s76, 100352
  v_add_u32_dpp v64, v51, v2 row_newbcast:3 row_mask:0xf bank_mask:0x3
  buffer_load_dwordx4 v65, s[32:35], 0 offen lds
  s_nop 0
  v_add_u32_dpp v64, v49, v2 row_newbcast:10 row_mask:0xf bank_mask:0xc
  v_add_u32_dpp v65, v55, v2 row_newbcast:3 row_mask:0xf bank_mask:0x3
  s_nop 1
  v_add_u32_dpp v65, v53, v2 row_newbcast:10 row_mask:0xf bank_mask:0xc
  v_mov_b32_dpp v17, v17 row_shl:3 row_mask:0xf bank_mask:0xf
  v_mov_b32_dpp v19, v19 row_shl:3 row_mask:0xf bank_mask:0xf
  v_mov_b32_dpp v21, v21 row_shl:3 row_mask:0xf bank_mask:0xf
  v_mov_b32_dpp v23, v23 row_shl:3 row_mask:0xf bank_mask:0xf
  v_mov_b32_dpp v25, v25 row_shl:3 row_mask:0xf bank_mask:0xf
  v_mov_b32_dpp v27, v27 row_shl:3 row_mask:0xf bank_mask:0xf
  v_mov_b32_dpp v29, v29 row_shl:3 row_mask:0xf bank_mask:0xf
  v_mov_b32_dpp v31, v31 row_shl:3 row_mask:0xf bank_mask:0xf
  v_mov_b32_dpp v33, v33 row_shl:3 row_mask:0xf bank_mask:0xf
  v_mov_b32_dpp v35, v35 row_shl:3 row_mask:0xf bank_mask:0xf
  v_mov_b32_dpp v37, v37 row_shl:3 row_mask:0xf bank_mask:0xf
  v_mov_b32_dpp v39, v39 row_shl:3 row_mask:0xf bank_mask:0xf
  v_mov_b32_dpp v41, v41 row_shl:3 row_mask:0xf bank_mask:0xf
  v_mov_b32_dpp v43, v43 row_shl:3 row_mask:0xf bank_mask:0xf
  v_mov_b32_dpp v45, v45 row_shl:3 row_mask:0xf bank_mask:0xf
  v_mov_b32_dpp v47, v47 row_shl:3 row_mask:0xf bank_mask:0xf
  v_mov_b32_dpp v49, v49 row_shl:3 row_mask:0xf bank_mask:0xf
  v_mov_b32_dpp v51, v51 row_shl:3 row_mask:0xf bank_mask:0xf
  v_mov_b32_dpp v53, v53 row_shl:3 row_mask:0xf bank_mask:0xf
  v_mov_b32_dpp v55, v55 row_shl:3 row_mask:0xf bank_mask:0xf
  s_add_u32 s72, s72, 1
  s_cmp_lt_u32 s72, 2
  s_waitcnt vmcnt(10)
  s_cbranch_scc1 L_dnn_loop1
  s_branch L_ld_tail
L_cin:
  v_lshlrev_b32 v1, 4, v0
  s_and_b32 s79, s3, 3
  s_lshr_b32 s84, s3, 2
  s_lshl_b32 s95, s79, 10
  s_mul_i32 s26, s68, 11
  s_add_u32 s26, s26, s69
  s_sub_u32 s26, s26, 22
  s_cmp_eq_u32 s26, 86
  s_cbranch_scc1 L_spare
  s_cmp_eq_u32 s84, 0
  s_cbranch_scc1 L_sc
  s_setprio 2
  v_add_u32 v2, L_tables-L_pc+4096, v1
  v_mov_b32 v3, s93
  v_add_co_u32 v2, vcc, s92, v2
  s_nop 1
  v_addc_co_u32 v3, vcc, 0, v3, vcc
  v_add_co_u32 v32, vcc, s95, v2
  s_nop 1
  v_addc_co_u32 v33, vcc, 0, v3, vcc
  global_load_dwordx4 v[224:227], v[2:3], off offset:-4096
  v_add_co_u32 v2, vcc, 0x1800, v2
  s_nop 1
  v_addc_co_u32 v3, vcc, 0, v3, vcc
  global_load_dwordx4 v[240:243], v[2:3], off
  s_cmp_lt_u32 s79, 3
  s_mov_b32 s70, 122176
  s_cselect_b32 s70, 81920, s70
  s_add_u32 m0, s95, 81920
  s_nop 0
  global_load_lds_dwordx4 v[32:33], off offset:-4096
  s_add_u32 m0, s95, s70
  s_nop 0
  global_load_lds_dwordx4 v[32:33], off offset:0
  v_add_co_u32 v32, vcc, 0x2000, v32
  s_nop 1
  v_addc_co_u32 v33, vcc, 0, v33, vcc
  s_add_u32 m0, s95, 2048
  s_nop 0
  global_load_lds_dwordx4 v[32:33], off offset:0
  s_add_u32 m0, s95, 130368
  s_cmp_ge_u32 s79, 2
  s_cbranch_scc1 L_sc
  global_load_lds_dwordx4 v[32:33], off offset:-4096
L_sc:
  s_mul_i32 s85, s84, 20
  s_add_u32 s85, s85, s3
  s_mul_i32 s94, s26, 48
  s_add_u32 s94, s94, s85
  s_mul_i32 s94, s94, 104
  v_lshrrev_b32 v30, 3, v0
  v_lshlrev_b32 v30, 4, v30
  v_and_b32 v29, 0x70, v1
  s_mul_i32 s76, s3, 4064
  s_add_u32 s76, s76, 131136
  s_cmp_eq_u32 s84, 0
  s_cbranch_scc1 L_g0
  s_sub_u32 s68, s71, 22
  s_min_u32 s68, s68, 9
  s_lshl_b32 s68, s68, 2
  s_add_u32 s68, s68, s79
  s_lshl_b32 s68, s68, 7
  v_mul_u32_u24 v31, 5120, v0
  s_waitcnt lgkmcnt(0)
  s_mov_b32 s36, s8
  s_and_b32 s37, s9, 0xffff
  s_mov_b32 s38, 105456
  s_mov_b32 s39, 0x20000
  buffer_load_dword v107, v31, s[36:39], s68 offen
  s_waitcnt lgkmcnt(0)
  s_mov_b32 s40, s10
  s_and_b32 s41, s11, 0xffff
  s_mov_b32 s42, 156
  s_mov_b32 s43, 0x20000
  s_mov_b32 m0, 129472
  s_mov_b64 exec, 0x7ff
  buffer_load_dwordx4 v1, s[40:43], 0 offen lds
  s_mov_b64 exec, -1
  s_barrier
L_v3b:
  s_lshl_b32 s85, s85, 2
  s_add_u32 s85, s85, 129728
  s_mul_i32 s72, s84, 3
  s_sub_u32 s72, 4, s72
  s_cmp_eq_u32 s26, 85
  s_cselect_b32 s72, s72, 6
  s_lshl_b32 s52, s3, 7
  s_mul_i32 s53, s3, 5280
  s_lshl_b32 s54, s3, 2
  s_lshl_b32 s55, s3, 1
  s_lshl_b32 s82, s3, 12
  s_and_b32 s98, s3, 1
  s_lshr_b32 s99, s3, 1
  s_mul_i32 s68, s99, 3072
  s_lshl_b32 s83, s98, 3
  s_add_u32 s68, s68, s83
  v_add_u32 v59, s68, v1
  s_lshl_b32 s69, s99, 3
  s_lshr_b32 s69, 0x05030200, s69
  s_and_b32 s69, s69, 0xff
  s_lshl_b32 s69, s69, 9
  s_lshl_b32 s70, s98, 2
  s_add_u32 s91, s69, s70
  s_mov_b32 s99, 0x05040100
  s_mov_b32 s100, 0x07060302
  v_mov_b32 v2, 129664
  v_mov_b32 v109, 0
  v_mov_b32 v108, 0
  v_mov_b64 v[32:33], 0
  v_mov_b64 v[34:35], 0
  v_mov_b64 v[36:37], 0
  v_mov_b64 v[38:39], 0
  v_mov_b64 v[40:41], 0
  v_mov_b64 v[42:43], 0
  v_mov_b64 v[44:45], 0
  v_mov_b64 v[46:47], 0
  v_mov_b64 v[48:49], 0
  v_mov_b64 v[50:51], 0
  v_mov_b64 v[52:53], 0
  v_mov_b64 v[54:55], 0
  v_mov_b64 v[56:57], 0
  v_add_u32 v250, 77824, v1
  s_waitcnt vmcnt(7)
  v_add_u32 v251, 125248, v1
  v_lshrrev_b32 v3, 5, v0
  v_lshl_add_u32 v3, v3, 2, v2
  s_mov_b32 s28, s4
  s_and_b32 s29, s5, 0xffff
  s_mov_b32 s30, 425984
  s_mov_b32 s31, 0x20000
  s_mov_b32 s32, s6
  s_and_b32 s33, s7, 0xffff
  s_mov_b32 s34, 12800000
  s_mov_b32 s35, 0x20000
  v_and_b32 v13, 31, v0
  v_min_u32 v13, 25, v13
  v_lshrrev_b32 v14, 5, v0
  v_mul_u32_u24 v14, 416, v14
  v_lshl_add_u32 v13, v13, 2, v14
  buffer_load_dword v14, v13, s[28:31], s94 offen
  v_min_u32 v12, 47, v0
  v_mul_u32_u24 v15, 16384, v12
  v_lshrrev_b32 v15, 16, v15
  v_mul_u32_u24 v15, 88, v15
  v_lshl_add_u32 v12, v12, 2, v15
  s_lshl_b32 s68, s26, 2
  s_add_u32 s68, s68, s79
  s_mul_i32 s68, s68, 1248
  buffer_load_dword v15, v12, s[28:31], s68 offen offset:16
  ds_write_b128 v2, v[32:35] offset:16
  s_lshl_b32 s68, s79, 6
  v_add_u32_e64 v29, s68, v0
  v_mul_u32_u24 v30, 2521, v29
  v_lshrrev_b32 v30, 16, v30
  v_mul_u32_u24 v30, 12, v30
  v_lshl_add_u32 v28, v29, 1, v30
  v_add_u32 v29, 256, v29
  v_mul_u32_u24 v30, 2521, v29
  v_lshrrev_b32 v30, 16, v30
  v_mul_u32_u24 v30, 12, v30
  v_lshl_add_u32 v58, v29, 1, v30
  v_add_u32 v29, 256, v29
  v_mul_u32_u24 v30, 2521, v29
  v_lshrrev_b32 v30, 16, v30
  v_mul_u32_u24 v30, 12, v30
  v_lshl_add_u32 v111, v29, 1, v30
  v_cmp_gt_u32 vcc, 676, v29
  s_nop 0
  s_mov_b64 s[92:93], vcc
  v_lshlrev_b32 v29, 3, v0
  s_mov_b32 exec_hi, 0xffff
  ds_write_b64 v29, v[32:33] offset:1664
  s_mov_b32 exec_hi, -1
  s_waitcnt vmcnt(7)
  ds_write_b32 v243, v32
  ds_write_b32 v243, v32 offset:43328
  s_waitcnt vmcnt(2)
  ds_read_b64 v[112:113], v240 offset:0
  ds_read_b64 v[114:115], v240 offset:8
  ds_read_b64 v[116:117], v240 offset:32
  ds_read_b64 v[118:119], v240 offset:40
  ds_read_u16 v110, v241
  s_mov_b64 exec, 0x3ffffff
  s_waitcnt lgkmcnt(0)
  ds_write_b16 v242, v110
  v_lshlrev_b32 v109, 17, v110
  v_lshrrev_b32 v109, 1, v109
  s_mov_b64 exec, -1
  v_add_u32 v225, s52, v225
  v_add_u32 v226, s52, v226
  v_add_u32_e64 v227, s52, v227
  s_waitcnt lgkmcnt(0)
  s_barrier
  ds_read_b64_tr_b16 v[60:61], v225 offset:35328
  ds_read_b64_tr_b16 v[62:63], v225 offset:40736
  ds_read_b64_tr_b16 v[64:65], v226 offset:35328
  ds_read_b64_tr_b16 v[66:67], v227 offset:35328
  ds_read_b64_tr_b16 v[68:69], v225 offset:35392
  ds_read_b64_tr_b16 v[70:71], v225 offset:40800
  ds_read_b64_tr_b16 v[72:73], v226 offset:35392
  ds_read_b64_tr_b16 v[74:75], v227 offset:35392
  ds_read_b64_tr_b16 v[76:77], v225 offset:35840
  ds_read_b64_tr_b16 v[78:79], v225 offset:41248
  ds_read_b64_tr_b16 v[80:81], v226 offset:35840
  ds_read_b64_tr_b16 v[82:83], v227 offset:35840
  ds_read_b64_tr_b16 v[84:85], v225 offset:35904
  ds_read_b64_tr_b16 v[86:87], v225 offset:41312
  ds_read_b64_tr_b16 v[88:89], v226 offset:35904
  ds_read_b64_tr_b16 v[90:91], v227 offset:35904
  s_waitcnt lgkmcnt(14)
  v_mfma_f32_32x32x16_bf16 v[120:135], v[112:115], v[60:63], 0
  s_waitcnt lgkmcnt(12)
  v_mfma_f32_32x32x16_bf16 v[120:135], v[116:119], v[64:67], v[120:135]
  ds_read_b64_tr_b16 v[92:93], v225 offset:36352
  ds_read_b64_tr_b16 v[94:95], v225 offset:41760
  ds_read_b64_tr_b16 v[96:97], v226 offset:36352
  ds_read_b64_tr_b16 v[98:99], v227 offset:36352
  s_waitcnt lgkmcnt(14)
  v_mfma_f32_32x32x16_bf16 v[136:151], v[112:115], v[68:71], 0
  s_waitcnt lgkmcnt(12)
  v_mfma_f32_32x32x16_bf16 v[136:151], v[116:119], v[72:75], v[136:151]
  ds_read_b64_tr_b16 v[100:101], v225 offset:36416
  ds_read_b64_tr_b16 v[102:103], v225 offset:41824
  ds_read_b64_tr_b16 v[104:105], v226 offset:36416
  ds_read_b64_tr_b16 v[106:107], v227 offset:36416
  s_waitcnt lgkmcnt(14)
  v_mfma_f32_32x32x16_bf16 v[152:167], v[112:115], v[76:79], 0
  s_waitcnt lgkmcnt(12)
  v_mfma_f32_32x32x16_bf16 v[152:167], v[116:119], v[80:83], v[152:167]
  s_waitcnt lgkmcnt(10)
  v_mfma_f32_32x32x16_bf16 v[168:183], v[112:115], v[84:87], 0
  s_waitcnt lgkmcnt(8)
  v_mfma_f32_32x32x16_bf16 v[168:183], v[116:119], v[88:91], v[168:183]
  ds_read_b128 v[228:231], v250 offset:6144
  ds_read_b128 v[232:235], v251 offset:0
  ds_read_b128 v[4:7], v250 offset:3072
  ds_read_b128 v[8:11], v251 offset:2048
  ds_read_b128 v[20:23], v250 offset:1024
  ds_read_b128 v[24:27], v250 offset:2048
  ds_read_b128 v[216:219], v250 offset:4096
  ds_read_b128 v[220:223], v250 offset:5120
  ds_read_b128 v[236:239], v251 offset:1024
  s_waitcnt lgkmcnt(14)
  v_mfma_f32_32x32x16_bf16 v[184:199], v[112:115], v[92:95], 0
  s_waitcnt lgkmcnt(13)
  v_mfma_f32_32x32x16_bf16 v[184:199], v[116:119], v[96:99], v[184:199]
  s_waitcnt lgkmcnt(11)
  v_mfma_f32_32x32x16_bf16 v[200:215], v[112:115], v[100:103], 0
  s_waitcnt lgkmcnt(9)
  v_mfma_f32_32x32x16_bf16 v[200:215], v[116:119], v[104:107], v[200:215]
  s_waitcnt lgkmcnt(8)
  v_add_u32 v228, s54, v228
  v_add_u32 v229, s54, v229
  v_add_u32 v231, s83, v231
  v_add_u32 v230, s91, v230
  s_waitcnt lgkmcnt(7)
  v_mad_u32_u24 v232, v233, s3, v232
  v_add_u32 v234, s55, v234
  v_mad_u32_u24 v233, v233, 8, v232
  v_add_u32 v246, s82, v235
  v_add_u32 v247, 2048, v246
  v_add_u32 v31, 0, v234
  v_and_b32 v31, 3, v31
  v_lshl_add_u32 v244, v31, 4, v232
  v_add_u32 v31, 1, v234
  v_and_b32 v31, 3, v31
  v_lshl_add_u32 v245, v31, 4, v232
  v_add_u32 v245, 1664, v245
  v_add_u32 v31, 0, v234
  v_and_b32 v31, 3, v31
  v_lshl_add_u32 v248, v31, 4, v233
  v_add_u32 v31, 1, v234
  v_and_b32 v31, 3, v31
  v_lshl_add_u32 v249, v31, 4, v233
  v_add_u32 v249, 1664, v249
  s_waitcnt lgkmcnt(5)
  v_add_u32 v10, s76, v10
  v_add_u32 v4, s76, v4
  v_add_u32 v5, s76, v5
  ds_write_b32 v10, v7 offset:2880
  v_add_u32 v11, s53, v11
  s_waitcnt lgkmcnt(5)
  v_add_u32 v20, s53, v20
  v_add_u32 v21, s53, v21
  v_add_u32 v22, s53, v22
  v_add_u32 v23, s53, v23
  s_waitcnt lgkmcnt(4)
  v_add_u32 v24, s53, v24
  v_add_u32 v25, s53, v25
  v_add_u32 v26, s53, v26
  v_add_u32 v27, s53, v27
  s_mov_b32 exec_lo, 0
  v_mov_b32 v120, v136
  s_mov_b32 exec_lo, -1
  v_cvt_pk_bf16_f32 v60, 0, v120
  ds_write_b16_d16_hi v28, v60
  v_max_f32 v108, |v60|, v108
  s_mov_b32 exec_lo, 0
  v_mov_b32 v152, v168
  s_mov_b32 exec_lo, -1
  v_cvt_pk_bf16_f32 v61, 0, v152
  ds_write_b16_d16_hi v58, v61
  v_max_f32 v108, |v61|, v108
  s_mov_b32 exec_lo, 0
  v_mov_b32_e64 v184, v200
  s_mov_b32 exec_lo, -1
  v_cvt_pk_bf16_f32 v62, 0, v184
  s_mov_b64 exec, s[92:93]
  ds_write_b16_d16_hi v111, v62
  v_max_f32 v108, |v62|, v108
  s_mov_b64 exec, -1
  s_nop 0
  v_permlane32_swap_b32 v108, v109
  v_max_u32_e64 v108, v108, v109
  s_nop 1
  v_max_u32_dpp v108, v108, v108 row_shr:1 row_mask:0xf bank_mask:0xf
  s_nop 1
  v_max_u32_dpp v108, v108, v108 row_shr:2 row_mask:0xf bank_mask:0xf
  s_nop 1
  v_max_u32_dpp v108, v108, v108 row_shr:4 row_mask:0xf bank_mask:0xf
  s_nop 1
  v_max_u32_dpp v108, v108, v108 row_shr:8 row_mask:0xf bank_mask:0xf
  s_nop 1
  v_max_u32_dpp v108, v108, v108 row_bcast:15 row_mask:0xa bank_mask:0xf
  s_mov_b32 exec_lo, 0x80000000
  s_mov_b32 exec_hi, 0x80000000
  ds_max_u32 v3, v108 offset:24
  s_mov_b64 exec, -1
  s_setprio 0
  s_waitcnt vmcnt(0)
  v_lshlrev_b32 v15, 7, v15
  buffer_load_dword v12, v15, s[32:35], 0 offen
  s_waitcnt lgkmcnt(0)
  s_barrier
  s_branch L_w2
L_g0:
  s_waitcnt lgkmcnt(0)
  s_mov_b32 s36, s8
  s_and_b32 s37, s9, 0xffff
  s_mov_b32 s38, 105456
  s_mov_b32 s39, 0x20000
  s_barrier
  s_add_u32 m0, s95, 41984
  s_add_u32 s81, s95, 70304
  buffer_load_dwordx4 v1, s[36:39], s81 offen lds
  s_add_u32 m0, s95, 46080
  s_add_u32 s81, s95, 74400
  buffer_load_dwordx4 v1, s[36:39], s81 offen lds
  s_add_u32 m0, s95, 50176
  s_add_u32 s81, s95, 78496
  buffer_load_dwordx4 v1, s[36:39], s81 offen lds
  s_add_u32 m0, s95, 54272
  s_add_u32 s81, s95, 82592
  buffer_load_dwordx4 v1, s[36:39], s81 offen lds
  s_add_u32 m0, s95, 58368
  s_add_u32 s81, s95, 86688
  buffer_load_dwordx4 v1, s[36:39], s81 offen lds
  s_add_u32 m0, s95, 62464
  s_add_u32 s81, s95, 90784
  buffer_load_dwordx4 v1, s[36:39], s81 offen lds
  s_add_u32 m0, s95, 66560
  s_add_u32 s81, s95, 94880
  buffer_load_dwordx4 v1, s[36:39], s81 offen lds
  s_add_u32 m0, s95, 70656
  s_add_u32 s81, s95, 98976
  buffer_load_dwordx4 v1, s[36:39], s81 offen lds
  s_cmp_eq_u32 s79, 3
  s_cbranch_scc1 L_st3
  s_add_u32 m0, s95, 74752
  s_add_u32 s81, s95, 103072
  buffer_load_dwordx4 v1, s[36:39], s81 offen lds
L_st3:
L_g0b:
  s_mov_b32 s28, s4
  s_and_b32 s29, s5, 0xffff
  s_mov_b32 s30, 425984
  s_mov_b32 s31, 0x20000
  buffer_load_dwordx4 v[16:19], v30, s[28:31], s94 offen
  s_add_u32 s94, s94, 416
  buffer_load_dwordx4 v[12:15], v30, s[28:31], s94 offen
  s_add_u32 s94, s94, 416
  s_mov_b32 s32, s6
  s_and_b32 s33, s7, 0xffff
  s_mov_b32 s34, 12800000
  s_mov_b32 s35, 0x20000
  s_mul_i32 s96, s79, 3072
  s_mul_i32 s97, s79, 2704
  v_lshrrev_b32 v31, 5, v0
  v_mul_u32_u24 v31, 184, v31
  v_sub_u32 v31, v1, v31
  s_add_u32 m0, s96, 85312
  s_add_u32 s81, s97, 35152
  buffer_load_dwordx4 v1, s[36:39], s81 offen lds
  s_lshl_b32 s85, s85, 2
  s_add_u32 s85, s85, 129728
  s_mul_i32 s72, s84, 3
  s_sub_u32 s72, 4, s72
  s_cmp_eq_u32 s26, 85
  s_cselect_b32 s72, s72, 6
  s_add_u32 m0, s96, 86336
  s_add_u32 s81, s97, 36176
  buffer_load_dwordx4 v31, s[36:39], s81 offen lds
  s_lshl_b32 s52, s3, 7
  s_mul_i32 s53, s3, 5280
  s_lshl_b32 s54, s3, 2
  s_lshl_b32 s55, s3, 1
  s_lshl_b32 s82, s3, 12
  s_add_u32 m0, s96, 87360
  s_add_u32 s81, s97, 37016
  buffer_load_dwordx4 v1, s[36:39], s81 offen lds
  s_and_b32 s98, s3, 1
  s_lshr_b32 s99, s3, 1
  s_mul_i32 s68, s99, 3072
  s_lshl_b32 s83, s98, 3
  s_add_u32 s68, s68, s83
  s_add_u32 m0, s96, 97600
  s_add_u32 s81, s97, 45968
  buffer_load_dwordx4 v1, s[36:39], s81 offen lds
  v_add_u32 v59, s68, v1
  s_lshl_b32 s69, s99, 3
  s_lshr_b32 s69, 0x05030200, s69
  s_and_b32 s69, s69, 0xff
  s_lshl_b32 s69, s69, 9
  s_add_u32 m0, s96, 98624
  s_add_u32 s81, s97, 46992
  buffer_load_dwordx4 v31, s[36:39], s81 offen lds
  s_lshl_b32 s70, s98, 2
  s_add_u32 s91, s69, s70
  s_mov_b32 s99, 0x05040100
  s_mov_b32 s100, 0x07060302
  v_mov_b32 v2, 129664
  s_add_u32 m0, s96, 99648
  s_add_u32 s81, s97, 47832
  buffer_load_dwordx4 v1, s[36:39], s81 offen lds
  v_mov_b32 v109, 0
  v_mov_b32 v108, 0
  v_mov_b64 v[32:33], 0
  v_mov_b64 v[34:35], 0
  v_mov_b64 v[36:37], 0
  s_add_u32 m0, s96, 109888
  s_add_u32 s81, s97, 56784
  buffer_load_dwordx4 v1, s[36:39], s81 offen lds
  v_mov_b64 v[38:39], 0
  v_mov_b64 v[40:41], 0
  v_mov_b64 v[42:43], 0
  v_mov_b64 v[44:45], 0
  v_mov_b64 v[46:47], 0
  s_add_u32 m0, s96, 110912
  s_add_u32 s81, s97, 57808
  buffer_load_dwordx4 v31, s[36:39], s81 offen lds
  v_mov_b64 v[48:49], 0
  v_mov_b64 v[50:51], 0
  v_mov_b64 v[52:53], 0
  v_mov_b64 v[54:55], 0
  v_mov_b64 v[56:57], 0
  s_add_u32 m0, s96, 111936
  s_add_u32 s81, s97, 58648
  buffer_load_dwordx4 v1, s[36:39], s81 offen lds
  v_add_u32 v250, 77824, v1
  s_waitcnt vmcnt(19)
  v_add_u32 v251, 125248, v1
  v_lshrrev_b32 v3, 5, v0
  v_lshl_add_u32 v3, v3, 2, v2
  s_cmp_lg_u32 s79, 0
  s_cbranch_scc1 L_st2
  s_add_u32 m0, s96, 122176
  s_add_u32 s81, s97, 67600
  buffer_load_dwordx4 v1, s[36:39], s81 offen lds
  s_add_u32 m0, s96, 123200
  s_add_u32 s81, s97, 68624
  buffer_load_dwordx4 v31, s[36:39], s81 offen lds
  s_add_u32 m0, s96, 124224
  s_add_u32 s81, s97, 69464
  buffer_load_dwordx4 v1, s[36:39], s81 offen lds
L_st2:
  s_add_u32 m0, s95, 6144
  s_add_u32 s81, s95, 0
  buffer_load_dwordx4 v1, s[36:39], s81 offen lds
  s_add_u32 m0, s95, 10240
  s_add_u32 s81, s95, 4096
  buffer_load_dwordx4 v1, s[36:39], s81 offen lds
  s_add_u32 m0, s95, 14336
  s_add_u32 s81, s95, 8192
  buffer_load_dwordx4 v1, s[36:39], s81 offen lds
  s_add_u32 m0, s95, 18432
  s_add_u32 s81, s95, 12288
  buffer_load_dwordx4 v1, s[36:39], s81 offen lds
  s_waitcnt vmcnt(15)
  s_barrier
  ds_read_b128 v[224:227], v250 offset:0
  ds_read_b128 v[228:231], v250 offset:6144
  ds_read_b128 v[232:235], v251 offset:0
  ds_read_b128 v[4:7], v250 offset:3072
  ds_read_b128 v[8:11], v251 offset:2048
  ds_read_b128 v[20:23], v250 offset:1024
  ds_read_b128 v[24:27], v250 offset:2048
  ds_read_b128 v[216:219], v250 offset:4096
  ds_read_b128 v[220:223], v250 offset:5120
  ds_read_b128 v[236:239], v251 offset:1024
  s_add_u32 m0, s95, 22528
  s_add_u32 s81, s95, 16384
  buffer_load_dwordx4 v1, s[36:39], s81 offen lds
  s_add_u32 m0, s95, 26624
  s_add_u32 s81, s95, 20480
  buffer_load_dwordx4 v1, s[36:39], s81 offen lds
  s_add_u32 m0, s95, 30720
  s_add_u32 s81, s95, 24576
  buffer_load_dwordx4 v1, s[36:39], s81 offen lds
  s_add_u32 m0, s95, 34816
  s_add_u32 s81, s95, 28672
  buffer_load_dwordx4 v1, s[36:39], s81 offen lds
  s_cmp_eq_u32 s79, 3
  s_cbranch_scc1 L_st1
  s_add_u32 m0, s95, 38912
  s_add_u32 s81, s95, 32768
  buffer_load_dwordx4 v1, s[36:39], s81 offen lds
L_st1:
  s_waitcnt lgkmcnt(9)
  v_add_u32 v225, s52, v225
  v_add_u32 v226, s52, v226
  v_add_u32 v227, s52, v227
  s_waitcnt lgkmcnt(8)
  v_add_u32 v228, s54, v228
  v_add_u32 v229, s54, v229
  v_add_u32 v231, s83, v231
  v_add_u32 v230, s91, v230
  s_waitcnt lgkmcnt(7)
  v_mad_u32_u24 v232, v233, s3, v232
  v_add_u32 v234, s55, v234
  v_mad_u32_u24 v233, v233, 8, v232
  v_add_u32 v246, s82, v235
  v_add_u32 v247, 2048, v246
  v_add_u32 v31, 0, v234
  v_and_b32 v31, 3, v31
  v_lshl_add_u32 v244, v31, 4, v232
  v_add_u32 v31, 1, v234
  v_and_b32_e64 v31, 3, v31
  v_lshl_add_u32 v245, v31, 4, v232
  v_add_u32 v245, 1664, v245
  v_add_u32 v31, 0, v234
  v_and_b32 v31, 3, v31
  v_lshl_add_u32 v248, v31, 4, v233
  v_add_u32 v31, 1, v234
  v_and_b32 v31, 3, v31
  v_lshl_add_u32 v249, v31, 4, v233
  v_add_u32 v249, 1664, v249
  s_waitcnt lgkmcnt(5)
  v_add_u32 v10, s76, v10
  v_add_u32 v4, s76, v4
  v_add_u32 v5, s76, v5
  ds_write_b32 v10, v7 offset:2880
  v_add_u32 v11, s53, v11
  s_waitcnt lgkmcnt(5)
  v_add_u32 v20, s53, v20
  v_add_u32 v21, s53, v21
  v_add_u32 v22, s53, v22
  v_add_u32 v23, s53, v23
  s_waitcnt lgkmcnt(4)
  v_add_u32 v24, s53, v24
  v_add_u32 v25, s53, v25
  v_add_u32 v26, s53, v26
  v_add_u32 v27, s53, v27
  s_waitcnt vmcnt(18)
  v_lshl_add_u32 v16, v16, 7, v29
  v_lshl_add_u32 v17, v17, 7, v29
  v_lshl_add_u32 v18, v18, 7, v29
  v_lshl_add_u32 v19, v19, 7, v29
  s_add_u32 m0, s76, 0
  s_mov_b32 exec_hi, 0xffffff
  buffer_load_dwordx4 v16, s[32:35], 0 offen lds
  s_add_u32 m0, s76, 1056
  s_nop 0
  buffer_load_dwordx4 v17, s[32:35], 0 offen lds
  s_add_u32 m0, s76, 2112
  s_mov_b32 exec_hi, 0xffff
  buffer_load_dwordx4 v18, s[32:35], 0 offen lds
  s_add_u32 m0, s76, 3168
  s_nop 0
  buffer_load_dwordx4 v19, s[32:35], 0 offen lds
  s_mov_b32 exec_hi, -1
  s_waitcnt vmcnt(4)
  s_barrier
L_w2:
  ds_read2st64_b32 v[60:61], v228 offset0:0 offset1:6
  ds_read2st64_b32 v[62:63], v228 offset0:12 offset1:18
  ds_read2st64_b32 v[64:65], v228 offset0:24 offset1:30
  ds_read2st64_b32 v[66:67], v228 offset0:36 offset1:42
  ds_read2st64_b32 v[68:69], v228 offset0:96 offset1:102
  ds_read2st64_b32 v[70:71], v229 offset0:108 offset1:114
  ds_read2st64_b32 v[72:73], v229 offset0:120 offset1:126
  ds_read2st64_b32 v[74:75], v229 offset0:132 offset1:138
  s_cmp_ge_u32 s3, 5
  s_cbranch_scc1 L_u0
  v_add_u32 v228, 32, v228
  v_add_u32 v229, 32, v229
  ds_read2st64_b32 v[92:93], v228 offset0:0 offset1:6
  ds_read2st64_b32 v[94:95], v228 offset0:12 offset1:18
  ds_read2st64_b32 v[96:97], v228 offset0:24 offset1:30
  ds_read2st64_b32 v[98:99], v228 offset0:36 offset1:42
  ds_read2st64_b32 v[100:101], v228 offset0:96 offset1:102
  ds_read2st64_b32 v[102:103], v229 offset0:108 offset1:114
  ds_read2st64_b32 v[104:105], v229 offset0:120 offset1:126
  ds_read2st64_b32 v[106:107], v229 offset0:132 offset1:138
  ds_read_b64_tr_b16 v[76:77], v225 offset:0
  ds_read_b64_tr_b16 v[78:79], v225 offset:5408
  ds_read_b64_tr_b16 v[80:81], v226 offset:0
  ds_read_b64_tr_b16 v[82:83], v227 offset:0
  ds_read_b64_tr_b16 v[84:85], v225 offset:64
  ds_read_b64_tr_b16 v[86:87], v225 offset:5472
  ds_read_b64_tr_b16 v[88:89], v226 offset:64
  ds_read_b64_tr_b16 v[90:91], v227 offset:64
  ds_read_b64_tr_b16 v[112:113], v224 offset:0
  ds_read_b64_tr_b16 v[114:115], v224 offset:256
  ds_read_b64_tr_b16 v[116:117], v224 offset:1024
  ds_read_b64_tr_b16 v[118:119], v224 offset:1280
  s_waitcnt lgkmcnt(14)
  v_mfma_f32_16x16x32_bf16 v[108:111], v[60:63], v[60:63], 0
  v_mfma_f32_16x16x32_bf16 v[108:111], v[64:67], v[64:67], v[108:111]
  v_mfma_f32_16x16x32_bf16 v[108:111], v[68:71], v[68:71], v[108:111]
  v_mfma_f32_16x16x32_bf16 v[108:111], v[72:75], v[72:75], v[108:111]
  v_perm_b32 v184, v61, v60, s99
  v_perm_b32 v185, v63, v62, s99
  v_perm_b32 v186, v65, v64, s99
  v_perm_b32 v187, v67, v66, s99
  v_perm_b32 v188, v69, v68, s99
  v_perm_b32 v189, v71, v70, s99
  v_perm_b32 v190, v73, v72, s99
  v_perm_b32 v191, v75, v74, s99
  v_mfma_f32_16x16x32_bf16 v[108:111], v[92:95], v[92:95], v[108:111]
  v_mfma_f32_16x16x32_bf16 v[108:111], v[96:99], v[96:99], v[108:111]
  v_mfma_f32_16x16x32_bf16 v[108:111], v[100:103], v[100:103], v[108:111]
  s_waitcnt lgkmcnt(12)
  v_mfma_f32_16x16x32_bf16 v[108:111], v[104:107], v[104:107], v[108:111]
  s_waitcnt lgkmcnt(10)
  v_mfma_f32_16x16x32_bf16 v[28:31], v[76:79], v[76:79], 0
  s_waitcnt lgkmcnt(8)
  v_mfma_f32_16x16x32_bf16 v[28:31], v[80:83], v[80:83], v[28:31]
  s_waitcnt lgkmcnt(6)
  v_mfma_f32_16x16x32_bf16 v[28:31], v[84:87], v[84:87], v[28:31]
  s_waitcnt lgkmcnt(4)
  v_mfma_f32_16x16x32_bf16 v[28:31], v[88:91], v[88:91], v[28:31]
  v_perm_b32 v192, v61, v60, s100
  v_perm_b32 v193, v63, v62, s100
  v_perm_b32 v194, v65, v64, s100
  v_perm_b32 v195, v67, v66, s100
  v_perm_b32 v196, v69, v68, s100
  v_perm_b32 v197, v71, v70, s100
  v_perm_b32 v198, v73, v72, s100
  v_perm_b32 v199, v75, v74, s100
  v_max3_f32 v28, v28, v29, 0
  v_perm_b32 v60, v93, v92, s99
  v_perm_b32 v61, v95, v94, s99
  v_max3_f32 v108, v108, v109, 0
  v_perm_b32 v62, v97, v96, s99
  v_max3_f32 v28, v28, v30, v31
  v_perm_b32 v63, v99, v98, s99
  v_max3_f32 v108, v108, v110, v111
  v_perm_b32 v64, v101, v100, s99
  v_perm_b32 v65, v103, v102, s99
  v_permlane32_swap_b32 v28, v108
  v_perm_b32 v66, v105, v104, s99
  v_max_u32 v28, v28, v108
  v_perm_b32 v67, v107, v106, s99
  s_nop 0
  v_max_u32_dpp v28, v28, v28 row_shr:1 row_mask:0xf bank_mask:0xf
  v_perm_b32 v68, v93, v92, s100
  v_perm_b32 v69, v95, v94, s100
  v_max_u32_dpp v28, v28, v28 row_shr:2 row_mask:0xf bank_mask:0xf
  v_perm_b32 v70, v97, v96, s100
  s_nop 0
  v_max_u32_dpp v28, v28, v28 row_shr:4 row_mask:0xf bank_mask:0xf
  v_perm_b32 v71, v99, v98, s100
  s_nop 0
  v_max_u32_dpp v28, v28, v28 row_shr:8 row_mask:0xf bank_mask:0xf
  v_perm_b32 v72, v101, v100, s100
  v_perm_b32 v73, v103, v102, s100
  v_max_u32_dpp v28, v28, v28 row_bcast:15 row_mask:0xa bank_mask:0xf
  v_perm_b32 v74, v105, v104, s100
  s_mov_b32 exec_lo, 0x80000000
  s_mov_b32 exec_hi, 0x80000000
  ds_max_u32 v3, v28 offset:16
  s_mov_b64 exec, -1
  v_perm_b32 v75, v107, v106, s100
  s_branch L_u1
L_u0:
  ds_read_b64_tr_b16 v[76:77], v225 offset:0
  ds_read_b64_tr_b16 v[78:79], v225 offset:5408
  ds_read_b64_tr_b16 v[80:81], v226 offset:0
  ds_read_b64_tr_b16 v[82:83], v227 offset:0
  ds_read_b64_tr_b16 v[84:85], v225 offset:64
  ds_read_b64_tr_b16 v[86:87], v225 offset:5472
  ds_read_b64_tr_b16 v[88:89], v226 offset:64
  ds_read_b64_tr_b16 v[90:91], v227 offset:64
  ds_read_b64_tr_b16 v[92:93], v225 offset:384
  ds_read_b64_tr_b16 v[94:95], v225 offset:5792
  ds_read_b64_tr_b16 v[96:97], v226 offset:384
  ds_read_b64_tr_b16 v[98:99], v227 offset:384
  ds_read_b64_tr_b16 v[100:101], v225 offset:448
  ds_read_b64_tr_b16 v[102:103], v225 offset:5856
  ds_read_b64_tr_b16 v[104:105], v226 offset:448
  ds_read_b64_tr_b16 v[106:107], v227 offset:448
  ds_read_b64_tr_b16 v[112:113], v224 offset:0
  ds_read_b64_tr_b16 v[114:115], v224 offset:256
  ds_read_b64_tr_b16 v[116:117], v224 offset:1024
  ds_read_b64_tr_b16 v[118:119], v224 offset:1280
  s_waitcnt lgkmcnt(14)
  v_mfma_f32_16x16x32_bf16 v[108:111], v[60:63], v[60:63], 0
  v_mfma_f32_16x16x32_bf16 v[108:111], v[64:67], v[64:67], v[108:111]
  v_mfma_f32_16x16x32_bf16 v[108:111], v[68:71], v[68:71], v[108:111]
  v_mfma_f32_16x16x32_bf16 v[108:111], v[72:75], v[72:75], v[108:111]
  v_mfma_f32_16x16x32_bf16 v[28:31], v[76:79], v[76:79], 0
  v_mfma_f32_16x16x32_bf16 v[28:31], v[80:83], v[80:83], v[28:31]
  v_mfma_f32_16x16x32_bf16 v[28:31], v[84:87], v[84:87], v[28:31]
  s_waitcnt lgkmcnt(12)
  v_mfma_f32_16x16x32_bf16 v[28:31], v[88:91], v[88:91], v[28:31]
  s_waitcnt lgkmcnt(10)
  v_mfma_f32_16x16x32_bf16 v[28:31], v[92:95], v[92:95], v[28:31]
  s_waitcnt lgkmcnt(8)
  v_mfma_f32_16x16x32_bf16 v[28:31], v[96:99], v[96:99], v[28:31]
  s_waitcnt lgkmcnt(6)
  v_mfma_f32_16x16x32_bf16 v[28:31], v[100:103], v[100:103], v[28:31]
  s_waitcnt lgkmcnt(4)
  v_mfma_f32_16x16x32_bf16 v[28:31], v[104:107], v[104:107], v[28:31]
  v_perm_b32 v184, v61, v60, s99
  v_perm_b32 v185, v63, v62, s99
  v_perm_b32 v186, v65, v64, s99
  v_perm_b32 v187, v67, v66, s99
  s_nop 3
  v_max3_f32 v28, v28, v29, 0
  v_perm_b32 v188, v69, v68, s99
  v_max3_f32 v108, v108, v109, 0
  v_perm_b32 v189, v71, v70, s99
  v_max3_f32 v28, v28, v30, v31
  v_perm_b32 v190, v73, v72, s99
  v_max3_f32 v108, v108, v110, v111
  v_perm_b32 v191, v75, v74, s99
  s_nop 0
  v_permlane32_swap_b32 v28, v108
  v_perm_b32 v192, v61, v60, s100
  v_max_u32 v28, v28, v108
  v_perm_b32 v193, v63, v62, s100
  s_nop 0
  v_max_u32_dpp v28, v28, v28 row_shr:1 row_mask:0xf bank_mask:0xf
  v_perm_b32 v194, v65, v64, s100
  s_nop 0
  v_max_u32_dpp v28, v28, v28 row_shr:2 row_mask:0xf bank_mask:0xf
  v_perm_b32 v195, v67, v66, s100
  s_nop 0
  v_max_u32_dpp v28, v28, v28 row_shr:4 row_mask:0xf bank_mask:0xf
  v_perm_b32 v196, v69, v68, s100
  s_nop 0
  v_max_u32_dpp v28, v28, v28 row_shr:8 row_mask:0xf bank_mask:0xf
  v_perm_b32 v197, v71, v70, s100
  s_nop 0
  v_max_u32_dpp v28, v28, v28 row_bcast:15 row_mask:0xa bank_mask:0xf
  v_perm_b32 v198, v73, v72, s100
  s_mov_b32 exec_lo, 0x80000000
  s_mov_b32 exec_hi, 0x80000000
  ds_max_u32 v3, v28 offset:16
  s_mov_b64 exec, -1
  v_perm_b32 v199, v75, v74, s100
  v_add_u32 v248, 12288, v246
  v_add_u32 v249, 12288, v247
  s_cmp_lg_u32 s3, 7
  s_cbranch_scc1 L_u1
  s_mov_b32 exec_lo, 0xfffffff0
  s_mov_b32 exec_hi, 0xfffffff0
  v_mov_b32 v249, 1048576
  s_mov_b64 exec, -1
L_u1:
  s_waitcnt lgkmcnt(0)
  s_barrier
  ds_read_b128 v[108:111], v2 offset:16
  s_cmp_lg_u32 s84, 0
  s_cbranch_scc1 L_hb1
  s_branch L_hb2
L_hb1:
  v_lshlrev_b32 v14, 7, v14
  buffer_load_dword v13, v14, s[32:35], 0 offen
L_hb2:
  s_mul_i32 s68, s3, 384
  v_lshrrev_b32 v29, 2, v0
  v_mul_u32_u24 v29, 24, v29
  v_add_u32 v29, s68, v29
  v_and_b32 v30, 3, v0
  v_lshlrev_b32_e64 v30, 3, v30
  ds_read_b64 v[224:225], v29 offset:2048
  ds_read_b64 v[226:227], v29 offset:2056
  ds_read_b64 v[228:229], v29 offset:2064
  s_waitcnt lgkmcnt(3)
  v_add_u32 v108, 0x3f800000, v108
  v_add_u32 v109, 0x3f800000, v109
  v_lshrrev_b32 v108, 24, v108
  v_lshrrev_b32_e64 v109, 24, v109
  v_sub_u32 v108, 267, v108
  s_mov_b32 vcc_lo, 0x4000000
  v_min_u32 v108, 167, v108
  s_mov_b32 vcc_hi, 0x4000000
  v_readfirstlane_b32 s74, v108
  v_cndmask_b32 v250, v110, v111, vcc
  v_mul_u32_u24 v108, 0x800080, v108
  v_lshrrev_b32 v250, 23, v250
  v_and_b32 v216, v216, v108
  v_and_b32 v217, v217, v108
  v_and_b32 v218, v218, v108
  v_and_b32 v219, v219, v108
  v_and_b32 v220, v220, v108
  v_and_b32 v221, v221, v108
  v_and_b32 v222, v222, v108
  v_and_b32_e64 v223, v223, v108
  v_mfma_f32_32x32x16_bf16 v[152:167], v[216:219], v[76:79], 0
  v_add_u32 v250, v250, v109
  v_sub_u32 v250, 388, v250
  v_mfma_f32_32x32x16_bf16 v[168:183], v[216:219], v[84:87], 0
  s_movk_i32 s98, 167
  v_med3_i32 v250, v250, 1, s98
  v_mfma_f32_32x32x16_bf16 v[152:167], v[220:223], v[80:83], v[152:167]
  v_subrev_u32 v110, 127, v250
  v_lshlrev_b32_e64 v250, 23, v250
  v_mfma_f32_32x32x16_bf16 v[168:183], v[220:223], v[88:91], v[168:183]
  v_cmp_gt_i32 vcc, 0, v110
  v_mul_u32_u24 v110, 0x800080, v110
  s_cbranch_vccnz L_sdown
  v_add_u32 v112, v112, v110
  v_add_u32 v113, v113, v110
  v_add_u32 v114, v114, v110
  v_add_u32 v115, v115, v110
  v_add_u32 v116, v116, v110
  v_add_u32 v117, v117, v110
  v_add_u32 v118, v118, v110
  v_add_u32 v119, v119, v110
L_scaled:
  v_mfma_f32_32x32x16_bf16 v[120:135], v[184:187], v[112:115], 0
  v_cvt_pk_f16_f32 v152, v152, v153
  v_cvt_pk_f16_f32 v153, v154, v155
  v_cvt_pk_f16_f32 v154, v156, v157
  v_cvt_pk_f16_f32 v155, v158, v159
  ds_write_b128 v246, v[152:155]
  v_xor_b32_e64 v246, 16, v246
  v_mfma_f32_32x32x16_bf16 v[120:135], v[188:191], v[116:119], v[120:135]
  v_cvt_pk_f16_f32 v156, v160, v161
  v_cvt_pk_f16_f32 v157, v162, v163
  v_cvt_pk_f16_f32 v158, v164, v165
  v_cvt_pk_f16_f32 v159, v166, v167
  ds_write_b128 v246, v[156:159]
  v_mfma_f32_32x32x16_bf16 v[136:151], v[192:195], v[112:115], 0
  v_cvt_pk_f16_f32 v168, v168, v169
  v_cvt_pk_f16_f32 v169, v170, v171
  v_cvt_pk_f16_f32 v170, v172, v173
  v_cvt_pk_f16_f32 v171, v174, v175
  ds_write_b128 v247, v[168:171]
  v_xor_b32_e64 v247, 16, v247
  v_mfma_f32_32x32x16_bf16 v[136:151], v[196:199], v[116:119], v[136:151]
  v_cvt_pk_f16_f32 v172, v176, v177
  v_cvt_pk_f16_f32 v173, v178, v179
  v_cvt_pk_f16_f32 v174, v180, v181
  v_cvt_pk_f16_f32 v175, v182, v183
  ds_write_b128 v247, v[172:175]
  s_cmp_ge_u32 s3, 5
  s_cbranch_scc1 L_u2
  v_mfma_f32_32x32x16_bf16 v[184:199], v[60:63], v[112:115], 0
  v_cvt_pk_f16_f32 v120, v120, v121
  v_cvt_pk_f16_f32 v121, v122, v123
  v_cvt_pk_f16_f32 v122, v124, v125
  v_mfma_f32_32x32x16_bf16 v[184:199], v[64:67], v[116:119], v[184:199]
  v_cvt_pk_f16_f32 v123, v126, v127
  ds_write_b128 v244, v[120:123]
  v_xor_b32_e64 v244, 16, v244
  v_mfma_f32_32x32x16_bf16 v[200:215], v[68:71], v[112:115], 0
  v_cvt_pk_f16_f32 v124, v128, v129
  v_cvt_pk_f16_f32 v125, v130, v131
  v_cvt_pk_f16_f32 v126, v132, v133
  v_mfma_f32_32x32x16_bf16 v[200:215], v[72:75], v[116:119], v[200:215]
  v_cvt_pk_f16_f32 v127, v134, v135
  ds_write_b128 v244, v[124:127]
  s_branch L_u3
L_u2:
  v_mfma_f32_32x32x16_bf16 v[184:199], v[216:219], v[92:95], 0
  v_cvt_pk_f16_f32 v120, v120, v121
  v_cvt_pk_f16_f32 v121, v122, v123
  v_cvt_pk_f16_f32 v122, v124, v125
  v_mfma_f32_32x32x16_bf16 v[184:199], v[220:223], v[96:99], v[184:199]
  v_cvt_pk_f16_f32 v123, v126, v127
  ds_write_b128 v244, v[120:123]
  v_xor_b32 v244, 16, v244
  v_mfma_f32_32x32x16_bf16 v[200:215], v[216:219], v[100:103], 0
  v_cvt_pk_f16_f32 v124, v128, v129
  v_cvt_pk_f16_f32 v125, v130, v131
  v_cvt_pk_f16_f32 v126, v132, v133
  v_mfma_f32_32x32x16_bf16 v[200:215], v[220:223], v[104:107], v[200:215]
  v_cvt_pk_f16_f32 v127, v134, v135
  ds_write_b128 v244, v[124:127]
L_u3:
  buffer_load_dwordx4 v[16:19], v6, s[28:31], s94 offen
  s_add_u32 s94, s94, 416
  buffer_load_dwordx4 v[112:115], v6, s[28:31], s94 offen
  s_add_u32 s94, s94, 416
  s_cmp_lg_u32 s84, 0
  s_cbranch_scc1 L_hu1
  v_lshl_add_u32 v12, v12, 7, v8
  v_lshl_add_u32 v13, v13, 7, v8
  v_lshl_add_u32 v14, v14, 7, v8
  v_lshl_add_u32 v15, v15, 7, v8
  s_add_u32 m0, s76, 16256
  s_mov_b32 exec_hi, 0xffffff
  buffer_load_dwordx4 v12, s[32:35], 0 offen lds
  s_add_u32 m0, s76, 17312
  s_nop 0
  buffer_load_dwordx4 v13, s[32:35], 0 offen lds
  s_add_u32 m0, s76, 18368
  s_mov_b32 exec_hi, 0xffff
  buffer_load_dwordx4 v14, s[32:35], 0 offen lds
  s_add_u32 m0, s76, 19424
  s_nop 0
  buffer_load_dwordx4 v15, s[32:35], 0 offen lds
  s_mov_b32 exec_hi, -1
  s_branch L_hu2
L_hu1:
L_hu2:
  v_cvt_pk_f16_f32 v136, v136, v137
  s_waitcnt lgkmcnt(8)
  v_xor_b32 v224, v224, v30
  v_cvt_pk_f16_f32 v137, v138, v139
  v_cvt_pk_f16_f32 v138, v140, v141
  v_xor_b32 v232, 32, v224
  v_cvt_pk_f16_f32 v139, v142, v143
  ds_write_b128 v245, v[136:139]
  v_xor_b32 v245, 16, v245
  v_xor_b32 v225, v225, v30
  v_cvt_pk_f16_f32 v140, v144, v145
  v_cvt_pk_f16_f32 v141, v146, v147
  v_cvt_pk_f16_f32 v142, v148, v149
  v_xor_b32 v233, 32, v225
  v_cvt_pk_f16_f32 v143, v150, v151
  ds_write_b128 v245, v[140:143]
  v_cvt_pk_f16_f32 v184, v184, v185
  s_waitcnt lgkmcnt(9)
  v_xor_b32 v226, v226, v30
  v_cvt_pk_f16_f32 v185, v186, v187
  v_cvt_pk_f16_f32 v186, v188, v189
  v_xor_b32_e64 v234, 32, v226
  v_cvt_pk_f16_f32 v187, v190, v191
  ds_write_b128 v248, v[184:187]
  v_xor_b32 v248, 16, v248
  v_xor_b32 v227, v227, v30
  v_cvt_pk_f16_f32 v188, v192, v193
  v_cvt_pk_f16_f32 v189, v194, v195
  v_cvt_pk_f16_f32 v190, v196, v197
  v_xor_b32_e64 v235, 32, v227
  v_cvt_pk_f16_f32 v191, v198, v199
  ds_write_b128 v248, v[188:191]
  v_cvt_pk_f16_f32 v200, v200, v201
  s_waitcnt lgkmcnt(10)
  v_xor_b32 v228, v228, v30
  v_cvt_pk_f16_f32 v201, v202, v203
  v_cvt_pk_f16_f32 v202, v204, v205
  v_xor_b32 v240, 32, v228
  v_cvt_pk_f16_f32 v203, v206, v207
  ds_write_b128 v249, v[200:203]
  v_xor_b32 v249, 16, v249
  v_xor_b32_e64 v229, v229, v30
  v_cvt_pk_f16_f32 v204, v208, v209
  v_cvt_pk_f16_f32 v205, v210, v211
  v_cvt_pk_f16_f32 v206, v212, v213
  v_xor_b32_e64 v241, 32, v229
  v_cvt_pk_f16_f32 v207, v214, v215
  ds_write_b128 v249, v[204:207]
  v_readlane_b32 s0, v250, 0
  v_readlane_b32 s1, v250, 26
  s_sub_u32 s75, 0x7f000000, s0
  s_sub_u32 s1, 0x7f000000, s1
  s_sub_u32 s74, 254, s74
  s_lshl_b32 s74, s74, 23
  s_mov_b32 s92, 0x88888888
  s_mov_b32 s93, 0x88888888
  s_waitcnt lgkmcnt(0)
  s_barrier
  ds_read_b64_tr_b16 v[60:61], v224 offset:0
  ds_read_b64_tr_b16 v[62:63], v225 offset:0
  ds_read_b64_tr_b16 v[64:65], v232 offset:0
  ds_read_b64_tr_b16 v[66:67], v233 offset:0
  ds_read_b64_tr_b16 v[68:69], v224 offset:43328
  ds_read_b64_tr_b16 v[70:71], v225 offset:43328
  ds_read_b64_tr_b16 v[72:73], v232 offset:43328
  ds_read_b64_tr_b16 v[74:75], v233 offset:43328
  ds_read_b64_tr_b16 v[76:77], v226 offset:0
  ds_read_b64_tr_b16 v[78:79], v227 offset:0
  ds_read_b64_tr_b16 v[80:81], v234 offset:0
  ds_read_b64_tr_b16 v[82:83], v235 offset:0
  ds_read_b64_tr_b16 v[84:85], v226 offset:43328
  ds_read_b64_tr_b16 v[86:87], v227 offset:43328
  ds_read_b64_tr_b16 v[88:89], v234 offset:43328
  ds_read_b64_tr_b16 v[90:91], v235 offset:43328
  s_cmp_ge_u32 s3, 6
  s_cbranch_scc1 L_lin
  ds_read_b64_tr_b16 v[92:93], v228 offset:0
  ds_read_b64_tr_b16 v[94:95], v229 offset:0
  ds_read_b64_tr_b16 v[96:97], v240 offset:0
  ds_read_b64_tr_b16 v[98:99], v241 offset:0
  ds_read_b64_tr_b16 v[100:101], v228 offset:43328
  ds_read_b64_tr_b16 v[102:103], v229 offset:43328
  ds_read_b64_tr_b16 v[104:105], v240 offset:43328
  ds_read_b64_tr_b16 v[106:107], v241 offset:43328
  s_waitcnt lgkmcnt(6)
  v_pk_add_f16 v92, v92, v94
  v_pk_add_f16 v93, v93, v95
  ds_write_b64 v59, v[92:93] offset:30720
  s_waitcnt lgkmcnt(5)
  v_pk_add_f16 v96, v96, v98
  v_pk_add_f16 v97, v97, v99
  s_waitcnt lgkmcnt(3)
  v_pk_add_f16 v100, v100, v102
  v_pk_add_f16 v101, v101, v103
  ds_write_b64 v59, v[100:101] offset:32768
  s_waitcnt lgkmcnt(2)
  v_pk_add_f16 v104, v104, v106
  v_pk_add_f16 v105, v105, v107
  v_cndmask_b32 v96, v96, v104, s[92:93]
  v_cndmask_b32 v97, v97, v105, s[92:93]
  ds_write_b64 v59, v[96:97] offset:31744
  ds_write_b32 v230, v104 offset:3072
  ds_write_b32 v230, v105 offset:3088
  s_branch L_p2
L_lin:
  s_and_b32 s98, s3, 1
  s_cselect_b64 vcc, -1, 0
  s_lshl_b32 s99, s98, 5
  v_mov_b32 v31, 0
  v_xor_b32 v236, s99, v236
  v_xor_b32 v237, s99, v237
  v_cndmask_b32 v238, v238, v239, vcc
  ds_read_b64_tr_b16 v[92:93], v236
  ds_read_b64_tr_b16 v[94:95], v237
  ds_read_u16_d16_hi v31, v238
  s_lshl_b32 s98, s98, 10
  v_add_u32 v29, s98, v1
  s_waitcnt lgkmcnt(2)
  v_cvt_f32_f16 v96, v92
  v_cvt_f32_f16_sdwa v97, v92 dst_sel:DWORD dst_unused:UNUSED_PAD src0_sel:WORD_1
  v_mul_f32 v96, s1, v96
  v_mul_f32 v97, s1, v97
  v_mul_f32 v96, s0, v96
  v_mul_f32 v97, s0, v97
  v_cvt_pk_bf16_f32 v92, v96, v97
  v_cvt_f32_f16 v98, v93
  v_cvt_f32_f16_sdwa v99, v93 dst_sel:DWORD dst_unused:UNUSED_PAD src0_sel:WORD_1
  v_mul_f32 v98, s1, v98
  v_mul_f32 v99, s1, v99
  v_mul_f32 v98, s0, v98
  v_mul_f32 v99, s0, v99
  v_cvt_pk_bf16_f32 v93, v98, v99
  s_waitcnt lgkmcnt(1)
  v_cvt_f32_f16 v100, v94
  v_cvt_f32_f16_sdwa v101, v94 dst_sel:DWORD dst_unused:UNUSED_PAD src0_sel:WORD_1
  v_mul_f32 v100, s1, v100
  v_mul_f32 v101, s1, v101
  v_mul_f32 v100, s0, v100
  v_mul_f32 v101, s0, v101
  v_cvt_pk_bf16_f32 v94, v100, v101
  v_cvt_f32_f16_e64 v102, v95
  v_cvt_f32_f16_sdwa v103, v95 dst_sel:DWORD dst_unused:UNUSED_PAD src0_sel:WORD_1
  v_mul_f32 v102, s1, v102
  v_mul_f32 v103, s1, v103
  s_mov_b32 exec_lo, 0
  s_mov_b32 exec_hi, 0xffff
  s_waitcnt lgkmcnt(0)
  v_mov_b32 v102, v31
  s_mov_b64 exec, -1
  v_mul_f32 v102, s0, v102
  v_mul_f32 v103, s0, v103
  v_cvt_pk_bf16_f32 v95, v102, v103
  ds_write_b128 v29, v[92:95] offset:39936
L_p2:
  v_pk_add_f16 v76, v76, v78
  v_pk_add_f16 v77, v77, v79
  ds_write_b64 v59, v[76:77] offset:18432
  v_pk_add_f16 v80, v80, v82
  v_pk_add_f16 v81, v81, v83
  v_pk_add_f16 v84, v84, v86
  v_pk_add_f16 v85, v85, v87
  ds_write_b64 v59, v[84:85] offset:20480
  v_pk_add_f16 v88, v88, v90
  v_pk_add_f16 v89, v89, v91
  v_cndmask_b32 v80, v80, v88, s[92:93]
  v_cndmask_b32 v81, v81, v89, s[92:93]
  ds_write_b64 v59, v[80:81] offset:19456
  ds_write_b32 v230, v88 offset:1024
  ds_write_b32 v230, v89 offset:1040
  v_pk_add_f16 v60, v60, v62
  v_pk_add_f16 v61, v61, v63
  ds_write_b64 v59, v[60:61] offset:6144
  v_pk_add_f16 v64, v64, v66
  v_pk_add_f16 v65, v65, v67
  v_pk_add_f16 v68, v68, v70
  v_pk_add_f16 v69, v69, v71
  ds_write_b64 v59, v[68:69] offset:8192
  v_pk_add_f16 v72, v72, v74
  v_pk_add_f16 v73, v73, v75
  v_cndmask_b32 v64, v64, v72, s[92:93]
  v_cndmask_b32 v65, v65, v73, s[92:93]
  ds_write_b64 v59, v[64:65] offset:7168
  s_cmp_lt_u32 s3, 2
  s_cbranch_scc1 L_p2d
  v_subrev_u32 v230, 1024, v230
  ds_write_b32 v230, v72 offset:0
  ds_write_b32 v230, v73 offset:16
  s_branch L_built
L_p2d:
  ds_write_b64 v231, v[72:73] offset:5120
L_built:
  s_mov_b32 s0, s74
  s_mov_b32 s1, s75
  s_mov_b32 s96, 0x3e000000
  s_mov_b32 s97, 0x43000000
  s_mov_b32 s51, 1
  s_mul_i32 s98, s3, 1536
  s_add_u32 s98, s98, 116736
  s_cmp_lg_u32 s84, 0
  s_cbranch_scc1 L_g1c
  s_sub_u32 s94, s94, 416
  s_waitcnt vmcnt(4)
  ds_read_u16_d16_hi v32, v10 offset:0
  ds_read_u16_d16_hi v33, v10 offset:2
  ds_read_u16_d16_hi v34, v10 offset:2112
  ds_read_u16_d16_hi v35, v10 offset:2114
  ds_read_u16_d16_hi v36, v10 offset:128
  ds_read_u16_d16_hi v37, v10 offset:130
  ds_read_u16_d16_hi v38, v10 offset:2240
  ds_read_u16_d16_hi v39, v10 offset:2242
  ds_read_u16_d16_hi v40, v10 offset:256
  ds_read_u16_d16_hi v41, v10 offset:258
  ds_read_u16_d16_hi v42, v10 offset:2368
  ds_read_u16_d16_hi v43, v10 offset:2370
  ds_read_u16_d16_hi v44, v10 offset:384
  ds_read_u16_d16_hi v45, v10 offset:386
  ds_read_u16_d16_hi v46, v10 offset:2496
  ds_read_u16_d16_hi v47, v10 offset:2498
  ds_read_u16_d16_hi v48, v10 offset:512
  ds_read_u16_d16_hi v49, v10 offset:514
  ds_read_u16_d16_hi v50, v10 offset:2624
  ds_read_u16_d16_hi v51, v10 offset:2626
  ds_read_u16_d16_hi v52, v10 offset:640
  ds_read_u16_d16_hi v53, v10 offset:642
  ds_read_u16_d16_hi v54, v10 offset:2752
  ds_read_u16_d16_hi v55, v10 offset:2754
  ds_read_u16_d16_hi v56, v10 offset:768
  ds_read_u16_d16_hi v57, v10 offset:770
  s_waitcnt lgkmcnt(14)
  v_max3_f32 v58, |v32|, |v33|, 0
  v_cvt_pk_f16_f32 v184, v32, v33
  v_max3_f32 v58, |v34|, |v35|, v58
  v_cvt_pk_f16_f32 v185, v34, v35
  v_max3_f32 v58, |v36|, |v37|, v58
  v_cvt_pk_f16_f32 v186, v36, v37
  v_max3_f32 v58, |v38|, |v39|, v58
  v_cvt_pk_f16_f32 v187, v38, v39
  v_max3_f32 v58, |v40|, |v41|, v58
  v_cvt_pk_f16_f32 v188, v40, v41
  v_max3_f32 v58, |v42|, |v43|, v58
  v_cvt_pk_f16_f32 v189, v42, v43
  s_waitcnt lgkmcnt(12)
  v_max3_f32 v58, |v44|, |v45|, v58
  v_cvt_pk_f16_f32 v190, v44, v45
  s_waitcnt lgkmcnt(10)
  v_max3_f32 v58, |v46|, |v47|, v58
  v_cvt_pk_f16_f32 v191, v46, v47
  s_waitcnt lgkmcnt(8)
  v_max3_f32 v58, |v48|, |v49|, v58
  v_cvt_pk_f16_f32 v192, v48, v49
  s_waitcnt lgkmcnt(6)
  v_max3_f32 v58, |v50|, |v51|, v58
  v_cvt_pk_f16_f32 v193, v50, v51
  s_waitcnt lgkmcnt(4)
  v_max3_f32 v58, |v52|, |v53|, v58
  v_cvt_pk_f16_f32 v194, v52, v53
  s_waitcnt lgkmcnt(2)
  v_max3_f32 v58, |v54|, |v55|, v58
  v_cvt_pk_f16_f32 v195, v54, v55
  s_waitcnt lgkmcnt(0)
  v_max3_f32 v58, |v56|, |v57|, v58
  v_cvt_pk_f16_f32 v196, v56, v57
  s_waitcnt lgkmcnt(0)
  s_barrier
  s_branch L_cin_go
L_g1c:
  s_waitcnt lgkmcnt(0)
  s_barrier
  s_add_u32 s76, s76, -63168
  s_waitcnt vmcnt(1)
  v_lshl_add_u32 v16, v16, 7, v8
  v_lshl_add_u32 v17, v17, 7, v8
  v_lshl_add_u32 v18, v18, 7, v8
  v_lshl_add_u32 v19, v19, 7, v8
  s_add_u32 m0, s76, 0
  s_mov_b32 exec_hi, 0xffffff
  buffer_load_dwordx4 v16, s[32:35], 0 offen lds
  s_add_u32 m0, s76, 1056
  s_nop 0
  buffer_load_dwordx4 v17, s[32:35], 0 offen lds
  s_add_u32 m0, s76, 2112
  s_mov_b32 exec_hi, 0xffff
  buffer_load_dwordx4 v18, s[32:35], 0 offen lds
  s_add_u32 m0, s76, 3168
  s_nop 0
  buffer_load_dwordx4 v19, s[32:35], 0 offen lds
  s_mov_b32 exec_hi, -1
  s_waitcnt vmcnt(4)
  v_lshl_add_u32 v112, v112, 7, v8
  v_lshl_add_u32 v113, v113, 7, v8
  v_lshl_add_u32 v114, v114, 7, v8
  v_lshl_add_u32 v115, v115, 7, v8
  s_add_u32 m0, s76, 16256
  s_mov_b32 exec_hi, 0xffffff
  buffer_load_dwordx4 v112, s[32:35], 0 offen lds
  s_add_u32 m0, s76, 17312
  s_nop 0
  buffer_load_dwordx4 v113, s[32:35], 0 offen lds
  s_add_u32 m0, s76, 18368
  s_mov_b32 exec_hi, 0xffff
  buffer_load_dwordx4 v114, s[32:35], 0 offen lds
  s_add_u32 m0, s76, 19424
  s_nop 0
  buffer_load_dwordx4 v115, s[32:35], 0 offen lds
  s_mov_b32 exec_hi, -1
  buffer_load_dwordx4 v[16:19], v6, s[28:31], s94 offen
  s_add_u32 s94, s94, 416
  v_add_u32 v10, -63168, v10
  v_add_u32 v4, -63168, v4
  v_add_u32 v5, -63168, v5
  ds_write_b32 v10, v7 offset:2880
  ds_write_b32 v10, v7 offset:19136
L_g1d:
  s_waitcnt vmcnt(5)
  ds_read_u16_d16_hi v32, v10 offset:0
  ds_read_u16_d16_hi v33, v10 offset:2
  ds_read_u16_d16_hi v34, v10 offset:2112
  ds_read_u16_d16_hi v35, v10 offset:2114
  ds_read_u16_d16_hi v36, v10 offset:128
  ds_read_u16_d16_hi v37, v10 offset:130
  ds_read_u16_d16_hi v38, v10 offset:2240
  ds_read_u16_d16_hi v39, v10 offset:2242
  ds_read_u16_d16_hi v40, v10 offset:256
  ds_read_u16_d16_hi v41, v10 offset:258
  ds_read_u16_d16_hi v42, v10 offset:2368
  ds_read_u16_d16_hi v43, v10 offset:2370
  ds_read_u16_d16_hi v44, v10 offset:384
  ds_read_u16_d16_hi v45, v10 offset:386
  ds_read_u16_d16_hi v46, v10 offset:2496
  ds_read_u16_d16_hi v47, v10 offset:2498
  ds_read_u16_d16_hi v48, v10 offset:512
  ds_read_u16_d16_hi v49, v10 offset:514
  ds_read_u16_d16_hi v50, v10 offset:2624
  ds_read_u16_d16_hi v51, v10 offset:2626
  ds_read_u16_d16_hi v52, v10 offset:640
  ds_read_u16_d16_hi v53, v10 offset:642
  ds_read_u16_d16_hi v54, v10 offset:2752
  ds_read_u16_d16_hi v55, v10 offset:2754
  ds_read_u16_d16_hi v56, v10 offset:768
  ds_read_u16_d16_hi v57, v10 offset:770
  s_waitcnt lgkmcnt(14)
  v_max3_f32 v58, |v32|, |v33|, 0
  v_cvt_pk_f16_f32 v184, v32, v33
  v_max3_f32 v58, |v34|, |v35|, v58
  v_cvt_pk_f16_f32 v185, v34, v35
  v_max3_f32 v58, |v36|, |v37|, v58
  v_cvt_pk_f16_f32 v186, v36, v37
  v_max3_f32 v58, |v38|, |v39|, v58
  v_cvt_pk_f16_f32 v187, v38, v39
  v_max3_f32 v58, |v40|, |v41|, v58
  v_cvt_pk_f16_f32 v188, v40, v41
  v_max3_f32 v58, |v42|, |v43|, v58
  v_cvt_pk_f16_f32 v189, v42, v43
  s_waitcnt lgkmcnt(12)
  v_max3_f32 v58, |v44|, |v45|, v58
  v_cvt_pk_f16_f32 v190, v44, v45
  s_waitcnt lgkmcnt(10)
  v_max3_f32 v58, |v46|, |v47|, v58
  v_cvt_pk_f16_f32 v191, v46, v47
  s_waitcnt lgkmcnt(8)
  v_max3_f32 v58, |v48|, |v49|, v58
  v_cvt_pk_f16_f32 v192, v48, v49
  s_waitcnt lgkmcnt(6)
  v_max3_f32 v58, |v50|, |v51|, v58
  v_cvt_pk_f16_f32 v193, v50, v51
  s_waitcnt lgkmcnt(4)
  v_max3_f32 v58, |v52|, |v53|, v58
  v_cvt_pk_f16_f32 v194, v52, v53
  s_waitcnt lgkmcnt(2)
  v_max3_f32 v58, |v54|, |v55|, v58
  v_cvt_pk_f16_f32 v195, v54, v55
  s_waitcnt lgkmcnt(0)
  v_max3_f32 v58, |v56|, |v57|, v58
  v_cvt_pk_f16_f32 v196, v56, v57
L_cin_go:
  ds_write_b32 v11, v184 offset:0
  ds_write_b32 v11, v185 offset:160
  ds_write_b32 v11, v186 offset:320
  ds_write_b32 v11, v187 offset:480
  ds_write_b32 v11, v188 offset:640
  ds_write_b32 v11, v189 offset:800
  ds_write_b32 v11, v190 offset:960
  ds_write_b32 v11, v191 offset:1120
  ds_write_b32 v11, v192 offset:1280
  ds_write_b32 v11, v193 offset:1440
  ds_write_b32 v11, v194 offset:1600
  ds_write_b32 v11, v195 offset:1760
  ds_write_b32 v11, v196 offset:1920
  s_mov_b32 s81, 16256
  s_add_u32 s76, s76, 16256
  v_lshlrev_b32 v7, 2, v0
  v_add_u32 v7, s98, v7
L_cin_loop:
  v_cmp_le_f32 s[90:91], s97, v58
  v_cmp_le_f32 vcc, s96, v58
  s_mov_b32 s49, s74
  s_mov_b32 s50, s75
  s_cmp_lg_u64 s[90:91], 0
  s_cbranch_scc1 L_cslow
  s_cbranch_vccz L_cslow
L_cconv:
  s_cmp_lg_u32 s51, 0
  s_cbranch_scc1 L_first
  ds_read_b64_tr_b16 v[60:61], v20 offset:0
  v_mul_f32 v116, v184, v192
  v_mul_f32 v117, v185, v193
  ds_read_b64_tr_b16 v[74:75], v20 offset:32
  v_mul_f32 v118, v186, v194
  ds_read_b64_tr_b16 v[88:89], v20 offset:64
  v_mul_f32 v119, v187, v195
  ds_read_b64_tr_b16 v[102:103], v20 offset:96
  v_fmac_f32_e64 v116, v188, v191
  ds_read_b64_tr_b16 v[66:67], v23 offset:0
  v_fmac_f32 v117, v200, v208
  ds_read_b64_tr_b16 v[80:81], v23 offset:32
  v_fmac_f32 v118, v201, v209
  ds_read_b64_tr_b16 v[94:95], v23 offset:64
  v_fmac_f32 v119, v202, v210
  ds_read_b64_tr_b16 v[108:109], v23 offset:96
  v_fmac_f32 v116, v203, v211
  ds_read_b64_tr_b16 v[68:69], v24 offset:0
  v_fmac_f32_e64 v117, v204, v207
  ds_read_b64_tr_b16 v[82:83], v24 offset:32
  v_fmac_f32 v118, v216, v224
  ds_read_b64_tr_b16 v[96:97], v24 offset:64
  v_fmac_f32 v119, v217, v225
  ds_read_b64_tr_b16 v[110:111], v24 offset:96
  v_fmac_f32 v116, v218, v226
  ds_read_b64_tr_b16 v[124:125], v4 offset:0
  v_fmac_f32 v117, v219, v227
  ds_read_b64_tr_b16 v[126:127], v5 offset:0
  v_fmac_f32 v118, v220, v223
  v_fmac_f32 v119, v232, v240
  ds_read_b64_tr_b16 v[136:137], v4 offset:32
  v_fmac_f32 v116, v233, v241
  ds_read_b64_tr_b16 v[138:139], v5 offset:32
  v_fmac_f32 v117, v234, v242
  ds_read_b64_tr_b16 v[148:149], v4 offset:64
  v_fmac_f32 v118, v235, v243
  ds_read_b64_tr_b16 v[150:151], v5 offset:64
  v_fmac_f32 v119, v236, v239
  ds_read_b64_tr_b16 v[160:161], v4 offset:96
  v_fmac_f32_e64 v116, v189, v196
  ds_read_b64_tr_b16 v[162:163], v5 offset:96
  v_fmac_f32 v117, v189, v197
  ds_read_b128 v[164:167], v1 offset:39936
  v_fmac_f32 v118, v190, v198
  ds_read_b128 v[168:171], v1 offset:40960
  v_fmac_f32 v119, v190, v199
  ds_read_b128 v[172:175], v1 offset:8192
  v_fmac_f32 v116, v205, v212
  ds_read_b128 v[176:179], v1 offset:6144
  v_fmac_f32_e64 v117, v205, v213
  ds_read_b64_tr_b16 v[70:71], v25 offset:0
  v_fmac_f32 v118, v206, v214
  ds_read_b64_tr_b16 v[84:85], v25 offset:32
  v_fmac_f32 v119, v206, v215
  ds_read_b64_tr_b16 v[98:99], v25 offset:64
  v_fmac_f32 v116, v221, v228
  v_fmac_f32 v117, v221, v229
  ds_read_b64_tr_b16 v[112:113], v25 offset:96
  v_fmac_f32 v118, v222, v230
  ds_read_b64_tr_b16 v[72:73], v26 offset:0
  v_fmac_f32 v119, v222, v231
  ds_read_b64_tr_b16 v[86:87], v26 offset:32
  v_fmac_f32 v116, v237, v244
  ds_read_b64_tr_b16 v[100:101], v26 offset:64
  v_fmac_f32 v117, v237, v245
  ds_read_b64_tr_b16 v[114:115], v26 offset:96
  v_fmac_f32 v118, v238, v246
  ds_read_b64_tr_b16 v[62:63], v21 offset:0
  v_fmac_f32 v119, v238, v247
  ds_read_b64_tr_b16 v[76:77], v21 offset:32
  v_add_f32_e64 v116, v116, v117
  ds_read_b64_tr_b16 v[90:91], v21 offset:64
  v_add_f32 v118, v118, v119
  ds_read_b64_tr_b16 v[104:105], v21 offset:96
  v_add_f32 v116, v116, v118
  ds_read_b64_tr_b16 v[64:65], v22 offset:0
  v_mul_f32 v116, s49, v116
  ds_read_b64_tr_b16 v[78:79], v22 offset:32
  v_mul_f32 v116, s50, v116
  ds_read_b64_tr_b16 v[92:93], v22 offset:64
  ds_write_b32 v7, v116
  ds_read_b64_tr_b16 v[106:107], v22 offset:96
  v_add_u32 v7, 256, v7
  s_waitcnt lgkmcnt(14)
  v_pk_mul_f16 v120, v60, v67 op_sel:[0,0] op_sel_hi:[0,1]
  v_pk_mul_f16 v121, v60, v67 op_sel:[1,0] op_sel_hi:[1,1]
  v_pk_mul_f16 v122, v60, v68 op_sel:[0,0] op_sel_hi:[0,1]
  v_pk_mul_f16 v123, v60, v68 op_sel:[1,0] op_sel_hi:[1,1]
  v_pk_mul_f16 v132, v74, v81 op_sel:[0,0] op_sel_hi:[0,1]
  v_pk_mul_f16 v133, v74, v81 op_sel:[1,0] op_sel_hi:[1,1]
  v_pk_mul_f16 v134, v74, v82 op_sel:[0,0] op_sel_hi:[0,1]
  v_pk_mul_f16 v135, v74, v82 op_sel:[1,0] op_sel_hi:[1,1]
  v_pk_mul_f16 v144, v88, v95 op_sel:[0,0] op_sel_hi:[0,1]
  v_pk_mul_f16 v145, v88, v95 op_sel:[1,0] op_sel_hi:[1,1]
  v_pk_mul_f16 v146, v88, v96 op_sel:[0,0] op_sel_hi:[0,1]
  v_pk_mul_f16 v147, v88, v96 op_sel:[1,0] op_sel_hi:[1,1]
  v_pk_mul_f16 v156, v102, v109 op_sel:[0,0] op_sel_hi:[0,1]
  v_pk_mul_f16 v157, v102, v109 op_sel:[1,0] op_sel_hi:[1,1]
  v_pk_mul_f16 v158, v102, v110 op_sel:[0,0] op_sel_hi:[0,1]
  v_pk_mul_f16 v159, v102, v110 op_sel:[1,0] op_sel_hi:[1,1]
  s_waitcnt vmcnt(0)
  v_lshl_add_u32 v16, v16, 7, v8
  v_lshl_add_u32 v17, v17, 7, v8
  v_lshl_add_u32 v18, v18, 7, v8
  v_lshl_add_u32 v19, v19, 7, v8
  s_add_u32 m0, s76, 0
  s_mov_b32 exec_hi, 0xffffff
  buffer_load_dwordx4 v16, s[32:35], 0 offen lds
  s_add_u32 m0, s76, 1056
  s_nop 0
  buffer_load_dwordx4 v17, s[32:35], 0 offen lds
  s_add_u32 m0, s76, 2112
  s_mov_b32 exec_hi, 0xffff
  buffer_load_dwordx4 v18, s[32:35], 0 offen lds
  s_add_u32 m0, s76, 3168
  s_nop 0
  buffer_load_dwordx4 v19, s[32:35], 0 offen lds
  s_mov_b32 exec_hi, -1
  buffer_load_dwordx4 v[16:19], v6, s[28:31], s94 offen
  s_add_u32 s94, s94, 416
L_novm:
  v_add_u32 v10, s81, v10
  v_add_u32 v4, s81, v4
  v_add_u32 v5, s81, v5
  s_sub_u32 s76, s76, s81
  s_sub_u32 s81, 0, s81
  s_mov_b32 s51, 0
  s_waitcnt lgkmcnt(14)
  s_cmp_eq_u32 s84, 0
  s_cbranch_scc1 L_np1
  s_setprio 1
L_np1:
  v_mfma_f32_16x16x32_bf16 v[184:187], v[164:167], v[124:127], 0
  ds_read_b128 v[180:183], v1 offset:7168
  v_pk_mul_f16 v116, v60, v69 op_sel:[0,0] op_sel_hi:[0,1]
  v_mfma_f32_16x16x32_bf16 v[200:203], v[164:167], v[136:139], 0
  v_pk_mul_f16 v117, v60, v69 op_sel:[1,0] op_sel_hi:[1,1]
  v_mfma_f32_16x16x32_bf16 v[216:219], v[164:167], v[148:151], 0
  v_pk_mul_f16 v118, v60, v70 op_sel:[0,0] op_sel_hi:[0,1]
  v_mfma_f32_16x16x32_bf16 v[232:235], v[164:167], v[160:163], 0
  v_pk_mul_f16 v119, v60, v70 op_sel:[1,0] op_sel_hi:[1,1]
  v_mfma_f32_16x16x32_bf16 v[236:239], v[168:171], v[160:163], 0
  ds_read_b128 v[164:167], v1 offset:5120
  v_pk_mul_f16 v128, v74, v83 op_sel:[0,0] op_sel_hi:[0,1]
  v_mfma_f32_16x16x32_bf16 v[220:223], v[168:171], v[148:151], 0
  v_pk_mul_f16 v129, v74, v83 op_sel:[1,0] op_sel_hi:[1,1]
  v_mfma_f32_16x16x32_bf16 v[204:207], v[168:171], v[136:139], 0
  v_pk_mul_f16 v130, v74, v84 op_sel:[0,0] op_sel_hi:[0,1]
  v_mfma_f32_16x16x32_bf16 v[188:191], v[168:171], v[124:127], 0
  v_pk_mul_f16 v131, v74, v84 op_sel:[1,0] op_sel_hi:[1,1]
  v_mfma_f32_16x16x32_f16 v[192:195], v[172:175], v[120:123], 0
  ds_read_b128 v[168:171], v1 offset:11264
  v_pk_mul_f16 v140, v88, v97 op_sel:[0,0] op_sel_hi:[0,1]
  v_mfma_f32_16x16x32_f16 v[208:211], v[172:175], v[132:135], 0
  v_pk_mul_f16 v141, v88, v97 op_sel:[1,0] op_sel_hi:[1,1]
  v_mfma_f32_16x16x32_f16 v[224:227], v[172:175], v[144:147], 0
  s_waitcnt lgkmcnt(14)
  v_pk_mul_f16 v142, v88, v98 op_sel:[0,0] op_sel_hi:[0,1]
  v_mfma_f32_16x16x32_f16 v[240:243], v[172:175], v[156:159], 0
  v_pk_mul_f16 v143, v88, v98 op_sel:[1,0] op_sel_hi:[1,1]
  v_mfma_f32_16x16x32_f16 v[232:235], v[176:179], v[156:159], v[232:235]
  ds_read_b128 v[172:175], v1 offset:9216
  v_pk_mul_f16 v152, v102, v111 op_sel:[0,0] op_sel_hi:[0,1]
  v_mfma_f32_16x16x32_f16 v[216:219], v[176:179], v[144:147], v[216:219]
  v_pk_mul_f16 v153, v102, v111 op_sel:[1,0] op_sel_hi:[1,1]
  v_mfma_f32_16x16x32_f16 v[200:203], v[176:179], v[132:135], v[200:203]
  s_waitcnt lgkmcnt(14)
  v_pk_mul_f16 v154, v102, v112 op_sel:[0,0] op_sel_hi:[0,1]
  v_mfma_f32_16x16x32_f16 v[184:187], v[176:179], v[120:123], v[184:187]
  s_waitcnt lgkmcnt(3)
  v_pk_mul_f16 v155, v102, v112 op_sel:[1,0] op_sel_hi:[1,1]
  v_mfma_f32_16x16x32_f16 v[188:191], v[180:183], v[120:123], v[188:191]
  ds_read_b128 v[176:179], v1 offset:10240
  v_pk_mul_f16 v124, v61, v68 op_sel:[0,0] op_sel_hi:[0,1]
  v_mfma_f32_16x16x32_f16 v[204:207], v[180:183], v[132:135], v[204:207]
  v_pk_mul_f16 v125, v61, v68 op_sel:[1,0] op_sel_hi:[1,1]
  v_mfma_f32_16x16x32_f16 v[220:223], v[180:183], v[144:147], v[220:223]
  v_pk_mul_f16 v126, v61, v69 op_sel:[0,0] op_sel_hi:[0,1]
  v_mfma_f32_16x16x32_f16 v[236:239], v[180:183], v[156:159], v[236:239]
  s_waitcnt lgkmcnt(3)
  v_pk_mul_f16 v127, v61, v69 op_sel:[1,0] op_sel_hi:[1,1]
  v_mfma_f32_16x16x32_f16 v[196:199], v[164:167], v[120:123], 0
  ds_read_b128 v[180:183], v1 offset:14336
  v_pk_mul_f16 v136, v75, v82 op_sel:[0,0] op_sel_hi:[0,1]
  v_mfma_f32_16x16x32_f16 v[212:215], v[164:167], v[132:135], 0
  v_pk_mul_f16 v120, v60, v71 op_sel:[0,0] op_sel_hi:[0,1]
  v_mfma_f32_16x16x32_f16 v[228:231], v[164:167], v[144:147], 0
  v_pk_mul_f16 v121, v60, v71 op_sel:[1,0] op_sel_hi:[1,1]
  v_mfma_f32_16x16x32_f16 v[244:247], v[164:167], v[156:159], 0
  s_waitcnt lgkmcnt(3)
  v_pk_mul_f16 v122, v60, v66 op_sel:[0,1] op_sel_hi:[0,0]
  v_mfma_f32_16x16x32_f16 v[192:195], v[168:171], v[116:119], v[192:195]
  ds_read_b128 v[164:167], v1 offset:12288
  v_pk_mul_f16 v123, v60, v72 op_sel:[0,0] op_sel_hi:[1,0]
  v_mfma_f32_16x16x32_f16 v[208:211], v[168:171], v[128:131], v[208:211]
  v_pk_mul_f16 v132, v74, v85 op_sel:[0,0] op_sel_hi:[0,1]
  v_mfma_f32_16x16x32_f16 v[224:227], v[168:171], v[140:143], v[224:227]
  v_pk_mul_f16 v133, v74, v85 op_sel:[1,0] op_sel_hi:[1,1]
  v_mfma_f32_16x16x32_f16 v[240:243], v[168:171], v[152:155], v[240:243]
  s_waitcnt lgkmcnt(3)
  v_pk_mul_f16 v134, v74, v80 op_sel:[0,1] op_sel_hi:[0,0]
  v_mfma_f32_16x16x32_f16 v[232:235], v[172:175], v[152:155], v[232:235]
  ds_read_b128 v[168:171], v1 offset:13312
  v_pk_mul_f16 v135, v74, v86 op_sel:[0,0] op_sel_hi:[1,0]
  v_mfma_f32_16x16x32_f16 v[216:219], v[172:175], v[140:143], v[216:219]
  v_pk_mul_f16 v144, v88, v99 op_sel:[0,0] op_sel_hi:[0,1]
  v_mfma_f32_16x16x32_f16 v[200:203], v[172:175], v[128:131], v[200:203]
  s_setprio 2
  v_pk_mul_f16 v145, v88, v99 op_sel:[1,0] op_sel_hi:[1,1]
  v_mfma_f32_16x16x32_f16 v[184:187], v[172:175], v[116:119], v[184:187]
  s_waitcnt lgkmcnt(3)
  v_pk_mul_f16 v146, v88, v94 op_sel:[0,1] op_sel_hi:[0,0]
  v_mfma_f32_16x16x32_f16 v[188:191], v[176:179], v[116:119], v[188:191]
  ds_read_b128 v[172:175], v1 offset:0
  v_pk_mul_f16 v147, v88, v100 op_sel:[0,0] op_sel_hi:[1,0]
  v_mfma_f32_16x16x32_f16 v[204:207], v[176:179], v[128:131], v[204:207]
  v_pk_mul_f16 v156, v102, v113 op_sel:[0,0] op_sel_hi:[0,1]
  v_mfma_f32_16x16x32_f16 v[220:223], v[176:179], v[140:143], v[220:223]
  v_pk_mul_f16 v157, v102, v113 op_sel:[1,0] op_sel_hi:[1,1]
  v_mfma_f32_16x16x32_f16 v[236:239], v[176:179], v[152:155], v[236:239]
  s_waitcnt lgkmcnt(3)
  v_pk_mul_f16 v158, v102, v108 op_sel:[0,1] op_sel_hi:[0,0]
  v_mfma_f32_16x16x32_f16 v[192:195], v[180:183], v[120:123], v[192:195]
  ds_read_b128 v[176:179], v1 offset:17408
  v_pk_mul_f16 v159, v102, v114 op_sel:[0,0] op_sel_hi:[1,0]
  v_mfma_f32_16x16x32_f16 v[208:211], v[180:183], v[132:135], v[208:211]
  v_pk_mul_f16 v137, v75, v82 op_sel:[1,0] op_sel_hi:[1,1]
  v_mfma_f32_16x16x32_f16 v[224:227], v[180:183], v[144:147], v[224:227]
  v_pk_mul_f16 v138, v75, v83 op_sel:[0,0] op_sel_hi:[0,1]
  v_mfma_f32_16x16x32_f16 v[240:243], v[180:183], v[156:159], v[240:243]
  s_waitcnt lgkmcnt(3)
  v_pk_mul_f16 v139, v75, v83 op_sel:[1,0] op_sel_hi:[1,1]
  v_mfma_f32_16x16x32_f16 v[232:235], v[164:167], v[156:159], v[232:235]
  ds_read_b128 v[180:183], v1 offset:15360
  v_pk_mul_f16 v148, v89, v96 op_sel:[0,0] op_sel_hi:[0,1]
  v_mfma_f32_16x16x32_f16 v[216:219], v[164:167], v[144:147], v[216:219]
  v_pk_mul_f16 v149, v89, v96 op_sel:[1,0] op_sel_hi:[1,1]
  v_mfma_f32_16x16x32_f16 v[200:203], v[164:167], v[132:135], v[200:203]
  v_pk_mul_f16 v150, v89, v97 op_sel:[0,0] op_sel_hi:[0,1]
  v_mfma_f32_16x16x32_f16 v[184:187], v[164:167], v[120:123], v[184:187]
  s_waitcnt lgkmcnt(3)
  v_pk_mul_f16 v151, v89, v97 op_sel:[1,0] op_sel_hi:[1,1]
  v_mfma_f32_16x16x32_f16 v[188:191], v[168:171], v[120:123], v[188:191]
  ds_read_b128 v[164:167], v1 offset:16384
  v_pk_mul_f16 v160, v103, v110 op_sel:[0,0] op_sel_hi:[0,1]
  v_mfma_f32_16x16x32_f16 v[204:207], v[168:171], v[132:135], v[204:207]
  v_pk_mul_f16 v161, v103, v110 op_sel:[1,0] op_sel_hi:[1,1]
  v_mfma_f32_16x16x32_f16 v[220:223], v[168:171], v[144:147], v[220:223]
  v_pk_mul_f16 v162, v103, v111 op_sel:[0,0] op_sel_hi:[0,1]
  v_mfma_f32_16x16x32_f16 v[236:239], v[168:171], v[156:159], v[236:239]
  s_waitcnt lgkmcnt(3)
  v_pk_mul_f16 v163, v103, v111 op_sel:[1,0] op_sel_hi:[1,1]
  v_smfmac_f32_16x16x64_f16 v[196:199], v[172:175], v[116:123], v9
  ds_read_b128 v[168:171], v1 offset:20480
  v_smfmac_f32_16x16x64_f16 v[212:215], v[172:175], v[128:135], v9
  v_pk_mul_f16 v120, v61, v70 op_sel:[0,0] op_sel_hi:[0,1]
  v_smfmac_f32_16x16x64_f16 v[228:231], v[172:175], v[140:147], v9
  v_pk_mul_f16 v121, v61, v70 op_sel:[1,0] op_sel_hi:[1,1]
  v_smfmac_f32_16x16x64_f16 v[244:247], v[172:175], v[152:159], v9
  s_waitcnt lgkmcnt(3)
  v_pk_mul_f16 v122, v61, v71 op_sel:[0,0] op_sel_hi:[0,1]
  v_mfma_f32_16x16x32_f16 v[192:195], v[176:179], v[124:127], v[192:195]
  ds_read_b128 v[172:175], v1 offset:18432
  v_pk_mul_f16 v123, v61, v71 op_sel:[1,0] op_sel_hi:[1,1]
  v_mfma_f32_16x16x32_f16 v[208:211], v[176:179], v[136:139], v[208:211]
  v_pk_mul_f16 v132, v75, v84 op_sel:[0,0] op_sel_hi:[0,1]
  v_mfma_f32_16x16x32_f16 v[224:227], v[176:179], v[148:151], v[224:227]
  v_pk_mul_f16 v133, v75, v84 op_sel:[1,0] op_sel_hi:[1,1]
  v_mfma_f32_16x16x32_f16 v[240:243], v[176:179], v[160:163], v[240:243]
  s_waitcnt lgkmcnt(3)
  v_pk_mul_f16 v134, v75, v85 op_sel:[0,0] op_sel_hi:[0,1]
  v_mfma_f32_16x16x32_f16 v[232:235], v[180:183], v[160:163], v[232:235]
  ds_read_b128 v[176:179], v1 offset:19456
  v_pk_mul_f16 v135, v75, v85 op_sel:[1,0] op_sel_hi:[1,1]
  v_mfma_f32_16x16x32_f16 v[216:219], v[180:183], v[148:151], v[216:219]
  v_pk_mul_f16 v144, v89, v98 op_sel:[0,0] op_sel_hi:[0,1]
  v_mfma_f32_16x16x32_f16 v[200:203], v[180:183], v[136:139], v[200:203]
  v_pk_mul_f16 v145, v89, v98 op_sel:[1,0] op_sel_hi:[1,1]
  v_mfma_f32_16x16x32_f16 v[184:187], v[180:183], v[124:127], v[184:187]
  s_waitcnt lgkmcnt(3)
  v_pk_mul_f16 v146, v89, v99 op_sel:[0,0] op_sel_hi:[0,1]
  v_mfma_f32_16x16x32_f16 v[188:191], v[164:167], v[124:127], v[188:191]
  ds_read_b128 v[180:183], v1 offset:1024
  v_pk_mul_f16 v147, v89, v99 op_sel:[1,0] op_sel_hi:[1,1]
  v_mfma_f32_16x16x32_f16 v[204:207], v[164:167], v[136:139], v[204:207]
  s_waitcnt vmcnt(0)
  ds_read_u16_d16_hi v32, v10 offset:0
  v_pk_mul_f16 v156, v103, v112 op_sel:[0,0] op_sel_hi:[0,1]
  v_mfma_f32_16x16x32_f16 v[220:223], v[164:167], v[148:151], v[220:223]
  ds_read_u16_d16_hi v33, v10 offset:2
  v_pk_mul_f16 v157, v103, v112 op_sel:[1,0] op_sel_hi:[1,1]
  v_mfma_f32_16x16x32_f16 v[236:239], v[164:167], v[160:163], v[236:239]
  s_waitcnt lgkmcnt(5)
  v_pk_mul_f16 v158, v103, v113 op_sel:[0,0] op_sel_hi:[0,1]
  v_mfma_f32_16x16x32_f16 v[192:195], v[168:171], v[120:123], v[192:195]
  ds_read_b128 v[164:167], v1 offset:23552
  v_pk_mul_f16 v159, v103, v113 op_sel:[1,0] op_sel_hi:[1,1]
  v_mfma_f32_16x16x32_f16 v[208:211], v[168:171], v[132:135], v[208:211]
  ds_read_u16_d16_hi v34, v10 offset:2112
  v_pk_mul_f16 v116, v61, v67 op_sel:[0,1] op_sel_hi:[0,0]
  v_mfma_f32_16x16x32_f16 v[224:227], v[168:171], v[144:147], v[224:227]
  ds_read_u16_d16_hi v35, v10 offset:2114
  v_pk_mul_f16 v117, v61, v72 op_sel:[0,0] op_sel_hi:[1,0]
  v_mfma_f32_16x16x32_f16 v[240:243], v[168:171], v[156:159], v[240:243]
  s_waitcnt lgkmcnt(7)
  v_pk_mul_f16 v118, v62, v69 op_sel:[0,0] op_sel_hi:[0,1]
  v_mfma_f32_16x16x32_f16 v[232:235], v[172:175], v[156:159], v[232:235]
  ds_read_b128 v[168:171], v1 offset:21504
  v_pk_mul_f16 v119, v62, v69 op_sel:[1,0] op_sel_hi:[1,1]
  v_mfma_f32_16x16x32_f16 v[216:219], v[172:175], v[144:147], v[216:219]
  ds_read_b64_tr_b16 v[60:61], v27 offset:0
  v_pk_mul_f16 v128, v75, v81 op_sel:[0,1] op_sel_hi:[0,0]
  v_mfma_f32_16x16x32_f16 v[200:203], v[172:175], v[132:135], v[200:203]
  ds_read_u16_d16_hi v36, v10 offset:128
  v_pk_mul_f16 v129, v75, v86 op_sel:[0,0] op_sel_hi:[1,0]
  v_mfma_f32_16x16x32_f16 v[184:187], v[172:175], v[120:123], v[184:187]
  s_waitcnt lgkmcnt(9)
  v_pk_mul_f16 v130, v76, v83 op_sel:[0,0] op_sel_hi:[0,1]
  v_pk_mul_f16 v131, v76, v83 op_sel:[1,0] op_sel_hi:[1,1]
  v_mfma_f32_16x16x32_f16 v[188:191], v[176:179], v[120:123], v[188:191]
  ds_read_b128 v[172:175], v1 offset:22528
  v_pk_mul_f16 v140, v89, v95 op_sel:[0,1] op_sel_hi:[0,0]
  v_mfma_f32_16x16x32_f16 v[204:207], v[176:179], v[132:135], v[204:207]
  ds_read_b64_tr_b16 v[74:75], v27 offset:32
  v_pk_mul_f16 v141, v89, v100 op_sel:[0,0] op_sel_hi:[1,0]
  v_mfma_f32_16x16x32_f16 v[220:223], v[176:179], v[144:147], v[220:223]
  ds_read_b64_tr_b16 v[88:89], v27 offset:64
  v_pk_mul_f16 v142, v90, v97 op_sel:[0,0] op_sel_hi:[0,1]
  v_mfma_f32_16x16x32_f16 v[236:239], v[176:179], v[156:159], v[236:239]
  s_waitcnt lgkmcnt(11)
  v_pk_mul_f16 v143, v90, v97 op_sel:[1,0] op_sel_hi:[1,1]
  v_pk_mul_f16 v152, v103, v109 op_sel:[0,1] op_sel_hi:[0,0]
  v_smfmac_f32_16x16x64_f16 v[196:199], v[180:183], v[120:127], v9
  ds_read_b128 v[176:179], v1 offset:26624
  v_pk_mul_f16 v153, v103, v114 op_sel:[0,0] op_sel_hi:[1,0]
  v_smfmac_f32_16x16x64_f16 v[212:215], v[180:183], v[132:139], v9
  ds_read_b64_tr_b16 v[102:103], v27 offset:96
  v_pk_mul_f16 v154, v104, v111 op_sel:[0,0] op_sel_hi:[0,1]
  v_smfmac_f32_16x16x64_f16 v[228:231], v[180:183], v[144:151], v9
  ds_read_u16_d16_hi v37, v10 offset:130
  v_pk_mul_f16 v155, v104, v111 op_sel:[1,0] op_sel_hi:[1,1]
  v_smfmac_f32_16x16x64_f16 v[244:247], v[180:183], v[156:163], v9
  s_waitcnt lgkmcnt(11)
  v_pk_mul_f16 v120, v62, v70 op_sel:[0,0] op_sel_hi:[0,1]
  v_mfma_f32_16x16x32_f16 v[192:195], v[164:167], v[116:119], v[192:195]
  ds_read_b128 v[180:183], v1 offset:24576
  v_pk_mul_f16 v121, v62, v70 op_sel:[1,0] op_sel_hi:[1,1]
  v_mfma_f32_16x16x32_f16 v[208:211], v[164:167], v[128:131], v[208:211]
  ds_read_u16_d16_hi v38, v10 offset:2240
  v_pk_mul_f16 v122, v62, v71 op_sel:[0,0] op_sel_hi:[0,1]
  v_mfma_f32_16x16x32_f16 v[224:227], v[164:167], v[140:143], v[224:227]
  ds_read_u16_d16_hi v39, v10 offset:2242
  v_pk_mul_f16 v123, v62, v71 op_sel:[1,0] op_sel_hi:[1,1]
  v_mfma_f32_16x16x32_f16 v[240:243], v[164:167], v[152:155], v[240:243]
  s_waitcnt lgkmcnt(11)
  v_pk_mul_f16 v132, v76, v84 op_sel:[0,0] op_sel_hi:[0,1]
  v_max3_f32 v58, |v32|, |v33|, 0
  v_mfma_f32_16x16x32_f16 v[232:235], v[168:171], v[152:155], v[232:235]
  ds_read_b128 v[164:167], v1 offset:25600
  v_pk_mul_f16 v133, v76, v84 op_sel:[1,0] op_sel_hi:[1,1]
  v_mfma_f32_16x16x32_f16 v[216:219], v[168:171], v[140:143], v[216:219]
  ds_read_u16_d16_hi v40, v10 offset:256
  v_pk_mul_f16 v134, v76, v85 op_sel:[0,0] op_sel_hi:[0,1]
  v_mfma_f32_16x16x32_f16 v[200:203], v[168:171], v[128:131], v[200:203]
  ds_read_u16_d16_hi v41, v10 offset:258
  v_pk_mul_f16 v135, v76, v85 op_sel:[1,0] op_sel_hi:[1,1]
  v_mfma_f32_16x16x32_f16 v[184:187], v[168:171], v[116:119], v[184:187]
  s_waitcnt lgkmcnt(11)
  v_pk_mul_f16 v144, v90, v98 op_sel:[0,0] op_sel_hi:[0,1]
  v_max3_f32 v58, |v34|, |v35|, v58
  v_mfma_f32_16x16x32_f16 v[188:191], v[172:175], v[116:119], v[188:191]
  ds_read_b128 v[168:171], v1 offset:2048
  v_pk_mul_f16 v145, v90, v98 op_sel:[1,0] op_sel_hi:[1,1]
  v_mfma_f32_16x16x32_f16 v[204:207], v[172:175], v[128:131], v[204:207]
  ds_read_u16_d16_hi v42, v10 offset:2368
  v_pk_mul_f16 v146, v90, v99 op_sel:[0,0] op_sel_hi:[0,1]
  v_mfma_f32_16x16x32_f16 v[220:223], v[172:175], v[140:143], v[220:223]
  ds_read_u16_d16_hi v43, v10 offset:2370
  v_pk_mul_f16 v147, v90, v99 op_sel:[1,0] op_sel_hi:[1,1]
  v_mfma_f32_16x16x32_f16 v[236:239], v[172:175], v[152:155], v[236:239]
  s_waitcnt lgkmcnt(11)
  v_pk_mul_f16 v156, v104, v112 op_sel:[0,0] op_sel_hi:[0,1]
  v_mfma_f32_16x16x32_f16 v[192:195], v[176:179], v[120:123], v[192:195]
  ds_read_b128 v[172:175], v1 offset:29696
  v_pk_mul_f16 v157, v104, v112 op_sel:[1,0] op_sel_hi:[1,1]
  v_mfma_f32_16x16x32_f16 v[208:211], v[176:179], v[132:135], v[208:211]
  ds_read_u16_d16_hi v44, v10 offset:384
  v_pk_mul_f16 v158, v104, v113 op_sel:[0,0] op_sel_hi:[0,1]
  v_mfma_f32_16x16x32_f16 v[224:227], v[176:179], v[144:147], v[224:227]
  ds_read_u16_d16_hi v45, v10 offset:386
  v_pk_mul_f16 v159, v104, v113 op_sel:[1,0] op_sel_hi:[1,1]
  s_nop 1
  v_mfma_f32_16x16x32_f16 v[240:243], v[176:179], v[156:159], v[240:243]
  s_waitcnt lgkmcnt(11)
  v_pk_mul_f16 v124, v62, v68 op_sel:[0,1] op_sel_hi:[0,0]
  v_mfma_f32_16x16x32_f16 v[232:235], v[180:183], v[156:159], v[232:235]
  ds_read_b128 v[176:179], v1 offset:27648
  v_pk_mul_f16 v125, v62, v72 op_sel:[0,0] op_sel_hi:[1,0]
  v_mfma_f32_16x16x32_f16 v[216:219], v[180:183], v[144:147], v[216:219]
  ds_read_u16_d16_hi v46, v10 offset:2496
  v_pk_mul_f16 v126, v63, v70 op_sel:[0,0] op_sel_hi:[0,1]
  v_mfma_f32_16x16x32_f16 v[200:203], v[180:183], v[132:135], v[200:203]
  ds_read_u16_d16_hi v47, v10 offset:2498
  v_pk_mul_f16 v127, v63, v70 op_sel:[1,0] op_sel_hi:[1,1]
  v_mfma_f32_16x16x32_f16 v[184:187], v[180:183], v[120:123], v[184:187]
  s_waitcnt lgkmcnt(11)
  v_pk_mul_f16 v136, v76, v82 op_sel:[0,1] op_sel_hi:[0,0]
  v_pk_mul_f16 v137, v76, v86 op_sel:[0,0] op_sel_hi:[1,0]
  v_mfma_f32_16x16x32_f16 v[188:191], v[164:167], v[120:123], v[188:191]
  ds_read_b128 v[180:183], v1 offset:28672
  v_pk_mul_f16 v138, v77, v84 op_sel:[0,0] op_sel_hi:[0,1]
  v_mfma_f32_16x16x32_f16 v[204:207], v[164:167], v[132:135], v[204:207]
  ds_read_u16_d16_hi v48, v10 offset:512
  v_pk_mul_f16 v139, v77, v84 op_sel:[1,0] op_sel_hi:[1,1]
  v_mfma_f32_16x16x32_f16 v[220:223], v[164:167], v[144:147], v[220:223]
  ds_read_u16_d16_hi v49, v10 offset:514
  v_pk_mul_f16 v148, v90, v96 op_sel:[0,1] op_sel_hi:[0,0]
  v_mfma_f32_16x16x32_f16 v[236:239], v[164:167], v[156:159], v[236:239]
  s_waitcnt lgkmcnt(11)
  v_pk_mul_f16 v149, v90, v100 op_sel:[0,0] op_sel_hi:[1,0]
  v_pk_mul_f16 v150, v91, v98 op_sel:[0,0] op_sel_hi:[0,1]
  v_smfmac_f32_16x16x64_f16 v[196:199], v[168:171], v[116:123], v9
  ds_read_b128 v[164:167], v1 offset:32768
  v_pk_mul_f16 v151, v91, v98 op_sel:[1,0] op_sel_hi:[1,1]
  v_smfmac_f32_16x16x64_f16 v[212:215], v[168:171], v[128:135], v9
  ds_read_u16_d16_hi v50, v10 offset:2624
  v_pk_mul_f16 v160, v104, v110 op_sel:[0,1] op_sel_hi:[0,0]
  v_smfmac_f32_16x16x64_f16 v[228:231], v[168:171], v[140:147], v9
  ds_read_u16_d16_hi v51, v10 offset:2626
  v_pk_mul_f16 v161, v104, v114 op_sel:[0,0] op_sel_hi:[1,0]
  v_smfmac_f32_16x16x64_f16 v[244:247], v[168:171], v[152:159], v9
  s_waitcnt lgkmcnt(11)
  v_pk_mul_f16 v162, v105, v112 op_sel:[0,0] op_sel_hi:[0,1]
  v_mfma_f32_16x16x32_f16 v[192:195], v[172:175], v[124:127], v[192:195]
  ds_read_b128 v[168:171], v1 offset:30720
  v_pk_mul_f16 v163, v105, v112 op_sel:[1,0] op_sel_hi:[1,1]
  v_mfma_f32_16x16x32_f16 v[208:211], v[172:175], v[136:139], v[208:211]
  ds_read_u16_d16_hi v52, v10 offset:640
  v_pk_mul_f16 v120, v63, v71 op_sel:[0,0] op_sel_hi:[0,1]
  v_mfma_f32_16x16x32_f16 v[224:227], v[172:175], v[148:151], v[224:227]
  ds_read_u16_d16_hi v53, v10 offset:642
  v_pk_mul_f16 v121, v63, v71 op_sel:[1,0] op_sel_hi:[1,1]
  v_mfma_f32_16x16x32_f16 v[240:243], v[172:175], v[160:163], v[240:243]
  s_waitcnt lgkmcnt(11)
  v_pk_mul_f16 v122, v63, v69 op_sel:[0,1] op_sel_hi:[1,1]
  v_pk_mul_f16 v123, v63, v72 op_sel:[0,0] op_sel_hi:[1,0]
  v_mfma_f32_16x16x32_f16 v[232:235], v[176:179], v[160:163], v[232:235]
  ds_read_b128 v[172:175], v1 offset:31744
  v_pk_mul_f16 v132, v77, v85 op_sel:[0,0] op_sel_hi:[0,1]
  v_mfma_f32_16x16x32_f16 v[216:219], v[176:179], v[148:151], v[216:219]
  ds_read_u16_d16_hi v54, v10 offset:2752
  v_pk_mul_f16 v133, v77, v85 op_sel:[1,0] op_sel_hi:[1,1]
  v_mfma_f32_16x16x32_f16 v[200:203], v[176:179], v[136:139], v[200:203]
  ds_read_u16_d16_hi v55, v10 offset:2754
  v_pk_mul_f16 v134, v77, v83 op_sel:[0,1] op_sel_hi:[1,1]
  v_mfma_f32_16x16x32_f16 v[184:187], v[176:179], v[124:127], v[184:187]
  s_waitcnt lgkmcnt(11)
  v_pk_mul_f16 v135, v77, v86 op_sel:[0,0] op_sel_hi:[1,0]
  v_pk_mul_f16 v144, v91, v99 op_sel:[0,0] op_sel_hi:[0,1]
  v_mfma_f32_16x16x32_f16 v[188:191], v[180:183], v[124:127], v[188:191]
  ds_read_b128 v[176:179], v1 offset:3072
  v_pk_mul_f16 v145, v91, v99 op_sel:[1,0] op_sel_hi:[1,1]
  v_mfma_f32_16x16x32_f16 v[204:207], v[180:183], v[136:139], v[204:207]
  ds_read_u16_d16_hi v56, v10 offset:768
  v_pk_mul_f16 v146, v91, v97 op_sel:[0,1] op_sel_hi:[1,1]
  v_mfma_f32_16x16x32_f16 v[220:223], v[180:183], v[148:151], v[220:223]
  ds_read_u16_d16_hi v57, v10 offset:770
  v_pk_mul_f16 v147, v91, v100 op_sel:[0,0] op_sel_hi:[1,0]
  v_mfma_f32_16x16x32_f16 v[236:239], v[180:183], v[160:163], v[236:239]
  s_waitcnt lgkmcnt(11)
  v_pk_mul_f16 v156, v105, v113 op_sel:[0,0] op_sel_hi:[0,1]
  v_max3_f32 v58, |v36|, |v37|, v58
  v_mfma_f32_16x16x32_f16 v[192:195], v[164:167], v[120:123], v[192:195]
  ds_read_b128 v[180:183], v1 offset:35840
  v_pk_mul_f16 v157, v105, v113 op_sel:[1,0] op_sel_hi:[1,1]
  v_mfma_f32_16x16x32_f16 v[208:211], v[164:167], v[132:135], v[208:211]
  v_pk_mul_f16 v158, v105, v111 op_sel:[0,1] op_sel_hi:[1,1]
  v_max3_f32 v58, |v38|, |v39|, v58
  v_mfma_f32_16x16x32_f16 v[224:227], v[164:167], v[144:147], v[224:227]
  v_pk_mul_f16 v159, v105, v114 op_sel:[0,0] op_sel_hi:[1,0]
  v_max3_f32 v58, |v40|, |v41|, v58
  s_nop 0
  v_mfma_f32_16x16x32_f16 v[240:243], v[164:167], v[156:159], v[240:243]
  s_waitcnt lgkmcnt(9)
  v_pk_mul_f16 v116, v64, v71 op_sel:[0,0] op_sel_hi:[0,1]
  v_mfma_f32_16x16x32_f16 v[232:235], v[168:171], v[156:159], v[232:235]
  ds_read_b128 v[164:167], v1 offset:33792
  v_pk_mul_f16 v117, v64, v71 op_sel:[1,0] op_sel_hi:[1,1]
  v_mfma_f32_16x16x32_f16 v[216:219], v[168:171], v[144:147], v[216:219]
  v_pk_mul_f16 v118, v64, v70 op_sel:[0,1] op_sel_hi:[1,1]
  v_max3_f32 v58, |v42|, |v43|, v58
  v_mfma_f32_16x16x32_f16 v[200:203], v[168:171], v[132:135], v[200:203]
  v_pk_mul_f16 v119, v64, v72 op_sel:[0,0] op_sel_hi:[1,0]
  v_pk_mul_f16 v128, v78, v85 op_sel:[0,0] op_sel_hi:[0,1]
  v_mfma_f32_16x16x32_f16 v[184:187], v[168:171], v[120:123], v[184:187]
  s_waitcnt lgkmcnt(7)
  v_pk_mul_f16 v129, v78, v85 op_sel:[1,0] op_sel_hi:[1,1]
  v_pk_mul_f16 v130, v78, v84 op_sel:[0,1] op_sel_hi:[1,1]
  v_mfma_f32_16x16x32_f16 v[188:191], v[172:175], v[120:123], v[188:191]
  ds_read_b128 v[168:171], v1 offset:34816
  v_pk_mul_f16 v131, v78, v86 op_sel:[0,0] op_sel_hi:[1,0]
  v_mfma_f32_16x16x32_f16 v[204:207], v[172:175], v[132:135], v[204:207]
  v_pk_mul_f16 v140, v92, v99 op_sel:[0,0] op_sel_hi:[0,1]
  v_pk_mul_f16 v141, v92, v99 op_sel:[1,0] op_sel_hi:[1,1]
  v_mfma_f32_16x16x32_f16 v[220:223], v[172:175], v[144:147], v[220:223]
  v_pk_mul_f16 v142, v92, v98 op_sel:[0,1] op_sel_hi:[1,1]
  v_pk_mul_f16 v143, v92, v100 op_sel:[0,0] op_sel_hi:[1,0]
  v_mfma_f32_16x16x32_f16 v[236:239], v[172:175], v[156:159], v[236:239]
  s_waitcnt lgkmcnt(5)
  v_pk_mul_f16 v152, v106, v113 op_sel:[0,0] op_sel_hi:[0,1]
  v_smfmac_f32_16x16x64_f16 v[196:199], v[176:179], v[120:127], v9
  ds_read_b128 v[172:175], v1 offset:38912
  v_pk_mul_f16 v153, v106, v113 op_sel:[1,0] op_sel_hi:[1,1]
  v_smfmac_f32_16x16x64_f16 v[212:215], v[176:179], v[132:139], v9
  v_pk_mul_f16 v154, v106, v112 op_sel:[0,1] op_sel_hi:[1,1]
  v_smfmac_f32_16x16x64_f16 v[228:231], v[176:179], v[144:151], v9
  v_pk_mul_f16 v155, v106, v114 op_sel:[0,0] op_sel_hi:[1,0]
  v_smfmac_f32_16x16x64_f16 v[244:247], v[176:179], v[156:163], v9
  s_waitcnt lgkmcnt(3)
  v_pk_mul_f16 v120, v65, v71 op_sel:[0,1] op_sel_hi:[1,1]
  v_mfma_f32_16x16x32_f16 v[192:195], v[180:183], v[116:119], v[192:195]
  ds_read_b128 v[176:179], v1 offset:36864
  v_pk_mul_f16 v121, v65, v72 op_sel:[0,0] op_sel_hi:[1,0]
  v_mfma_f32_16x16x32_f16 v[208:211], v[180:183], v[128:131], v[208:211]
  v_pk_mul_f16 v122, v72, v72 op_sel:[0,0] op_sel_hi:[1,1]
  v_max3_f32 v58, |v44|, |v45|, v58
  v_mfma_f32_16x16x32_f16 v[224:227], v[180:183], v[140:143], v[224:227]
  v_pk_mul_f16 v123, v60, v61 op_sel:[0,0] op_sel_hi:[1,1]
  v_max3_f32 v58, |v46|, |v47|, v58
  v_mfma_f32_16x16x32_f16 v[240:243], v[180:183], v[152:155], v[240:243]
  s_waitcnt lgkmcnt(3)
  v_pk_mul_f16 v132, v79, v85 op_sel:[0,1] op_sel_hi:[1,1]
  v_mfma_f32_16x16x32_f16 v[232:235], v[164:167], v[152:155], v[232:235]
  ds_read_b128 v[180:183], v1 offset:37888
  v_pk_mul_f16 v133, v79, v86 op_sel:[0,0] op_sel_hi:[1,0]
  v_mfma_f32_16x16x32_f16 v[216:219], v[164:167], v[140:143], v[216:219]
  v_pk_mul_f16 v134, v86, v86 op_sel:[0,0] op_sel_hi:[1,1]
  v_max3_f32 v58, |v48|, |v49|, v58
  v_mfma_f32_16x16x32_f16 v[200:203], v[164:167], v[128:131], v[200:203]
  v_pk_mul_f16 v135, v74, v75 op_sel:[0,0] op_sel_hi:[1,1]
  v_max3_f32 v58, |v50|, |v51|, v58
  v_mfma_f32_16x16x32_f16 v[184:187], v[164:167], v[116:119], v[184:187]
  s_waitcnt lgkmcnt(3)
  v_pk_mul_f16 v144, v93, v99 op_sel:[0,1] op_sel_hi:[1,1]
  v_mfma_f32_16x16x32_f16 v[188:191], v[168:171], v[116:119], v[188:191]
  ds_read_b128 v[164:167], v1 offset:4096
  v_pk_mul_f16 v145, v93, v100 op_sel:[0,0] op_sel_hi:[1,0]
  v_mfma_f32_16x16x32_f16 v[204:207], v[168:171], v[128:131], v[204:207]
  v_pk_mul_f16 v146, v100, v100 op_sel:[0,0] op_sel_hi:[1,1]
  v_max3_f32 v58, |v52|, |v53|, v58
  v_mfma_f32_16x16x32_f16 v[220:223], v[168:171], v[140:143], v[220:223]
  v_pk_mul_f16 v147, v88, v89 op_sel:[0,0] op_sel_hi:[1,1]
  v_max3_f32 v58, |v54|, |v55|, v58
  v_mfma_f32_16x16x32_f16 v[236:239], v[168:171], v[152:155], v[236:239]
  s_waitcnt lgkmcnt(3)
  v_pk_mul_f16 v156, v107, v113 op_sel:[0,1] op_sel_hi:[1,1]
  v_mfma_f32_16x16x32_f16 v[192:195], v[172:175], v[120:123], v[192:195]
  v_pk_mul_f16 v157, v107, v114 op_sel:[0,0] op_sel_hi:[1,0]
  v_max3_f32 v58, |v56|, |v57|, v58
  v_mfma_f32_16x16x32_f16 v[208:211], v[172:175], v[132:135], v[208:211]
  v_pk_mul_f16 v158, v114, v114 op_sel:[0,0] op_sel_hi:[1,1]
  v_cvt_pk_f16_f32 v62, v32, v33
  v_mfma_f32_16x16x32_f16 v[224:227], v[172:175], v[144:147], v[224:227]
  v_pk_mul_f16 v159, v102, v103 op_sel:[0,0] op_sel_hi:[1,1]
  s_nop 1
  v_mfma_f32_16x16x32_f16 v[240:243], v[172:175], v[156:159], v[240:243]
  s_waitcnt lgkmcnt(2)
  v_cvt_pk_f16_f32 v76, v34, v35
  v_cvt_pk_f16_f32 v90, v36, v37
  v_mfma_f32_16x16x32_f16 v[232:235], v[176:179], v[156:159], v[232:235]
  ds_write_b32 v11, v62 offset:0
  v_mfma_f32_16x16x32_f16 v[216:219], v[176:179], v[144:147], v[216:219]
  ds_write_b32 v11, v76 offset:160
  v_mfma_f32_16x16x32_f16 v[200:203], v[176:179], v[132:135], v[200:203]
  ds_write_b32 v11, v90 offset:320
  v_mfma_f32_16x16x32_f16 v[184:187], v[176:179], v[120:123], v[184:187]
  s_waitcnt lgkmcnt(4)
  v_cvt_pk_f16_f32 v104, v38, v39
  v_cvt_pk_f16_f32 v63, v40, v41
  v_mfma_f32_16x16x32_f16 v[188:191], v[180:183], v[120:123], v[188:191]
  ds_write_b32 v11, v104 offset:480
  v_mfma_f32_16x16x32_f16 v[204:207], v[180:183], v[132:135], v[204:207]
  ds_write_b32 v11, v63 offset:640
  v_mfma_f32_16x16x32_f16 v[220:223], v[180:183], v[144:147], v[220:223]
  v_cvt_pk_f16_f32 v77, v42, v43
  v_cvt_pk_f16_f32 v91, v44, v45
  v_mfma_f32_16x16x32_f16 v[236:239], v[180:183], v[156:159], v[236:239]
  s_waitcnt lgkmcnt(5)
  v_cvt_pk_f16_f32 v105, v46, v47
  v_cvt_pk_f16_f32 v66, v48, v49
  v_smfmac_f32_16x16x64_f16 v[196:199], v[164:167], v[116:123], v9
  ds_write_b32 v11, v77 offset:800
  v_smfmac_f32_16x16x64_f16 v[212:215], v[164:167], v[128:135], v9
  ds_write_b32 v11, v91 offset:960
  v_smfmac_f32_16x16x64_f16 v[228:231], v[164:167], v[140:147], v9
  ds_write_b32 v11, v105 offset:1120
  v_smfmac_f32_16x16x64_f16 v[244:247], v[164:167], v[152:159], v9
  ds_write_b32 v11, v66 offset:1280
  s_setprio 0
  s_sub_u32 s72, s72, 1
  s_cmp_eq_u32 s72, 0
  s_cbranch_scc1 L_cin_done
  v_cvt_pk_f16_f32 v80, v50, v51
  v_cvt_pk_f16_f32 v94, v52, v53
  v_cvt_pk_f16_f32 v108, v54, v55
  v_cvt_pk_f16_f32 v67, v56, v57
  ds_write_b32 v11, v80 offset:1440
  ds_write_b32 v11, v94 offset:1600
  ds_write_b32 v11, v108 offset:1760
  ds_write_b32 v11, v67 offset:1920
  s_branch L_cin_loop
L_cslow:
  v_max_f32_dpp v58, v58, v58 row_shr:1 row_mask:0xf bank_mask:0xf
  s_nop 1
  v_max_f32_dpp v58, v58, v58 row_shr:2 row_mask:0xf bank_mask:0xf
  s_nop 1
  v_max_f32_dpp v58, v58, v58 row_shr:4 row_mask:0xf bank_mask:0xf
  s_nop 1
  v_max_f32_dpp v58, v58, v58 row_shr:8 row_mask:0xf bank_mask:0xf
  s_nop 1
  v_max_f32_dpp v58, v58, v58 row_bcast:15 row_mask:0xa bank_mask:0xf
  s_nop 1
  v_max_f32_dpp v58, v58, v58 row_bcast:31 row_mask:0xc bank_mask:0xf
  s_nop 0
  v_readlane_b32 s98, v58, 63
  s_mov_b32 s97, 0
  s_lshr_b32 s98, s98, 23
  s_min_u32 s98, s98, 182
  s_lshr_b32 s99, s1, 23
  s_sub_u32 s99, s99, 47
  s_lshr_b32 s99, s99, 1
  s_min_u32 s99, s99, 59
  s_sub_u32 s99, 131, s99
  s_max_u32 s98, s98, s99
  s_sub_u32 s99, 258, s98
  s_lshl_b32 s100, s99, 1
  s_sub_u32 s100, s100, 127
  s_sub_u32 s95, 254, s100
  s_lshl_b32 s95, s95, 23
  v_mov_b32 v60, s95
  v_mul_f32 v61, s0, v60
  v_mul_f32 v60, s1, v60
  v_readfirstlane_b32 s74, v61
  v_readfirstlane_b32 s75, v60
  s_lshl_b32 s99, s99, 23
  s_lshl_b32 s100, s100, 23
  v_mul_f32 v60, s99, v32
  v_mul_f32 v61, s99, v33
  v_mul_f32 v62, s100, v32
  v_mul_f32 v63, s100, v33
  v_cvt_pk_f16_f32 v80, v60, v61
  v_cvt_pk_bf16_f32 v64, v62, v63
  ds_write_b32 v11, v80 offset:0
  ds_write_b32 v10, v64 offset:0
  v_mul_f32 v60, s99, v34
  v_mul_f32 v61, s99, v35
  v_mul_f32 v62, s100, v34
  v_mul_f32_e64 v63, s100, v35
  v_cvt_pk_f16_f32 v81, v60, v61
  v_cvt_pk_bf16_f32 v65, v62, v63
  ds_write_b32 v11, v81 offset:160
  ds_write_b32 v10, v65 offset:2112
  v_mul_f32 v60, s99, v36
  v_mul_f32 v61, s99, v37
  v_mul_f32 v62, s100, v36
  v_mul_f32 v63, s100, v37
  v_cvt_pk_f16_f32 v82, v60, v61
  v_cvt_pk_bf16_f32 v66, v62, v63
  ds_write_b32 v11, v82 offset:320
  ds_write_b32 v10, v66 offset:128
  v_mul_f32 v60, s99, v38
  v_mul_f32 v61, s99, v39
  v_mul_f32 v62, s100, v38
  v_mul_f32 v63, s100, v39
  v_cvt_pk_f16_f32 v83, v60, v61
  v_cvt_pk_bf16_f32 v67, v62, v63
  ds_write_b32 v11, v83 offset:480
  ds_write_b32 v10, v67 offset:2240
  v_mul_f32 v60, s99, v40
  v_mul_f32 v61, s99, v41
  v_mul_f32 v62, s100, v40
  v_mul_f32 v63, s100, v41
  v_cvt_pk_f16_f32 v84, v60, v61
  v_cvt_pk_bf16_f32 v68, v62, v63
  ds_write_b32 v11, v84 offset:640
  ds_write_b32 v10, v68 offset:256
  v_mul_f32 v60, s99, v42
  v_mul_f32 v61, s99, v43
  v_mul_f32 v62, s100, v42
  v_mul_f32 v63, s100, v43
  v_cvt_pk_f16_f32 v85, v60, v61
  v_cvt_pk_bf16_f32 v69, v62, v63
  ds_write_b32 v11, v85 offset:800
  ds_write_b32 v10, v69 offset:2368
  v_mul_f32 v60, s99, v44
  v_mul_f32 v61, s99, v45
  v_mul_f32 v62, s100, v44
  v_mul_f32 v63, s100, v45
  v_cvt_pk_f16_f32 v86, v60, v61
  v_cvt_pk_bf16_f32 v70, v62, v63
  ds_write_b32 v11, v86 offset:960
  ds_write_b32 v10, v70 offset:384
  v_mul_f32 v60, s99, v46
  v_mul_f32 v61, s99, v47
  v_mul_f32 v62, s100, v46
  v_mul_f32 v63, s100, v47
  v_cvt_pk_f16_f32 v87, v60, v61
  v_cvt_pk_bf16_f32 v71, v62, v63
  ds_write_b32 v11, v87 offset:1120
  ds_write_b32 v10, v71 offset:2496
  v_mul_f32 v60, s99, v48
  v_mul_f32 v61, s99, v49
  v_mul_f32 v62, s100, v48
  v_mul_f32 v63, s100, v49
  v_cvt_pk_f16_f32 v88, v60, v61
  v_cvt_pk_bf16_f32 v72, v62, v63
  ds_write_b32 v11, v88 offset:1280
  ds_write_b32 v10, v72 offset:512
  v_mul_f32 v60, s99, v50
  v_mul_f32 v61, s99, v51
  v_mul_f32 v62, s100, v50
  v_mul_f32 v63, s100, v51
  v_cvt_pk_f16_f32 v89, v60, v61
  v_cvt_pk_bf16_f32 v73, v62, v63
  ds_write_b32 v11, v89 offset:1440
  ds_write_b32 v10, v73 offset:2624
  v_mul_f32 v60, s99, v52
  v_mul_f32 v61, s99, v53
  v_mul_f32 v62, s100, v52
  v_mul_f32 v63, s100, v53
  v_cvt_pk_f16_f32 v90, v60, v61
  v_cvt_pk_bf16_f32 v74, v62, v63
  ds_write_b32 v11, v90 offset:1600
  ds_write_b32 v10, v74 offset:640
  v_mul_f32 v60, s99, v54
  v_mul_f32 v61, s99, v55
  v_mul_f32 v62, s100, v54
  v_mul_f32 v63, s100, v55
  v_cvt_pk_f16_f32 v91, v60, v61
  v_cvt_pk_bf16_f32 v75, v62, v63
  ds_write_b32 v11, v91 offset:1760
  ds_write_b32 v10, v75 offset:2752
  v_mul_f32 v60, s99, v56
  v_mul_f32 v61, s99, v57
  v_mul_f32 v62, s100, v56
  v_mul_f32 v63, s100, v57
  v_cvt_pk_f16_f32 v92, v60, v61
  v_cvt_pk_bf16_f32 v76, v62, v63
  ds_write_b32 v11, v92 offset:1920
  ds_write_b32 v10, v76 offset:768
  v_mov_b32 v60, s100
  v_cvt_pk_bf16_f32 v60, v60, v60
  s_mov_b32 exec_hi, 0
  ds_write_b32 v10, v60 offset:2880
  s_mov_b32 exec_hi, -1
  s_waitcnt lgkmcnt(0)
  s_branch L_cconv
L_sdown:
  v_lshlrev_b32 v108, 16, v112
  v_and_b32 v109, 0xffff0000, v112
  v_mul_f32 v108, v108, v250
  v_mul_f32 v109, v109, v250
  v_cvt_pk_bf16_f32 v112, v108, v109
  v_lshlrev_b32 v108, 16, v113
  v_and_b32 v109, 0xffff0000, v113
  v_mul_f32 v108, v108, v250
  v_mul_f32_e64 v109, v109, v250
  v_cvt_pk_bf16_f32 v113, v108, v109
  v_lshlrev_b32 v108, 16, v114
  v_and_b32 v109, 0xffff0000, v114
  v_mul_f32 v108, v108, v250
  v_mul_f32 v109, v109, v250
  v_cvt_pk_bf16_f32 v114, v108, v109
  v_lshlrev_b32 v108, 16, v115
  v_and_b32 v109, 0xffff0000, v115
  v_mul_f32 v108, v108, v250
  v_mul_f32 v109, v109, v250
  v_cvt_pk_bf16_f32 v115, v108, v109
  v_lshlrev_b32 v108, 16, v116
  v_and_b32 v109, 0xffff0000, v116
  v_mul_f32 v108, v108, v250
  v_mul_f32 v109, v109, v250
  v_cvt_pk_bf16_f32 v116, v108, v109
  v_lshlrev_b32 v108, 16, v117
  v_and_b32 v109, 0xffff0000, v117
  v_mul_f32 v108, v108, v250
  v_mul_f32 v109, v109, v250
  v_cvt_pk_bf16_f32 v117, v108, v109
  v_lshlrev_b32_e64 v108, 16, v118
  v_and_b32 v109, 0xffff0000, v118
  v_mul_f32 v108, v108, v250
  v_mul_f32 v109, v109, v250
  v_cvt_pk_bf16_f32 v118, v108, v109
  v_lshlrev_b32 v108, 16, v119
  v_and_b32 v109, 0xffff0000, v119
  v_mul_f32 v108, v108, v250
  v_mul_f32 v109, v109, v250
  v_cvt_pk_bf16_f32 v119, v108, v109
  s_branch L_scaled
L_first:
  ds_read_b64_tr_b16 v[60:61], v20 offset:0
  ds_read_b64_tr_b16 v[74:75], v20 offset:32
  ds_read_b64_tr_b16 v[88:89], v20 offset:64
  ds_read_b64_tr_b16 v[102:103], v20 offset:96
  ds_read_b64_tr_b16 v[66:67], v23 offset:0
  ds_read_b64_tr_b16 v[80:81], v23 offset:32
  ds_read_b64_tr_b16 v[94:95], v23 offset:64
  ds_read_b64_tr_b16 v[108:109], v23 offset:96
  ds_read_b64_tr_b16 v[68:69], v24 offset:0
  ds_read_b64_tr_b16 v[82:83], v24 offset:32
  ds_read_b64_tr_b16 v[96:97], v24 offset:64
  ds_read_b64_tr_b16 v[110:111], v24 offset:96
  ds_read_b64_tr_b16 v[124:125], v4 offset:0
  ds_read_b64_tr_b16 v[126:127], v5 offset:0
  ds_read_b64_tr_b16 v[136:137], v4 offset:32
  ds_read_b64_tr_b16 v[138:139], v5 offset:32
  ds_read_b64_tr_b16 v[148:149], v4 offset:64
  ds_read_b64_tr_b16 v[150:151], v5 offset:64
  ds_read_b64_tr_b16 v[160:161], v4 offset:96
  ds_read_b64_tr_b16 v[162:163], v5 offset:96
  ds_read_b128 v[164:167], v1 offset:39936
  ds_read_b128 v[168:171], v1 offset:40960
  ds_read_b128 v[172:175], v1 offset:8192
  ds_read_b128 v[176:179], v1 offset:6144
  ds_read_b64_tr_b16 v[70:71], v25 offset:0
  ds_read_b64_tr_b16 v[84:85], v25 offset:32
  ds_read_b64_tr_b16 v[98:99], v25 offset:64
  ds_read_b64_tr_b16 v[112:113], v25 offset:96
  ds_read_b64_tr_b16 v[72:73], v26 offset:0
  s_waitcnt lgkmcnt(14)
  v_pk_mul_f16 v120, v60, v67 op_sel:[0,0] op_sel_hi:[0,1]
  v_pk_mul_f16 v121, v60, v67 op_sel:[1,0] op_sel_hi:[1,1]
  ds_read_b64_tr_b16 v[86:87], v26 offset:32
  v_pk_mul_f16 v122, v60, v68 op_sel:[0,0] op_sel_hi:[0,1]
  ds_read_b64_tr_b16 v[100:101], v26 offset:64
  v_pk_mul_f16 v123, v60, v68 op_sel:[1,0] op_sel_hi:[1,1]
  ds_read_b64_tr_b16 v[114:115], v26 offset:96
  v_pk_mul_f16 v132, v74, v81 op_sel:[0,0] op_sel_hi:[0,1]
  v_pk_mul_f16 v133, v74, v81 op_sel:[1,0] op_sel_hi:[1,1]
  ds_read_b64_tr_b16 v[62:63], v21 offset:0
  v_pk_mul_f16 v134, v74, v82 op_sel:[0,0] op_sel_hi:[0,1]
  ds_read_b64_tr_b16 v[76:77], v21 offset:32
  v_pk_mul_f16 v135, v74, v82 op_sel:[1,0] op_sel_hi:[1,1]
  ds_read_b64_tr_b16 v[90:91], v21 offset:64
  v_pk_mul_f16 v144, v88, v95 op_sel:[0,0] op_sel_hi:[0,1]
  v_pk_mul_f16 v145, v88, v95 op_sel:[1,0] op_sel_hi:[1,1]
  ds_read_b64_tr_b16 v[104:105], v21 offset:96
  v_pk_mul_f16 v146, v88, v96 op_sel:[0,0] op_sel_hi:[0,1]
  ds_read_b64_tr_b16 v[64:65], v22 offset:0
  v_pk_mul_f16 v147, v88, v96 op_sel:[1,0] op_sel_hi:[1,1]
  ds_read_b64_tr_b16 v[78:79], v22 offset:32
  v_pk_mul_f16 v156, v102, v109 op_sel:[0,0] op_sel_hi:[0,1]
  v_pk_mul_f16 v157, v102, v109 op_sel:[1,0] op_sel_hi:[1,1]
  ds_read_b64_tr_b16 v[92:93], v22 offset:64
  v_pk_mul_f16 v158, v102, v110 op_sel:[0,0] op_sel_hi:[0,1]
  ds_read_b64_tr_b16 v[106:107], v22 offset:96
  v_pk_mul_f16 v159, v102, v110 op_sel:[1,0] op_sel_hi:[1,1]
  s_branch L_novm
L_cid:
  s_mov_b64 exec, 0x1fff
  v_mov_b32 v20, 1
  v_mov_b32 v21, 0
  v_lshlrev_b32_e64 v22, 8, v0
  s_mov_b64 exec, 1
  buffer_atomic_add v20, v21, s[64:67], 0 offen sc0
  s_mov_b32 s81, 0x60000
  s_waitcnt vmcnt(0)
  v_cmp_ne_u32 vcc, 0, v20
  s_cbranch_vccnz L_cpd
  s_mov_b64 exec, 0x1fff
  buffer_store_dword v21, v22, s[60:63], s81 offen sc1
  s_mov_b64 exec, 1
  v_mov_b32 v20, 1
  s_waitcnt vmcnt(0)
  buffer_store_dword v20, v21, s[64:67], 0 offen offset:128 sc1
L_cpd:
  buffer_load_dword v20, v21, s[64:67], 0 offen offset:128 sc1
  s_waitcnt vmcnt(0)
  v_cmp_eq_u32 vcc, 0, v20
  s_cbranch_vccnz L_cpd
  s_mov_b64 exec, -1
  s_branch L_crd
L_cic:
  s_mov_b64 exec, 0x1fff
  v_mov_b32 v20, 1
  v_mov_b32 v21, 0
  v_lshlrev_b32 v22, 8, v0
  s_mov_b64 exec, 1
  buffer_atomic_add v20, v21, s[64:67], 0 offen sc0
  s_mov_b32 s81, 0x60000
  s_waitcnt vmcnt(0)
  v_cmp_ne_u32 vcc, 0, v20
  s_cbranch_vccnz L_cpc
  s_mov_b64 exec, 0x1fff
  buffer_store_dword v21, v22, s[60:63], s81 offen sc1
  s_mov_b64 exec, 1
  v_mov_b32_e64 v20, 1
  s_waitcnt vmcnt(0)
  buffer_store_dword v20, v21, s[64:67], 0 offen offset:128 sc1
L_cpc:
  buffer_load_dword v20, v21, s[64:67], 0 offen offset:128 sc1
  s_waitcnt vmcnt(0)
  v_cmp_eq_u32 vcc, 0, v20
  s_cbranch_vccnz L_cpc
  s_mov_b64 exec, -1
  s_branch L_crc
L_spare:
  s_cmp_lg_u32 s3, 0
  s_cbranch_scc1 L_end
  s_waitcnt lgkmcnt(0)
  s_mov_b32 s60, s24
  s_and_b32 s61, s25, 0xffff
  s_mov_b32 s62, 268435456
  s_mov_b32 s63, 0x20000
  s_mov_b32 s56, s20
  s_and_b32 s57, s21, 0xffff
  s_mov_b32 s58, 8192
  s_mov_b32 s59, 0x20000
  s_mov_b32 s64, s22
  s_and_b32 s65, s23, 0xffff
  s_mov_b32 s66, 256
  s_mov_b32 s67, 0x20000
  s_mov_b64 exec, 0x1fff
  v_mov_b32 v20, 1
  v_mov_b32 v21, 0
  v_lshlrev_b32 v22, 8, v0
  s_mov_b64 exec, 1
  buffer_atomic_add v20, v21, s[64:67], 0 offen sc0
  s_mov_b32 s81, 0x60000
  s_waitcnt vmcnt(0)
  v_cmp_ne_u32 vcc, 0, v20
  s_cbranch_vccnz L_end
  s_mov_b64 exec, 0x1fff
  buffer_store_dword v21, v22, s[60:63], s81 offen sc1
  s_mov_b64 exec, 1
  v_mov_b32 v20, 1
  s_waitcnt vmcnt(0)
  buffer_store_dword v20, v21, s[64:67], 0 offen offset:128 sc1
L_end:
  s_endpgm
.p2align 8
L_tables:
.long 0x0, 0x1800, 0x6c80, 0x81a0, 0x8, 0x1808, 0x6c88, 0x81a8
.long 0x10, 0x1810, 0x6c90, 0x81b0, 0x18, 0x1818, 0x6c98, 0x81b8
.long 0x40, 0x1d48, 0x71c8, 0x86e8, 0x48, 0x1d50, 0x71d0, 0x86f0
.long 0x50, 0x1d58, 0x71d8, 0x86f8, 0x58, 0x1d60, 0x71e0, 0x8700
.long 0x80, 0x2290, 0x7710, 0x8c30, 0x88, 0x2298, 0x7718, 0x8c38
.long 0x90, 0x22a0, 0x7720, 0x8c40, 0x98, 0x22a8, 0x7728, 0x8c48
.long 0xc0, 0x27d8, 0x7c58, 0x9178, 0xc8, 0x27e0, 0x7c60, 0x9180
.long 0xd0, 0x27e8, 0x7c68, 0x9188, 0xd8, 0x27f0, 0x7c70, 0x9190
.long 0x20, 0x1820, 0x6ca0, 0x81c0, 0x28, 0x1828, 0x6ca8, 0x81c8
.long 0x30, 0x1830, 0x6cb0, 0x81d0, 0x38, 0x1838, 0x6cb8, 0x81d8
.long 0x60, 0x1d68, 0x71e8, 0x8708, 0x68, 0x1d70, 0x71f0, 0x8710
.long 0x70, 0x1d78, 0x71f8, 0x8718, 0x78, 0x1d80, 0x7200, 0x8720
.long 0xa0, 0x22b0, 0x7730, 0x8c50, 0xa8, 0x22b8, 0x7738, 0x8c58
.long 0xb0, 0x22c0, 0x7740, 0x8c60, 0xb8, 0x22c8, 0x7748, 0x8c68
.long 0xe0, 0x27f8, 0x7c78, 0x9198, 0xe8, 0x2800, 0x7c80, 0x91a0
.long 0xf0, 0x2808, 0x7c88, 0x91a8, 0xf8, 0x2810, 0x7c90, 0x91b0
.long 0x200, 0x4240, 0x96c0, 0x9c08, 0x208, 0x4248, 0x96c8, 0x9c10
.long 0x210, 0x4250, 0x96d0, 0x9c18, 0x218, 0x4258, 0x96d8, 0x9c20
.long 0x240, 0x4788, 0x9c08, 0x9c08, 0x248, 0x4790, 0x9c10, 0x9c10
.long 0x250, 0x4798, 0x9c18, 0x9c18, 0x258, 0x47a0, 0x9c20, 0x9c20
.long 0x280, 0x4cd0, 0x9c08, 0x9c08, 0x288, 0x4cd8, 0x9c10, 0x9c10
.long 0x290, 0x4ce0, 0x9c18, 0x9c18, 0x298, 0x4ce8, 0x9c20, 0x9c20
.long 0x2c0, 0x5218, 0x9c08, 0x9c08, 0x2c8, 0x5220, 0x9c10, 0x9c10
.long 0x2d0, 0x5228, 0x9c18, 0x9c18, 0x2d8, 0x5230, 0x9c20, 0x9c20
.long 0x220, 0x4260, 0x96e0, 0x9c28, 0x228, 0x4268, 0x96e8, 0x9c30
.long 0x230, 0x4270, 0x96f0, 0x9c38, 0x238, 0x4278, 0x96f8, 0x9c40
.long 0x260, 0x47a8, 0x9c28, 0x9c28, 0x268, 0x47b0, 0x9c30, 0x9c30
.long 0x270, 0x47b8, 0x9c38, 0x9c38, 0x278, 0x47c0, 0x9c40, 0x9c40
.long 0x2a0, 0x4cf0, 0x9c28, 0x9c28, 0x2a8, 0x4cf8, 0x9c30, 0x9c30
.long 0x2b0, 0x4d00, 0x9c38, 0x9c38, 0x2b8, 0x4d08, 0x9c40, 0x9c40
.long 0x2e0, 0x5238, 0x9c28, 0x9c28, 0x2e8, 0x5240, 0x9c30, 0x9c30
.long 0x2f0, 0x5248, 0x9c38, 0x9c38, 0x2f8, 0x5250, 0x9c40, 0x9c40
.long 0xaae0, 0xa680, 0xa900, 0xaae0, 0xaae8, 0xa688, 0xa908, 0xaae8
.long 0xaaf0, 0xa690, 0xa910, 0xaaf0, 0xaaf8, 0xa698, 0xa918, 0xaaf8
.long 0xaa40, 0xa860, 0xa9a0, 0xaa40, 0xaa48, 0xa868, 0xa9a8, 0xaa48
.long 0xaa50, 0xa870, 0xa9b0, 0xaa50, 0xaa58, 0xa878, 0xa9b8, 0xaa58
.long 0xa400, 0xa7c0, 0xa540, 0xa400, 0xa408, 0xa7c8, 0xa548, 0xa408
.long 0xa410, 0xa7d0, 0xa550, 0xa410, 0xa418, 0xa7d8, 0xa558, 0xa418
.long 0xa4a0, 0xa720, 0xa5e0, 0xa4a0, 0xa4a8, 0xa728, 0xa5e8, 0xa4a8
.long 0xa4b0, 0xa730, 0xa5f0, 0xa4b0, 0xa4b8, 0xa738, 0xa5f8, 0xa4b8
.long 0xb260, 0xb4e0, 0xb6c0, 0xb260, 0xb268, 0xb4e8, 0xb6c8, 0xb268
.long 0xb270, 0xb4f0, 0xb6d0, 0xb270, 0xb278, 0xb4f8, 0xb6d8, 0xb278
.long 0xb1c0, 0xb300, 0xb760, 0xb1c0, 0xb1c8, 0xb308, 0xb768, 0xb1c8
.long 0xb1d0, 0xb310, 0xb770, 0xb1d0, 0xb1d8, 0xb318, 0xb778, 0xb1d8
.long 0xb580, 0xb440, 0xb080, 0xb580, 0xb588, 0xb448, 0xb088, 0xb588
.long 0xb590, 0xb450, 0xb090, 0xb590, 0xb598, 0xb458, 0xb098, 0xb598
.long 0xb620, 0xb3a0, 0xb120, 0xb620, 0xb628, 0xb3a8, 0xb128, 0xb628
.long 0xb630, 0xb3b0, 0xb130, 0xb630, 0xb638, 0xb3b8, 0xb138, 0xb638
.long 0xa900, 0xa400, 0xaae0, 0xb620, 0xa908, 0xa408, 0xaae8, 0xb628
.long 0xa910, 0xa410, 0xaaf0, 0xb630, 0xa918, 0xa418, 0xaaf8, 0xb638
.long 0xa9a0, 0xa4a0, 0xab80, 0xb800, 0xa9a8, 0xa4a8, 0xab88, 0xb808
.long 0xa9b0, 0xa4b0, 0xab90, 0xb810, 0xa9b8, 0xa4b8, 0xab98, 0xb818
.long 0xaa40, 0xa680, 0xa860, 0xb3a0, 0xaa48, 0xa688, 0xa868, 0xb3a8
.long 0xaa50, 0xa690, 0xa870, 0xb3b0, 0xaa58, 0xa698, 0xa878, 0xb3b8
.long 0xa720, 0xa540, 0xa7c0, 0xb1c0, 0xa728, 0xa548, 0xa7c8, 0xb1c8
.long 0xa730, 0xa550, 0xa7d0, 0xb1d0, 0xa738, 0xa558, 0xa7d8, 0xb1d8
.long 0xa5e0, 0xaae0, 0xa400, 0xb080, 0xa5e8, 0xaae8, 0xa408, 0xb088
.long 0xa5f0, 0xaaf0, 0xa410, 0xb090, 0xa5f8, 0xaaf8, 0xa418, 0xb098
.long 0xa7c0, 0xa540, 0xa720, 0xb760, 0xa7c8, 0xa548, 0xa728, 0xb768
.long 0xa7d0, 0xa550, 0xa730, 0xb770, 0xa7d8, 0xa558, 0xa738, 0xb778
.long 0xa860, 0xa680, 0xaa40, 0xb440, 0xa868, 0xa688, 0xaa48, 0xb448
.long 0xa870, 0xa690, 0xaa50, 0xb450, 0xa878, 0xa698, 0xaa58, 0xb458
.long 0xab80, 0xa4a0, 0xa9a0, 0xb4e0, 0xab88, 0xa4a8, 0xa9a8, 0xb4e8
.long 0xab90, 0xa4b0, 0xa9b0, 0xb4f0, 0xab98, 0xa4b8, 0xa9b8, 0xb4f8
.long 0xa680, 0xa900, 0xab80, 0xa4a0, 0xa688, 0xa908, 0xab88, 0xa4a8
.long 0xa690, 0xa910, 0xab90, 0xa4b0, 0xa698, 0xa918, 0xab98, 0xa4b8
.long 0xa860, 0xa9a0, 0xb1c0, 0xb440, 0xa868, 0xa9a8, 0xb1c8, 0xb448
.long 0xa870, 0xa9b0, 0xb1d0, 0xb450, 0xa878, 0xa9b8, 0xb1d8, 0xb458
.long 0xa7c0, 0xa540, 0xab80, 0xa4a0, 0xa7c8, 0xa548, 0xab88, 0xa4a8
.long 0xa7d0, 0xa550, 0xab90, 0xa4b0, 0xa7d8, 0xa558, 0xab98, 0xa4b8
.long 0xa720, 0xa5e0, 0xb1c0, 0xb440, 0xa728, 0xa5e8, 0xb1c8, 0xb448
.long 0xa730, 0xa5f0, 0xb1d0, 0xb450, 0xa738, 0xa5f8, 0xb1d8, 0xb458
.long 0xb4e0, 0xb6c0, 0xb800, 0xa860, 0xb4e8, 0xb6c8, 0xb808, 0xa868
.long 0xb4f0, 0xb6d0, 0xb810, 0xa870, 0xb4f8, 0xb6d8, 0xb818, 0xa878
.long 0xb300, 0xb760, 0xa540, 0xa900, 0xb308, 0xb768, 0xa548, 0xa908
.long 0xb310, 0xb770, 0xa550, 0xa910, 0xb318, 0xb778, 0xa558, 0xa918
.long 0xb440, 0xb080, 0xb800, 0xa860, 0xb448, 0xb088, 0xb808, 0xa868
.long 0xb450, 0xb090, 0xb810, 0xa870, 0xb458, 0xb098, 0xb818, 0xa878
.long 0xb3a0, 0xb120, 0xa540, 0xa900, 0xb3a8, 0xb128, 0xa548, 0xa908
.long 0xb3b0, 0xb130, 0xa550, 0xa910, 0xb3b8, 0xb138, 0xa558, 0xa918
.long 0xb120, 0xb580, 0xb080, 0xb300, 0xb128, 0xb588, 0xb088, 0xb308
.long 0xb130, 0xb590, 0xb090, 0xb310, 0xb138, 0xb598, 0xb098, 0xb318
.long 0xb6c0, 0xb4e0, 0xaa40, 0xb6c0, 0xb6c8, 0xb4e8, 0xaa48, 0xb6c8
.long 0xb6d0, 0xb4f0, 0xaa50, 0xb6d0, 0xb6d8, 0xb4f8, 0xaa58, 0xb6d8
.long 0xb300, 0xb440, 0xb080, 0xb300, 0xb308, 0xb448, 0xb088, 0xb308
.long 0xb310, 0xb450, 0xb090, 0xb310, 0xb318, 0xb458, 0xb098, 0xb318
.long 0xb260, 0xb760, 0xaa40, 0xb6c0, 0xb268, 0xb768, 0xaa48, 0xb6c8
.long 0xb270, 0xb770, 0xaa50, 0xb6d0, 0xb278, 0xb778, 0xaa58, 0xb6d8
.long 0xb580, 0xb120, 0xb620, 0xa680, 0xb588, 0xb128, 0xb628, 0xa688
.long 0xb590, 0xb130, 0xb630, 0xa690, 0xb598, 0xb138, 0xb638, 0xa698
.long 0xb260, 0xb1c0, 0xa7c0, 0xa680, 0xb268, 0xb1c8, 0xa7c8, 0xa688
.long 0xb270, 0xb1d0, 0xa7d0, 0xa690, 0xb278, 0xb1d8, 0xa7d8, 0xa698
.long 0xb300, 0xb3a0, 0xb620, 0xb300, 0xb308, 0xb3a8, 0xb628, 0xb308
.long 0xb310, 0xb3b0, 0xb630, 0xb310, 0xb318, 0xb3b8, 0xb638, 0xb318
.long 0xb6c0, 0xb800, 0xa7c0, 0xb300, 0xb6c8, 0xb808, 0xa7c8, 0xb308
.long 0xb6d0, 0xb810, 0xa7d0, 0xb310, 0xb6d8, 0xb818, 0xa7d8, 0xb318
.long 0x0, 0x200, 0x0, 0x3f803f80, 0x8, 0x208, 0x0, 0x3f803f80
.long 0x10, 0x210, 0x0, 0x3f803f80, 0x18, 0x218, 0x0, 0x3f803f80
.long 0x420, 0x620, 0x0, 0x3f803f80, 0x428, 0x628, 0x0, 0x3f803f80
.long 0x430, 0x630, 0x0, 0x3f803f80, 0x438, 0x638, 0x0, 0x3f803f80
.long 0x840, 0xa40, 0x10, 0x3f803f80, 0x848, 0xa48, 0x10, 0x3f803f80
.long 0x850, 0xa50, 0x10, 0x3f803f80, 0x858, 0xa58, 0x10, 0x3f803f80
.long 0xc60, 0xe60, 0x10, 0x3f803f80, 0xc68, 0xe68, 0x10, 0x3f803f80
.long 0xc70, 0xe70, 0x10, 0x3f803f80, 0xc78, 0xe78, 0x10, 0x3f803f80
.long 0x80, 0x280, 0x20, 0x3f803f80, 0x88, 0x288, 0x20, 0x3f803f80
.long 0x90, 0x290, 0x20, 0x3f803f80, 0x98, 0x298, 0x20, 0x3f803f80
.long 0x4a0, 0x6a0, 0x20, 0x3f803f80, 0x4a8, 0x6a8, 0x20, 0x3f803f80
.long 0x4b0, 0x6b0, 0x20, 0x3f803f80, 0x4b8, 0x6b8, 0x20, 0x3f803f80
.long 0x8c0, 0xac0, 0x30, 0x3f803f80, 0x8c8, 0xac8, 0x30, 0x3f803f80
.long 0x8d0, 0xad0, 0x30, 0x3f803f80, 0x8d8, 0xad8, 0x30, 0x3f803f80
.long 0xce0, 0xee0, 0x30, 0x3f803f80, 0xce8, 0xee8, 0x30, 0x3f803f80
.long 0xcf0, 0xef0, 0x30, 0x3f803f80, 0xcf8, 0xef8, 0x30, 0x3f803f80
.long 0x100, 0x300, 0x40, 0x0, 0x108, 0x308, 0x40, 0x0
.long 0x110, 0x310, 0x40, 0x0, 0x118, 0x318, 0x40, 0x0
.long 0x520, 0x720, 0x40, 0x0, 0x528, 0x728, 0x40, 0x0
.long 0x530, 0x730, 0x40, 0x0, 0x538, 0x738, 0x40, 0x0
.long 0x940, 0xb40, 0x50, 0x0, 0x948, 0xb48, 0x50, 0x0
.long 0x950, 0xb50, 0x50, 0x0, 0x958, 0xb58, 0x50, 0x0
.long 0xd60, 0xf60, 0x50, 0x0, 0xd68, 0xf68, 0x50, 0x0
.long 0xd70, 0xf70, 0x50, 0x0, 0xd78, 0xf78, 0x50, 0x0
.long 0x180, 0xf60, 0x60, 0x0, 0x188, 0xf68, 0x60, 0x0
.long 0x190, 0xf70, 0x60, 0x0, 0x198, 0xf78, 0x60, 0x0
.long 0x5a0, 0xf60, 0x60, 0x0, 0x5a8, 0xf68, 0x60, 0x0
.long 0x5b0, 0xf70, 0x60, 0x0, 0x5b8, 0xf78, 0x60, 0x0
.long 0x9c0, 0xf60, 0x70, 0x0, 0x9c8, 0xf68, 0x70, 0x0
.long 0x9d0, 0xf70, 0x70, 0x0, 0x9d8, 0xf78, 0x70, 0x0
.long 0xde0, 0xf60, 0x70, 0x0, 0xde8, 0xf68, 0x70, 0x0
.long 0xdf0, 0xf70, 0x70, 0x0, 0xdf8, 0xf78, 0x70, 0x0
.long 0xffff, 0x0, 0x0, 0x0, 0x0, 0x0, 0xffff, 0x0
.long 0x0, 0x0, 0x0, 0x0, 0x0, 0x0, 0x0, 0x0
.long 0x0, 0x0, 0x0, 0x0, 0x0, 0x0, 0x0, 0x0
.long 0x0, 0x0, 0x0, 0x0, 0x0, 0x0, 0x0, 0x0
.long 0xffff0000, 0x0, 0x0, 0x0, 0x0, 0x0, 0xffff0000, 0x0
.long 0x0, 0x0, 0x0, 0x0, 0x0, 0x0, 0x0, 0x0
.long 0x0, 0x0, 0x0, 0x0, 0x0, 0x0, 0x0, 0x0
.long 0x0, 0x0, 0x0, 0x0, 0x0, 0x0, 0x0, 0x0
.long 0x0, 0xffff, 0x0, 0x0, 0x0, 0x0, 0x0, 0xffff
.long 0x0, 0x0, 0x0, 0x0, 0x0, 0x0, 0x0, 0x0
.long 0x0, 0x0, 0x0, 0x0, 0x0, 0x0, 0x0, 0x0
.long 0x0, 0x0, 0x0, 0x0, 0x0, 0x0, 0x0, 0x0
.long 0x0, 0xffff0000, 0x0, 0x0, 0x0, 0x0, 0x0, 0xffff0000
.long 0x0, 0x0, 0x0, 0x0, 0x0, 0x0, 0x0, 0x0
.long 0x0, 0x0, 0x0, 0x0, 0x0, 0x0, 0x0, 0x0
.long 0x0, 0x0, 0x0, 0x0, 0x0, 0x0, 0x0, 0x0
.long 0x0, 0x0, 0x0, 0x0, 0x0, 0x0, 0x0, 0x0
.long 0xffff, 0x0, 0x0, 0x0, 0x0, 0x0, 0xffff, 0x0
.long 0x0, 0x0, 0x0, 0x0, 0x0, 0x0, 0x0, 0x0
.long 0x0, 0x0, 0x0, 0x0, 0x0, 0x0, 0x0, 0x0
.long 0x0, 0x0, 0x0, 0x0, 0x0, 0x0, 0x0, 0x0
.long 0xffff0000, 0x0, 0x0, 0x0, 0x0, 0x0, 0xffff0000, 0x0
.long 0x0, 0x0, 0x0, 0x0, 0x0, 0x0, 0x0, 0x0
.long 0x0, 0x0, 0x0, 0x0, 0x0, 0x0, 0x0, 0x0
.long 0x0, 0x0, 0x0, 0x0, 0x0, 0x0, 0x0, 0x0
.long 0x0, 0xffff, 0x0, 0x0, 0x0, 0x0, 0x0, 0xffff
.long 0x0, 0x0, 0x0, 0x0, 0x0, 0x0, 0x0, 0x0
.long 0x0, 0x0, 0x0, 0x0, 0x0, 0x0, 0x0, 0x0
.long 0x0, 0x0, 0x0, 0x0, 0x0, 0x0, 0x0, 0x0
.long 0x0, 0xffff0000, 0x0, 0x0, 0x0, 0x0, 0x0, 0xffff0000
.long 0x0, 0x0, 0x0, 0x0, 0x0, 0x0, 0x0, 0x0
.long 0x0, 0x0, 0x0, 0x0, 0x0, 0x0, 0x0, 0x0
.long 0x0, 0x0, 0x0, 0x0, 0x0, 0x0, 0x0, 0x0
.long 0x0, 0x0, 0x0, 0x0, 0x0, 0x0, 0x0, 0x0
.long 0x0, 0x0, 0xffff, 0x0, 0x0, 0x0, 0x0, 0x0
.long 0x0, 0x0, 0x0, 0x0, 0xffff, 0x0, 0x0, 0x0
.long 0x0, 0x0, 0x0, 0x0, 0x0, 0x0, 0x0, 0x0
.long 0x0, 0x0, 0x0, 0x0, 0x0, 0x0, 0x0, 0x0
.long 0x0, 0x0, 0xffff0000, 0x0, 0x0, 0x0, 0x0, 0x0
.long 0x0, 0x0, 0x0, 0x0, 0xffff0000, 0x0, 0x0, 0x0
.long 0x0, 0x0, 0x0, 0x0, 0x0, 0x0, 0x0, 0x0
.long 0x0, 0x0, 0x0, 0x0, 0x0, 0x0, 0x0, 0x0
.long 0x0, 0x0, 0x0, 0xffff, 0x0, 0x0, 0x0, 0x0
.long 0x0, 0x0, 0x0, 0x0, 0x0, 0xffff, 0x0, 0x0
.long 0x0, 0x0, 0x0, 0x0, 0x0, 0x0, 0x0, 0x0
.long 0x0, 0x0, 0x0, 0x0, 0x0, 0x0, 0x0, 0x0
.long 0x0, 0x0, 0x0, 0xffff0000, 0x0, 0x0, 0x0, 0x0
.long 0x0, 0x0, 0x0, 0x0, 0x0, 0xffff0000, 0x0, 0x0
.long 0x0, 0x0, 0x0, 0x0, 0x0, 0x0, 0x0, 0x0
.long 0x0, 0x0, 0x0, 0x0, 0x0, 0x0, 0x0, 0x0
.long 0x0, 0x0, 0x0, 0x0, 0xffff, 0x0, 0x0, 0x0
.long 0x0, 0x0, 0x0, 0x0, 0x0, 0x0, 0x0, 0x0
.long 0x0, 0x0, 0x0, 0x0, 0x0, 0x0, 0x0, 0x0
.long 0x0, 0x0, 0x0, 0x0, 0x0, 0x0, 0x0, 0x0
.long 0x0, 0x0, 0x0, 0x0, 0xffff0000, 0x0, 0x0, 0x0
.long 0x0, 0x0, 0x0, 0x0, 0x0, 0x0, 0x0, 0x0
.long 0x0, 0x0, 0x0, 0x0, 0x0, 0x0, 0x0, 0x0
.long 0x0, 0x0, 0x0, 0x0, 0x0, 0x0, 0x0, 0x0
.long 0x0, 0x0, 0x0, 0x0, 0x0, 0x0, 0x0, 0x0
.long 0x0, 0x0, 0x0, 0x0, 0x0, 0x0, 0x0, 0x0
.long 0x0, 0x0, 0x0, 0x0, 0x0, 0x0, 0x0, 0x0
.long 0x0, 0x0, 0x0, 0x0, 0x0, 0x0, 0x0, 0x0
.long 0x0, 0x0, 0x0, 0x0, 0x0, 0x0, 0x0, 0x0
.long 0x0, 0x0, 0x0, 0x0, 0x0, 0x0, 0x0, 0x0
.long 0x14d40, 0x14d40, 0x0, 0x0, 0x14e10, 0x14e10, 0x20, 0x20
.long 0x14ee0, 0x14ee0, 0x100000, 0x100000, 0x14fb0, 0x14fb0, 0x100020, 0x100020
.long 0x15080, 0x15080, 0x40, 0x40, 0x15150, 0x15150, 0x60, 0x60
.long 0x15220, 0x15220, 0x100040, 0x100040, 0x100000, 0x100000, 0x100060, 0x100060
.long 0x14d74, 0x14d74, 0x80, 0x80, 0x14e44, 0x14e44, 0xa0, 0xa0
.long 0x14f14, 0x14f14, 0x100080, 0x100080, 0x14fe4, 0x14fe4, 0x1000a0, 0x1000a0
.long 0x150b4, 0x150b4, 0xc0, 0xc0, 0x15184, 0x15184, 0xe0, 0xe0
.long 0x15254, 0x15254, 0x1000c0, 0x1000c0, 0x100000, 0x100000, 0x1000e0, 0x1000e0
.long 0x14da8, 0x14da8, 0x8, 0x100, 0x14e78, 0x14e78, 0x28, 0x120
.long 0x14f48, 0x14f48, 0x100008, 0x100100, 0x15018, 0x15018, 0x100028, 0x100120
.long 0x150e8, 0x150e8, 0x48, 0x140, 0x151b8, 0x151b8, 0x68, 0x160
.long 0x100000, 0x100000, 0x100048, 0x100140, 0x100000, 0x100000, 0x100068, 0x100160
.long 0x14ddc, 0x14ddc, 0x88, 0x180, 0x14eac, 0x14eac, 0xa8, 0x1a0
.long 0x14f7c, 0x14f7c, 0x100088, 0x100180, 0x1504c, 0x1504c, 0x1000a8, 0x1001a0
.long 0x1511c, 0x1511c, 0xc8, 0x1c0, 0x151ec, 0x151ec, 0xe8, 0x1e0
.long 0x100000, 0x100000, 0x1000c8, 0x1001c0, 0x100000, 0x100000, 0x1000e8, 0x1001e0
.long 0x17d40, 0x114d40, 0x100, 0x200, 0x17e10, 0x114e10, 0x120, 0x220
.long 0x17ee0, 0x114ee0, 0x100100, 0x100200, 0x17fb0, 0x114fb0, 0x100120, 0x100220
.long 0x18080, 0x115080, 0x140, 0x240, 0x18150, 0x115150, 0x160, 0x260
.long 0x18220, 0x115220, 0x100140, 0x100240, 0x103000, 0x200000, 0x100160, 0x100260
.long 0x17d74, 0x114d74, 0x180, 0x280, 0x17e44, 0x114e44, 0x1a0, 0x2a0
.long 0x17f14, 0x114f14, 0x100180, 0x100280, 0x17fe4, 0x114fe4, 0x1001a0, 0x1002a0
.long 0x180b4, 0x1150b4, 0x1c0, 0x2c0, 0x18184, 0x115184, 0x1e0, 0x2e0
.long 0x18254, 0x115254, 0x1001c0, 0x1002c0, 0x103000, 0x200000, 0x1001e0, 0x1002e0
.long 0x17da8, 0x114da8, 0x108, 0x300, 0x17e78, 0x114e78, 0x128, 0x320
.long 0x17f48, 0x114f48, 0x100108, 0x100300, 0x18018, 0x115018, 0x100128, 0x100320
.long 0x180e8, 0x1150e8, 0x148, 0x340, 0x181b8, 0x1151b8, 0x168, 0x360
.long 0x103000, 0x200000, 0x100148, 0x100340, 0x103000, 0x200000, 0x100168, 0x100360
.long 0x17ddc, 0x114ddc, 0x188, 0x380, 0x17eac, 0x114eac, 0x1a8, 0x3a0
.long 0x17f7c, 0x114f7c, 0x100188, 0x100380, 0x1804c, 0x11504c, 0x1001a8, 0x1003a0
.long 0x1811c, 0x11511c, 0x1c8, 0x3c0, 0x181ec, 0x1151ec, 0x1e8, 0x3e0
.long 0x103000, 0x200000, 0x1001c8, 0x1003c0, 0x103000, 0x200000, 0x1001e8, 0x1003e0
.long 0xa400, 0xd00, 0x0, 0x14d40, 0xa440, 0xd00, 0x0, 0x14d80
.long 0xa480, 0xd00, 0x1, 0x14dd0, 0xa4c0, 0xd00, 0x1, 0x14e10
.long 0xa500, 0xd00, 0x2, 0x14e60, 0xa540, 0xd00, 0x2, 0x14ea0
.long 0xa580, 0xd00, 0x3, 0x14ef0, 0xa5c0, 0xd00, 0x3, 0x14f30
.long 0xa600, 0xd00, 0x4, 0x14f40, 0xa640, 0xd00, 0x4, 0x14f80
.long 0xa680, 0xd00, 0x5, 0x14fd0, 0xa6c0, 0xd00, 0x5, 0x15010
.long 0xa700, 0xd00, 0x6, 0x15060, 0xa740, 0xd00, 0x6, 0x150a0
.long 0xa780, 0xd00, 0x7, 0x150f0, 0xa7c0, 0xd00, 0x7, 0x15130
.long 0xa800, 0xd00, 0x8, 0x15140, 0xa840, 0xd00, 0x8, 0x15180
.long 0xa880, 0xd00, 0x9, 0x151d0, 0xa8c0, 0xd00, 0x9, 0x15210
.long 0xa900, 0xd00, 0xa, 0x15260, 0xa940, 0xd00, 0xa, 0x152a0
.long 0xa980, 0xd00, 0xb, 0x152f0, 0xa9c0, 0xd00, 0xb, 0x15330
.long 0xaa00, 0xd00, 0xc, 0x15340, 0xaa40, 0xd00, 0xc, 0x15380
.long 0x1f680, 0x40, 0xd, 0x153d0, 0x100000, 0xd00, 0xd, 0x15410
.long 0x100000, 0xd00, 0xe, 0x15460, 0x100000, 0xd00, 0xe, 0x154a0
.long 0x100000, 0xd00, 0xf, 0x154f0, 0x100000, 0xd00, 0xf, 0x15530
.long 0xa400, 0xd00, 0x2, 0x14d60, 0xa440, 0xd00, 0x2, 0x14da0
.long 0xa480, 0xd00, 0x3, 0x14df0, 0xa4c0, 0xd00, 0x3, 0x14e30
.long 0xa500, 0xd00, 0x4, 0x14e40, 0xa540, 0xd00, 0x4, 0x14e80
.long 0xa580, 0xd00, 0x5, 0x14ed0, 0xa5c0, 0xd00, 0x5, 0x14f10
.long 0xa600, 0xd00, 0x6, 0x14f60, 0xa640, 0xd00, 0x6, 0x14fa0
.long 0xa680, 0xd00, 0x7, 0x14ff0, 0xa6c0, 0xd00, 0x7, 0x15030
.long 0xa700, 0xd00, 0x8, 0x15040, 0xa740, 0xd00, 0x8, 0x15080
.long 0xa780, 0xd00, 0x9, 0x150d0, 0xa7c0, 0xd00, 0x9, 0x15110
.long 0xa800, 0xd00, 0xa, 0x15160, 0xa840, 0xd00, 0xa, 0x151a0
.long 0xa880, 0xd00, 0xb, 0x151f0, 0xa8c0, 0xd00, 0xb, 0x15230
.long 0xa900, 0xd00, 0xc, 0x15240, 0xa940, 0xd00, 0xc, 0x15280
.long 0xa980, 0xd00, 0xd, 0x152d0, 0xa9c0, 0xd00, 0xd, 0x15310
.long 0xaa00, 0xd00, 0xe, 0x15360, 0xaa40, 0xd00, 0xe, 0x153a0
.long 0x1f680, 0x40, 0xf, 0x153f0, 0x100000, 0xd00, 0xf, 0x15430
.long 0x100000, 0xd00, 0x10, 0x15440, 0x100000, 0xd00, 0x10, 0x15480
.long 0x100000, 0xd00, 0x11, 0x154d0, 0x100000, 0xd00, 0x11, 0x15510
.long 0x1f690, 0x1f890, 0x1f9c0, 0x1f9e0, 0x1f698, 0x1f898, 0x1f9c8, 0x1f9e8
.long 0x1f680, 0x1f880, 0x1f9d0, 0x1f9f0, 0x1f688, 0x1f888, 0x1f9d8, 0x100000
.long 0x1fd20, 0x1ff20, 0x1f9c2, 0x1f9e2, 0x1fd28, 0x1ff28, 0x1f9ca, 0x1f9ea
.long 0x1fd30, 0x1ff30, 0x1f9d2, 0x1f9f2, 0x1fd38, 0x1ff38, 0x1f9da, 0x100000
.long 0x1f6f0, 0x1f8f0, 0x1f9c4, 0x1f9e4, 0x1f6f8, 0x1f8f8, 0x1f9cc, 0x1f9ec
.long 0x1f6e0, 0x1f8e0, 0x1f9d4, 0x100000, 0x1f6e8, 0x1f8e8, 0x1f9dc, 0x100000
.long 0x1fd40, 0x1ff40, 0x1f9c6, 0x1f9e6, 0x1fd48, 0x1ff48, 0x1f9ce, 0x1f9ee
.long 0x1fd50, 0x1ff50, 0x1f9d6, 0x100000, 0x1fd58, 0x1ff58, 0x1f9de, 0x100000
.long 0x1f710, 0x1f910, 0x1f9c0, 0x1f9e0, 0x1f718, 0x1f918, 0x1f9c8, 0x1f9e8
.long 0x1f700, 0x1f900, 0x1f9d0, 0x1f9f0, 0x1f708, 0x1f908, 0x1f9d8, 0x100000
.long 0x1fda0, 0x1ffa0, 0x1f9c2, 0x1f9e2, 0x1fda8, 0x1ffa8, 0x1f9ca, 0x1f9ea
.long 0x1fdb0, 0x1ffb0, 0x1f9d2, 0x1f9f2, 0x1fdb8, 0x1ffb8, 0x1f9da, 0x100000
.long 0x1f770, 0x1f970, 0x1f9c4, 0x1f9e4, 0x1f778, 0x1f978, 0x1f9cc, 0x1f9ec
.long 0x1f760, 0x1f960, 0x1f9d4, 0x100000, 0x1f768, 0x1f968, 0x1f9dc, 0x100000
.long 0x1fdc0, 0x1ffc0, 0x1f9c6, 0x1f9e6, 0x1fdc8, 0x1ffc8, 0x1f9ce, 0x1f9ee
.long 0x1fdd0, 0x1ffd0, 0x1f9d6, 0x100000, 0x1fdd8, 0x1ffd8, 0x1f9de, 0x100000
.long 0x1f790, 0x1f990, 0x1f9c0, 0x1f9e0, 0x1f798, 0x1f998, 0x1f9c8, 0x1f9e8
.long 0x1f780, 0x1f980, 0x1f9d0, 0x1f9f0, 0x1f788, 0x1f988, 0x1f9d8, 0x100000
.long 0x1fe20, 0x20020, 0x1f9c2, 0x1f9e2, 0x1fe28, 0x20028, 0x1f9ca, 0x1f9ea
.long 0x1fe30, 0x20030, 0x1f9d2, 0x1f9f2, 0x1fe38, 0x20038, 0x1f9da, 0x100000
.long 0x1f7f0, 0x14d00, 0x1f9c4, 0x1f9e4, 0x1f7f8, 0x14d08, 0x1f9cc, 0x1f9ec
.long 0x1f7e0, 0x14d10, 0x1f9d4, 0x100000, 0x1f7e8, 0x14d18, 0x1f9dc, 0x100000
.long 0x1fe40, 0x14d00, 0x1f9c6, 0x1f9e6, 0x1fe48, 0x14d08, 0x1f9ce, 0x1f9ee
.long 0x1fe50, 0x14d10, 0x1f9d6, 0x100000, 0x1fe58, 0x14d18, 0x1f9de, 0x100000
.long 0x1f810, 0x14d00, 0x1f9c0, 0x1f9e0, 0x1f818, 0x14d08, 0x1f9c8, 0x1f9e8
.long 0x1f800, 0x14d10, 0x1f9d0, 0x1f9f0, 0x1f808, 0x14d18, 0x1f9d8, 0x100000
.long 0x1fea0, 0x14d00, 0x1f9c2, 0x1f9e2, 0x1fea8, 0x14d08, 0x1f9ca, 0x1f9ea
.long 0x1feb0, 0x14d10, 0x1f9d2, 0x1f9f2, 0x1feb8, 0x14d18, 0x1f9da, 0x100000
.long 0x1f870, 0x14d00, 0x1f9c4, 0x1f9e4, 0x1f878, 0x14d08, 0x1f9cc, 0x1f9ec
.long 0x1f860, 0x14d10, 0x1f9d4, 0x100000, 0x1f868, 0x14d18, 0x1f9dc, 0x100000
.long 0x1fec0, 0x14d00, 0x1f9c6, 0x1f9e6, 0x1fec8, 0x14d08, 0x1f9ce, 0x1f9ee
.long 0x1fed0, 0x14d10, 0x1f9d6, 0x100000, 0x1fed8, 0x14d18, 0x1f9de, 0x100000
.long 0x0, 0x4444, 0x0, 0xa400, 0x10, 0xeeee, 0x4, 0xa404
.long 0x20, 0x4444, 0x8, 0xa408, 0x30, 0xeeee, 0xc, 0xa40c
.long 0x40, 0x4444, 0x10, 0xa410, 0x50, 0xeeee, 0x14, 0xa414
.long 0x60, 0x4444, 0x18, 0xa418, 0x70, 0xeeee, 0x1c, 0xa41c
.long 0x0, 0x4444, 0x20, 0xa420, 0x10, 0xeeee, 0x24, 0xa424
.long 0x20, 0x4444, 0x28, 0xa428, 0x30, 0xeeee, 0x2c, 0xa42c
.long 0x40, 0x4444, 0x30, 0xa430, 0x50, 0xeeee, 0x34, 0xa434
.long 0x60, 0x4444, 0x38, 0xa438, 0x70, 0xeeee, 0x3c, 0xa43c
.long 0x0, 0x4444, 0x40, 0xa440, 0x10, 0xeeee, 0x44, 0xa444
.long 0x20, 0x4444, 0x48, 0xa448, 0x30, 0xeeee, 0x4c, 0xa44c
.long 0x40, 0x4444, 0x50, 0xa450, 0x50, 0xeeee, 0x54, 0xa454
.long 0x60, 0x4444, 0x58, 0xa458, 0x70, 0xeeee, 0x5c, 0xa45c
.long 0x0, 0x4444, 0x60, 0xa460, 0x10, 0xeeee, 0x64, 0xa464
.long 0x20, 0x4444, 0x68, 0xa468, 0x30, 0xeeee, 0x6c, 0xa46c
.long 0x40, 0x4444, 0x70, 0xa470, 0x50, 0xeeee, 0x74, 0xa474
.long 0x60, 0x4444, 0x78, 0xa478, 0x70, 0xeeee, 0x7c, 0xa47c
.long 0x0, 0x4444, 0x420, 0xb080, 0x10, 0xeeee, 0x424, 0xb084
.long 0x20, 0x4444, 0x428, 0xb088, 0x30, 0xeeee, 0x42c, 0xb08c
.long 0x40, 0x4444, 0x430, 0xb090, 0x50, 0xeeee, 0x434, 0xb094
.long 0x60, 0x4444, 0x438, 0xb098, 0x70, 0xeeee, 0x43c, 0xb09c
.long 0x0, 0x4444, 0x440, 0xb0a0, 0x10, 0xeeee, 0x444, 0xb0a4
.long 0x20, 0x4444, 0x448, 0xb0a8, 0x30, 0xeeee, 0x44c, 0xb0ac
.long 0x40, 0x4444, 0x450, 0xb0b0, 0x50, 0xeeee, 0x454, 0xb0b4
.long 0x60, 0x4444, 0x458, 0xb0b8, 0x70, 0xeeee, 0x45c, 0xb0bc
.long 0x0, 0x4444, 0x460, 0xb0c0, 0x10, 0xeeee, 0x464, 0xb0c4
.long 0x20, 0x4444, 0x468, 0xb0c8, 0x30, 0xeeee, 0x46c, 0xb0cc
.long 0x40, 0x4444, 0x470, 0xb0d0, 0x50, 0xeeee, 0x474, 0xb0d4
.long 0x60, 0x4444, 0x478, 0xb0d8, 0x70, 0xeeee, 0x47c, 0xb0dc
.long 0x0, 0x4444, 0x480, 0xb0e0, 0x10, 0xeeee, 0x484, 0xb0e4
.long 0x20, 0x4444, 0x488, 0xb0e8, 0x30, 0xeeee, 0x48c, 0xb0ec
.long 0x40, 0x4444, 0x490, 0xb0f0, 0x50, 0xeeee, 0x494, 0xb0f4
.long 0x60, 0x4444, 0x498, 0xb0f8, 0x70, 0xeeee, 0x49c, 0xb0fc
.long 0x1fa28, 0x1f9f4, 0x34, 0x14d00, 0x1fa28, 0x1f9f6, 0x74, 0x14d04
.long 0x1fa28, 0x1f9f8, 0xb4, 0x14d08, 0x1fa28, 0x1f9fa, 0xf4, 0x14d0c
.long 0x1fa28, 0x1f9fc, 0x134, 0x14d10, 0x1fa28, 0x1f9fe, 0x174, 0x14d14
.long 0x1fa28, 0x1fa00, 0x1b4, 0x14d18, 0x1fa28, 0x1fa02, 0x1f4, 0x14d1c
.long 0x1fa28, 0x1fa04, 0x234, 0x14d20, 0x1fa28, 0x1fa06, 0x274, 0x14d24
.long 0x1fa28, 0x1fa08, 0x2b4, 0x14d28, 0x1fa28, 0x1fa0a, 0x2f4, 0x14d2c
.long 0x1fa28, 0x1fa0c, 0x334, 0x14d30, 0x1fa28, 0x1fa0e, 0x374, 0x14d34
.long 0x1fa28, 0x1fa10, 0x3b4, 0x14d38, 0x1fa28, 0x1fa12, 0x3f4, 0x14d3c
.long 0x1fa28, 0x1fa14, 0x434, 0x14d00, 0x1fa28, 0x1fa16, 0x474, 0x14d04
.long 0x1fa28, 0x1fa18, 0x4b4, 0x14d08, 0x1fa28, 0x1fa1a, 0x4f4, 0x14d0c
.long 0x1fa28, 0x1fa1c, 0x534, 0x14d10, 0x1fa28, 0x1fa1e, 0x574, 0x14d14
.long 0x1fa28, 0x1fa20, 0x5b4, 0x14d18, 0x1fa28, 0x1fa22, 0x5f4, 0x14d1c
.long 0x1fa28, 0x1fa24, 0x634, 0x14d20, 0x1fa28, 0x1fa26, 0x674, 0x14d24
.long 0x1fa28, 0x1fa28, 0x6b4, 0x14d28, 0x1fa28, 0x1fa2a, 0x6f4, 0x14d2c
.long 0x1fa28, 0x1fa2c, 0x734, 0x14d30, 0x1fa28, 0x1fa2e, 0x774, 0x14d34
.long 0x1fa28, 0x1fa30, 0x7b4, 0x14d38, 0x1fa28, 0x1fa32, 0x7f4, 0x14d3c
.long 0x1fa38, 0x1fa34, 0x834, 0x14d00, 0x1fa38, 0x1fa36, 0x874, 0x14d04
.long 0x1fa38, 0x1fa38, 0x8b4, 0x14d08, 0x1fa38, 0x1fa3a, 0x8f4, 0x14d0c
.long 0x1fa38, 0x1fa3c, 0x934, 0x14d10, 0x1fa38, 0x1fa3e, 0x974, 0x14d14
.long 0x1fa38, 0x1fa40, 0x9b4, 0x14d18, 0x1fa38, 0x1fa42, 0x9f4, 0x14d1c
.long 0x1fa38, 0x1fa44, 0xa34, 0x14d20, 0x1fa38, 0x1fa46, 0xa74, 0x14d24
.long 0x1fa38, 0x1fa48, 0xab4, 0x14d28, 0x1fa38, 0x1fa4a, 0xaf4, 0x14d2c
.long 0x1fa38, 0x1fa4c, 0xb34, 0x14d30, 0x1fa38, 0x1fa4e, 0xb74, 0x14d34
.long 0x1fa38, 0x1fa50, 0xbb4, 0x14d38, 0x1fa38, 0x1fa52, 0xbf4, 0x14d3c
.long 0x1fa38, 0x1fa54, 0xc34, 0x14d00, 0x1fa38, 0x1fa56, 0xc74, 0x14d04
.long 0x1fa38, 0x1fa58, 0xcb4, 0x14d08, 0x1fa38, 0x1fa5a, 0xcf4, 0x14d0c
.long 0x1fa38, 0x1fa5c, 0xd34, 0x14d10, 0x1fa38, 0x1fa5e, 0xd74, 0x14d14
.long 0x1fa38, 0x1fa60, 0xdb4, 0x14d18, 0x1fa38, 0x1fa62, 0xdf4, 0x14d1c
.long 0x1fa38, 0x1fa64, 0xe34, 0x14d20, 0x1fa38, 0x1fa66, 0xe74, 0x14d24
.long 0x1fa38, 0x1fa68, 0xeb4, 0x14d28, 0x1fa38, 0x1fa6a, 0xef4, 0x14d2c
.long 0x1fa38, 0x1fa6c, 0xf34, 0x14d30, 0x1fa38, 0x1fa6e, 0xf74, 0x14d34
.long 0x1fa38, 0x1fa70, 0xfb4, 0x14d38, 0x1fa38, 0x1fa72, 0xff4, 0x14d3c
.long 0x0, 0x0, 0x0, 0x0, 0x0, 0x0, 0x0, 0x0
.long 0x0, 0x0, 0x0, 0x0, 0x0, 0x0, 0x0, 0x0
.long 0x0, 0x0, 0x0, 0x0, 0x0, 0x0, 0x0, 0x0
.long 0x0, 0x0, 0x0, 0x0, 0x0, 0x0, 0x0, 0x0
.long 0x0, 0x0, 0x0, 0x0, 0x0, 0x0, 0x0, 0x0
.long 0x0, 0x0, 0x0, 0x0, 0x0, 0x0, 0x0, 0x0
.long 0x0, 0x0, 0x0, 0x0, 0x0, 0x0, 0x0, 0x0
.long 0x0, 0x0, 0x0, 0x0, 0x0, 0x0, 0x0, 0x0
.long 0x0, 0x0, 0x0, 0x0, 0x0, 0x0, 0x0, 0x0
.long 0x0, 0x0, 0x0, 0x0, 0x0, 0x0, 0x0, 0x0
.long 0x0, 0x0, 0x0, 0x0, 0x0, 0x0, 0x0, 0x0
.long 0x0, 0x0, 0x0, 0x0, 0x0, 0x0, 0x0, 0x0
.long 0x0, 0x0, 0x0, 0x0, 0x0, 0x0, 0x0, 0x0
.long 0x0, 0x0, 0x0, 0x0, 0x0, 0x0, 0x0, 0x0
.long 0x0, 0x0, 0x0, 0x0, 0x0, 0x0, 0x0, 0x0
.long 0x0, 0x0, 0x0, 0x0, 0x0, 0x0, 0x0, 0x0
.long 0x0, 0x0, 0x0, 0x0, 0x0, 0x0, 0x0, 0x0
.long 0x0, 0x0, 0x0, 0x0, 0x0, 0x0, 0x0, 0x0
.long 0x0, 0x0, 0x0, 0x0, 0x0, 0x0, 0x0, 0x0
.long 0x0, 0x0, 0x0, 0x0, 0x0, 0x0, 0x0, 0x0
.long 0x0, 0x0, 0x0, 0x0, 0x0, 0x0, 0x0, 0x0
.long 0x0, 0x0, 0x0, 0x0, 0x0, 0x0, 0x0, 0x0
.long 0x0, 0x0, 0x0, 0x0, 0x0, 0x0, 0x0, 0x0
.long 0x0, 0x0, 0x0, 0x0, 0x0, 0x0, 0x0, 0x0
.long 0x0, 0x0, 0x0, 0x0, 0x0, 0x0, 0x0, 0x0
.long 0x0, 0x0, 0x0, 0x0, 0x0, 0x0, 0x0, 0x0
.long 0x0, 0x0, 0x0, 0x0, 0x0, 0x0, 0x0, 0x0
.long 0x0, 0x0, 0x0, 0x0, 0x0, 0x0, 0x0, 0x0
.long 0x0, 0x0, 0x0, 0x0, 0x0, 0x0, 0x0, 0x0
.long 0x0, 0x0, 0x0, 0x0, 0x0, 0x0, 0x0, 0x0
.long 0x0, 0x0, 0x0, 0x0, 0x0, 0x0, 0x0, 0x0
.long 0x0, 0x0, 0x0, 0x0, 0x0, 0x0, 0x0, 0x0
.long 0x13320, 0xa9b0, 0xa800, 0x10c00, 0xf320, 0xc120, 0x133b0, 0xb690
.long 0xa890, 0x11920, 0xf3b0, 0xce00, 0x12600, 0xa920, 0xb520, 0x10c90
.long 0xe600, 0xc090, 0x12690, 0xb600, 0xb5b0, 0x119b0, 0xe690, 0xcdb0
.long 0xd5f0, 0x11440, 0x117f0, 0x130d0, 0xf8d0, 0xadf0, 0xd640, 0x12160
.long 0x11840, 0x13df0, 0xf960, 0xbad0, 0xc8d0, 0x113f0, 0x124d0, 0x13160
.long 0xebf0, 0xad60, 0xc960, 0x120d0, 0x12560, 0x13e40, 0xec40, 0xba40
.long 0xefb0, 0x10ed0, 0x117b0, 0x12a40, 0xfa90, 0xdb60, 0xc890, 0x10d60
.long 0x10a90, 0x129f0, 0x13bb0, 0xddf0, 0xf000, 0x11bf0, 0x11520, 0xe960
.long 0xc160, 0xf9b0, 0xc920, 0x11a40, 0x10800, 0xe8d0, 0xc3f0, 0x13a90
.long 0xce40, 0xfa00, 0xfff0, 0xbb20, 0xedb0, 0xdad0, 0xced0, 0x10720
.long 0x10040, 0xc800, 0x14890, 0xde40, 0xf560, 0xfbb0, 0x140d0, 0xbdb0
.long 0xb3f0, 0xec00, 0xf5f0, 0x10890, 0x14160, 0xca90, 0xb760, 0x14720
.long 0x13520, 0xddb0, 0xa520, 0xbe00, 0xf490, 0xe800, 0x13690, 0x10490
.long 0xa5b0, 0xcb20, 0xe7b0, 0x14d00, 0x12800, 0xdd20, 0xb200, 0xbe90
.long 0xf800, 0x14320, 0x129b0, 0x10400, 0xb290, 0xcbb0, 0xeb20, 0x14290
.long 0xd560, 0x10760, 0x112d0, 0xaed0, 0xfb60, 0xeed0, 0xd3f0, 0xe040
.long 0x11360, 0xbbf0, 0xee40, 0x14d00, 0xc840, 0x106d0, 0x11ff0, 0xaf60
.long 0xfed0, 0x149f0, 0xc6d0, 0xdff0, 0x12040, 0xbc40, 0xf1f0, 0x14960
.long 0xbbb0, 0x10cd0, 0xfdb0, 0x12960, 0xd3b0, 0xd9f0, 0x13090, 0x11160
.long 0x13e90, 0x12bf0, 0xbff0, 0xd290, 0xbc00, 0x119f0, 0xfb20, 0xe840
.long 0xac90, 0xd840, 0x13120, 0x11e40, 0x13c00, 0xead0, 0xbe40, 0xabb0
.long 0xcf60, 0x11400, 0x101f0, 0xef20, 0x12e90, 0xdd60, 0xccd0, 0xd320
.long 0x10560, 0x14a00, 0xb640, 0x12d20, 0xf640, 0x115b0, 0x142d0, 0xf1b0
.long 0x121b0, 0xdcd0, 0xf3f0, 0xd490, 0x14640, 0x14c90, 0xb5f0, 0x12000
.long 0x13600, 0xf7b0, 0xa490, 0xb120, 0x10d20, 0xc200, 0x135b0, 0xea90
.long 0xa400, 0x14d00, 0x10db0, 0xcf20, 0x12920, 0xf720, 0xaa00, 0x14000
.long 0x11a00, 0xc290, 0x12890, 0xea00, 0xb720, 0x14090, 0x11a90, 0xcfb0
.long 0xd4d0, 0xfa40, 0x11760, 0x123f0, 0x12cd0, 0xaff0, 0xd440, 0xed60
.long 0x116d0, 0x14d00, 0x12d60, 0xbcd0, 0xc7f0, 0xf9f0, 0x118d0, 0x14ad0
.long 0x139f0, 0xb040, 0xc760, 0xecd0, 0x125f0, 0x14b60, 0x13a40, 0xbd60
.long 0xe290, 0x10e40, 0xc9b0, 0x12760, 0xfe00, 0x13640, 0x10df0, 0xd5b0
.long 0xf090, 0x128d0, 0x13f20, 0x138d0, 0xe320, 0x11b60, 0x12640, 0xafb0
.long 0xfe90, 0x14360, 0x11ad0, 0xd600, 0xe560, 0xad20, 0x13fb0, 0x145f0
.long 0xe000, 0xcd60, 0x10920, 0x102d0, 0xa6d0, 0xebb0, 0xd040, 0x12e00
.long 0xfc00, 0x10240, 0xaa40, 0x14690, 0xe1b0, 0xf440, 0x103f0, 0x12320
.long 0xe7f0, 0xee00, 0xf760, 0x12fb0, 0x144d0, 0x125b0, 0xeb60, 0x14920
.long 0x13720, 0x111b0, 0xdb20, 0xf400, 0x11090, 0x11d20, 0x137b0, 0x11e90
.long 0xda90, 0xe720, 0x11db0, 0x14d00, 0x12a00, 0x11120, 0x10200, 0xf5b0
.long 0x11200, 0x14400, 0x12a90, 0x11e00, 0x101b0, 0xe890, 0x11f20, 0x14490
.long 0xd6d0, 0x12e40, 0x108d0, 0xfc40, 0x13240, 0x13ed0, 0xd760, 0x13b60
.long 0x10840, 0xef60, 0x13f60, 0x14d00, 0xc9f0, 0x12df0, 0xe1f0, 0xfad0
.long 0x132d0, 0x14bf0, 0xca40, 0x13ad0, 0xe160, 0xedf0, 0x13ff0, 0x14c40
.long 0x11690, 0x11040, 0xde90, 0xa640, 0x10b20, 0x136d0, 0x109b0, 0x10ff0
.long 0xa5f0, 0xd1b0, 0x10bb0, 0x143f0, 0x11720, 0x11d60, 0xdf20, 0xb360
.long 0xb000, 0x13360, 0x10a00, 0x11cd0, 0xb2d0, 0xd200, 0xb090, 0x14040
.long 0xcbf0, 0xb920, 0xe400, 0x13560, 0xa560, 0xc490, 0xcc40, 0xc600
.long 0x13840, 0x13200, 0xe640, 0xc720, 0xf2d0, 0xba90, 0xdfb0, 0xc040
.long 0xa8d0, 0x11fb0, 0xf360, 0xc7b0, 0xc360, 0x12db0, 0xe9f0, 0x12200
.long 0x13400, 0xc3b0, 0xdc00, 0x10e00, 0xbfb0, 0xcc00, 0x13490, 0xd090
.long 0xdc90, 0x11b20, 0xcc90, 0x14d00, 0x12720, 0xc320, 0x10320, 0x10fb0
.long 0xc400, 0x14120, 0x127b0, 0xd000, 0x103b0, 0x11c90, 0xd120, 0x141b0
.long 0xd1f0, 0xac40, 0x10ad0, 0x13040, 0xab60, 0xb7f0, 0xd240, 0xb960
.long 0x10b60, 0x13d60, 0xb840, 0x14d00, 0xc4d0, 0xabf0, 0xe3f0, 0x12ed0
.long 0xb0d0, 0x146d0, 0xc560, 0xb8d0, 0xe440, 0x13bf0, 0xbdf0, 0x14760
.long 0xfc90, 0x10f60, 0x11290, 0xa840, 0x13d20, 0x104d0, 0x13db0, 0x111f0
.long 0x105b0, 0xa7f0, 0x13c90, 0xf7f0, 0xfd20, 0x11c40, 0x11320, 0xb560
.long 0xae00, 0xff60, 0x13e00, 0x11ed0, 0x10600, 0xb4d0, 0xadb0, 0xf240
.long 0xcdf0, 0xed20, 0x133f0, 0xbd20, 0x12c40, 0x14bb0, 0xd160, 0x14800
.long 0x13440, 0xca00, 0x11f60, 0x14b20, 0xf4d0, 0xee90, 0xbed0, 0xb890
.long 0x12ad0, 0x12490, 0xf840, 0x149b0, 0xbf60, 0xc5b0, 0x11df0, 0x12400
.long 0x12bb0, 0x13800, 0xd920, 0xc000, 0x14600, 0x14d00, 0x13890, 0x14d00
.long 0xd9b0, 0xcd20, 0xc5f0, 0x14d00, 0x13920, 0x145b0, 0x10000, 0xc1b0
.long 0xb1b0, 0x14d00, 0x12c00, 0x14520, 0x10090, 0xce90, 0xfbf0, 0x14d00
.long 0xc640, 0xd2d0, 0x105f0, 0xae40, 0x14cd0, 0x14d00, 0xd360, 0x14d00
.long 0x10640, 0xbb60, 0xbf20, 0x14d00, 0xd7f0, 0x14840, 0xded0, 0xacd0
.long 0x10290, 0x14d00, 0xcad0, 0x147f0, 0xdf60, 0xb9f0, 0x11000, 0x14d00
.long 0x14a90, 0x11240, 0xf890, 0xa760, 0x14d00, 0xaad0, 0x123b0, 0x110d0
.long 0x139b0, 0xa9f0, 0x14d00, 0x12b20, 0x10c40, 0xae90, 0xf920, 0xb440
.long 0xe0d0, 0x14d00, 0x11960, 0xaf20, 0x13a00, 0xb6d0, 0x131f0, 0x14d00
.long 0x13b20, 0xd0d0, 0x135f0, 0xf120, 0x14d00, 0x12440, 0xac00, 0xcb60
.long 0x13960, 0x14c00, 0xf520, 0x14d00, 0xcff0, 0x12120, 0xc0d0, 0xec90
.long 0xda40, 0xe090, 0xf6d0, 0x12290, 0xc440, 0x147b0, 0x14d00, 0x14d00
.long 0xa600, 0xd800, 0xdbb0, 0x10120, 0x0, 0x0, 0xa7b0, 0xff20
.long 0xda00, 0x14d00, 0x0, 0x0, 0xb320, 0xd890, 0xde00, 0x14200
.long 0x0, 0x0, 0xb490, 0xffb0, 0x10520, 0x143b0, 0x0, 0x0
.long 0x11640, 0x109f0, 0x107f0, 0xe240, 0x0, 0x0, 0x114d0, 0xe2d0
.long 0x10960, 0x14d00, 0x0, 0x0, 0x12360, 0x10a40, 0x10bf0, 0x14a40
.long 0x0, 0x0, 0x121f0, 0xe360, 0xe4d0, 0x148d0, 0x0, 0x0
.long 0xbc90, 0x126d0, 0x12c90, 0xa960, 0x0, 0x0, 0x131b0, 0x12b60
.long 0xb7b0, 0xa4d0, 0x0, 0x0, 0xba00, 0xe5f0, 0xa440, 0xaa90
.long 0x0, 0x0, 0x12f20, 0xea40, 0xb160, 0xab20, 0x0, 0x0
.long 0x10360, 0x11600, 0xd720, 0x134d0, 0x0, 0x0, 0x100d0, 0xd520
.long 0x11800, 0x13760, 0x0, 0x0, 0x14440, 0x11890, 0x137f0, 0x12520
.long 0x0, 0x0, 0x141f0, 0xd7b0, 0xc2d0, 0x12090, 0x0, 0x0
.long 0xa720, 0xf200, 0xf600, 0x10f20, 0x0, 0x0, 0xa690, 0xe520
.long 0xf690, 0x11c00, 0x0, 0x0, 0xb400, 0xf290, 0xe920, 0x10e90
.long 0x0, 0x0, 0xb3b0, 0xe5b0, 0xe9b0, 0x11bb0, 0x0, 0x0
.long 0x115f0, 0xfcd0, 0xfdf0, 0x12ff0, 0x0, 0x0, 0x11560, 0xeff0
.long 0xfe40, 0x13cd0, 0x0, 0x0, 0x122d0, 0xfd60, 0xf0d0, 0x12f60
.long 0x0, 0x0, 0x12240, 0xf040, 0xf160, 0x13c40, 0x0, 0x0
.long 0xe3b0, 0x12840, 0x11490, 0xdc40, 0x0, 0x0, 0x127f0, 0xd690
.long 0x107b0, 0xdbf0, 0x0, 0x0, 0xe120, 0xe760, 0xc240, 0x113b0
.long 0x0, 0x0, 0xe6d0, 0xd400, 0xc1f0, 0x10690, 0x0, 0x0
.long 0xe200, 0x10160, 0xb9b0, 0xd8d0, 0x0, 0x0, 0x10440, 0x13000
.long 0xc690, 0xd960, 0x0, 0x0, 0xe490, 0x14240, 0xb1f0, 0xb800
.long 0x0, 0x0, 0x14560, 0x13290, 0xb240, 0xc520, 0x0, 0x0
.long 0x0, 0x0, 0x0, 0x0, 0x0, 0x0, 0x0, 0x0
.long 0x0, 0x0, 0x0, 0x0, 0x0, 0x0, 0x0, 0x0
.long 0x0, 0x0, 0x0, 0x0, 0x0, 0x0, 0x0, 0x0
.long 0x0, 0x0, 0x0, 0x0, 0x0, 0x0, 0x0, 0x0
.long 0x0, 0x0, 0x0, 0x0, 0x0, 0x0, 0x0, 0x0
.long 0x0, 0x0, 0x0, 0x0, 0x0, 0x0, 0x0, 0x0
.long 0x0, 0x0, 0x0, 0x0, 0x0, 0x0, 0x0, 0x0
.long 0x0, 0x0, 0x0, 0x0, 0x0, 0x0, 0x0, 0x0
.long 0x0, 0x0, 0x0, 0x0, 0x0, 0x0, 0x0, 0x0
.long 0x0, 0x0, 0x0, 0x0, 0x0, 0x0, 0x0, 0x0
.long 0x0, 0x0, 0x0, 0x0, 0x0, 0x0, 0x0, 0x0
.long 0x0, 0x0, 0x0, 0x0, 0x0, 0x0, 0x0, 0x0
.long 0x0, 0x0, 0x0, 0x0, 0x0, 0x0, 0x0, 0x0
.long 0x0, 0x0, 0x0, 0x0, 0x0, 0x0, 0x0, 0x0
.long 0x0, 0x0, 0x0, 0x0, 0x0, 0x0, 0x0, 0x0
.long 0x0, 0x0, 0x0, 0x0, 0x0, 0x0, 0x0, 0x0
.long 0x0, 0x0, 0x0, 0x0, 0x0, 0x0, 0x0, 0x0
.long 0x0, 0x0, 0x0, 0x0, 0x0, 0x0, 0x0, 0x0
.long 0x0, 0x0, 0x0, 0x0, 0x0, 0x0, 0x0, 0x0
.long 0x0, 0x0, 0x0, 0x0, 0x0, 0x0, 0x0, 0x0
.long 0x0, 0x0, 0x0, 0x0, 0x0, 0x0, 0x0, 0x0
.long 0x0, 0x0, 0x0, 0x0, 0x0, 0x0, 0x0, 0x0
.long 0x0, 0x0, 0x0, 0x0, 0x0, 0x0, 0x0, 0x0
.long 0x0, 0x0, 0x0, 0x0, 0x0, 0x0, 0x0, 0x0
.long 0x0, 0x0, 0x0, 0x0, 0x0, 0x0, 0x0, 0x0
.long 0x0, 0x0, 0x0, 0x0, 0x0, 0x0, 0x0, 0x0
.long 0x0, 0x0, 0x0, 0x0, 0x0, 0x0, 0x0, 0x0
.long 0x0, 0x0, 0x0, 0x0, 0x0, 0x0, 0x0, 0x0
.long 0x0, 0x0, 0x0, 0x0, 0x0, 0x0, 0x0, 0x0
.long 0x0, 0x0, 0x0, 0x0, 0x0, 0x0, 0x0, 0x0
.long 0x0, 0x0, 0x0, 0x0, 0x0, 0x0, 0x0, 0x0
.long 0x0, 0x0, 0x0, 0x0, 0x0, 0x0, 0x0, 0x0
.section .rodata,"a"
.p2align 6
.amdhsa_kernel standalone__deep_cross_xdeepfm__recsys_kernel
  .amdhsa_next_free_vgpr 256
  .amdhsa_next_free_sgpr 102
  .amdhsa_accum_offset 256
  .amdhsa_group_segment_fixed_size 0
  .amdhsa_kernarg_size 88
  .amdhsa_user_sgpr_count 2
  .amdhsa_user_sgpr_kernarg_segment_ptr 1
  .amdhsa_system_sgpr_workgroup_id_x 1
  .amdhsa_float_denorm_mode_32 3
.end_amdhsa_kernel
```
